```python
import torch

def _softmax(x, axis=-1):
    return torch.softmax(x, dim=axis)
def _gelu(x):
    return torch.nn.functional.gelu(x, approximate="tanh")
def _silu(x):
    return torch.nn.functional.silu(x)
def _sigmoid(x):
    return torch.sigmoid(x)
def _layernorm(x, axis=-1, eps=1e-5):
    m = x.mean(dim=axis, keepdim=True)
    v = x.var(dim=axis, keepdim=True, unbiased=False)
    return (x - m) / torch.sqrt(v + eps)
def _scatter_add(tgt, idx, src, axis=0):
    return tgt.clone().index_add_(axis, idx, src)
def _segment_sum(src, seg, n):
    out = torch.zeros((n,) + src.shape[1:], dtype=src.dtype)
    return out.index_add_(0, seg, src)
def _pad(x, pw):
    flat = tuple(v for pair in reversed(pw) for v in pair)
    return torch.nn.functional.pad(x, flat)

kernel_name = 'concat_heads__gqa_block_cached__compressed_kv_cla__decode'

def setup_inputs():

    _w = (lambda a: (lambda t: t.to(torch.bfloat16) if t.is_floating_point() else t)(torch.as_tensor(a)))
    def _A_setup():
        B, Sq, D = 2, 1, 512
        Hq, Hkv, Sk, Dh = 32, 32, 8192, 128
        assert Hq % Hkv == 0, (Hq, Hkv)
        return {
            "x": _w((lambda *s: torch.randn(*s, dtype=torch.bfloat16) * 1.6)(B, Sq, D)),
            "k_cache": _w((lambda *s: torch.randn(*s, dtype=torch.bfloat16) * 1.6)(B, Hkv, Sk, Dh)),
            "v_cache": _w((lambda *s: torch.randn(*s, dtype=torch.bfloat16) * 0.05)(B, Hkv, Sk, Dh)),
            "wq": _w((lambda *s: torch.randn(*s, dtype=torch.bfloat16) * 1.6)(D, Hq * Dh) * (D ** -0.5)),
            "wo": _w((lambda *s: torch.randn(*s, dtype=torch.bfloat16) * 0.05)(Hq * Dh, D) * ((Hq * Dh) ** -0.5)),
        }
    _A_in = _A_setup()

    def _B_setup():
        B, H, Sq, Sk, D, M = 2, 32, 1, 8192, 128, 512
        Dc = 4 * D
        return {
            "x": _w((lambda *s: torch.randn(*s, dtype=torch.bfloat16) * 3.2)(B, Sq, M)),
            "c_kv": _w((lambda *s: torch.randn(*s, dtype=torch.bfloat16) * 0.1)(B, Sk, Dc)),
            "w_q": _w((lambda *s: torch.randn(*s, dtype=torch.bfloat16) * 6.4)(M, H, D) * (M ** -0.5)),
            "w_uk": _w((lambda *s: torch.randn(*s, dtype=torch.bfloat16) * 6.4)(Dc, H, D) * (Dc ** -0.5)),
            "w_uv": _w((lambda *s: torch.randn(*s, dtype=torch.bfloat16) * 0.1)(Dc, H, D) * (Dc ** -0.5)),
            "w_o": _w((lambda *s: torch.randn(*s, dtype=torch.bfloat16) * 0.1)(H, D, M) * ((H * D) ** -0.5)),
        }
    _B_in = _B_setup()

    return {
        "A_x": _A_in["x"],
        "A_k_cache": _A_in["k_cache"],
        "A_v_cache": _A_in["v_cache"],
        "A_wq": _A_in["wq"],
        "A_wo": _A_in["wo"],
        "B_x": _B_in["x"],
        "B_c_kv": _B_in["c_kv"],
        "B_w_q": _B_in["w_q"],
        "B_w_uk": _B_in["w_uk"],
        "B_w_uv": _B_in["w_uv"],
        "B_w_o": _B_in["w_o"],
    }

def reference(A_x, A_k_cache, A_v_cache, A_wq, A_wo, B_x, B_c_kv, B_w_q, B_w_uk, B_w_uv, B_w_o):
    def _A_ref(x, k_cache, v_cache, wq, wo):
        B, Sq, D = x.shape
        Hq, Dh = 32, 128
        Hkv = k_cache.shape[1]
        rep = Hq // Hkv
        q = (lambda x, *d: x.permute(*d))((x @ wq).reshape(B, Sq, Hq, Dh), 0, 2, 1, 3)
        k = (lambda x, n, axis: torch.repeat_interleave(x, n, dim=axis))(k_cache, rep, axis=1)
        v = (lambda x, n, axis: torch.repeat_interleave(x, n, dim=axis))(v_cache, rep, axis=1)
        scores = torch.einsum("bhqd,bhkd->bhqk", q, k) * (Dh ** -0.5)
        p = _softmax(scores, axis=-1)
        o = torch.einsum("bhqk,bhkd->bhqd", p, v)
        return (lambda x, *d: x.permute(*d))(o, 0, 2, 1, 3).reshape(B, Sq, Hq * Dh) @ wo

    def _B_ref(x, c_kv, w_q, w_uk, w_uv, w_o):
        B, Sq, M = x.shape[0], x.shape[1], x.shape[2]
        Sk = c_kv.shape[1]
        H, D = w_q.shape[1], w_q.shape[2]
        q = torch.einsum("bqm,mhd->bhqd", x, w_q)
        k = torch.einsum("bkc,chd->bhkd", c_kv, w_uk)
        v = torch.einsum("bkc,chd->bhkd", c_kv, w_uv)
        scores = torch.einsum("bhqd,bhkd->bhqk", q, k) * (D ** -0.5)
        off = Sk - Sq
        qi = torch.arange(Sq)[:, None]
        kj = torch.arange(Sk)[None, :]
        cmask = kj <= (qi + off)
        scores = torch.where(cmask[None, None], scores, -1e9)
        p = _softmax(scores, axis=-1)
        ctx = torch.einsum("bhqk,bhkd->bhqd", p, v)
        return torch.einsum("bhqd,hdm->bqm", ctx, w_o)

    a = _A_ref(A_x, A_k_cache, A_v_cache, A_wq, A_wo)
    b = _B_ref(B_x, B_c_kv, B_w_q, B_w_uk, B_w_uv, B_w_o)
    return torch.concatenate([a, b], axis=-1)
```

```asm
; @launch grid=(256,1,1) block=(512,1,1) lds=153600
.amdgcn_target "amdgcn-amd-amdhsa--gfx950"
.text
.globl concat_heads__gqa_block_cached__compressed_kv_cla__decode_kernel
.p2align 8
.type concat_heads__gqa_block_cached__compressed_kv_cla__decode_kernel,@function
concat_heads__gqa_block_cached__compressed_kv_cla__decode_kernel:
s_cmp_ge_u32 s2, 256
s_cbranch_scc1 L_exit
s_load_dwordx16 s[4:19], s[0:1], 0
s_load_dwordx8 s[20:27], s[0:1], 64
s_load_dwordx4 s[28:31], s[0:1], 96
v_lshrrev_b32 v8, 6, v0
s_add_u32 s60, s2, 0
s_and_b32 s60, s60, 7
s_lshr_b32 s61, s2, 3
v_readfirstlane_b32 s34, v8
s_and_b32 s33, s61, 7
s_lshr_b32 s61, s61, 3
s_lshl_b32 s61, s61, 3
s_add_u32 s32, s60, s61
v_and_b32 v1, 63, v0
v_and_b32 v2, 15, v0
v_bfe_u32 v3, v0, 4, 2
v_and_b32 v8, 1, v0
v_lshlrev_b32 v8, 4, v8
v_mov_b32 v9, 0xffff
v_lshlrev_b32 v8, v8, v9
v_bfe_u32 v9, v0, 1, 2
v_cmp_eq_u32 vcc, 0, v9
s_nop 1
v_cndmask_b32 v4, 0, v8, vcc
v_cmp_eq_u32 vcc, 1, v9
s_nop 1
v_cndmask_b32 v5, 0, v8, vcc
v_cmp_eq_u32 vcc, 2, v9
s_nop 1
v_cndmask_b32 v6, 0, v8, vcc
v_cmp_eq_u32 vcc, 3, v9
s_nop 1
v_cndmask_b32 v7, 0, v8, vcc
s_waitcnt lgkmcnt(0)
s_cmp_eq_u32 s33, 6
s_cbranch_scc1 L_roleW
s_cmp_eq_u32 s33, 7
s_cbranch_scc1 L_roleC
L_roleA:
s_cmp_ge_u32 s34, 4
s_cbranch_scc1 L_A_helper
s_lshl_b32 s62, s32, 21
s_sub_u32 s63, 0x8000000, s62
s_add_u32 s40, s6, s62
s_addc_u32 s41, s7, 0
s_and_b32 s41, s41, 0xffff
s_mov_b32 s42, s63
s_mov_b32 s43, 0x20000
s_lshl_b32 s35, s33, 2
s_add_u32 s35, s35, s34
s_lshl_b32 s35, s35, 12
s_mov_b32 s36, s35
v_lshlrev_b32 v8, 4, v1
v_add_u32 v9, 0x4000000, v8
buffer_load_dwordx4 v[64:67], v8, s[40:43], s36 offen offset:0 nt
buffer_load_dwordx4 v[68:71], v8, s[40:43], s36 offen offset:1024 nt
buffer_load_dwordx4 v[72:75], v8, s[40:43], s36 offen offset:2048 nt
buffer_load_dwordx4 v[76:79], v8, s[40:43], s36 offen offset:3072 nt
s_add_u32 s44, s8, s62
s_addc_u32 s45, s9, 0
s_and_b32 s45, s45, 0xffff
s_mov_b32 s46, s63
s_mov_b32 s47, 0x20000
s_mul_i32 s60, s34, 6
s_add_u32 s60, s60, s33
s_lshl_b32 s37, s60, 10
s_add_u32 s37, s37, 0x1f8000
s_mov_b32 s52, 0x555f
s_cmp_lt_u32 s60, 8
s_cselect_b32 s61, 0, 1
s_cselect_b32 s62, 0x200, 0
s_or_b32 s52, s52, s62
s_lshl_b32 s61, s61, 31
s_add_u32 s61, s61, 24576
v_add_u32 v10, s61, v8
s_sub_u32 s60, s60, 8
s_cmp_lt_u32 s60, 8
s_cselect_b32 s61, 0, 1
s_cselect_b32 s62, 0x800, 0
s_or_b32 s52, s52, s62
s_lshl_b32 s61, s61, 31
s_add_u32 s61, s61, 16384
v_add_u32 v11, s61, v9
s_mul_i32 s52, s52, 0x10001
s_mov_b32 s53, s52
s_mov_b32 s48, 0xcccccccc
s_mov_b32 s49, 0xcccccccc
s_mov_b32 s50, 0xaaaaaaaa
s_mov_b32 s51, 0xaaaaaaaa
v_cmp_gt_u32 vcc, 8, v2
v_mov_b32 v47, 0
v_mov_b32 v48, 0
v_mov_b32 v49, 0
v_mov_b32 v50, 0
v_mov_b32 v51, 0
v_cndmask_b32 v12, v4, v47, vcc
v_cndmask_b32 v13, v5, v47, vcc
v_cndmask_b32 v14, v6, v47, vcc
v_cndmask_b32 v15, v7, v47, vcc
v_cndmask_b32 v4, v47, v4, vcc
v_cndmask_b32 v5, v47, v5, vcc
v_cndmask_b32 v6, v47, v6, vcc
v_cndmask_b32 v7, v47, v7, vcc
s_barrier
s_waitcnt vmcnt(3)
buffer_load_dwordx4 v[80:83], v9, s[40:43], s36 offen offset:0 nt
s_waitcnt vmcnt(3)
buffer_load_dwordx4 v[84:87], v9, s[40:43], s36 offen offset:1024 nt
s_waitcnt vmcnt(3)
buffer_load_dwordx4 v[88:91], v9, s[40:43], s36 offen offset:2048 nt
s_waitcnt vmcnt(3)
buffer_load_dwordx4 v[92:95], v9, s[40:43], s36 offen offset:3072 nt
s_waitcnt vmcnt(3)
s_add_u32 s36, s36, 0x18000
buffer_load_dwordx4 v[96:99], v8, s[40:43], s36 offen offset:0 nt
s_waitcnt vmcnt(3)
buffer_load_dwordx4 v[100:103], v8, s[40:43], s36 offen offset:1024 nt
s_waitcnt vmcnt(3)
buffer_load_dwordx4 v[104:107], v8, s[40:43], s36 offen offset:2048 nt
s_waitcnt vmcnt(3)
buffer_load_dwordx4 v[108:111], v8, s[40:43], s36 offen offset:3072 nt
s_waitcnt vmcnt(3)
buffer_load_dwordx4 v[112:115], v9, s[40:43], s36 offen offset:0 nt
s_waitcnt vmcnt(3)
buffer_load_dwordx4 v[116:119], v9, s[40:43], s36 offen offset:1024 nt
s_waitcnt vmcnt(3)
buffer_load_dwordx4 v[120:123], v9, s[40:43], s36 offen offset:2048 nt
s_waitcnt vmcnt(3)
buffer_load_dwordx4 v[124:127], v9, s[40:43], s36 offen offset:3072 nt
s_waitcnt vmcnt(3)
s_add_u32 s36, s36, 0x18000
buffer_load_dwordx4 v[128:131], v8, s[40:43], s36 offen offset:0 nt
s_waitcnt vmcnt(3)
buffer_load_dwordx4 v[132:135], v8, s[40:43], s36 offen offset:1024 nt
s_waitcnt vmcnt(3)
buffer_load_dwordx4 v[136:139], v8, s[40:43], s36 offen offset:2048 nt
s_waitcnt vmcnt(3)
buffer_load_dwordx4 v[140:143], v8, s[40:43], s36 offen offset:3072 nt
s_waitcnt vmcnt(3)
buffer_load_dwordx4 v[144:147], v9, s[40:43], s36 offen offset:0 nt
s_waitcnt vmcnt(3)
buffer_load_dwordx4 v[148:151], v9, s[40:43], s36 offen offset:1024 nt
s_waitcnt vmcnt(3)
buffer_load_dwordx4 v[152:155], v9, s[40:43], s36 offen offset:2048 nt
s_waitcnt vmcnt(3)
buffer_load_dwordx4 v[156:159], v9, s[40:43], s36 offen offset:3072 nt
s_waitcnt vmcnt(3)
s_add_u32 s36, s36, 0x18000
buffer_load_dwordx4 v[160:163], v8, s[40:43], s36 offen offset:0 nt
s_waitcnt vmcnt(3)
buffer_load_dwordx4 v[164:167], v8, s[40:43], s36 offen offset:1024 nt
s_waitcnt vmcnt(3)
buffer_load_dwordx4 v[168:171], v8, s[40:43], s36 offen offset:2048 nt
s_waitcnt vmcnt(3)
buffer_load_dwordx4 v[172:175], v8, s[40:43], s36 offen offset:3072 nt
s_waitcnt vmcnt(3)
buffer_load_dwordx4 v[176:179], v9, s[40:43], s36 offen offset:0 nt
s_waitcnt vmcnt(3)
buffer_load_dwordx4 v[180:183], v9, s[40:43], s36 offen offset:1024 nt
s_waitcnt vmcnt(3)
buffer_load_dwordx4 v[184:187], v9, s[40:43], s36 offen offset:2048 nt
s_waitcnt vmcnt(3)
buffer_load_dwordx4 v[188:191], v9, s[40:43], s36 offen offset:3072 nt
s_mov_b32 s64, 0
L_A_qw:
ds_read_b32 v60, v47 offset:0
s_waitcnt lgkmcnt(0)
v_readfirstlane_b32 s65, v60
s_add_u32 s64, s64, 1
s_nop 2
s_cmp_ge_u32 s65, 4
s_cbranch_scc1 L_A_qw_ok
s_sleep 1
s_cmp_lt_u32 s64, 1048576
s_cbranch_scc1 L_A_qw
L_A_qw_ok:
v_lshlrev_b32 v60, 5, v2
ds_read_b128 v[24:27], v60 offset:1024
ds_read_b128 v[28:31], v60 offset:2048
ds_read_b128 v[36:39], v60 offset:3072
ds_read_b128 v[40:43], v60 offset:4096
s_waitcnt lgkmcnt(2)
v_add_f32 v24, v24, v28
v_add_f32 v25, v25, v29
v_add_f32 v26, v26, v30
v_add_f32 v27, v27, v31
s_waitcnt lgkmcnt(0)
v_add_f32 v36, v36, v40
v_add_f32 v37, v37, v41
v_add_f32 v38, v38, v42
v_add_f32 v39, v39, v43
v_add_f32 v24, v24, v36
v_add_f32 v25, v25, v37
v_add_f32 v26, v26, v38
v_add_f32 v27, v27, v39
v_cvt_pk_bf16_f32 v16, v24, v25
v_cvt_pk_bf16_f32 v17, v26, v27
ds_read_b128 v[24:27], v60 offset:1040
ds_read_b128 v[28:31], v60 offset:2064
ds_read_b128 v[36:39], v60 offset:3088
ds_read_b128 v[40:43], v60 offset:4112
s_waitcnt lgkmcnt(2)
v_add_f32 v24, v24, v28
v_add_f32 v25, v25, v29
v_add_f32 v26, v26, v30
v_add_f32 v27, v27, v31
s_waitcnt lgkmcnt(0)
v_add_f32 v36, v36, v40
v_add_f32 v37, v37, v41
v_add_f32 v38, v38, v42
v_add_f32 v39, v39, v43
v_add_f32 v24, v24, v36
v_add_f32 v25, v25, v37
v_add_f32 v26, v26, v38
v_add_f32 v27, v27, v39
v_cvt_pk_bf16_f32 v18, v24, v25
v_cvt_pk_bf16_f32 v19, v26, v27
ds_read_b128 v[24:27], v60 offset:1536
ds_read_b128 v[28:31], v60 offset:2560
ds_read_b128 v[36:39], v60 offset:3584
ds_read_b128 v[40:43], v60 offset:4608
s_waitcnt lgkmcnt(2)
v_add_f32 v24, v24, v28
v_add_f32 v25, v25, v29
v_add_f32 v26, v26, v30
v_add_f32 v27, v27, v31
s_waitcnt lgkmcnt(0)
v_add_f32 v36, v36, v40
v_add_f32 v37, v37, v41
v_add_f32 v38, v38, v42
v_add_f32 v39, v39, v43
v_add_f32 v24, v24, v36
v_add_f32 v25, v25, v37
v_add_f32 v26, v26, v38
v_add_f32 v27, v27, v39
v_cvt_pk_bf16_f32 v20, v24, v25
v_cvt_pk_bf16_f32 v21, v26, v27
ds_read_b128 v[24:27], v60 offset:1552
ds_read_b128 v[28:31], v60 offset:2576
ds_read_b128 v[36:39], v60 offset:3600
ds_read_b128 v[40:43], v60 offset:4624
s_waitcnt lgkmcnt(2)
v_add_f32 v24, v24, v28
v_add_f32 v25, v25, v29
v_add_f32 v26, v26, v30
v_add_f32 v27, v27, v31
s_waitcnt lgkmcnt(0)
v_add_f32 v36, v36, v40
v_add_f32 v37, v37, v41
v_add_f32 v38, v38, v42
v_add_f32 v39, v39, v43
v_add_f32 v24, v24, v36
v_add_f32 v25, v25, v37
v_add_f32 v26, v26, v38
v_add_f32 v27, v27, v39
v_cvt_pk_bf16_f32 v22, v24, v25
v_cvt_pk_bf16_f32 v23, v26, v27
v_dot2_f32_bf16 v24, v64, v16, 0
v_dot2_f32_bf16 v24, v65, v17, v24
v_dot2_f32_bf16 v24, v66, v18, v24
v_dot2_f32_bf16 v24, v67, v19, v24
s_waitcnt vmcnt(4)
s_add_u32 s36, s36, 0x18000
buffer_load_dwordx4 v[64:67], v8, s[40:43], s36 offen offset:0 nt
v_dot2_f32_bf16 v25, v68, v16, 0
v_dot2_f32_bf16 v25, v69, v17, v25
v_dot2_f32_bf16 v25, v70, v18, v25
v_dot2_f32_bf16 v25, v71, v19, v25
s_waitcnt vmcnt(4)
buffer_load_dwordx4 v[68:71], v8, s[40:43], s36 offen offset:1024 nt
v_add_f32_dpp v28, v24, v24 row_ror:8 row_mask:0xf bank_mask:0x3
v_dot2_f32_bf16 v26, v72, v16, 0
v_dot2_f32_bf16 v26, v73, v17, v26
v_dot2_f32_bf16 v26, v74, v18, v26
v_dot2_f32_bf16 v26, v75, v19, v26
v_add_f32_dpp v28, v25, v25 row_ror:8 row_mask:0xf bank_mask:0xc
s_waitcnt vmcnt(4)
buffer_load_dwordx4 v[72:75], v8, s[40:43], s36 offen offset:2048 nt
v_dot2_f32_bf16 v27, v76, v16, 0
v_dot2_f32_bf16 v27, v77, v17, v27
v_dot2_f32_bf16 v27, v78, v18, v27
v_dot2_f32_bf16 v27, v79, v19, v27
s_waitcnt vmcnt(4)
buffer_load_dwordx4 v[76:79], v8, s[40:43], s36 offen offset:3072 nt
v_add_f32_dpp v29, v26, v26 row_ror:8 row_mask:0xf bank_mask:0x3
v_dot2_f32_bf16 v24, v80, v20, 0
v_dot2_f32_bf16 v24, v81, v21, v24
v_dot2_f32_bf16 v24, v82, v22, v24
v_dot2_f32_bf16 v24, v83, v23, v24
v_add_f32_dpp v29, v27, v27 row_ror:8 row_mask:0xf bank_mask:0xc
s_waitcnt vmcnt(4)
buffer_load_dwordx4 v[80:83], v9, s[40:43], s36 offen offset:0 nt
v_add_f32_dpp v30, v28, v28 row_shl:4 row_mask:0xf bank_mask:0x5
v_dot2_f32_bf16 v25, v84, v20, 0
v_dot2_f32_bf16 v25, v85, v21, v25
v_dot2_f32_bf16 v25, v86, v22, v25
v_dot2_f32_bf16 v25, v87, v23, v25
v_add_f32_dpp v30, v29, v29 row_shr:4 row_mask:0xf bank_mask:0xa
v_add_f32_dpp v28, v24, v24 row_ror:8 row_mask:0xf bank_mask:0x3
v_dot2_f32_bf16 v26, v88, v20, 0
v_dot2_f32_bf16 v26, v89, v21, v26
v_dot2_f32_bf16 v26, v90, v22, v26
v_dot2_f32_bf16 v26, v91, v23, v26
v_add_f32_dpp v28, v25, v25 row_ror:8 row_mask:0xf bank_mask:0xc
v_dot2_f32_bf16 v27, v92, v20, 0
v_dot2_f32_bf16 v27, v93, v21, v27
v_dot2_f32_bf16 v27, v94, v22, v27
v_dot2_f32_bf16 v27, v95, v23, v27
s_waitcnt vmcnt(4)
buffer_load_dwordx4 v[84:87], v9, s[40:43], s36 offen offset:1024 nt
v_add_f32_dpp v29, v26, v26 row_ror:8 row_mask:0xf bank_mask:0x3
v_dot2_f32_bf16 v24, v96, v16, 0
v_dot2_f32_bf16 v24, v97, v17, v24
v_dot2_f32_bf16 v24, v98, v18, v24
v_dot2_f32_bf16 v24, v99, v19, v24
v_add_f32_dpp v29, v27, v27 row_ror:8 row_mask:0xf bank_mask:0xc
v_add_f32_dpp v31, v28, v28 row_shl:4 row_mask:0xf bank_mask:0x5
v_dot2_f32_bf16 v25, v100, v16, 0
v_dot2_f32_bf16 v25, v101, v17, v25
v_dot2_f32_bf16 v25, v102, v18, v25
v_dot2_f32_bf16 v25, v103, v19, v25
v_add_f32_dpp v31, v29, v29 row_shr:4 row_mask:0xf bank_mask:0xa
v_add_f32_dpp v34, v30, v30 quad_perm:[2,3,0,1] row_mask:0xf bank_mask:0xf
v_add_f32_dpp v28, v24, v24 row_ror:8 row_mask:0xf bank_mask:0x3
v_dot2_f32_bf16 v26, v104, v16, 0
v_dot2_f32_bf16 v26, v105, v17, v26
v_dot2_f32_bf16 v26, v106, v18, v26
v_dot2_f32_bf16 v26, v107, v19, v26
v_add_f32_dpp v35, v31, v31 quad_perm:[2,3,0,1] row_mask:0xf bank_mask:0xf
v_cndmask_b32 v32, v34, v35, s[48:49]
v_add_f32_dpp v28, v25, v25 row_ror:8 row_mask:0xf bank_mask:0xc
s_waitcnt vmcnt(4)
buffer_load_dwordx4 v[88:91], v9, s[40:43], s36 offen offset:2048 nt
v_dot2_f32_bf16 v27, v108, v16, 0
v_dot2_f32_bf16 v27, v109, v17, v27
v_dot2_f32_bf16 v27, v110, v18, v27
v_dot2_f32_bf16 v27, v111, v19, v27
v_add_f32_dpp v29, v26, v26 row_ror:8 row_mask:0xf bank_mask:0x3
v_dot2_f32_bf16 v24, v112, v20, 0
v_dot2_f32_bf16 v24, v113, v21, v24
v_dot2_f32_bf16 v24, v114, v22, v24
v_dot2_f32_bf16 v24, v115, v23, v24
v_add_f32_dpp v29, v27, v27 row_ror:8 row_mask:0xf bank_mask:0xc
v_add_f32_dpp v30, v28, v28 row_shl:4 row_mask:0xf bank_mask:0x5
v_dot2_f32_bf16 v25, v116, v20, 0
v_dot2_f32_bf16 v25, v117, v21, v25
v_dot2_f32_bf16 v25, v118, v22, v25
v_dot2_f32_bf16 v25, v119, v23, v25
v_add_f32_dpp v30, v29, v29 row_shr:4 row_mask:0xf bank_mask:0xa
s_waitcnt vmcnt(4)
buffer_load_dwordx4 v[92:95], v9, s[40:43], s36 offen offset:3072 nt
v_add_f32_dpp v28, v24, v24 row_ror:8 row_mask:0xf bank_mask:0x3
v_dot2_f32_bf16 v26, v120, v20, 0
v_dot2_f32_bf16 v26, v121, v21, v26
v_dot2_f32_bf16 v26, v122, v22, v26
v_dot2_f32_bf16 v26, v123, v23, v26
v_add_f32_dpp v28, v25, v25 row_ror:8 row_mask:0xf bank_mask:0xc
v_dot2_f32_bf16 v27, v124, v20, 0
v_dot2_f32_bf16 v27, v125, v21, v27
v_dot2_f32_bf16 v27, v126, v22, v27
v_dot2_f32_bf16 v27, v127, v23, v27
v_add_f32_dpp v29, v26, v26 row_ror:8 row_mask:0xf bank_mask:0x3
v_dot2_f32_bf16 v24, v128, v16, 0
v_dot2_f32_bf16 v24, v129, v17, v24
v_dot2_f32_bf16 v24, v130, v18, v24
v_dot2_f32_bf16 v24, v131, v19, v24
v_add_f32_dpp v29, v27, v27 row_ror:8 row_mask:0xf bank_mask:0xc
s_waitcnt vmcnt(4)
s_add_u32 s36, s36, 0x18000
buffer_load_dwordx4 v[96:99], v8, s[40:43], s36 offen offset:0 nt
v_add_f32_dpp v31, v28, v28 row_shl:4 row_mask:0xf bank_mask:0x5
v_dot2_f32_bf16 v25, v132, v16, 0
v_dot2_f32_bf16 v25, v133, v17, v25
v_dot2_f32_bf16 v25, v134, v18, v25
v_dot2_f32_bf16 v25, v135, v19, v25
v_add_f32_dpp v31, v29, v29 row_shr:4 row_mask:0xf bank_mask:0xa
v_add_f32_dpp v34, v30, v30 quad_perm:[2,3,0,1] row_mask:0xf bank_mask:0xf
v_add_f32_dpp v28, v24, v24 row_ror:8 row_mask:0xf bank_mask:0x3
v_dot2_f32_bf16 v26, v136, v16, 0
v_dot2_f32_bf16 v26, v137, v17, v26
v_dot2_f32_bf16 v26, v138, v18, v26
v_dot2_f32_bf16 v26, v139, v19, v26
v_add_f32_dpp v35, v31, v31 quad_perm:[2,3,0,1] row_mask:0xf bank_mask:0xf
v_cndmask_b32 v33, v34, v35, s[48:49]
v_add_f32_dpp v28, v25, v25 row_ror:8 row_mask:0xf bank_mask:0xc
v_add_f32_dpp v34, v32, v32 quad_perm:[1,0,3,2] row_mask:0xf bank_mask:0xf
v_mov_b32 v36, v37
v_mov_b32 v37, v38
v_mov_b32 v38, v39
v_mov_b32 v39, v40
v_mov_b32 v40, v41
v_mov_b32 v41, v42
v_mov_b32 v42, v43
v_mov_b32 v43, v44
v_mov_b32 v44, v45
v_mov_b32 v45, v46
v_dot2_f32_bf16 v27, v140, v16, 0
v_dot2_f32_bf16 v27, v141, v17, v27
v_dot2_f32_bf16 v27, v142, v18, v27
v_dot2_f32_bf16 v27, v143, v19, v27
v_add_f32_dpp v35, v33, v33 quad_perm:[1,0,3,2] row_mask:0xf bank_mask:0xf
v_cndmask_b32 v46, v34, v35, s[50:51]
s_waitcnt vmcnt(4)
buffer_load_dwordx4 v[100:103], v8, s[40:43], s36 offen offset:1024 nt
v_add_f32_dpp v29, v26, v26 row_ror:8 row_mask:0xf bank_mask:0x3
v_dot2_f32_bf16 v24, v144, v20, 0
v_dot2_f32_bf16 v24, v145, v21, v24
v_dot2_f32_bf16 v24, v146, v22, v24
v_dot2_f32_bf16 v24, v147, v23, v24
v_add_f32_dpp v29, v27, v27 row_ror:8 row_mask:0xf bank_mask:0xc
v_add_f32_dpp v30, v28, v28 row_shl:4 row_mask:0xf bank_mask:0x5
v_dot2_f32_bf16 v25, v148, v20, 0
v_dot2_f32_bf16 v25, v149, v21, v25
v_dot2_f32_bf16 v25, v150, v22, v25
v_dot2_f32_bf16 v25, v151, v23, v25
v_add_f32_dpp v30, v29, v29 row_shr:4 row_mask:0xf bank_mask:0xa
v_add_f32_dpp v28, v24, v24 row_ror:8 row_mask:0xf bank_mask:0x3
v_dot2_f32_bf16 v26, v152, v20, 0
v_dot2_f32_bf16 v26, v153, v21, v26
v_dot2_f32_bf16 v26, v154, v22, v26
v_dot2_f32_bf16 v26, v155, v23, v26
v_add_f32_dpp v28, v25, v25 row_ror:8 row_mask:0xf bank_mask:0xc
s_waitcnt vmcnt(4)
buffer_load_dwordx4 v[104:107], v8, s[40:43], s36 offen offset:2048 nt
v_dot2_f32_bf16 v27, v156, v20, 0
v_dot2_f32_bf16 v27, v157, v21, v27
v_dot2_f32_bf16 v27, v158, v22, v27
v_dot2_f32_bf16 v27, v159, v23, v27
v_add_f32_dpp v29, v26, v26 row_ror:8 row_mask:0xf bank_mask:0x3
v_dot2_f32_bf16 v24, v160, v16, 0
v_dot2_f32_bf16 v24, v161, v17, v24
v_dot2_f32_bf16 v24, v162, v18, v24
v_dot2_f32_bf16 v24, v163, v19, v24
v_add_f32_dpp v29, v27, v27 row_ror:8 row_mask:0xf bank_mask:0xc
v_add_f32_dpp v31, v28, v28 row_shl:4 row_mask:0xf bank_mask:0x5
v_dot2_f32_bf16 v25, v164, v16, 0
v_dot2_f32_bf16 v25, v165, v17, v25
v_dot2_f32_bf16 v25, v166, v18, v25
v_dot2_f32_bf16 v25, v167, v19, v25
v_add_f32_dpp v31, v29, v29 row_shr:4 row_mask:0xf bank_mask:0xa
s_waitcnt vmcnt(4)
buffer_load_dwordx4 v[108:111], v8, s[40:43], s36 offen offset:3072 nt
v_add_f32_dpp v34, v30, v30 quad_perm:[2,3,0,1] row_mask:0xf bank_mask:0xf
v_add_f32_dpp v28, v24, v24 row_ror:8 row_mask:0xf bank_mask:0x3
v_dot2_f32_bf16 v26, v168, v16, 0
v_dot2_f32_bf16 v26, v169, v17, v26
v_dot2_f32_bf16 v26, v170, v18, v26
v_dot2_f32_bf16 v26, v171, v19, v26
v_add_f32_dpp v35, v31, v31 quad_perm:[2,3,0,1] row_mask:0xf bank_mask:0xf
v_cndmask_b32 v32, v34, v35, s[48:49]
v_add_f32_dpp v28, v25, v25 row_ror:8 row_mask:0xf bank_mask:0xc
v_dot2_f32_bf16 v27, v172, v16, 0
v_dot2_f32_bf16 v27, v173, v17, v27
v_dot2_f32_bf16 v27, v174, v18, v27
v_dot2_f32_bf16 v27, v175, v19, v27
v_add_f32_dpp v29, v26, v26 row_ror:8 row_mask:0xf bank_mask:0x3
v_dot2_f32_bf16 v24, v176, v20, 0
v_dot2_f32_bf16 v24, v177, v21, v24
v_dot2_f32_bf16 v24, v178, v22, v24
v_dot2_f32_bf16 v24, v179, v23, v24
v_add_f32_dpp v29, v27, v27 row_ror:8 row_mask:0xf bank_mask:0xc
s_waitcnt vmcnt(4)
buffer_load_dwordx4 v[112:115], v9, s[40:43], s36 offen offset:0 nt
v_add_f32_dpp v30, v28, v28 row_shl:4 row_mask:0xf bank_mask:0x5
v_dot2_f32_bf16 v25, v180, v20, 0
v_dot2_f32_bf16 v25, v181, v21, v25
v_dot2_f32_bf16 v25, v182, v22, v25
v_dot2_f32_bf16 v25, v183, v23, v25
v_add_f32_dpp v30, v29, v29 row_shr:4 row_mask:0xf bank_mask:0xa
v_add_f32_dpp v28, v24, v24 row_ror:8 row_mask:0xf bank_mask:0x3
v_dot2_f32_bf16 v26, v184, v20, 0
v_dot2_f32_bf16 v26, v185, v21, v26
v_dot2_f32_bf16 v26, v186, v22, v26
v_dot2_f32_bf16 v26, v187, v23, v26
v_add_f32_dpp v28, v25, v25 row_ror:8 row_mask:0xf bank_mask:0xc
v_dot2_f32_bf16 v27, v188, v20, 0
v_dot2_f32_bf16 v27, v189, v21, v27
v_dot2_f32_bf16 v27, v190, v22, v27
v_dot2_f32_bf16 v27, v191, v23, v27
s_waitcnt vmcnt(4)
buffer_load_dwordx4 v[116:119], v9, s[40:43], s36 offen offset:1024 nt
v_add_f32_dpp v29, v26, v26 row_ror:8 row_mask:0xf bank_mask:0x3
v_dot2_f32_bf16 v24, v64, v16, 0
v_dot2_f32_bf16 v24, v65, v17, v24
v_dot2_f32_bf16 v24, v66, v18, v24
v_dot2_f32_bf16 v24, v67, v19, v24
v_add_f32_dpp v29, v27, v27 row_ror:8 row_mask:0xf bank_mask:0xc
v_add_f32_dpp v31, v28, v28 row_shl:4 row_mask:0xf bank_mask:0x5
v_dot2_f32_bf16 v25, v68, v16, 0
v_dot2_f32_bf16 v25, v69, v17, v25
v_dot2_f32_bf16 v25, v70, v18, v25
v_dot2_f32_bf16 v25, v71, v19, v25
v_add_f32_dpp v31, v29, v29 row_shr:4 row_mask:0xf bank_mask:0xa
v_add_f32_dpp v34, v30, v30 quad_perm:[2,3,0,1] row_mask:0xf bank_mask:0xf
v_add_f32_dpp v28, v24, v24 row_ror:8 row_mask:0xf bank_mask:0x3
v_dot2_f32_bf16 v26, v72, v16, 0
v_dot2_f32_bf16 v26, v73, v17, v26
v_dot2_f32_bf16 v26, v74, v18, v26
v_dot2_f32_bf16 v26, v75, v19, v26
v_add_f32_dpp v35, v31, v31 quad_perm:[2,3,0,1] row_mask:0xf bank_mask:0xf
v_cndmask_b32 v33, v34, v35, s[48:49]
v_add_f32_dpp v28, v25, v25 row_ror:8 row_mask:0xf bank_mask:0xc
s_waitcnt vmcnt(4)
buffer_load_dwordx4 v[120:123], v9, s[40:43], s36 offen offset:2048 nt
v_add_f32_dpp v34, v32, v32 quad_perm:[1,0,3,2] row_mask:0xf bank_mask:0xf
v_mov_b32 v36, v37
v_mov_b32 v37, v38
v_mov_b32 v38, v39
v_mov_b32 v39, v40
v_mov_b32 v40, v41
v_mov_b32 v41, v42
v_mov_b32 v42, v43
v_mov_b32 v43, v44
v_mov_b32 v44, v45
v_mov_b32 v45, v46
v_dot2_f32_bf16 v27, v76, v16, 0
v_dot2_f32_bf16 v27, v77, v17, v27
v_dot2_f32_bf16 v27, v78, v18, v27
v_dot2_f32_bf16 v27, v79, v19, v27
v_add_f32_dpp v35, v33, v33 quad_perm:[1,0,3,2] row_mask:0xf bank_mask:0xf
v_cndmask_b32 v46, v34, v35, s[50:51]
v_add_f32_dpp v29, v26, v26 row_ror:8 row_mask:0xf bank_mask:0x3
v_dot2_f32_bf16 v24, v80, v20, 0
v_dot2_f32_bf16 v24, v81, v21, v24
v_dot2_f32_bf16 v24, v82, v22, v24
v_dot2_f32_bf16 v24, v83, v23, v24
v_add_f32_dpp v29, v27, v27 row_ror:8 row_mask:0xf bank_mask:0xc
v_add_f32_dpp v30, v28, v28 row_shl:4 row_mask:0xf bank_mask:0x5
v_dot2_f32_bf16 v25, v84, v20, 0
v_dot2_f32_bf16 v25, v85, v21, v25
v_dot2_f32_bf16 v25, v86, v22, v25
v_dot2_f32_bf16 v25, v87, v23, v25
v_add_f32_dpp v30, v29, v29 row_shr:4 row_mask:0xf bank_mask:0xa
s_waitcnt vmcnt(4)
buffer_load_dwordx4 v[124:127], v9, s[40:43], s36 offen offset:3072 nt
v_add_f32_dpp v28, v24, v24 row_ror:8 row_mask:0xf bank_mask:0x3
v_dot2_f32_bf16 v26, v88, v20, 0
v_dot2_f32_bf16 v26, v89, v21, v26
v_dot2_f32_bf16 v26, v90, v22, v26
v_dot2_f32_bf16 v26, v91, v23, v26
v_add_f32_dpp v28, v25, v25 row_ror:8 row_mask:0xf bank_mask:0xc
v_dot2_f32_bf16 v27, v92, v20, 0
v_dot2_f32_bf16 v27, v93, v21, v27
v_dot2_f32_bf16 v27, v94, v22, v27
v_dot2_f32_bf16 v27, v95, v23, v27
s_waitcnt vmcnt(4)
s_add_u32 s36, s36, 0x18000
buffer_load_dwordx4 v[64:67], v8, s[40:43], s36 offen offset:0 nt
v_add_f32_dpp v29, v26, v26 row_ror:8 row_mask:0xf bank_mask:0x3
v_dot2_f32_bf16 v24, v96, v16, 0
v_dot2_f32_bf16 v24, v97, v17, v24
v_dot2_f32_bf16 v24, v98, v18, v24
v_dot2_f32_bf16 v24, v99, v19, v24
v_add_f32_dpp v29, v27, v27 row_ror:8 row_mask:0xf bank_mask:0xc
s_waitcnt vmcnt(4)
buffer_load_dwordx4 v[68:71], v8, s[40:43], s36 offen offset:1024 nt
v_add_f32_dpp v31, v28, v28 row_shl:4 row_mask:0xf bank_mask:0x5
v_dot2_f32_bf16 v25, v100, v16, 0
v_dot2_f32_bf16 v25, v101, v17, v25
v_dot2_f32_bf16 v25, v102, v18, v25
v_dot2_f32_bf16 v25, v103, v19, v25
v_add_f32_dpp v31, v29, v29 row_shr:4 row_mask:0xf bank_mask:0xa
s_waitcnt vmcnt(4)
buffer_load_dwordx4 v[72:75], v8, s[40:43], s36 offen offset:2048 nt
v_add_f32_dpp v34, v30, v30 quad_perm:[2,3,0,1] row_mask:0xf bank_mask:0xf
v_add_f32_dpp v28, v24, v24 row_ror:8 row_mask:0xf bank_mask:0x3
v_dot2_f32_bf16 v26, v104, v16, 0
v_dot2_f32_bf16 v26, v105, v17, v26
v_dot2_f32_bf16 v26, v106, v18, v26
v_dot2_f32_bf16 v26, v107, v19, v26
v_add_f32_dpp v35, v31, v31 quad_perm:[2,3,0,1] row_mask:0xf bank_mask:0xf
v_cndmask_b32 v32, v34, v35, s[48:49]
v_add_f32_dpp v28, v25, v25 row_ror:8 row_mask:0xf bank_mask:0xc
s_waitcnt vmcnt(4)
buffer_load_dwordx4 v[76:79], v8, s[40:43], s36 offen offset:3072 nt
v_dot2_f32_bf16 v27, v108, v16, 0
v_dot2_f32_bf16 v27, v109, v17, v27
v_dot2_f32_bf16 v27, v110, v18, v27
v_dot2_f32_bf16 v27, v111, v19, v27
s_waitcnt vmcnt(4)
buffer_load_dwordx4 v[80:83], v9, s[40:43], s36 offen offset:0 nt
v_add_f32_dpp v29, v26, v26 row_ror:8 row_mask:0xf bank_mask:0x3
v_dot2_f32_bf16 v24, v112, v20, 0
v_dot2_f32_bf16 v24, v113, v21, v24
v_dot2_f32_bf16 v24, v114, v22, v24
v_dot2_f32_bf16 v24, v115, v23, v24
v_add_f32_dpp v29, v27, v27 row_ror:8 row_mask:0xf bank_mask:0xc
s_waitcnt vmcnt(4)
buffer_load_dwordx4 v[84:87], v9, s[40:43], s36 offen offset:1024 nt
v_add_f32_dpp v30, v28, v28 row_shl:4 row_mask:0xf bank_mask:0x5
v_dot2_f32_bf16 v25, v116, v20, 0
v_dot2_f32_bf16 v25, v117, v21, v25
v_dot2_f32_bf16 v25, v118, v22, v25
v_dot2_f32_bf16 v25, v119, v23, v25
v_add_f32_dpp v30, v29, v29 row_shr:4 row_mask:0xf bank_mask:0xa
s_waitcnt vmcnt(4)
buffer_load_dwordx4 v[88:91], v9, s[40:43], s36 offen offset:2048 nt
v_add_f32_dpp v28, v24, v24 row_ror:8 row_mask:0xf bank_mask:0x3
v_dot2_f32_bf16 v26, v120, v20, 0
v_dot2_f32_bf16 v26, v121, v21, v26
v_dot2_f32_bf16 v26, v122, v22, v26
v_dot2_f32_bf16 v26, v123, v23, v26
v_add_f32_dpp v28, v25, v25 row_ror:8 row_mask:0xf bank_mask:0xc
s_waitcnt vmcnt(4)
buffer_load_dwordx4 v[92:95], v9, s[40:43], s36 offen offset:3072 nt
v_dot2_f32_bf16 v27, v124, v20, 0
v_dot2_f32_bf16 v27, v125, v21, v27
v_dot2_f32_bf16 v27, v126, v22, v27
v_dot2_f32_bf16 v27, v127, v23, v27
s_mov_b32 s38, 2
.p2align 6
L_A_ka:
s_waitcnt vmcnt(4)
s_add_u32 s36, s36, 0x18000
buffer_load_dwordx4 v[96:99], v8, s[40:43], s36 offen offset:0 nt
v_add_f32_dpp v29, v26, v26 row_ror:8 row_mask:0xf bank_mask:0x3
v_dot2_f32_bf16 v24, v64, v16, 0
v_dot2_f32_bf16 v24, v65, v17, v24
v_dot2_f32_bf16 v24, v66, v18, v24
v_dot2_f32_bf16 v24, v67, v19, v24
v_add_f32_dpp v29, v27, v27 row_ror:8 row_mask:0xf bank_mask:0xc
s_waitcnt vmcnt(4)
buffer_load_dwordx4 v[100:103], v8, s[40:43], s36 offen offset:1024 nt
v_add_f32_dpp v31, v28, v28 row_shl:4 row_mask:0xf bank_mask:0x5
v_dot2_f32_bf16 v25, v68, v16, 0
v_dot2_f32_bf16 v25, v69, v17, v25
v_dot2_f32_bf16 v25, v70, v18, v25
v_dot2_f32_bf16 v25, v71, v19, v25
v_add_f32_dpp v31, v29, v29 row_shr:4 row_mask:0xf bank_mask:0xa
s_waitcnt vmcnt(4)
buffer_load_dwordx4 v[104:107], v8, s[40:43], s36 offen offset:2048 nt
v_add_f32_dpp v34, v30, v30 quad_perm:[2,3,0,1] row_mask:0xf bank_mask:0xf
v_add_f32_dpp v28, v24, v24 row_ror:8 row_mask:0xf bank_mask:0x3
v_dot2_f32_bf16 v26, v72, v16, 0
v_dot2_f32_bf16 v26, v73, v17, v26
v_dot2_f32_bf16 v26, v74, v18, v26
v_dot2_f32_bf16 v26, v75, v19, v26
v_add_f32_dpp v35, v31, v31 quad_perm:[2,3,0,1] row_mask:0xf bank_mask:0xf
v_cndmask_b32 v33, v34, v35, s[48:49]
v_add_f32_dpp v28, v25, v25 row_ror:8 row_mask:0xf bank_mask:0xc
s_waitcnt vmcnt(4)
buffer_load_dwordx4 v[108:111], v8, s[40:43], s36 offen offset:3072 nt
v_add_f32_dpp v34, v32, v32 quad_perm:[1,0,3,2] row_mask:0xf bank_mask:0xf
v_mov_b32 v36, v37
v_mov_b32 v37, v38
v_mov_b32 v38, v39
v_mov_b32 v39, v40
v_mov_b32 v40, v41
v_mov_b32 v41, v42
v_mov_b32 v42, v43
v_mov_b32 v43, v44
v_mov_b32 v44, v45
v_mov_b32 v45, v46
v_dot2_f32_bf16 v27, v76, v16, 0
v_dot2_f32_bf16 v27, v77, v17, v27
v_dot2_f32_bf16 v27, v78, v18, v27
v_dot2_f32_bf16 v27, v79, v19, v27
v_add_f32_dpp v35, v33, v33 quad_perm:[1,0,3,2] row_mask:0xf bank_mask:0xf
v_cndmask_b32 v46, v34, v35, s[50:51]
s_waitcnt vmcnt(4)
buffer_load_dwordx4 v[112:115], v9, s[40:43], s36 offen offset:0 nt
v_add_f32_dpp v29, v26, v26 row_ror:8 row_mask:0xf bank_mask:0x3
v_dot2_f32_bf16 v24, v80, v20, 0
v_dot2_f32_bf16 v24, v81, v21, v24
v_dot2_f32_bf16 v24, v82, v22, v24
v_dot2_f32_bf16 v24, v83, v23, v24
v_add_f32_dpp v29, v27, v27 row_ror:8 row_mask:0xf bank_mask:0xc
s_waitcnt vmcnt(4)
buffer_load_dwordx4 v[116:119], v9, s[40:43], s36 offen offset:1024 nt
v_add_f32_dpp v30, v28, v28 row_shl:4 row_mask:0xf bank_mask:0x5
v_dot2_f32_bf16 v25, v84, v20, 0
v_dot2_f32_bf16 v25, v85, v21, v25
v_dot2_f32_bf16 v25, v86, v22, v25
v_dot2_f32_bf16 v25, v87, v23, v25
v_add_f32_dpp v30, v29, v29 row_shr:4 row_mask:0xf bank_mask:0xa
s_waitcnt vmcnt(4)
buffer_load_dwordx4 v[120:123], v9, s[40:43], s36 offen offset:2048 nt
v_add_f32_dpp v28, v24, v24 row_ror:8 row_mask:0xf bank_mask:0x3
v_dot2_f32_bf16 v26, v88, v20, 0
v_dot2_f32_bf16 v26, v89, v21, v26
v_dot2_f32_bf16 v26, v90, v22, v26
v_dot2_f32_bf16 v26, v91, v23, v26
v_add_f32_dpp v28, v25, v25 row_ror:8 row_mask:0xf bank_mask:0xc
s_waitcnt vmcnt(4)
buffer_load_dwordx4 v[124:127], v9, s[40:43], s36 offen offset:3072 nt
v_dot2_f32_bf16 v27, v92, v20, 0
v_dot2_f32_bf16 v27, v93, v21, v27
v_dot2_f32_bf16 v27, v94, v22, v27
v_dot2_f32_bf16 v27, v95, v23, v27
s_waitcnt vmcnt(4)
s_add_u32 s36, s36, 0x18000
buffer_load_dwordx4 v[64:67], v8, s[40:43], s36 offen offset:0 nt
v_add_f32_dpp v29, v26, v26 row_ror:8 row_mask:0xf bank_mask:0x3
v_dot2_f32_bf16 v24, v96, v16, 0
v_dot2_f32_bf16 v24, v97, v17, v24
v_dot2_f32_bf16 v24, v98, v18, v24
v_dot2_f32_bf16 v24, v99, v19, v24
v_add_f32_dpp v29, v27, v27 row_ror:8 row_mask:0xf bank_mask:0xc
s_waitcnt vmcnt(4)
buffer_load_dwordx4 v[68:71], v8, s[40:43], s36 offen offset:1024 nt
v_add_f32_dpp v31, v28, v28 row_shl:4 row_mask:0xf bank_mask:0x5
v_dot2_f32_bf16 v25, v100, v16, 0
v_dot2_f32_bf16 v25, v101, v17, v25
v_dot2_f32_bf16 v25, v102, v18, v25
v_dot2_f32_bf16 v25, v103, v19, v25
v_add_f32_dpp v31, v29, v29 row_shr:4 row_mask:0xf bank_mask:0xa
s_waitcnt vmcnt(4)
buffer_load_dwordx4 v[72:75], v8, s[40:43], s36 offen offset:2048 nt
v_add_f32_dpp v34, v30, v30 quad_perm:[2,3,0,1] row_mask:0xf bank_mask:0xf
v_add_f32_dpp v28, v24, v24 row_ror:8 row_mask:0xf bank_mask:0x3
v_dot2_f32_bf16 v26, v104, v16, 0
v_dot2_f32_bf16 v26, v105, v17, v26
v_dot2_f32_bf16 v26, v106, v18, v26
v_dot2_f32_bf16 v26, v107, v19, v26
v_add_f32_dpp v35, v31, v31 quad_perm:[2,3,0,1] row_mask:0xf bank_mask:0xf
v_cndmask_b32 v32, v34, v35, s[48:49]
v_add_f32_dpp v28, v25, v25 row_ror:8 row_mask:0xf bank_mask:0xc
s_waitcnt vmcnt(4)
buffer_load_dwordx4 v[76:79], v8, s[40:43], s36 offen offset:3072 nt
v_dot2_f32_bf16 v27, v108, v16, 0
v_dot2_f32_bf16 v27, v109, v17, v27
v_dot2_f32_bf16 v27, v110, v18, v27
v_dot2_f32_bf16 v27, v111, v19, v27
s_waitcnt vmcnt(4)
buffer_load_dwordx4 v[80:83], v9, s[40:43], s36 offen offset:0 nt
v_add_f32_dpp v29, v26, v26 row_ror:8 row_mask:0xf bank_mask:0x3
v_dot2_f32_bf16 v24, v112, v20, 0
v_dot2_f32_bf16 v24, v113, v21, v24
v_dot2_f32_bf16 v24, v114, v22, v24
v_dot2_f32_bf16 v24, v115, v23, v24
v_add_f32_dpp v29, v27, v27 row_ror:8 row_mask:0xf bank_mask:0xc
s_waitcnt vmcnt(4)
buffer_load_dwordx4 v[84:87], v9, s[40:43], s36 offen offset:1024 nt
v_add_f32_dpp v30, v28, v28 row_shl:4 row_mask:0xf bank_mask:0x5
v_dot2_f32_bf16 v25, v116, v20, 0
v_dot2_f32_bf16 v25, v117, v21, v25
v_dot2_f32_bf16 v25, v118, v22, v25
v_dot2_f32_bf16 v25, v119, v23, v25
v_add_f32_dpp v30, v29, v29 row_shr:4 row_mask:0xf bank_mask:0xa
s_waitcnt vmcnt(4)
buffer_load_dwordx4 v[88:91], v9, s[40:43], s36 offen offset:2048 nt
v_add_f32_dpp v28, v24, v24 row_ror:8 row_mask:0xf bank_mask:0x3
v_dot2_f32_bf16 v26, v120, v20, 0
v_dot2_f32_bf16 v26, v121, v21, v26
v_dot2_f32_bf16 v26, v122, v22, v26
v_dot2_f32_bf16 v26, v123, v23, v26
v_add_f32_dpp v28, v25, v25 row_ror:8 row_mask:0xf bank_mask:0xc
s_waitcnt vmcnt(4)
buffer_load_dwordx4 v[92:95], v9, s[40:43], s36 offen offset:3072 nt
v_dot2_f32_bf16 v27, v124, v20, 0
v_dot2_f32_bf16 v27, v125, v21, v27
v_dot2_f32_bf16 v27, v126, v22, v27
v_dot2_f32_bf16 v27, v127, v23, v27
s_sub_u32 s38, s38, 1
s_cmp_lg_u32 s38, 0
s_cbranch_scc1 L_A_ka
s_mov_b32 s38, 5
.p2align 6
L_A_kb:
s_waitcnt vmcnt(6)
s_add_u32 s36, s36, 0x18000
buffer_load_dwordx4 v[96:99], v8, s[40:43], s36 offen offset:0 nt
v_add_f32_dpp v29, v26, v26 row_ror:8 row_mask:0xf bank_mask:0x3
v_dot2_f32_bf16 v24, v64, v16, 0
v_dot2_f32_bf16 v24, v65, v17, v24
v_dot2_f32_bf16 v24, v66, v18, v24
v_dot2_f32_bf16 v24, v67, v19, v24
v_add_f32_dpp v29, v27, v27 row_ror:8 row_mask:0xf bank_mask:0xc
s_waitcnt vmcnt(6)
buffer_load_dwordx4 v[100:103], v8, s[40:43], s36 offen offset:1024 nt
v_add_f32_dpp v31, v28, v28 row_shl:4 row_mask:0xf bank_mask:0x5
v_dot2_f32_bf16 v25, v68, v16, 0
v_dot2_f32_bf16 v25, v69, v17, v25
v_dot2_f32_bf16 v25, v70, v18, v25
v_dot2_f32_bf16 v25, v71, v19, v25
v_add_f32_dpp v31, v29, v29 row_shr:4 row_mask:0xf bank_mask:0xa
s_waitcnt vmcnt(6)
buffer_load_dwordx4 v[104:107], v8, s[40:43], s36 offen offset:2048 nt
v_add_f32_dpp v34, v30, v30 quad_perm:[2,3,0,1] row_mask:0xf bank_mask:0xf
v_add_f32_dpp v28, v24, v24 row_ror:8 row_mask:0xf bank_mask:0x3
v_dot2_f32_bf16 v26, v72, v16, 0
v_dot2_f32_bf16 v26, v73, v17, v26
v_dot2_f32_bf16 v26, v74, v18, v26
v_dot2_f32_bf16 v26, v75, v19, v26
v_add_f32_dpp v35, v31, v31 quad_perm:[2,3,0,1] row_mask:0xf bank_mask:0xf
v_cndmask_b32 v33, v34, v35, s[48:49]
v_add_f32_dpp v28, v25, v25 row_ror:8 row_mask:0xf bank_mask:0xc
s_waitcnt vmcnt(6)
buffer_load_dwordx4 v[108:111], v8, s[40:43], s36 offen offset:3072 nt
v_add_f32_dpp v34, v32, v32 quad_perm:[1,0,3,2] row_mask:0xf bank_mask:0xf
v_mov_b32 v36, v37
v_mov_b32 v37, v38
v_mov_b32 v38, v39
v_mov_b32 v39, v40
v_mov_b32 v40, v41
v_mov_b32 v41, v42
v_mov_b32 v42, v43
v_mov_b32 v43, v44
v_mov_b32 v44, v45
v_mov_b32 v45, v46
v_dot2_f32_bf16 v27, v76, v16, 0
v_dot2_f32_bf16 v27, v77, v17, v27
v_dot2_f32_bf16 v27, v78, v18, v27
v_dot2_f32_bf16 v27, v79, v19, v27
v_add_f32_dpp v35, v33, v33 quad_perm:[1,0,3,2] row_mask:0xf bank_mask:0xf
v_cndmask_b32 v46, v34, v35, s[50:51]
s_waitcnt vmcnt(6)
buffer_load_dwordx4 v[112:115], v9, s[40:43], s36 offen offset:0 nt
v_add_f32_dpp v29, v26, v26 row_ror:8 row_mask:0xf bank_mask:0x3
v_dot2_f32_bf16 v24, v80, v20, 0
v_dot2_f32_bf16 v24, v81, v21, v24
v_dot2_f32_bf16 v24, v82, v22, v24
v_dot2_f32_bf16 v24, v83, v23, v24
v_add_f32_dpp v29, v27, v27 row_ror:8 row_mask:0xf bank_mask:0xc
s_waitcnt vmcnt(6)
buffer_load_dwordx4 v[116:119], v9, s[40:43], s36 offen offset:1024 nt
v_add_f32_dpp v30, v28, v28 row_shl:4 row_mask:0xf bank_mask:0x5
v_dot2_f32_bf16 v25, v84, v20, 0
v_dot2_f32_bf16 v25, v85, v21, v25
v_dot2_f32_bf16 v25, v86, v22, v25
v_dot2_f32_bf16 v25, v87, v23, v25
v_add_f32_dpp v30, v29, v29 row_shr:4 row_mask:0xf bank_mask:0xa
s_waitcnt vmcnt(6)
buffer_load_dwordx4 v[120:123], v9, s[40:43], s36 offen offset:2048 nt
v_add_f32_dpp v28, v24, v24 row_ror:8 row_mask:0xf bank_mask:0x3
v_dot2_f32_bf16 v26, v88, v20, 0
v_dot2_f32_bf16 v26, v89, v21, v26
v_dot2_f32_bf16 v26, v90, v22, v26
v_dot2_f32_bf16 v26, v91, v23, v26
v_add_f32_dpp v28, v25, v25 row_ror:8 row_mask:0xf bank_mask:0xc
s_waitcnt vmcnt(6)
buffer_load_dwordx4 v[124:127], v9, s[40:43], s36 offen offset:3072 nt
v_dot2_f32_bf16 v27, v92, v20, 0
v_dot2_f32_bf16 v27, v93, v21, v27
v_dot2_f32_bf16 v27, v94, v22, v27
v_dot2_f32_bf16 v27, v95, v23, v27
s_waitcnt vmcnt(6)
s_add_u32 s36, s36, 0x18000
buffer_load_dwordx4 v[64:67], v8, s[40:43], s36 offen offset:0 nt
v_add_f32_dpp v29, v26, v26 row_ror:8 row_mask:0xf bank_mask:0x3
v_dot2_f32_bf16 v24, v96, v16, 0
v_dot2_f32_bf16 v24, v97, v17, v24
v_dot2_f32_bf16 v24, v98, v18, v24
v_dot2_f32_bf16 v24, v99, v19, v24
v_add_f32_dpp v29, v27, v27 row_ror:8 row_mask:0xf bank_mask:0xc
s_waitcnt vmcnt(6)
buffer_load_dwordx4 v[68:71], v8, s[40:43], s36 offen offset:1024 nt
v_add_f32_dpp v31, v28, v28 row_shl:4 row_mask:0xf bank_mask:0x5
v_dot2_f32_bf16 v25, v100, v16, 0
v_dot2_f32_bf16 v25, v101, v17, v25
v_dot2_f32_bf16 v25, v102, v18, v25
v_dot2_f32_bf16 v25, v103, v19, v25
v_add_f32_dpp v31, v29, v29 row_shr:4 row_mask:0xf bank_mask:0xa
s_waitcnt vmcnt(6)
buffer_load_dwordx4 v[72:75], v8, s[40:43], s36 offen offset:2048 nt
v_add_f32_dpp v34, v30, v30 quad_perm:[2,3,0,1] row_mask:0xf bank_mask:0xf
v_add_f32_dpp v28, v24, v24 row_ror:8 row_mask:0xf bank_mask:0x3
v_dot2_f32_bf16 v26, v104, v16, 0
v_dot2_f32_bf16 v26, v105, v17, v26
v_dot2_f32_bf16 v26, v106, v18, v26
v_dot2_f32_bf16 v26, v107, v19, v26
v_add_f32_dpp v35, v31, v31 quad_perm:[2,3,0,1] row_mask:0xf bank_mask:0xf
v_cndmask_b32 v32, v34, v35, s[48:49]
v_add_f32_dpp v28, v25, v25 row_ror:8 row_mask:0xf bank_mask:0xc
s_waitcnt vmcnt(6)
buffer_load_dwordx4 v[76:79], v8, s[40:43], s36 offen offset:3072 nt
v_dot2_f32_bf16 v27, v108, v16, 0
v_dot2_f32_bf16 v27, v109, v17, v27
v_dot2_f32_bf16 v27, v110, v18, v27
v_dot2_f32_bf16 v27, v111, v19, v27
s_waitcnt vmcnt(6)
buffer_load_dwordx4 v[80:83], v9, s[40:43], s36 offen offset:0 nt
v_add_f32_dpp v29, v26, v26 row_ror:8 row_mask:0xf bank_mask:0x3
v_dot2_f32_bf16 v24, v112, v20, 0
v_dot2_f32_bf16 v24, v113, v21, v24
v_dot2_f32_bf16 v24, v114, v22, v24
v_dot2_f32_bf16 v24, v115, v23, v24
v_add_f32_dpp v29, v27, v27 row_ror:8 row_mask:0xf bank_mask:0xc
s_waitcnt vmcnt(6)
buffer_load_dwordx4 v[84:87], v9, s[40:43], s36 offen offset:1024 nt
v_add_f32_dpp v30, v28, v28 row_shl:4 row_mask:0xf bank_mask:0x5
v_dot2_f32_bf16 v25, v116, v20, 0
v_dot2_f32_bf16 v25, v117, v21, v25
v_dot2_f32_bf16 v25, v118, v22, v25
v_dot2_f32_bf16 v25, v119, v23, v25
v_add_f32_dpp v30, v29, v29 row_shr:4 row_mask:0xf bank_mask:0xa
s_waitcnt vmcnt(6)
buffer_load_dwordx4 v[88:91], v9, s[40:43], s36 offen offset:2048 nt
v_add_f32_dpp v28, v24, v24 row_ror:8 row_mask:0xf bank_mask:0x3
v_dot2_f32_bf16 v26, v120, v20, 0
v_dot2_f32_bf16 v26, v121, v21, v26
v_dot2_f32_bf16 v26, v122, v22, v26
v_dot2_f32_bf16 v26, v123, v23, v26
v_add_f32_dpp v28, v25, v25 row_ror:8 row_mask:0xf bank_mask:0xc
s_waitcnt vmcnt(6)
buffer_load_dwordx4 v[92:95], v9, s[40:43], s36 offen offset:3072 nt
v_dot2_f32_bf16 v27, v124, v20, 0
v_dot2_f32_bf16 v27, v125, v21, v27
v_dot2_f32_bf16 v27, v126, v22, v27
v_dot2_f32_bf16 v27, v127, v23, v27
s_sub_u32 s38, s38, 1
s_cmp_lg_u32 s38, 0
s_cbranch_scc1 L_A_kb
s_waitcnt vmcnt(6)
buffer_load_dwordx4 v[96:99], v8, s[40:43], s37 offen nt
v_add_f32_dpp v29, v26, v26 row_ror:8 row_mask:0xf bank_mask:0x3
v_dot2_f32_bf16 v24, v64, v16, 0
v_dot2_f32_bf16 v24, v65, v17, v24
v_dot2_f32_bf16 v24, v66, v18, v24
v_dot2_f32_bf16 v24, v67, v19, v24
v_add_f32_dpp v29, v27, v27 row_ror:8 row_mask:0xf bank_mask:0xc
s_waitcnt vmcnt(6)
buffer_load_dwordx4 v[100:103], v10, s[40:43], s37 offen nt
v_add_f32_dpp v31, v28, v28 row_shl:4 row_mask:0xf bank_mask:0x5
v_dot2_f32_bf16 v25, v68, v16, 0
v_dot2_f32_bf16 v25, v69, v17, v25
v_dot2_f32_bf16 v25, v70, v18, v25
v_dot2_f32_bf16 v25, v71, v19, v25
v_add_f32_dpp v31, v29, v29 row_shr:4 row_mask:0xf bank_mask:0xa
s_waitcnt vmcnt(6)
buffer_load_dwordx4 v[104:107], v9, s[40:43], s37 offen nt
v_add_f32_dpp v34, v30, v30 quad_perm:[2,3,0,1] row_mask:0xf bank_mask:0xf
v_add_f32_dpp v28, v24, v24 row_ror:8 row_mask:0xf bank_mask:0x3
v_dot2_f32_bf16 v26, v72, v16, 0
v_dot2_f32_bf16 v26, v73, v17, v26
v_dot2_f32_bf16 v26, v74, v18, v26
v_dot2_f32_bf16 v26, v75, v19, v26
v_add_f32_dpp v35, v31, v31 quad_perm:[2,3,0,1] row_mask:0xf bank_mask:0xf
v_cndmask_b32 v33, v34, v35, s[48:49]
v_add_f32_dpp v28, v25, v25 row_ror:8 row_mask:0xf bank_mask:0xc
s_waitcnt vmcnt(6)
buffer_load_dwordx4 v[108:111], v11, s[40:43], s37 offen nt
v_add_f32_dpp v34, v32, v32 quad_perm:[1,0,3,2] row_mask:0xf bank_mask:0xf
v_mov_b32 v36, v37
v_mov_b32 v37, v38
v_mov_b32 v38, v39
v_mov_b32 v39, v40
v_mov_b32 v40, v41
v_mov_b32 v41, v42
v_mov_b32 v42, v43
v_mov_b32 v43, v44
v_mov_b32 v44, v45
v_mov_b32 v45, v46
v_dot2_f32_bf16 v27, v76, v16, 0
v_dot2_f32_bf16 v27, v77, v17, v27
v_dot2_f32_bf16 v27, v78, v18, v27
v_dot2_f32_bf16 v27, v79, v19, v27
v_add_f32_dpp v35, v33, v33 quad_perm:[1,0,3,2] row_mask:0xf bank_mask:0xf
v_cndmask_b32 v46, v34, v35, s[50:51]
s_waitcnt vmcnt(6)
s_mov_b32 s36, s35
buffer_load_dwordx4 v[112:115], v8, s[44:47], s36 offen offset:0 nt
v_add_f32_dpp v29, v26, v26 row_ror:8 row_mask:0xf bank_mask:0x3
v_dot2_f32_bf16 v24, v80, v20, 0
v_dot2_f32_bf16 v24, v81, v21, v24
v_dot2_f32_bf16 v24, v82, v22, v24
v_dot2_f32_bf16 v24, v83, v23, v24
v_add_f32_dpp v29, v27, v27 row_ror:8 row_mask:0xf bank_mask:0xc
s_waitcnt vmcnt(6)
buffer_load_dwordx4 v[116:119], v8, s[44:47], s36 offen offset:1024 nt
v_add_f32_dpp v30, v28, v28 row_shl:4 row_mask:0xf bank_mask:0x5
v_dot2_f32_bf16 v25, v84, v20, 0
v_dot2_f32_bf16 v25, v85, v21, v25
v_dot2_f32_bf16 v25, v86, v22, v25
v_dot2_f32_bf16 v25, v87, v23, v25
v_add_f32_dpp v30, v29, v29 row_shr:4 row_mask:0xf bank_mask:0xa
s_waitcnt vmcnt(6)
buffer_load_dwordx4 v[120:123], v8, s[44:47], s36 offen offset:2048 nt
v_add_f32_dpp v28, v24, v24 row_ror:8 row_mask:0xf bank_mask:0x3
v_dot2_f32_bf16 v26, v88, v20, 0
v_dot2_f32_bf16 v26, v89, v21, v26
v_dot2_f32_bf16 v26, v90, v22, v26
v_dot2_f32_bf16 v26, v91, v23, v26
v_add_f32_dpp v28, v25, v25 row_ror:8 row_mask:0xf bank_mask:0xc
s_waitcnt vmcnt(6)
buffer_load_dwordx4 v[124:127], v8, s[44:47], s36 offen offset:3072 nt
v_dot2_f32_bf16 v27, v92, v20, 0
v_dot2_f32_bf16 v27, v93, v21, v27
v_dot2_f32_bf16 v27, v94, v22, v27
v_dot2_f32_bf16 v27, v95, v23, v27
s_waitcnt vmcnt(6)
buffer_load_dwordx4 v[64:67], v9, s[44:47], s36 offen offset:0 nt
v_add_f32_dpp v29, v26, v26 row_ror:8 row_mask:0xf bank_mask:0x3
v_dot2_f32_bf16 v24, v96, v16, 0
v_dot2_f32_bf16 v24, v97, v17, v24
v_dot2_f32_bf16 v24, v98, v18, v24
v_dot2_f32_bf16 v24, v99, v19, v24
v_add_f32_dpp v29, v27, v27 row_ror:8 row_mask:0xf bank_mask:0xc
s_waitcnt vmcnt(6)
buffer_load_dwordx4 v[68:71], v9, s[44:47], s36 offen offset:1024 nt
v_add_f32_dpp v31, v28, v28 row_shl:4 row_mask:0xf bank_mask:0x5
v_dot2_f32_bf16 v25, v100, v16, 0
v_dot2_f32_bf16 v25, v101, v17, v25
v_dot2_f32_bf16 v25, v102, v18, v25
v_dot2_f32_bf16 v25, v103, v19, v25
v_add_f32_dpp v31, v29, v29 row_shr:4 row_mask:0xf bank_mask:0xa
s_waitcnt vmcnt(6)
buffer_load_dwordx4 v[72:75], v9, s[44:47], s36 offen offset:2048 nt
v_add_f32_dpp v34, v30, v30 quad_perm:[2,3,0,1] row_mask:0xf bank_mask:0xf
v_add_f32_dpp v28, v24, v24 row_ror:8 row_mask:0xf bank_mask:0x3
v_dot2_f32_bf16 v26, v104, v20, 0
v_dot2_f32_bf16 v26, v105, v21, v26
v_dot2_f32_bf16 v26, v106, v22, v26
v_dot2_f32_bf16 v26, v107, v23, v26
v_add_f32_dpp v35, v31, v31 quad_perm:[2,3,0,1] row_mask:0xf bank_mask:0xf
v_cndmask_b32 v32, v34, v35, s[48:49]
v_add_f32_dpp v28, v25, v25 row_ror:8 row_mask:0xf bank_mask:0xc
s_waitcnt vmcnt(6)
buffer_load_dwordx4 v[76:79], v9, s[44:47], s36 offen offset:3072 nt
v_dot2_f32_bf16 v27, v108, v20, 0
v_dot2_f32_bf16 v27, v109, v21, v27
v_dot2_f32_bf16 v27, v110, v22, v27
v_dot2_f32_bf16 v27, v111, v23, v27
v_add_f32_dpp v30, v28, v28 row_shl:4 row_mask:0xf bank_mask:0x5
s_nop 2
v_add_f32_dpp v28, v26, v26 row_ror:8 row_mask:0xf bank_mask:0x3
s_nop 1
v_add_f32_dpp v28, v27, v27 row_ror:8 row_mask:0xf bank_mask:0xc
s_nop 2
s_nop 1
v_add_f32_dpp v31, v28, v28 row_shl:4 row_mask:0xf bank_mask:0x5
s_nop 2
v_add_f32_dpp v34, v30, v30 quad_perm:[2,3,0,1] row_mask:0xf bank_mask:0xf
s_nop 1
v_add_f32_dpp v35, v31, v31 quad_perm:[2,3,0,1] row_mask:0xf bank_mask:0xf
v_cndmask_b32 v33, v34, v35, s[48:49]
s_nop 2
v_add_f32_dpp v34, v32, v32 quad_perm:[1,0,3,2] row_mask:0xf bank_mask:0xf
v_mov_b32 v36, v37
v_mov_b32 v37, v38
v_mov_b32 v38, v39
v_mov_b32 v39, v40
v_mov_b32 v40, v41
v_mov_b32 v41, v42
v_mov_b32 v42, v43
v_mov_b32 v43, v44
v_mov_b32 v44, v45
v_mov_b32 v45, v46
s_nop 1
v_add_f32_dpp v35, v33, v33 quad_perm:[1,0,3,2] row_mask:0xf bank_mask:0xf
v_cndmask_b32 v46, v34, v35, s[50:51]
v_mov_b32 v60, 0xff800000
v_cndmask_b32 v46, v60, v46, s[52:53]
v_max3_f32 v60, v36, v37, v38
v_max3_f32 v60, v60, v39, v40
v_max3_f32 v60, v60, v41, v42
v_max3_f32 v60, v60, v43, v44
v_max3_f32 v60, v60, v45, v46
s_waitcnt vmcnt(6)
s_add_u32 s36, s36, 0x18000
buffer_load_dwordx4 v[80:83], v8, s[44:47], s36 offen offset:0 nt
s_nop 1
v_max_f32_dpp v60, v60, v60 quad_perm:[1,0,3,2] row_mask:0xf bank_mask:0xf
s_nop 1
v_max_f32_dpp v60, v60, v60 row_ror:4 row_mask:0xf bank_mask:0xf
s_nop 1
v_max_f32_dpp v60, v60, v60 row_ror:8 row_mask:0xf bank_mask:0xf
v_mov_b32 v34, v60
s_nop 1
v_permlane16_swap_b32 v60, v34
s_nop 0
v_max_f32 v60, v60, v34
v_mov_b32 v34, v60
s_nop 1
v_permlane32_swap_b32 v60, v34
s_nop 0
v_max_f32 v60, v60, v34
s_mov_b32 s62, 0x3e0293ee
v_mul_f32 v60, s62, v60
s_waitcnt vmcnt(6)
buffer_load_dwordx4 v[84:87], v8, s[44:47], s36 offen offset:1024 nt
v_fma_f32 v36, v36, s62, -v60
v_fma_f32 v37, v37, s62, -v60
v_fma_f32 v38, v38, s62, -v60
v_fma_f32 v39, v39, s62, -v60
v_fma_f32 v40, v40, s62, -v60
v_fma_f32 v41, v41, s62, -v60
v_fma_f32 v42, v42, s62, -v60
v_fma_f32 v43, v43, s62, -v60
v_fma_f32 v44, v44, s62, -v60
v_fma_f32 v45, v45, s62, -v60
v_fma_f32 v46, v46, s62, -v60
v_exp_f32 v36, v36
v_exp_f32 v37, v37
v_exp_f32 v38, v38
v_exp_f32 v39, v39
v_exp_f32 v40, v40
v_exp_f32 v41, v41
v_exp_f32 v42, v42
v_exp_f32 v43, v43
v_exp_f32 v44, v44
v_exp_f32 v45, v45
v_exp_f32 v46, v46
s_waitcnt vmcnt(6)
buffer_load_dwordx4 v[88:91], v8, s[44:47], s36 offen offset:2048 nt
v_add_f32 v61, v36, v37
v_add_f32 v61, v61, v38
v_add_f32 v61, v61, v39
v_add_f32 v61, v61, v40
v_add_f32 v61, v61, v41
v_add_f32 v61, v61, v42
v_add_f32 v61, v61, v43
v_add_f32 v61, v61, v44
v_add_f32 v61, v61, v45
v_add_f32 v61, v61, v46
v_cvt_pk_bf16_f32 v36, v36, v36
v_cvt_pk_bf16_f32 v37, v37, v37
v_cvt_pk_bf16_f32 v38, v38, v38
v_cvt_pk_bf16_f32 v39, v39, v39
v_cvt_pk_bf16_f32 v40, v40, v40
v_cvt_pk_bf16_f32 v41, v41, v41
v_cvt_pk_bf16_f32 v42, v42, v42
v_cvt_pk_bf16_f32 v43, v43, v43
v_cvt_pk_bf16_f32 v44, v44, v44
v_cvt_pk_bf16_f32 v45, v45, v45
v_cvt_pk_bf16_f32 v46, v46, v46
s_waitcnt vmcnt(6)
buffer_load_dwordx4 v[92:95], v8, s[44:47], s36 offen offset:3072 nt
s_nop 1
v_add_f32_dpp v61, v61, v61 quad_perm:[1,0,3,2] row_mask:0xf bank_mask:0xf
s_nop 1
v_add_f32_dpp v61, v61, v61 row_ror:4 row_mask:0xf bank_mask:0xf
s_nop 1
v_add_f32_dpp v61, v61, v61 row_ror:8 row_mask:0xf bank_mask:0xf
v_mov_b32 v34, v61
s_nop 1
v_permlane16_swap_b32 v61, v34
s_nop 0
v_add_f32 v61, v61, v34
v_mov_b32 v34, v61
s_nop 1
v_permlane32_swap_b32 v61, v34
s_nop 0
v_add_f32 v61, v61, v34
s_lshl_b32 s62, s34, 2
v_lshl_add_u32 v62, v1, 3, s62
v_mov_b32 v63, 1
s_mov_b64 exec, 5
ds_write_b32 v62, v60 offset:64
ds_write_b32 v62, v61 offset:96
s_mov_b64 exec, 1
ds_add_u32 v47, v63 offset:4
s_mov_b64 exec, -1
v_and_b32_dpp v52, v36, v4 row_newbcast:0 row_mask:0xf bank_mask:0xf
v_and_b32_dpp v53, v36, v5 row_newbcast:0 row_mask:0xf bank_mask:0xf
v_and_b32_dpp v54, v36, v6 row_newbcast:0 row_mask:0xf bank_mask:0xf
v_and_b32_dpp v55, v36, v7 row_newbcast:0 row_mask:0xf bank_mask:0xf
s_mov_b32 s38, 9
.p2align 6
L_A_va:
s_waitcnt vmcnt(6)
buffer_load_dwordx4 v[96:99], v9, s[44:47], s36 offen offset:0 nt
v_mfma_f32_16x16x32_bf16 v[48:51], v[52:55], v[112:115], v[48:51]
v_and_b32_dpp v56, v36, v4 row_newbcast:8 row_mask:0xf bank_mask:0xf
v_and_b32_dpp v57, v36, v5 row_newbcast:8 row_mask:0xf bank_mask:0xf
v_and_b32_dpp v58, v36, v6 row_newbcast:8 row_mask:0xf bank_mask:0xf
v_and_b32_dpp v59, v36, v7 row_newbcast:8 row_mask:0xf bank_mask:0xf
s_waitcnt vmcnt(6)
buffer_load_dwordx4 v[100:103], v9, s[44:47], s36 offen offset:1024 nt
v_mfma_f32_16x16x32_bf16 v[48:51], v[56:59], v[116:119], v[48:51]
v_and_b32_dpp v52, v36, v4 row_newbcast:4 row_mask:0xf bank_mask:0xf
v_and_b32_dpp v53, v36, v5 row_newbcast:4 row_mask:0xf bank_mask:0xf
v_and_b32_dpp v54, v36, v6 row_newbcast:4 row_mask:0xf bank_mask:0xf
v_and_b32_dpp v55, v36, v7 row_newbcast:4 row_mask:0xf bank_mask:0xf
s_waitcnt vmcnt(6)
buffer_load_dwordx4 v[104:107], v9, s[44:47], s36 offen offset:2048 nt
v_mfma_f32_16x16x32_bf16 v[48:51], v[52:55], v[120:123], v[48:51]
v_and_b32_dpp v56, v36, v4 row_newbcast:12 row_mask:0xf bank_mask:0xf
v_and_b32_dpp v57, v36, v5 row_newbcast:12 row_mask:0xf bank_mask:0xf
v_and_b32_dpp v58, v36, v6 row_newbcast:12 row_mask:0xf bank_mask:0xf
v_and_b32_dpp v59, v36, v7 row_newbcast:12 row_mask:0xf bank_mask:0xf
s_waitcnt vmcnt(6)
buffer_load_dwordx4 v[108:111], v9, s[44:47], s36 offen offset:3072 nt
v_mfma_f32_16x16x32_bf16 v[48:51], v[56:59], v[124:127], v[48:51]
v_and_b32_dpp v52, v36, v12 row_newbcast:2 row_mask:0xf bank_mask:0xf
v_and_b32_dpp v53, v36, v13 row_newbcast:2 row_mask:0xf bank_mask:0xf
v_and_b32_dpp v54, v36, v14 row_newbcast:2 row_mask:0xf bank_mask:0xf
v_and_b32_dpp v55, v36, v15 row_newbcast:2 row_mask:0xf bank_mask:0xf
s_waitcnt vmcnt(6)
s_add_u32 s36, s36, 0x18000
buffer_load_dwordx4 v[112:115], v8, s[44:47], s36 offen offset:0 nt
v_mfma_f32_16x16x32_bf16 v[48:51], v[52:55], v[64:67], v[48:51]
v_and_b32_dpp v56, v36, v12 row_newbcast:10 row_mask:0xf bank_mask:0xf
v_and_b32_dpp v57, v36, v13 row_newbcast:10 row_mask:0xf bank_mask:0xf
v_and_b32_dpp v58, v36, v14 row_newbcast:10 row_mask:0xf bank_mask:0xf
v_and_b32_dpp v59, v36, v15 row_newbcast:10 row_mask:0xf bank_mask:0xf
s_waitcnt vmcnt(6)
buffer_load_dwordx4 v[116:119], v8, s[44:47], s36 offen offset:1024 nt
v_mfma_f32_16x16x32_bf16 v[48:51], v[56:59], v[68:71], v[48:51]
v_and_b32_dpp v52, v36, v12 row_newbcast:6 row_mask:0xf bank_mask:0xf
v_and_b32_dpp v53, v36, v13 row_newbcast:6 row_mask:0xf bank_mask:0xf
v_and_b32_dpp v54, v36, v14 row_newbcast:6 row_mask:0xf bank_mask:0xf
v_and_b32_dpp v55, v36, v15 row_newbcast:6 row_mask:0xf bank_mask:0xf
s_waitcnt vmcnt(6)
buffer_load_dwordx4 v[120:123], v8, s[44:47], s36 offen offset:2048 nt
v_mfma_f32_16x16x32_bf16 v[48:51], v[52:55], v[72:75], v[48:51]
v_and_b32_dpp v56, v36, v12 row_newbcast:14 row_mask:0xf bank_mask:0xf
v_and_b32_dpp v57, v36, v13 row_newbcast:14 row_mask:0xf bank_mask:0xf
v_and_b32_dpp v58, v36, v14 row_newbcast:14 row_mask:0xf bank_mask:0xf
v_and_b32_dpp v59, v36, v15 row_newbcast:14 row_mask:0xf bank_mask:0xf
s_waitcnt vmcnt(6)
buffer_load_dwordx4 v[124:127], v8, s[44:47], s36 offen offset:3072 nt
v_mfma_f32_16x16x32_bf16 v[48:51], v[56:59], v[76:79], v[48:51]
v_and_b32_dpp v52, v36, v4 row_newbcast:1 row_mask:0xf bank_mask:0xf
v_and_b32_dpp v53, v36, v5 row_newbcast:1 row_mask:0xf bank_mask:0xf
v_and_b32_dpp v54, v36, v6 row_newbcast:1 row_mask:0xf bank_mask:0xf
v_and_b32_dpp v55, v36, v7 row_newbcast:1 row_mask:0xf bank_mask:0xf
s_waitcnt vmcnt(6)
buffer_load_dwordx4 v[64:67], v9, s[44:47], s36 offen offset:0 nt
v_mfma_f32_16x16x32_bf16 v[48:51], v[52:55], v[80:83], v[48:51]
v_and_b32_dpp v56, v36, v4 row_newbcast:9 row_mask:0xf bank_mask:0xf
v_and_b32_dpp v57, v36, v5 row_newbcast:9 row_mask:0xf bank_mask:0xf
v_and_b32_dpp v58, v36, v6 row_newbcast:9 row_mask:0xf bank_mask:0xf
v_and_b32_dpp v59, v36, v7 row_newbcast:9 row_mask:0xf bank_mask:0xf
s_waitcnt vmcnt(6)
buffer_load_dwordx4 v[68:71], v9, s[44:47], s36 offen offset:1024 nt
v_mfma_f32_16x16x32_bf16 v[48:51], v[56:59], v[84:87], v[48:51]
v_and_b32_dpp v52, v36, v4 row_newbcast:5 row_mask:0xf bank_mask:0xf
v_and_b32_dpp v53, v36, v5 row_newbcast:5 row_mask:0xf bank_mask:0xf
v_and_b32_dpp v54, v36, v6 row_newbcast:5 row_mask:0xf bank_mask:0xf
v_and_b32_dpp v55, v36, v7 row_newbcast:5 row_mask:0xf bank_mask:0xf
s_waitcnt vmcnt(6)
buffer_load_dwordx4 v[72:75], v9, s[44:47], s36 offen offset:2048 nt
v_mfma_f32_16x16x32_bf16 v[48:51], v[52:55], v[88:91], v[48:51]
v_and_b32_dpp v56, v36, v4 row_newbcast:13 row_mask:0xf bank_mask:0xf
v_and_b32_dpp v57, v36, v5 row_newbcast:13 row_mask:0xf bank_mask:0xf
v_and_b32_dpp v58, v36, v6 row_newbcast:13 row_mask:0xf bank_mask:0xf
v_and_b32_dpp v59, v36, v7 row_newbcast:13 row_mask:0xf bank_mask:0xf
s_waitcnt vmcnt(6)
buffer_load_dwordx4 v[76:79], v9, s[44:47], s36 offen offset:3072 nt
v_mfma_f32_16x16x32_bf16 v[48:51], v[56:59], v[92:95], v[48:51]
v_and_b32_dpp v52, v36, v12 row_newbcast:3 row_mask:0xf bank_mask:0xf
v_and_b32_dpp v53, v36, v13 row_newbcast:3 row_mask:0xf bank_mask:0xf
v_and_b32_dpp v54, v36, v14 row_newbcast:3 row_mask:0xf bank_mask:0xf
v_and_b32_dpp v55, v36, v15 row_newbcast:3 row_mask:0xf bank_mask:0xf
s_waitcnt vmcnt(6)
s_add_u32 s36, s36, 0x18000
buffer_load_dwordx4 v[80:83], v8, s[44:47], s36 offen offset:0 nt
v_mfma_f32_16x16x32_bf16 v[48:51], v[52:55], v[96:99], v[48:51]
v_and_b32_dpp v56, v36, v12 row_newbcast:11 row_mask:0xf bank_mask:0xf
v_and_b32_dpp v57, v36, v13 row_newbcast:11 row_mask:0xf bank_mask:0xf
v_and_b32_dpp v58, v36, v14 row_newbcast:11 row_mask:0xf bank_mask:0xf
v_and_b32_dpp v59, v36, v15 row_newbcast:11 row_mask:0xf bank_mask:0xf
s_waitcnt vmcnt(6)
buffer_load_dwordx4 v[84:87], v8, s[44:47], s36 offen offset:1024 nt
v_mfma_f32_16x16x32_bf16 v[48:51], v[56:59], v[100:103], v[48:51]
v_and_b32_dpp v52, v36, v12 row_newbcast:7 row_mask:0xf bank_mask:0xf
v_and_b32_dpp v53, v36, v13 row_newbcast:7 row_mask:0xf bank_mask:0xf
v_and_b32_dpp v54, v36, v14 row_newbcast:7 row_mask:0xf bank_mask:0xf
v_and_b32_dpp v55, v36, v15 row_newbcast:7 row_mask:0xf bank_mask:0xf
s_waitcnt vmcnt(6)
buffer_load_dwordx4 v[88:91], v8, s[44:47], s36 offen offset:2048 nt
v_mfma_f32_16x16x32_bf16 v[48:51], v[52:55], v[104:107], v[48:51]
v_and_b32_dpp v56, v36, v12 row_newbcast:15 row_mask:0xf bank_mask:0xf
v_and_b32_dpp v57, v36, v13 row_newbcast:15 row_mask:0xf bank_mask:0xf
v_and_b32_dpp v58, v36, v14 row_newbcast:15 row_mask:0xf bank_mask:0xf
v_and_b32_dpp v59, v36, v15 row_newbcast:15 row_mask:0xf bank_mask:0xf
s_waitcnt vmcnt(6)
buffer_load_dwordx4 v[92:95], v8, s[44:47], s36 offen offset:3072 nt
v_mfma_f32_16x16x32_bf16 v[48:51], v[56:59], v[108:111], v[48:51]
v_mov_b32 v36, v37
v_mov_b32 v37, v38
v_mov_b32 v38, v39
v_mov_b32 v39, v40
v_mov_b32 v40, v41
v_mov_b32 v41, v42
v_mov_b32 v42, v43
v_mov_b32 v43, v44
v_mov_b32 v44, v45
v_mov_b32 v45, v46
v_and_b32_dpp v52, v36, v4 row_newbcast:0 row_mask:0xf bank_mask:0xf
v_and_b32_dpp v53, v36, v5 row_newbcast:0 row_mask:0xf bank_mask:0xf
v_and_b32_dpp v54, v36, v6 row_newbcast:0 row_mask:0xf bank_mask:0xf
v_and_b32_dpp v55, v36, v7 row_newbcast:0 row_mask:0xf bank_mask:0xf
s_sub_u32 s38, s38, 1
s_cmp_lg_u32 s38, 0
s_cbranch_scc1 L_A_va
s_waitcnt vmcnt(6)
buffer_load_dwordx4 v[96:99], v9, s[44:47], s36 offen offset:0 nt
v_mfma_f32_16x16x32_bf16 v[48:51], v[52:55], v[112:115], v[48:51]
v_and_b32_dpp v56, v36, v4 row_newbcast:8 row_mask:0xf bank_mask:0xf
v_and_b32_dpp v57, v36, v5 row_newbcast:8 row_mask:0xf bank_mask:0xf
v_and_b32_dpp v58, v36, v6 row_newbcast:8 row_mask:0xf bank_mask:0xf
v_and_b32_dpp v59, v36, v7 row_newbcast:8 row_mask:0xf bank_mask:0xf
s_mov_b32 s64, 0
L_A_sw:
ds_read_b32 v60, v47 offset:4
s_waitcnt lgkmcnt(0)
v_readfirstlane_b32 s65, v60
s_add_u32 s64, s64, 1
s_nop 2
s_cmp_ge_u32 s65, 4
s_cbranch_scc1 L_A_sw_ok
s_sleep 1
s_cmp_lt_u32 s64, 1048576
s_cbranch_scc1 L_A_sw
L_A_sw_ok:
v_lshrrev_b32 v60, 1, v3
v_lshlrev_b32 v60, 4, v60
s_lshl_b32 s62, s34, 2
v_add_u32 v61, s62, v60
ds_read_b128 v[24:27], v60 offset:64
ds_read_b32 v63, v61 offset:64
s_waitcnt vmcnt(6)
buffer_load_dwordx4 v[100:103], v9, s[44:47], s36 offen offset:1024 nt
v_mfma_f32_16x16x32_bf16 v[48:51], v[56:59], v[116:119], v[48:51]
v_and_b32_dpp v52, v36, v4 row_newbcast:4 row_mask:0xf bank_mask:0xf
v_and_b32_dpp v53, v36, v5 row_newbcast:4 row_mask:0xf bank_mask:0xf
v_and_b32_dpp v54, v36, v6 row_newbcast:4 row_mask:0xf bank_mask:0xf
v_and_b32_dpp v55, v36, v7 row_newbcast:4 row_mask:0xf bank_mask:0xf
s_waitcnt vmcnt(6)
buffer_load_dwordx4 v[104:107], v9, s[44:47], s36 offen offset:2048 nt
v_mfma_f32_16x16x32_bf16 v[48:51], v[52:55], v[120:123], v[48:51]
v_and_b32_dpp v56, v36, v4 row_newbcast:12 row_mask:0xf bank_mask:0xf
v_and_b32_dpp v57, v36, v5 row_newbcast:12 row_mask:0xf bank_mask:0xf
v_and_b32_dpp v58, v36, v6 row_newbcast:12 row_mask:0xf bank_mask:0xf
v_and_b32_dpp v59, v36, v7 row_newbcast:12 row_mask:0xf bank_mask:0xf
s_waitcnt lgkmcnt(0)
v_max3_f32 v60, v24, v25, v26
v_max_f32 v60, v60, v27
v_sub_f32 v63, v63, v60
v_exp_f32 v63, v63
v_lshrrev_b32 v62, 1, v3
v_mul_u32_u24 v62, 1088, v62
v_lshl_add_u32 v62, v2, 4, v62
v_and_b32 v61, 1, v3
v_lshl_add_u32 v62, v61, 3, v62
s_mul_i32 s62, s34, 272
v_add_u32 v62, s62, v62
s_waitcnt vmcnt(6)
buffer_load_dwordx4 v[108:111], v9, s[44:47], s36 offen offset:3072 nt
v_mfma_f32_16x16x32_bf16 v[48:51], v[56:59], v[124:127], v[48:51]
v_and_b32_dpp v52, v36, v12 row_newbcast:2 row_mask:0xf bank_mask:0xf
v_and_b32_dpp v53, v36, v13 row_newbcast:2 row_mask:0xf bank_mask:0xf
v_and_b32_dpp v54, v36, v14 row_newbcast:2 row_mask:0xf bank_mask:0xf
v_and_b32_dpp v55, v36, v15 row_newbcast:2 row_mask:0xf bank_mask:0xf
s_waitcnt vmcnt(6)
s_add_u32 s36, s36, 0x18000
buffer_load_dwordx4 v[112:115], v8, s[44:47], s36 offen offset:0 nt
v_mfma_f32_16x16x32_bf16 v[48:51], v[52:55], v[64:67], v[48:51]
v_and_b32_dpp v56, v36, v12 row_newbcast:10 row_mask:0xf bank_mask:0xf
v_and_b32_dpp v57, v36, v13 row_newbcast:10 row_mask:0xf bank_mask:0xf
v_and_b32_dpp v58, v36, v14 row_newbcast:10 row_mask:0xf bank_mask:0xf
v_and_b32_dpp v59, v36, v15 row_newbcast:10 row_mask:0xf bank_mask:0xf
s_waitcnt vmcnt(6)
buffer_load_dwordx4 v[116:119], v8, s[44:47], s36 offen offset:1024 nt
v_mfma_f32_16x16x32_bf16 v[48:51], v[56:59], v[68:71], v[48:51]
v_and_b32_dpp v52, v36, v12 row_newbcast:6 row_mask:0xf bank_mask:0xf
v_and_b32_dpp v53, v36, v13 row_newbcast:6 row_mask:0xf bank_mask:0xf
v_and_b32_dpp v54, v36, v14 row_newbcast:6 row_mask:0xf bank_mask:0xf
v_and_b32_dpp v55, v36, v15 row_newbcast:6 row_mask:0xf bank_mask:0xf
s_waitcnt vmcnt(6)
buffer_load_dwordx4 v[120:123], v8, s[44:47], s36 offen offset:2048 nt
v_mfma_f32_16x16x32_bf16 v[48:51], v[52:55], v[72:75], v[48:51]
v_and_b32_dpp v56, v36, v12 row_newbcast:14 row_mask:0xf bank_mask:0xf
v_and_b32_dpp v57, v36, v13 row_newbcast:14 row_mask:0xf bank_mask:0xf
v_and_b32_dpp v58, v36, v14 row_newbcast:14 row_mask:0xf bank_mask:0xf
v_and_b32_dpp v59, v36, v15 row_newbcast:14 row_mask:0xf bank_mask:0xf
s_waitcnt vmcnt(6)
buffer_load_dwordx4 v[124:127], v8, s[44:47], s36 offen offset:3072 nt
v_mfma_f32_16x16x32_bf16 v[48:51], v[56:59], v[76:79], v[48:51]
v_and_b32_dpp v52, v36, v4 row_newbcast:1 row_mask:0xf bank_mask:0xf
v_and_b32_dpp v53, v36, v5 row_newbcast:1 row_mask:0xf bank_mask:0xf
v_and_b32_dpp v54, v36, v6 row_newbcast:1 row_mask:0xf bank_mask:0xf
v_and_b32_dpp v55, v36, v7 row_newbcast:1 row_mask:0xf bank_mask:0xf
s_waitcnt vmcnt(6)
buffer_load_dwordx4 v[64:67], v9, s[44:47], s36 offen offset:0 nt
v_mfma_f32_16x16x32_bf16 v[48:51], v[52:55], v[80:83], v[48:51]
v_and_b32_dpp v56, v36, v4 row_newbcast:9 row_mask:0xf bank_mask:0xf
v_and_b32_dpp v57, v36, v5 row_newbcast:9 row_mask:0xf bank_mask:0xf
v_and_b32_dpp v58, v36, v6 row_newbcast:9 row_mask:0xf bank_mask:0xf
v_and_b32_dpp v59, v36, v7 row_newbcast:9 row_mask:0xf bank_mask:0xf
s_waitcnt vmcnt(6)
buffer_load_dwordx4 v[68:71], v9, s[44:47], s36 offen offset:1024 nt
v_mfma_f32_16x16x32_bf16 v[48:51], v[56:59], v[84:87], v[48:51]
v_and_b32_dpp v52, v36, v4 row_newbcast:5 row_mask:0xf bank_mask:0xf
v_and_b32_dpp v53, v36, v5 row_newbcast:5 row_mask:0xf bank_mask:0xf
v_and_b32_dpp v54, v36, v6 row_newbcast:5 row_mask:0xf bank_mask:0xf
v_and_b32_dpp v55, v36, v7 row_newbcast:5 row_mask:0xf bank_mask:0xf
s_waitcnt vmcnt(6)
buffer_load_dwordx4 v[72:75], v9, s[44:47], s36 offen offset:2048 nt
v_mfma_f32_16x16x32_bf16 v[48:51], v[52:55], v[88:91], v[48:51]
v_and_b32_dpp v56, v36, v4 row_newbcast:13 row_mask:0xf bank_mask:0xf
v_and_b32_dpp v57, v36, v5 row_newbcast:13 row_mask:0xf bank_mask:0xf
v_and_b32_dpp v58, v36, v6 row_newbcast:13 row_mask:0xf bank_mask:0xf
v_and_b32_dpp v59, v36, v7 row_newbcast:13 row_mask:0xf bank_mask:0xf
s_waitcnt vmcnt(6)
buffer_load_dwordx4 v[76:79], v9, s[44:47], s36 offen offset:3072 nt
v_mfma_f32_16x16x32_bf16 v[48:51], v[56:59], v[92:95], v[48:51]
v_and_b32_dpp v52, v36, v12 row_newbcast:3 row_mask:0xf bank_mask:0xf
v_and_b32_dpp v53, v36, v13 row_newbcast:3 row_mask:0xf bank_mask:0xf
v_and_b32_dpp v54, v36, v14 row_newbcast:3 row_mask:0xf bank_mask:0xf
v_and_b32_dpp v55, v36, v15 row_newbcast:3 row_mask:0xf bank_mask:0xf
s_waitcnt vmcnt(6)
buffer_load_dwordx4 v[80:83], v8, s[44:47], s37 offen nt
v_mfma_f32_16x16x32_bf16 v[48:51], v[52:55], v[96:99], v[48:51]
v_and_b32_dpp v56, v36, v12 row_newbcast:11 row_mask:0xf bank_mask:0xf
v_and_b32_dpp v57, v36, v13 row_newbcast:11 row_mask:0xf bank_mask:0xf
v_and_b32_dpp v58, v36, v14 row_newbcast:11 row_mask:0xf bank_mask:0xf
v_and_b32_dpp v59, v36, v15 row_newbcast:11 row_mask:0xf bank_mask:0xf
s_waitcnt vmcnt(6)
buffer_load_dwordx4 v[84:87], v10, s[44:47], s37 offen nt
v_mfma_f32_16x16x32_bf16 v[48:51], v[56:59], v[100:103], v[48:51]
v_and_b32_dpp v52, v36, v12 row_newbcast:7 row_mask:0xf bank_mask:0xf
v_and_b32_dpp v53, v36, v13 row_newbcast:7 row_mask:0xf bank_mask:0xf
v_and_b32_dpp v54, v36, v14 row_newbcast:7 row_mask:0xf bank_mask:0xf
v_and_b32_dpp v55, v36, v15 row_newbcast:7 row_mask:0xf bank_mask:0xf
s_waitcnt vmcnt(6)
buffer_load_dwordx4 v[88:91], v9, s[44:47], s37 offen nt
v_mfma_f32_16x16x32_bf16 v[48:51], v[52:55], v[104:107], v[48:51]
v_and_b32_dpp v56, v36, v12 row_newbcast:15 row_mask:0xf bank_mask:0xf
v_and_b32_dpp v57, v36, v13 row_newbcast:15 row_mask:0xf bank_mask:0xf
v_and_b32_dpp v58, v36, v14 row_newbcast:15 row_mask:0xf bank_mask:0xf
v_and_b32_dpp v59, v36, v15 row_newbcast:15 row_mask:0xf bank_mask:0xf
s_waitcnt vmcnt(6)
buffer_load_dwordx4 v[92:95], v11, s[44:47], s37 offen nt
v_mfma_f32_16x16x32_bf16 v[48:51], v[56:59], v[108:111], v[48:51]
v_mov_b32 v36, v37
v_mov_b32 v37, v38
v_mov_b32 v38, v39
v_mov_b32 v39, v40
v_mov_b32 v40, v41
v_mov_b32 v41, v42
v_mov_b32 v42, v43
v_mov_b32 v43, v44
v_mov_b32 v44, v45
v_mov_b32 v45, v46
v_and_b32_dpp v52, v36, v4 row_newbcast:0 row_mask:0xf bank_mask:0xf
v_and_b32_dpp v53, v36, v5 row_newbcast:0 row_mask:0xf bank_mask:0xf
v_and_b32_dpp v54, v36, v6 row_newbcast:0 row_mask:0xf bank_mask:0xf
v_and_b32_dpp v55, v36, v7 row_newbcast:0 row_mask:0xf bank_mask:0xf
s_nop 0
s_nop 0
v_mfma_f32_16x16x32_bf16 v[48:51], v[52:55], v[112:115], v[48:51]
v_and_b32_dpp v56, v36, v4 row_newbcast:8 row_mask:0xf bank_mask:0xf
v_and_b32_dpp v57, v36, v5 row_newbcast:8 row_mask:0xf bank_mask:0xf
v_and_b32_dpp v58, v36, v6 row_newbcast:8 row_mask:0xf bank_mask:0xf
v_and_b32_dpp v59, v36, v7 row_newbcast:8 row_mask:0xf bank_mask:0xf
s_nop 0
s_nop 0
v_mfma_f32_16x16x32_bf16 v[48:51], v[56:59], v[116:119], v[48:51]
v_and_b32_dpp v52, v36, v4 row_newbcast:4 row_mask:0xf bank_mask:0xf
v_and_b32_dpp v53, v36, v5 row_newbcast:4 row_mask:0xf bank_mask:0xf
v_and_b32_dpp v54, v36, v6 row_newbcast:4 row_mask:0xf bank_mask:0xf
v_and_b32_dpp v55, v36, v7 row_newbcast:4 row_mask:0xf bank_mask:0xf
s_nop 0
s_nop 0
v_mfma_f32_16x16x32_bf16 v[48:51], v[52:55], v[120:123], v[48:51]
v_and_b32_dpp v56, v36, v4 row_newbcast:12 row_mask:0xf bank_mask:0xf
v_and_b32_dpp v57, v36, v5 row_newbcast:12 row_mask:0xf bank_mask:0xf
v_and_b32_dpp v58, v36, v6 row_newbcast:12 row_mask:0xf bank_mask:0xf
v_and_b32_dpp v59, v36, v7 row_newbcast:12 row_mask:0xf bank_mask:0xf
s_nop 0
s_nop 0
v_mfma_f32_16x16x32_bf16 v[48:51], v[56:59], v[124:127], v[48:51]
v_and_b32_dpp v52, v36, v12 row_newbcast:2 row_mask:0xf bank_mask:0xf
v_and_b32_dpp v53, v36, v13 row_newbcast:2 row_mask:0xf bank_mask:0xf
v_and_b32_dpp v54, v36, v14 row_newbcast:2 row_mask:0xf bank_mask:0xf
v_and_b32_dpp v55, v36, v15 row_newbcast:2 row_mask:0xf bank_mask:0xf
s_nop 0
s_nop 0
v_mfma_f32_16x16x32_bf16 v[48:51], v[52:55], v[64:67], v[48:51]
v_and_b32_dpp v56, v36, v12 row_newbcast:10 row_mask:0xf bank_mask:0xf
v_and_b32_dpp v57, v36, v13 row_newbcast:10 row_mask:0xf bank_mask:0xf
v_and_b32_dpp v58, v36, v14 row_newbcast:10 row_mask:0xf bank_mask:0xf
v_and_b32_dpp v59, v36, v15 row_newbcast:10 row_mask:0xf bank_mask:0xf
s_waitcnt vmcnt(6)
s_nop 0
v_mfma_f32_16x16x32_bf16 v[48:51], v[56:59], v[68:71], v[48:51]
v_and_b32_dpp v52, v36, v12 row_newbcast:6 row_mask:0xf bank_mask:0xf
v_and_b32_dpp v53, v36, v13 row_newbcast:6 row_mask:0xf bank_mask:0xf
v_and_b32_dpp v54, v36, v14 row_newbcast:6 row_mask:0xf bank_mask:0xf
v_and_b32_dpp v55, v36, v15 row_newbcast:6 row_mask:0xf bank_mask:0xf
s_waitcnt vmcnt(5)
s_nop 0
v_mfma_f32_16x16x32_bf16 v[48:51], v[52:55], v[72:75], v[48:51]
v_and_b32_dpp v56, v36, v12 row_newbcast:14 row_mask:0xf bank_mask:0xf
v_and_b32_dpp v57, v36, v13 row_newbcast:14 row_mask:0xf bank_mask:0xf
v_and_b32_dpp v58, v36, v14 row_newbcast:14 row_mask:0xf bank_mask:0xf
v_and_b32_dpp v59, v36, v15 row_newbcast:14 row_mask:0xf bank_mask:0xf
s_waitcnt vmcnt(4)
s_nop 0
v_mfma_f32_16x16x32_bf16 v[48:51], v[56:59], v[76:79], v[48:51]
v_and_b32_dpp v52, v36, v4 row_newbcast:1 row_mask:0xf bank_mask:0xf
v_and_b32_dpp v53, v36, v5 row_newbcast:1 row_mask:0xf bank_mask:0xf
v_and_b32_dpp v54, v36, v6 row_newbcast:1 row_mask:0xf bank_mask:0xf
v_and_b32_dpp v55, v36, v7 row_newbcast:1 row_mask:0xf bank_mask:0xf
s_waitcnt vmcnt(3)
s_nop 0
v_mfma_f32_16x16x32_bf16 v[48:51], v[52:55], v[80:83], v[48:51]
v_and_b32_dpp v56, v36, v4 row_newbcast:9 row_mask:0xf bank_mask:0xf
v_and_b32_dpp v57, v36, v5 row_newbcast:9 row_mask:0xf bank_mask:0xf
v_and_b32_dpp v58, v36, v6 row_newbcast:9 row_mask:0xf bank_mask:0xf
v_and_b32_dpp v59, v36, v7 row_newbcast:9 row_mask:0xf bank_mask:0xf
s_waitcnt vmcnt(2)
s_nop 0
v_mfma_f32_16x16x32_bf16 v[48:51], v[56:59], v[84:87], v[48:51]
v_and_b32_dpp v52, v36, v12 row_newbcast:3 row_mask:0xf bank_mask:0xf
v_and_b32_dpp v53, v36, v13 row_newbcast:3 row_mask:0xf bank_mask:0xf
v_and_b32_dpp v54, v36, v14 row_newbcast:3 row_mask:0xf bank_mask:0xf
v_and_b32_dpp v55, v36, v15 row_newbcast:3 row_mask:0xf bank_mask:0xf
s_waitcnt vmcnt(1)
s_nop 0
v_mfma_f32_16x16x32_bf16 v[48:51], v[52:55], v[88:91], v[48:51]
v_and_b32_dpp v56, v36, v12 row_newbcast:11 row_mask:0xf bank_mask:0xf
v_and_b32_dpp v57, v36, v13 row_newbcast:11 row_mask:0xf bank_mask:0xf
v_and_b32_dpp v58, v36, v14 row_newbcast:11 row_mask:0xf bank_mask:0xf
v_and_b32_dpp v59, v36, v15 row_newbcast:11 row_mask:0xf bank_mask:0xf
s_waitcnt vmcnt(0)
s_nop 0
v_mfma_f32_16x16x32_bf16 v[48:51], v[56:59], v[92:95], v[48:51]
s_nop 7
v_mul_f32 v48, v48, v63
v_mul_f32 v49, v49, v63
v_mul_f32 v50, v50, v63
v_mul_f32 v51, v51, v63
v_cvt_pk_bf16_f32 v48, v48, v49
v_cvt_pk_bf16_f32 v49, v50, v51
ds_write_b64 v62, v[48:49] offset:8192
s_waitcnt lgkmcnt(0)
s_barrier
s_endpgm
L_A_helper:
s_sub_u32 s35, s34, 4
s_mov_b32 s44, s4
s_and_b32 s45, s5, 0xffff
s_mov_b32 s46, 0x800
s_mov_b32 s47, 0x20000
s_lshl_b32 s62, s32, 8
s_sub_u32 s63, 0x400000, s62
s_add_u32 s40, s10, s62
s_addc_u32 s41, s11, 0
s_and_b32 s41, s41, 0xffff
s_mov_b32 s42, s63
s_mov_b32 s43, 0x20000
s_and_b32 s36, s33, 3
v_lshrrev_b32 v10, 3, v2
v_lshlrev_b32 v10, 10, v10
v_lshl_add_u32 v10, v3, 6, v10
s_lshl_b32 s62, s35, 8
v_add_u32 v10, s62, v10
v_lshlrev_b32 v9, 18, v3
v_lshl_add_u32 v9, v2, 4, v9
s_lshl_b32 s62, s35, 20
v_add_u32 v9, s62, v9
s_add_u32 s62, s36, 0
s_and_b32 s62, s62, 3
s_lshl_b32 s62, s62, 4
v_add_u32 v11, s62, v10
buffer_load_dwordx4 v[12:15], v11, s[44:47], 0 offen
s_add_u32 s62, s36, 1
s_and_b32 s62, s62, 3
s_lshl_b32 s62, s62, 4
v_add_u32 v11, s62, v10
buffer_load_dwordx4 v[16:19], v11, s[44:47], 0 offen
s_add_u32 s62, s36, 2
s_and_b32 s62, s62, 3
s_lshl_b32 s62, s62, 4
v_add_u32 v11, s62, v10
buffer_load_dwordx4 v[20:23], v11, s[44:47], 0 offen
s_add_u32 s62, s36, 3
s_and_b32 s62, s62, 3
s_lshl_b32 s62, s62, 4
v_add_u32 v11, s62, v10
buffer_load_dwordx4 v[24:27], v11, s[44:47], 0 offen
s_add_u32 s61, s36, 0
s_and_b32 s61, s61, 3
s_lshl_b32 s61, s61, 16
buffer_load_dwordx4 v[56:59], v9, s[40:43], s61 offen
s_add_u32 s61, s61, 0x2000
buffer_load_dwordx4 v[60:63], v9, s[40:43], s61 offen
s_add_u32 s61, s61, 0x2000
buffer_load_dwordx4 v[64:67], v9, s[40:43], s61 offen
s_add_u32 s61, s61, 0x2000
buffer_load_dwordx4 v[68:71], v9, s[40:43], s61 offen
v_mov_b32 v8, 0
v_mov_b32 v11, 0
ds_write_b32 v8, v8 offset:0
ds_write_b32 v8, v8 offset:4
s_waitcnt lgkmcnt(0)
s_barrier
s_mov_b32 s66, 0x01000100
s_mov_b32 s67, 0x03020302
s_waitcnt vmcnt(3)
s_add_u32 s61, s61, 0x2000
buffer_load_dwordx4 v[72:75], v9, s[40:43], s61 offen
v_perm_b32 v10, v12, v12, s66
v_and_b32 v28, v10, v4
v_and_b32 v29, v10, v5
v_and_b32 v30, v10, v6
v_and_b32 v31, v10, v7
s_nop 1
v_mfma_f32_16x16x32_bf16 v[36:39], v[28:31], v[56:59], 0
s_waitcnt vmcnt(3)
s_add_u32 s61, s61, 0x2000
buffer_load_dwordx4 v[76:79], v9, s[40:43], s61 offen
v_perm_b32 v10, v12, v12, s67
v_and_b32 v32, v10, v4
v_and_b32 v33, v10, v5
v_and_b32 v34, v10, v6
v_and_b32 v35, v10, v7
s_nop 1
v_mfma_f32_16x16x32_bf16 v[40:43], v[32:35], v[60:63], 0
s_waitcnt vmcnt(3)
s_add_u32 s61, s61, 0x2000
buffer_load_dwordx4 v[80:83], v9, s[40:43], s61 offen
v_perm_b32 v10, v13, v13, s66
v_and_b32 v28, v10, v4
v_and_b32 v29, v10, v5
v_and_b32 v30, v10, v6
v_and_b32 v31, v10, v7
s_nop 1
v_mfma_f32_16x16x32_bf16 v[36:39], v[28:31], v[64:67], v[36:39]
s_waitcnt vmcnt(3)
s_add_u32 s61, s61, 0x2000
buffer_load_dwordx4 v[84:87], v9, s[40:43], s61 offen
v_perm_b32 v10, v13, v13, s67
v_and_b32 v32, v10, v4
v_and_b32 v33, v10, v5
v_and_b32 v34, v10, v6
v_and_b32 v35, v10, v7
s_nop 1
v_mfma_f32_16x16x32_bf16 v[40:43], v[32:35], v[68:71], v[40:43]
s_waitcnt vmcnt(3)
s_add_u32 s61, s36, 1
s_and_b32 s61, s61, 3
s_lshl_b32 s61, s61, 16
buffer_load_dwordx4 v[88:91], v9, s[40:43], s61 offen
v_perm_b32 v10, v14, v14, s66
v_and_b32 v28, v10, v4
v_and_b32 v29, v10, v5
v_and_b32 v30, v10, v6
v_and_b32 v31, v10, v7
s_nop 1
v_mfma_f32_16x16x32_bf16 v[36:39], v[28:31], v[72:75], v[36:39]
s_waitcnt vmcnt(3)
s_add_u32 s61, s61, 0x2000
buffer_load_dwordx4 v[92:95], v9, s[40:43], s61 offen
v_perm_b32 v10, v14, v14, s67
v_and_b32 v32, v10, v4
v_and_b32 v33, v10, v5
v_and_b32 v34, v10, v6
v_and_b32 v35, v10, v7
s_nop 1
v_mfma_f32_16x16x32_bf16 v[40:43], v[32:35], v[76:79], v[40:43]
s_waitcnt vmcnt(3)
s_add_u32 s61, s61, 0x2000
buffer_load_dwordx4 v[96:99], v9, s[40:43], s61 offen
v_perm_b32 v10, v15, v15, s66
v_and_b32 v28, v10, v4
v_and_b32 v29, v10, v5
v_and_b32 v30, v10, v6
v_and_b32 v31, v10, v7
s_nop 1
v_mfma_f32_16x16x32_bf16 v[36:39], v[28:31], v[80:83], v[36:39]
s_waitcnt vmcnt(3)
s_add_u32 s61, s61, 0x2000
buffer_load_dwordx4 v[100:103], v9, s[40:43], s61 offen
v_perm_b32 v10, v15, v15, s67
v_and_b32 v32, v10, v4
v_and_b32 v33, v10, v5
v_and_b32 v34, v10, v6
v_and_b32 v35, v10, v7
s_nop 1
v_mfma_f32_16x16x32_bf16 v[40:43], v[32:35], v[84:87], v[40:43]
s_waitcnt vmcnt(3)
s_add_u32 s61, s61, 0x2000
buffer_load_dwordx4 v[104:107], v9, s[40:43], s61 offen
v_perm_b32 v10, v16, v16, s66
v_and_b32 v28, v10, v4
v_and_b32 v29, v10, v5
v_and_b32 v30, v10, v6
v_and_b32 v31, v10, v7
s_nop 1
v_mfma_f32_16x16x32_bf16 v[36:39], v[28:31], v[88:91], v[36:39]
s_waitcnt vmcnt(3)
s_add_u32 s61, s61, 0x2000
buffer_load_dwordx4 v[108:111], v9, s[40:43], s61 offen
v_perm_b32 v10, v16, v16, s67
v_and_b32 v32, v10, v4
v_and_b32 v33, v10, v5
v_and_b32 v34, v10, v6
v_and_b32 v35, v10, v7
s_nop 1
v_mfma_f32_16x16x32_bf16 v[40:43], v[32:35], v[92:95], v[40:43]
s_waitcnt vmcnt(3)
s_add_u32 s61, s61, 0x2000
buffer_load_dwordx4 v[112:115], v9, s[40:43], s61 offen
v_perm_b32 v10, v17, v17, s66
v_and_b32 v28, v10, v4
v_and_b32 v29, v10, v5
v_and_b32 v30, v10, v6
v_and_b32 v31, v10, v7
s_nop 1
v_mfma_f32_16x16x32_bf16 v[36:39], v[28:31], v[96:99], v[36:39]
s_waitcnt vmcnt(3)
s_add_u32 s61, s61, 0x2000
buffer_load_dwordx4 v[116:119], v9, s[40:43], s61 offen
v_perm_b32 v10, v17, v17, s67
v_and_b32 v32, v10, v4
v_and_b32 v33, v10, v5
v_and_b32 v34, v10, v6
v_and_b32 v35, v10, v7
s_nop 1
v_mfma_f32_16x16x32_bf16 v[40:43], v[32:35], v[100:103], v[40:43]
s_waitcnt vmcnt(3)
s_add_u32 s61, s36, 2
s_and_b32 s61, s61, 3
s_lshl_b32 s61, s61, 16
buffer_load_dwordx4 v[120:123], v9, s[40:43], s61 offen
v_perm_b32 v10, v18, v18, s66
v_and_b32 v28, v10, v4
v_and_b32 v29, v10, v5
v_and_b32 v30, v10, v6
v_and_b32 v31, v10, v7
s_nop 1
v_mfma_f32_16x16x32_bf16 v[36:39], v[28:31], v[104:107], v[36:39]
s_waitcnt vmcnt(3)
s_add_u32 s61, s61, 0x2000
buffer_load_dwordx4 v[124:127], v9, s[40:43], s61 offen
v_perm_b32 v10, v18, v18, s67
v_and_b32 v32, v10, v4
v_and_b32 v33, v10, v5
v_and_b32 v34, v10, v6
v_and_b32 v35, v10, v7
s_nop 1
v_mfma_f32_16x16x32_bf16 v[40:43], v[32:35], v[108:111], v[40:43]
s_waitcnt vmcnt(3)
s_add_u32 s61, s61, 0x2000
buffer_load_dwordx4 v[128:131], v9, s[40:43], s61 offen
v_perm_b32 v10, v19, v19, s66
v_and_b32 v28, v10, v4
v_and_b32 v29, v10, v5
v_and_b32 v30, v10, v6
v_and_b32 v31, v10, v7
s_nop 1
v_mfma_f32_16x16x32_bf16 v[36:39], v[28:31], v[112:115], v[36:39]
s_waitcnt vmcnt(3)
s_add_u32 s61, s61, 0x2000
buffer_load_dwordx4 v[132:135], v9, s[40:43], s61 offen
v_perm_b32 v10, v19, v19, s67
v_and_b32 v32, v10, v4
v_and_b32 v33, v10, v5
v_and_b32 v34, v10, v6
v_and_b32 v35, v10, v7
s_nop 1
v_mfma_f32_16x16x32_bf16 v[40:43], v[32:35], v[116:119], v[40:43]
s_waitcnt vmcnt(3)
s_add_u32 s61, s61, 0x2000
buffer_load_dwordx4 v[136:139], v9, s[40:43], s61 offen
v_perm_b32 v10, v20, v20, s66
v_and_b32 v28, v10, v4
v_and_b32 v29, v10, v5
v_and_b32 v30, v10, v6
v_and_b32 v31, v10, v7
s_nop 1
v_mfma_f32_16x16x32_bf16 v[36:39], v[28:31], v[120:123], v[36:39]
s_waitcnt vmcnt(3)
s_add_u32 s61, s61, 0x2000
buffer_load_dwordx4 v[140:143], v9, s[40:43], s61 offen
v_perm_b32 v10, v20, v20, s67
v_and_b32 v32, v10, v4
v_and_b32 v33, v10, v5
v_and_b32 v34, v10, v6
v_and_b32 v35, v10, v7
s_nop 1
v_mfma_f32_16x16x32_bf16 v[40:43], v[32:35], v[124:127], v[40:43]
s_waitcnt vmcnt(3)
s_add_u32 s61, s61, 0x2000
buffer_load_dwordx4 v[144:147], v9, s[40:43], s61 offen
v_perm_b32 v10, v21, v21, s66
v_and_b32 v28, v10, v4
v_and_b32 v29, v10, v5
v_and_b32 v30, v10, v6
v_and_b32 v31, v10, v7
s_nop 1
v_mfma_f32_16x16x32_bf16 v[36:39], v[28:31], v[128:131], v[36:39]
s_waitcnt vmcnt(3)
s_add_u32 s61, s61, 0x2000
buffer_load_dwordx4 v[148:151], v9, s[40:43], s61 offen
v_perm_b32 v10, v21, v21, s67
v_and_b32 v32, v10, v4
v_and_b32 v33, v10, v5
v_and_b32 v34, v10, v6
v_and_b32 v35, v10, v7
s_nop 1
v_mfma_f32_16x16x32_bf16 v[40:43], v[32:35], v[132:135], v[40:43]
s_waitcnt vmcnt(3)
s_add_u32 s61, s36, 3
s_and_b32 s61, s61, 3
s_lshl_b32 s61, s61, 16
buffer_load_dwordx4 v[152:155], v9, s[40:43], s61 offen
v_perm_b32 v10, v22, v22, s66
v_and_b32 v28, v10, v4
v_and_b32 v29, v10, v5
v_and_b32 v30, v10, v6
v_and_b32 v31, v10, v7
s_nop 1
v_mfma_f32_16x16x32_bf16 v[36:39], v[28:31], v[136:139], v[36:39]
s_waitcnt vmcnt(3)
s_add_u32 s61, s61, 0x2000
buffer_load_dwordx4 v[156:159], v9, s[40:43], s61 offen
v_perm_b32 v10, v22, v22, s67
v_and_b32 v32, v10, v4
v_and_b32 v33, v10, v5
v_and_b32 v34, v10, v6
v_and_b32 v35, v10, v7
s_nop 1
v_mfma_f32_16x16x32_bf16 v[40:43], v[32:35], v[140:143], v[40:43]
s_waitcnt vmcnt(3)
s_add_u32 s61, s61, 0x2000
buffer_load_dwordx4 v[160:163], v9, s[40:43], s61 offen
v_perm_b32 v10, v23, v23, s66
v_and_b32 v28, v10, v4
v_and_b32 v29, v10, v5
v_and_b32 v30, v10, v6
v_and_b32 v31, v10, v7
s_nop 1
v_mfma_f32_16x16x32_bf16 v[36:39], v[28:31], v[144:147], v[36:39]
s_waitcnt vmcnt(3)
s_add_u32 s61, s61, 0x2000
buffer_load_dwordx4 v[164:167], v9, s[40:43], s61 offen
v_perm_b32 v10, v23, v23, s67
v_and_b32 v32, v10, v4
v_and_b32 v33, v10, v5
v_and_b32 v34, v10, v6
v_and_b32 v35, v10, v7
s_nop 1
v_mfma_f32_16x16x32_bf16 v[40:43], v[32:35], v[148:151], v[40:43]
s_waitcnt vmcnt(3)
s_add_u32 s61, s61, 0x2000
buffer_load_dwordx4 v[168:171], v9, s[40:43], s61 offen
v_perm_b32 v10, v24, v24, s66
v_and_b32 v28, v10, v4
v_and_b32 v29, v10, v5
v_and_b32 v30, v10, v6
v_and_b32 v31, v10, v7
s_nop 1
v_mfma_f32_16x16x32_bf16 v[36:39], v[28:31], v[152:155], v[36:39]
s_waitcnt vmcnt(3)
s_add_u32 s61, s61, 0x2000
buffer_load_dwordx4 v[172:175], v9, s[40:43], s61 offen
v_perm_b32 v10, v24, v24, s67
v_and_b32 v32, v10, v4
v_and_b32 v33, v10, v5
v_and_b32 v34, v10, v6
v_and_b32 v35, v10, v7
s_nop 1
v_mfma_f32_16x16x32_bf16 v[40:43], v[32:35], v[156:159], v[40:43]
s_waitcnt vmcnt(3)
s_add_u32 s61, s61, 0x2000
buffer_load_dwordx4 v[176:179], v9, s[40:43], s61 offen
v_perm_b32 v10, v25, v25, s66
v_and_b32 v28, v10, v4
v_and_b32 v29, v10, v5
v_and_b32 v30, v10, v6
v_and_b32 v31, v10, v7
s_nop 1
v_mfma_f32_16x16x32_bf16 v[36:39], v[28:31], v[160:163], v[36:39]
s_waitcnt vmcnt(3)
s_add_u32 s61, s61, 0x2000
buffer_load_dwordx4 v[180:183], v9, s[40:43], s61 offen
v_perm_b32 v10, v25, v25, s67
v_and_b32 v32, v10, v4
v_and_b32 v33, v10, v5
v_and_b32 v34, v10, v6
v_and_b32 v35, v10, v7
s_nop 1
v_mfma_f32_16x16x32_bf16 v[40:43], v[32:35], v[164:167], v[40:43]
s_waitcnt vmcnt(3)
v_perm_b32 v10, v26, v26, s66
v_and_b32 v28, v10, v4
v_and_b32 v29, v10, v5
v_and_b32 v30, v10, v6
v_and_b32 v31, v10, v7
s_nop 1
v_mfma_f32_16x16x32_bf16 v[36:39], v[28:31], v[168:171], v[36:39]
s_waitcnt vmcnt(2)
v_perm_b32 v10, v26, v26, s67
v_and_b32 v32, v10, v4
v_and_b32 v33, v10, v5
v_and_b32 v34, v10, v6
v_and_b32 v35, v10, v7
s_nop 1
v_mfma_f32_16x16x32_bf16 v[40:43], v[32:35], v[172:175], v[40:43]
s_waitcnt vmcnt(1)
v_perm_b32 v10, v27, v27, s66
v_and_b32 v28, v10, v4
v_and_b32 v29, v10, v5
v_and_b32 v30, v10, v6
v_and_b32 v31, v10, v7
s_nop 1
v_mfma_f32_16x16x32_bf16 v[36:39], v[28:31], v[176:179], v[36:39]
s_waitcnt vmcnt(0)
v_perm_b32 v10, v27, v27, s67
v_and_b32 v32, v10, v4
v_and_b32 v33, v10, v5
v_and_b32 v34, v10, v6
v_and_b32 v35, v10, v7
s_nop 1
v_mfma_f32_16x16x32_bf16 v[40:43], v[32:35], v[180:183], v[40:43]
s_lshl_b32 s62, s32, 17
s_mov_b32 s63, 0x20000
s_add_u32 s40, s12, s62
s_addc_u32 s41, s13, 0
s_and_b32 s41, s41, 0xffff
s_mov_b32 s42, s63
s_mov_b32 s43, 0x20000
v_lshlrev_b32 v9, 13, v3
v_lshl_add_u32 v9, v2, 4, v9
s_lshl_b32 s62, s35, 8
v_add_u32 v9, s62, v9
v_lshrrev_b32 v10, 1, v3
v_lshlrev_b32 v10, 9, v10
v_lshl_add_u32 v10, v2, 5, v10
v_and_b32 v11, 1, v3
v_lshl_add_u32 v10, v11, 4, v10
s_lshl_b32 s63, s35, 10
v_add_u32 v10, s63, v10
v_mov_b32 v11, 1
v_add_f32 v36, v36, v40
v_add_f32 v37, v37, v41
v_add_f32 v38, v38, v42
v_add_f32 v39, v39, v43
ds_write_b128 v10, v[36:39] offset:1024
s_mov_b64 exec, 1
ds_add_u32 v8, v11 offset:0
s_mov_b64 exec, -1
s_mov_b32 s66, 0x05040100
s_mov_b32 s67, 0x07060302
s_mov_b32 s61, 0
buffer_load_dwordx4 v[184:187], v9, s[40:43], s61 offen offset:0
buffer_load_dwordx4 v[188:191], v9, s[40:43], s61 offen offset:1024
s_waitcnt vmcnt(1)
buffer_load_dwordx4 v[192:195], v9, s[40:43], s61 offen offset:2048
s_waitcnt vmcnt(1)
buffer_load_dwordx4 v[196:199], v9, s[40:43], s61 offen offset:3072
v_perm_b32 v56, v188, v184, s66
v_perm_b32 v60, v188, v184, s67
v_perm_b32 v64, v189, v185, s66
v_perm_b32 v68, v189, v185, s67
v_perm_b32 v72, v190, v186, s66
v_perm_b32 v76, v190, v186, s67
v_perm_b32 v80, v191, v187, s66
v_perm_b32 v84, v191, v187, s67
s_waitcnt vmcnt(1)
s_mov_b32 s61, 4096
buffer_load_dwordx4 v[200:203], v9, s[40:43], s61 offen offset:0
s_waitcnt vmcnt(1)
buffer_load_dwordx4 v[204:207], v9, s[40:43], s61 offen offset:1024
v_perm_b32 v57, v196, v192, s66
v_perm_b32 v61, v196, v192, s67
v_perm_b32 v65, v197, v193, s66
v_perm_b32 v69, v197, v193, s67
v_perm_b32 v73, v198, v194, s66
v_perm_b32 v77, v198, v194, s67
v_perm_b32 v81, v199, v195, s66
v_perm_b32 v85, v199, v195, s67
s_waitcnt vmcnt(1)
buffer_load_dwordx4 v[208:211], v9, s[40:43], s61 offen offset:2048
s_waitcnt vmcnt(1)
buffer_load_dwordx4 v[212:215], v9, s[40:43], s61 offen offset:3072
v_perm_b32 v58, v204, v200, s66
v_perm_b32 v62, v204, v200, s67
v_perm_b32 v66, v205, v201, s66
v_perm_b32 v70, v205, v201, s67
v_perm_b32 v74, v206, v202, s66
v_perm_b32 v78, v206, v202, s67
v_perm_b32 v82, v207, v203, s66
v_perm_b32 v86, v207, v203, s67
s_waitcnt vmcnt(1)
s_mov_b32 s61, 32768
buffer_load_dwordx4 v[216:219], v9, s[40:43], s61 offen offset:0
s_waitcnt vmcnt(1)
buffer_load_dwordx4 v[220:223], v9, s[40:43], s61 offen offset:1024
v_perm_b32 v59, v212, v208, s66
v_perm_b32 v63, v212, v208, s67
v_perm_b32 v67, v213, v209, s66
v_perm_b32 v71, v213, v209, s67
v_perm_b32 v75, v214, v210, s66
v_perm_b32 v79, v214, v210, s67
v_perm_b32 v83, v215, v211, s66
v_perm_b32 v87, v215, v211, s67
s_waitcnt vmcnt(1)
buffer_load_dwordx4 v[224:227], v9, s[40:43], s61 offen offset:2048
s_waitcnt vmcnt(1)
buffer_load_dwordx4 v[228:231], v9, s[40:43], s61 offen offset:3072
v_perm_b32 v88, v220, v216, s66
v_perm_b32 v92, v220, v216, s67
v_perm_b32 v96, v221, v217, s66
v_perm_b32 v100, v221, v217, s67
v_perm_b32 v104, v222, v218, s66
v_perm_b32 v108, v222, v218, s67
v_perm_b32 v112, v223, v219, s66
v_perm_b32 v116, v223, v219, s67
s_waitcnt vmcnt(1)
s_mov_b32 s61, 36864
buffer_load_dwordx4 v[232:235], v9, s[40:43], s61 offen offset:0
s_waitcnt vmcnt(1)
buffer_load_dwordx4 v[236:239], v9, s[40:43], s61 offen offset:1024
v_perm_b32 v89, v228, v224, s66
v_perm_b32 v93, v228, v224, s67
v_perm_b32 v97, v229, v225, s66
v_perm_b32 v101, v229, v225, s67
v_perm_b32 v105, v230, v226, s66
v_perm_b32 v109, v230, v226, s67
v_perm_b32 v113, v231, v227, s66
v_perm_b32 v117, v231, v227, s67
s_waitcnt vmcnt(1)
buffer_load_dwordx4 v[240:243], v9, s[40:43], s61 offen offset:2048
s_waitcnt vmcnt(1)
buffer_load_dwordx4 v[244:247], v9, s[40:43], s61 offen offset:3072
v_perm_b32 v90, v236, v232, s66
v_perm_b32 v94, v236, v232, s67
v_perm_b32 v98, v237, v233, s66
v_perm_b32 v102, v237, v233, s67
v_perm_b32 v106, v238, v234, s66
v_perm_b32 v110, v238, v234, s67
v_perm_b32 v114, v239, v235, s66
v_perm_b32 v118, v239, v235, s67
s_waitcnt vmcnt(1)
s_mov_b32 s61, 65536
buffer_load_dwordx4 v[184:187], v9, s[40:43], s61 offen offset:0
s_waitcnt vmcnt(1)
buffer_load_dwordx4 v[188:191], v9, s[40:43], s61 offen offset:1024
v_perm_b32 v91, v244, v240, s66
v_perm_b32 v95, v244, v240, s67
v_perm_b32 v99, v245, v241, s66
v_perm_b32 v103, v245, v241, s67
v_perm_b32 v107, v246, v242, s66
v_perm_b32 v111, v246, v242, s67
v_perm_b32 v115, v247, v243, s66
v_perm_b32 v119, v247, v243, s67
s_waitcnt vmcnt(1)
buffer_load_dwordx4 v[192:195], v9, s[40:43], s61 offen offset:2048
s_waitcnt vmcnt(1)
buffer_load_dwordx4 v[196:199], v9, s[40:43], s61 offen offset:3072
v_perm_b32 v120, v188, v184, s66
v_perm_b32 v124, v188, v184, s67
v_perm_b32 v128, v189, v185, s66
v_perm_b32 v132, v189, v185, s67
v_perm_b32 v136, v190, v186, s66
v_perm_b32 v140, v190, v186, s67
v_perm_b32 v144, v191, v187, s66
v_perm_b32 v148, v191, v187, s67
s_waitcnt vmcnt(1)
s_mov_b32 s61, 69632
buffer_load_dwordx4 v[200:203], v9, s[40:43], s61 offen offset:0
s_waitcnt vmcnt(1)
buffer_load_dwordx4 v[204:207], v9, s[40:43], s61 offen offset:1024
v_perm_b32 v121, v196, v192, s66
v_perm_b32 v125, v196, v192, s67
v_perm_b32 v129, v197, v193, s66
v_perm_b32 v133, v197, v193, s67
v_perm_b32 v137, v198, v194, s66
v_perm_b32 v141, v198, v194, s67
v_perm_b32 v145, v199, v195, s66
v_perm_b32 v149, v199, v195, s67
s_waitcnt vmcnt(1)
buffer_load_dwordx4 v[208:211], v9, s[40:43], s61 offen offset:2048
s_waitcnt vmcnt(1)
buffer_load_dwordx4 v[212:215], v9, s[40:43], s61 offen offset:3072
v_perm_b32 v122, v204, v200, s66
v_perm_b32 v126, v204, v200, s67
v_perm_b32 v130, v205, v201, s66
v_perm_b32 v134, v205, v201, s67
v_perm_b32 v138, v206, v202, s66
v_perm_b32 v142, v206, v202, s67
v_perm_b32 v146, v207, v203, s66
v_perm_b32 v150, v207, v203, s67
s_waitcnt vmcnt(1)
s_mov_b32 s61, 98304
buffer_load_dwordx4 v[216:219], v9, s[40:43], s61 offen offset:0
s_waitcnt vmcnt(1)
buffer_load_dwordx4 v[220:223], v9, s[40:43], s61 offen offset:1024
v_perm_b32 v123, v212, v208, s66
v_perm_b32 v127, v212, v208, s67
v_perm_b32 v131, v213, v209, s66
v_perm_b32 v135, v213, v209, s67
v_perm_b32 v139, v214, v210, s66
v_perm_b32 v143, v214, v210, s67
v_perm_b32 v147, v215, v211, s66
v_perm_b32 v151, v215, v211, s67
s_waitcnt vmcnt(1)
buffer_load_dwordx4 v[224:227], v9, s[40:43], s61 offen offset:2048
s_waitcnt vmcnt(1)
buffer_load_dwordx4 v[228:231], v9, s[40:43], s61 offen offset:3072
v_perm_b32 v152, v220, v216, s66
v_perm_b32 v156, v220, v216, s67
v_perm_b32 v160, v221, v217, s66
v_perm_b32 v164, v221, v217, s67
v_perm_b32 v168, v222, v218, s66
v_perm_b32 v172, v222, v218, s67
v_perm_b32 v176, v223, v219, s66
v_perm_b32 v180, v223, v219, s67
s_waitcnt vmcnt(1)
s_mov_b32 s61, 102400
buffer_load_dwordx4 v[232:235], v9, s[40:43], s61 offen offset:0
s_waitcnt vmcnt(1)
buffer_load_dwordx4 v[236:239], v9, s[40:43], s61 offen offset:1024
v_perm_b32 v153, v228, v224, s66
v_perm_b32 v157, v228, v224, s67
v_perm_b32 v161, v229, v225, s66
v_perm_b32 v165, v229, v225, s67
v_perm_b32 v169, v230, v226, s66
v_perm_b32 v173, v230, v226, s67
v_perm_b32 v177, v231, v227, s66
v_perm_b32 v181, v231, v227, s67
s_waitcnt vmcnt(1)
buffer_load_dwordx4 v[240:243], v9, s[40:43], s61 offen offset:2048
s_waitcnt vmcnt(1)
buffer_load_dwordx4 v[244:247], v9, s[40:43], s61 offen offset:3072
v_perm_b32 v154, v236, v232, s66
v_perm_b32 v158, v236, v232, s67
v_perm_b32 v162, v237, v233, s66
v_perm_b32 v166, v237, v233, s67
v_perm_b32 v170, v238, v234, s66
v_perm_b32 v174, v238, v234, s67
v_perm_b32 v178, v239, v235, s66
v_perm_b32 v182, v239, v235, s67
s_waitcnt vmcnt(1)
s_waitcnt vmcnt(0)
v_perm_b32 v155, v244, v240, s66
v_perm_b32 v159, v244, v240, s67
v_perm_b32 v163, v245, v241, s66
v_perm_b32 v167, v245, v241, s67
v_perm_b32 v171, v246, v242, s66
v_perm_b32 v175, v246, v242, s67
v_perm_b32 v179, v247, v243, s66
v_perm_b32 v183, v247, v243, s67
s_lshl_b32 s60, s32, 3
s_add_u32 s60, s60, s33
s_cmp_lg_u32 s35, 0
s_cbranch_scc1 L_A_nostat
s_mov_b32 s64, 0
L_A_hs:
ds_read_b32 v10, v8 offset:4
s_waitcnt lgkmcnt(0)
v_readfirstlane_b32 s65, v10
s_add_u32 s64, s64, 1
s_nop 2
s_cmp_ge_u32 s65, 4
s_cbranch_scc1 L_A_hs_ok
s_sleep 16
s_cmp_lt_u32 s64, 1048576
s_cbranch_scc1 L_A_hs
L_A_hs_ok:
s_mov_b32 s64, 0
L_poll_A_q:
global_load_dword v10, v8, s[28:29] offset:0 sc1
s_waitcnt vmcnt(0)
v_readfirstlane_b32 s65, v10
s_add_u32 s64, s64, 1
s_nop 2
s_cmp_ge_u32 s65, 32
s_cbranch_scc1 L_done_A_q
s_sleep 2
s_cmp_lt_u32 s64, 65536
s_cbranch_scc1 L_poll_A_q
L_done_A_q:
v_and_b32 v10, 1, v1
v_lshlrev_b32 v11, 4, v10
ds_read_b128 v[44:47], v11 offset:64
ds_read_b128 v[48:51], v11 offset:96
v_lshlrev_b32 v10, 11, v10
s_lshl_b32 s63, s60, 3
s_add_u32 s63, s63, 0x14000
v_add_u32 v10, s63, v10
s_waitcnt lgkmcnt(0)
v_max3_f32 v52, v44, v45, v46
v_max_f32 v52, v52, v47
v_sub_f32 v44, v44, v52
v_sub_f32 v45, v45, v52
v_sub_f32 v46, v46, v52
v_sub_f32 v47, v47, v52
v_exp_f32 v44, v44
v_exp_f32 v45, v45
v_exp_f32 v46, v46
v_exp_f32 v47, v47
s_nop 0
v_mul_f32 v53, v44, v48
v_fma_f32 v53, v45, v49, v53
v_fma_f32 v53, v46, v50, v53
v_fma_f32 v53, v47, v51, v53
v_min_u32 v52, 0xfffffffe, v52
v_min_u32 v53, 0xfffffffe, v53
s_mov_b64 exec, 3
global_store_dwordx2 v10, v[52:53], s[30:31] sc1
s_mov_b64 exec, -1
L_A_nostat:
v_and_b32 v10, 7, v2
v_mul_u32_u24 v10, 272, v10
v_lshl_add_u32 v10, v3, 4, v10
v_lshlrev_b32 v11, 18, v3
v_lshl_add_u32 v11, v2, 4, v11
s_lshl_b32 s63, s60, 10
s_lshl_b32 s62, s35, 8
s_add_u32 s63, s63, s62
s_add_u32 s63, s63, 0x100000
v_add_u32 v11, s63, v11
s_barrier
ds_read_b128 v[12:15], v10 offset:8192
ds_read_b128 v[16:19], v10 offset:8256
ds_read_b128 v[20:23], v10 offset:8320
ds_read_b128 v[24:27], v10 offset:8384
s_waitcnt lgkmcnt(3)
v_mfma_f32_16x16x32_bf16 v[184:187], v[12:15], v[56:59], 0
v_mfma_f32_16x16x32_bf16 v[188:191], v[12:15], v[60:63], 0
s_waitcnt lgkmcnt(2)
v_mfma_f32_16x16x32_bf16 v[184:187], v[16:19], v[88:91], v[184:187]
v_mfma_f32_16x16x32_bf16 v[188:191], v[16:19], v[92:95], v[188:191]
s_waitcnt lgkmcnt(1)
v_mfma_f32_16x16x32_bf16 v[184:187], v[20:23], v[120:123], v[184:187]
v_mfma_f32_16x16x32_bf16 v[188:191], v[20:23], v[124:127], v[188:191]
s_waitcnt lgkmcnt(0)
v_mfma_f32_16x16x32_bf16 v[184:187], v[24:27], v[152:155], v[184:187]
v_mfma_f32_16x16x32_bf16 v[188:191], v[24:27], v[156:159], v[188:191]
v_mfma_f32_16x16x32_bf16 v[192:195], v[12:15], v[64:67], 0
v_mfma_f32_16x16x32_bf16 v[196:199], v[12:15], v[68:71], 0
v_mfma_f32_16x16x32_bf16 v[192:195], v[16:19], v[96:99], v[192:195]
v_mfma_f32_16x16x32_bf16 v[196:199], v[16:19], v[100:103], v[196:199]
v_mfma_f32_16x16x32_bf16 v[192:195], v[20:23], v[128:131], v[192:195]
v_mfma_f32_16x16x32_bf16 v[196:199], v[20:23], v[132:135], v[196:199]
v_mfma_f32_16x16x32_bf16 v[192:195], v[24:27], v[160:163], v[192:195]
v_mfma_f32_16x16x32_bf16 v[196:199], v[24:27], v[164:167], v[196:199]
v_add_f32 v184, v184, v185
v_add_f32 v186, v186, v187
v_add_f32 v184, v184, v186
v_add_f32 v188, v188, v189
v_add_f32 v190, v190, v191
v_add_f32 v188, v188, v190
v_cvt_pk_bf16_f32 v36, v184, v188
v_min_u32 v36, 0xfffffffe, v36
v_mfma_f32_16x16x32_bf16 v[200:203], v[12:15], v[72:75], 0
v_mfma_f32_16x16x32_bf16 v[204:207], v[12:15], v[76:79], 0
v_mfma_f32_16x16x32_bf16 v[200:203], v[16:19], v[104:107], v[200:203]
v_mfma_f32_16x16x32_bf16 v[204:207], v[16:19], v[108:111], v[204:207]
v_mfma_f32_16x16x32_bf16 v[200:203], v[20:23], v[136:139], v[200:203]
v_mfma_f32_16x16x32_bf16 v[204:207], v[20:23], v[140:143], v[204:207]
v_mfma_f32_16x16x32_bf16 v[200:203], v[24:27], v[168:171], v[200:203]
v_mfma_f32_16x16x32_bf16 v[204:207], v[24:27], v[172:175], v[204:207]
v_add_f32 v192, v192, v193
v_add_f32 v194, v194, v195
v_add_f32 v192, v192, v194
v_add_f32 v196, v196, v197
v_add_f32 v198, v198, v199
v_add_f32 v196, v196, v198
v_cvt_pk_bf16_f32 v37, v192, v196
v_min_u32 v37, 0xfffffffe, v37
v_mfma_f32_16x16x32_bf16 v[208:211], v[12:15], v[80:83], 0
v_mfma_f32_16x16x32_bf16 v[212:215], v[12:15], v[84:87], 0
v_mfma_f32_16x16x32_bf16 v[208:211], v[16:19], v[112:115], v[208:211]
v_mfma_f32_16x16x32_bf16 v[212:215], v[16:19], v[116:119], v[212:215]
v_mfma_f32_16x16x32_bf16 v[208:211], v[20:23], v[144:147], v[208:211]
v_mfma_f32_16x16x32_bf16 v[212:215], v[20:23], v[148:151], v[212:215]
v_mfma_f32_16x16x32_bf16 v[208:211], v[24:27], v[176:179], v[208:211]
v_mfma_f32_16x16x32_bf16 v[212:215], v[24:27], v[180:183], v[212:215]
v_add_f32 v200, v200, v201
v_add_f32 v202, v202, v203
v_add_f32 v200, v200, v202
v_add_f32 v204, v204, v205
v_add_f32 v206, v206, v207
v_add_f32 v204, v204, v206
v_cvt_pk_bf16_f32 v38, v200, v204
v_min_u32 v38, 0xfffffffe, v38
s_nop 0
v_add_f32 v208, v208, v209
v_add_f32 v210, v210, v211
v_add_f32 v208, v208, v210
v_add_f32 v212, v212, v213
v_add_f32 v214, v214, v215
v_add_f32 v212, v212, v214
v_cvt_pk_bf16_f32 v39, v208, v212
v_min_u32 v39, 0xfffffffe, v39
s_mov_b32 exec_hi, 0
global_store_dwordx4 v11, v[36:39], s[30:31] sc1
s_endpgm
L_roleW:
v_mov_b32 v8, 0
s_mov_b32 s52, s30
s_and_b32 s53, s31, 0xffff
s_mov_b32 s54, 0x1000000
s_mov_b32 s55, 0x20000
s_lshl_b32 s60, s32, 8
s_sub_u32 s61, 0x400000, s60
s_add_u32 s40, s18, s60
s_addc_u32 s41, s19, 0
s_and_b32 s41, s41, 0xffff
s_mov_b32 s42, s61
s_mov_b32 s43, 0x20000
s_add_u32 s44, s20, s60
s_addc_u32 s45, s21, 0
s_and_b32 s45, s45, 0xffff
s_mov_b32 s46, s61
s_mov_b32 s47, 0x20000
s_mov_b32 s48, s14
s_and_b32 s49, s15, 0xffff
s_mov_b32 s50, 0x800
s_mov_b32 s51, 0x20000
v_lshrrev_b32 v192, 3, v2
v_lshlrev_b32 v192, 10, v192
v_lshl_add_u32 v192, v3, 5, v192
s_lshl_b32 s62, s34, 7
v_add_u32 v192, s62, v192
buffer_load_dwordx4 v[12:15], v192, s[48:51], 0 offen
buffer_load_dwordx4 v[16:19], v192, s[48:51], 0 offen offset:16
v_lshlrev_b32 v9, 17, v3
v_lshl_add_u32 v9, v2, 4, v9
s_lshl_b32 s62, s34, 19
v_add_u32 v9, s62, v9
s_waitcnt vmcnt(2)
s_mov_b32 s62, 0
buffer_load_dwordx4 v[64:67], v9, s[40:43], s62 offen nt
s_waitcnt vmcnt(2)
s_mov_b32 s62, 8192
buffer_load_dwordx4 v[68:71], v9, s[40:43], s62 offen nt
s_waitcnt vmcnt(2)
s_mov_b32 s62, 16384
buffer_load_dwordx4 v[72:75], v9, s[40:43], s62 offen nt
s_waitcnt vmcnt(2)
s_mov_b32 s62, 24576
buffer_load_dwordx4 v[76:79], v9, s[40:43], s62 offen nt
s_waitcnt vmcnt(2)
s_mov_b32 s62, 32768
buffer_load_dwordx4 v[80:83], v9, s[40:43], s62 offen nt
s_waitcnt vmcnt(2)
s_mov_b32 s62, 40960
buffer_load_dwordx4 v[84:87], v9, s[40:43], s62 offen nt
s_waitcnt vmcnt(2)
s_mov_b32 s62, 49152
buffer_load_dwordx4 v[88:91], v9, s[40:43], s62 offen nt
s_waitcnt vmcnt(2)
s_mov_b32 s62, 57344
buffer_load_dwordx4 v[92:95], v9, s[40:43], s62 offen nt
s_waitcnt vmcnt(2)
s_mov_b32 s62, 65536
buffer_load_dwordx4 v[96:99], v9, s[40:43], s62 offen nt
s_waitcnt vmcnt(2)
s_mov_b32 s62, 73728
buffer_load_dwordx4 v[100:103], v9, s[40:43], s62 offen nt
s_waitcnt vmcnt(2)
s_mov_b32 s62, 81920
buffer_load_dwordx4 v[104:107], v9, s[40:43], s62 offen nt
s_waitcnt vmcnt(2)
s_mov_b32 s62, 90112
buffer_load_dwordx4 v[108:111], v9, s[40:43], s62 offen nt
s_waitcnt vmcnt(2)
s_mov_b32 s62, 98304
buffer_load_dwordx4 v[112:115], v9, s[40:43], s62 offen nt
s_waitcnt vmcnt(2)
s_mov_b32 s62, 106496
buffer_load_dwordx4 v[116:119], v9, s[40:43], s62 offen nt
s_waitcnt vmcnt(2)
s_mov_b32 s62, 114688
buffer_load_dwordx4 v[120:123], v9, s[40:43], s62 offen nt
s_waitcnt vmcnt(2)
s_mov_b32 s62, 122880
buffer_load_dwordx4 v[124:127], v9, s[40:43], s62 offen nt
s_barrier
s_waitcnt vmcnt(16)
s_mov_b32 s60, 0x01000100
v_perm_b32 v192, v12, v12, s60
v_and_b32 v28, v192, v4
v_and_b32 v29, v192, v5
v_and_b32 v30, v192, v6
v_and_b32 v31, v192, v7
s_waitcnt vmcnt(15)
s_nop 0
v_mfma_f32_16x16x32_bf16 v[44:47], v[28:31], v[64:67], 0
s_mov_b32 s62, 0
buffer_load_dwordx4 v[128:131], v9, s[44:47], s62 offen nt
s_mov_b32 s60, 0x03020302
v_perm_b32 v193, v12, v12, s60
v_and_b32 v32, v193, v4
v_and_b32 v33, v193, v5
v_and_b32 v34, v193, v6
v_and_b32 v35, v193, v7
s_waitcnt vmcnt(15)
s_nop 0
v_mfma_f32_16x16x32_bf16 v[44:47], v[32:35], v[68:71], v[44:47]
s_mov_b32 s62, 8192
buffer_load_dwordx4 v[132:135], v9, s[44:47], s62 offen nt
s_mov_b32 s60, 0x01000100
v_perm_b32 v192, v13, v13, s60
v_and_b32 v28, v192, v4
v_and_b32 v29, v192, v5
v_and_b32 v30, v192, v6
v_and_b32 v31, v192, v7
s_waitcnt vmcnt(15)
s_nop 0
v_mfma_f32_16x16x32_bf16 v[44:47], v[28:31], v[72:75], v[44:47]
s_mov_b32 s62, 16384
buffer_load_dwordx4 v[136:139], v9, s[44:47], s62 offen nt
s_mov_b32 s60, 0x03020302
v_perm_b32 v193, v13, v13, s60
v_and_b32 v32, v193, v4
v_and_b32 v33, v193, v5
v_and_b32 v34, v193, v6
v_and_b32 v35, v193, v7
s_waitcnt vmcnt(15)
s_nop 0
v_mfma_f32_16x16x32_bf16 v[44:47], v[32:35], v[76:79], v[44:47]
s_mov_b32 s62, 24576
buffer_load_dwordx4 v[140:143], v9, s[44:47], s62 offen nt
s_mov_b32 s60, 0x01000100
v_perm_b32 v192, v14, v14, s60
v_and_b32 v28, v192, v4
v_and_b32 v29, v192, v5
v_and_b32 v30, v192, v6
v_and_b32 v31, v192, v7
s_waitcnt vmcnt(15)
s_nop 0
v_mfma_f32_16x16x32_bf16 v[44:47], v[28:31], v[80:83], v[44:47]
s_mov_b32 s62, 32768
buffer_load_dwordx4 v[144:147], v9, s[44:47], s62 offen nt
s_mov_b32 s60, 0x03020302
v_perm_b32 v193, v14, v14, s60
v_and_b32 v32, v193, v4
v_and_b32 v33, v193, v5
v_and_b32 v34, v193, v6
v_and_b32 v35, v193, v7
s_waitcnt vmcnt(15)
s_nop 0
v_mfma_f32_16x16x32_bf16 v[44:47], v[32:35], v[84:87], v[44:47]
s_mov_b32 s62, 40960
buffer_load_dwordx4 v[148:151], v9, s[44:47], s62 offen nt
s_mov_b32 s60, 0x01000100
v_perm_b32 v192, v15, v15, s60
v_and_b32 v28, v192, v4
v_and_b32 v29, v192, v5
v_and_b32 v30, v192, v6
v_and_b32 v31, v192, v7
s_waitcnt vmcnt(15)
s_nop 0
v_mfma_f32_16x16x32_bf16 v[44:47], v[28:31], v[88:91], v[44:47]
s_mov_b32 s62, 49152
buffer_load_dwordx4 v[152:155], v9, s[44:47], s62 offen nt
s_mov_b32 s60, 0x03020302
v_perm_b32 v193, v15, v15, s60
v_and_b32 v32, v193, v4
v_and_b32 v33, v193, v5
v_and_b32 v34, v193, v6
v_and_b32 v35, v193, v7
s_waitcnt vmcnt(15)
s_nop 0
v_mfma_f32_16x16x32_bf16 v[44:47], v[32:35], v[92:95], v[44:47]
s_mov_b32 s62, 57344
buffer_load_dwordx4 v[156:159], v9, s[44:47], s62 offen nt
s_mov_b32 s60, 0x01000100
v_perm_b32 v192, v16, v16, s60
v_and_b32 v28, v192, v4
v_and_b32 v29, v192, v5
v_and_b32 v30, v192, v6
v_and_b32 v31, v192, v7
s_waitcnt vmcnt(15)
s_nop 0
v_mfma_f32_16x16x32_bf16 v[44:47], v[28:31], v[96:99], v[44:47]
s_mov_b32 s62, 65536
buffer_load_dwordx4 v[160:163], v9, s[44:47], s62 offen nt
s_mov_b32 s60, 0x03020302
v_perm_b32 v193, v16, v16, s60
v_and_b32 v32, v193, v4
v_and_b32 v33, v193, v5
v_and_b32 v34, v193, v6
v_and_b32 v35, v193, v7
s_waitcnt vmcnt(15)
s_nop 0
v_mfma_f32_16x16x32_bf16 v[44:47], v[32:35], v[100:103], v[44:47]
s_mov_b32 s62, 73728
buffer_load_dwordx4 v[164:167], v9, s[44:47], s62 offen nt
s_mov_b32 s60, 0x01000100
v_perm_b32 v192, v17, v17, s60
v_and_b32 v28, v192, v4
v_and_b32 v29, v192, v5
v_and_b32 v30, v192, v6
v_and_b32 v31, v192, v7
s_waitcnt vmcnt(15)
s_nop 0
v_mfma_f32_16x16x32_bf16 v[44:47], v[28:31], v[104:107], v[44:47]
s_mov_b32 s62, 81920
buffer_load_dwordx4 v[168:171], v9, s[44:47], s62 offen nt
s_mov_b32 s60, 0x03020302
v_perm_b32 v193, v17, v17, s60
v_and_b32 v32, v193, v4
v_and_b32 v33, v193, v5
v_and_b32 v34, v193, v6
v_and_b32 v35, v193, v7
s_waitcnt vmcnt(15)
s_nop 0
v_mfma_f32_16x16x32_bf16 v[44:47], v[32:35], v[108:111], v[44:47]
s_mov_b32 s62, 90112
buffer_load_dwordx4 v[172:175], v9, s[44:47], s62 offen nt
s_mov_b32 s60, 0x01000100
v_perm_b32 v192, v18, v18, s60
v_and_b32 v28, v192, v4
v_and_b32 v29, v192, v5
v_and_b32 v30, v192, v6
v_and_b32 v31, v192, v7
s_waitcnt vmcnt(15)
s_nop 0
v_mfma_f32_16x16x32_bf16 v[44:47], v[28:31], v[112:115], v[44:47]
s_mov_b32 s62, 98304
buffer_load_dwordx4 v[176:179], v9, s[44:47], s62 offen nt
s_mov_b32 s60, 0x03020302
v_perm_b32 v193, v18, v18, s60
v_and_b32 v32, v193, v4
v_and_b32 v33, v193, v5
v_and_b32 v34, v193, v6
v_and_b32 v35, v193, v7
s_waitcnt vmcnt(15)
s_nop 0
v_mfma_f32_16x16x32_bf16 v[44:47], v[32:35], v[116:119], v[44:47]
s_mov_b32 s62, 106496
buffer_load_dwordx4 v[180:183], v9, s[44:47], s62 offen nt
s_mov_b32 s60, 0x01000100
v_perm_b32 v192, v19, v19, s60
v_and_b32 v28, v192, v4
v_and_b32 v29, v192, v5
v_and_b32 v30, v192, v6
v_and_b32 v31, v192, v7
s_waitcnt vmcnt(15)
s_nop 0
v_mfma_f32_16x16x32_bf16 v[44:47], v[28:31], v[120:123], v[44:47]
s_mov_b32 s62, 114688
buffer_load_dwordx4 v[184:187], v9, s[44:47], s62 offen nt
s_mov_b32 s60, 0x03020302
v_perm_b32 v193, v19, v19, s60
v_and_b32 v32, v193, v4
v_and_b32 v33, v193, v5
v_and_b32 v34, v193, v6
v_and_b32 v35, v193, v7
s_waitcnt vmcnt(15)
s_nop 0
v_mfma_f32_16x16x32_bf16 v[44:47], v[32:35], v[124:127], v[44:47]
s_mov_b32 s62, 122880
buffer_load_dwordx4 v[188:191], v9, s[44:47], s62 offen nt
v_mov_b32 v196, -1
v_mov_b32 v197, -1
v_mov_b32 v198, -1
v_mov_b32 v199, -1
s_cmp_ge_u32 s34, 6
s_cbranch_scc1 L_W_noclr
s_lshl_b32 s62, s32, 13
s_add_u32 s62, s62, 0x100000
v_lshl_add_u32 v192, v0, 4, s62
s_mov_b32 s62, 0x40000
buffer_store_dwordx4 v[196:199], v192, s[52:55], 0 offen sc1
buffer_store_dwordx4 v[196:199], v192, s[52:55], s62 offen sc1
L_W_noclr:
s_cmp_lg_u32 s34, 0
s_cbranch_scc1 L_W_nostat
v_lshrrev_b32 v192, 2, v1
v_lshlrev_b32 v192, 11, v192
v_and_b32 v193, 3, v1
v_lshl_add_u32 v192, v193, 4, v192
s_lshl_b32 s62, s32, 6
s_add_u32 s62, s62, 0x14000
v_add_u32 v192, s62, v192
s_mov_b64 exec, 0xff
buffer_store_dwordx4 v[196:199], v192, s[52:55], 0 offen sc1
s_mov_b64 exec, -1
L_W_nostat:
s_cmp_lg_u32 s34, 1
s_cbranch_scc1 L_W_noctr
s_lshl_b32 s62, s32, 7
s_add_u32 s62, s62, 0x1a000
v_lshl_add_u32 v192, v1, 12, s62
s_mov_b64 exec, 3
buffer_store_dword v8, v192, s[52:55], 0 offen sc1
s_mov_b64 exec, -1
L_W_noctr:
s_nop 1
v_lshrrev_b32 v192, 1, v3
v_lshlrev_b32 v192, 9, v192
v_lshl_add_u32 v192, v2, 5, v192
v_and_b32 v193, 1, v3
v_lshl_add_u32 v192, v193, 4, v192
s_lshl_b32 s63, s34, 10
v_add_u32 v192, s63, v192
s_nop 1
s_nop 5
ds_write_b128 v192, v[44:47] offset:0
s_waitcnt lgkmcnt(0)
s_barrier
s_cmp_ge_u32 s34, 4
s_cbranch_scc1 L_W_qskip
v_lshlrev_b32 v194, 2, v0
ds_read_b32 v196, v194 offset:0
ds_read_b32 v197, v194 offset:1024
ds_read_b32 v198, v194 offset:2048
ds_read_b32 v199, v194 offset:3072
ds_read_b32 v200, v194 offset:4096
ds_read_b32 v201, v194 offset:5120
ds_read_b32 v202, v194 offset:6144
ds_read_b32 v203, v194 offset:7168
s_waitcnt lgkmcnt(0)
v_add_f32 v196, v196, v197
v_add_f32 v196, v196, v198
v_add_f32 v196, v196, v199
v_add_f32 v196, v196, v200
v_add_f32 v196, v196, v201
v_add_f32 v196, v196, v202
v_add_f32 v196, v196, v203
v_cvt_pk_bf16_f32 v196, v196, v196
v_lshlrev_b32 v194, 1, v0
ds_write_b16 v194, v196 offset:8192
s_waitcnt lgkmcnt(0)
L_W_qskip:
s_barrier
v_lshlrev_b32 v194, 4, v2
ds_read_b128 v[20:23], v194 offset:8192
ds_read_b128 v[24:27], v194 offset:8448
v_mov_b32 v200, 0
v_mov_b32 v201, 0
s_waitcnt lgkmcnt(0)
s_waitcnt vmcnt(14)
v_dot2_f32_bf16 v60, v128, v20, 0
v_dot2_f32_bf16 v61, v128, v24, 0
v_dot2_f32_bf16 v62, v132, v20, 0
v_dot2_f32_bf16 v63, v132, v24, 0
v_dot2_f32_bf16 v60, v129, v21, v60
v_dot2_f32_bf16 v61, v129, v25, v61
v_dot2_f32_bf16 v62, v133, v21, v62
v_dot2_f32_bf16 v63, v133, v25, v63
v_dot2_f32_bf16 v60, v130, v22, v60
v_dot2_f32_bf16 v61, v130, v26, v61
v_dot2_f32_bf16 v62, v134, v22, v62
v_dot2_f32_bf16 v63, v134, v26, v63
v_dot2_f32_bf16 v60, v131, v23, v60
v_dot2_f32_bf16 v61, v131, v27, v61
v_dot2_f32_bf16 v62, v135, v23, v62
v_dot2_f32_bf16 v63, v135, v27, v63
v_add_f32_dpp v60, v60, v60 row_ror:8 row_mask:0xf bank_mask:0xf
v_add_f32_dpp v61, v61, v61 row_ror:8 row_mask:0xf bank_mask:0xf
v_add_f32_dpp v62, v62, v62 row_ror:8 row_mask:0xf bank_mask:0xf
v_add_f32_dpp v63, v63, v63 row_ror:8 row_mask:0xf bank_mask:0xf
v_add_f32_dpp v60, v60, v60 row_ror:4 row_mask:0xf bank_mask:0xf
v_add_f32_dpp v61, v61, v61 row_ror:4 row_mask:0xf bank_mask:0xf
v_add_f32_dpp v62, v62, v62 row_ror:4 row_mask:0xf bank_mask:0xf
v_add_f32_dpp v63, v63, v63 row_ror:4 row_mask:0xf bank_mask:0xf
v_add_f32_dpp v60, v60, v60 row_ror:2 row_mask:0xf bank_mask:0xf
v_add_f32_dpp v61, v61, v61 row_ror:2 row_mask:0xf bank_mask:0xf
v_add_f32_dpp v62, v62, v62 row_ror:2 row_mask:0xf bank_mask:0xf
v_add_f32_dpp v63, v63, v63 row_ror:2 row_mask:0xf bank_mask:0xf
v_add_f32_dpp v60, v60, v60 row_ror:1 row_mask:0xf bank_mask:0xf
v_add_f32_dpp v61, v61, v61 row_ror:1 row_mask:0xf bank_mask:0xf
v_add_f32_dpp v62, v62, v62 row_ror:1 row_mask:0xf bank_mask:0xf
v_add_f32_dpp v63, v63, v63 row_ror:1 row_mask:0xf bank_mask:0xf
v_cmp_eq_u32 vcc, 0, v2
s_nop 1
v_cndmask_b32 v200, v200, v60, vcc
v_cndmask_b32 v201, v201, v61, vcc
v_cmp_eq_u32 vcc, 1, v2
s_nop 1
v_cndmask_b32 v200, v200, v62, vcc
v_cndmask_b32 v201, v201, v63, vcc
s_waitcnt vmcnt(12)
v_dot2_f32_bf16 v60, v136, v20, 0
v_dot2_f32_bf16 v61, v136, v24, 0
v_dot2_f32_bf16 v62, v140, v20, 0
v_dot2_f32_bf16 v63, v140, v24, 0
v_dot2_f32_bf16 v60, v137, v21, v60
v_dot2_f32_bf16 v61, v137, v25, v61
v_dot2_f32_bf16 v62, v141, v21, v62
v_dot2_f32_bf16 v63, v141, v25, v63
v_dot2_f32_bf16 v60, v138, v22, v60
v_dot2_f32_bf16 v61, v138, v26, v61
v_dot2_f32_bf16 v62, v142, v22, v62
v_dot2_f32_bf16 v63, v142, v26, v63
v_dot2_f32_bf16 v60, v139, v23, v60
v_dot2_f32_bf16 v61, v139, v27, v61
v_dot2_f32_bf16 v62, v143, v23, v62
v_dot2_f32_bf16 v63, v143, v27, v63
v_add_f32_dpp v60, v60, v60 row_ror:8 row_mask:0xf bank_mask:0xf
v_add_f32_dpp v61, v61, v61 row_ror:8 row_mask:0xf bank_mask:0xf
v_add_f32_dpp v62, v62, v62 row_ror:8 row_mask:0xf bank_mask:0xf
v_add_f32_dpp v63, v63, v63 row_ror:8 row_mask:0xf bank_mask:0xf
v_add_f32_dpp v60, v60, v60 row_ror:4 row_mask:0xf bank_mask:0xf
v_add_f32_dpp v61, v61, v61 row_ror:4 row_mask:0xf bank_mask:0xf
v_add_f32_dpp v62, v62, v62 row_ror:4 row_mask:0xf bank_mask:0xf
v_add_f32_dpp v63, v63, v63 row_ror:4 row_mask:0xf bank_mask:0xf
v_add_f32_dpp v60, v60, v60 row_ror:2 row_mask:0xf bank_mask:0xf
v_add_f32_dpp v61, v61, v61 row_ror:2 row_mask:0xf bank_mask:0xf
v_add_f32_dpp v62, v62, v62 row_ror:2 row_mask:0xf bank_mask:0xf
v_add_f32_dpp v63, v63, v63 row_ror:2 row_mask:0xf bank_mask:0xf
v_add_f32_dpp v60, v60, v60 row_ror:1 row_mask:0xf bank_mask:0xf
v_add_f32_dpp v61, v61, v61 row_ror:1 row_mask:0xf bank_mask:0xf
v_add_f32_dpp v62, v62, v62 row_ror:1 row_mask:0xf bank_mask:0xf
v_add_f32_dpp v63, v63, v63 row_ror:1 row_mask:0xf bank_mask:0xf
v_cmp_eq_u32 vcc, 2, v2
s_nop 1
v_cndmask_b32 v200, v200, v60, vcc
v_cndmask_b32 v201, v201, v61, vcc
v_cmp_eq_u32 vcc, 3, v2
s_nop 1
v_cndmask_b32 v200, v200, v62, vcc
v_cndmask_b32 v201, v201, v63, vcc
s_waitcnt vmcnt(10)
v_dot2_f32_bf16 v60, v144, v20, 0
v_dot2_f32_bf16 v61, v144, v24, 0
v_dot2_f32_bf16 v62, v148, v20, 0
v_dot2_f32_bf16 v63, v148, v24, 0
v_dot2_f32_bf16 v60, v145, v21, v60
v_dot2_f32_bf16 v61, v145, v25, v61
v_dot2_f32_bf16 v62, v149, v21, v62
v_dot2_f32_bf16 v63, v149, v25, v63
v_dot2_f32_bf16 v60, v146, v22, v60
v_dot2_f32_bf16 v61, v146, v26, v61
v_dot2_f32_bf16 v62, v150, v22, v62
v_dot2_f32_bf16 v63, v150, v26, v63
v_dot2_f32_bf16 v60, v147, v23, v60
v_dot2_f32_bf16 v61, v147, v27, v61
v_dot2_f32_bf16 v62, v151, v23, v62
v_dot2_f32_bf16 v63, v151, v27, v63
v_add_f32_dpp v60, v60, v60 row_ror:8 row_mask:0xf bank_mask:0xf
v_add_f32_dpp v61, v61, v61 row_ror:8 row_mask:0xf bank_mask:0xf
v_add_f32_dpp v62, v62, v62 row_ror:8 row_mask:0xf bank_mask:0xf
v_add_f32_dpp v63, v63, v63 row_ror:8 row_mask:0xf bank_mask:0xf
v_add_f32_dpp v60, v60, v60 row_ror:4 row_mask:0xf bank_mask:0xf
v_add_f32_dpp v61, v61, v61 row_ror:4 row_mask:0xf bank_mask:0xf
v_add_f32_dpp v62, v62, v62 row_ror:4 row_mask:0xf bank_mask:0xf
v_add_f32_dpp v63, v63, v63 row_ror:4 row_mask:0xf bank_mask:0xf
v_add_f32_dpp v60, v60, v60 row_ror:2 row_mask:0xf bank_mask:0xf
v_add_f32_dpp v61, v61, v61 row_ror:2 row_mask:0xf bank_mask:0xf
v_add_f32_dpp v62, v62, v62 row_ror:2 row_mask:0xf bank_mask:0xf
v_add_f32_dpp v63, v63, v63 row_ror:2 row_mask:0xf bank_mask:0xf
v_add_f32_dpp v60, v60, v60 row_ror:1 row_mask:0xf bank_mask:0xf
v_add_f32_dpp v61, v61, v61 row_ror:1 row_mask:0xf bank_mask:0xf
v_add_f32_dpp v62, v62, v62 row_ror:1 row_mask:0xf bank_mask:0xf
v_add_f32_dpp v63, v63, v63 row_ror:1 row_mask:0xf bank_mask:0xf
v_cmp_eq_u32 vcc, 4, v2
s_nop 1
v_cndmask_b32 v200, v200, v60, vcc
v_cndmask_b32 v201, v201, v61, vcc
v_cmp_eq_u32 vcc, 5, v2
s_nop 1
v_cndmask_b32 v200, v200, v62, vcc
v_cndmask_b32 v201, v201, v63, vcc
s_waitcnt vmcnt(8)
v_dot2_f32_bf16 v60, v152, v20, 0
v_dot2_f32_bf16 v61, v152, v24, 0
v_dot2_f32_bf16 v62, v156, v20, 0
v_dot2_f32_bf16 v63, v156, v24, 0
v_dot2_f32_bf16 v60, v153, v21, v60
v_dot2_f32_bf16 v61, v153, v25, v61
v_dot2_f32_bf16 v62, v157, v21, v62
v_dot2_f32_bf16 v63, v157, v25, v63
v_dot2_f32_bf16 v60, v154, v22, v60
v_dot2_f32_bf16 v61, v154, v26, v61
v_dot2_f32_bf16 v62, v158, v22, v62
v_dot2_f32_bf16 v63, v158, v26, v63
v_dot2_f32_bf16 v60, v155, v23, v60
v_dot2_f32_bf16 v61, v155, v27, v61
v_dot2_f32_bf16 v62, v159, v23, v62
v_dot2_f32_bf16 v63, v159, v27, v63
v_add_f32_dpp v60, v60, v60 row_ror:8 row_mask:0xf bank_mask:0xf
v_add_f32_dpp v61, v61, v61 row_ror:8 row_mask:0xf bank_mask:0xf
v_add_f32_dpp v62, v62, v62 row_ror:8 row_mask:0xf bank_mask:0xf
v_add_f32_dpp v63, v63, v63 row_ror:8 row_mask:0xf bank_mask:0xf
v_add_f32_dpp v60, v60, v60 row_ror:4 row_mask:0xf bank_mask:0xf
v_add_f32_dpp v61, v61, v61 row_ror:4 row_mask:0xf bank_mask:0xf
v_add_f32_dpp v62, v62, v62 row_ror:4 row_mask:0xf bank_mask:0xf
v_add_f32_dpp v63, v63, v63 row_ror:4 row_mask:0xf bank_mask:0xf
v_add_f32_dpp v60, v60, v60 row_ror:2 row_mask:0xf bank_mask:0xf
v_add_f32_dpp v61, v61, v61 row_ror:2 row_mask:0xf bank_mask:0xf
v_add_f32_dpp v62, v62, v62 row_ror:2 row_mask:0xf bank_mask:0xf
v_add_f32_dpp v63, v63, v63 row_ror:2 row_mask:0xf bank_mask:0xf
v_add_f32_dpp v60, v60, v60 row_ror:1 row_mask:0xf bank_mask:0xf
v_add_f32_dpp v61, v61, v61 row_ror:1 row_mask:0xf bank_mask:0xf
v_add_f32_dpp v62, v62, v62 row_ror:1 row_mask:0xf bank_mask:0xf
v_add_f32_dpp v63, v63, v63 row_ror:1 row_mask:0xf bank_mask:0xf
v_cmp_eq_u32 vcc, 6, v2
s_nop 1
v_cndmask_b32 v200, v200, v60, vcc
v_cndmask_b32 v201, v201, v61, vcc
v_cmp_eq_u32 vcc, 7, v2
s_nop 1
v_cndmask_b32 v200, v200, v62, vcc
v_cndmask_b32 v201, v201, v63, vcc
s_waitcnt vmcnt(6)
v_dot2_f32_bf16 v60, v160, v20, 0
v_dot2_f32_bf16 v61, v160, v24, 0
v_dot2_f32_bf16 v62, v164, v20, 0
v_dot2_f32_bf16 v63, v164, v24, 0
v_dot2_f32_bf16 v60, v161, v21, v60
v_dot2_f32_bf16 v61, v161, v25, v61
v_dot2_f32_bf16 v62, v165, v21, v62
v_dot2_f32_bf16 v63, v165, v25, v63
v_dot2_f32_bf16 v60, v162, v22, v60
v_dot2_f32_bf16 v61, v162, v26, v61
v_dot2_f32_bf16 v62, v166, v22, v62
v_dot2_f32_bf16 v63, v166, v26, v63
v_dot2_f32_bf16 v60, v163, v23, v60
v_dot2_f32_bf16 v61, v163, v27, v61
v_dot2_f32_bf16 v62, v167, v23, v62
v_dot2_f32_bf16 v63, v167, v27, v63
v_add_f32_dpp v60, v60, v60 row_ror:8 row_mask:0xf bank_mask:0xf
v_add_f32_dpp v61, v61, v61 row_ror:8 row_mask:0xf bank_mask:0xf
v_add_f32_dpp v62, v62, v62 row_ror:8 row_mask:0xf bank_mask:0xf
v_add_f32_dpp v63, v63, v63 row_ror:8 row_mask:0xf bank_mask:0xf
v_add_f32_dpp v60, v60, v60 row_ror:4 row_mask:0xf bank_mask:0xf
v_add_f32_dpp v61, v61, v61 row_ror:4 row_mask:0xf bank_mask:0xf
v_add_f32_dpp v62, v62, v62 row_ror:4 row_mask:0xf bank_mask:0xf
v_add_f32_dpp v63, v63, v63 row_ror:4 row_mask:0xf bank_mask:0xf
v_add_f32_dpp v60, v60, v60 row_ror:2 row_mask:0xf bank_mask:0xf
v_add_f32_dpp v61, v61, v61 row_ror:2 row_mask:0xf bank_mask:0xf
v_add_f32_dpp v62, v62, v62 row_ror:2 row_mask:0xf bank_mask:0xf
v_add_f32_dpp v63, v63, v63 row_ror:2 row_mask:0xf bank_mask:0xf
v_add_f32_dpp v60, v60, v60 row_ror:1 row_mask:0xf bank_mask:0xf
v_add_f32_dpp v61, v61, v61 row_ror:1 row_mask:0xf bank_mask:0xf
v_add_f32_dpp v62, v62, v62 row_ror:1 row_mask:0xf bank_mask:0xf
v_add_f32_dpp v63, v63, v63 row_ror:1 row_mask:0xf bank_mask:0xf
v_cmp_eq_u32 vcc, 8, v2
s_nop 1
v_cndmask_b32 v200, v200, v60, vcc
v_cndmask_b32 v201, v201, v61, vcc
v_cmp_eq_u32 vcc, 9, v2
s_nop 1
v_cndmask_b32 v200, v200, v62, vcc
v_cndmask_b32 v201, v201, v63, vcc
s_waitcnt vmcnt(4)
v_dot2_f32_bf16 v60, v168, v20, 0
v_dot2_f32_bf16 v61, v168, v24, 0
v_dot2_f32_bf16 v62, v172, v20, 0
v_dot2_f32_bf16 v63, v172, v24, 0
v_dot2_f32_bf16 v60, v169, v21, v60
v_dot2_f32_bf16 v61, v169, v25, v61
v_dot2_f32_bf16 v62, v173, v21, v62
v_dot2_f32_bf16 v63, v173, v25, v63
v_dot2_f32_bf16 v60, v170, v22, v60
v_dot2_f32_bf16 v61, v170, v26, v61
v_dot2_f32_bf16 v62, v174, v22, v62
v_dot2_f32_bf16 v63, v174, v26, v63
v_dot2_f32_bf16 v60, v171, v23, v60
v_dot2_f32_bf16 v61, v171, v27, v61
v_dot2_f32_bf16 v62, v175, v23, v62
v_dot2_f32_bf16 v63, v175, v27, v63
v_add_f32_dpp v60, v60, v60 row_ror:8 row_mask:0xf bank_mask:0xf
v_add_f32_dpp v61, v61, v61 row_ror:8 row_mask:0xf bank_mask:0xf
v_add_f32_dpp v62, v62, v62 row_ror:8 row_mask:0xf bank_mask:0xf
v_add_f32_dpp v63, v63, v63 row_ror:8 row_mask:0xf bank_mask:0xf
v_add_f32_dpp v60, v60, v60 row_ror:4 row_mask:0xf bank_mask:0xf
v_add_f32_dpp v61, v61, v61 row_ror:4 row_mask:0xf bank_mask:0xf
v_add_f32_dpp v62, v62, v62 row_ror:4 row_mask:0xf bank_mask:0xf
v_add_f32_dpp v63, v63, v63 row_ror:4 row_mask:0xf bank_mask:0xf
v_add_f32_dpp v60, v60, v60 row_ror:2 row_mask:0xf bank_mask:0xf
v_add_f32_dpp v61, v61, v61 row_ror:2 row_mask:0xf bank_mask:0xf
v_add_f32_dpp v62, v62, v62 row_ror:2 row_mask:0xf bank_mask:0xf
v_add_f32_dpp v63, v63, v63 row_ror:2 row_mask:0xf bank_mask:0xf
v_add_f32_dpp v60, v60, v60 row_ror:1 row_mask:0xf bank_mask:0xf
v_add_f32_dpp v61, v61, v61 row_ror:1 row_mask:0xf bank_mask:0xf
v_add_f32_dpp v62, v62, v62 row_ror:1 row_mask:0xf bank_mask:0xf
v_add_f32_dpp v63, v63, v63 row_ror:1 row_mask:0xf bank_mask:0xf
v_cmp_eq_u32 vcc, 10, v2
s_nop 1
v_cndmask_b32 v200, v200, v60, vcc
v_cndmask_b32 v201, v201, v61, vcc
v_cmp_eq_u32 vcc, 11, v2
s_nop 1
v_cndmask_b32 v200, v200, v62, vcc
v_cndmask_b32 v201, v201, v63, vcc
s_waitcnt vmcnt(2)
v_dot2_f32_bf16 v60, v176, v20, 0
v_dot2_f32_bf16 v61, v176, v24, 0
v_dot2_f32_bf16 v62, v180, v20, 0
v_dot2_f32_bf16 v63, v180, v24, 0
v_dot2_f32_bf16 v60, v177, v21, v60
v_dot2_f32_bf16 v61, v177, v25, v61
v_dot2_f32_bf16 v62, v181, v21, v62
v_dot2_f32_bf16 v63, v181, v25, v63
v_dot2_f32_bf16 v60, v178, v22, v60
v_dot2_f32_bf16 v61, v178, v26, v61
v_dot2_f32_bf16 v62, v182, v22, v62
v_dot2_f32_bf16 v63, v182, v26, v63
v_dot2_f32_bf16 v60, v179, v23, v60
v_dot2_f32_bf16 v61, v179, v27, v61
v_dot2_f32_bf16 v62, v183, v23, v62
v_dot2_f32_bf16 v63, v183, v27, v63
v_add_f32_dpp v60, v60, v60 row_ror:8 row_mask:0xf bank_mask:0xf
v_add_f32_dpp v61, v61, v61 row_ror:8 row_mask:0xf bank_mask:0xf
v_add_f32_dpp v62, v62, v62 row_ror:8 row_mask:0xf bank_mask:0xf
v_add_f32_dpp v63, v63, v63 row_ror:8 row_mask:0xf bank_mask:0xf
v_add_f32_dpp v60, v60, v60 row_ror:4 row_mask:0xf bank_mask:0xf
v_add_f32_dpp v61, v61, v61 row_ror:4 row_mask:0xf bank_mask:0xf
v_add_f32_dpp v62, v62, v62 row_ror:4 row_mask:0xf bank_mask:0xf
v_add_f32_dpp v63, v63, v63 row_ror:4 row_mask:0xf bank_mask:0xf
v_add_f32_dpp v60, v60, v60 row_ror:2 row_mask:0xf bank_mask:0xf
v_add_f32_dpp v61, v61, v61 row_ror:2 row_mask:0xf bank_mask:0xf
v_add_f32_dpp v62, v62, v62 row_ror:2 row_mask:0xf bank_mask:0xf
v_add_f32_dpp v63, v63, v63 row_ror:2 row_mask:0xf bank_mask:0xf
v_add_f32_dpp v60, v60, v60 row_ror:1 row_mask:0xf bank_mask:0xf
v_add_f32_dpp v61, v61, v61 row_ror:1 row_mask:0xf bank_mask:0xf
v_add_f32_dpp v62, v62, v62 row_ror:1 row_mask:0xf bank_mask:0xf
v_add_f32_dpp v63, v63, v63 row_ror:1 row_mask:0xf bank_mask:0xf
v_cmp_eq_u32 vcc, 12, v2
s_nop 1
v_cndmask_b32 v200, v200, v60, vcc
v_cndmask_b32 v201, v201, v61, vcc
v_cmp_eq_u32 vcc, 13, v2
s_nop 1
v_cndmask_b32 v200, v200, v62, vcc
v_cndmask_b32 v201, v201, v63, vcc
s_waitcnt vmcnt(0)
v_dot2_f32_bf16 v60, v184, v20, 0
v_dot2_f32_bf16 v61, v184, v24, 0
v_dot2_f32_bf16 v62, v188, v20, 0
v_dot2_f32_bf16 v63, v188, v24, 0
v_dot2_f32_bf16 v60, v185, v21, v60
v_dot2_f32_bf16 v61, v185, v25, v61
v_dot2_f32_bf16 v62, v189, v21, v62
v_dot2_f32_bf16 v63, v189, v25, v63
v_dot2_f32_bf16 v60, v186, v22, v60
v_dot2_f32_bf16 v61, v186, v26, v61
v_dot2_f32_bf16 v62, v190, v22, v62
v_dot2_f32_bf16 v63, v190, v26, v63
v_dot2_f32_bf16 v60, v187, v23, v60
v_dot2_f32_bf16 v61, v187, v27, v61
v_dot2_f32_bf16 v62, v191, v23, v62
v_dot2_f32_bf16 v63, v191, v27, v63
v_add_f32_dpp v60, v60, v60 row_ror:8 row_mask:0xf bank_mask:0xf
v_add_f32_dpp v61, v61, v61 row_ror:8 row_mask:0xf bank_mask:0xf
v_add_f32_dpp v62, v62, v62 row_ror:8 row_mask:0xf bank_mask:0xf
v_add_f32_dpp v63, v63, v63 row_ror:8 row_mask:0xf bank_mask:0xf
v_add_f32_dpp v60, v60, v60 row_ror:4 row_mask:0xf bank_mask:0xf
v_add_f32_dpp v61, v61, v61 row_ror:4 row_mask:0xf bank_mask:0xf
v_add_f32_dpp v62, v62, v62 row_ror:4 row_mask:0xf bank_mask:0xf
v_add_f32_dpp v63, v63, v63 row_ror:4 row_mask:0xf bank_mask:0xf
v_add_f32_dpp v60, v60, v60 row_ror:2 row_mask:0xf bank_mask:0xf
v_add_f32_dpp v61, v61, v61 row_ror:2 row_mask:0xf bank_mask:0xf
v_add_f32_dpp v62, v62, v62 row_ror:2 row_mask:0xf bank_mask:0xf
v_add_f32_dpp v63, v63, v63 row_ror:2 row_mask:0xf bank_mask:0xf
v_add_f32_dpp v60, v60, v60 row_ror:1 row_mask:0xf bank_mask:0xf
v_add_f32_dpp v61, v61, v61 row_ror:1 row_mask:0xf bank_mask:0xf
v_add_f32_dpp v62, v62, v62 row_ror:1 row_mask:0xf bank_mask:0xf
v_add_f32_dpp v63, v63, v63 row_ror:1 row_mask:0xf bank_mask:0xf
v_cmp_eq_u32 vcc, 14, v2
s_nop 1
v_cndmask_b32 v200, v200, v60, vcc
v_cndmask_b32 v201, v201, v61, vcc
v_cmp_eq_u32 vcc, 15, v2
s_nop 1
v_cndmask_b32 v200, v200, v62, vcc
v_cndmask_b32 v201, v201, v63, vcc
v_cvt_pk_bf16_f32 v200, v200, v200
v_cvt_pk_bf16_f32 v201, v201, v201
s_lshl_b32 s62, s32, 10
s_lshl_b32 s63, s34, 7
s_add_u32 s62, s62, s63
s_add_u32 s62, s62, 0x0
v_lshl_add_u32 v192, v1, 1, s62
buffer_store_short v200, v192, s[52:55], 0 offen sc1
s_mov_b32 s62, 32768
buffer_store_short v201, v192, s[52:55], s62 offen sc1
s_waitcnt vmcnt(0)
s_barrier
s_cmp_lg_u32 s34, 0
s_cbranch_scc1 L_sig_Wq
v_mov_b32 v192, 1
s_mov_b64 exec, 1
global_atomic_add v8, v192, s[28:29] offset:0 sc1
s_mov_b64 exec, -1
L_sig_Wq:
s_lshl_b32 s60, s32, 8
s_sub_u32 s61, 0x400000, s60
s_add_u32 s40, s22, s60
s_addc_u32 s41, s23, 0
s_and_b32 s41, s41, 0xffff
s_mov_b32 s42, s61
s_mov_b32 s43, 0x20000
s_lshl_b32 s60, s32, 17
s_mov_b32 s61, 0x20000
s_add_u32 s44, s24, s60
s_addc_u32 s45, s25, 0
s_and_b32 s45, s45, 0xffff
s_mov_b32 s46, s61
s_mov_b32 s47, 0x20000
v_lshlrev_b32 v10, 12, v3
v_lshl_add_u32 v10, v2, 4, v10
s_lshl_b32 s62, s34, 14
v_add_u32 v10, s62, v10
s_waitcnt vmcnt(1)
s_mov_b32 s62, 0
buffer_load_dwordx4 v[64:67], v9, s[40:43], s62 offen nt
s_waitcnt vmcnt(1)
s_mov_b32 s62, 8192
buffer_load_dwordx4 v[68:71], v9, s[40:43], s62 offen nt
s_waitcnt vmcnt(1)
s_mov_b32 s62, 16384
buffer_load_dwordx4 v[72:75], v9, s[40:43], s62 offen nt
s_waitcnt vmcnt(1)
s_mov_b32 s62, 24576
buffer_load_dwordx4 v[76:79], v9, s[40:43], s62 offen nt
s_waitcnt vmcnt(1)
s_mov_b32 s62, 32768
buffer_load_dwordx4 v[80:83], v9, s[40:43], s62 offen nt
s_waitcnt vmcnt(1)
s_mov_b32 s62, 40960
buffer_load_dwordx4 v[84:87], v9, s[40:43], s62 offen nt
s_waitcnt vmcnt(1)
s_mov_b32 s62, 49152
buffer_load_dwordx4 v[88:91], v9, s[40:43], s62 offen nt
s_waitcnt vmcnt(1)
s_mov_b32 s62, 57344
buffer_load_dwordx4 v[92:95], v9, s[40:43], s62 offen nt
s_waitcnt vmcnt(1)
s_mov_b32 s62, 65536
buffer_load_dwordx4 v[96:99], v9, s[40:43], s62 offen nt
s_waitcnt vmcnt(1)
s_mov_b32 s62, 73728
buffer_load_dwordx4 v[100:103], v9, s[40:43], s62 offen nt
s_waitcnt vmcnt(1)
s_mov_b32 s62, 81920
buffer_load_dwordx4 v[104:107], v9, s[40:43], s62 offen nt
s_waitcnt vmcnt(1)
s_mov_b32 s62, 90112
buffer_load_dwordx4 v[108:111], v9, s[40:43], s62 offen nt
s_waitcnt vmcnt(1)
s_mov_b32 s62, 98304
buffer_load_dwordx4 v[112:115], v9, s[40:43], s62 offen nt
s_waitcnt vmcnt(1)
s_mov_b32 s62, 106496
buffer_load_dwordx4 v[116:119], v9, s[40:43], s62 offen nt
s_waitcnt vmcnt(1)
s_mov_b32 s62, 114688
buffer_load_dwordx4 v[120:123], v9, s[40:43], s62 offen nt
s_waitcnt vmcnt(1)
s_mov_b32 s62, 122880
buffer_load_dwordx4 v[124:127], v9, s[40:43], s62 offen nt
s_waitcnt vmcnt(1)
buffer_load_dwordx4 v[128:131], v10, s[44:47], 0 offen offset:0 nt
s_waitcnt vmcnt(1)
buffer_load_dwordx4 v[132:135], v10, s[44:47], 0 offen offset:256 nt
s_waitcnt vmcnt(1)
buffer_load_dwordx4 v[136:139], v10, s[44:47], 0 offen offset:512 nt
s_waitcnt vmcnt(1)
buffer_load_dwordx4 v[140:143], v10, s[44:47], 0 offen offset:768 nt
s_waitcnt vmcnt(1)
buffer_load_dwordx4 v[144:147], v10, s[44:47], 0 offen offset:1024 nt
s_waitcnt vmcnt(1)
buffer_load_dwordx4 v[148:151], v10, s[44:47], 0 offen offset:1280 nt
s_waitcnt vmcnt(1)
buffer_load_dwordx4 v[152:155], v10, s[44:47], 0 offen offset:1536 nt
s_waitcnt vmcnt(1)
buffer_load_dwordx4 v[156:159], v10, s[44:47], 0 offen offset:1792 nt
s_waitcnt vmcnt(1)
buffer_load_dwordx4 v[160:163], v10, s[44:47], 0 offen offset:2048 nt
s_waitcnt vmcnt(1)
buffer_load_dwordx4 v[164:167], v10, s[44:47], 0 offen offset:2304 nt
s_waitcnt vmcnt(1)
buffer_load_dwordx4 v[168:171], v10, s[44:47], 0 offen offset:2560 nt
s_waitcnt vmcnt(1)
buffer_load_dwordx4 v[172:175], v10, s[44:47], 0 offen offset:2816 nt
s_waitcnt vmcnt(1)
buffer_load_dwordx4 v[176:179], v10, s[44:47], 0 offen offset:3072 nt
s_waitcnt vmcnt(1)
buffer_load_dwordx4 v[180:183], v10, s[44:47], 0 offen offset:3328 nt
s_waitcnt vmcnt(1)
buffer_load_dwordx4 v[184:187], v10, s[44:47], 0 offen offset:3584 nt
s_waitcnt vmcnt(1)
buffer_load_dwordx4 v[188:191], v10, s[44:47], 0 offen offset:3840 nt
s_cmp_lg_u32 s34, 0
s_cbranch_scc1 L_wc_Wc
s_mov_b32 s64, 0
L_poll_Wc:
global_load_dword v192, v8, s[28:29] offset:64 sc1
s_waitcnt vmcnt(0)
v_readfirstlane_b32 s65, v192
s_add_u32 s64, s64, 1
s_nop 2
s_cmp_ge_u32 s65, 32
s_cbranch_scc1 L_done_Wc
s_sleep 2
s_cmp_lt_u32 s64, 65536
s_cbranch_scc1 L_poll_Wc
L_done_Wc:
L_wc_Wc:
s_barrier
s_lshr_b32 s35, s34, 2
s_and_b32 s36, s34, 3
s_lshl_b32 s62, s35, 5
s_add_u32 s62, s62, s32
s_lshl_b32 s63, s62, 7
s_add_u32 s63, s63, 0x10000
v_lshl_add_u32 v192, v2, 3, s63
buffer_load_dwordx2 v[194:195], v192, s[52:55], 0 offen sc1
s_lshl_b32 s63, s62, 14
s_add_u32 s63, s63, 0x200000
s_lshl_b32 s64, s36, 12
s_add_u32 s63, s63, s64
v_lshl_add_u32 v193, v1, 4, s63
buffer_load_dwordx4 v[200:203], v193, s[52:55], 0 offen offset:0 sc1
buffer_load_dwordx4 v[204:207], v193, s[52:55], 0 offen offset:1024 sc1
buffer_load_dwordx4 v[208:211], v193, s[52:55], 0 offen offset:2048 sc1
buffer_load_dwordx4 v[212:215], v193, s[52:55], 0 offen offset:3072 sc1
s_waitcnt vmcnt(4)
v_mov_b32 v196, v194
s_nop 1
v_max_f32_dpp v196, v196, v196 row_ror:8 row_mask:0xf bank_mask:0xf
s_nop 1
v_max_f32_dpp v196, v196, v196 row_ror:4 row_mask:0xf bank_mask:0xf
s_nop 1
v_max_f32_dpp v196, v196, v196 row_ror:2 row_mask:0xf bank_mask:0xf
s_nop 1
v_max_f32_dpp v196, v196, v196 row_ror:1 row_mask:0xf bank_mask:0xf
v_sub_f32 v197, v194, v196
v_exp_f32 v197, v197
s_nop 0
v_mul_f32 v195, v195, v197
s_nop 1
v_add_f32_dpp v195, v195, v195 row_ror:8 row_mask:0xf bank_mask:0xf
s_nop 1
v_add_f32_dpp v195, v195, v195 row_ror:4 row_mask:0xf bank_mask:0xf
s_nop 1
v_add_f32_dpp v195, v195, v195 row_ror:2 row_mask:0xf bank_mask:0xf
s_nop 1
v_add_f32_dpp v195, v195, v195 row_ror:1 row_mask:0xf bank_mask:0xf
v_rcp_f32 v195, v195
s_nop 0
v_mul_f32 v197, v197, v195
s_lshl_b32 s64, s36, 2
s_add_u32 s65, s64, 0
v_readlane_b32 s66, v197, s65
s_add_u32 s65, s64, 1
v_readlane_b32 s67, v197, s65
s_add_u32 s65, s64, 2
v_readlane_b32 s68, v197, s65
s_add_u32 s65, s64, 3
v_readlane_b32 s69, v197, s65
s_waitcnt vmcnt(3)
v_lshlrev_b32 v216, 16, v200
v_and_b32 v217, 0xffff0000, v200
v_lshlrev_b32 v218, 16, v201
v_and_b32 v219, 0xffff0000, v201
v_lshlrev_b32 v220, 16, v202
v_and_b32 v221, 0xffff0000, v202
v_lshlrev_b32 v222, 16, v203
v_and_b32 v223, 0xffff0000, v203
v_mul_f32 v232, s66, v216
v_mul_f32 v233, s66, v217
v_mul_f32 v234, s66, v218
v_mul_f32 v235, s66, v219
v_mul_f32 v236, s66, v220
v_mul_f32 v237, s66, v221
v_mul_f32 v238, s66, v222
v_mul_f32 v239, s66, v223
s_waitcnt vmcnt(2)
v_lshlrev_b32 v216, 16, v204
v_and_b32 v217, 0xffff0000, v204
v_lshlrev_b32 v218, 16, v205
v_and_b32 v219, 0xffff0000, v205
v_lshlrev_b32 v220, 16, v206
v_and_b32 v221, 0xffff0000, v206
v_lshlrev_b32 v222, 16, v207
v_and_b32 v223, 0xffff0000, v207
v_fma_f32 v232, v216, s67, v232
v_fma_f32 v233, v217, s67, v233
v_fma_f32 v234, v218, s67, v234
v_fma_f32 v235, v219, s67, v235
v_fma_f32 v236, v220, s67, v236
v_fma_f32 v237, v221, s67, v237
v_fma_f32 v238, v222, s67, v238
v_fma_f32 v239, v223, s67, v239
s_waitcnt vmcnt(1)
v_lshlrev_b32 v216, 16, v208
v_and_b32 v217, 0xffff0000, v208
v_lshlrev_b32 v218, 16, v209
v_and_b32 v219, 0xffff0000, v209
v_lshlrev_b32 v220, 16, v210
v_and_b32 v221, 0xffff0000, v210
v_lshlrev_b32 v222, 16, v211
v_and_b32 v223, 0xffff0000, v211
v_fma_f32 v232, v216, s68, v232
v_fma_f32 v233, v217, s68, v233
v_fma_f32 v234, v218, s68, v234
v_fma_f32 v235, v219, s68, v235
v_fma_f32 v236, v220, s68, v236
v_fma_f32 v237, v221, s68, v237
v_fma_f32 v238, v222, s68, v238
v_fma_f32 v239, v223, s68, v239
s_waitcnt vmcnt(0)
v_lshlrev_b32 v216, 16, v212
v_and_b32 v217, 0xffff0000, v212
v_lshlrev_b32 v218, 16, v213
v_and_b32 v219, 0xffff0000, v213
v_lshlrev_b32 v220, 16, v214
v_and_b32 v221, 0xffff0000, v214
v_lshlrev_b32 v222, 16, v215
v_and_b32 v223, 0xffff0000, v215
v_fma_f32 v232, v216, s69, v232
v_fma_f32 v233, v217, s69, v233
v_fma_f32 v234, v218, s69, v234
v_fma_f32 v235, v219, s69, v235
v_fma_f32 v236, v220, s69, v236
v_fma_f32 v237, v221, s69, v237
v_fma_f32 v238, v222, s69, v238
v_fma_f32 v239, v223, s69, v239
s_lshl_b32 s62, s34, 11
v_lshl_add_u32 v192, v1, 5, s62
ds_write_b128 v192, v[232:235] offset:18432
ds_write_b128 v192, v[236:239] offset:18448
s_waitcnt lgkmcnt(0)
s_barrier
v_lshrrev_b32 v192, 3, v2
v_lshlrev_b32 v192, 13, v192
v_lshl_add_u32 v192, v3, 6, v192
s_lshl_b32 s62, s34, 8
v_add_u32 v192, s62, v192
ds_read_b128 v[200:203], v192 offset:18432
ds_read_b128 v[204:207], v192 offset:18448
ds_read_b128 v[208:211], v192 offset:18464
ds_read_b128 v[212:215], v192 offset:18480
ds_read_b128 v[216:219], v192 offset:20480
ds_read_b128 v[220:223], v192 offset:20496
ds_read_b128 v[224:227], v192 offset:20512
ds_read_b128 v[228:231], v192 offset:20528
s_waitcnt lgkmcnt(0)
v_add_f32 v200, v200, v216
v_add_f32 v201, v201, v217
v_add_f32 v202, v202, v218
v_add_f32 v203, v203, v219
v_add_f32 v204, v204, v220
v_add_f32 v205, v205, v221
v_add_f32 v206, v206, v222
v_add_f32 v207, v207, v223
v_add_f32 v208, v208, v224
v_add_f32 v209, v209, v225
v_add_f32 v210, v210, v226
v_add_f32 v211, v211, v227
v_add_f32 v212, v212, v228
v_add_f32 v213, v213, v229
v_add_f32 v214, v214, v230
v_add_f32 v215, v215, v231
ds_read_b128 v[216:219], v192 offset:22528
ds_read_b128 v[220:223], v192 offset:22544
ds_read_b128 v[224:227], v192 offset:22560
ds_read_b128 v[228:231], v192 offset:22576
s_waitcnt lgkmcnt(0)
v_add_f32 v200, v200, v216
v_add_f32 v201, v201, v217
v_add_f32 v202, v202, v218
v_add_f32 v203, v203, v219
v_add_f32 v204, v204, v220
v_add_f32 v205, v205, v221
v_add_f32 v206, v206, v222
v_add_f32 v207, v207, v223
v_add_f32 v208, v208, v224
v_add_f32 v209, v209, v225
v_add_f32 v210, v210, v226
v_add_f32 v211, v211, v227
v_add_f32 v212, v212, v228
v_add_f32 v213, v213, v229
v_add_f32 v214, v214, v230
v_add_f32 v215, v215, v231
ds_read_b128 v[216:219], v192 offset:24576
ds_read_b128 v[220:223], v192 offset:24592
ds_read_b128 v[224:227], v192 offset:24608
ds_read_b128 v[228:231], v192 offset:24624
s_waitcnt lgkmcnt(0)
v_add_f32 v200, v200, v216
v_add_f32 v201, v201, v217
v_add_f32 v202, v202, v218
v_add_f32 v203, v203, v219
v_add_f32 v204, v204, v220
v_add_f32 v205, v205, v221
v_add_f32 v206, v206, v222
v_add_f32 v207, v207, v223
v_add_f32 v208, v208, v224
v_add_f32 v209, v209, v225
v_add_f32 v210, v210, v226
v_add_f32 v211, v211, v227
v_add_f32 v212, v212, v228
v_add_f32 v213, v213, v229
v_add_f32 v214, v214, v230
v_add_f32 v215, v215, v231
v_cvt_pk_bf16_f32 v12, v200, v201
v_cvt_pk_bf16_f32 v13, v202, v203
v_cvt_pk_bf16_f32 v14, v204, v205
v_cvt_pk_bf16_f32 v15, v206, v207
v_cvt_pk_bf16_f32 v16, v208, v209
v_cvt_pk_bf16_f32 v17, v210, v211
v_cvt_pk_bf16_f32 v18, v212, v213
v_cvt_pk_bf16_f32 v19, v214, v215
s_mov_b32 s60, 0x01000100
v_perm_b32 v192, v12, v12, s60
v_and_b32 v28, v192, v4
v_and_b32 v29, v192, v5
v_and_b32 v30, v192, v6
v_and_b32 v31, v192, v7
s_waitcnt vmcnt(63)
s_nop 0
v_mfma_f32_16x16x32_bf16 v[44:47], v[28:31], v[64:67], 0
s_mov_b32 s60, 0x03020302
v_perm_b32 v193, v12, v12, s60
v_and_b32 v32, v193, v4
v_and_b32 v33, v193, v5
v_and_b32 v34, v193, v6
v_and_b32 v35, v193, v7
s_waitcnt vmcnt(63)
s_nop 0
v_mfma_f32_16x16x32_bf16 v[44:47], v[32:35], v[68:71], v[44:47]
s_mov_b32 s60, 0x01000100
v_perm_b32 v192, v13, v13, s60
v_and_b32 v28, v192, v4
v_and_b32 v29, v192, v5
v_and_b32 v30, v192, v6
v_and_b32 v31, v192, v7
s_waitcnt vmcnt(63)
s_nop 0
v_mfma_f32_16x16x32_bf16 v[44:47], v[28:31], v[72:75], v[44:47]
s_mov_b32 s60, 0x03020302
v_perm_b32 v193, v13, v13, s60
v_and_b32 v32, v193, v4
v_and_b32 v33, v193, v5
v_and_b32 v34, v193, v6
v_and_b32 v35, v193, v7
s_waitcnt vmcnt(63)
s_nop 0
v_mfma_f32_16x16x32_bf16 v[44:47], v[32:35], v[76:79], v[44:47]
s_mov_b32 s60, 0x01000100
v_perm_b32 v192, v14, v14, s60
v_and_b32 v28, v192, v4
v_and_b32 v29, v192, v5
v_and_b32 v30, v192, v6
v_and_b32 v31, v192, v7
s_waitcnt vmcnt(63)
s_nop 0
v_mfma_f32_16x16x32_bf16 v[44:47], v[28:31], v[80:83], v[44:47]
s_mov_b32 s60, 0x03020302
v_perm_b32 v193, v14, v14, s60
v_and_b32 v32, v193, v4
v_and_b32 v33, v193, v5
v_and_b32 v34, v193, v6
v_and_b32 v35, v193, v7
s_waitcnt vmcnt(63)
s_nop 0
v_mfma_f32_16x16x32_bf16 v[44:47], v[32:35], v[84:87], v[44:47]
s_mov_b32 s60, 0x01000100
v_perm_b32 v192, v15, v15, s60
v_and_b32 v28, v192, v4
v_and_b32 v29, v192, v5
v_and_b32 v30, v192, v6
v_and_b32 v31, v192, v7
s_waitcnt vmcnt(63)
s_nop 0
v_mfma_f32_16x16x32_bf16 v[44:47], v[28:31], v[88:91], v[44:47]
s_mov_b32 s60, 0x03020302
v_perm_b32 v193, v15, v15, s60
v_and_b32 v32, v193, v4
v_and_b32 v33, v193, v5
v_and_b32 v34, v193, v6
v_and_b32 v35, v193, v7
s_waitcnt vmcnt(63)
s_nop 0
v_mfma_f32_16x16x32_bf16 v[44:47], v[32:35], v[92:95], v[44:47]
s_mov_b32 s60, 0x01000100
v_perm_b32 v192, v16, v16, s60
v_and_b32 v28, v192, v4
v_and_b32 v29, v192, v5
v_and_b32 v30, v192, v6
v_and_b32 v31, v192, v7
s_waitcnt vmcnt(63)
s_nop 0
v_mfma_f32_16x16x32_bf16 v[44:47], v[28:31], v[96:99], v[44:47]
s_mov_b32 s60, 0x03020302
v_perm_b32 v193, v16, v16, s60
v_and_b32 v32, v193, v4
v_and_b32 v33, v193, v5
v_and_b32 v34, v193, v6
v_and_b32 v35, v193, v7
s_waitcnt vmcnt(63)
s_nop 0
v_mfma_f32_16x16x32_bf16 v[44:47], v[32:35], v[100:103], v[44:47]
s_mov_b32 s60, 0x01000100
v_perm_b32 v192, v17, v17, s60
v_and_b32 v28, v192, v4
v_and_b32 v29, v192, v5
v_and_b32 v30, v192, v6
v_and_b32 v31, v192, v7
s_waitcnt vmcnt(63)
s_nop 0
v_mfma_f32_16x16x32_bf16 v[44:47], v[28:31], v[104:107], v[44:47]
s_mov_b32 s60, 0x03020302
v_perm_b32 v193, v17, v17, s60
v_and_b32 v32, v193, v4
v_and_b32 v33, v193, v5
v_and_b32 v34, v193, v6
v_and_b32 v35, v193, v7
s_waitcnt vmcnt(63)
s_nop 0
v_mfma_f32_16x16x32_bf16 v[44:47], v[32:35], v[108:111], v[44:47]
s_mov_b32 s60, 0x01000100
v_perm_b32 v192, v18, v18, s60
v_and_b32 v28, v192, v4
v_and_b32 v29, v192, v5
v_and_b32 v30, v192, v6
v_and_b32 v31, v192, v7
s_waitcnt vmcnt(63)
s_nop 0
v_mfma_f32_16x16x32_bf16 v[44:47], v[28:31], v[112:115], v[44:47]
s_mov_b32 s60, 0x03020302
v_perm_b32 v193, v18, v18, s60
v_and_b32 v32, v193, v4
v_and_b32 v33, v193, v5
v_and_b32 v34, v193, v6
v_and_b32 v35, v193, v7
s_waitcnt vmcnt(63)
s_nop 0
v_mfma_f32_16x16x32_bf16 v[44:47], v[32:35], v[116:119], v[44:47]
s_mov_b32 s60, 0x01000100
v_perm_b32 v192, v19, v19, s60
v_and_b32 v28, v192, v4
v_and_b32 v29, v192, v5
v_and_b32 v30, v192, v6
v_and_b32 v31, v192, v7
s_waitcnt vmcnt(63)
s_nop 0
v_mfma_f32_16x16x32_bf16 v[44:47], v[28:31], v[120:123], v[44:47]
s_mov_b32 s60, 0x03020302
v_perm_b32 v193, v19, v19, s60
v_and_b32 v32, v193, v4
v_and_b32 v33, v193, v5
v_and_b32 v34, v193, v6
v_and_b32 v35, v193, v7
s_waitcnt vmcnt(63)
s_nop 0
v_mfma_f32_16x16x32_bf16 v[44:47], v[32:35], v[124:127], v[44:47]
v_lshrrev_b32 v192, 1, v3
v_lshlrev_b32 v192, 9, v192
v_lshl_add_u32 v192, v2, 5, v192
v_and_b32 v193, 1, v3
v_lshl_add_u32 v192, v193, 4, v192
s_lshl_b32 s63, s34, 10
v_add_u32 v192, s63, v192
s_nop 1
s_nop 5
ds_write_b128 v192, v[44:47] offset:9216
s_waitcnt lgkmcnt(0)
s_barrier
v_lshrrev_b32 v192, 3, v2
v_lshlrev_b32 v192, 9, v192
v_lshl_add_u32 v192, v3, 4, v192
s_lshl_b32 s62, s34, 6
v_add_u32 v192, s62, v192
ds_read_b128 v[200:203], v192 offset:9216
ds_read_b128 v[204:207], v192 offset:10240
ds_read_b128 v[208:211], v192 offset:11264
ds_read_b128 v[212:215], v192 offset:12288
ds_read_b128 v[216:219], v192 offset:13312
ds_read_b128 v[220:223], v192 offset:14336
ds_read_b128 v[224:227], v192 offset:15360
ds_read_b128 v[228:231], v192 offset:16384
s_waitcnt lgkmcnt(6)
v_add_f32 v200, v200, v204
v_add_f32 v201, v201, v205
v_add_f32 v202, v202, v206
v_add_f32 v203, v203, v207
s_waitcnt lgkmcnt(5)
v_add_f32 v200, v200, v208
v_add_f32 v201, v201, v209
v_add_f32 v202, v202, v210
v_add_f32 v203, v203, v211
s_waitcnt lgkmcnt(4)
v_add_f32 v200, v200, v212
v_add_f32 v201, v201, v213
v_add_f32 v202, v202, v214
v_add_f32 v203, v203, v215
s_waitcnt lgkmcnt(3)
v_add_f32 v200, v200, v216
v_add_f32 v201, v201, v217
v_add_f32 v202, v202, v218
v_add_f32 v203, v203, v219
s_waitcnt lgkmcnt(2)
v_add_f32 v200, v200, v220
v_add_f32 v201, v201, v221
v_add_f32 v202, v202, v222
v_add_f32 v203, v203, v223
s_waitcnt lgkmcnt(1)
v_add_f32 v200, v200, v224
v_add_f32 v201, v201, v225
v_add_f32 v202, v202, v226
v_add_f32 v203, v203, v227
s_waitcnt lgkmcnt(0)
v_add_f32 v200, v200, v228
v_add_f32 v201, v201, v229
v_add_f32 v202, v202, v230
v_add_f32 v203, v203, v231
v_cvt_pk_bf16_f32 v60, v200, v200
v_cvt_pk_bf16_f32 v61, v201, v201
v_cvt_pk_bf16_f32 v62, v202, v202
v_cvt_pk_bf16_f32 v63, v203, v203
v_and_b32 v28, v60, v4
v_and_b32 v29, v60, v5
v_and_b32 v30, v60, v6
v_and_b32 v31, v60, v7
v_and_b32 v32, v61, v4
v_and_b32 v33, v61, v5
v_and_b32 v34, v61, v6
v_and_b32 v35, v61, v7
v_and_b32 v36, v62, v4
v_and_b32 v37, v62, v5
v_and_b32 v38, v62, v6
v_and_b32 v39, v62, v7
v_and_b32 v40, v63, v4
v_and_b32 v41, v63, v5
v_and_b32 v42, v63, v6
v_and_b32 v43, v63, v7
s_nop 1
v_mfma_f32_16x16x32_bf16 v[44:47], v[28:31], v[128:131], 0
v_mfma_f32_16x16x32_bf16 v[48:51], v[28:31], v[132:135], 0
v_mfma_f32_16x16x32_bf16 v[52:55], v[28:31], v[136:139], 0
v_mfma_f32_16x16x32_bf16 v[56:59], v[28:31], v[140:143], 0
v_mfma_f32_16x16x32_bf16 v[44:47], v[32:35], v[144:147], v[44:47]
v_mfma_f32_16x16x32_bf16 v[48:51], v[32:35], v[148:151], v[48:51]
v_mfma_f32_16x16x32_bf16 v[52:55], v[32:35], v[152:155], v[52:55]
v_mfma_f32_16x16x32_bf16 v[56:59], v[32:35], v[156:159], v[56:59]
v_mfma_f32_16x16x32_bf16 v[44:47], v[36:39], v[160:163], v[44:47]
v_mfma_f32_16x16x32_bf16 v[48:51], v[36:39], v[164:167], v[48:51]
v_mfma_f32_16x16x32_bf16 v[52:55], v[36:39], v[168:171], v[52:55]
v_mfma_f32_16x16x32_bf16 v[56:59], v[36:39], v[172:175], v[56:59]
v_mfma_f32_16x16x32_bf16 v[44:47], v[40:43], v[176:179], v[44:47]
v_mfma_f32_16x16x32_bf16 v[48:51], v[40:43], v[180:183], v[48:51]
v_mfma_f32_16x16x32_bf16 v[52:55], v[40:43], v[184:187], v[52:55]
v_mfma_f32_16x16x32_bf16 v[56:59], v[40:43], v[188:191], v[56:59]
v_lshrrev_b32 v192, 1, v3
v_lshlrev_b32 v192, 11, v192
v_lshl_add_u32 v192, v2, 5, v192
v_and_b32 v193, 1, v3
v_lshl_add_u32 v192, v193, 4, v192
s_lshl_b32 s63, s34, 12
v_add_u32 v192, s63, v192
s_nop 1
ds_write_b128 v192, v[44:47] offset:18432
ds_write_b128 v192, v[48:51] offset:18944
ds_write_b128 v192, v[52:55] offset:19456
s_nop 5
ds_write_b128 v192, v[56:59] offset:19968
s_waitcnt lgkmcnt(0)
s_barrier
s_cmp_ge_u32 s34, 4
s_cbranch_scc1 L_W_yskip
v_lshlrev_b32 v192, 4, v0
ds_read_b128 v[200:203], v192 offset:18432
ds_read_b128 v[204:207], v192 offset:22528
ds_read_b128 v[208:211], v192 offset:26624
ds_read_b128 v[212:215], v192 offset:30720
ds_read_b128 v[216:219], v192 offset:34816
ds_read_b128 v[220:223], v192 offset:38912
ds_read_b128 v[224:227], v192 offset:43008
ds_read_b128 v[228:231], v192 offset:47104
v_lshrrev_b32 v193, 7, v0
v_lshlrev_b32 v193, 16, v193
v_and_b32 v194, 127, v0
v_lshl_add_u32 v193, v194, 4, v193
s_lshl_b32 s63, s32, 11
s_add_u32 s63, s63, 0x20000
v_add_u32 v193, s63, v193
s_waitcnt lgkmcnt(6)
v_add_f32 v200, v200, v204
v_add_f32 v201, v201, v205
v_add_f32 v202, v202, v206
v_add_f32 v203, v203, v207
s_waitcnt lgkmcnt(5)
v_add_f32 v200, v200, v208
v_add_f32 v201, v201, v209
v_add_f32 v202, v202, v210
v_add_f32 v203, v203, v211
s_waitcnt lgkmcnt(4)
v_add_f32 v200, v200, v212
v_add_f32 v201, v201, v213
v_add_f32 v202, v202, v214
v_add_f32 v203, v203, v215
s_waitcnt lgkmcnt(3)
v_add_f32 v200, v200, v216
v_add_f32 v201, v201, v217
v_add_f32 v202, v202, v218
v_add_f32 v203, v203, v219
s_waitcnt lgkmcnt(2)
v_add_f32 v200, v200, v220
v_add_f32 v201, v201, v221
v_add_f32 v202, v202, v222
v_add_f32 v203, v203, v223
s_waitcnt lgkmcnt(1)
v_add_f32 v200, v200, v224
v_add_f32 v201, v201, v225
v_add_f32 v202, v202, v226
v_add_f32 v203, v203, v227
s_waitcnt lgkmcnt(0)
v_add_f32 v200, v200, v228
v_add_f32 v201, v201, v229
v_add_f32 v202, v202, v230
v_add_f32 v203, v203, v231
buffer_store_dwordx4 v[200:203], v193, s[52:55], 0 offen sc1
L_W_yskip:
s_waitcnt vmcnt(0)
s_barrier
s_cmp_lg_u32 s34, 0
s_cbranch_scc1 L_sig_Wyb
v_mov_b32 v192, 1
s_mov_b64 exec, 1
global_atomic_add v8, v192, s[28:29] offset:128 sc1
s_mov_b64 exec, -1
L_sig_Wyb:
s_cmp_lg_u32 s34, 0
s_cbranch_scc1 L_wc_Wyb2
s_mov_b32 s64, 0
L_poll_Wyb2:
global_load_dword v192, v8, s[28:29] offset:128 sc1
s_waitcnt vmcnt(0)
v_readfirstlane_b32 s65, v192
s_add_u32 s64, s64, 1
s_nop 2
s_cmp_ge_u32 s65, 32
s_cbranch_scc1 L_done_Wyb2
s_sleep 2
s_cmp_lt_u32 s64, 65536
s_cbranch_scc1 L_poll_Wyb2
L_done_Wyb2:
L_wc_Wyb2:
s_barrier
s_lshr_b32 s35, s32, 4
s_and_b32 s36, s32, 15
v_mov_b32 v232, 0
v_mov_b32 v233, 0
v_mov_b32 v234, 0
v_mov_b32 v235, 0
s_cmp_ge_u32 s34, 4
s_cbranch_scc1 L_W_bskip
v_lshrrev_b32 v192, 3, v0
v_lshlrev_b32 v192, 11, v192
v_and_b32 v193, 7, v0
v_lshl_add_u32 v192, v193, 4, v192
s_lshl_b32 s62, s35, 16
s_lshl_b32 s63, s36, 7
s_add_u32 s62, s62, s63
s_add_u32 s62, s62, 0x20000
v_add_u32 v192, s62, v192
buffer_load_dwordx4 v[232:235], v192, s[52:55], 0 offen sc1
s_waitcnt vmcnt(0)
L_W_bskip:
s_nop 1
v_add_f32_dpp v232, v232, v232 row_ror:8 row_mask:0xf bank_mask:0xf
v_add_f32_dpp v233, v233, v233 row_ror:8 row_mask:0xf bank_mask:0xf
v_add_f32_dpp v234, v234, v234 row_ror:8 row_mask:0xf bank_mask:0xf
v_add_f32_dpp v235, v235, v235 row_ror:8 row_mask:0xf bank_mask:0xf
v_mov_b32 v192, v232
v_mov_b32 v193, v233
v_mov_b32 v194, v234
v_mov_b32 v195, v235
s_nop 1
v_permlane16_swap_b32 v232, v192
v_permlane16_swap_b32 v233, v193
v_permlane16_swap_b32 v234, v194
v_permlane16_swap_b32 v235, v195
s_nop 0
v_add_f32 v232, v232, v192
v_add_f32 v233, v233, v193
v_add_f32 v234, v234, v194
v_add_f32 v235, v235, v195
v_mov_b32 v192, v232
v_mov_b32 v193, v233
v_mov_b32 v194, v234
v_mov_b32 v195, v235
s_nop 1
v_permlane32_swap_b32 v232, v192
v_permlane32_swap_b32 v233, v193
v_permlane32_swap_b32 v234, v194
v_permlane32_swap_b32 v235, v195
s_nop 0
v_add_f32 v232, v232, v192
v_add_f32 v233, v233, v193
v_add_f32 v234, v234, v194
v_add_f32 v235, v235, v195
v_lshlrev_b32 v192, 4, v1
s_lshl_b32 s63, s34, 7
v_add_u32 v192, s63, v192
s_mov_b64 exec, 0xff
ds_write_b128 v192, v[232:235] offset:17408
s_mov_b64 exec, -1
s_waitcnt lgkmcnt(0)
s_barrier
s_cmp_lg_u32 s34, 0
s_cbranch_scc1 L_Wb_fin
v_lshlrev_b32 v192, 2, v1
s_mov_b32 exec_hi, 0
ds_read_b32 v193, v192 offset:17408
ds_read_b32 v194, v192 offset:17536
ds_read_b32 v195, v192 offset:17664
ds_read_b32 v196, v192 offset:17792
s_waitcnt lgkmcnt(0)
v_add_f32 v193, v193, v194
v_add_f32 v193, v193, v195
v_add_f32 v193, v193, v196
v_cvt_pk_bf16_f32 v193, v193, v193
s_lshr_b32 s62, s32, 4
s_lshl_b32 s62, s62, 11
s_and_b32 s63, s32, 15
s_lshl_b32 s63, s63, 6
s_add_u32 s62, s62, s63
s_add_u32 s62, s62, 1024
v_lshl_add_u32 v192, v1, 1, s62
global_store_short v192, v193, s[26:27]
s_mov_b64 exec, -1
L_Wb_fin:
v_lshrrev_b32 v192, 3, v1
s_lshl_b32 s62, s35, 8
s_lshl_b32 s63, s34, 3
s_add_u32 s62, s62, s63
v_add_u32 v192, s62, v192
v_lshlrev_b32 v9, 3, v192
v_add_u32 v9, 0x14000, v9
v_lshlrev_b32 v10, 10, v192
v_and_b32 v193, 7, v1
v_lshl_add_u32 v10, v193, 3, v10
s_lshl_b32 s63, s36, 6
s_add_u32 s63, s63, 0x100000
v_add_u32 v10, s63, v10
v_mov_b32 v80, 0xff800000
v_mov_b32 v81, 0
v_mov_b32 v64, 0
v_mov_b32 v65, 0
v_mov_b32 v82, 0xff800000
v_mov_b32 v83, 0
v_mov_b32 v66, 0
v_mov_b32 v67, 0
v_mov_b32 v84, 0xff800000
v_mov_b32 v85, 0
v_mov_b32 v68, 0
v_mov_b32 v69, 0
v_mov_b32 v86, 0xff800000
v_mov_b32 v87, 0
v_mov_b32 v70, 0
v_mov_b32 v71, 0
s_mov_b32 s66, -1
s_mov_b32 s67, 0xffff
s_mov_b32 s68, -1
s_mov_b32 s69, 0xffff
s_mov_b32 s70, -1
s_mov_b32 s71, 0xffff
s_mov_b32 s72, -1
s_mov_b32 s73, 0xffff
s_mov_b32 s64, 0
L_W_st:
s_mov_b64 exec, s[66:67]
buffer_load_dwordx2 v[80:81], v9, s[52:55], 0 offen offset:0 sc1
buffer_load_dwordx2 v[82:83], v9, s[52:55], 0 offen offset:512 sc1
buffer_load_dwordx2 v[84:85], v9, s[52:55], 0 offen offset:1024 sc1
buffer_load_dwordx2 v[86:87], v9, s[52:55], 0 offen offset:1536 sc1
s_mov_b64 exec, -1
s_waitcnt vmcnt(0)
v_max3_u32 v192, v80, v81, v82
v_max3_u32 v192, v192, v83, v84
v_max3_u32 v192, v192, v85, v86
v_max_u32 v192, v192, v87
v_cmp_eq_u32 vcc, -1, v192
s_add_u32 s64, s64, 1
s_nop 0
s_cmp_eq_u64 vcc, 0
s_cbranch_scc1 L_W_st_done
s_sleep 16
s_cmp_lt_u32 s64, 65536
s_cbranch_scc1 L_W_st
L_W_st_done:
v_mov_b32 v192, v80
v_mov_b32 v193, v82
v_mov_b32 v194, v84
v_mov_b32 v195, v86
s_nop 1
v_max_f32_dpp v192, v192, v192 row_ror:8 row_mask:0xf bank_mask:0xf
v_max_f32_dpp v193, v193, v193 row_ror:8 row_mask:0xf bank_mask:0xf
v_max_f32_dpp v194, v194, v194 row_ror:8 row_mask:0xf bank_mask:0xf
v_max_f32_dpp v195, v195, v195 row_ror:8 row_mask:0xf bank_mask:0xf
v_mov_b32 v196, v192
v_mov_b32 v197, v193
v_mov_b32 v198, v194
v_mov_b32 v199, v195
s_nop 1
v_permlane16_swap_b32 v192, v196
v_permlane16_swap_b32 v193, v197
v_permlane16_swap_b32 v194, v198
v_permlane16_swap_b32 v195, v199
s_nop 0
v_max_f32 v192, v192, v196
v_max_f32 v193, v193, v197
v_max_f32 v194, v194, v198
v_max_f32 v195, v195, v199
v_mov_b32 v196, v192
v_mov_b32 v197, v193
v_mov_b32 v198, v194
v_mov_b32 v199, v195
s_nop 1
v_permlane32_swap_b32 v192, v196
v_permlane32_swap_b32 v193, v197
v_permlane32_swap_b32 v194, v198
v_permlane32_swap_b32 v195, v199
s_nop 0
v_max_f32 v192, v192, v196
v_max_f32 v193, v193, v197
v_max_f32 v194, v194, v198
v_max_f32 v195, v195, v199
v_sub_f32 v192, v80, v192
v_sub_f32 v193, v82, v193
v_sub_f32 v194, v84, v194
v_sub_f32 v195, v86, v195
v_exp_f32 v192, v192
v_exp_f32 v193, v193
v_exp_f32 v194, v194
v_exp_f32 v195, v195
s_nop 0
v_mul_f32 v200, v81, v192
v_mul_f32 v201, v83, v193
v_mul_f32 v202, v85, v194
v_mul_f32 v203, v87, v195
s_nop 1
v_add_f32_dpp v200, v200, v200 row_ror:8 row_mask:0xf bank_mask:0xf
v_add_f32_dpp v201, v201, v201 row_ror:8 row_mask:0xf bank_mask:0xf
v_add_f32_dpp v202, v202, v202 row_ror:8 row_mask:0xf bank_mask:0xf
v_add_f32_dpp v203, v203, v203 row_ror:8 row_mask:0xf bank_mask:0xf
v_mov_b32 v196, v200
v_mov_b32 v197, v201
v_mov_b32 v198, v202
v_mov_b32 v199, v203
s_nop 1
v_permlane16_swap_b32 v200, v196
v_permlane16_swap_b32 v201, v197
v_permlane16_swap_b32 v202, v198
v_permlane16_swap_b32 v203, v199
s_nop 0
v_add_f32 v200, v200, v196
v_add_f32 v201, v201, v197
v_add_f32 v202, v202, v198
v_add_f32 v203, v203, v199
v_mov_b32 v196, v200
v_mov_b32 v197, v201
v_mov_b32 v198, v202
v_mov_b32 v199, v203
s_nop 1
v_permlane32_swap_b32 v200, v196
v_permlane32_swap_b32 v201, v197
v_permlane32_swap_b32 v202, v198
v_permlane32_swap_b32 v203, v199
s_nop 0
v_add_f32 v200, v200, v196
v_add_f32 v201, v201, v197
v_add_f32 v202, v202, v198
v_add_f32 v203, v203, v199
v_rcp_f32 v200, v200
v_rcp_f32 v201, v201
v_rcp_f32 v202, v202
v_rcp_f32 v203, v203
s_nop 0
v_mul_f32 v80, v192, v200
v_mul_f32 v81, v193, v201
v_mul_f32 v82, v194, v202
v_mul_f32 v83, v195, v203
v_mov_b32 v232, 0
v_mov_b32 v233, 0
v_mov_b32 v234, 0
v_mov_b32 v235, 0
s_mov_b32 s64, 0
s_mov_b32 s74, 0x01010101
s_mov_b32 s75, 0x0101
L_W_gate:
s_mov_b64 exec, s[74:75]
buffer_load_dword v192, v10, s[52:55], 0 offen sc1
s_waitcnt vmcnt(0)
v_cmp_ne_u32 vcc, -1, v192
s_mov_b64 exec, -1
s_add_u32 s64, s64, 1
s_cmp_lg_u64 vcc, 0
s_cbranch_scc1 L_W_gate_done
s_sleep 4
s_cmp_lt_u32 s64, 65536
s_cbranch_scc1 L_W_gate
L_W_gate_done:
s_mov_b32 s64, 0
s_mov_b32 s77, 65536
s_mov_b32 s78, 131072
s_mov_b32 s79, 196608
L_W_sweep:
s_mov_b64 exec, s[66:67]
s_cbranch_execz L_W_sw0
buffer_load_dwordx2 v[64:65], v10, s[52:55], 0 offen sc1
L_W_sw0:
s_mov_b64 exec, s[68:69]
s_cbranch_execz L_W_sw1
buffer_load_dwordx2 v[66:67], v10, s[52:55], s77 offen sc1
L_W_sw1:
s_mov_b64 exec, s[70:71]
s_cbranch_execz L_W_sw2
buffer_load_dwordx2 v[68:69], v10, s[52:55], s78 offen sc1
L_W_sw2:
s_mov_b64 exec, s[72:73]
s_cbranch_execz L_W_sw3
buffer_load_dwordx2 v[70:71], v10, s[52:55], s79 offen sc1
L_W_sw3:
s_waitcnt vmcnt(0)
s_mov_b64 exec, s[66:67]
s_cbranch_execz L_W_sx0
v_max_u32 v192, v64, v65
v_cmp_ne_u32 vcc, -1, v192
v_lshlrev_b32 v88, 16, v64
v_and_b32 v89, 0xffff0000, v64
v_lshlrev_b32 v90, 16, v65
v_and_b32 v91, 0xffff0000, v65
s_andn2_b64 s[66:67], exec, vcc
s_mov_b64 exec, vcc
v_fma_f32 v232, v80, v88, v232
v_fma_f32 v233, v80, v89, v233
v_fma_f32 v234, v80, v90, v234
v_fma_f32 v235, v80, v91, v235
L_W_sx0:
s_mov_b64 exec, s[68:69]
s_cbranch_execz L_W_sx1
v_max_u32 v192, v66, v67
v_cmp_ne_u32 vcc, -1, v192
v_lshlrev_b32 v88, 16, v66
v_and_b32 v89, 0xffff0000, v66
v_lshlrev_b32 v90, 16, v67
v_and_b32 v91, 0xffff0000, v67
s_andn2_b64 s[68:69], exec, vcc
s_mov_b64 exec, vcc
v_fma_f32 v232, v81, v88, v232
v_fma_f32 v233, v81, v89, v233
v_fma_f32 v234, v81, v90, v234
v_fma_f32 v235, v81, v91, v235
L_W_sx1:
s_mov_b64 exec, s[70:71]
s_cbranch_execz L_W_sx2
v_max_u32 v192, v68, v69
v_cmp_ne_u32 vcc, -1, v192
v_lshlrev_b32 v88, 16, v68
v_and_b32 v89, 0xffff0000, v68
v_lshlrev_b32 v90, 16, v69
v_and_b32 v91, 0xffff0000, v69
s_andn2_b64 s[70:71], exec, vcc
s_mov_b64 exec, vcc
v_fma_f32 v232, v82, v88, v232
v_fma_f32 v233, v82, v89, v233
v_fma_f32 v234, v82, v90, v234
v_fma_f32 v235, v82, v91, v235
L_W_sx2:
s_mov_b64 exec, s[72:73]
s_cbranch_execz L_W_sx3
v_max_u32 v192, v70, v71
v_cmp_ne_u32 vcc, -1, v192
v_lshlrev_b32 v88, 16, v70
v_and_b32 v89, 0xffff0000, v70
v_lshlrev_b32 v90, 16, v71
v_and_b32 v91, 0xffff0000, v71
s_andn2_b64 s[72:73], exec, vcc
s_mov_b64 exec, vcc
v_fma_f32 v232, v83, v88, v232
v_fma_f32 v233, v83, v89, v233
v_fma_f32 v234, v83, v90, v234
v_fma_f32 v235, v83, v91, v235
L_W_sx3:
s_mov_b64 exec, -1
s_or_b64 s[74:75], s[66:67], s[68:69]
s_or_b64 s[80:81], s[70:71], s[72:73]
s_or_b64 s[74:75], s[74:75], s[80:81]
s_cbranch_scc0 L_W_sweep_done
s_add_u32 s64, s64, 1
s_cmp_lt_u32 s64, 65536
s_cbranch_scc1 L_W_sweep
L_W_sweep_done:
s_nop 1
v_add_f32_dpp v232, v232, v232 row_ror:8 row_mask:0xf bank_mask:0xf
v_add_f32_dpp v233, v233, v233 row_ror:8 row_mask:0xf bank_mask:0xf
v_add_f32_dpp v234, v234, v234 row_ror:8 row_mask:0xf bank_mask:0xf
v_add_f32_dpp v235, v235, v235 row_ror:8 row_mask:0xf bank_mask:0xf
v_mov_b32 v204, v232
v_mov_b32 v205, v233
v_mov_b32 v206, v234
v_mov_b32 v207, v235
s_nop 1
v_permlane16_swap_b32 v232, v204
v_permlane16_swap_b32 v233, v205
v_permlane16_swap_b32 v234, v206
v_permlane16_swap_b32 v235, v207
s_nop 0
v_add_f32 v232, v232, v204
v_add_f32 v233, v233, v205
v_add_f32 v234, v234, v206
v_add_f32 v235, v235, v207
v_mov_b32 v204, v232
v_mov_b32 v205, v233
v_mov_b32 v206, v234
v_mov_b32 v207, v235
s_nop 1
v_permlane32_swap_b32 v232, v204
v_permlane32_swap_b32 v233, v205
v_permlane32_swap_b32 v234, v206
v_permlane32_swap_b32 v235, v207
s_nop 0
v_add_f32 v232, v232, v204
v_add_f32 v233, v233, v205
v_add_f32 v234, v234, v206
v_add_f32 v235, v235, v207
v_lshlrev_b32 v204, 4, v1
s_lshl_b32 s63, s34, 7
v_add_u32 v204, s63, v204
s_mov_b64 exec, 0xff
ds_write_b128 v204, v[232:235] offset:0
s_mov_b64 exec, -1
s_waitcnt lgkmcnt(0)
s_barrier
s_cmp_lg_u32 s34, 0
s_cbranch_scc1 L_Wa_fin
v_lshlrev_b32 v204, 2, v1
s_mov_b32 exec_hi, 0
ds_read_b32 v205, v204 offset:0
ds_read_b32 v206, v204 offset:128
ds_read_b32 v207, v204 offset:256
ds_read_b32 v208, v204 offset:384
ds_read_b32 v209, v204 offset:512
ds_read_b32 v210, v204 offset:640
ds_read_b32 v211, v204 offset:768
ds_read_b32 v212, v204 offset:896
s_waitcnt lgkmcnt(0)
v_add_f32 v205, v205, v206
v_add_f32 v205, v205, v207
v_add_f32 v205, v205, v208
v_add_f32 v205, v205, v209
v_add_f32 v205, v205, v210
v_add_f32 v205, v205, v211
v_add_f32 v205, v205, v212
v_cvt_pk_bf16_f32 v205, v205, v205
s_lshr_b32 s62, s32, 4
s_lshl_b32 s62, s62, 11
s_and_b32 s63, s32, 15
s_lshl_b32 s63, s63, 6
s_add_u32 s62, s62, s63
s_add_u32 s62, s62, 0
v_lshl_add_u32 v204, v1, 1, s62
global_store_short v204, v205, s[26:27]
s_mov_b64 exec, -1
L_Wa_fin:
s_endpgm
L_roleC:
v_mov_b32 v8, 0
s_lshr_b32 s35, s32, 4
s_lshr_b32 s36, s34, 1
s_and_b32 s37, s34, 1
s_lshl_b32 s60, s32, 19
s_mov_b32 s61, 0x80000
s_add_u32 s40, s16, s60
s_addc_u32 s41, s17, 0
s_and_b32 s41, s41, 0xffff
s_mov_b32 s42, s61
s_mov_b32 s43, 0x20000
s_mov_b32 s44, s30
s_and_b32 s45, s31, 0xffff
s_mov_b32 s46, 0x1000000
s_mov_b32 s47, 0x20000
v_lshlrev_b32 v9, 4, v1
s_lshl_b32 s62, s34, 13
v_add_u32 v9, s62, v9
s_mul_i32 s38, s34, 8448
s_mov_b32 s51, 4096
s_add_u32 s50, s38, 5120
s_waitcnt vmcnt(0)
s_add_u32 m0, s50, 0
s_nop 0
buffer_load_dwordx4 v9, s[40:43], 0 offen offset:0 nt lds
s_waitcnt vmcnt(0)
s_add_u32 m0, s50, 32
s_nop 0
buffer_load_dwordx4 v9, s[40:43], 0 offen offset:1024 nt lds
s_waitcnt vmcnt(0)
s_add_u32 m0, s50, 64
s_nop 0
buffer_load_dwordx4 v9, s[40:43], 0 offen offset:2048 nt lds
s_waitcnt vmcnt(0)
s_add_u32 m0, s50, 96
s_nop 0
buffer_load_dwordx4 v9, s[40:43], 0 offen offset:3072 nt lds
s_waitcnt vmcnt(0)
s_add_u32 m0, s50, 4224
s_nop 0
buffer_load_dwordx4 v9, s[40:43], s51 offen offset:0 nt lds
s_waitcnt vmcnt(0)
s_add_u32 m0, s50, 4256
s_nop 0
buffer_load_dwordx4 v9, s[40:43], s51 offen offset:1024 nt lds
s_waitcnt vmcnt(0)
s_add_u32 m0, s50, 4288
s_nop 0
buffer_load_dwordx4 v9, s[40:43], s51 offen offset:2048 nt lds
s_waitcnt vmcnt(0)
s_add_u32 m0, s50, 4320
s_nop 0
buffer_load_dwordx4 v9, s[40:43], s51 offen offset:3072 nt lds
v_add_u32 v9, 0x10000, v9
s_add_u32 s50, s38, 72704
s_waitcnt vmcnt(0)
s_add_u32 m0, s50, 0
s_nop 0
buffer_load_dwordx4 v9, s[40:43], 0 offen offset:0 nt lds
s_waitcnt vmcnt(0)
s_add_u32 m0, s50, 32
s_nop 0
buffer_load_dwordx4 v9, s[40:43], 0 offen offset:1024 nt lds
s_waitcnt vmcnt(0)
s_add_u32 m0, s50, 64
s_nop 0
buffer_load_dwordx4 v9, s[40:43], 0 offen offset:2048 nt lds
s_waitcnt vmcnt(0)
s_add_u32 m0, s50, 96
s_nop 0
buffer_load_dwordx4 v9, s[40:43], 0 offen offset:3072 nt lds
s_waitcnt vmcnt(0)
s_add_u32 m0, s50, 4224
s_nop 0
buffer_load_dwordx4 v9, s[40:43], s51 offen offset:0 nt lds
s_waitcnt vmcnt(0)
s_add_u32 m0, s50, 4256
s_nop 0
buffer_load_dwordx4 v9, s[40:43], s51 offen offset:1024 nt lds
s_waitcnt vmcnt(0)
s_add_u32 m0, s50, 4288
s_nop 0
buffer_load_dwordx4 v9, s[40:43], s51 offen offset:2048 nt lds
s_waitcnt vmcnt(0)
s_add_u32 m0, s50, 4320
s_nop 0
buffer_load_dwordx4 v9, s[40:43], s51 offen offset:3072 nt lds
v_add_u32 v9, 0x10000, v9
s_waitcnt vmcnt(0)
buffer_load_dwordx4 v[208:211], v9, s[40:43], 0 offen offset:0 nt
s_waitcnt vmcnt(0)
buffer_load_dwordx4 v[212:215], v9, s[40:43], 0 offen offset:1024 nt
s_waitcnt vmcnt(0)
buffer_load_dwordx4 v[216:219], v9, s[40:43], 0 offen offset:2048 nt
s_waitcnt vmcnt(0)
buffer_load_dwordx4 v[220:223], v9, s[40:43], 0 offen offset:3072 nt
s_waitcnt vmcnt(0)
buffer_load_dwordx4 v[224:227], v9, s[40:43], s51 offen offset:0 nt
s_waitcnt vmcnt(0)
buffer_load_dwordx4 v[228:231], v9, s[40:43], s51 offen offset:1024 nt
s_waitcnt vmcnt(0)
buffer_load_dwordx4 v[232:235], v9, s[40:43], s51 offen offset:2048 nt
s_waitcnt vmcnt(0)
buffer_load_dwordx4 v[236:239], v9, s[40:43], s51 offen offset:3072 nt
v_add_u32 v9, 0x10000, v9
s_add_u32 s62, s38, 5120
v_lshl_add_u32 v22, v1, 4, s62
s_lshl_b32 s62, s36, 4
v_add_u32 v240, s62, v2
v_mul_u32_u24 v10, 1056, v240
v_lshl_add_u32 v10, v3, 4, v10
v_add_u32 v10, 5120, v10
v_lshrrev_b32 v240, 1, v3
v_lshlrev_b32 v240, 3, v240
v_lshrrev_b32 v241, 2, v2
v_add_u32 v240, v240, v241
v_mul_u32_u24 v11, 1056, v240
v_and_b32 v240, 1, v3
v_lshl_add_u32 v11, v240, 5, v11
v_and_b32 v240, 3, v2
v_lshl_add_u32 v11, v240, 3, v11
s_lshl_b32 s62, s34, 7
s_add_u32 s62, s62, 5120
v_add_u32 v11, s62, v11
s_lshl_b32 s62, s37, 4
v_add_u32 v240, s62, v2
v_mul_u32_u24 v12, 144, v240
v_lshl_add_u32 v12, v3, 3, v12
s_lshl_b32 s62, s36, 5
v_add_u32 v12, s62, v12
v_lshlrev_b32 v15, 4, v240
s_lshl_b32 s62, s36, 2
v_add_u32 v14, s62, v15
v_and_b32 v240, 31, v1
v_mul_u32_u24 v13, 144, v240
v_lshrrev_b32 v241, 5, v1
v_lshl_add_u32 v13, v241, 4, v13
v_lshlrev_b32 v16, 4, v240
v_mov_b32 v17, 0x3e0293ee
v_mov_b32 v18, 0xff800000
v_mov_b32 v19, 0xff800000
v_mov_b32 v20, 0
v_mov_b32 v96, 0
v_mov_b32 v97, 0
v_mov_b32 v98, 0
v_mov_b32 v99, 0
v_mov_b32 v100, 0
v_mov_b32 v101, 0
v_mov_b32 v102, 0
v_mov_b32 v103, 0
v_mov_b32 v104, 0
v_mov_b32 v105, 0
v_mov_b32 v106, 0
v_mov_b32 v107, 0
v_mov_b32 v108, 0
v_mov_b32 v109, 0
v_mov_b32 v110, 0
v_mov_b32 v111, 0
v_mov_b32 v112, 0
v_mov_b32 v113, 0
v_mov_b32 v114, 0
v_mov_b32 v115, 0
v_mov_b32 v116, 0
v_mov_b32 v117, 0
v_mov_b32 v118, 0
v_mov_b32 v119, 0
v_mov_b32 v120, 0
v_mov_b32 v121, 0
v_mov_b32 v122, 0
v_mov_b32 v123, 0
v_mov_b32 v124, 0
v_mov_b32 v125, 0
v_mov_b32 v126, 0
v_mov_b32 v127, 0
s_cmp_lg_u32 s34, 0
s_cbranch_scc1 L_wc_Cq
s_mov_b32 s64, 0
L_poll_Cq:
global_load_dword v240, v8, s[28:29] offset:0 sc1
s_waitcnt vmcnt(0)
v_readfirstlane_b32 s65, v240
s_add_u32 s64, s64, 1
s_nop 2
s_cmp_ge_u32 s65, 32
s_cbranch_scc1 L_done_Cq
s_sleep 2
s_cmp_lt_u32 s64, 65536
s_cbranch_scc1 L_poll_Cq
L_done_Cq:
L_wc_Cq:
s_barrier
s_lshl_b32 s62, s35, 5
s_lshl_b32 s63, s37, 4
s_add_u32 s62, s62, s63
v_add_u32 v240, s62, v2
v_lshlrev_b32 v240, 10, v240
v_lshl_add_u32 v240, v3, 4, v240
v_add_u32 v240, 0x0, v240
buffer_load_dwordx4 v[32:35], v240, s[44:47], 0 offen offset:0 sc1
buffer_load_dwordx4 v[36:39], v240, s[44:47], 0 offen offset:64 sc1
buffer_load_dwordx4 v[40:43], v240, s[44:47], 0 offen offset:128 sc1
buffer_load_dwordx4 v[44:47], v240, s[44:47], 0 offen offset:192 sc1
buffer_load_dwordx4 v[48:51], v240, s[44:47], 0 offen offset:256 sc1
buffer_load_dwordx4 v[52:55], v240, s[44:47], 0 offen offset:320 sc1
buffer_load_dwordx4 v[56:59], v240, s[44:47], 0 offen offset:384 sc1
buffer_load_dwordx4 v[60:63], v240, s[44:47], 0 offen offset:448 sc1
buffer_load_dwordx4 v[64:67], v240, s[44:47], 0 offen offset:512 sc1
buffer_load_dwordx4 v[68:71], v240, s[44:47], 0 offen offset:576 sc1
buffer_load_dwordx4 v[72:75], v240, s[44:47], 0 offen offset:640 sc1
buffer_load_dwordx4 v[76:79], v240, s[44:47], 0 offen offset:704 sc1
buffer_load_dwordx4 v[80:83], v240, s[44:47], 0 offen offset:768 sc1
buffer_load_dwordx4 v[84:87], v240, s[44:47], 0 offen offset:832 sc1
buffer_load_dwordx4 v[88:91], v240, s[44:47], 0 offen offset:896 sc1
buffer_load_dwordx4 v[92:95], v240, s[44:47], 0 offen offset:960 sc1
s_mov_b32 s39, 0
s_mov_b32 s48, 0
.p2align 6
L_C_loop:
s_cmp_lg_u32 s39, 0
s_cbranch_scc1 L_C_top
s_waitcnt vmcnt(0)
L_C_top:
s_waitcnt lgkmcnt(0)
s_barrier
s_mov_b32 s52, 1
s_cmp_eq_u32 s39, 0
s_cselect_b32 s52, 0, s52
s_cmp_ge_u32 s39, 7
s_cselect_b32 s52, 0, s52
s_sub_u32 s50, 67584, s48
v_add_u32 v23, s50, v22
s_cmp_eq_u32 s52, 0
s_cbranch_scc1 L_C_st0
s_waitcnt vmcnt(7)
ds_write_b128 v23, v[208:211] offset:0
buffer_load_dwordx4 v[208:211], v9, s[40:43], 0 offen offset:0 nt
s_waitcnt vmcnt(7)
ds_write_b128 v23, v[212:215] offset:1056
buffer_load_dwordx4 v[212:215], v9, s[40:43], 0 offen offset:1024 nt
L_C_st0:
v_add_u32 v240, s48, v10
v_add_u32 v241, s48, v11
ds_read_b128 v[128:131], v240 offset:0
ds_read_b128 v[132:135], v240 offset:64
ds_read_b128 v[136:139], v240 offset:128
ds_read_b128 v[140:143], v240 offset:192
ds_read_b128 v[144:147], v240 offset:256
ds_read_b128 v[148:151], v240 offset:320
ds_read_b128 v[152:155], v240 offset:384
ds_read_b128 v[156:159], v240 offset:448
ds_read_b128 v[160:163], v240 offset:512
ds_read_b128 v[164:167], v240 offset:576
ds_read_b128 v[168:171], v240 offset:640
ds_read_b128 v[172:175], v240 offset:704
ds_read_b128 v[176:179], v240 offset:768
ds_read_b128 v[180:183], v240 offset:832
ds_read_b128 v[184:187], v240 offset:896
ds_read_b128 v[188:191], v240 offset:960
s_waitcnt lgkmcnt(15)
v_mfma_f32_16x16x32_bf16 v[28:31], v[128:131], v[32:35], 0
s_waitcnt lgkmcnt(14)
v_mfma_f32_16x16x32_bf16 v[28:31], v[132:135], v[36:39], v[28:31]
s_waitcnt lgkmcnt(13)
v_mfma_f32_16x16x32_bf16 v[28:31], v[136:139], v[40:43], v[28:31]
s_waitcnt lgkmcnt(12)
v_mfma_f32_16x16x32_bf16 v[28:31], v[140:143], v[44:47], v[28:31]
s_waitcnt lgkmcnt(11)
v_mfma_f32_16x16x32_bf16 v[28:31], v[144:147], v[48:51], v[28:31]
s_waitcnt lgkmcnt(10)
v_mfma_f32_16x16x32_bf16 v[28:31], v[148:151], v[52:55], v[28:31]
s_waitcnt lgkmcnt(9)
v_mfma_f32_16x16x32_bf16 v[28:31], v[152:155], v[56:59], v[28:31]
s_waitcnt lgkmcnt(8)
v_mfma_f32_16x16x32_bf16 v[28:31], v[156:159], v[60:63], v[28:31]
s_waitcnt lgkmcnt(7)
v_mfma_f32_16x16x32_bf16 v[28:31], v[160:163], v[64:67], v[28:31]
s_waitcnt lgkmcnt(6)
v_mfma_f32_16x16x32_bf16 v[28:31], v[164:167], v[68:71], v[28:31]
s_waitcnt lgkmcnt(5)
v_mfma_f32_16x16x32_bf16 v[28:31], v[168:171], v[72:75], v[28:31]
s_waitcnt lgkmcnt(4)
v_mfma_f32_16x16x32_bf16 v[28:31], v[172:175], v[76:79], v[28:31]
s_waitcnt lgkmcnt(3)
v_mfma_f32_16x16x32_bf16 v[28:31], v[176:179], v[80:83], v[28:31]
s_waitcnt lgkmcnt(2)
v_mfma_f32_16x16x32_bf16 v[28:31], v[180:183], v[84:87], v[28:31]
s_waitcnt lgkmcnt(1)
v_mfma_f32_16x16x32_bf16 v[28:31], v[184:187], v[88:91], v[28:31]
s_waitcnt lgkmcnt(0)
v_mfma_f32_16x16x32_bf16 v[28:31], v[188:191], v[92:95], v[28:31]
s_cmp_eq_u32 s52, 0
s_cbranch_scc1 L_C_st1
s_waitcnt vmcnt(7)
ds_write_b128 v23, v[216:219] offset:2112
buffer_load_dwordx4 v[216:219], v9, s[40:43], 0 offen offset:2048 nt
s_waitcnt vmcnt(7)
ds_write_b128 v23, v[220:223] offset:3168
buffer_load_dwordx4 v[220:223], v9, s[40:43], 0 offen offset:3072 nt
L_C_st1:
s_nop 7
v_mul_f32 v24, v28, v17
v_mul_f32 v25, v29, v17
v_mul_f32 v26, v30, v17
v_mul_f32 v27, v31, v17
v_max3_f32 v242, v24, v25, v26
v_max_f32 v242, v242, v27
v_mov_b32 v243, v242
s_nop 1
v_permlane16_swap_b32 v242, v243
s_nop 0
v_max_f32 v242, v242, v243
v_mov_b32 v243, v242
s_nop 1
v_permlane32_swap_b32 v242, v243
s_nop 0
v_max_f32 v242, v242, v243
s_mov_b64 exec, 0xffff
ds_write_b32 v14, v242 offset:0
s_mov_b64 exec, -1
s_waitcnt lgkmcnt(0)
s_barrier
ds_read_b128 v[192:195], v15 offset:0
ds_read_b128 v[196:199], v16 offset:0
s_waitcnt lgkmcnt(1)
v_max3_f32 v242, v192, v193, v194
v_max3_f32 v242, v242, v195, v18
v_sub_f32 v21, v18, v242
v_sub_f32 v24, v24, v242
v_sub_f32 v25, v25, v242
v_sub_f32 v26, v26, v242
v_sub_f32 v27, v27, v242
v_exp_f32 v21, v21
v_exp_f32 v24, v24
v_exp_f32 v25, v25
v_exp_f32 v26, v26
v_exp_f32 v27, v27
v_mov_b32 v18, v242
v_cvt_pk_bf16_f32 v244, v24, v25
v_cvt_pk_bf16_f32 v245, v26, v27
ds_write_b64 v12, v[244:245] offset:512
v_add_f32 v24, v24, v25
v_add_f32 v26, v26, v27
v_fma_f32 v20, v20, v21, v24
v_add_f32 v20, v20, v26
s_waitcnt lgkmcnt(1)
v_max3_f32 v242, v196, v197, v198
v_max3_f32 v242, v242, v199, v19
v_sub_f32 v21, v19, v242
v_exp_f32 v21, v21
v_mov_b32 v19, v242
v_mul_f32 v96, v96, v21
v_mul_f32 v97, v97, v21
v_mul_f32 v98, v98, v21
v_mul_f32 v99, v99, v21
v_mul_f32 v100, v100, v21
v_mul_f32 v101, v101, v21
v_mul_f32 v102, v102, v21
v_mul_f32 v103, v103, v21
v_mul_f32 v104, v104, v21
v_mul_f32 v105, v105, v21
v_mul_f32 v106, v106, v21
v_mul_f32 v107, v107, v21
v_mul_f32 v108, v108, v21
v_mul_f32 v109, v109, v21
v_mul_f32 v110, v110, v21
v_mul_f32 v111, v111, v21
v_mul_f32 v112, v112, v21
v_mul_f32 v113, v113, v21
v_mul_f32 v114, v114, v21
v_mul_f32 v115, v115, v21
v_mul_f32 v116, v116, v21
v_mul_f32 v117, v117, v21
v_mul_f32 v118, v118, v21
v_mul_f32 v119, v119, v21
v_mul_f32 v120, v120, v21
v_mul_f32 v121, v121, v21
v_mul_f32 v122, v122, v21
v_mul_f32 v123, v123, v21
v_mul_f32 v124, v124, v21
v_mul_f32 v125, v125, v21
v_mul_f32 v126, v126, v21
v_mul_f32 v127, v127, v21
s_cmp_eq_u32 s52, 0
s_cbranch_scc1 L_C_st2
s_waitcnt vmcnt(7)
ds_write_b128 v23, v[224:227] offset:4224
buffer_load_dwordx4 v[224:227], v9, s[40:43], s51 offen offset:0 nt
s_waitcnt vmcnt(7)
ds_write_b128 v23, v[228:231] offset:5280
buffer_load_dwordx4 v[228:231], v9, s[40:43], s51 offen offset:1024 nt
L_C_st2:
s_waitcnt lgkmcnt(0)
s_barrier
ds_read_b128 v[192:195], v13 offset:512
ds_read_b128 v[196:199], v13 offset:544
ds_read_b128 v[200:203], v13 offset:576
ds_read_b128 v[204:207], v13 offset:608
ds_read_b64_tr_b16 v[128:129], v241 offset:0
ds_read_b64_tr_b16 v[130:131], v241 offset:4224
ds_read_b64_tr_b16 v[132:133], v241 offset:64
ds_read_b64_tr_b16 v[134:135], v241 offset:4288
ds_read_b64_tr_b16 v[136:137], v241 offset:16896
ds_read_b64_tr_b16 v[138:139], v241 offset:21120
ds_read_b64_tr_b16 v[140:141], v241 offset:16960
ds_read_b64_tr_b16 v[142:143], v241 offset:21184
ds_read_b64_tr_b16 v[144:145], v241 offset:33792
ds_read_b64_tr_b16 v[146:147], v241 offset:38016
ds_read_b64_tr_b16 v[148:149], v241 offset:33856
ds_read_b64_tr_b16 v[150:151], v241 offset:38080
ds_read_b64_tr_b16 v[152:153], v241 offset:50688
ds_read_b64_tr_b16 v[154:155], v241 offset:54912
ds_read_b64_tr_b16 v[156:157], v241 offset:50752
ds_read_b64_tr_b16 v[158:159], v241 offset:54976
s_waitcnt lgkmcnt(12)
v_mfma_f32_32x32x16_bf16 v[96:111], v[128:131], v[192:195], v[96:111]
v_mfma_f32_32x32x16_bf16 v[112:127], v[132:135], v[192:195], v[112:127]
s_waitcnt lgkmcnt(8)
v_mfma_f32_32x32x16_bf16 v[96:111], v[136:139], v[196:199], v[96:111]
v_mfma_f32_32x32x16_bf16 v[112:127], v[140:143], v[196:199], v[112:127]
s_waitcnt lgkmcnt(4)
v_mfma_f32_32x32x16_bf16 v[96:111], v[144:147], v[200:203], v[96:111]
v_mfma_f32_32x32x16_bf16 v[112:127], v[148:151], v[200:203], v[112:127]
s_waitcnt lgkmcnt(0)
v_mfma_f32_32x32x16_bf16 v[96:111], v[152:155], v[204:207], v[96:111]
v_mfma_f32_32x32x16_bf16 v[112:127], v[156:159], v[204:207], v[112:127]
s_cmp_eq_u32 s52, 0
s_cbranch_scc1 L_C_st3
s_waitcnt vmcnt(7)
ds_write_b128 v23, v[232:235] offset:6336
buffer_load_dwordx4 v[232:235], v9, s[40:43], s51 offen offset:2048 nt
s_waitcnt vmcnt(7)
ds_write_b128 v23, v[236:239] offset:7392
buffer_load_dwordx4 v[236:239], v9, s[40:43], s51 offen offset:3072 nt
v_add_u32 v9, 0x10000, v9
L_C_st3:
s_sub_u32 s48, 67584, s48
s_add_u32 s39, s39, 1
s_cmp_lt_u32 s39, 8
s_cbranch_scc1 L_C_loop
v_mov_b32 v243, v20
s_nop 1
v_permlane16_swap_b32 v20, v243
s_nop 0
v_add_f32 v20, v20, v243
v_mov_b32 v243, v20
s_nop 1
v_permlane32_swap_b32 v20, v243
s_nop 0
v_add_f32 v20, v20, v243
s_barrier
s_mov_b64 exec, 0xffff
ds_write_b32 v14, v20 offset:0
s_mov_b64 exec, -1
v_and_b32 v240, 31, v1
v_mul_u32_u24 v240, 2064, v240
v_lshrrev_b32 v241, 5, v1
v_lshl_add_u32 v240, v241, 4, v240
s_lshl_b32 s62, s34, 8
s_add_u32 s62, s62, 5120
v_add_u32 v240, s62, v240
s_nop 5
ds_write_b128 v240, v[96:99] offset:0
ds_write_b128 v240, v[100:103] offset:32
ds_write_b128 v240, v[104:107] offset:64
ds_write_b128 v240, v[108:111] offset:96
ds_write_b128 v240, v[112:115] offset:128
ds_write_b128 v240, v[116:119] offset:160
ds_write_b128 v240, v[120:123] offset:192
ds_write_b128 v240, v[124:127] offset:224
s_waitcnt lgkmcnt(0)
s_barrier
s_mul_i32 s62, s34, 8256
s_add_u32 s62, s62, 5120
v_lshl_add_u32 v240, v1, 5, s62
ds_read_b128 v[128:131], v240 offset:0
ds_read_b128 v[132:135], v240 offset:16
ds_read_b128 v[136:139], v240 offset:2064
ds_read_b128 v[140:143], v240 offset:2080
ds_read_b128 v[144:147], v240 offset:4128
ds_read_b128 v[148:151], v240 offset:4144
ds_read_b128 v[152:155], v240 offset:6192
ds_read_b128 v[156:159], v240 offset:6208
s_lshl_b32 s62, s35, 5
s_lshl_b32 s63, s34, 2
s_add_u32 s62, s62, s63
s_lshl_b32 s62, s62, 4
s_and_b32 s63, s32, 15
s_add_u32 s62, s62, s63
s_lshl_b32 s62, s62, 10
s_add_u32 s62, s62, 0x200000
v_lshl_add_u32 v241, v1, 4, s62
s_waitcnt lgkmcnt(6)
v_cvt_pk_bf16_f32 v160, v128, v129
v_cvt_pk_bf16_f32 v161, v130, v131
v_cvt_pk_bf16_f32 v162, v132, v133
v_cvt_pk_bf16_f32 v163, v134, v135
s_mov_b32 s63, 0
buffer_store_dwordx4 v[160:163], v241, s[44:47], s63 offen sc1
s_waitcnt lgkmcnt(4)
v_cvt_pk_bf16_f32 v164, v136, v137
v_cvt_pk_bf16_f32 v165, v138, v139
v_cvt_pk_bf16_f32 v166, v140, v141
v_cvt_pk_bf16_f32 v167, v142, v143
s_mov_b32 s63, 16384
buffer_store_dwordx4 v[164:167], v241, s[44:47], s63 offen sc1
s_waitcnt lgkmcnt(2)
v_cvt_pk_bf16_f32 v168, v144, v145
v_cvt_pk_bf16_f32 v169, v146, v147
v_cvt_pk_bf16_f32 v170, v148, v149
v_cvt_pk_bf16_f32 v171, v150, v151
s_mov_b32 s63, 32768
buffer_store_dwordx4 v[168:171], v241, s[44:47], s63 offen sc1
s_waitcnt lgkmcnt(0)
v_cvt_pk_bf16_f32 v172, v152, v153
v_cvt_pk_bf16_f32 v173, v154, v155
v_cvt_pk_bf16_f32 v174, v156, v157
v_cvt_pk_bf16_f32 v175, v158, v159
s_mov_b32 s63, 49152
buffer_store_dwordx4 v[172:175], v241, s[44:47], s63 offen sc1
s_cmp_lg_u32 s34, 0
s_cbranch_scc1 L_C_nostat
ds_read_b128 v[192:195], v16 offset:0
s_lshl_b32 s62, s35, 5
v_and_b32 v240, 31, v1
v_add_u32 v240, s62, v240
v_lshlrev_b32 v240, 7, v240
s_and_b32 s63, s32, 15
s_lshl_b32 s63, s63, 3
s_add_u32 s63, s63, 0x10000
v_add_u32 v240, s63, v240
s_waitcnt lgkmcnt(0)
v_add_f32 v192, v192, v193
v_add_f32 v194, v194, v195
v_add_f32 v243, v192, v194
v_mov_b32 v242, v19
s_mov_b32 exec_hi, 0
buffer_store_dwordx2 v[242:243], v240, s[44:47], 0 offen sc1
s_mov_b64 exec, -1
L_C_nostat:
s_waitcnt vmcnt(0)
s_barrier
s_cmp_lg_u32 s34, 0
s_cbranch_scc1 L_sig_Cc
v_mov_b32 v244, 1
s_mov_b64 exec, 1
global_atomic_add v8, v244, s[28:29] offset:64 sc1
s_mov_b64 exec, -1
L_sig_Cc:
s_endpgm
L_exit:
s_endpgm
.section .rodata,"a"
.p2align 6
.amdhsa_kernel concat_heads__gqa_block_cached__compressed_kv_cla__decode_kernel
  .amdhsa_next_free_vgpr 256
  .amdhsa_next_free_sgpr 102
  .amdhsa_accum_offset 256
  .amdhsa_group_segment_fixed_size 0
  .amdhsa_kernarg_size 112
  .amdhsa_user_sgpr_count 2
  .amdhsa_user_sgpr_kernarg_segment_ptr 1
  .amdhsa_system_sgpr_workgroup_id_x 1
.end_amdhsa_kernel
```

```asm
; @launch grid=(256,1,1) block=(512,1,1) lds=153600
.amdgcn_target "amdgcn-amd-amdhsa--gfx950"
.text
.globl concat_heads__gqa_block_cached__compressed_kv_cla__decode_kernel
.p2align 8
.type concat_heads__gqa_block_cached__compressed_kv_cla__decode_kernel,@function
concat_heads__gqa_block_cached__compressed_kv_cla__decode_kernel:
s_cmp_ge_u32 s2, 256
s_cbranch_scc1 L_exit
s_load_dwordx16 s[4:19], s[0:1], 0
s_load_dwordx8 s[20:27], s[0:1], 64
s_load_dwordx4 s[28:31], s[0:1], 96
v_lshrrev_b32 v8, 6, v0
s_add_u32 s60, s2, 0
s_and_b32 s60, s60, 7
s_lshr_b32 s61, s2, 3
v_readfirstlane_b32 s34, v8
s_and_b32 s33, s61, 7
s_lshr_b32 s61, s61, 3
s_lshl_b32 s61, s61, 3
s_add_u32 s32, s60, s61
v_and_b32 v1, 63, v0
v_and_b32 v2, 15, v0
v_bfe_u32 v3, v0, 4, 2
v_and_b32 v8, 1, v0
v_lshlrev_b32 v8, 4, v8
v_mov_b32 v9, 0xffff
v_lshlrev_b32 v8, v8, v9
v_bfe_u32 v9, v0, 1, 2
v_cmp_eq_u32 vcc, 0, v9
s_nop 1
v_cndmask_b32 v4, 0, v8, vcc
v_cmp_eq_u32 vcc, 1, v9
s_nop 1
v_cndmask_b32 v5, 0, v8, vcc
v_cmp_eq_u32 vcc, 2, v9
s_nop 1
v_cndmask_b32 v6, 0, v8, vcc
v_cmp_eq_u32 vcc, 3, v9
s_nop 1
v_cndmask_b32 v7, 0, v8, vcc
s_waitcnt lgkmcnt(0)
s_cmp_eq_u32 s33, 6
s_cbranch_scc1 L_roleW
s_cmp_eq_u32 s33, 7
s_cbranch_scc1 L_roleC
L_roleA:
s_cmp_ge_u32 s34, 4
s_cbranch_scc1 L_A_helper
s_lshl_b32 s62, s32, 21
s_sub_u32 s63, 0x8000000, s62
s_add_u32 s40, s6, s62
s_addc_u32 s41, s7, 0
s_and_b32 s41, s41, 0xffff
s_mov_b32 s42, s63
s_mov_b32 s43, 0x20000
s_lshl_b32 s35, s33, 2
s_add_u32 s35, s35, s34
s_lshl_b32 s35, s35, 12
s_mov_b32 s36, s35
v_lshlrev_b32 v8, 4, v1
v_add_u32 v9, 0x4000000, v8
buffer_load_dwordx4 v[64:67], v8, s[40:43], s36 offen offset:0 nt
buffer_load_dwordx4 v[68:71], v8, s[40:43], s36 offen offset:1024 nt
buffer_load_dwordx4 v[72:75], v8, s[40:43], s36 offen offset:2048 nt
buffer_load_dwordx4 v[76:79], v8, s[40:43], s36 offen offset:3072 nt
s_add_u32 s44, s8, s62
s_addc_u32 s45, s9, 0
s_and_b32 s45, s45, 0xffff
s_mov_b32 s46, s63
s_mov_b32 s47, 0x20000
s_mul_i32 s60, s34, 6
s_add_u32 s60, s60, s33
s_lshl_b32 s37, s60, 10
s_add_u32 s37, s37, 0x1f8000
s_mov_b32 s52, 0x555f
s_cmp_lt_u32 s60, 8
s_cselect_b32 s61, 0, 1
s_cselect_b32 s62, 0x200, 0
s_or_b32 s52, s52, s62
s_lshl_b32 s61, s61, 31
s_add_u32 s61, s61, 24576
v_add_u32 v10, s61, v8
s_sub_u32 s60, s60, 8
s_cmp_lt_u32 s60, 8
s_cselect_b32 s61, 0, 1
s_cselect_b32 s62, 0x800, 0
s_or_b32 s52, s52, s62
s_lshl_b32 s61, s61, 31
s_add_u32 s61, s61, 16384
v_add_u32 v11, s61, v9
s_mul_i32 s52, s52, 0x10001
s_mov_b32 s53, s52
s_mov_b32 s48, 0xcccccccc
s_mov_b32 s49, 0xcccccccc
s_mov_b32 s50, 0xaaaaaaaa
s_mov_b32 s51, 0xaaaaaaaa
v_cmp_gt_u32 vcc, 8, v2
v_mov_b32 v47, 0
v_mov_b32 v48, 0
v_mov_b32 v49, 0
v_mov_b32 v50, 0
v_mov_b32 v51, 0
v_cndmask_b32 v12, v4, v47, vcc
v_cndmask_b32 v13, v5, v47, vcc
v_cndmask_b32 v14, v6, v47, vcc
v_cndmask_b32 v15, v7, v47, vcc
v_cndmask_b32 v4, v47, v4, vcc
v_cndmask_b32 v5, v47, v5, vcc
v_cndmask_b32 v6, v47, v6, vcc
v_cndmask_b32 v7, v47, v7, vcc
v_lshlrev_b32 v192, 2, v1
v_mov_b32 v193, 1
s_mov_b64 vcc, 0
s_barrier
s_waitcnt vmcnt(3)
buffer_load_dwordx4 v[80:83], v9, s[40:43], s36 offen offset:0 nt
s_waitcnt vmcnt(3)
buffer_load_dwordx4 v[84:87], v9, s[40:43], s36 offen offset:1024 nt
s_waitcnt vmcnt(3)
buffer_load_dwordx4 v[88:91], v9, s[40:43], s36 offen offset:2048 nt
s_waitcnt vmcnt(3)
buffer_load_dwordx4 v[92:95], v9, s[40:43], s36 offen offset:3072 nt
s_waitcnt vmcnt(3)
s_add_u32 s36, s36, 0x18000
buffer_load_dwordx4 v[96:99], v8, s[40:43], s36 offen offset:0 nt
s_waitcnt vmcnt(3)
buffer_load_dwordx4 v[100:103], v8, s[40:43], s36 offen offset:1024 nt
ds_add_u32 v192, v193 offset:256
s_waitcnt vmcnt(3)
buffer_load_dwordx4 v[104:107], v8, s[40:43], s36 offen offset:2048 nt
s_waitcnt vmcnt(3)
buffer_load_dwordx4 v[108:111], v8, s[40:43], s36 offen offset:3072 nt
ds_add_u32 v192, v193 offset:256
s_waitcnt vmcnt(3)
buffer_load_dwordx4 v[112:115], v9, s[40:43], s36 offen offset:0 nt
s_waitcnt vmcnt(3)
buffer_load_dwordx4 v[116:119], v9, s[40:43], s36 offen offset:1024 nt
ds_add_u32 v192, v193 offset:256
s_waitcnt vmcnt(3)
buffer_load_dwordx4 v[120:123], v9, s[40:43], s36 offen offset:2048 nt
s_waitcnt vmcnt(3)
buffer_load_dwordx4 v[124:127], v9, s[40:43], s36 offen offset:3072 nt
ds_add_u32 v192, v193 offset:256
s_waitcnt vmcnt(3)
s_add_u32 s36, s36, 0x18000
buffer_load_dwordx4 v[128:131], v8, s[40:43], s36 offen offset:0 nt
s_waitcnt vmcnt(3)
buffer_load_dwordx4 v[132:135], v8, s[40:43], s36 offen offset:1024 nt
ds_add_u32 v192, v193 offset:256
s_waitcnt vmcnt(3)
buffer_load_dwordx4 v[136:139], v8, s[40:43], s36 offen offset:2048 nt
s_waitcnt vmcnt(3)
buffer_load_dwordx4 v[140:143], v8, s[40:43], s36 offen offset:3072 nt
ds_add_u32 v192, v193 offset:256
s_waitcnt vmcnt(3)
buffer_load_dwordx4 v[144:147], v9, s[40:43], s36 offen offset:0 nt
s_waitcnt vmcnt(3)
buffer_load_dwordx4 v[148:151], v9, s[40:43], s36 offen offset:1024 nt
ds_add_u32 v192, v193 offset:256
s_waitcnt vmcnt(3)
buffer_load_dwordx4 v[152:155], v9, s[40:43], s36 offen offset:2048 nt
s_waitcnt vmcnt(3)
buffer_load_dwordx4 v[156:159], v9, s[40:43], s36 offen offset:3072 nt
ds_add_u32 v192, v193 offset:256
s_waitcnt vmcnt(3)
s_add_u32 s36, s36, 0x18000
buffer_load_dwordx4 v[160:163], v8, s[40:43], s36 offen offset:0 nt
s_waitcnt vmcnt(3)
buffer_load_dwordx4 v[164:167], v8, s[40:43], s36 offen offset:1024 nt
ds_add_u32 v192, v193 offset:256
s_waitcnt vmcnt(3)
buffer_load_dwordx4 v[168:171], v8, s[40:43], s36 offen offset:2048 nt
s_waitcnt vmcnt(3)
buffer_load_dwordx4 v[172:175], v8, s[40:43], s36 offen offset:3072 nt
ds_add_u32 v192, v193 offset:256
s_waitcnt vmcnt(3)
buffer_load_dwordx4 v[176:179], v9, s[40:43], s36 offen offset:0 nt
s_waitcnt vmcnt(3)
buffer_load_dwordx4 v[180:183], v9, s[40:43], s36 offen offset:1024 nt
ds_add_u32 v192, v193 offset:256
s_waitcnt vmcnt(3)
buffer_load_dwordx4 v[184:187], v9, s[40:43], s36 offen offset:2048 nt
s_waitcnt vmcnt(3)
buffer_load_dwordx4 v[188:191], v9, s[40:43], s36 offen offset:3072 nt
ds_add_u32 v192, v193 offset:256
v_lshlrev_b32 v61, 4, v2
s_mov_b32 s64, 0
L_A_qw:
ds_read_b32 v60, v47 offset:0
s_waitcnt lgkmcnt(0)
v_readfirstlane_b32 s65, v60
s_add_u32 s64, s64, 1
s_nop 2
s_cmp_ge_u32 s65, 1
s_cbranch_scc1 L_A_qw_ok
s_sleep 1
s_cmp_lt_u32 s64, 1048576
s_cbranch_scc1 L_A_qw
L_A_qw_ok:
v_lshlrev_b32 v60, 5, v2
ds_read_b128 v[16:19], v61 offset:1024
ds_read_b128 v[20:23], v61 offset:1280
s_waitcnt lgkmcnt(0)
v_dot2_f32_bf16 v24, v64, v16, 0
v_dot2_f32_bf16 v24, v65, v17, v24
v_dot2_f32_bf16 v24, v66, v18, v24
v_dot2_f32_bf16 v24, v67, v19, v24
s_waitcnt vmcnt(5)
s_add_u32 s36, s36, 0x18000
buffer_load_dwordx4 v[64:67], v8, s[40:43], s36 offen offset:0 nt
v_dot2_f32_bf16 v25, v68, v16, 0
v_dot2_f32_bf16 v25, v69, v17, v25
v_dot2_f32_bf16 v25, v70, v18, v25
v_dot2_f32_bf16 v25, v71, v19, v25
s_waitcnt vmcnt(5)
buffer_load_dwordx4 v[68:71], v8, s[40:43], s36 offen offset:1024 nt
ds_add_u32 v192, v193 offset:256
v_add_f32_dpp v28, v24, v24 row_ror:8 row_mask:0xf bank_mask:0x3
v_dot2_f32_bf16 v26, v72, v16, 0
v_dot2_f32_bf16 v26, v73, v17, v26
v_dot2_f32_bf16 v26, v74, v18, v26
v_dot2_f32_bf16 v26, v75, v19, v26
v_add_f32_dpp v28, v25, v25 row_ror:8 row_mask:0xf bank_mask:0xc
s_waitcnt vmcnt(5)
buffer_load_dwordx4 v[72:75], v8, s[40:43], s36 offen offset:2048 nt
v_dot2_f32_bf16 v27, v76, v16, 0
v_dot2_f32_bf16 v27, v77, v17, v27
v_dot2_f32_bf16 v27, v78, v18, v27
v_dot2_f32_bf16 v27, v79, v19, v27
s_waitcnt vmcnt(5)
buffer_load_dwordx4 v[76:79], v8, s[40:43], s36 offen offset:3072 nt
ds_add_u32 v192, v193 offset:256
v_add_f32_dpp v29, v26, v26 row_ror:8 row_mask:0xf bank_mask:0x3
v_dot2_f32_bf16 v24, v80, v20, 0
v_dot2_f32_bf16 v24, v81, v21, v24
v_dot2_f32_bf16 v24, v82, v22, v24
v_dot2_f32_bf16 v24, v83, v23, v24
v_add_f32_dpp v29, v27, v27 row_ror:8 row_mask:0xf bank_mask:0xc
s_waitcnt vmcnt(5)
buffer_load_dwordx4 v[80:83], v9, s[40:43], s36 offen offset:0 nt
v_add_f32_dpp v30, v28, v28 row_shl:4 row_mask:0xf bank_mask:0x5
v_dot2_f32_bf16 v25, v84, v20, 0
v_dot2_f32_bf16 v25, v85, v21, v25
v_dot2_f32_bf16 v25, v86, v22, v25
v_dot2_f32_bf16 v25, v87, v23, v25
v_add_f32_dpp v30, v29, v29 row_shr:4 row_mask:0xf bank_mask:0xa
s_waitcnt vmcnt(5)
buffer_load_dwordx4 v[84:87], v9, s[40:43], s36 offen offset:1024 nt
ds_add_u32 v192, v193 offset:256
v_add_f32_dpp v28, v24, v24 row_ror:8 row_mask:0xf bank_mask:0x3
v_dot2_f32_bf16 v26, v88, v20, 0
v_dot2_f32_bf16 v26, v89, v21, v26
v_dot2_f32_bf16 v26, v90, v22, v26
v_dot2_f32_bf16 v26, v91, v23, v26
v_add_f32_dpp v28, v25, v25 row_ror:8 row_mask:0xf bank_mask:0xc
v_dot2_f32_bf16 v27, v92, v20, 0
v_dot2_f32_bf16 v27, v93, v21, v27
v_dot2_f32_bf16 v27, v94, v22, v27
v_dot2_f32_bf16 v27, v95, v23, v27
v_add_f32_dpp v29, v26, v26 row_ror:8 row_mask:0xf bank_mask:0x3
v_dot2_f32_bf16 v24, v96, v16, 0
v_dot2_f32_bf16 v24, v97, v17, v24
v_dot2_f32_bf16 v24, v98, v18, v24
v_dot2_f32_bf16 v24, v99, v19, v24
v_add_f32_dpp v29, v27, v27 row_ror:8 row_mask:0xf bank_mask:0xc
s_waitcnt vmcnt(5)
buffer_load_dwordx4 v[88:91], v9, s[40:43], s36 offen offset:2048 nt
v_add_f32_dpp v31, v28, v28 row_shl:4 row_mask:0xf bank_mask:0x5
v_dot2_f32_bf16 v25, v100, v16, 0
v_dot2_f32_bf16 v25, v101, v17, v25
v_dot2_f32_bf16 v25, v102, v18, v25
v_dot2_f32_bf16 v25, v103, v19, v25
v_add_f32_dpp v31, v29, v29 row_shr:4 row_mask:0xf bank_mask:0xa
v_add_f32_dpp v34, v30, v30 quad_perm:[2,3,0,1] row_mask:0xf bank_mask:0xf
v_add_f32_dpp v28, v24, v24 row_ror:8 row_mask:0xf bank_mask:0x3
v_dot2_f32_bf16 v26, v104, v16, 0
v_dot2_f32_bf16 v26, v105, v17, v26
v_dot2_f32_bf16 v26, v106, v18, v26
v_dot2_f32_bf16 v26, v107, v19, v26
v_add_f32_dpp v35, v31, v31 quad_perm:[2,3,0,1] row_mask:0xf bank_mask:0xf
v_cndmask_b32 v32, v34, v35, s[48:49]
v_add_f32_dpp v28, v25, v25 row_ror:8 row_mask:0xf bank_mask:0xc
v_dot2_f32_bf16 v27, v108, v16, 0
v_dot2_f32_bf16 v27, v109, v17, v27
v_dot2_f32_bf16 v27, v110, v18, v27
v_dot2_f32_bf16 v27, v111, v19, v27
s_waitcnt vmcnt(5)
buffer_load_dwordx4 v[92:95], v9, s[40:43], s36 offen offset:3072 nt
ds_add_u32 v192, v193 offset:256
v_add_f32_dpp v29, v26, v26 row_ror:8 row_mask:0xf bank_mask:0x3
v_dot2_f32_bf16 v24, v112, v20, 0
v_dot2_f32_bf16 v24, v113, v21, v24
v_dot2_f32_bf16 v24, v114, v22, v24
v_dot2_f32_bf16 v24, v115, v23, v24
v_add_f32_dpp v29, v27, v27 row_ror:8 row_mask:0xf bank_mask:0xc
v_add_f32_dpp v30, v28, v28 row_shl:4 row_mask:0xf bank_mask:0x5
v_dot2_f32_bf16 v25, v116, v20, 0
v_dot2_f32_bf16 v25, v117, v21, v25
v_dot2_f32_bf16 v25, v118, v22, v25
v_dot2_f32_bf16 v25, v119, v23, v25
v_add_f32_dpp v30, v29, v29 row_shr:4 row_mask:0xf bank_mask:0xa
v_add_f32_dpp v28, v24, v24 row_ror:8 row_mask:0xf bank_mask:0x3
v_dot2_f32_bf16 v26, v120, v20, 0
v_dot2_f32_bf16 v26, v121, v21, v26
v_dot2_f32_bf16 v26, v122, v22, v26
v_dot2_f32_bf16 v26, v123, v23, v26
v_add_f32_dpp v28, v25, v25 row_ror:8 row_mask:0xf bank_mask:0xc
s_waitcnt vmcnt(5)
s_add_u32 s36, s36, 0x18000
buffer_load_dwordx4 v[96:99], v8, s[40:43], s36 offen offset:0 nt
v_dot2_f32_bf16 v27, v124, v20, 0
v_dot2_f32_bf16 v27, v125, v21, v27
v_dot2_f32_bf16 v27, v126, v22, v27
v_dot2_f32_bf16 v27, v127, v23, v27
v_add_f32_dpp v29, v26, v26 row_ror:8 row_mask:0xf bank_mask:0x3
v_dot2_f32_bf16 v24, v128, v16, 0
v_dot2_f32_bf16 v24, v129, v17, v24
v_dot2_f32_bf16 v24, v130, v18, v24
v_dot2_f32_bf16 v24, v131, v19, v24
v_add_f32_dpp v29, v27, v27 row_ror:8 row_mask:0xf bank_mask:0xc
v_add_f32_dpp v31, v28, v28 row_shl:4 row_mask:0xf bank_mask:0x5
v_dot2_f32_bf16 v25, v132, v16, 0
v_dot2_f32_bf16 v25, v133, v17, v25
v_dot2_f32_bf16 v25, v134, v18, v25
v_dot2_f32_bf16 v25, v135, v19, v25
v_add_f32_dpp v31, v29, v29 row_shr:4 row_mask:0xf bank_mask:0xa
s_waitcnt vmcnt(5)
buffer_load_dwordx4 v[100:103], v8, s[40:43], s36 offen offset:1024 nt
ds_add_u32 v192, v193 offset:256
v_add_f32_dpp v34, v30, v30 quad_perm:[2,3,0,1] row_mask:0xf bank_mask:0xf
v_add_f32_dpp v28, v24, v24 row_ror:8 row_mask:0xf bank_mask:0x3
v_dot2_f32_bf16 v26, v136, v16, 0
v_dot2_f32_bf16 v26, v137, v17, v26
v_dot2_f32_bf16 v26, v138, v18, v26
v_dot2_f32_bf16 v26, v139, v19, v26
v_add_f32_dpp v35, v31, v31 quad_perm:[2,3,0,1] row_mask:0xf bank_mask:0xf
v_cndmask_b32 v33, v34, v35, s[48:49]
v_add_f32_dpp v28, v25, v25 row_ror:8 row_mask:0xf bank_mask:0xc
v_add_f32_dpp v34, v32, v32 quad_perm:[1,0,3,2] row_mask:0xf bank_mask:0xf
v_mov_b32 v36, v37
v_mov_b32 v37, v38
v_mov_b32 v38, v39
v_mov_b32 v39, v40
v_mov_b32 v40, v41
v_mov_b32 v41, v42
v_mov_b32 v42, v43
v_mov_b32 v43, v44
v_mov_b32 v44, v45
v_mov_b32 v45, v46
v_dot2_f32_bf16 v27, v140, v16, 0
v_dot2_f32_bf16 v27, v141, v17, v27
v_dot2_f32_bf16 v27, v142, v18, v27
v_dot2_f32_bf16 v27, v143, v19, v27
v_add_f32_dpp v35, v33, v33 quad_perm:[1,0,3,2] row_mask:0xf bank_mask:0xf
v_cndmask_b32 v46, v34, v35, s[50:51]
v_add_f32_dpp v29, v26, v26 row_ror:8 row_mask:0xf bank_mask:0x3
v_dot2_f32_bf16 v24, v144, v20, 0
v_dot2_f32_bf16 v24, v145, v21, v24
v_dot2_f32_bf16 v24, v146, v22, v24
v_dot2_f32_bf16 v24, v147, v23, v24
v_add_f32_dpp v29, v27, v27 row_ror:8 row_mask:0xf bank_mask:0xc
s_waitcnt vmcnt(5)
buffer_load_dwordx4 v[104:107], v8, s[40:43], s36 offen offset:2048 nt
v_add_f32_dpp v30, v28, v28 row_shl:4 row_mask:0xf bank_mask:0x5
v_dot2_f32_bf16 v25, v148, v20, 0
v_dot2_f32_bf16 v25, v149, v21, v25
v_dot2_f32_bf16 v25, v150, v22, v25
v_dot2_f32_bf16 v25, v151, v23, v25
v_add_f32_dpp v30, v29, v29 row_shr:4 row_mask:0xf bank_mask:0xa
v_add_f32_dpp v28, v24, v24 row_ror:8 row_mask:0xf bank_mask:0x3
v_dot2_f32_bf16 v26, v152, v20, 0
v_dot2_f32_bf16 v26, v153, v21, v26
v_dot2_f32_bf16 v26, v154, v22, v26
v_dot2_f32_bf16 v26, v155, v23, v26
v_add_f32_dpp v28, v25, v25 row_ror:8 row_mask:0xf bank_mask:0xc
v_dot2_f32_bf16 v27, v156, v20, 0
v_dot2_f32_bf16 v27, v157, v21, v27
v_dot2_f32_bf16 v27, v158, v22, v27
v_dot2_f32_bf16 v27, v159, v23, v27
s_waitcnt vmcnt(5)
buffer_load_dwordx4 v[108:111], v8, s[40:43], s36 offen offset:3072 nt
ds_add_u32 v192, v193 offset:256
v_add_f32_dpp v29, v26, v26 row_ror:8 row_mask:0xf bank_mask:0x3
v_dot2_f32_bf16 v24, v160, v16, 0
v_dot2_f32_bf16 v24, v161, v17, v24
v_dot2_f32_bf16 v24, v162, v18, v24
v_dot2_f32_bf16 v24, v163, v19, v24
v_add_f32_dpp v29, v27, v27 row_ror:8 row_mask:0xf bank_mask:0xc
v_add_f32_dpp v31, v28, v28 row_shl:4 row_mask:0xf bank_mask:0x5
v_dot2_f32_bf16 v25, v164, v16, 0
v_dot2_f32_bf16 v25, v165, v17, v25
v_dot2_f32_bf16 v25, v166, v18, v25
v_dot2_f32_bf16 v25, v167, v19, v25
v_add_f32_dpp v31, v29, v29 row_shr:4 row_mask:0xf bank_mask:0xa
v_add_f32_dpp v34, v30, v30 quad_perm:[2,3,0,1] row_mask:0xf bank_mask:0xf
v_add_f32_dpp v28, v24, v24 row_ror:8 row_mask:0xf bank_mask:0x3
v_dot2_f32_bf16 v26, v168, v16, 0
v_dot2_f32_bf16 v26, v169, v17, v26
v_dot2_f32_bf16 v26, v170, v18, v26
v_dot2_f32_bf16 v26, v171, v19, v26
v_add_f32_dpp v35, v31, v31 quad_perm:[2,3,0,1] row_mask:0xf bank_mask:0xf
v_cndmask_b32 v32, v34, v35, s[48:49]
v_add_f32_dpp v28, v25, v25 row_ror:8 row_mask:0xf bank_mask:0xc
s_waitcnt vmcnt(5)
buffer_load_dwordx4 v[112:115], v9, s[40:43], s36 offen offset:0 nt
v_dot2_f32_bf16 v27, v172, v16, 0
v_dot2_f32_bf16 v27, v173, v17, v27
v_dot2_f32_bf16 v27, v174, v18, v27
v_dot2_f32_bf16 v27, v175, v19, v27
v_add_f32_dpp v29, v26, v26 row_ror:8 row_mask:0xf bank_mask:0x3
v_dot2_f32_bf16 v24, v176, v20, 0
v_dot2_f32_bf16 v24, v177, v21, v24
v_dot2_f32_bf16 v24, v178, v22, v24
v_dot2_f32_bf16 v24, v179, v23, v24
v_add_f32_dpp v29, v27, v27 row_ror:8 row_mask:0xf bank_mask:0xc
v_add_f32_dpp v30, v28, v28 row_shl:4 row_mask:0xf bank_mask:0x5
v_dot2_f32_bf16 v25, v180, v20, 0
v_dot2_f32_bf16 v25, v181, v21, v25
v_dot2_f32_bf16 v25, v182, v22, v25
v_dot2_f32_bf16 v25, v183, v23, v25
v_add_f32_dpp v30, v29, v29 row_shr:4 row_mask:0xf bank_mask:0xa
s_waitcnt vmcnt(5)
buffer_load_dwordx4 v[116:119], v9, s[40:43], s36 offen offset:1024 nt
ds_add_u32 v192, v193 offset:256
v_add_f32_dpp v28, v24, v24 row_ror:8 row_mask:0xf bank_mask:0x3
v_dot2_f32_bf16 v26, v184, v20, 0
v_dot2_f32_bf16 v26, v185, v21, v26
v_dot2_f32_bf16 v26, v186, v22, v26
v_dot2_f32_bf16 v26, v187, v23, v26
v_add_f32_dpp v28, v25, v25 row_ror:8 row_mask:0xf bank_mask:0xc
v_dot2_f32_bf16 v27, v188, v20, 0
v_dot2_f32_bf16 v27, v189, v21, v27
v_dot2_f32_bf16 v27, v190, v22, v27
v_dot2_f32_bf16 v27, v191, v23, v27
v_add_f32_dpp v29, v26, v26 row_ror:8 row_mask:0xf bank_mask:0x3
v_dot2_f32_bf16 v24, v64, v16, 0
v_dot2_f32_bf16 v24, v65, v17, v24
v_dot2_f32_bf16 v24, v66, v18, v24
v_dot2_f32_bf16 v24, v67, v19, v24
v_add_f32_dpp v29, v27, v27 row_ror:8 row_mask:0xf bank_mask:0xc
s_waitcnt vmcnt(5)
buffer_load_dwordx4 v[120:123], v9, s[40:43], s36 offen offset:2048 nt
v_add_f32_dpp v31, v28, v28 row_shl:4 row_mask:0xf bank_mask:0x5
v_dot2_f32_bf16 v25, v68, v16, 0
v_dot2_f32_bf16 v25, v69, v17, v25
v_dot2_f32_bf16 v25, v70, v18, v25
v_dot2_f32_bf16 v25, v71, v19, v25
v_add_f32_dpp v31, v29, v29 row_shr:4 row_mask:0xf bank_mask:0xa
v_add_f32_dpp v34, v30, v30 quad_perm:[2,3,0,1] row_mask:0xf bank_mask:0xf
v_add_f32_dpp v28, v24, v24 row_ror:8 row_mask:0xf bank_mask:0x3
v_dot2_f32_bf16 v26, v72, v16, 0
v_dot2_f32_bf16 v26, v73, v17, v26
v_dot2_f32_bf16 v26, v74, v18, v26
v_dot2_f32_bf16 v26, v75, v19, v26
v_add_f32_dpp v35, v31, v31 quad_perm:[2,3,0,1] row_mask:0xf bank_mask:0xf
v_cndmask_b32 v33, v34, v35, s[48:49]
v_add_f32_dpp v28, v25, v25 row_ror:8 row_mask:0xf bank_mask:0xc
v_add_f32_dpp v34, v32, v32 quad_perm:[1,0,3,2] row_mask:0xf bank_mask:0xf
v_mov_b32 v36, v37
v_mov_b32 v37, v38
v_mov_b32 v38, v39
v_mov_b32 v39, v40
v_mov_b32 v40, v41
v_mov_b32 v41, v42
v_mov_b32 v42, v43
v_mov_b32 v43, v44
v_mov_b32 v44, v45
v_mov_b32 v45, v46
v_dot2_f32_bf16 v27, v76, v16, 0
v_dot2_f32_bf16 v27, v77, v17, v27
v_dot2_f32_bf16 v27, v78, v18, v27
v_dot2_f32_bf16 v27, v79, v19, v27
v_add_f32_dpp v35, v33, v33 quad_perm:[1,0,3,2] row_mask:0xf bank_mask:0xf
v_cndmask_b32 v46, v34, v35, s[50:51]
s_waitcnt vmcnt(5)
buffer_load_dwordx4 v[124:127], v9, s[40:43], s36 offen offset:3072 nt
ds_add_u32 v192, v193 offset:256
v_add_f32_dpp v29, v26, v26 row_ror:8 row_mask:0xf bank_mask:0x3
v_dot2_f32_bf16 v24, v80, v20, 0
v_dot2_f32_bf16 v24, v81, v21, v24
v_dot2_f32_bf16 v24, v82, v22, v24
v_dot2_f32_bf16 v24, v83, v23, v24
v_add_f32_dpp v29, v27, v27 row_ror:8 row_mask:0xf bank_mask:0xc
v_add_f32_dpp v30, v28, v28 row_shl:4 row_mask:0xf bank_mask:0x5
v_dot2_f32_bf16 v25, v84, v20, 0
v_dot2_f32_bf16 v25, v85, v21, v25
v_dot2_f32_bf16 v25, v86, v22, v25
v_dot2_f32_bf16 v25, v87, v23, v25
v_add_f32_dpp v30, v29, v29 row_shr:4 row_mask:0xf bank_mask:0xa
v_add_f32_dpp v28, v24, v24 row_ror:8 row_mask:0xf bank_mask:0x3
v_dot2_f32_bf16 v26, v88, v20, 0
v_dot2_f32_bf16 v26, v89, v21, v26
v_dot2_f32_bf16 v26, v90, v22, v26
v_dot2_f32_bf16 v26, v91, v23, v26
v_add_f32_dpp v28, v25, v25 row_ror:8 row_mask:0xf bank_mask:0xc
s_waitcnt vmcnt(5)
s_add_u32 s36, s36, 0x18000
buffer_load_dwordx4 v[64:67], v8, s[40:43], s36 offen offset:0 nt
v_dot2_f32_bf16 v27, v92, v20, 0
v_dot2_f32_bf16 v27, v93, v21, v27
v_dot2_f32_bf16 v27, v94, v22, v27
v_dot2_f32_bf16 v27, v95, v23, v27
v_add_f32_dpp v29, v26, v26 row_ror:8 row_mask:0xf bank_mask:0x3
v_dot2_f32_bf16 v24, v96, v16, 0
v_dot2_f32_bf16 v24, v97, v17, v24
v_dot2_f32_bf16 v24, v98, v18, v24
v_dot2_f32_bf16 v24, v99, v19, v24
v_add_f32_dpp v29, v27, v27 row_ror:8 row_mask:0xf bank_mask:0xc
s_waitcnt vmcnt(5)
buffer_load_dwordx4 v[68:71], v8, s[40:43], s36 offen offset:1024 nt
ds_add_u32 v192, v193 offset:256
v_add_f32_dpp v31, v28, v28 row_shl:4 row_mask:0xf bank_mask:0x5
v_dot2_f32_bf16 v25, v100, v16, 0
v_dot2_f32_bf16 v25, v101, v17, v25
v_dot2_f32_bf16 v25, v102, v18, v25
v_dot2_f32_bf16 v25, v103, v19, v25
v_add_f32_dpp v31, v29, v29 row_shr:4 row_mask:0xf bank_mask:0xa
s_waitcnt vmcnt(5)
buffer_load_dwordx4 v[72:75], v8, s[40:43], s36 offen offset:2048 nt
v_add_f32_dpp v34, v30, v30 quad_perm:[2,3,0,1] row_mask:0xf bank_mask:0xf
v_add_f32_dpp v28, v24, v24 row_ror:8 row_mask:0xf bank_mask:0x3
v_dot2_f32_bf16 v26, v104, v16, 0
v_dot2_f32_bf16 v26, v105, v17, v26
v_dot2_f32_bf16 v26, v106, v18, v26
v_dot2_f32_bf16 v26, v107, v19, v26
v_add_f32_dpp v35, v31, v31 quad_perm:[2,3,0,1] row_mask:0xf bank_mask:0xf
v_cndmask_b32 v32, v34, v35, s[48:49]
v_add_f32_dpp v28, v25, v25 row_ror:8 row_mask:0xf bank_mask:0xc
s_waitcnt vmcnt(5)
buffer_load_dwordx4 v[76:79], v8, s[40:43], s36 offen offset:3072 nt
ds_add_u32 v192, v193 offset:256
v_dot2_f32_bf16 v27, v108, v16, 0
v_dot2_f32_bf16 v27, v109, v17, v27
v_dot2_f32_bf16 v27, v110, v18, v27
v_dot2_f32_bf16 v27, v111, v19, v27
s_waitcnt vmcnt(5)
buffer_load_dwordx4 v[80:83], v9, s[40:43], s36 offen offset:0 nt
v_add_f32_dpp v29, v26, v26 row_ror:8 row_mask:0xf bank_mask:0x3
v_dot2_f32_bf16 v24, v112, v20, 0
v_dot2_f32_bf16 v24, v113, v21, v24
v_dot2_f32_bf16 v24, v114, v22, v24
v_dot2_f32_bf16 v24, v115, v23, v24
v_add_f32_dpp v29, v27, v27 row_ror:8 row_mask:0xf bank_mask:0xc
s_waitcnt vmcnt(5)
buffer_load_dwordx4 v[84:87], v9, s[40:43], s36 offen offset:1024 nt
ds_add_u32 v192, v193 offset:256
v_add_f32_dpp v30, v28, v28 row_shl:4 row_mask:0xf bank_mask:0x5
v_dot2_f32_bf16 v25, v116, v20, 0
v_dot2_f32_bf16 v25, v117, v21, v25
v_dot2_f32_bf16 v25, v118, v22, v25
v_dot2_f32_bf16 v25, v119, v23, v25
v_add_f32_dpp v30, v29, v29 row_shr:4 row_mask:0xf bank_mask:0xa
s_waitcnt vmcnt(5)
buffer_load_dwordx4 v[88:91], v9, s[40:43], s36 offen offset:2048 nt
v_add_f32_dpp v28, v24, v24 row_ror:8 row_mask:0xf bank_mask:0x3
v_dot2_f32_bf16 v26, v120, v20, 0
v_dot2_f32_bf16 v26, v121, v21, v26
v_dot2_f32_bf16 v26, v122, v22, v26
v_dot2_f32_bf16 v26, v123, v23, v26
v_add_f32_dpp v28, v25, v25 row_ror:8 row_mask:0xf bank_mask:0xc
s_waitcnt vmcnt(5)
buffer_load_dwordx4 v[92:95], v9, s[40:43], s36 offen offset:3072 nt
ds_add_u32 v192, v193 offset:256
v_dot2_f32_bf16 v27, v124, v20, 0
v_dot2_f32_bf16 v27, v125, v21, v27
v_dot2_f32_bf16 v27, v126, v22, v27
v_dot2_f32_bf16 v27, v127, v23, v27
s_mov_b32 s38, 2
.p2align 6
L_A_ka:
s_cbranch_vccnz L_A_w1
s_waitcnt vmcnt(5)
L_A_w1:
s_waitcnt vmcnt(7)
s_add_u32 s36, s36, 0x18000
buffer_load_dwordx4 v[96:99], v8, s[40:43], s36 offen offset:0 nt
ds_read_b32 v194, v47 offset:8
v_add_f32_dpp v29, v26, v26 row_ror:8 row_mask:0xf bank_mask:0x3
v_dot2_f32_bf16 v24, v64, v16, 0
v_dot2_f32_bf16 v24, v65, v17, v24
v_dot2_f32_bf16 v24, v66, v18, v24
v_dot2_f32_bf16 v24, v67, v19, v24
v_add_f32_dpp v29, v27, v27 row_ror:8 row_mask:0xf bank_mask:0xc
s_cbranch_vccnz L_A_w2
s_waitcnt vmcnt(5)
L_A_w2:
s_waitcnt vmcnt(7)
buffer_load_dwordx4 v[100:103], v8, s[40:43], s36 offen offset:1024 nt
ds_add_u32 v192, v193 offset:256
s_waitcnt lgkmcnt(1)
v_cmp_ne_u32 vcc, 0, v194
v_add_f32_dpp v31, v28, v28 row_shl:4 row_mask:0xf bank_mask:0x5
v_dot2_f32_bf16 v25, v68, v16, 0
v_dot2_f32_bf16 v25, v69, v17, v25
v_dot2_f32_bf16 v25, v70, v18, v25
v_dot2_f32_bf16 v25, v71, v19, v25
v_add_f32_dpp v31, v29, v29 row_shr:4 row_mask:0xf bank_mask:0xa
s_cbranch_vccnz L_A_w3
s_waitcnt vmcnt(5)
L_A_w3:
s_waitcnt vmcnt(7)
buffer_load_dwordx4 v[104:107], v8, s[40:43], s36 offen offset:2048 nt
v_add_f32_dpp v34, v30, v30 quad_perm:[2,3,0,1] row_mask:0xf bank_mask:0xf
v_add_f32_dpp v28, v24, v24 row_ror:8 row_mask:0xf bank_mask:0x3
v_dot2_f32_bf16 v26, v72, v16, 0
v_dot2_f32_bf16 v26, v73, v17, v26
v_dot2_f32_bf16 v26, v74, v18, v26
v_dot2_f32_bf16 v26, v75, v19, v26
v_add_f32_dpp v35, v31, v31 quad_perm:[2,3,0,1] row_mask:0xf bank_mask:0xf
v_cndmask_b32 v33, v34, v35, s[48:49]
v_add_f32_dpp v28, v25, v25 row_ror:8 row_mask:0xf bank_mask:0xc
s_cbranch_vccnz L_A_w4
s_waitcnt vmcnt(5)
L_A_w4:
s_waitcnt vmcnt(7)
buffer_load_dwordx4 v[108:111], v8, s[40:43], s36 offen offset:3072 nt
ds_add_u32 v192, v193 offset:256
v_add_f32_dpp v34, v32, v32 quad_perm:[1,0,3,2] row_mask:0xf bank_mask:0xf
v_mov_b32 v36, v37
v_mov_b32 v37, v38
v_mov_b32 v38, v39
v_mov_b32 v39, v40
v_mov_b32 v40, v41
v_mov_b32 v41, v42
v_mov_b32 v42, v43
v_mov_b32 v43, v44
v_mov_b32 v44, v45
v_mov_b32 v45, v46
v_dot2_f32_bf16 v27, v76, v16, 0
v_dot2_f32_bf16 v27, v77, v17, v27
v_dot2_f32_bf16 v27, v78, v18, v27
v_dot2_f32_bf16 v27, v79, v19, v27
v_add_f32_dpp v35, v33, v33 quad_perm:[1,0,3,2] row_mask:0xf bank_mask:0xf
v_cndmask_b32 v46, v34, v35, s[50:51]
s_cbranch_vccnz L_A_w5
s_waitcnt vmcnt(5)
L_A_w5:
s_waitcnt vmcnt(7)
buffer_load_dwordx4 v[112:115], v9, s[40:43], s36 offen offset:0 nt
v_add_f32_dpp v29, v26, v26 row_ror:8 row_mask:0xf bank_mask:0x3
v_dot2_f32_bf16 v24, v80, v20, 0
v_dot2_f32_bf16 v24, v81, v21, v24
v_dot2_f32_bf16 v24, v82, v22, v24
v_dot2_f32_bf16 v24, v83, v23, v24
v_add_f32_dpp v29, v27, v27 row_ror:8 row_mask:0xf bank_mask:0xc
s_cbranch_vccnz L_A_w6
s_waitcnt vmcnt(5)
L_A_w6:
s_waitcnt vmcnt(7)
buffer_load_dwordx4 v[116:119], v9, s[40:43], s36 offen offset:1024 nt
ds_add_u32 v192, v193 offset:256
v_add_f32_dpp v30, v28, v28 row_shl:4 row_mask:0xf bank_mask:0x5
v_dot2_f32_bf16 v25, v84, v20, 0
v_dot2_f32_bf16 v25, v85, v21, v25
v_dot2_f32_bf16 v25, v86, v22, v25
v_dot2_f32_bf16 v25, v87, v23, v25
v_add_f32_dpp v30, v29, v29 row_shr:4 row_mask:0xf bank_mask:0xa
s_cbranch_vccnz L_A_w7
s_waitcnt vmcnt(5)
L_A_w7:
s_waitcnt vmcnt(7)
buffer_load_dwordx4 v[120:123], v9, s[40:43], s36 offen offset:2048 nt
v_add_f32_dpp v28, v24, v24 row_ror:8 row_mask:0xf bank_mask:0x3
v_dot2_f32_bf16 v26, v88, v20, 0
v_dot2_f32_bf16 v26, v89, v21, v26
v_dot2_f32_bf16 v26, v90, v22, v26
v_dot2_f32_bf16 v26, v91, v23, v26
v_add_f32_dpp v28, v25, v25 row_ror:8 row_mask:0xf bank_mask:0xc
s_cbranch_vccnz L_A_w8
s_waitcnt vmcnt(5)
L_A_w8:
s_waitcnt vmcnt(7)
buffer_load_dwordx4 v[124:127], v9, s[40:43], s36 offen offset:3072 nt
ds_add_u32 v192, v193 offset:256
v_dot2_f32_bf16 v27, v92, v20, 0
v_dot2_f32_bf16 v27, v93, v21, v27
v_dot2_f32_bf16 v27, v94, v22, v27
v_dot2_f32_bf16 v27, v95, v23, v27
s_cbranch_vccnz L_A_w9
s_waitcnt vmcnt(5)
L_A_w9:
s_waitcnt vmcnt(7)
s_add_u32 s36, s36, 0x18000
buffer_load_dwordx4 v[64:67], v8, s[40:43], s36 offen offset:0 nt
ds_read_b32 v194, v47 offset:8
v_add_f32_dpp v29, v26, v26 row_ror:8 row_mask:0xf bank_mask:0x3
v_dot2_f32_bf16 v24, v96, v16, 0
v_dot2_f32_bf16 v24, v97, v17, v24
v_dot2_f32_bf16 v24, v98, v18, v24
v_dot2_f32_bf16 v24, v99, v19, v24
v_add_f32_dpp v29, v27, v27 row_ror:8 row_mask:0xf bank_mask:0xc
s_cbranch_vccnz L_A_w10
s_waitcnt vmcnt(5)
L_A_w10:
s_waitcnt vmcnt(7)
buffer_load_dwordx4 v[68:71], v8, s[40:43], s36 offen offset:1024 nt
ds_add_u32 v192, v193 offset:256
s_waitcnt lgkmcnt(1)
v_cmp_ne_u32 vcc, 0, v194
v_add_f32_dpp v31, v28, v28 row_shl:4 row_mask:0xf bank_mask:0x5
v_dot2_f32_bf16 v25, v100, v16, 0
v_dot2_f32_bf16 v25, v101, v17, v25
v_dot2_f32_bf16 v25, v102, v18, v25
v_dot2_f32_bf16 v25, v103, v19, v25
v_add_f32_dpp v31, v29, v29 row_shr:4 row_mask:0xf bank_mask:0xa
s_cbranch_vccnz L_A_w11
s_waitcnt vmcnt(5)
L_A_w11:
s_waitcnt vmcnt(7)
buffer_load_dwordx4 v[72:75], v8, s[40:43], s36 offen offset:2048 nt
v_add_f32_dpp v34, v30, v30 quad_perm:[2,3,0,1] row_mask:0xf bank_mask:0xf
v_add_f32_dpp v28, v24, v24 row_ror:8 row_mask:0xf bank_mask:0x3
v_dot2_f32_bf16 v26, v104, v16, 0
v_dot2_f32_bf16 v26, v105, v17, v26
v_dot2_f32_bf16 v26, v106, v18, v26
v_dot2_f32_bf16 v26, v107, v19, v26
v_add_f32_dpp v35, v31, v31 quad_perm:[2,3,0,1] row_mask:0xf bank_mask:0xf
v_cndmask_b32 v32, v34, v35, s[48:49]
v_add_f32_dpp v28, v25, v25 row_ror:8 row_mask:0xf bank_mask:0xc
s_cbranch_vccnz L_A_w12
s_waitcnt vmcnt(5)
L_A_w12:
s_waitcnt vmcnt(7)
buffer_load_dwordx4 v[76:79], v8, s[40:43], s36 offen offset:3072 nt
ds_add_u32 v192, v193 offset:256
v_dot2_f32_bf16 v27, v108, v16, 0
v_dot2_f32_bf16 v27, v109, v17, v27
v_dot2_f32_bf16 v27, v110, v18, v27
v_dot2_f32_bf16 v27, v111, v19, v27
s_cbranch_vccnz L_A_w13
s_waitcnt vmcnt(5)
L_A_w13:
s_waitcnt vmcnt(7)
buffer_load_dwordx4 v[80:83], v9, s[40:43], s36 offen offset:0 nt
v_add_f32_dpp v29, v26, v26 row_ror:8 row_mask:0xf bank_mask:0x3
v_dot2_f32_bf16 v24, v112, v20, 0
v_dot2_f32_bf16 v24, v113, v21, v24
v_dot2_f32_bf16 v24, v114, v22, v24
v_dot2_f32_bf16 v24, v115, v23, v24
v_add_f32_dpp v29, v27, v27 row_ror:8 row_mask:0xf bank_mask:0xc
s_cbranch_vccnz L_A_w14
s_waitcnt vmcnt(5)
L_A_w14:
s_waitcnt vmcnt(7)
buffer_load_dwordx4 v[84:87], v9, s[40:43], s36 offen offset:1024 nt
ds_add_u32 v192, v193 offset:256
v_add_f32_dpp v30, v28, v28 row_shl:4 row_mask:0xf bank_mask:0x5
v_dot2_f32_bf16 v25, v116, v20, 0
v_dot2_f32_bf16 v25, v117, v21, v25
v_dot2_f32_bf16 v25, v118, v22, v25
v_dot2_f32_bf16 v25, v119, v23, v25
v_add_f32_dpp v30, v29, v29 row_shr:4 row_mask:0xf bank_mask:0xa
s_cbranch_vccnz L_A_w15
s_waitcnt vmcnt(5)
L_A_w15:
s_waitcnt vmcnt(7)
buffer_load_dwordx4 v[88:91], v9, s[40:43], s36 offen offset:2048 nt
v_add_f32_dpp v28, v24, v24 row_ror:8 row_mask:0xf bank_mask:0x3
v_dot2_f32_bf16 v26, v120, v20, 0
v_dot2_f32_bf16 v26, v121, v21, v26
v_dot2_f32_bf16 v26, v122, v22, v26
v_dot2_f32_bf16 v26, v123, v23, v26
v_add_f32_dpp v28, v25, v25 row_ror:8 row_mask:0xf bank_mask:0xc
s_cbranch_vccnz L_A_w16
s_waitcnt vmcnt(5)
L_A_w16:
s_waitcnt vmcnt(7)
buffer_load_dwordx4 v[92:95], v9, s[40:43], s36 offen offset:3072 nt
ds_add_u32 v192, v193 offset:256
v_dot2_f32_bf16 v27, v124, v20, 0
v_dot2_f32_bf16 v27, v125, v21, v27
v_dot2_f32_bf16 v27, v126, v22, v27
v_dot2_f32_bf16 v27, v127, v23, v27
s_sub_u32 s38, s38, 1
s_cmp_lg_u32 s38, 0
s_cbranch_scc1 L_A_ka
s_mov_b32 s38, 5
.p2align 6
L_A_kb:
s_cbranch_vccnz L_A_w17
s_waitcnt vmcnt(5)
L_A_w17:
s_waitcnt vmcnt(7)
s_add_u32 s36, s36, 0x18000
buffer_load_dwordx4 v[96:99], v8, s[40:43], s36 offen offset:0 nt
ds_read_b32 v194, v47 offset:8
v_add_f32_dpp v29, v26, v26 row_ror:8 row_mask:0xf bank_mask:0x3
v_dot2_f32_bf16 v24, v64, v16, 0
v_dot2_f32_bf16 v24, v65, v17, v24
v_dot2_f32_bf16 v24, v66, v18, v24
v_dot2_f32_bf16 v24, v67, v19, v24
v_add_f32_dpp v29, v27, v27 row_ror:8 row_mask:0xf bank_mask:0xc
s_cbranch_vccnz L_A_w18
s_waitcnt vmcnt(5)
L_A_w18:
s_waitcnt vmcnt(7)
buffer_load_dwordx4 v[100:103], v8, s[40:43], s36 offen offset:1024 nt
ds_add_u32 v192, v193 offset:256
s_waitcnt lgkmcnt(1)
v_cmp_ne_u32 vcc, 0, v194
v_add_f32_dpp v31, v28, v28 row_shl:4 row_mask:0xf bank_mask:0x5
v_dot2_f32_bf16 v25, v68, v16, 0
v_dot2_f32_bf16 v25, v69, v17, v25
v_dot2_f32_bf16 v25, v70, v18, v25
v_dot2_f32_bf16 v25, v71, v19, v25
v_add_f32_dpp v31, v29, v29 row_shr:4 row_mask:0xf bank_mask:0xa
s_cbranch_vccnz L_A_w19
s_waitcnt vmcnt(5)
L_A_w19:
s_waitcnt vmcnt(7)
buffer_load_dwordx4 v[104:107], v8, s[40:43], s36 offen offset:2048 nt
v_add_f32_dpp v34, v30, v30 quad_perm:[2,3,0,1] row_mask:0xf bank_mask:0xf
v_add_f32_dpp v28, v24, v24 row_ror:8 row_mask:0xf bank_mask:0x3
v_dot2_f32_bf16 v26, v72, v16, 0
v_dot2_f32_bf16 v26, v73, v17, v26
v_dot2_f32_bf16 v26, v74, v18, v26
v_dot2_f32_bf16 v26, v75, v19, v26
v_add_f32_dpp v35, v31, v31 quad_perm:[2,3,0,1] row_mask:0xf bank_mask:0xf
v_cndmask_b32 v33, v34, v35, s[48:49]
v_add_f32_dpp v28, v25, v25 row_ror:8 row_mask:0xf bank_mask:0xc
s_cbranch_vccnz L_A_w20
s_waitcnt vmcnt(5)
L_A_w20:
s_waitcnt vmcnt(7)
buffer_load_dwordx4 v[108:111], v8, s[40:43], s36 offen offset:3072 nt
ds_add_u32 v192, v193 offset:256
v_add_f32_dpp v34, v32, v32 quad_perm:[1,0,3,2] row_mask:0xf bank_mask:0xf
v_mov_b32 v36, v37
v_mov_b32 v37, v38
v_mov_b32 v38, v39
v_mov_b32 v39, v40
v_mov_b32 v40, v41
v_mov_b32 v41, v42
v_mov_b32 v42, v43
v_mov_b32 v43, v44
v_mov_b32 v44, v45
v_mov_b32 v45, v46
v_dot2_f32_bf16 v27, v76, v16, 0
v_dot2_f32_bf16 v27, v77, v17, v27
v_dot2_f32_bf16 v27, v78, v18, v27
v_dot2_f32_bf16 v27, v79, v19, v27
v_add_f32_dpp v35, v33, v33 quad_perm:[1,0,3,2] row_mask:0xf bank_mask:0xf
v_cndmask_b32 v46, v34, v35, s[50:51]
s_cbranch_vccnz L_A_w21
s_waitcnt vmcnt(5)
L_A_w21:
s_waitcnt vmcnt(7)
buffer_load_dwordx4 v[112:115], v9, s[40:43], s36 offen offset:0 nt
v_add_f32_dpp v29, v26, v26 row_ror:8 row_mask:0xf bank_mask:0x3
v_dot2_f32_bf16 v24, v80, v20, 0
v_dot2_f32_bf16 v24, v81, v21, v24
v_dot2_f32_bf16 v24, v82, v22, v24
v_dot2_f32_bf16 v24, v83, v23, v24
v_add_f32_dpp v29, v27, v27 row_ror:8 row_mask:0xf bank_mask:0xc
s_cbranch_vccnz L_A_w22
s_waitcnt vmcnt(5)
L_A_w22:
s_waitcnt vmcnt(7)
buffer_load_dwordx4 v[116:119], v9, s[40:43], s36 offen offset:1024 nt
ds_add_u32 v192, v193 offset:256
v_add_f32_dpp v30, v28, v28 row_shl:4 row_mask:0xf bank_mask:0x5
v_dot2_f32_bf16 v25, v84, v20, 0
v_dot2_f32_bf16 v25, v85, v21, v25
v_dot2_f32_bf16 v25, v86, v22, v25
v_dot2_f32_bf16 v25, v87, v23, v25
v_add_f32_dpp v30, v29, v29 row_shr:4 row_mask:0xf bank_mask:0xa
s_cbranch_vccnz L_A_w23
s_waitcnt vmcnt(5)
L_A_w23:
s_waitcnt vmcnt(7)
buffer_load_dwordx4 v[120:123], v9, s[40:43], s36 offen offset:2048 nt
v_add_f32_dpp v28, v24, v24 row_ror:8 row_mask:0xf bank_mask:0x3
v_dot2_f32_bf16 v26, v88, v20, 0
v_dot2_f32_bf16 v26, v89, v21, v26
v_dot2_f32_bf16 v26, v90, v22, v26
v_dot2_f32_bf16 v26, v91, v23, v26
v_add_f32_dpp v28, v25, v25 row_ror:8 row_mask:0xf bank_mask:0xc
s_cbranch_vccnz L_A_w24
s_waitcnt vmcnt(5)
L_A_w24:
s_waitcnt vmcnt(7)
buffer_load_dwordx4 v[124:127], v9, s[40:43], s36 offen offset:3072 nt
ds_add_u32 v192, v193 offset:256
v_dot2_f32_bf16 v27, v92, v20, 0
v_dot2_f32_bf16 v27, v93, v21, v27
v_dot2_f32_bf16 v27, v94, v22, v27
v_dot2_f32_bf16 v27, v95, v23, v27
s_cbranch_vccnz L_A_w25
s_waitcnt vmcnt(5)
L_A_w25:
s_waitcnt vmcnt(7)
s_add_u32 s36, s36, 0x18000
buffer_load_dwordx4 v[64:67], v8, s[40:43], s36 offen offset:0 nt
ds_read_b32 v194, v47 offset:8
v_add_f32_dpp v29, v26, v26 row_ror:8 row_mask:0xf bank_mask:0x3
v_dot2_f32_bf16 v24, v96, v16, 0
v_dot2_f32_bf16 v24, v97, v17, v24
v_dot2_f32_bf16 v24, v98, v18, v24
v_dot2_f32_bf16 v24, v99, v19, v24
v_add_f32_dpp v29, v27, v27 row_ror:8 row_mask:0xf bank_mask:0xc
s_cbranch_vccnz L_A_w26
s_waitcnt vmcnt(5)
L_A_w26:
s_waitcnt vmcnt(7)
buffer_load_dwordx4 v[68:71], v8, s[40:43], s36 offen offset:1024 nt
ds_add_u32 v192, v193 offset:256
s_waitcnt lgkmcnt(1)
v_cmp_ne_u32 vcc, 0, v194
v_add_f32_dpp v31, v28, v28 row_shl:4 row_mask:0xf bank_mask:0x5
v_dot2_f32_bf16 v25, v100, v16, 0
v_dot2_f32_bf16 v25, v101, v17, v25
v_dot2_f32_bf16 v25, v102, v18, v25
v_dot2_f32_bf16 v25, v103, v19, v25
v_add_f32_dpp v31, v29, v29 row_shr:4 row_mask:0xf bank_mask:0xa
s_cbranch_vccnz L_A_w27
s_waitcnt vmcnt(5)
L_A_w27:
s_waitcnt vmcnt(7)
buffer_load_dwordx4 v[72:75], v8, s[40:43], s36 offen offset:2048 nt
v_add_f32_dpp v34, v30, v30 quad_perm:[2,3,0,1] row_mask:0xf bank_mask:0xf
v_add_f32_dpp v28, v24, v24 row_ror:8 row_mask:0xf bank_mask:0x3
v_dot2_f32_bf16 v26, v104, v16, 0
v_dot2_f32_bf16 v26, v105, v17, v26
v_dot2_f32_bf16 v26, v106, v18, v26
v_dot2_f32_bf16 v26, v107, v19, v26
v_add_f32_dpp v35, v31, v31 quad_perm:[2,3,0,1] row_mask:0xf bank_mask:0xf
v_cndmask_b32 v32, v34, v35, s[48:49]
v_add_f32_dpp v28, v25, v25 row_ror:8 row_mask:0xf bank_mask:0xc
s_cbranch_vccnz L_A_w28
s_waitcnt vmcnt(5)
L_A_w28:
s_waitcnt vmcnt(7)
buffer_load_dwordx4 v[76:79], v8, s[40:43], s36 offen offset:3072 nt
ds_add_u32 v192, v193 offset:256
v_dot2_f32_bf16 v27, v108, v16, 0
v_dot2_f32_bf16 v27, v109, v17, v27
v_dot2_f32_bf16 v27, v110, v18, v27
v_dot2_f32_bf16 v27, v111, v19, v27
s_cbranch_vccnz L_A_w29
s_waitcnt vmcnt(5)
L_A_w29:
s_waitcnt vmcnt(7)
buffer_load_dwordx4 v[80:83], v9, s[40:43], s36 offen offset:0 nt
v_add_f32_dpp v29, v26, v26 row_ror:8 row_mask:0xf bank_mask:0x3
v_dot2_f32_bf16 v24, v112, v20, 0
v_dot2_f32_bf16 v24, v113, v21, v24
v_dot2_f32_bf16 v24, v114, v22, v24
v_dot2_f32_bf16 v24, v115, v23, v24
v_add_f32_dpp v29, v27, v27 row_ror:8 row_mask:0xf bank_mask:0xc
s_cbranch_vccnz L_A_w30
s_waitcnt vmcnt(5)
L_A_w30:
s_waitcnt vmcnt(7)
buffer_load_dwordx4 v[84:87], v9, s[40:43], s36 offen offset:1024 nt
ds_add_u32 v192, v193 offset:256
v_add_f32_dpp v30, v28, v28 row_shl:4 row_mask:0xf bank_mask:0x5
v_dot2_f32_bf16 v25, v116, v20, 0
v_dot2_f32_bf16 v25, v117, v21, v25
v_dot2_f32_bf16 v25, v118, v22, v25
v_dot2_f32_bf16 v25, v119, v23, v25
v_add_f32_dpp v30, v29, v29 row_shr:4 row_mask:0xf bank_mask:0xa
s_cbranch_vccnz L_A_w31
s_waitcnt vmcnt(5)
L_A_w31:
s_waitcnt vmcnt(7)
buffer_load_dwordx4 v[88:91], v9, s[40:43], s36 offen offset:2048 nt
v_add_f32_dpp v28, v24, v24 row_ror:8 row_mask:0xf bank_mask:0x3
v_dot2_f32_bf16 v26, v120, v20, 0
v_dot2_f32_bf16 v26, v121, v21, v26
v_dot2_f32_bf16 v26, v122, v22, v26
v_dot2_f32_bf16 v26, v123, v23, v26
v_add_f32_dpp v28, v25, v25 row_ror:8 row_mask:0xf bank_mask:0xc
s_cbranch_vccnz L_A_w32
s_waitcnt vmcnt(5)
L_A_w32:
s_waitcnt vmcnt(7)
buffer_load_dwordx4 v[92:95], v9, s[40:43], s36 offen offset:3072 nt
ds_add_u32 v192, v193 offset:256
v_dot2_f32_bf16 v27, v124, v20, 0
v_dot2_f32_bf16 v27, v125, v21, v27
v_dot2_f32_bf16 v27, v126, v22, v27
v_dot2_f32_bf16 v27, v127, v23, v27
s_sub_u32 s38, s38, 1
s_cmp_lg_u32 s38, 0
s_cbranch_scc1 L_A_kb
s_cbranch_vccnz L_A_w33
s_waitcnt vmcnt(5)
L_A_w33:
s_waitcnt vmcnt(7)
buffer_load_dwordx4 v[96:99], v8, s[40:43], s37 offen nt
v_add_f32_dpp v29, v26, v26 row_ror:8 row_mask:0xf bank_mask:0x3
v_dot2_f32_bf16 v24, v64, v16, 0
v_dot2_f32_bf16 v24, v65, v17, v24
v_dot2_f32_bf16 v24, v66, v18, v24
v_dot2_f32_bf16 v24, v67, v19, v24
v_add_f32_dpp v29, v27, v27 row_ror:8 row_mask:0xf bank_mask:0xc
s_cbranch_vccnz L_A_w34
s_waitcnt vmcnt(5)
L_A_w34:
s_waitcnt vmcnt(7)
buffer_load_dwordx4 v[100:103], v10, s[40:43], s37 offen nt
ds_add_u32 v192, v193 offset:256
v_add_f32_dpp v31, v28, v28 row_shl:4 row_mask:0xf bank_mask:0x5
v_dot2_f32_bf16 v25, v68, v16, 0
v_dot2_f32_bf16 v25, v69, v17, v25
v_dot2_f32_bf16 v25, v70, v18, v25
v_dot2_f32_bf16 v25, v71, v19, v25
v_add_f32_dpp v31, v29, v29 row_shr:4 row_mask:0xf bank_mask:0xa
s_cbranch_vccnz L_A_w35
s_waitcnt vmcnt(5)
L_A_w35:
s_waitcnt vmcnt(7)
buffer_load_dwordx4 v[104:107], v9, s[40:43], s37 offen nt
v_add_f32_dpp v34, v30, v30 quad_perm:[2,3,0,1] row_mask:0xf bank_mask:0xf
v_add_f32_dpp v28, v24, v24 row_ror:8 row_mask:0xf bank_mask:0x3
v_dot2_f32_bf16 v26, v72, v16, 0
v_dot2_f32_bf16 v26, v73, v17, v26
v_dot2_f32_bf16 v26, v74, v18, v26
v_dot2_f32_bf16 v26, v75, v19, v26
v_add_f32_dpp v35, v31, v31 quad_perm:[2,3,0,1] row_mask:0xf bank_mask:0xf
v_cndmask_b32 v33, v34, v35, s[48:49]
v_add_f32_dpp v28, v25, v25 row_ror:8 row_mask:0xf bank_mask:0xc
s_cbranch_vccnz L_A_w36
s_waitcnt vmcnt(5)
L_A_w36:
s_waitcnt vmcnt(7)
buffer_load_dwordx4 v[108:111], v11, s[40:43], s37 offen nt
ds_add_u32 v192, v193 offset:256
v_add_f32_dpp v34, v32, v32 quad_perm:[1,0,3,2] row_mask:0xf bank_mask:0xf
v_mov_b32 v36, v37
v_mov_b32 v37, v38
v_mov_b32 v38, v39
v_mov_b32 v39, v40
v_mov_b32 v40, v41
v_mov_b32 v41, v42
v_mov_b32 v42, v43
v_mov_b32 v43, v44
v_mov_b32 v44, v45
v_mov_b32 v45, v46
v_dot2_f32_bf16 v27, v76, v16, 0
v_dot2_f32_bf16 v27, v77, v17, v27
v_dot2_f32_bf16 v27, v78, v18, v27
v_dot2_f32_bf16 v27, v79, v19, v27
v_add_f32_dpp v35, v33, v33 quad_perm:[1,0,3,2] row_mask:0xf bank_mask:0xf
v_cndmask_b32 v46, v34, v35, s[50:51]
s_cbranch_vccnz L_A_w37
s_waitcnt vmcnt(5)
L_A_w37:
s_waitcnt vmcnt(7)
s_mov_b32 s36, s35
buffer_load_dwordx4 v[112:115], v8, s[44:47], s36 offen offset:0 nt
v_add_f32_dpp v29, v26, v26 row_ror:8 row_mask:0xf bank_mask:0x3
v_dot2_f32_bf16 v24, v80, v20, 0
v_dot2_f32_bf16 v24, v81, v21, v24
v_dot2_f32_bf16 v24, v82, v22, v24
v_dot2_f32_bf16 v24, v83, v23, v24
v_add_f32_dpp v29, v27, v27 row_ror:8 row_mask:0xf bank_mask:0xc
s_cbranch_vccnz L_A_w38
s_waitcnt vmcnt(5)
L_A_w38:
s_waitcnt vmcnt(7)
buffer_load_dwordx4 v[116:119], v8, s[44:47], s36 offen offset:1024 nt
ds_add_u32 v192, v193 offset:256
v_add_f32_dpp v30, v28, v28 row_shl:4 row_mask:0xf bank_mask:0x5
v_dot2_f32_bf16 v25, v84, v20, 0
v_dot2_f32_bf16 v25, v85, v21, v25
v_dot2_f32_bf16 v25, v86, v22, v25
v_dot2_f32_bf16 v25, v87, v23, v25
v_add_f32_dpp v30, v29, v29 row_shr:4 row_mask:0xf bank_mask:0xa
s_cbranch_vccnz L_A_w39
s_waitcnt vmcnt(5)
L_A_w39:
s_waitcnt vmcnt(7)
buffer_load_dwordx4 v[120:123], v8, s[44:47], s36 offen offset:2048 nt
v_add_f32_dpp v28, v24, v24 row_ror:8 row_mask:0xf bank_mask:0x3
v_dot2_f32_bf16 v26, v88, v20, 0
v_dot2_f32_bf16 v26, v89, v21, v26
v_dot2_f32_bf16 v26, v90, v22, v26
v_dot2_f32_bf16 v26, v91, v23, v26
v_add_f32_dpp v28, v25, v25 row_ror:8 row_mask:0xf bank_mask:0xc
s_cbranch_vccnz L_A_w40
s_waitcnt vmcnt(5)
L_A_w40:
s_waitcnt vmcnt(7)
buffer_load_dwordx4 v[124:127], v8, s[44:47], s36 offen offset:3072 nt
ds_add_u32 v192, v193 offset:256
v_dot2_f32_bf16 v27, v92, v20, 0
v_dot2_f32_bf16 v27, v93, v21, v27
v_dot2_f32_bf16 v27, v94, v22, v27
v_dot2_f32_bf16 v27, v95, v23, v27
s_cbranch_vccnz L_A_w41
s_waitcnt vmcnt(5)
L_A_w41:
s_waitcnt vmcnt(7)
buffer_load_dwordx4 v[64:67], v9, s[44:47], s36 offen offset:0 nt
v_add_f32_dpp v29, v26, v26 row_ror:8 row_mask:0xf bank_mask:0x3
v_dot2_f32_bf16 v24, v96, v16, 0
v_dot2_f32_bf16 v24, v97, v17, v24
v_dot2_f32_bf16 v24, v98, v18, v24
v_dot2_f32_bf16 v24, v99, v19, v24
v_add_f32_dpp v29, v27, v27 row_ror:8 row_mask:0xf bank_mask:0xc
s_cbranch_vccnz L_A_w42
s_waitcnt vmcnt(5)
L_A_w42:
s_waitcnt vmcnt(7)
buffer_load_dwordx4 v[68:71], v9, s[44:47], s36 offen offset:1024 nt
ds_add_u32 v192, v193 offset:256
v_add_f32_dpp v31, v28, v28 row_shl:4 row_mask:0xf bank_mask:0x5
v_dot2_f32_bf16 v25, v100, v16, 0
v_dot2_f32_bf16 v25, v101, v17, v25
v_dot2_f32_bf16 v25, v102, v18, v25
v_dot2_f32_bf16 v25, v103, v19, v25
v_add_f32_dpp v31, v29, v29 row_shr:4 row_mask:0xf bank_mask:0xa
s_cbranch_vccnz L_A_w43
s_waitcnt vmcnt(5)
L_A_w43:
s_waitcnt vmcnt(7)
buffer_load_dwordx4 v[72:75], v9, s[44:47], s36 offen offset:2048 nt
v_add_f32_dpp v34, v30, v30 quad_perm:[2,3,0,1] row_mask:0xf bank_mask:0xf
v_add_f32_dpp v28, v24, v24 row_ror:8 row_mask:0xf bank_mask:0x3
v_dot2_f32_bf16 v26, v104, v20, 0
v_dot2_f32_bf16 v26, v105, v21, v26
v_dot2_f32_bf16 v26, v106, v22, v26
v_dot2_f32_bf16 v26, v107, v23, v26
v_add_f32_dpp v35, v31, v31 quad_perm:[2,3,0,1] row_mask:0xf bank_mask:0xf
v_cndmask_b32 v32, v34, v35, s[48:49]
v_add_f32_dpp v28, v25, v25 row_ror:8 row_mask:0xf bank_mask:0xc
s_cbranch_vccnz L_A_w44
s_waitcnt vmcnt(5)
L_A_w44:
s_waitcnt vmcnt(7)
buffer_load_dwordx4 v[76:79], v9, s[44:47], s36 offen offset:3072 nt
ds_add_u32 v192, v193 offset:256
v_dot2_f32_bf16 v27, v108, v20, 0
v_dot2_f32_bf16 v27, v109, v21, v27
v_dot2_f32_bf16 v27, v110, v22, v27
v_dot2_f32_bf16 v27, v111, v23, v27
v_add_f32_dpp v30, v28, v28 row_shl:4 row_mask:0xf bank_mask:0x5
s_nop 2
v_add_f32_dpp v28, v26, v26 row_ror:8 row_mask:0xf bank_mask:0x3
s_nop 1
v_add_f32_dpp v28, v27, v27 row_ror:8 row_mask:0xf bank_mask:0xc
s_nop 2
s_nop 1
v_add_f32_dpp v31, v28, v28 row_shl:4 row_mask:0xf bank_mask:0x5
s_nop 2
v_add_f32_dpp v34, v30, v30 quad_perm:[2,3,0,1] row_mask:0xf bank_mask:0xf
s_nop 1
v_add_f32_dpp v35, v31, v31 quad_perm:[2,3,0,1] row_mask:0xf bank_mask:0xf
v_cndmask_b32 v33, v34, v35, s[48:49]
s_nop 2
v_add_f32_dpp v34, v32, v32 quad_perm:[1,0,3,2] row_mask:0xf bank_mask:0xf
v_mov_b32 v36, v37
v_mov_b32 v37, v38
v_mov_b32 v38, v39
v_mov_b32 v39, v40
v_mov_b32 v40, v41
v_mov_b32 v41, v42
v_mov_b32 v42, v43
v_mov_b32 v43, v44
v_mov_b32 v44, v45
v_mov_b32 v45, v46
s_nop 1
v_add_f32_dpp v35, v33, v33 quad_perm:[1,0,3,2] row_mask:0xf bank_mask:0xf
v_cndmask_b32 v46, v34, v35, s[50:51]
v_mov_b32 v60, 0xff800000
v_cndmask_b32 v46, v60, v46, s[52:53]
v_max3_f32 v60, v36, v37, v38
v_max3_f32 v60, v60, v39, v40
v_max3_f32 v60, v60, v41, v42
v_max3_f32 v60, v60, v43, v44
v_max3_f32 v60, v60, v45, v46
s_waitcnt vmcnt(5)
s_add_u32 s36, s36, 0x18000
buffer_load_dwordx4 v[80:83], v8, s[44:47], s36 offen offset:0 nt
s_nop 1
v_max_f32_dpp v60, v60, v60 quad_perm:[1,0,3,2] row_mask:0xf bank_mask:0xf
s_nop 1
v_max_f32_dpp v60, v60, v60 row_ror:4 row_mask:0xf bank_mask:0xf
s_nop 1
v_max_f32_dpp v60, v60, v60 row_ror:8 row_mask:0xf bank_mask:0xf
v_mov_b32 v34, v60
s_nop 1
v_permlane16_swap_b32 v60, v34
s_nop 0
v_max_f32 v60, v60, v34
v_mov_b32 v34, v60
s_nop 1
v_permlane32_swap_b32 v60, v34
s_nop 0
v_max_f32 v60, v60, v34
s_mov_b32 s62, 0x3e0293ee
v_mul_f32 v60, s62, v60
s_waitcnt vmcnt(5)
buffer_load_dwordx4 v[84:87], v8, s[44:47], s36 offen offset:1024 nt
ds_add_u32 v192, v193 offset:256
v_fma_f32 v36, v36, s62, -v60
v_fma_f32 v37, v37, s62, -v60
v_fma_f32 v38, v38, s62, -v60
v_fma_f32 v39, v39, s62, -v60
v_fma_f32 v40, v40, s62, -v60
v_fma_f32 v41, v41, s62, -v60
v_fma_f32 v42, v42, s62, -v60
v_fma_f32 v43, v43, s62, -v60
v_fma_f32 v44, v44, s62, -v60
v_fma_f32 v45, v45, s62, -v60
v_fma_f32 v46, v46, s62, -v60
v_exp_f32 v36, v36
v_exp_f32 v37, v37
v_exp_f32 v38, v38
v_exp_f32 v39, v39
v_exp_f32 v40, v40
v_exp_f32 v41, v41
v_exp_f32 v42, v42
v_exp_f32 v43, v43
v_exp_f32 v44, v44
v_exp_f32 v45, v45
v_exp_f32 v46, v46
s_waitcnt vmcnt(5)
buffer_load_dwordx4 v[88:91], v8, s[44:47], s36 offen offset:2048 nt
v_add_f32 v61, v36, v37
v_add_f32 v61, v61, v38
v_add_f32 v61, v61, v39
v_add_f32 v61, v61, v40
v_add_f32 v61, v61, v41
v_add_f32 v61, v61, v42
v_add_f32 v61, v61, v43
v_add_f32 v61, v61, v44
v_add_f32 v61, v61, v45
v_add_f32 v61, v61, v46
v_cvt_pk_bf16_f32 v36, v36, v36
v_cvt_pk_bf16_f32 v37, v37, v37
v_cvt_pk_bf16_f32 v38, v38, v38
v_cvt_pk_bf16_f32 v39, v39, v39
v_cvt_pk_bf16_f32 v40, v40, v40
v_cvt_pk_bf16_f32 v41, v41, v41
v_cvt_pk_bf16_f32 v42, v42, v42
v_cvt_pk_bf16_f32 v43, v43, v43
v_cvt_pk_bf16_f32 v44, v44, v44
v_cvt_pk_bf16_f32 v45, v45, v45
v_cvt_pk_bf16_f32 v46, v46, v46
s_waitcnt vmcnt(5)
buffer_load_dwordx4 v[92:95], v8, s[44:47], s36 offen offset:3072 nt
ds_add_u32 v192, v193 offset:256
s_nop 1
v_add_f32_dpp v61, v61, v61 quad_perm:[1,0,3,2] row_mask:0xf bank_mask:0xf
s_nop 1
v_add_f32_dpp v61, v61, v61 row_ror:4 row_mask:0xf bank_mask:0xf
s_nop 1
v_add_f32_dpp v61, v61, v61 row_ror:8 row_mask:0xf bank_mask:0xf
v_mov_b32 v34, v61
s_nop 1
v_permlane16_swap_b32 v61, v34
s_nop 0
v_add_f32 v61, v61, v34
v_mov_b32 v34, v61
s_nop 1
v_permlane32_swap_b32 v61, v34
s_nop 0
v_add_f32 v61, v61, v34
s_lshl_b32 s62, s34, 2
v_lshl_add_u32 v62, v1, 3, s62
v_mov_b32 v63, 1
s_mov_b64 exec, 5
ds_write_b32 v62, v60 offset:64
ds_write_b32 v62, v61 offset:96
s_mov_b64 exec, 1
ds_add_u32 v47, v63 offset:4
s_mov_b64 exec, -1
v_and_b32_dpp v52, v36, v4 row_newbcast:0 row_mask:0xf bank_mask:0xf
v_and_b32_dpp v53, v36, v5 row_newbcast:0 row_mask:0xf bank_mask:0xf
v_and_b32_dpp v54, v36, v6 row_newbcast:0 row_mask:0xf bank_mask:0xf
v_and_b32_dpp v55, v36, v7 row_newbcast:0 row_mask:0xf bank_mask:0xf
s_mov_b32 s38, 9
.p2align 6
L_A_va:
s_cbranch_vccnz L_A_w45
s_waitcnt vmcnt(5)
L_A_w45:
s_waitcnt vmcnt(7)
buffer_load_dwordx4 v[96:99], v9, s[44:47], s36 offen offset:0 nt
v_mfma_f32_16x16x32_bf16 v[48:51], v[52:55], v[112:115], v[48:51]
ds_read_b32 v194, v47 offset:8
v_and_b32_dpp v56, v36, v4 row_newbcast:8 row_mask:0xf bank_mask:0xf
v_and_b32_dpp v57, v36, v5 row_newbcast:8 row_mask:0xf bank_mask:0xf
v_and_b32_dpp v58, v36, v6 row_newbcast:8 row_mask:0xf bank_mask:0xf
v_and_b32_dpp v59, v36, v7 row_newbcast:8 row_mask:0xf bank_mask:0xf
s_cbranch_vccnz L_A_w46
s_waitcnt vmcnt(5)
L_A_w46:
s_waitcnt vmcnt(7)
buffer_load_dwordx4 v[100:103], v9, s[44:47], s36 offen offset:1024 nt
ds_add_u32 v192, v193 offset:256
v_mfma_f32_16x16x32_bf16 v[48:51], v[56:59], v[116:119], v[48:51]
s_waitcnt lgkmcnt(1)
v_cmp_ne_u32 vcc, 0, v194
v_and_b32_dpp v52, v36, v4 row_newbcast:4 row_mask:0xf bank_mask:0xf
v_and_b32_dpp v53, v36, v5 row_newbcast:4 row_mask:0xf bank_mask:0xf
v_and_b32_dpp v54, v36, v6 row_newbcast:4 row_mask:0xf bank_mask:0xf
v_and_b32_dpp v55, v36, v7 row_newbcast:4 row_mask:0xf bank_mask:0xf
s_cbranch_vccnz L_A_w47
s_waitcnt vmcnt(5)
L_A_w47:
s_waitcnt vmcnt(7)
buffer_load_dwordx4 v[104:107], v9, s[44:47], s36 offen offset:2048 nt
v_mfma_f32_16x16x32_bf16 v[48:51], v[52:55], v[120:123], v[48:51]
v_and_b32_dpp v56, v36, v4 row_newbcast:12 row_mask:0xf bank_mask:0xf
v_and_b32_dpp v57, v36, v5 row_newbcast:12 row_mask:0xf bank_mask:0xf
v_and_b32_dpp v58, v36, v6 row_newbcast:12 row_mask:0xf bank_mask:0xf
v_and_b32_dpp v59, v36, v7 row_newbcast:12 row_mask:0xf bank_mask:0xf
s_cbranch_vccnz L_A_w48
s_waitcnt vmcnt(5)
L_A_w48:
s_waitcnt vmcnt(7)
buffer_load_dwordx4 v[108:111], v9, s[44:47], s36 offen offset:3072 nt
ds_add_u32 v192, v193 offset:256
v_mfma_f32_16x16x32_bf16 v[48:51], v[56:59], v[124:127], v[48:51]
v_and_b32_dpp v52, v36, v12 row_newbcast:2 row_mask:0xf bank_mask:0xf
v_and_b32_dpp v53, v36, v13 row_newbcast:2 row_mask:0xf bank_mask:0xf
v_and_b32_dpp v54, v36, v14 row_newbcast:2 row_mask:0xf bank_mask:0xf
v_and_b32_dpp v55, v36, v15 row_newbcast:2 row_mask:0xf bank_mask:0xf
s_cbranch_vccnz L_A_w49
s_waitcnt vmcnt(5)
L_A_w49:
s_waitcnt vmcnt(7)
s_add_u32 s36, s36, 0x18000
buffer_load_dwordx4 v[112:115], v8, s[44:47], s36 offen offset:0 nt
v_mfma_f32_16x16x32_bf16 v[48:51], v[52:55], v[64:67], v[48:51]
v_and_b32_dpp v56, v36, v12 row_newbcast:10 row_mask:0xf bank_mask:0xf
v_and_b32_dpp v57, v36, v13 row_newbcast:10 row_mask:0xf bank_mask:0xf
v_and_b32_dpp v58, v36, v14 row_newbcast:10 row_mask:0xf bank_mask:0xf
v_and_b32_dpp v59, v36, v15 row_newbcast:10 row_mask:0xf bank_mask:0xf
s_cbranch_vccnz L_A_w50
s_waitcnt vmcnt(5)
L_A_w50:
s_waitcnt vmcnt(7)
buffer_load_dwordx4 v[116:119], v8, s[44:47], s36 offen offset:1024 nt
ds_add_u32 v192, v193 offset:256
v_mfma_f32_16x16x32_bf16 v[48:51], v[56:59], v[68:71], v[48:51]
v_and_b32_dpp v52, v36, v12 row_newbcast:6 row_mask:0xf bank_mask:0xf
v_and_b32_dpp v53, v36, v13 row_newbcast:6 row_mask:0xf bank_mask:0xf
v_and_b32_dpp v54, v36, v14 row_newbcast:6 row_mask:0xf bank_mask:0xf
v_and_b32_dpp v55, v36, v15 row_newbcast:6 row_mask:0xf bank_mask:0xf
s_cbranch_vccnz L_A_w51
s_waitcnt vmcnt(5)
L_A_w51:
s_waitcnt vmcnt(7)
buffer_load_dwordx4 v[120:123], v8, s[44:47], s36 offen offset:2048 nt
v_mfma_f32_16x16x32_bf16 v[48:51], v[52:55], v[72:75], v[48:51]
v_and_b32_dpp v56, v36, v12 row_newbcast:14 row_mask:0xf bank_mask:0xf
v_and_b32_dpp v57, v36, v13 row_newbcast:14 row_mask:0xf bank_mask:0xf
v_and_b32_dpp v58, v36, v14 row_newbcast:14 row_mask:0xf bank_mask:0xf
v_and_b32_dpp v59, v36, v15 row_newbcast:14 row_mask:0xf bank_mask:0xf
s_cbranch_vccnz L_A_w52
s_waitcnt vmcnt(5)
L_A_w52:
s_waitcnt vmcnt(7)
buffer_load_dwordx4 v[124:127], v8, s[44:47], s36 offen offset:3072 nt
ds_add_u32 v192, v193 offset:256
v_mfma_f32_16x16x32_bf16 v[48:51], v[56:59], v[76:79], v[48:51]
v_and_b32_dpp v52, v36, v4 row_newbcast:1 row_mask:0xf bank_mask:0xf
v_and_b32_dpp v53, v36, v5 row_newbcast:1 row_mask:0xf bank_mask:0xf
v_and_b32_dpp v54, v36, v6 row_newbcast:1 row_mask:0xf bank_mask:0xf
v_and_b32_dpp v55, v36, v7 row_newbcast:1 row_mask:0xf bank_mask:0xf
s_cbranch_vccnz L_A_w53
s_waitcnt vmcnt(5)
L_A_w53:
s_waitcnt vmcnt(7)
buffer_load_dwordx4 v[64:67], v9, s[44:47], s36 offen offset:0 nt
v_mfma_f32_16x16x32_bf16 v[48:51], v[52:55], v[80:83], v[48:51]
ds_read_b32 v194, v47 offset:8
v_and_b32_dpp v56, v36, v4 row_newbcast:9 row_mask:0xf bank_mask:0xf
v_and_b32_dpp v57, v36, v5 row_newbcast:9 row_mask:0xf bank_mask:0xf
v_and_b32_dpp v58, v36, v6 row_newbcast:9 row_mask:0xf bank_mask:0xf
v_and_b32_dpp v59, v36, v7 row_newbcast:9 row_mask:0xf bank_mask:0xf
s_cbranch_vccnz L_A_w54
s_waitcnt vmcnt(5)
L_A_w54:
s_waitcnt vmcnt(7)
buffer_load_dwordx4 v[68:71], v9, s[44:47], s36 offen offset:1024 nt
ds_add_u32 v192, v193 offset:256
v_mfma_f32_16x16x32_bf16 v[48:51], v[56:59], v[84:87], v[48:51]
s_waitcnt lgkmcnt(1)
v_cmp_ne_u32 vcc, 0, v194
v_and_b32_dpp v52, v36, v4 row_newbcast:5 row_mask:0xf bank_mask:0xf
v_and_b32_dpp v53, v36, v5 row_newbcast:5 row_mask:0xf bank_mask:0xf
v_and_b32_dpp v54, v36, v6 row_newbcast:5 row_mask:0xf bank_mask:0xf
v_and_b32_dpp v55, v36, v7 row_newbcast:5 row_mask:0xf bank_mask:0xf
s_cbranch_vccnz L_A_w55
s_waitcnt vmcnt(5)
L_A_w55:
s_waitcnt vmcnt(7)
buffer_load_dwordx4 v[72:75], v9, s[44:47], s36 offen offset:2048 nt
v_mfma_f32_16x16x32_bf16 v[48:51], v[52:55], v[88:91], v[48:51]
v_and_b32_dpp v56, v36, v4 row_newbcast:13 row_mask:0xf bank_mask:0xf
v_and_b32_dpp v57, v36, v5 row_newbcast:13 row_mask:0xf bank_mask:0xf
v_and_b32_dpp v58, v36, v6 row_newbcast:13 row_mask:0xf bank_mask:0xf
v_and_b32_dpp v59, v36, v7 row_newbcast:13 row_mask:0xf bank_mask:0xf
s_cbranch_vccnz L_A_w56
s_waitcnt vmcnt(5)
L_A_w56:
s_waitcnt vmcnt(7)
buffer_load_dwordx4 v[76:79], v9, s[44:47], s36 offen offset:3072 nt
ds_add_u32 v192, v193 offset:256
v_mfma_f32_16x16x32_bf16 v[48:51], v[56:59], v[92:95], v[48:51]
v_and_b32_dpp v52, v36, v12 row_newbcast:3 row_mask:0xf bank_mask:0xf
v_and_b32_dpp v53, v36, v13 row_newbcast:3 row_mask:0xf bank_mask:0xf
v_and_b32_dpp v54, v36, v14 row_newbcast:3 row_mask:0xf bank_mask:0xf
v_and_b32_dpp v55, v36, v15 row_newbcast:3 row_mask:0xf bank_mask:0xf
s_cbranch_vccnz L_A_w57
s_waitcnt vmcnt(5)
L_A_w57:
s_waitcnt vmcnt(7)
s_add_u32 s36, s36, 0x18000
buffer_load_dwordx4 v[80:83], v8, s[44:47], s36 offen offset:0 nt
v_mfma_f32_16x16x32_bf16 v[48:51], v[52:55], v[96:99], v[48:51]
v_and_b32_dpp v56, v36, v12 row_newbcast:11 row_mask:0xf bank_mask:0xf
v_and_b32_dpp v57, v36, v13 row_newbcast:11 row_mask:0xf bank_mask:0xf
v_and_b32_dpp v58, v36, v14 row_newbcast:11 row_mask:0xf bank_mask:0xf
v_and_b32_dpp v59, v36, v15 row_newbcast:11 row_mask:0xf bank_mask:0xf
s_cbranch_vccnz L_A_w58
s_waitcnt vmcnt(5)
L_A_w58:
s_waitcnt vmcnt(7)
buffer_load_dwordx4 v[84:87], v8, s[44:47], s36 offen offset:1024 nt
ds_add_u32 v192, v193 offset:256
v_mfma_f32_16x16x32_bf16 v[48:51], v[56:59], v[100:103], v[48:51]
v_and_b32_dpp v52, v36, v12 row_newbcast:7 row_mask:0xf bank_mask:0xf
v_and_b32_dpp v53, v36, v13 row_newbcast:7 row_mask:0xf bank_mask:0xf
v_and_b32_dpp v54, v36, v14 row_newbcast:7 row_mask:0xf bank_mask:0xf
v_and_b32_dpp v55, v36, v15 row_newbcast:7 row_mask:0xf bank_mask:0xf
s_cbranch_vccnz L_A_w59
s_waitcnt vmcnt(5)
L_A_w59:
s_waitcnt vmcnt(7)
buffer_load_dwordx4 v[88:91], v8, s[44:47], s36 offen offset:2048 nt
v_mfma_f32_16x16x32_bf16 v[48:51], v[52:55], v[104:107], v[48:51]
v_and_b32_dpp v56, v36, v12 row_newbcast:15 row_mask:0xf bank_mask:0xf
v_and_b32_dpp v57, v36, v13 row_newbcast:15 row_mask:0xf bank_mask:0xf
v_and_b32_dpp v58, v36, v14 row_newbcast:15 row_mask:0xf bank_mask:0xf
v_and_b32_dpp v59, v36, v15 row_newbcast:15 row_mask:0xf bank_mask:0xf
s_cbranch_vccnz L_A_w60
s_waitcnt vmcnt(5)
L_A_w60:
s_waitcnt vmcnt(7)
buffer_load_dwordx4 v[92:95], v8, s[44:47], s36 offen offset:3072 nt
ds_add_u32 v192, v193 offset:256
v_mfma_f32_16x16x32_bf16 v[48:51], v[56:59], v[108:111], v[48:51]
v_mov_b32 v36, v37
v_mov_b32 v37, v38
v_mov_b32 v38, v39
v_mov_b32 v39, v40
v_mov_b32 v40, v41
v_mov_b32 v41, v42
v_mov_b32 v42, v43
v_mov_b32 v43, v44
v_mov_b32 v44, v45
v_mov_b32 v45, v46
v_and_b32_dpp v52, v36, v4 row_newbcast:0 row_mask:0xf bank_mask:0xf
v_and_b32_dpp v53, v36, v5 row_newbcast:0 row_mask:0xf bank_mask:0xf
v_and_b32_dpp v54, v36, v6 row_newbcast:0 row_mask:0xf bank_mask:0xf
v_and_b32_dpp v55, v36, v7 row_newbcast:0 row_mask:0xf bank_mask:0xf
s_sub_u32 s38, s38, 1
s_cmp_lg_u32 s38, 0
s_cbranch_scc1 L_A_va
s_waitcnt vmcnt(8)
buffer_load_dwordx4 v[96:99], v9, s[44:47], s36 offen offset:0 nt
v_mfma_f32_16x16x32_bf16 v[48:51], v[52:55], v[112:115], v[48:51]
v_and_b32_dpp v56, v36, v4 row_newbcast:8 row_mask:0xf bank_mask:0xf
v_and_b32_dpp v57, v36, v5 row_newbcast:8 row_mask:0xf bank_mask:0xf
v_and_b32_dpp v58, v36, v6 row_newbcast:8 row_mask:0xf bank_mask:0xf
v_and_b32_dpp v59, v36, v7 row_newbcast:8 row_mask:0xf bank_mask:0xf
s_mov_b32 s64, 0
L_A_sw:
ds_read_b32 v60, v47 offset:4
s_waitcnt lgkmcnt(0)
v_readfirstlane_b32 s65, v60
s_add_u32 s64, s64, 1
s_nop 2
s_cmp_ge_u32 s65, 4
s_cbranch_scc1 L_A_sw_ok
s_sleep 1
s_cmp_lt_u32 s64, 1048576
s_cbranch_scc1 L_A_sw
L_A_sw_ok:
v_lshrrev_b32 v60, 1, v3
v_lshlrev_b32 v60, 4, v60
s_lshl_b32 s62, s34, 2
v_add_u32 v61, s62, v60
ds_read_b128 v[24:27], v60 offset:64
ds_read_b32 v63, v61 offset:64
s_waitcnt vmcnt(8)
buffer_load_dwordx4 v[100:103], v9, s[44:47], s36 offen offset:1024 nt
ds_add_u32 v192, v193 offset:256
v_mfma_f32_16x16x32_bf16 v[48:51], v[56:59], v[116:119], v[48:51]
v_and_b32_dpp v52, v36, v4 row_newbcast:4 row_mask:0xf bank_mask:0xf
v_and_b32_dpp v53, v36, v5 row_newbcast:4 row_mask:0xf bank_mask:0xf
v_and_b32_dpp v54, v36, v6 row_newbcast:4 row_mask:0xf bank_mask:0xf
v_and_b32_dpp v55, v36, v7 row_newbcast:4 row_mask:0xf bank_mask:0xf
s_waitcnt vmcnt(8)
buffer_load_dwordx4 v[104:107], v9, s[44:47], s36 offen offset:2048 nt
v_mfma_f32_16x16x32_bf16 v[48:51], v[52:55], v[120:123], v[48:51]
v_and_b32_dpp v56, v36, v4 row_newbcast:12 row_mask:0xf bank_mask:0xf
v_and_b32_dpp v57, v36, v5 row_newbcast:12 row_mask:0xf bank_mask:0xf
v_and_b32_dpp v58, v36, v6 row_newbcast:12 row_mask:0xf bank_mask:0xf
v_and_b32_dpp v59, v36, v7 row_newbcast:12 row_mask:0xf bank_mask:0xf
s_waitcnt lgkmcnt(0)
v_max3_f32 v60, v24, v25, v26
v_max_f32 v60, v60, v27
v_sub_f32 v63, v63, v60
v_exp_f32 v63, v63
v_lshrrev_b32 v62, 1, v3
v_mul_u32_u24 v62, 1088, v62
v_lshl_add_u32 v62, v2, 4, v62
v_and_b32 v61, 1, v3
v_lshl_add_u32 v62, v61, 3, v62
s_mul_i32 s62, s34, 272
v_add_u32 v62, s62, v62
s_waitcnt vmcnt(8)
buffer_load_dwordx4 v[108:111], v9, s[44:47], s36 offen offset:3072 nt
ds_add_u32 v192, v193 offset:256
v_mfma_f32_16x16x32_bf16 v[48:51], v[56:59], v[124:127], v[48:51]
v_and_b32_dpp v52, v36, v12 row_newbcast:2 row_mask:0xf bank_mask:0xf
v_and_b32_dpp v53, v36, v13 row_newbcast:2 row_mask:0xf bank_mask:0xf
v_and_b32_dpp v54, v36, v14 row_newbcast:2 row_mask:0xf bank_mask:0xf
v_and_b32_dpp v55, v36, v15 row_newbcast:2 row_mask:0xf bank_mask:0xf
s_waitcnt vmcnt(8)
s_add_u32 s36, s36, 0x18000
buffer_load_dwordx4 v[112:115], v8, s[44:47], s36 offen offset:0 nt
v_mfma_f32_16x16x32_bf16 v[48:51], v[52:55], v[64:67], v[48:51]
v_and_b32_dpp v56, v36, v12 row_newbcast:10 row_mask:0xf bank_mask:0xf
v_and_b32_dpp v57, v36, v13 row_newbcast:10 row_mask:0xf bank_mask:0xf
v_and_b32_dpp v58, v36, v14 row_newbcast:10 row_mask:0xf bank_mask:0xf
v_and_b32_dpp v59, v36, v15 row_newbcast:10 row_mask:0xf bank_mask:0xf
s_waitcnt vmcnt(8)
buffer_load_dwordx4 v[116:119], v8, s[44:47], s36 offen offset:1024 nt
ds_add_u32 v192, v193 offset:256
v_mfma_f32_16x16x32_bf16 v[48:51], v[56:59], v[68:71], v[48:51]
v_and_b32_dpp v52, v36, v12 row_newbcast:6 row_mask:0xf bank_mask:0xf
v_and_b32_dpp v53, v36, v13 row_newbcast:6 row_mask:0xf bank_mask:0xf
v_and_b32_dpp v54, v36, v14 row_newbcast:6 row_mask:0xf bank_mask:0xf
v_and_b32_dpp v55, v36, v15 row_newbcast:6 row_mask:0xf bank_mask:0xf
s_waitcnt vmcnt(8)
buffer_load_dwordx4 v[120:123], v8, s[44:47], s36 offen offset:2048 nt
v_mfma_f32_16x16x32_bf16 v[48:51], v[52:55], v[72:75], v[48:51]
v_and_b32_dpp v56, v36, v12 row_newbcast:14 row_mask:0xf bank_mask:0xf
v_and_b32_dpp v57, v36, v13 row_newbcast:14 row_mask:0xf bank_mask:0xf
v_and_b32_dpp v58, v36, v14 row_newbcast:14 row_mask:0xf bank_mask:0xf
v_and_b32_dpp v59, v36, v15 row_newbcast:14 row_mask:0xf bank_mask:0xf
s_waitcnt vmcnt(8)
buffer_load_dwordx4 v[124:127], v8, s[44:47], s36 offen offset:3072 nt
ds_add_u32 v192, v193 offset:256
v_mfma_f32_16x16x32_bf16 v[48:51], v[56:59], v[76:79], v[48:51]
v_and_b32_dpp v52, v36, v4 row_newbcast:1 row_mask:0xf bank_mask:0xf
v_and_b32_dpp v53, v36, v5 row_newbcast:1 row_mask:0xf bank_mask:0xf
v_and_b32_dpp v54, v36, v6 row_newbcast:1 row_mask:0xf bank_mask:0xf
v_and_b32_dpp v55, v36, v7 row_newbcast:1 row_mask:0xf bank_mask:0xf
s_waitcnt vmcnt(8)
buffer_load_dwordx4 v[64:67], v9, s[44:47], s36 offen offset:0 nt
v_mfma_f32_16x16x32_bf16 v[48:51], v[52:55], v[80:83], v[48:51]
v_and_b32_dpp v56, v36, v4 row_newbcast:9 row_mask:0xf bank_mask:0xf
v_and_b32_dpp v57, v36, v5 row_newbcast:9 row_mask:0xf bank_mask:0xf
v_and_b32_dpp v58, v36, v6 row_newbcast:9 row_mask:0xf bank_mask:0xf
v_and_b32_dpp v59, v36, v7 row_newbcast:9 row_mask:0xf bank_mask:0xf
s_waitcnt vmcnt(8)
buffer_load_dwordx4 v[68:71], v9, s[44:47], s36 offen offset:1024 nt
ds_add_u32 v192, v193 offset:256
v_mfma_f32_16x16x32_bf16 v[48:51], v[56:59], v[84:87], v[48:51]
v_and_b32_dpp v52, v36, v4 row_newbcast:5 row_mask:0xf bank_mask:0xf
v_and_b32_dpp v53, v36, v5 row_newbcast:5 row_mask:0xf bank_mask:0xf
v_and_b32_dpp v54, v36, v6 row_newbcast:5 row_mask:0xf bank_mask:0xf
v_and_b32_dpp v55, v36, v7 row_newbcast:5 row_mask:0xf bank_mask:0xf
s_waitcnt vmcnt(8)
buffer_load_dwordx4 v[72:75], v9, s[44:47], s36 offen offset:2048 nt
v_mfma_f32_16x16x32_bf16 v[48:51], v[52:55], v[88:91], v[48:51]
v_and_b32_dpp v56, v36, v4 row_newbcast:13 row_mask:0xf bank_mask:0xf
v_and_b32_dpp v57, v36, v5 row_newbcast:13 row_mask:0xf bank_mask:0xf
v_and_b32_dpp v58, v36, v6 row_newbcast:13 row_mask:0xf bank_mask:0xf
v_and_b32_dpp v59, v36, v7 row_newbcast:13 row_mask:0xf bank_mask:0xf
s_waitcnt vmcnt(8)
buffer_load_dwordx4 v[76:79], v9, s[44:47], s36 offen offset:3072 nt
ds_add_u32 v192, v193 offset:256
v_mfma_f32_16x16x32_bf16 v[48:51], v[56:59], v[92:95], v[48:51]
v_and_b32_dpp v52, v36, v12 row_newbcast:3 row_mask:0xf bank_mask:0xf
v_and_b32_dpp v53, v36, v13 row_newbcast:3 row_mask:0xf bank_mask:0xf
v_and_b32_dpp v54, v36, v14 row_newbcast:3 row_mask:0xf bank_mask:0xf
v_and_b32_dpp v55, v36, v15 row_newbcast:3 row_mask:0xf bank_mask:0xf
s_waitcnt vmcnt(8)
buffer_load_dwordx4 v[80:83], v8, s[44:47], s37 offen nt
v_mfma_f32_16x16x32_bf16 v[48:51], v[52:55], v[96:99], v[48:51]
v_and_b32_dpp v56, v36, v12 row_newbcast:11 row_mask:0xf bank_mask:0xf
v_and_b32_dpp v57, v36, v13 row_newbcast:11 row_mask:0xf bank_mask:0xf
v_and_b32_dpp v58, v36, v14 row_newbcast:11 row_mask:0xf bank_mask:0xf
v_and_b32_dpp v59, v36, v15 row_newbcast:11 row_mask:0xf bank_mask:0xf
s_waitcnt vmcnt(8)
buffer_load_dwordx4 v[84:87], v10, s[44:47], s37 offen nt
ds_add_u32 v192, v193 offset:256
v_mfma_f32_16x16x32_bf16 v[48:51], v[56:59], v[100:103], v[48:51]
v_and_b32_dpp v52, v36, v12 row_newbcast:7 row_mask:0xf bank_mask:0xf
v_and_b32_dpp v53, v36, v13 row_newbcast:7 row_mask:0xf bank_mask:0xf
v_and_b32_dpp v54, v36, v14 row_newbcast:7 row_mask:0xf bank_mask:0xf
v_and_b32_dpp v55, v36, v15 row_newbcast:7 row_mask:0xf bank_mask:0xf
s_waitcnt vmcnt(8)
buffer_load_dwordx4 v[88:91], v9, s[44:47], s37 offen nt
v_mfma_f32_16x16x32_bf16 v[48:51], v[52:55], v[104:107], v[48:51]
v_and_b32_dpp v56, v36, v12 row_newbcast:15 row_mask:0xf bank_mask:0xf
v_and_b32_dpp v57, v36, v13 row_newbcast:15 row_mask:0xf bank_mask:0xf
v_and_b32_dpp v58, v36, v14 row_newbcast:15 row_mask:0xf bank_mask:0xf
v_and_b32_dpp v59, v36, v15 row_newbcast:15 row_mask:0xf bank_mask:0xf
s_waitcnt vmcnt(8)
buffer_load_dwordx4 v[92:95], v11, s[44:47], s37 offen nt
ds_add_u32 v192, v193 offset:256
v_mfma_f32_16x16x32_bf16 v[48:51], v[56:59], v[108:111], v[48:51]
v_mov_b32 v36, v37
v_mov_b32 v37, v38
v_mov_b32 v38, v39
v_mov_b32 v39, v40
v_mov_b32 v40, v41
v_mov_b32 v41, v42
v_mov_b32 v42, v43
v_mov_b32 v43, v44
v_mov_b32 v44, v45
v_mov_b32 v45, v46
v_and_b32_dpp v52, v36, v4 row_newbcast:0 row_mask:0xf bank_mask:0xf
v_and_b32_dpp v53, v36, v5 row_newbcast:0 row_mask:0xf bank_mask:0xf
v_and_b32_dpp v54, v36, v6 row_newbcast:0 row_mask:0xf bank_mask:0xf
v_and_b32_dpp v55, v36, v7 row_newbcast:0 row_mask:0xf bank_mask:0xf
s_nop 0
s_nop 0
v_mfma_f32_16x16x32_bf16 v[48:51], v[52:55], v[112:115], v[48:51]
v_and_b32_dpp v56, v36, v4 row_newbcast:8 row_mask:0xf bank_mask:0xf
v_and_b32_dpp v57, v36, v5 row_newbcast:8 row_mask:0xf bank_mask:0xf
v_and_b32_dpp v58, v36, v6 row_newbcast:8 row_mask:0xf bank_mask:0xf
v_and_b32_dpp v59, v36, v7 row_newbcast:8 row_mask:0xf bank_mask:0xf
s_nop 0
s_nop 0
v_mfma_f32_16x16x32_bf16 v[48:51], v[56:59], v[116:119], v[48:51]
v_and_b32_dpp v52, v36, v4 row_newbcast:4 row_mask:0xf bank_mask:0xf
v_and_b32_dpp v53, v36, v5 row_newbcast:4 row_mask:0xf bank_mask:0xf
v_and_b32_dpp v54, v36, v6 row_newbcast:4 row_mask:0xf bank_mask:0xf
v_and_b32_dpp v55, v36, v7 row_newbcast:4 row_mask:0xf bank_mask:0xf
s_nop 0
s_nop 0
v_mfma_f32_16x16x32_bf16 v[48:51], v[52:55], v[120:123], v[48:51]
v_and_b32_dpp v56, v36, v4 row_newbcast:12 row_mask:0xf bank_mask:0xf
v_and_b32_dpp v57, v36, v5 row_newbcast:12 row_mask:0xf bank_mask:0xf
v_and_b32_dpp v58, v36, v6 row_newbcast:12 row_mask:0xf bank_mask:0xf
v_and_b32_dpp v59, v36, v7 row_newbcast:12 row_mask:0xf bank_mask:0xf
s_waitcnt vmcnt(8)
s_nop 0
v_mfma_f32_16x16x32_bf16 v[48:51], v[56:59], v[124:127], v[48:51]
v_and_b32_dpp v52, v36, v12 row_newbcast:2 row_mask:0xf bank_mask:0xf
v_and_b32_dpp v53, v36, v13 row_newbcast:2 row_mask:0xf bank_mask:0xf
v_and_b32_dpp v54, v36, v14 row_newbcast:2 row_mask:0xf bank_mask:0xf
v_and_b32_dpp v55, v36, v15 row_newbcast:2 row_mask:0xf bank_mask:0xf
s_waitcnt vmcnt(7)
s_nop 0
v_mfma_f32_16x16x32_bf16 v[48:51], v[52:55], v[64:67], v[48:51]
v_and_b32_dpp v56, v36, v12 row_newbcast:10 row_mask:0xf bank_mask:0xf
v_and_b32_dpp v57, v36, v13 row_newbcast:10 row_mask:0xf bank_mask:0xf
v_and_b32_dpp v58, v36, v14 row_newbcast:10 row_mask:0xf bank_mask:0xf
v_and_b32_dpp v59, v36, v15 row_newbcast:10 row_mask:0xf bank_mask:0xf
s_waitcnt vmcnt(6)
s_nop 0
v_mfma_f32_16x16x32_bf16 v[48:51], v[56:59], v[68:71], v[48:51]
v_and_b32_dpp v52, v36, v12 row_newbcast:6 row_mask:0xf bank_mask:0xf
v_and_b32_dpp v53, v36, v13 row_newbcast:6 row_mask:0xf bank_mask:0xf
v_and_b32_dpp v54, v36, v14 row_newbcast:6 row_mask:0xf bank_mask:0xf
v_and_b32_dpp v55, v36, v15 row_newbcast:6 row_mask:0xf bank_mask:0xf
s_waitcnt vmcnt(5)
s_nop 0
v_mfma_f32_16x16x32_bf16 v[48:51], v[52:55], v[72:75], v[48:51]
v_and_b32_dpp v56, v36, v12 row_newbcast:14 row_mask:0xf bank_mask:0xf
v_and_b32_dpp v57, v36, v13 row_newbcast:14 row_mask:0xf bank_mask:0xf
v_and_b32_dpp v58, v36, v14 row_newbcast:14 row_mask:0xf bank_mask:0xf
v_and_b32_dpp v59, v36, v15 row_newbcast:14 row_mask:0xf bank_mask:0xf
s_waitcnt vmcnt(4)
s_nop 0
v_mfma_f32_16x16x32_bf16 v[48:51], v[56:59], v[76:79], v[48:51]
v_and_b32_dpp v52, v36, v4 row_newbcast:1 row_mask:0xf bank_mask:0xf
v_and_b32_dpp v53, v36, v5 row_newbcast:1 row_mask:0xf bank_mask:0xf
v_and_b32_dpp v54, v36, v6 row_newbcast:1 row_mask:0xf bank_mask:0xf
v_and_b32_dpp v55, v36, v7 row_newbcast:1 row_mask:0xf bank_mask:0xf
s_waitcnt vmcnt(3)
s_nop 0
v_mfma_f32_16x16x32_bf16 v[48:51], v[52:55], v[80:83], v[48:51]
v_and_b32_dpp v56, v36, v4 row_newbcast:9 row_mask:0xf bank_mask:0xf
v_and_b32_dpp v57, v36, v5 row_newbcast:9 row_mask:0xf bank_mask:0xf
v_and_b32_dpp v58, v36, v6 row_newbcast:9 row_mask:0xf bank_mask:0xf
v_and_b32_dpp v59, v36, v7 row_newbcast:9 row_mask:0xf bank_mask:0xf
s_waitcnt vmcnt(2)
s_nop 0
v_mfma_f32_16x16x32_bf16 v[48:51], v[56:59], v[84:87], v[48:51]
v_and_b32_dpp v52, v36, v12 row_newbcast:3 row_mask:0xf bank_mask:0xf
v_and_b32_dpp v53, v36, v13 row_newbcast:3 row_mask:0xf bank_mask:0xf
v_and_b32_dpp v54, v36, v14 row_newbcast:3 row_mask:0xf bank_mask:0xf
v_and_b32_dpp v55, v36, v15 row_newbcast:3 row_mask:0xf bank_mask:0xf
s_waitcnt vmcnt(1)
s_nop 0
v_mfma_f32_16x16x32_bf16 v[48:51], v[52:55], v[88:91], v[48:51]
v_and_b32_dpp v56, v36, v12 row_newbcast:11 row_mask:0xf bank_mask:0xf
v_and_b32_dpp v57, v36, v13 row_newbcast:11 row_mask:0xf bank_mask:0xf
v_and_b32_dpp v58, v36, v14 row_newbcast:11 row_mask:0xf bank_mask:0xf
v_and_b32_dpp v59, v36, v15 row_newbcast:11 row_mask:0xf bank_mask:0xf
s_waitcnt vmcnt(0)
s_nop 0
v_mfma_f32_16x16x32_bf16 v[48:51], v[56:59], v[92:95], v[48:51]
s_nop 7
v_mul_f32 v48, v48, v63
v_mul_f32 v49, v49, v63
v_mul_f32 v50, v50, v63
v_mul_f32 v51, v51, v63
v_cvt_pk_bf16_f32 v48, v48, v49
v_cvt_pk_bf16_f32 v49, v50, v51
ds_write_b64 v62, v[48:49] offset:8192
s_waitcnt lgkmcnt(0)
s_barrier
s_endpgm
L_A_helper:
s_sub_u32 s35, s34, 4
s_lshl_b32 s37, s32, 3
s_add_u32 s37, s37, s33
s_cmp_lg_u32 s35, 0
s_cbranch_scc1 L_A_noclr
s_lshl_b32 s63, s37, 10
s_add_u32 s63, s63, 0x100000
v_lshl_add_u32 v10, v1, 4, s63
v_add_u32 v11, 0x40000, v10
v_mov_b32 v44, -1
v_mov_b32 v45, -1
v_mov_b32 v46, -1
v_mov_b32 v47, -1
global_store_dwordx4 v10, v[44:47], s[30:31] sc1
global_store_dwordx4 v11, v[44:47], s[30:31] sc1
L_A_noclr:
s_lshl_b32 s62, s32, 17
s_mov_b32 s63, 0x20000
s_add_u32 s40, s12, s62
s_addc_u32 s41, s13, 0
s_and_b32 s41, s41, 0xffff
s_mov_b32 s42, s63
s_mov_b32 s43, 0x20000
v_lshlrev_b32 v9, 13, v3
v_lshl_add_u32 v9, v2, 4, v9
s_lshl_b32 s62, s35, 8
v_add_u32 v9, s62, v9
s_mov_b32 s61, 0
buffer_load_dwordx4 v[184:187], v9, s[40:43], s61 offen offset:0
buffer_load_dwordx4 v[188:191], v9, s[40:43], s61 offen offset:1024
buffer_load_dwordx4 v[192:195], v9, s[40:43], s61 offen offset:2048
buffer_load_dwordx4 v[196:199], v9, s[40:43], s61 offen offset:3072
v_mov_b32 v8, 0
v_mov_b32 v11, 0
ds_write_b32 v8, v8 offset:0
ds_write_b32 v8, v8 offset:4
ds_write_b32 v8, v8 offset:8
ds_write_b32 v8, v8 offset:256
s_waitcnt lgkmcnt(0)
s_barrier
s_load_dword s88, s[30:31], 0x18000
s_mov_b32 s66, 0x05040100
s_mov_b32 s67, 0x07060302
s_mov_b32 s44, s30
s_and_b32 s45, s31, 0xffff
s_mov_b32 s46, 0x1000000
s_mov_b32 s47, 0x20000
s_lshl_b32 s63, s32, 10
s_add_u32 s63, s63, 0x40000
v_lshl_add_u32 v10, v1, 4, s63
v_lshlrev_b32 v11, 3, v1
s_mov_b32 s38, s35
s_waitcnt lgkmcnt(0)
s_add_u32 s88, s88, 0x9e3779b9
s_waitcnt vmcnt(3)
s_mov_b32 s61, 4096
buffer_load_dwordx4 v[200:203], v9, s[40:43], s61 offen offset:0
s_waitcnt vmcnt(3)
buffer_load_dwordx4 v[204:207], v9, s[40:43], s61 offen offset:1024
v_perm_b32 v56, v188, v184, s66
v_perm_b32 v60, v188, v184, s67
v_perm_b32 v64, v189, v185, s66
v_perm_b32 v68, v189, v185, s67
v_perm_b32 v72, v190, v186, s66
v_perm_b32 v76, v190, v186, s67
v_perm_b32 v80, v191, v187, s66
v_perm_b32 v84, v191, v187, s67
s_waitcnt vmcnt(3)
buffer_load_dwordx4 v[208:211], v9, s[40:43], s61 offen offset:2048
s_waitcnt vmcnt(3)
buffer_load_dwordx4 v[212:215], v9, s[40:43], s61 offen offset:3072
v_perm_b32 v57, v196, v192, s66
v_perm_b32 v61, v196, v192, s67
v_perm_b32 v65, v197, v193, s66
v_perm_b32 v69, v197, v193, s67
v_perm_b32 v73, v198, v194, s66
v_perm_b32 v77, v198, v194, s67
v_perm_b32 v81, v199, v195, s66
v_perm_b32 v85, v199, v195, s67
s_waitcnt vmcnt(3)
s_mov_b32 s61, 32768
buffer_load_dwordx4 v[216:219], v9, s[40:43], s61 offen offset:0
s_waitcnt vmcnt(3)
buffer_load_dwordx4 v[220:223], v9, s[40:43], s61 offen offset:1024
v_perm_b32 v58, v204, v200, s66
v_perm_b32 v62, v204, v200, s67
v_perm_b32 v66, v205, v201, s66
v_perm_b32 v70, v205, v201, s67
v_perm_b32 v74, v206, v202, s66
v_perm_b32 v78, v206, v202, s67
v_perm_b32 v82, v207, v203, s66
v_perm_b32 v86, v207, v203, s67
s_waitcnt vmcnt(3)
buffer_load_dwordx4 v[224:227], v9, s[40:43], s61 offen offset:2048
s_waitcnt vmcnt(3)
buffer_load_dwordx4 v[228:231], v9, s[40:43], s61 offen offset:3072
v_perm_b32 v59, v212, v208, s66
v_perm_b32 v63, v212, v208, s67
v_perm_b32 v67, v213, v209, s66
v_perm_b32 v71, v213, v209, s67
v_perm_b32 v75, v214, v210, s66
v_perm_b32 v79, v214, v210, s67
v_perm_b32 v83, v215, v211, s66
v_perm_b32 v87, v215, v211, s67
s_waitcnt vmcnt(3)
s_mov_b32 s61, 36864
buffer_load_dwordx4 v[232:235], v9, s[40:43], s61 offen offset:0
s_waitcnt vmcnt(3)
buffer_load_dwordx4 v[236:239], v9, s[40:43], s61 offen offset:1024
v_perm_b32 v88, v220, v216, s66
v_perm_b32 v92, v220, v216, s67
v_perm_b32 v96, v221, v217, s66
v_perm_b32 v100, v221, v217, s67
v_perm_b32 v104, v222, v218, s66
v_perm_b32 v108, v222, v218, s67
v_perm_b32 v112, v223, v219, s66
v_perm_b32 v116, v223, v219, s67
s_waitcnt vmcnt(3)
buffer_load_dwordx4 v[240:243], v9, s[40:43], s61 offen offset:2048
s_waitcnt vmcnt(3)
buffer_load_dwordx4 v[244:247], v9, s[40:43], s61 offen offset:3072
v_perm_b32 v89, v228, v224, s66
v_perm_b32 v93, v228, v224, s67
v_perm_b32 v97, v229, v225, s66
v_perm_b32 v101, v229, v225, s67
v_perm_b32 v105, v230, v226, s66
v_perm_b32 v109, v230, v226, s67
v_perm_b32 v113, v231, v227, s66
v_perm_b32 v117, v231, v227, s67
s_waitcnt vmcnt(3)
s_mov_b32 s61, 65536
buffer_load_dwordx4 v[184:187], v9, s[40:43], s61 offen offset:0
s_waitcnt vmcnt(3)
buffer_load_dwordx4 v[188:191], v9, s[40:43], s61 offen offset:1024
v_perm_b32 v90, v236, v232, s66
v_perm_b32 v94, v236, v232, s67
v_perm_b32 v98, v237, v233, s66
v_perm_b32 v102, v237, v233, s67
v_perm_b32 v106, v238, v234, s66
v_perm_b32 v110, v238, v234, s67
v_perm_b32 v114, v239, v235, s66
v_perm_b32 v118, v239, v235, s67
s_waitcnt vmcnt(3)
buffer_load_dwordx4 v[192:195], v9, s[40:43], s61 offen offset:2048
s_waitcnt vmcnt(3)
buffer_load_dwordx4 v[196:199], v9, s[40:43], s61 offen offset:3072
v_perm_b32 v91, v244, v240, s66
v_perm_b32 v95, v244, v240, s67
v_perm_b32 v99, v245, v241, s66
v_perm_b32 v103, v245, v241, s67
v_perm_b32 v107, v246, v242, s66
v_perm_b32 v111, v246, v242, s67
v_perm_b32 v115, v247, v243, s66
v_perm_b32 v119, v247, v243, s67
s_waitcnt vmcnt(3)
s_cmp_lg_u32 s38, 0
s_cbranch_scc1 L_A_qt16
buffer_load_dwordx4 v[44:47], v10, s[44:47], 0 offen sc1
L_A_qt16:
s_mov_b32 s61, 69632
buffer_load_dwordx4 v[200:203], v9, s[40:43], s61 offen offset:0
s_waitcnt vmcnt(3)
buffer_load_dwordx4 v[204:207], v9, s[40:43], s61 offen offset:1024
v_perm_b32 v120, v188, v184, s66
v_perm_b32 v124, v188, v184, s67
v_perm_b32 v128, v189, v185, s66
v_perm_b32 v132, v189, v185, s67
v_perm_b32 v136, v190, v186, s66
v_perm_b32 v140, v190, v186, s67
v_perm_b32 v144, v191, v187, s66
v_perm_b32 v148, v191, v187, s67
s_waitcnt vmcnt(3)
buffer_load_dwordx4 v[208:211], v9, s[40:43], s61 offen offset:2048
s_waitcnt vmcnt(3)
buffer_load_dwordx4 v[212:215], v9, s[40:43], s61 offen offset:3072
v_perm_b32 v121, v196, v192, s66
v_perm_b32 v125, v196, v192, s67
v_perm_b32 v129, v197, v193, s66
v_perm_b32 v133, v197, v193, s67
v_perm_b32 v137, v198, v194, s66
v_perm_b32 v141, v198, v194, s67
v_perm_b32 v145, v199, v195, s66
v_perm_b32 v149, v199, v195, s67
s_waitcnt vmcnt(3)
s_cmp_lg_u32 s38, 0
s_cbranch_scc1 L_A_qc20
v_cmp_ne_u32 s[62:63], s88, v45
v_cmp_ne_u32 vcc, s88, v47
s_nop 1
s_or_b64 vcc, vcc, s[62:63]
s_cbranch_scc1 L_A_qc20
s_mov_b32 s38, 1
v_mov_b32 v45, v46
v_mov_b32 v46, 1
ds_write_b64 v11, v[44:45] offset:1024
ds_write_b32 v8, v46 offset:0
L_A_qc20:
s_cmp_lg_u32 s38, 0
s_cbranch_scc1 L_A_qt20
buffer_load_dwordx4 v[44:47], v10, s[44:47], 0 offen sc1
L_A_qt20:
s_mov_b32 s61, 98304
buffer_load_dwordx4 v[216:219], v9, s[40:43], s61 offen offset:0
s_waitcnt vmcnt(3)
buffer_load_dwordx4 v[220:223], v9, s[40:43], s61 offen offset:1024
v_perm_b32 v122, v204, v200, s66
v_perm_b32 v126, v204, v200, s67
v_perm_b32 v130, v205, v201, s66
v_perm_b32 v134, v205, v201, s67
v_perm_b32 v138, v206, v202, s66
v_perm_b32 v142, v206, v202, s67
v_perm_b32 v146, v207, v203, s66
v_perm_b32 v150, v207, v203, s67
s_waitcnt vmcnt(3)
buffer_load_dwordx4 v[224:227], v9, s[40:43], s61 offen offset:2048
s_waitcnt vmcnt(3)
buffer_load_dwordx4 v[228:231], v9, s[40:43], s61 offen offset:3072
v_perm_b32 v123, v212, v208, s66
v_perm_b32 v127, v212, v208, s67
v_perm_b32 v131, v213, v209, s66
v_perm_b32 v135, v213, v209, s67
v_perm_b32 v139, v214, v210, s66
v_perm_b32 v143, v214, v210, s67
v_perm_b32 v147, v215, v211, s66
v_perm_b32 v151, v215, v211, s67
s_waitcnt vmcnt(3)
s_cmp_lg_u32 s38, 0
s_cbranch_scc1 L_A_qc24
v_cmp_ne_u32 s[62:63], s88, v45
v_cmp_ne_u32 vcc, s88, v47
s_nop 1
s_or_b64 vcc, vcc, s[62:63]
s_cbranch_scc1 L_A_qc24
s_mov_b32 s38, 1
v_mov_b32 v45, v46
v_mov_b32 v46, 1
ds_write_b64 v11, v[44:45] offset:1024
ds_write_b32 v8, v46 offset:0
L_A_qc24:
s_cmp_lg_u32 s38, 0
s_cbranch_scc1 L_A_qt24
buffer_load_dwordx4 v[44:47], v10, s[44:47], 0 offen sc1
L_A_qt24:
s_mov_b32 s61, 102400
buffer_load_dwordx4 v[232:235], v9, s[40:43], s61 offen offset:0
s_waitcnt vmcnt(3)
buffer_load_dwordx4 v[236:239], v9, s[40:43], s61 offen offset:1024
v_perm_b32 v152, v220, v216, s66
v_perm_b32 v156, v220, v216, s67
v_perm_b32 v160, v221, v217, s66
v_perm_b32 v164, v221, v217, s67
v_perm_b32 v168, v222, v218, s66
v_perm_b32 v172, v222, v218, s67
v_perm_b32 v176, v223, v219, s66
v_perm_b32 v180, v223, v219, s67
s_waitcnt vmcnt(3)
buffer_load_dwordx4 v[240:243], v9, s[40:43], s61 offen offset:2048
s_waitcnt vmcnt(3)
buffer_load_dwordx4 v[244:247], v9, s[40:43], s61 offen offset:3072
v_perm_b32 v153, v228, v224, s66
v_perm_b32 v157, v228, v224, s67
v_perm_b32 v161, v229, v225, s66
v_perm_b32 v165, v229, v225, s67
v_perm_b32 v169, v230, v226, s66
v_perm_b32 v173, v230, v226, s67
v_perm_b32 v177, v231, v227, s66
v_perm_b32 v181, v231, v227, s67
s_waitcnt vmcnt(3)
s_cmp_lg_u32 s38, 0
s_cbranch_scc1 L_A_qc28
v_cmp_ne_u32 s[62:63], s88, v45
v_cmp_ne_u32 vcc, s88, v47
s_nop 1
s_or_b64 vcc, vcc, s[62:63]
s_cbranch_scc1 L_A_qc28
s_mov_b32 s38, 1
v_mov_b32 v45, v46
v_mov_b32 v46, 1
ds_write_b64 v11, v[44:45] offset:1024
ds_write_b32 v8, v46 offset:0
L_A_qc28:
s_waitcnt vmcnt(2)
v_perm_b32 v154, v236, v232, s66
v_perm_b32 v158, v236, v232, s67
v_perm_b32 v162, v237, v233, s66
v_perm_b32 v166, v237, v233, s67
v_perm_b32 v170, v238, v234, s66
v_perm_b32 v174, v238, v234, s67
v_perm_b32 v178, v239, v235, s66
v_perm_b32 v182, v239, v235, s67
s_waitcnt vmcnt(1)
s_waitcnt vmcnt(0)
v_perm_b32 v155, v244, v240, s66
v_perm_b32 v159, v244, v240, s67
v_perm_b32 v163, v245, v241, s66
v_perm_b32 v167, v245, v241, s67
v_perm_b32 v171, v246, v242, s66
v_perm_b32 v175, v246, v242, s67
v_perm_b32 v179, v247, v243, s66
v_perm_b32 v183, v247, v243, s67
s_mov_b32 s60, s37
s_cmp_lg_u32 s35, 0
s_cbranch_scc1 L_A_nostat
s_cmp_lg_u32 s38, 0
s_cbranch_scc1 L_A_qdone
s_mov_b32 s64, 0
L_tp_Aq:
buffer_load_dwordx4 v[44:47], v10, s[44:47], 0 offen sc1
s_waitcnt vmcnt(0)
v_cmp_ne_u32 s[62:63], s88, v45
v_cmp_ne_u32 vcc, s88, v47
s_add_u32 s64, s64, 1
s_nop 0
s_or_b64 vcc, vcc, s[62:63]
s_cbranch_scc0 L_tp_Aq_ok
s_cmp_lt_u32 s64, 65536
s_cbranch_scc1 L_tp_Aq
L_tp_Aq_ok:
v_mov_b32 v45, v46
v_mov_b32 v46, 1
ds_write_b64 v11, v[44:45] offset:1024
ds_write_b32 v8, v46 offset:0
L_A_qdone:
s_mov_b32 s64, 0
L_A_hs:
ds_read_b32 v10, v8 offset:4
s_waitcnt lgkmcnt(0)
v_readfirstlane_b32 s65, v10
s_add_u32 s64, s64, 1
s_nop 2
s_cmp_ge_u32 s65, 4
s_cbranch_scc1 L_A_hs_ok
s_sleep 16
s_cmp_lt_u32 s64, 1048576
s_cbranch_scc1 L_A_hs
L_A_hs_ok:
s_waitcnt vmcnt(0)
v_and_b32 v10, 1, v1
v_lshlrev_b32 v11, 4, v10
ds_read_b128 v[44:47], v11 offset:64
ds_read_b128 v[48:51], v11 offset:96
v_lshlrev_b32 v10, 12, v10
s_lshl_b32 s63, s60, 4
s_add_u32 s63, s63, 0x14000
v_add_u32 v10, s63, v10
s_waitcnt lgkmcnt(0)
v_max3_f32 v52, v44, v45, v46
v_max_f32 v52, v52, v47
v_sub_f32 v44, v44, v52
v_sub_f32 v45, v45, v52
v_sub_f32 v46, v46, v52
v_sub_f32 v47, v47, v52
v_exp_f32 v44, v44
v_exp_f32 v45, v45
v_exp_f32 v46, v46
v_exp_f32 v47, v47
s_nop 0
v_mul_f32 v54, v44, v48
v_fma_f32 v54, v45, v49, v54
v_fma_f32 v54, v46, v50, v54
v_fma_f32 v54, v47, v51, v54
v_mov_b32 v53, s88
v_mov_b32 v55, s88
s_mov_b64 exec, 3
global_store_dwordx4 v10, v[52:55], s[30:31] sc1
s_mov_b64 exec, -1
L_A_nostat:
s_cmp_lg_u32 s35, 1
s_cbranch_scc1 L_A_monx
s_and_b32 s63, s32, 7
s_lshl_b32 s63, s63, 8
s_add_u32 s63, s63, 0xc0000
s_add_u32 s56, s30, s63
s_addc_u32 s57, s31, 0
s_mov_b32 s64, 0
s_mov_b32 s59, 0
s_lshr_b32 s62, s32, 3
s_mul_i32 s62, s62, 6
s_add_u32 s62, s62, s33
s_lshl_b32 s62, s62, 2
v_mov_b32 v44, s62
v_lshlrev_b32 v48, 2, v1
L_A_mon:
s_mov_b64 exec, 1
ds_read_b32 v45, v8 offset:256
s_waitcnt lgkmcnt(0)
v_add_u32 v46, s88, v45
v_readfirstlane_b32 s58, v45
global_store_dword v44, v46, s[56:57]
s_mov_b64 exec, 0x1ffffff
global_load_dword v49, v48, s[56:57] nt
s_waitcnt vmcnt(0)
v_subrev_u32 v49, s88, v49
s_mov_b64 exec, 0xffffff
v_cmp_le_u32 vcc, 0x400, v49
v_readlane_b32 s62, v49, 24
v_add_u32_dpp v49, v49, v49 row_shr:1 row_mask:0xf bank_mask:0xf bound_ctrl:0
s_nop 1
v_add_u32_dpp v49, v49, v49 row_shr:2 row_mask:0xf bank_mask:0xf bound_ctrl:0
s_nop 1
v_add_u32_dpp v49, v49, v49 row_shr:4 row_mask:0xf bank_mask:0xf bound_ctrl:0
s_nop 1
v_add_u32_dpp v49, v49, v49 row_shr:8 row_mask:0xf bank_mask:0xf bound_ctrl:0
s_nop 0
v_readlane_b32 s61, v49, 15
v_readlane_b32 s63, v49, 23
s_add_u32 s61, s61, s63
s_add_u32 s63, s58, s59
s_mul_i32 s63, s63, 12
s_sub_u32 s61, s61, s63
s_cmp_lt_u32 s62, 0x8000
s_cselect_b32 s62, s62, 0x4000
s_add_u32 s61, s61, s62
s_sub_u32 s61, s61, 0x4000
s_mov_b32 s63, 96
s_cmp_lt_u32 s58, 400
s_cselect_b32 s63, s63, 0
s_cmp_gt_i32 s61, s63
s_cselect_b32 s63, 1, 0
s_cmp_eq_u64 vcc, 0
s_cselect_b32 s63, s63, 0
s_cmp_lt_u32 s58, 620
s_cselect_b32 s63, s63, 1
v_mov_b32 v47, s63
ds_write_b32 v8, v47 offset:8
s_mov_b32 s59, s58
s_cmp_ge_u32 s58, 620
s_cbranch_scc1 L_A_monx
s_add_u32 s64, s64, 1
s_cmp_lt_u32 s64, 4096
s_cbranch_scc1 L_A_mon
L_A_monx:
s_mov_b64 exec, -1
v_and_b32 v10, 7, v2
v_mul_u32_u24 v10, 272, v10
v_lshl_add_u32 v10, v3, 4, v10
v_lshlrev_b32 v11, 18, v3
v_lshl_add_u32 v11, v2, 4, v11
s_lshl_b32 s63, s60, 10
s_lshl_b32 s62, s35, 8
s_add_u32 s63, s63, s62
s_add_u32 s63, s63, 0x100000
v_add_u32 v11, s63, v11
s_barrier
ds_read_b128 v[12:15], v10 offset:8192
ds_read_b128 v[16:19], v10 offset:8256
ds_read_b128 v[20:23], v10 offset:8320
ds_read_b128 v[24:27], v10 offset:8384
s_waitcnt lgkmcnt(3)
v_mfma_f32_16x16x32_bf16 v[184:187], v[12:15], v[56:59], 0
v_mfma_f32_16x16x32_bf16 v[188:191], v[12:15], v[60:63], 0
s_waitcnt lgkmcnt(2)
v_mfma_f32_16x16x32_bf16 v[184:187], v[16:19], v[88:91], v[184:187]
v_mfma_f32_16x16x32_bf16 v[188:191], v[16:19], v[92:95], v[188:191]
s_waitcnt lgkmcnt(1)
v_mfma_f32_16x16x32_bf16 v[184:187], v[20:23], v[120:123], v[184:187]
v_mfma_f32_16x16x32_bf16 v[188:191], v[20:23], v[124:127], v[188:191]
s_waitcnt lgkmcnt(0)
v_mfma_f32_16x16x32_bf16 v[184:187], v[24:27], v[152:155], v[184:187]
v_mfma_f32_16x16x32_bf16 v[188:191], v[24:27], v[156:159], v[188:191]
v_mfma_f32_16x16x32_bf16 v[192:195], v[12:15], v[64:67], 0
v_mfma_f32_16x16x32_bf16 v[196:199], v[12:15], v[68:71], 0
v_mfma_f32_16x16x32_bf16 v[192:195], v[16:19], v[96:99], v[192:195]
v_mfma_f32_16x16x32_bf16 v[196:199], v[16:19], v[100:103], v[196:199]
v_mfma_f32_16x16x32_bf16 v[192:195], v[20:23], v[128:131], v[192:195]
v_mfma_f32_16x16x32_bf16 v[196:199], v[20:23], v[132:135], v[196:199]
v_mfma_f32_16x16x32_bf16 v[192:195], v[24:27], v[160:163], v[192:195]
v_mfma_f32_16x16x32_bf16 v[196:199], v[24:27], v[164:167], v[196:199]
v_add_f32 v184, v184, v185
v_add_f32 v186, v186, v187
v_add_f32 v184, v184, v186
v_add_f32 v188, v188, v189
v_add_f32 v190, v190, v191
v_add_f32 v188, v188, v190
v_cvt_pk_bf16_f32 v36, v184, v188
v_min_u32 v36, 0xfffffffe, v36
v_mfma_f32_16x16x32_bf16 v[200:203], v[12:15], v[72:75], 0
v_mfma_f32_16x16x32_bf16 v[204:207], v[12:15], v[76:79], 0
v_mfma_f32_16x16x32_bf16 v[200:203], v[16:19], v[104:107], v[200:203]
v_mfma_f32_16x16x32_bf16 v[204:207], v[16:19], v[108:111], v[204:207]
v_mfma_f32_16x16x32_bf16 v[200:203], v[20:23], v[136:139], v[200:203]
v_mfma_f32_16x16x32_bf16 v[204:207], v[20:23], v[140:143], v[204:207]
v_mfma_f32_16x16x32_bf16 v[200:203], v[24:27], v[168:171], v[200:203]
v_mfma_f32_16x16x32_bf16 v[204:207], v[24:27], v[172:175], v[204:207]
v_add_f32 v192, v192, v193
v_add_f32 v194, v194, v195
v_add_f32 v192, v192, v194
v_add_f32 v196, v196, v197
v_add_f32 v198, v198, v199
v_add_f32 v196, v196, v198
v_cvt_pk_bf16_f32 v37, v192, v196
v_min_u32 v37, 0xfffffffe, v37
v_mfma_f32_16x16x32_bf16 v[208:211], v[12:15], v[80:83], 0
v_mfma_f32_16x16x32_bf16 v[212:215], v[12:15], v[84:87], 0
v_mfma_f32_16x16x32_bf16 v[208:211], v[16:19], v[112:115], v[208:211]
v_mfma_f32_16x16x32_bf16 v[212:215], v[16:19], v[116:119], v[212:215]
v_mfma_f32_16x16x32_bf16 v[208:211], v[20:23], v[144:147], v[208:211]
v_mfma_f32_16x16x32_bf16 v[212:215], v[20:23], v[148:151], v[212:215]
v_mfma_f32_16x16x32_bf16 v[208:211], v[24:27], v[176:179], v[208:211]
v_mfma_f32_16x16x32_bf16 v[212:215], v[24:27], v[180:183], v[212:215]
v_add_f32 v200, v200, v201
v_add_f32 v202, v202, v203
v_add_f32 v200, v200, v202
v_add_f32 v204, v204, v205
v_add_f32 v206, v206, v207
v_add_f32 v204, v204, v206
v_cvt_pk_bf16_f32 v38, v200, v204
v_min_u32 v38, 0xfffffffe, v38
s_nop 0
v_add_f32 v208, v208, v209
v_add_f32 v210, v210, v211
v_add_f32 v208, v208, v210
v_add_f32 v212, v212, v213
v_add_f32 v214, v214, v215
v_add_f32 v212, v212, v214
v_cvt_pk_bf16_f32 v39, v208, v212
v_min_u32 v39, 0xfffffffe, v39
s_mov_b32 exec_hi, 0
global_store_dwordx4 v11, v[36:39], s[30:31] sc1
s_endpgm
L_roleW:
s_load_dword s88, s[30:31], 0x18000
v_mov_b32 v8, 0
s_mov_b32 s52, s30
s_and_b32 s53, s31, 0xffff
s_mov_b32 s54, 0x1000000
s_mov_b32 s55, 0x20000
s_lshl_b32 s60, s32, 8
s_sub_u32 s61, 0x400000, s60
s_add_u32 s40, s18, s60
s_addc_u32 s41, s19, 0
s_and_b32 s41, s41, 0xffff
s_mov_b32 s42, s61
s_mov_b32 s43, 0x20000
s_add_u32 s44, s20, s60
s_addc_u32 s45, s21, 0
s_and_b32 s45, s45, 0xffff
s_mov_b32 s46, s61
s_mov_b32 s47, 0x20000
s_mov_b32 s48, s14
s_and_b32 s49, s15, 0xffff
s_mov_b32 s50, 0x800
s_mov_b32 s51, 0x20000
v_lshrrev_b32 v192, 3, v2
v_lshlrev_b32 v192, 10, v192
v_lshl_add_u32 v192, v3, 5, v192
s_lshl_b32 s62, s34, 7
v_add_u32 v192, s62, v192
buffer_load_dwordx4 v[12:15], v192, s[48:51], 0 offen
buffer_load_dwordx4 v[16:19], v192, s[48:51], 0 offen offset:16
v_lshlrev_b32 v9, 17, v3
v_lshl_add_u32 v9, v2, 4, v9
s_lshl_b32 s62, s34, 19
v_add_u32 v9, s62, v9
s_waitcnt vmcnt(2)
s_mov_b32 s62, 0
buffer_load_dwordx4 v[64:67], v9, s[40:43], s62 offen nt
s_waitcnt vmcnt(2)
s_mov_b32 s62, 8192
buffer_load_dwordx4 v[68:71], v9, s[40:43], s62 offen nt
s_waitcnt vmcnt(2)
s_mov_b32 s62, 16384
buffer_load_dwordx4 v[72:75], v9, s[40:43], s62 offen nt
s_waitcnt vmcnt(2)
s_mov_b32 s62, 24576
buffer_load_dwordx4 v[76:79], v9, s[40:43], s62 offen nt
s_waitcnt vmcnt(2)
s_mov_b32 s62, 32768
buffer_load_dwordx4 v[80:83], v9, s[40:43], s62 offen nt
s_waitcnt vmcnt(2)
s_mov_b32 s62, 40960
buffer_load_dwordx4 v[84:87], v9, s[40:43], s62 offen nt
s_waitcnt vmcnt(2)
s_mov_b32 s62, 49152
buffer_load_dwordx4 v[88:91], v9, s[40:43], s62 offen nt
s_waitcnt vmcnt(2)
s_mov_b32 s62, 57344
buffer_load_dwordx4 v[92:95], v9, s[40:43], s62 offen nt
s_waitcnt vmcnt(2)
s_mov_b32 s62, 65536
buffer_load_dwordx4 v[96:99], v9, s[40:43], s62 offen nt
s_waitcnt vmcnt(2)
s_mov_b32 s62, 73728
buffer_load_dwordx4 v[100:103], v9, s[40:43], s62 offen nt
s_waitcnt vmcnt(2)
s_mov_b32 s62, 81920
buffer_load_dwordx4 v[104:107], v9, s[40:43], s62 offen nt
s_waitcnt vmcnt(2)
s_mov_b32 s62, 90112
buffer_load_dwordx4 v[108:111], v9, s[40:43], s62 offen nt
s_waitcnt vmcnt(2)
s_mov_b32 s62, 98304
buffer_load_dwordx4 v[112:115], v9, s[40:43], s62 offen nt
s_waitcnt vmcnt(2)
s_mov_b32 s62, 106496
buffer_load_dwordx4 v[116:119], v9, s[40:43], s62 offen nt
s_waitcnt vmcnt(2)
s_mov_b32 s62, 114688
buffer_load_dwordx4 v[120:123], v9, s[40:43], s62 offen nt
s_waitcnt vmcnt(2)
s_mov_b32 s62, 122880
buffer_load_dwordx4 v[124:127], v9, s[40:43], s62 offen nt
s_barrier
s_waitcnt vmcnt(16)
s_mov_b32 s60, 0x01000100
v_perm_b32 v192, v12, v12, s60
v_and_b32 v28, v192, v4
v_and_b32 v29, v192, v5
v_and_b32 v30, v192, v6
v_and_b32 v31, v192, v7
s_waitcnt vmcnt(15)
s_nop 0
v_mfma_f32_16x16x32_bf16 v[44:47], v[28:31], v[64:67], 0
s_mov_b32 s62, 0
buffer_load_dwordx4 v[128:131], v9, s[44:47], s62 offen nt
s_mov_b32 s60, 0x03020302
v_perm_b32 v193, v12, v12, s60
v_and_b32 v32, v193, v4
v_and_b32 v33, v193, v5
v_and_b32 v34, v193, v6
v_and_b32 v35, v193, v7
s_waitcnt vmcnt(15)
s_nop 0
v_mfma_f32_16x16x32_bf16 v[44:47], v[32:35], v[68:71], v[44:47]
s_mov_b32 s62, 8192
buffer_load_dwordx4 v[132:135], v9, s[44:47], s62 offen nt
s_mov_b32 s60, 0x01000100
v_perm_b32 v192, v13, v13, s60
v_and_b32 v28, v192, v4
v_and_b32 v29, v192, v5
v_and_b32 v30, v192, v6
v_and_b32 v31, v192, v7
s_waitcnt vmcnt(15)
s_nop 0
v_mfma_f32_16x16x32_bf16 v[44:47], v[28:31], v[72:75], v[44:47]
s_mov_b32 s62, 16384
buffer_load_dwordx4 v[136:139], v9, s[44:47], s62 offen nt
s_mov_b32 s60, 0x03020302
v_perm_b32 v193, v13, v13, s60
v_and_b32 v32, v193, v4
v_and_b32 v33, v193, v5
v_and_b32 v34, v193, v6
v_and_b32 v35, v193, v7
s_waitcnt vmcnt(15)
s_nop 0
v_mfma_f32_16x16x32_bf16 v[44:47], v[32:35], v[76:79], v[44:47]
s_mov_b32 s62, 24576
buffer_load_dwordx4 v[140:143], v9, s[44:47], s62 offen nt
s_mov_b32 s60, 0x01000100
v_perm_b32 v192, v14, v14, s60
v_and_b32 v28, v192, v4
v_and_b32 v29, v192, v5
v_and_b32 v30, v192, v6
v_and_b32 v31, v192, v7
s_waitcnt vmcnt(15)
s_nop 0
v_mfma_f32_16x16x32_bf16 v[44:47], v[28:31], v[80:83], v[44:47]
s_mov_b32 s62, 32768
buffer_load_dwordx4 v[144:147], v9, s[44:47], s62 offen nt
s_mov_b32 s60, 0x03020302
v_perm_b32 v193, v14, v14, s60
v_and_b32 v32, v193, v4
v_and_b32 v33, v193, v5
v_and_b32 v34, v193, v6
v_and_b32 v35, v193, v7
s_waitcnt vmcnt(15)
s_nop 0
v_mfma_f32_16x16x32_bf16 v[44:47], v[32:35], v[84:87], v[44:47]
s_mov_b32 s62, 40960
buffer_load_dwordx4 v[148:151], v9, s[44:47], s62 offen nt
s_mov_b32 s60, 0x01000100
v_perm_b32 v192, v15, v15, s60
v_and_b32 v28, v192, v4
v_and_b32 v29, v192, v5
v_and_b32 v30, v192, v6
v_and_b32 v31, v192, v7
s_waitcnt vmcnt(15)
s_nop 0
v_mfma_f32_16x16x32_bf16 v[44:47], v[28:31], v[88:91], v[44:47]
s_mov_b32 s62, 49152
buffer_load_dwordx4 v[152:155], v9, s[44:47], s62 offen nt
s_mov_b32 s60, 0x03020302
v_perm_b32 v193, v15, v15, s60
v_and_b32 v32, v193, v4
v_and_b32 v33, v193, v5
v_and_b32 v34, v193, v6
v_and_b32 v35, v193, v7
s_waitcnt vmcnt(15)
s_nop 0
v_mfma_f32_16x16x32_bf16 v[44:47], v[32:35], v[92:95], v[44:47]
s_mov_b32 s62, 57344
buffer_load_dwordx4 v[156:159], v9, s[44:47], s62 offen nt
s_mov_b32 s60, 0x01000100
v_perm_b32 v192, v16, v16, s60
v_and_b32 v28, v192, v4
v_and_b32 v29, v192, v5
v_and_b32 v30, v192, v6
v_and_b32 v31, v192, v7
s_waitcnt vmcnt(15)
s_nop 0
v_mfma_f32_16x16x32_bf16 v[44:47], v[28:31], v[96:99], v[44:47]
s_mov_b32 s62, 65536
buffer_load_dwordx4 v[160:163], v9, s[44:47], s62 offen nt
s_mov_b32 s60, 0x03020302
v_perm_b32 v193, v16, v16, s60
v_and_b32 v32, v193, v4
v_and_b32 v33, v193, v5
v_and_b32 v34, v193, v6
v_and_b32 v35, v193, v7
s_waitcnt vmcnt(15)
s_nop 0
v_mfma_f32_16x16x32_bf16 v[44:47], v[32:35], v[100:103], v[44:47]
s_mov_b32 s62, 73728
buffer_load_dwordx4 v[164:167], v9, s[44:47], s62 offen nt
s_mov_b32 s60, 0x01000100
v_perm_b32 v192, v17, v17, s60
v_and_b32 v28, v192, v4
v_and_b32 v29, v192, v5
v_and_b32 v30, v192, v6
v_and_b32 v31, v192, v7
s_waitcnt vmcnt(15)
s_nop 0
v_mfma_f32_16x16x32_bf16 v[44:47], v[28:31], v[104:107], v[44:47]
s_mov_b32 s62, 81920
buffer_load_dwordx4 v[168:171], v9, s[44:47], s62 offen nt
s_mov_b32 s60, 0x03020302
v_perm_b32 v193, v17, v17, s60
v_and_b32 v32, v193, v4
v_and_b32 v33, v193, v5
v_and_b32 v34, v193, v6
v_and_b32 v35, v193, v7
s_waitcnt vmcnt(15)
s_nop 0
v_mfma_f32_16x16x32_bf16 v[44:47], v[32:35], v[108:111], v[44:47]
s_mov_b32 s62, 90112
buffer_load_dwordx4 v[172:175], v9, s[44:47], s62 offen nt
s_mov_b32 s60, 0x01000100
v_perm_b32 v192, v18, v18, s60
v_and_b32 v28, v192, v4
v_and_b32 v29, v192, v5
v_and_b32 v30, v192, v6
v_and_b32 v31, v192, v7
s_waitcnt vmcnt(15)
s_nop 0
v_mfma_f32_16x16x32_bf16 v[44:47], v[28:31], v[112:115], v[44:47]
s_mov_b32 s62, 98304
buffer_load_dwordx4 v[176:179], v9, s[44:47], s62 offen nt
s_mov_b32 s60, 0x03020302
v_perm_b32 v193, v18, v18, s60
v_and_b32 v32, v193, v4
v_and_b32 v33, v193, v5
v_and_b32 v34, v193, v6
v_and_b32 v35, v193, v7
s_waitcnt vmcnt(15)
s_nop 0
v_mfma_f32_16x16x32_bf16 v[44:47], v[32:35], v[116:119], v[44:47]
s_mov_b32 s62, 106496
buffer_load_dwordx4 v[180:183], v9, s[44:47], s62 offen nt
s_mov_b32 s60, 0x01000100
v_perm_b32 v192, v19, v19, s60
v_and_b32 v28, v192, v4
v_and_b32 v29, v192, v5
v_and_b32 v30, v192, v6
v_and_b32 v31, v192, v7
s_waitcnt vmcnt(15)
s_nop 0
v_mfma_f32_16x16x32_bf16 v[44:47], v[28:31], v[120:123], v[44:47]
s_mov_b32 s62, 114688
buffer_load_dwordx4 v[184:187], v9, s[44:47], s62 offen nt
s_mov_b32 s60, 0x03020302
v_perm_b32 v193, v19, v19, s60
v_and_b32 v32, v193, v4
v_and_b32 v33, v193, v5
v_and_b32 v34, v193, v6
v_and_b32 v35, v193, v7
s_waitcnt vmcnt(15)
s_nop 0
v_mfma_f32_16x16x32_bf16 v[44:47], v[32:35], v[124:127], v[44:47]
s_mov_b32 s62, 122880
buffer_load_dwordx4 v[188:191], v9, s[44:47], s62 offen nt
s_nop 1
v_lshrrev_b32 v192, 1, v3
v_lshlrev_b32 v192, 9, v192
v_lshl_add_u32 v192, v2, 5, v192
v_and_b32 v193, 1, v3
v_lshl_add_u32 v192, v193, 4, v192
s_lshl_b32 s63, s34, 10
v_add_u32 v192, s63, v192
s_nop 1
s_nop 5
ds_write_b128 v192, v[44:47] offset:0
s_waitcnt lgkmcnt(0)
s_barrier
s_cmp_ge_u32 s34, 4
s_cbranch_scc1 L_W_qskip
v_lshlrev_b32 v194, 2, v0
ds_read_b32 v196, v194 offset:0
ds_read_b32 v197, v194 offset:1024
ds_read_b32 v198, v194 offset:2048
ds_read_b32 v199, v194 offset:3072
ds_read_b32 v200, v194 offset:4096
ds_read_b32 v201, v194 offset:5120
ds_read_b32 v202, v194 offset:6144
ds_read_b32 v203, v194 offset:7168
s_waitcnt lgkmcnt(0)
v_add_f32 v196, v196, v197
v_add_f32 v196, v196, v198
v_add_f32 v196, v196, v199
v_add_f32 v196, v196, v200
v_add_f32 v196, v196, v201
v_add_f32 v196, v196, v202
v_add_f32 v196, v196, v203
v_cvt_pk_bf16_f32 v196, v196, v196
v_lshlrev_b32 v194, 1, v0
ds_write_b16 v194, v196 offset:8192
s_waitcnt lgkmcnt(0)
L_W_qskip:
s_barrier
s_waitcnt lgkmcnt(0)
s_add_u32 s88, s88, 0x9e3779b9
v_lshlrev_b32 v194, 4, v2
ds_read_b128 v[20:23], v194 offset:8192
ds_read_b128 v[24:27], v194 offset:8448
v_mov_b32 v200, 0
v_mov_b32 v201, 0
s_waitcnt lgkmcnt(0)
s_waitcnt vmcnt(14)
v_dot2_f32_bf16 v60, v128, v20, 0
v_dot2_f32_bf16 v61, v128, v24, 0
v_dot2_f32_bf16 v62, v132, v20, 0
v_dot2_f32_bf16 v63, v132, v24, 0
v_dot2_f32_bf16 v60, v129, v21, v60
v_dot2_f32_bf16 v61, v129, v25, v61
v_dot2_f32_bf16 v62, v133, v21, v62
v_dot2_f32_bf16 v63, v133, v25, v63
v_dot2_f32_bf16 v60, v130, v22, v60
v_dot2_f32_bf16 v61, v130, v26, v61
v_dot2_f32_bf16 v62, v134, v22, v62
v_dot2_f32_bf16 v63, v134, v26, v63
v_dot2_f32_bf16 v60, v131, v23, v60
v_dot2_f32_bf16 v61, v131, v27, v61
v_dot2_f32_bf16 v62, v135, v23, v62
v_dot2_f32_bf16 v63, v135, v27, v63
v_add_f32_dpp v60, v60, v60 row_ror:8 row_mask:0xf bank_mask:0xf
v_add_f32_dpp v61, v61, v61 row_ror:8 row_mask:0xf bank_mask:0xf
v_add_f32_dpp v62, v62, v62 row_ror:8 row_mask:0xf bank_mask:0xf
v_add_f32_dpp v63, v63, v63 row_ror:8 row_mask:0xf bank_mask:0xf
v_add_f32_dpp v60, v60, v60 row_ror:4 row_mask:0xf bank_mask:0xf
v_add_f32_dpp v61, v61, v61 row_ror:4 row_mask:0xf bank_mask:0xf
v_add_f32_dpp v62, v62, v62 row_ror:4 row_mask:0xf bank_mask:0xf
v_add_f32_dpp v63, v63, v63 row_ror:4 row_mask:0xf bank_mask:0xf
v_add_f32_dpp v60, v60, v60 row_ror:2 row_mask:0xf bank_mask:0xf
v_add_f32_dpp v61, v61, v61 row_ror:2 row_mask:0xf bank_mask:0xf
v_add_f32_dpp v62, v62, v62 row_ror:2 row_mask:0xf bank_mask:0xf
v_add_f32_dpp v63, v63, v63 row_ror:2 row_mask:0xf bank_mask:0xf
v_add_f32_dpp v60, v60, v60 row_ror:1 row_mask:0xf bank_mask:0xf
v_add_f32_dpp v61, v61, v61 row_ror:1 row_mask:0xf bank_mask:0xf
v_add_f32_dpp v62, v62, v62 row_ror:1 row_mask:0xf bank_mask:0xf
v_add_f32_dpp v63, v63, v63 row_ror:1 row_mask:0xf bank_mask:0xf
v_cmp_eq_u32 vcc, 0, v2
s_nop 1
v_cndmask_b32 v200, v200, v60, vcc
v_cndmask_b32 v201, v201, v61, vcc
v_cmp_eq_u32 vcc, 1, v2
s_nop 1
v_cndmask_b32 v200, v200, v62, vcc
v_cndmask_b32 v201, v201, v63, vcc
s_waitcnt vmcnt(12)
v_dot2_f32_bf16 v60, v136, v20, 0
v_dot2_f32_bf16 v61, v136, v24, 0
v_dot2_f32_bf16 v62, v140, v20, 0
v_dot2_f32_bf16 v63, v140, v24, 0
v_dot2_f32_bf16 v60, v137, v21, v60
v_dot2_f32_bf16 v61, v137, v25, v61
v_dot2_f32_bf16 v62, v141, v21, v62
v_dot2_f32_bf16 v63, v141, v25, v63
v_dot2_f32_bf16 v60, v138, v22, v60
v_dot2_f32_bf16 v61, v138, v26, v61
v_dot2_f32_bf16 v62, v142, v22, v62
v_dot2_f32_bf16 v63, v142, v26, v63
v_dot2_f32_bf16 v60, v139, v23, v60
v_dot2_f32_bf16 v61, v139, v27, v61
v_dot2_f32_bf16 v62, v143, v23, v62
v_dot2_f32_bf16 v63, v143, v27, v63
v_add_f32_dpp v60, v60, v60 row_ror:8 row_mask:0xf bank_mask:0xf
v_add_f32_dpp v61, v61, v61 row_ror:8 row_mask:0xf bank_mask:0xf
v_add_f32_dpp v62, v62, v62 row_ror:8 row_mask:0xf bank_mask:0xf
v_add_f32_dpp v63, v63, v63 row_ror:8 row_mask:0xf bank_mask:0xf
v_add_f32_dpp v60, v60, v60 row_ror:4 row_mask:0xf bank_mask:0xf
v_add_f32_dpp v61, v61, v61 row_ror:4 row_mask:0xf bank_mask:0xf
v_add_f32_dpp v62, v62, v62 row_ror:4 row_mask:0xf bank_mask:0xf
v_add_f32_dpp v63, v63, v63 row_ror:4 row_mask:0xf bank_mask:0xf
v_add_f32_dpp v60, v60, v60 row_ror:2 row_mask:0xf bank_mask:0xf
v_add_f32_dpp v61, v61, v61 row_ror:2 row_mask:0xf bank_mask:0xf
v_add_f32_dpp v62, v62, v62 row_ror:2 row_mask:0xf bank_mask:0xf
v_add_f32_dpp v63, v63, v63 row_ror:2 row_mask:0xf bank_mask:0xf
v_add_f32_dpp v60, v60, v60 row_ror:1 row_mask:0xf bank_mask:0xf
v_add_f32_dpp v61, v61, v61 row_ror:1 row_mask:0xf bank_mask:0xf
v_add_f32_dpp v62, v62, v62 row_ror:1 row_mask:0xf bank_mask:0xf
v_add_f32_dpp v63, v63, v63 row_ror:1 row_mask:0xf bank_mask:0xf
v_cmp_eq_u32 vcc, 2, v2
s_nop 1
v_cndmask_b32 v200, v200, v60, vcc
v_cndmask_b32 v201, v201, v61, vcc
v_cmp_eq_u32 vcc, 3, v2
s_nop 1
v_cndmask_b32 v200, v200, v62, vcc
v_cndmask_b32 v201, v201, v63, vcc
s_waitcnt vmcnt(10)
v_dot2_f32_bf16 v60, v144, v20, 0
v_dot2_f32_bf16 v61, v144, v24, 0
v_dot2_f32_bf16 v62, v148, v20, 0
v_dot2_f32_bf16 v63, v148, v24, 0
v_dot2_f32_bf16 v60, v145, v21, v60
v_dot2_f32_bf16 v61, v145, v25, v61
v_dot2_f32_bf16 v62, v149, v21, v62
v_dot2_f32_bf16 v63, v149, v25, v63
v_dot2_f32_bf16 v60, v146, v22, v60
v_dot2_f32_bf16 v61, v146, v26, v61
v_dot2_f32_bf16 v62, v150, v22, v62
v_dot2_f32_bf16 v63, v150, v26, v63
v_dot2_f32_bf16 v60, v147, v23, v60
v_dot2_f32_bf16 v61, v147, v27, v61
v_dot2_f32_bf16 v62, v151, v23, v62
v_dot2_f32_bf16 v63, v151, v27, v63
v_add_f32_dpp v60, v60, v60 row_ror:8 row_mask:0xf bank_mask:0xf
v_add_f32_dpp v61, v61, v61 row_ror:8 row_mask:0xf bank_mask:0xf
v_add_f32_dpp v62, v62, v62 row_ror:8 row_mask:0xf bank_mask:0xf
v_add_f32_dpp v63, v63, v63 row_ror:8 row_mask:0xf bank_mask:0xf
v_add_f32_dpp v60, v60, v60 row_ror:4 row_mask:0xf bank_mask:0xf
v_add_f32_dpp v61, v61, v61 row_ror:4 row_mask:0xf bank_mask:0xf
v_add_f32_dpp v62, v62, v62 row_ror:4 row_mask:0xf bank_mask:0xf
v_add_f32_dpp v63, v63, v63 row_ror:4 row_mask:0xf bank_mask:0xf
v_add_f32_dpp v60, v60, v60 row_ror:2 row_mask:0xf bank_mask:0xf
v_add_f32_dpp v61, v61, v61 row_ror:2 row_mask:0xf bank_mask:0xf
v_add_f32_dpp v62, v62, v62 row_ror:2 row_mask:0xf bank_mask:0xf
v_add_f32_dpp v63, v63, v63 row_ror:2 row_mask:0xf bank_mask:0xf
v_add_f32_dpp v60, v60, v60 row_ror:1 row_mask:0xf bank_mask:0xf
v_add_f32_dpp v61, v61, v61 row_ror:1 row_mask:0xf bank_mask:0xf
v_add_f32_dpp v62, v62, v62 row_ror:1 row_mask:0xf bank_mask:0xf
v_add_f32_dpp v63, v63, v63 row_ror:1 row_mask:0xf bank_mask:0xf
v_cmp_eq_u32 vcc, 4, v2
s_nop 1
v_cndmask_b32 v200, v200, v60, vcc
v_cndmask_b32 v201, v201, v61, vcc
v_cmp_eq_u32 vcc, 5, v2
s_nop 1
v_cndmask_b32 v200, v200, v62, vcc
v_cndmask_b32 v201, v201, v63, vcc
s_waitcnt vmcnt(8)
v_dot2_f32_bf16 v60, v152, v20, 0
v_dot2_f32_bf16 v61, v152, v24, 0
v_dot2_f32_bf16 v62, v156, v20, 0
v_dot2_f32_bf16 v63, v156, v24, 0
v_dot2_f32_bf16 v60, v153, v21, v60
v_dot2_f32_bf16 v61, v153, v25, v61
v_dot2_f32_bf16 v62, v157, v21, v62
v_dot2_f32_bf16 v63, v157, v25, v63
v_dot2_f32_bf16 v60, v154, v22, v60
v_dot2_f32_bf16 v61, v154, v26, v61
v_dot2_f32_bf16 v62, v158, v22, v62
v_dot2_f32_bf16 v63, v158, v26, v63
v_dot2_f32_bf16 v60, v155, v23, v60
v_dot2_f32_bf16 v61, v155, v27, v61
v_dot2_f32_bf16 v62, v159, v23, v62
v_dot2_f32_bf16 v63, v159, v27, v63
v_add_f32_dpp v60, v60, v60 row_ror:8 row_mask:0xf bank_mask:0xf
v_add_f32_dpp v61, v61, v61 row_ror:8 row_mask:0xf bank_mask:0xf
v_add_f32_dpp v62, v62, v62 row_ror:8 row_mask:0xf bank_mask:0xf
v_add_f32_dpp v63, v63, v63 row_ror:8 row_mask:0xf bank_mask:0xf
v_add_f32_dpp v60, v60, v60 row_ror:4 row_mask:0xf bank_mask:0xf
v_add_f32_dpp v61, v61, v61 row_ror:4 row_mask:0xf bank_mask:0xf
v_add_f32_dpp v62, v62, v62 row_ror:4 row_mask:0xf bank_mask:0xf
v_add_f32_dpp v63, v63, v63 row_ror:4 row_mask:0xf bank_mask:0xf
v_add_f32_dpp v60, v60, v60 row_ror:2 row_mask:0xf bank_mask:0xf
v_add_f32_dpp v61, v61, v61 row_ror:2 row_mask:0xf bank_mask:0xf
v_add_f32_dpp v62, v62, v62 row_ror:2 row_mask:0xf bank_mask:0xf
v_add_f32_dpp v63, v63, v63 row_ror:2 row_mask:0xf bank_mask:0xf
v_add_f32_dpp v60, v60, v60 row_ror:1 row_mask:0xf bank_mask:0xf
v_add_f32_dpp v61, v61, v61 row_ror:1 row_mask:0xf bank_mask:0xf
v_add_f32_dpp v62, v62, v62 row_ror:1 row_mask:0xf bank_mask:0xf
v_add_f32_dpp v63, v63, v63 row_ror:1 row_mask:0xf bank_mask:0xf
v_cmp_eq_u32 vcc, 6, v2
s_nop 1
v_cndmask_b32 v200, v200, v60, vcc
v_cndmask_b32 v201, v201, v61, vcc
v_cmp_eq_u32 vcc, 7, v2
s_nop 1
v_cndmask_b32 v200, v200, v62, vcc
v_cndmask_b32 v201, v201, v63, vcc
s_waitcnt vmcnt(6)
v_dot2_f32_bf16 v60, v160, v20, 0
v_dot2_f32_bf16 v61, v160, v24, 0
v_dot2_f32_bf16 v62, v164, v20, 0
v_dot2_f32_bf16 v63, v164, v24, 0
v_dot2_f32_bf16 v60, v161, v21, v60
v_dot2_f32_bf16 v61, v161, v25, v61
v_dot2_f32_bf16 v62, v165, v21, v62
v_dot2_f32_bf16 v63, v165, v25, v63
v_dot2_f32_bf16 v60, v162, v22, v60
v_dot2_f32_bf16 v61, v162, v26, v61
v_dot2_f32_bf16 v62, v166, v22, v62
v_dot2_f32_bf16 v63, v166, v26, v63
v_dot2_f32_bf16 v60, v163, v23, v60
v_dot2_f32_bf16 v61, v163, v27, v61
v_dot2_f32_bf16 v62, v167, v23, v62
v_dot2_f32_bf16 v63, v167, v27, v63
v_add_f32_dpp v60, v60, v60 row_ror:8 row_mask:0xf bank_mask:0xf
v_add_f32_dpp v61, v61, v61 row_ror:8 row_mask:0xf bank_mask:0xf
v_add_f32_dpp v62, v62, v62 row_ror:8 row_mask:0xf bank_mask:0xf
v_add_f32_dpp v63, v63, v63 row_ror:8 row_mask:0xf bank_mask:0xf
v_add_f32_dpp v60, v60, v60 row_ror:4 row_mask:0xf bank_mask:0xf
v_add_f32_dpp v61, v61, v61 row_ror:4 row_mask:0xf bank_mask:0xf
v_add_f32_dpp v62, v62, v62 row_ror:4 row_mask:0xf bank_mask:0xf
v_add_f32_dpp v63, v63, v63 row_ror:4 row_mask:0xf bank_mask:0xf
v_add_f32_dpp v60, v60, v60 row_ror:2 row_mask:0xf bank_mask:0xf
v_add_f32_dpp v61, v61, v61 row_ror:2 row_mask:0xf bank_mask:0xf
v_add_f32_dpp v62, v62, v62 row_ror:2 row_mask:0xf bank_mask:0xf
v_add_f32_dpp v63, v63, v63 row_ror:2 row_mask:0xf bank_mask:0xf
v_add_f32_dpp v60, v60, v60 row_ror:1 row_mask:0xf bank_mask:0xf
v_add_f32_dpp v61, v61, v61 row_ror:1 row_mask:0xf bank_mask:0xf
v_add_f32_dpp v62, v62, v62 row_ror:1 row_mask:0xf bank_mask:0xf
v_add_f32_dpp v63, v63, v63 row_ror:1 row_mask:0xf bank_mask:0xf
v_cmp_eq_u32 vcc, 8, v2
s_nop 1
v_cndmask_b32 v200, v200, v60, vcc
v_cndmask_b32 v201, v201, v61, vcc
v_cmp_eq_u32 vcc, 9, v2
s_nop 1
v_cndmask_b32 v200, v200, v62, vcc
v_cndmask_b32 v201, v201, v63, vcc
s_waitcnt vmcnt(4)
v_dot2_f32_bf16 v60, v168, v20, 0
v_dot2_f32_bf16 v61, v168, v24, 0
v_dot2_f32_bf16 v62, v172, v20, 0
v_dot2_f32_bf16 v63, v172, v24, 0
v_dot2_f32_bf16 v60, v169, v21, v60
v_dot2_f32_bf16 v61, v169, v25, v61
v_dot2_f32_bf16 v62, v173, v21, v62
v_dot2_f32_bf16 v63, v173, v25, v63
v_dot2_f32_bf16 v60, v170, v22, v60
v_dot2_f32_bf16 v61, v170, v26, v61
v_dot2_f32_bf16 v62, v174, v22, v62
v_dot2_f32_bf16 v63, v174, v26, v63
v_dot2_f32_bf16 v60, v171, v23, v60
v_dot2_f32_bf16 v61, v171, v27, v61
v_dot2_f32_bf16 v62, v175, v23, v62
v_dot2_f32_bf16 v63, v175, v27, v63
v_add_f32_dpp v60, v60, v60 row_ror:8 row_mask:0xf bank_mask:0xf
v_add_f32_dpp v61, v61, v61 row_ror:8 row_mask:0xf bank_mask:0xf
v_add_f32_dpp v62, v62, v62 row_ror:8 row_mask:0xf bank_mask:0xf
v_add_f32_dpp v63, v63, v63 row_ror:8 row_mask:0xf bank_mask:0xf
v_add_f32_dpp v60, v60, v60 row_ror:4 row_mask:0xf bank_mask:0xf
v_add_f32_dpp v61, v61, v61 row_ror:4 row_mask:0xf bank_mask:0xf
v_add_f32_dpp v62, v62, v62 row_ror:4 row_mask:0xf bank_mask:0xf
v_add_f32_dpp v63, v63, v63 row_ror:4 row_mask:0xf bank_mask:0xf
v_add_f32_dpp v60, v60, v60 row_ror:2 row_mask:0xf bank_mask:0xf
v_add_f32_dpp v61, v61, v61 row_ror:2 row_mask:0xf bank_mask:0xf
v_add_f32_dpp v62, v62, v62 row_ror:2 row_mask:0xf bank_mask:0xf
v_add_f32_dpp v63, v63, v63 row_ror:2 row_mask:0xf bank_mask:0xf
v_add_f32_dpp v60, v60, v60 row_ror:1 row_mask:0xf bank_mask:0xf
v_add_f32_dpp v61, v61, v61 row_ror:1 row_mask:0xf bank_mask:0xf
v_add_f32_dpp v62, v62, v62 row_ror:1 row_mask:0xf bank_mask:0xf
v_add_f32_dpp v63, v63, v63 row_ror:1 row_mask:0xf bank_mask:0xf
v_cmp_eq_u32 vcc, 10, v2
s_nop 1
v_cndmask_b32 v200, v200, v60, vcc
v_cndmask_b32 v201, v201, v61, vcc
v_cmp_eq_u32 vcc, 11, v2
s_nop 1
v_cndmask_b32 v200, v200, v62, vcc
v_cndmask_b32 v201, v201, v63, vcc
s_waitcnt vmcnt(2)
v_dot2_f32_bf16 v60, v176, v20, 0
v_dot2_f32_bf16 v61, v176, v24, 0
v_dot2_f32_bf16 v62, v180, v20, 0
v_dot2_f32_bf16 v63, v180, v24, 0
v_dot2_f32_bf16 v60, v177, v21, v60
v_dot2_f32_bf16 v61, v177, v25, v61
v_dot2_f32_bf16 v62, v181, v21, v62
v_dot2_f32_bf16 v63, v181, v25, v63
v_dot2_f32_bf16 v60, v178, v22, v60
v_dot2_f32_bf16 v61, v178, v26, v61
v_dot2_f32_bf16 v62, v182, v22, v62
v_dot2_f32_bf16 v63, v182, v26, v63
v_dot2_f32_bf16 v60, v179, v23, v60
v_dot2_f32_bf16 v61, v179, v27, v61
v_dot2_f32_bf16 v62, v183, v23, v62
v_dot2_f32_bf16 v63, v183, v27, v63
v_add_f32_dpp v60, v60, v60 row_ror:8 row_mask:0xf bank_mask:0xf
v_add_f32_dpp v61, v61, v61 row_ror:8 row_mask:0xf bank_mask:0xf
v_add_f32_dpp v62, v62, v62 row_ror:8 row_mask:0xf bank_mask:0xf
v_add_f32_dpp v63, v63, v63 row_ror:8 row_mask:0xf bank_mask:0xf
v_add_f32_dpp v60, v60, v60 row_ror:4 row_mask:0xf bank_mask:0xf
v_add_f32_dpp v61, v61, v61 row_ror:4 row_mask:0xf bank_mask:0xf
v_add_f32_dpp v62, v62, v62 row_ror:4 row_mask:0xf bank_mask:0xf
v_add_f32_dpp v63, v63, v63 row_ror:4 row_mask:0xf bank_mask:0xf
v_add_f32_dpp v60, v60, v60 row_ror:2 row_mask:0xf bank_mask:0xf
v_add_f32_dpp v61, v61, v61 row_ror:2 row_mask:0xf bank_mask:0xf
v_add_f32_dpp v62, v62, v62 row_ror:2 row_mask:0xf bank_mask:0xf
v_add_f32_dpp v63, v63, v63 row_ror:2 row_mask:0xf bank_mask:0xf
v_add_f32_dpp v60, v60, v60 row_ror:1 row_mask:0xf bank_mask:0xf
v_add_f32_dpp v61, v61, v61 row_ror:1 row_mask:0xf bank_mask:0xf
v_add_f32_dpp v62, v62, v62 row_ror:1 row_mask:0xf bank_mask:0xf
v_add_f32_dpp v63, v63, v63 row_ror:1 row_mask:0xf bank_mask:0xf
v_cmp_eq_u32 vcc, 12, v2
s_nop 1
v_cndmask_b32 v200, v200, v60, vcc
v_cndmask_b32 v201, v201, v61, vcc
v_cmp_eq_u32 vcc, 13, v2
s_nop 1
v_cndmask_b32 v200, v200, v62, vcc
v_cndmask_b32 v201, v201, v63, vcc
s_waitcnt vmcnt(0)
v_dot2_f32_bf16 v60, v184, v20, 0
v_dot2_f32_bf16 v61, v184, v24, 0
v_dot2_f32_bf16 v62, v188, v20, 0
v_dot2_f32_bf16 v63, v188, v24, 0
v_dot2_f32_bf16 v60, v185, v21, v60
v_dot2_f32_bf16 v61, v185, v25, v61
v_dot2_f32_bf16 v62, v189, v21, v62
v_dot2_f32_bf16 v63, v189, v25, v63
v_dot2_f32_bf16 v60, v186, v22, v60
v_dot2_f32_bf16 v61, v186, v26, v61
v_dot2_f32_bf16 v62, v190, v22, v62
v_dot2_f32_bf16 v63, v190, v26, v63
v_dot2_f32_bf16 v60, v187, v23, v60
v_dot2_f32_bf16 v61, v187, v27, v61
v_dot2_f32_bf16 v62, v191, v23, v62
v_dot2_f32_bf16 v63, v191, v27, v63
v_add_f32_dpp v60, v60, v60 row_ror:8 row_mask:0xf bank_mask:0xf
v_add_f32_dpp v61, v61, v61 row_ror:8 row_mask:0xf bank_mask:0xf
v_add_f32_dpp v62, v62, v62 row_ror:8 row_mask:0xf bank_mask:0xf
v_add_f32_dpp v63, v63, v63 row_ror:8 row_mask:0xf bank_mask:0xf
v_add_f32_dpp v60, v60, v60 row_ror:4 row_mask:0xf bank_mask:0xf
v_add_f32_dpp v61, v61, v61 row_ror:4 row_mask:0xf bank_mask:0xf
v_add_f32_dpp v62, v62, v62 row_ror:4 row_mask:0xf bank_mask:0xf
v_add_f32_dpp v63, v63, v63 row_ror:4 row_mask:0xf bank_mask:0xf
v_add_f32_dpp v60, v60, v60 row_ror:2 row_mask:0xf bank_mask:0xf
v_add_f32_dpp v61, v61, v61 row_ror:2 row_mask:0xf bank_mask:0xf
v_add_f32_dpp v62, v62, v62 row_ror:2 row_mask:0xf bank_mask:0xf
v_add_f32_dpp v63, v63, v63 row_ror:2 row_mask:0xf bank_mask:0xf
v_add_f32_dpp v60, v60, v60 row_ror:1 row_mask:0xf bank_mask:0xf
v_add_f32_dpp v61, v61, v61 row_ror:1 row_mask:0xf bank_mask:0xf
v_add_f32_dpp v62, v62, v62 row_ror:1 row_mask:0xf bank_mask:0xf
v_add_f32_dpp v63, v63, v63 row_ror:1 row_mask:0xf bank_mask:0xf
v_cmp_eq_u32 vcc, 14, v2
s_nop 1
v_cndmask_b32 v200, v200, v60, vcc
v_cndmask_b32 v201, v201, v61, vcc
v_cmp_eq_u32 vcc, 15, v2
s_nop 1
v_cndmask_b32 v200, v200, v62, vcc
v_cndmask_b32 v201, v201, v63, vcc
v_cvt_pk_bf16_f32 v200, v200, v200
v_cvt_pk_bf16_f32 v201, v201, v201
s_lshl_b32 s62, s32, 10
s_lshl_b32 s63, s34, 7
s_add_u32 s62, s62, s63
s_add_u32 s62, s62, 0x0
v_lshl_add_u32 v192, v1, 1, s62
buffer_store_short v200, v192, s[52:55], 0 offen sc1
s_mov_b32 s62, 32768
buffer_store_short v201, v192, s[52:55], s62 offen sc1
s_lshl_b32 s62, s32, 2
s_add_u32 s62, s62, 0x1a000
v_lshl_add_u32 v192, v1, 8, s62
v_mov_b32 v193, s88
s_waitcnt vmcnt(0)
s_barrier
s_cmp_lg_u32 s34, 0
s_cbranch_scc1 L_sig_Wq
s_mov_b32 exec_hi, 0
buffer_store_dword v193, v192, s[52:55], 0 offen sc1
s_mov_b64 exec, -1
L_sig_Wq:
s_lshl_b32 s60, s32, 8
s_sub_u32 s61, 0x400000, s60
s_add_u32 s40, s22, s60
s_addc_u32 s41, s23, 0
s_and_b32 s41, s41, 0xffff
s_mov_b32 s42, s61
s_mov_b32 s43, 0x20000
s_lshl_b32 s60, s32, 17
s_mov_b32 s61, 0x20000
s_add_u32 s44, s24, s60
s_addc_u32 s45, s25, 0
s_and_b32 s45, s45, 0xffff
s_mov_b32 s46, s61
s_mov_b32 s47, 0x20000
v_lshlrev_b32 v10, 12, v3
v_lshl_add_u32 v10, v2, 4, v10
s_lshl_b32 s62, s34, 14
v_add_u32 v10, s62, v10
s_waitcnt vmcnt(2)
s_mov_b32 s62, 0
buffer_load_dwordx4 v[64:67], v9, s[40:43], s62 offen nt
s_waitcnt vmcnt(2)
s_mov_b32 s62, 8192
buffer_load_dwordx4 v[68:71], v9, s[40:43], s62 offen nt
s_waitcnt vmcnt(2)
s_mov_b32 s62, 16384
buffer_load_dwordx4 v[72:75], v9, s[40:43], s62 offen nt
s_waitcnt vmcnt(2)
s_mov_b32 s62, 24576
buffer_load_dwordx4 v[76:79], v9, s[40:43], s62 offen nt
s_waitcnt vmcnt(2)
s_mov_b32 s62, 32768
buffer_load_dwordx4 v[80:83], v9, s[40:43], s62 offen nt
s_waitcnt vmcnt(2)
s_mov_b32 s62, 40960
buffer_load_dwordx4 v[84:87], v9, s[40:43], s62 offen nt
s_waitcnt vmcnt(2)
s_mov_b32 s62, 49152
buffer_load_dwordx4 v[88:91], v9, s[40:43], s62 offen nt
s_waitcnt vmcnt(2)
s_mov_b32 s62, 57344
buffer_load_dwordx4 v[92:95], v9, s[40:43], s62 offen nt
s_waitcnt vmcnt(2)
s_mov_b32 s62, 65536
buffer_load_dwordx4 v[96:99], v9, s[40:43], s62 offen nt
s_waitcnt vmcnt(2)
s_mov_b32 s62, 73728
buffer_load_dwordx4 v[100:103], v9, s[40:43], s62 offen nt
s_waitcnt vmcnt(2)
s_mov_b32 s62, 81920
buffer_load_dwordx4 v[104:107], v9, s[40:43], s62 offen nt
s_waitcnt vmcnt(2)
s_mov_b32 s62, 90112
buffer_load_dwordx4 v[108:111], v9, s[40:43], s62 offen nt
s_waitcnt vmcnt(2)
s_mov_b32 s62, 98304
buffer_load_dwordx4 v[112:115], v9, s[40:43], s62 offen nt
s_waitcnt vmcnt(2)
s_mov_b32 s62, 106496
buffer_load_dwordx4 v[116:119], v9, s[40:43], s62 offen nt
s_waitcnt vmcnt(2)
s_mov_b32 s62, 114688
buffer_load_dwordx4 v[120:123], v9, s[40:43], s62 offen nt
s_waitcnt vmcnt(2)
s_mov_b32 s62, 122880
buffer_load_dwordx4 v[124:127], v9, s[40:43], s62 offen nt
s_waitcnt vmcnt(2)
buffer_load_dwordx4 v[128:131], v10, s[44:47], 0 offen offset:0 nt
s_waitcnt vmcnt(2)
buffer_load_dwordx4 v[132:135], v10, s[44:47], 0 offen offset:256 nt
s_waitcnt vmcnt(2)
buffer_load_dwordx4 v[136:139], v10, s[44:47], 0 offen offset:512 nt
s_waitcnt vmcnt(2)
buffer_load_dwordx4 v[140:143], v10, s[44:47], 0 offen offset:768 nt
s_waitcnt vmcnt(2)
buffer_load_dwordx4 v[144:147], v10, s[44:47], 0 offen offset:1024 nt
s_waitcnt vmcnt(2)
buffer_load_dwordx4 v[148:151], v10, s[44:47], 0 offen offset:1280 nt
s_waitcnt vmcnt(2)
buffer_load_dwordx4 v[152:155], v10, s[44:47], 0 offen offset:1536 nt
s_waitcnt vmcnt(2)
buffer_load_dwordx4 v[156:159], v10, s[44:47], 0 offen offset:1792 nt
s_waitcnt vmcnt(2)
buffer_load_dwordx4 v[160:163], v10, s[44:47], 0 offen offset:2048 nt
s_waitcnt vmcnt(2)
buffer_load_dwordx4 v[164:167], v10, s[44:47], 0 offen offset:2304 nt
s_waitcnt vmcnt(2)
buffer_load_dwordx4 v[168:171], v10, s[44:47], 0 offen offset:2560 nt
s_waitcnt vmcnt(2)
buffer_load_dwordx4 v[172:175], v10, s[44:47], 0 offen offset:2816 nt
s_waitcnt vmcnt(2)
buffer_load_dwordx4 v[176:179], v10, s[44:47], 0 offen offset:3072 nt
s_waitcnt vmcnt(2)
buffer_load_dwordx4 v[180:183], v10, s[44:47], 0 offen offset:3328 nt
s_waitcnt vmcnt(2)
buffer_load_dwordx4 v[184:187], v10, s[44:47], 0 offen offset:3584 nt
s_waitcnt vmcnt(2)
buffer_load_dwordx4 v[188:191], v10, s[44:47], 0 offen offset:3840 nt
s_cmp_lg_u32 s34, 7
s_cbranch_scc1 L_W_nogm
s_cmp_ge_u32 s32, 8
s_cbranch_scc1 L_W_nogm
s_and_b32 s63, s32, 7
s_lshl_b32 s63, s63, 8
s_add_u32 s63, s63, 0xc0000
s_add_u32 s56, s30, s63
s_addc_u32 s57, s31, 0
s_mov_b32 s64, 0
s_mov_b32 s59, 0
s_lshl_b32 s62, s32, 8
s_add_u32 s62, s62, 0xc1000
v_lshl_add_u32 v204, v1, 4, s62
s_mov_b32 s62, 0xc1000
v_lshl_add_u32 v205, v1, 8, s62
v_lshlrev_b32 v206, 2, v1
v_mov_b32 v207, 96
L_gm_W:
s_mov_b64 exec, 0x1ffffff
global_load_dword v208, v206, s[56:57] nt
s_waitcnt vmcnt(0)
v_subrev_u32 v208, s88, v208
s_mov_b64 exec, 0xffffff
v_cmp_le_u32 vcc, 0x400, v208
v_readlane_b32 s62, v208, 24
v_add_u32_dpp v208, v208, v208 row_shr:1 row_mask:0xf bank_mask:0xf bound_ctrl:0
s_nop 1
v_add_u32_dpp v208, v208, v208 row_shr:2 row_mask:0xf bank_mask:0xf bound_ctrl:0
s_nop 1
v_add_u32_dpp v208, v208, v208 row_shr:4 row_mask:0xf bank_mask:0xf bound_ctrl:0
s_nop 1
v_add_u32_dpp v208, v208, v208 row_shr:8 row_mask:0xf bank_mask:0xf bound_ctrl:0
s_nop 0
v_readlane_b32 s61, v208, 15
v_readlane_b32 s63, v208, 23
s_add_u32 s61, s61, s63
s_mov_b64 exec, 0xff
s_cbranch_vccnz L_gm_W_next
s_add_u32 s63, s61, s88
v_mov_b32 v200, s63
v_mov_b32 v201, s63
v_mov_b32 v202, s63
v_mov_b32 v203, s63
global_store_dwordx4 v204, v[200:203], s[30:31] sc1
global_load_dword v209, v205, s[30:31] sc1
s_mul_i32 s63, s61, 4
s_mul_i32 s65, s59, 4
s_add_u32 s65, s65, s63
s_cmp_eq_u32 s59, 0
s_mov_b32 s59, s61
s_waitcnt vmcnt(0)
s_cbranch_scc1 L_gm_W_next
v_subrev_u32 v209, s88, v209
v_cmp_le_u32 vcc, 0x8000, v209
s_nop 0
v_add_u32_dpp v209, v209, v209 row_shr:1 row_mask:0xf bank_mask:0xf bound_ctrl:0
s_nop 1
v_add_u32_dpp v209, v209, v209 row_shr:2 row_mask:0xf bank_mask:0xf bound_ctrl:0
s_nop 1
v_add_u32_dpp v209, v209, v209 row_shr:4 row_mask:0xf bank_mask:0xf bound_ctrl:0
s_cbranch_vccnz L_gm_W_next
s_nop 0
v_readlane_b32 s63, v209, 7
s_sub_u32 s63, s63, s65
s_ashr_i32 s63, s63, 3
s_add_u32 s63, s63, 0x4000
s_add_u32 s63, s63, s88
v_mov_b32 v210, s63
global_store_dword v207, v210, s[56:57]
L_gm_W_next:
ds_read_b32 v211, v8 offset:8704
s_waitcnt lgkmcnt(0)
v_readfirstlane_b32 s63, v211
s_cmp_eq_u32 s63, s88
s_cbranch_scc1 L_gm_W_x
s_add_u32 s64, s64, 1
s_cmp_lt_u32 s64, 64
s_cbranch_scc1 L_gm_W
L_gm_W_x:
s_mov_b64 exec, -1
L_W_nogm:
s_cmp_lg_u32 s34, 0
s_cbranch_scc1 L_wc_Wc
s_lshl_b32 s62, s32, 9
s_add_u32 s62, s62, 0x10000
v_and_b32 v193, 31, v1
v_lshl_add_u32 v192, v193, 4, s62
s_mov_b32 exec_hi, 0
s_mov_b32 s64, 0
L_tp_Wc:
buffer_load_dwordx4 v[196:199], v192, s[52:55], 0 offen sc1
s_waitcnt vmcnt(0)
v_cmp_ne_u32 s[62:63], s88, v197
v_cmp_ne_u32 vcc, s88, v199
s_add_u32 s64, s64, 1
s_nop 0
s_or_b64 vcc, vcc, s[62:63]
s_cbranch_scc0 L_tp_Wc_ok
s_sleep 16
s_cmp_lt_u32 s64, 65536
s_cbranch_scc1 L_tp_Wc
L_tp_Wc_ok:
v_lshlrev_b32 v193, 3, v193
v_mov_b32 v197, v198
ds_write_b64 v193, v[196:197] offset:8192
v_mov_b32 v199, s88
ds_write_b32 v8, v199 offset:8704
s_mov_b64 exec, -1
s_waitcnt lgkmcnt(0)
L_wc_Wc:
s_barrier
s_lshr_b32 s35, s34, 2
s_and_b32 s36, s34, 3
s_lshl_b32 s62, s35, 5
s_add_u32 s62, s62, s32
s_lshl_b32 s63, s62, 7
s_add_u32 s63, s63, 0x10000
v_lshl_add_u32 v192, v2, 3, s63
s_lshl_b32 s63, s35, 7
v_lshl_add_u32 v192, v2, 3, s63
ds_read_b64 v[194:195], v192 offset:8192
s_lshl_b32 s63, s62, 14
s_add_u32 s63, s63, 0x200000
s_lshl_b32 s64, s36, 12
s_add_u32 s63, s63, s64
v_lshl_add_u32 v193, v1, 4, s63
buffer_load_dwordx4 v[200:203], v193, s[52:55], 0 offen offset:0 sc1
buffer_load_dwordx4 v[204:207], v193, s[52:55], 0 offen offset:1024 sc1
buffer_load_dwordx4 v[208:211], v193, s[52:55], 0 offen offset:2048 sc1
buffer_load_dwordx4 v[212:215], v193, s[52:55], 0 offen offset:3072 sc1
s_waitcnt vmcnt(4) lgkmcnt(0)
v_mov_b32 v196, v194
s_nop 1
v_max_f32_dpp v196, v196, v196 row_ror:8 row_mask:0xf bank_mask:0xf
s_nop 1
v_max_f32_dpp v196, v196, v196 row_ror:4 row_mask:0xf bank_mask:0xf
s_nop 1
v_max_f32_dpp v196, v196, v196 row_ror:2 row_mask:0xf bank_mask:0xf
s_nop 1
v_max_f32_dpp v196, v196, v196 row_ror:1 row_mask:0xf bank_mask:0xf
v_sub_f32 v197, v194, v196
v_exp_f32 v197, v197
s_nop 0
v_mul_f32 v195, v195, v197
s_nop 1
v_add_f32_dpp v195, v195, v195 row_ror:8 row_mask:0xf bank_mask:0xf
s_nop 1
v_add_f32_dpp v195, v195, v195 row_ror:4 row_mask:0xf bank_mask:0xf
s_nop 1
v_add_f32_dpp v195, v195, v195 row_ror:2 row_mask:0xf bank_mask:0xf
s_nop 1
v_add_f32_dpp v195, v195, v195 row_ror:1 row_mask:0xf bank_mask:0xf
v_rcp_f32 v195, v195
s_nop 0
v_mul_f32 v197, v197, v195
s_lshl_b32 s64, s36, 2
s_add_u32 s65, s64, 0
v_readlane_b32 s66, v197, s65
s_add_u32 s65, s64, 1
v_readlane_b32 s67, v197, s65
s_add_u32 s65, s64, 2
v_readlane_b32 s68, v197, s65
s_add_u32 s65, s64, 3
v_readlane_b32 s69, v197, s65
s_waitcnt vmcnt(3)
v_lshlrev_b32 v216, 16, v200
v_and_b32 v217, 0xffff0000, v200
v_lshlrev_b32 v218, 16, v201
v_and_b32 v219, 0xffff0000, v201
v_lshlrev_b32 v220, 16, v202
v_and_b32 v221, 0xffff0000, v202
v_lshlrev_b32 v222, 16, v203
v_and_b32 v223, 0xffff0000, v203
v_mul_f32 v232, s66, v216
v_mul_f32 v233, s66, v217
v_mul_f32 v234, s66, v218
v_mul_f32 v235, s66, v219
v_mul_f32 v236, s66, v220
v_mul_f32 v237, s66, v221
v_mul_f32 v238, s66, v222
v_mul_f32 v239, s66, v223
s_waitcnt vmcnt(2)
v_lshlrev_b32 v216, 16, v204
v_and_b32 v217, 0xffff0000, v204
v_lshlrev_b32 v218, 16, v205
v_and_b32 v219, 0xffff0000, v205
v_lshlrev_b32 v220, 16, v206
v_and_b32 v221, 0xffff0000, v206
v_lshlrev_b32 v222, 16, v207
v_and_b32 v223, 0xffff0000, v207
v_fma_f32 v232, v216, s67, v232
v_fma_f32 v233, v217, s67, v233
v_fma_f32 v234, v218, s67, v234
v_fma_f32 v235, v219, s67, v235
v_fma_f32 v236, v220, s67, v236
v_fma_f32 v237, v221, s67, v237
v_fma_f32 v238, v222, s67, v238
v_fma_f32 v239, v223, s67, v239
s_waitcnt vmcnt(1)
v_lshlrev_b32 v216, 16, v208
v_and_b32 v217, 0xffff0000, v208
v_lshlrev_b32 v218, 16, v209
v_and_b32 v219, 0xffff0000, v209
v_lshlrev_b32 v220, 16, v210
v_and_b32 v221, 0xffff0000, v210
v_lshlrev_b32 v222, 16, v211
v_and_b32 v223, 0xffff0000, v211
v_fma_f32 v232, v216, s68, v232
v_fma_f32 v233, v217, s68, v233
v_fma_f32 v234, v218, s68, v234
v_fma_f32 v235, v219, s68, v235
v_fma_f32 v236, v220, s68, v236
v_fma_f32 v237, v221, s68, v237
v_fma_f32 v238, v222, s68, v238
v_fma_f32 v239, v223, s68, v239
s_waitcnt vmcnt(0)
v_lshlrev_b32 v216, 16, v212
v_and_b32 v217, 0xffff0000, v212
v_lshlrev_b32 v218, 16, v213
v_and_b32 v219, 0xffff0000, v213
v_lshlrev_b32 v220, 16, v214
v_and_b32 v221, 0xffff0000, v214
v_lshlrev_b32 v222, 16, v215
v_and_b32 v223, 0xffff0000, v215
v_fma_f32 v232, v216, s69, v232
v_fma_f32 v233, v217, s69, v233
v_fma_f32 v234, v218, s69, v234
v_fma_f32 v235, v219, s69, v235
v_fma_f32 v236, v220, s69, v236
v_fma_f32 v237, v221, s69, v237
v_fma_f32 v238, v222, s69, v238
v_fma_f32 v239, v223, s69, v239
s_lshl_b32 s62, s34, 11
v_lshl_add_u32 v192, v1, 5, s62
ds_write_b128 v192, v[232:235] offset:18432
ds_write_b128 v192, v[236:239] offset:18448
s_waitcnt lgkmcnt(0)
s_barrier
v_lshrrev_b32 v192, 3, v2
v_lshlrev_b32 v192, 13, v192
v_lshl_add_u32 v192, v3, 6, v192
s_lshl_b32 s62, s34, 8
v_add_u32 v192, s62, v192
ds_read_b128 v[200:203], v192 offset:18432
ds_read_b128 v[204:207], v192 offset:18448
ds_read_b128 v[208:211], v192 offset:18464
ds_read_b128 v[212:215], v192 offset:18480
ds_read_b128 v[216:219], v192 offset:20480
ds_read_b128 v[220:223], v192 offset:20496
ds_read_b128 v[224:227], v192 offset:20512
ds_read_b128 v[228:231], v192 offset:20528
s_waitcnt lgkmcnt(0)
v_add_f32 v200, v200, v216
v_add_f32 v201, v201, v217
v_add_f32 v202, v202, v218
v_add_f32 v203, v203, v219
v_add_f32 v204, v204, v220
v_add_f32 v205, v205, v221
v_add_f32 v206, v206, v222
v_add_f32 v207, v207, v223
v_add_f32 v208, v208, v224
v_add_f32 v209, v209, v225
v_add_f32 v210, v210, v226
v_add_f32 v211, v211, v227
v_add_f32 v212, v212, v228
v_add_f32 v213, v213, v229
v_add_f32 v214, v214, v230
v_add_f32 v215, v215, v231
ds_read_b128 v[216:219], v192 offset:22528
ds_read_b128 v[220:223], v192 offset:22544
ds_read_b128 v[224:227], v192 offset:22560
ds_read_b128 v[228:231], v192 offset:22576
s_waitcnt lgkmcnt(0)
v_add_f32 v200, v200, v216
v_add_f32 v201, v201, v217
v_add_f32 v202, v202, v218
v_add_f32 v203, v203, v219
v_add_f32 v204, v204, v220
v_add_f32 v205, v205, v221
v_add_f32 v206, v206, v222
v_add_f32 v207, v207, v223
v_add_f32 v208, v208, v224
v_add_f32 v209, v209, v225
v_add_f32 v210, v210, v226
v_add_f32 v211, v211, v227
v_add_f32 v212, v212, v228
v_add_f32 v213, v213, v229
v_add_f32 v214, v214, v230
v_add_f32 v215, v215, v231
ds_read_b128 v[216:219], v192 offset:24576
ds_read_b128 v[220:223], v192 offset:24592
ds_read_b128 v[224:227], v192 offset:24608
ds_read_b128 v[228:231], v192 offset:24624
s_waitcnt lgkmcnt(0)
v_add_f32 v200, v200, v216
v_add_f32 v201, v201, v217
v_add_f32 v202, v202, v218
v_add_f32 v203, v203, v219
v_add_f32 v204, v204, v220
v_add_f32 v205, v205, v221
v_add_f32 v206, v206, v222
v_add_f32 v207, v207, v223
v_add_f32 v208, v208, v224
v_add_f32 v209, v209, v225
v_add_f32 v210, v210, v226
v_add_f32 v211, v211, v227
v_add_f32 v212, v212, v228
v_add_f32 v213, v213, v229
v_add_f32 v214, v214, v230
v_add_f32 v215, v215, v231
v_cvt_pk_bf16_f32 v12, v200, v201
v_cvt_pk_bf16_f32 v13, v202, v203
v_cvt_pk_bf16_f32 v14, v204, v205
v_cvt_pk_bf16_f32 v15, v206, v207
v_cvt_pk_bf16_f32 v16, v208, v209
v_cvt_pk_bf16_f32 v17, v210, v211
v_cvt_pk_bf16_f32 v18, v212, v213
v_cvt_pk_bf16_f32 v19, v214, v215
s_mov_b32 s60, 0x01000100
v_perm_b32 v192, v12, v12, s60
v_and_b32 v28, v192, v4
v_and_b32 v29, v192, v5
v_and_b32 v30, v192, v6
v_and_b32 v31, v192, v7
s_waitcnt vmcnt(63)
s_nop 0
v_mfma_f32_16x16x32_bf16 v[44:47], v[28:31], v[64:67], 0
s_mov_b32 s60, 0x03020302
v_perm_b32 v193, v12, v12, s60
v_and_b32 v32, v193, v4
v_and_b32 v33, v193, v5
v_and_b32 v34, v193, v6
v_and_b32 v35, v193, v7
s_waitcnt vmcnt(63)
s_nop 0
v_mfma_f32_16x16x32_bf16 v[44:47], v[32:35], v[68:71], v[44:47]
s_mov_b32 s60, 0x01000100
v_perm_b32 v192, v13, v13, s60
v_and_b32 v28, v192, v4
v_and_b32 v29, v192, v5
v_and_b32 v30, v192, v6
v_and_b32 v31, v192, v7
s_waitcnt vmcnt(63)
s_nop 0
v_mfma_f32_16x16x32_bf16 v[44:47], v[28:31], v[72:75], v[44:47]
s_mov_b32 s60, 0x03020302
v_perm_b32 v193, v13, v13, s60
v_and_b32 v32, v193, v4
v_and_b32 v33, v193, v5
v_and_b32 v34, v193, v6
v_and_b32 v35, v193, v7
s_waitcnt vmcnt(63)
s_nop 0
v_mfma_f32_16x16x32_bf16 v[44:47], v[32:35], v[76:79], v[44:47]
s_mov_b32 s60, 0x01000100
v_perm_b32 v192, v14, v14, s60
v_and_b32 v28, v192, v4
v_and_b32 v29, v192, v5
v_and_b32 v30, v192, v6
v_and_b32 v31, v192, v7
s_waitcnt vmcnt(63)
s_nop 0
v_mfma_f32_16x16x32_bf16 v[44:47], v[28:31], v[80:83], v[44:47]
s_mov_b32 s60, 0x03020302
v_perm_b32 v193, v14, v14, s60
v_and_b32 v32, v193, v4
v_and_b32 v33, v193, v5
v_and_b32 v34, v193, v6
v_and_b32 v35, v193, v7
s_waitcnt vmcnt(63)
s_nop 0
v_mfma_f32_16x16x32_bf16 v[44:47], v[32:35], v[84:87], v[44:47]
s_mov_b32 s60, 0x01000100
v_perm_b32 v192, v15, v15, s60
v_and_b32 v28, v192, v4
v_and_b32 v29, v192, v5
v_and_b32 v30, v192, v6
v_and_b32 v31, v192, v7
s_waitcnt vmcnt(63)
s_nop 0
v_mfma_f32_16x16x32_bf16 v[44:47], v[28:31], v[88:91], v[44:47]
s_mov_b32 s60, 0x03020302
v_perm_b32 v193, v15, v15, s60
v_and_b32 v32, v193, v4
v_and_b32 v33, v193, v5
v_and_b32 v34, v193, v6
v_and_b32 v35, v193, v7
s_waitcnt vmcnt(63)
s_nop 0
v_mfma_f32_16x16x32_bf16 v[44:47], v[32:35], v[92:95], v[44:47]
s_mov_b32 s60, 0x01000100
v_perm_b32 v192, v16, v16, s60
v_and_b32 v28, v192, v4
v_and_b32 v29, v192, v5
v_and_b32 v30, v192, v6
v_and_b32 v31, v192, v7
s_waitcnt vmcnt(63)
s_nop 0
v_mfma_f32_16x16x32_bf16 v[44:47], v[28:31], v[96:99], v[44:47]
s_mov_b32 s60, 0x03020302
v_perm_b32 v193, v16, v16, s60
v_and_b32 v32, v193, v4
v_and_b32 v33, v193, v5
v_and_b32 v34, v193, v6
v_and_b32 v35, v193, v7
s_waitcnt vmcnt(63)
s_nop 0
v_mfma_f32_16x16x32_bf16 v[44:47], v[32:35], v[100:103], v[44:47]
s_mov_b32 s60, 0x01000100
v_perm_b32 v192, v17, v17, s60
v_and_b32 v28, v192, v4
v_and_b32 v29, v192, v5
v_and_b32 v30, v192, v6
v_and_b32 v31, v192, v7
s_waitcnt vmcnt(63)
s_nop 0
v_mfma_f32_16x16x32_bf16 v[44:47], v[28:31], v[104:107], v[44:47]
s_mov_b32 s60, 0x03020302
v_perm_b32 v193, v17, v17, s60
v_and_b32 v32, v193, v4
v_and_b32 v33, v193, v5
v_and_b32 v34, v193, v6
v_and_b32 v35, v193, v7
s_waitcnt vmcnt(63)
s_nop 0
v_mfma_f32_16x16x32_bf16 v[44:47], v[32:35], v[108:111], v[44:47]
s_mov_b32 s60, 0x01000100
v_perm_b32 v192, v18, v18, s60
v_and_b32 v28, v192, v4
v_and_b32 v29, v192, v5
v_and_b32 v30, v192, v6
v_and_b32 v31, v192, v7
s_waitcnt vmcnt(63)
s_nop 0
v_mfma_f32_16x16x32_bf16 v[44:47], v[28:31], v[112:115], v[44:47]
s_mov_b32 s60, 0x03020302
v_perm_b32 v193, v18, v18, s60
v_and_b32 v32, v193, v4
v_and_b32 v33, v193, v5
v_and_b32 v34, v193, v6
v_and_b32 v35, v193, v7
s_waitcnt vmcnt(63)
s_nop 0
v_mfma_f32_16x16x32_bf16 v[44:47], v[32:35], v[116:119], v[44:47]
s_mov_b32 s60, 0x01000100
v_perm_b32 v192, v19, v19, s60
v_and_b32 v28, v192, v4
v_and_b32 v29, v192, v5
v_and_b32 v30, v192, v6
v_and_b32 v31, v192, v7
s_waitcnt vmcnt(63)
s_nop 0
v_mfma_f32_16x16x32_bf16 v[44:47], v[28:31], v[120:123], v[44:47]
s_mov_b32 s60, 0x03020302
v_perm_b32 v193, v19, v19, s60
v_and_b32 v32, v193, v4
v_and_b32 v33, v193, v5
v_and_b32 v34, v193, v6
v_and_b32 v35, v193, v7
s_waitcnt vmcnt(63)
s_nop 0
v_mfma_f32_16x16x32_bf16 v[44:47], v[32:35], v[124:127], v[44:47]
v_lshrrev_b32 v192, 1, v3
v_lshlrev_b32 v192, 9, v192
v_lshl_add_u32 v192, v2, 5, v192
v_and_b32 v193, 1, v3
v_lshl_add_u32 v192, v193, 4, v192
s_lshl_b32 s63, s34, 10
v_add_u32 v192, s63, v192
s_nop 1
s_nop 5
ds_write_b128 v192, v[44:47] offset:9216
s_waitcnt lgkmcnt(0)
s_barrier
v_lshrrev_b32 v192, 3, v2
v_lshlrev_b32 v192, 9, v192
v_lshl_add_u32 v192, v3, 4, v192
s_lshl_b32 s62, s34, 6
v_add_u32 v192, s62, v192
ds_read_b128 v[200:203], v192 offset:9216
ds_read_b128 v[204:207], v192 offset:10240
ds_read_b128 v[208:211], v192 offset:11264
ds_read_b128 v[212:215], v192 offset:12288
ds_read_b128 v[216:219], v192 offset:13312
ds_read_b128 v[220:223], v192 offset:14336
ds_read_b128 v[224:227], v192 offset:15360
ds_read_b128 v[228:231], v192 offset:16384
s_waitcnt lgkmcnt(6)
v_add_f32 v200, v200, v204
v_add_f32 v201, v201, v205
v_add_f32 v202, v202, v206
v_add_f32 v203, v203, v207
s_waitcnt lgkmcnt(5)
v_add_f32 v200, v200, v208
v_add_f32 v201, v201, v209
v_add_f32 v202, v202, v210
v_add_f32 v203, v203, v211
s_waitcnt lgkmcnt(4)
v_add_f32 v200, v200, v212
v_add_f32 v201, v201, v213
v_add_f32 v202, v202, v214
v_add_f32 v203, v203, v215
s_waitcnt lgkmcnt(3)
v_add_f32 v200, v200, v216
v_add_f32 v201, v201, v217
v_add_f32 v202, v202, v218
v_add_f32 v203, v203, v219
s_waitcnt lgkmcnt(2)
v_add_f32 v200, v200, v220
v_add_f32 v201, v201, v221
v_add_f32 v202, v202, v222
v_add_f32 v203, v203, v223
s_waitcnt lgkmcnt(1)
v_add_f32 v200, v200, v224
v_add_f32 v201, v201, v225
v_add_f32 v202, v202, v226
v_add_f32 v203, v203, v227
s_waitcnt lgkmcnt(0)
v_add_f32 v200, v200, v228
v_add_f32 v201, v201, v229
v_add_f32 v202, v202, v230
v_add_f32 v203, v203, v231
v_cvt_pk_bf16_f32 v60, v200, v200
v_cvt_pk_bf16_f32 v61, v201, v201
v_cvt_pk_bf16_f32 v62, v202, v202
v_cvt_pk_bf16_f32 v63, v203, v203
v_and_b32 v28, v60, v4
v_and_b32 v29, v60, v5
v_and_b32 v30, v60, v6
v_and_b32 v31, v60, v7
v_and_b32 v32, v61, v4
v_and_b32 v33, v61, v5
v_and_b32 v34, v61, v6
v_and_b32 v35, v61, v7
v_and_b32 v36, v62, v4
v_and_b32 v37, v62, v5
v_and_b32 v38, v62, v6
v_and_b32 v39, v62, v7
v_and_b32 v40, v63, v4
v_and_b32 v41, v63, v5
v_and_b32 v42, v63, v6
v_and_b32 v43, v63, v7
s_nop 1
v_mfma_f32_16x16x32_bf16 v[44:47], v[28:31], v[128:131], 0
v_mfma_f32_16x16x32_bf16 v[48:51], v[28:31], v[132:135], 0
v_mfma_f32_16x16x32_bf16 v[52:55], v[28:31], v[136:139], 0
v_mfma_f32_16x16x32_bf16 v[56:59], v[28:31], v[140:143], 0
v_mfma_f32_16x16x32_bf16 v[44:47], v[32:35], v[144:147], v[44:47]
v_mfma_f32_16x16x32_bf16 v[48:51], v[32:35], v[148:151], v[48:51]
v_mfma_f32_16x16x32_bf16 v[52:55], v[32:35], v[152:155], v[52:55]
v_mfma_f32_16x16x32_bf16 v[56:59], v[32:35], v[156:159], v[56:59]
v_mfma_f32_16x16x32_bf16 v[44:47], v[36:39], v[160:163], v[44:47]
v_mfma_f32_16x16x32_bf16 v[48:51], v[36:39], v[164:167], v[48:51]
v_mfma_f32_16x16x32_bf16 v[52:55], v[36:39], v[168:171], v[52:55]
v_mfma_f32_16x16x32_bf16 v[56:59], v[36:39], v[172:175], v[56:59]
v_mfma_f32_16x16x32_bf16 v[44:47], v[40:43], v[176:179], v[44:47]
v_mfma_f32_16x16x32_bf16 v[48:51], v[40:43], v[180:183], v[48:51]
v_mfma_f32_16x16x32_bf16 v[52:55], v[40:43], v[184:187], v[52:55]
v_mfma_f32_16x16x32_bf16 v[56:59], v[40:43], v[188:191], v[56:59]
v_lshrrev_b32 v192, 1, v3
v_lshlrev_b32 v192, 11, v192
v_lshl_add_u32 v192, v2, 5, v192
v_and_b32 v193, 1, v3
v_lshl_add_u32 v192, v193, 4, v192
s_lshl_b32 s63, s34, 12
v_add_u32 v192, s63, v192
s_nop 1
ds_write_b128 v192, v[44:47] offset:18432
ds_write_b128 v192, v[48:51] offset:18944
ds_write_b128 v192, v[52:55] offset:19456
s_nop 5
ds_write_b128 v192, v[56:59] offset:19968
s_waitcnt lgkmcnt(0)
s_barrier
s_cmp_ge_u32 s34, 4
s_cbranch_scc1 L_W_yskip
v_lshlrev_b32 v192, 4, v0
ds_read_b128 v[200:203], v192 offset:18432
ds_read_b128 v[204:207], v192 offset:22528
ds_read_b128 v[208:211], v192 offset:26624
ds_read_b128 v[212:215], v192 offset:30720
ds_read_b128 v[216:219], v192 offset:34816
ds_read_b128 v[220:223], v192 offset:38912
ds_read_b128 v[224:227], v192 offset:43008
ds_read_b128 v[228:231], v192 offset:47104
v_lshrrev_b32 v193, 7, v0
v_lshlrev_b32 v193, 16, v193
v_and_b32 v194, 127, v0
v_lshl_add_u32 v193, v194, 4, v193
s_lshl_b32 s63, s32, 11
s_add_u32 s63, s63, 0x20000
v_add_u32 v193, s63, v193
s_waitcnt lgkmcnt(6)
v_add_f32 v200, v200, v204
v_add_f32 v201, v201, v205
v_add_f32 v202, v202, v206
v_add_f32 v203, v203, v207
s_waitcnt lgkmcnt(5)
v_add_f32 v200, v200, v208
v_add_f32 v201, v201, v209
v_add_f32 v202, v202, v210
v_add_f32 v203, v203, v211
s_waitcnt lgkmcnt(4)
v_add_f32 v200, v200, v212
v_add_f32 v201, v201, v213
v_add_f32 v202, v202, v214
v_add_f32 v203, v203, v215
s_waitcnt lgkmcnt(3)
v_add_f32 v200, v200, v216
v_add_f32 v201, v201, v217
v_add_f32 v202, v202, v218
v_add_f32 v203, v203, v219
s_waitcnt lgkmcnt(2)
v_add_f32 v200, v200, v220
v_add_f32 v201, v201, v221
v_add_f32 v202, v202, v222
v_add_f32 v203, v203, v223
s_waitcnt lgkmcnt(1)
v_add_f32 v200, v200, v224
v_add_f32 v201, v201, v225
v_add_f32 v202, v202, v226
v_add_f32 v203, v203, v227
s_waitcnt lgkmcnt(0)
v_add_f32 v200, v200, v228
v_add_f32 v201, v201, v229
v_add_f32 v202, v202, v230
v_add_f32 v203, v203, v231
v_cvt_pk_bf16_f32 v200, v200, v201
v_cvt_pk_bf16_f32 v202, v202, v203
v_mov_b32 v201, s88
v_mov_b32 v203, s88
buffer_store_dwordx4 v[200:203], v193, s[52:55], 0 offen sc1
L_W_yskip:
s_lshr_b32 s35, s32, 4
s_and_b32 s36, s32, 15
v_mov_b32 v232, 0
v_mov_b32 v233, 0
v_mov_b32 v234, 0
v_mov_b32 v235, 0
s_cmp_ge_u32 s34, 4
s_cbranch_scc1 L_W_bskip
v_lshrrev_b32 v192, 3, v0
v_lshlrev_b32 v192, 11, v192
v_and_b32 v193, 7, v0
v_lshl_add_u32 v192, v193, 4, v192
s_lshl_b32 s62, s35, 16
s_lshl_b32 s63, s36, 7
s_add_u32 s62, s62, s63
s_add_u32 s62, s62, 0x20000
v_add_u32 v192, s62, v192
s_mov_b32 s64, 0
L_tp_Wyb:
buffer_load_dwordx4 v[232:235], v192, s[52:55], 0 offen sc1
s_waitcnt vmcnt(0)
v_cmp_ne_u32 s[62:63], s88, v233
v_cmp_ne_u32 vcc, s88, v235
s_add_u32 s64, s64, 1
s_nop 0
s_or_b64 vcc, vcc, s[62:63]
s_cbranch_scc0 L_tp_Wyb_ok
s_cmp_lt_u32 s64, 65536
s_cbranch_scc1 L_tp_Wyb
L_tp_Wyb_ok:
v_and_b32 v233, 0xffff0000, v232
v_lshlrev_b32 v232, 16, v232
v_and_b32 v235, 0xffff0000, v234
v_lshlrev_b32 v234, 16, v234
L_W_bskip:
s_nop 1
v_add_f32_dpp v232, v232, v232 row_ror:8 row_mask:0xf bank_mask:0xf
v_add_f32_dpp v233, v233, v233 row_ror:8 row_mask:0xf bank_mask:0xf
v_add_f32_dpp v234, v234, v234 row_ror:8 row_mask:0xf bank_mask:0xf
v_add_f32_dpp v235, v235, v235 row_ror:8 row_mask:0xf bank_mask:0xf
v_mov_b32 v192, v232
v_mov_b32 v193, v233
v_mov_b32 v194, v234
v_mov_b32 v195, v235
s_nop 1
v_permlane16_swap_b32 v232, v192
v_permlane16_swap_b32 v233, v193
v_permlane16_swap_b32 v234, v194
v_permlane16_swap_b32 v235, v195
s_nop 0
v_add_f32 v232, v232, v192
v_add_f32 v233, v233, v193
v_add_f32 v234, v234, v194
v_add_f32 v235, v235, v195
v_mov_b32 v192, v232
v_mov_b32 v193, v233
v_mov_b32 v194, v234
v_mov_b32 v195, v235
s_nop 1
v_permlane32_swap_b32 v232, v192
v_permlane32_swap_b32 v233, v193
v_permlane32_swap_b32 v234, v194
v_permlane32_swap_b32 v235, v195
s_nop 0
v_add_f32 v232, v232, v192
v_add_f32 v233, v233, v193
v_add_f32 v234, v234, v194
v_add_f32 v235, v235, v195
v_lshlrev_b32 v192, 4, v1
s_lshl_b32 s63, s34, 7
v_add_u32 v192, s63, v192
s_mov_b64 exec, 0xff
ds_write_b128 v192, v[232:235] offset:17408
s_mov_b64 exec, -1
s_waitcnt lgkmcnt(0)
s_barrier
s_cmp_lg_u32 s34, 0
s_cbranch_scc1 L_Wb_fin
v_lshlrev_b32 v192, 2, v1
s_mov_b32 exec_hi, 0
ds_read_b32 v193, v192 offset:17408
ds_read_b32 v194, v192 offset:17536
ds_read_b32 v195, v192 offset:17664
ds_read_b32 v196, v192 offset:17792
s_waitcnt lgkmcnt(0)
v_add_f32 v193, v193, v194
v_add_f32 v193, v193, v195
v_add_f32 v193, v193, v196
v_cvt_pk_bf16_f32 v193, v193, v193
s_lshr_b32 s62, s32, 4
s_lshl_b32 s62, s62, 11
s_and_b32 s63, s32, 15
s_lshl_b32 s63, s63, 6
s_add_u32 s62, s62, s63
s_add_u32 s62, s62, 1024
v_lshl_add_u32 v192, v1, 1, s62
global_store_short v192, v193, s[26:27]
s_mov_b64 exec, -1
L_Wb_fin:
v_lshrrev_b32 v192, 3, v1
s_lshl_b32 s62, s35, 8
s_lshl_b32 s63, s34, 3
s_add_u32 s62, s62, s63
v_add_u32 v192, s62, v192
v_lshlrev_b32 v9, 4, v192
v_add_u32 v9, 0x14000, v9
v_lshlrev_b32 v10, 10, v192
v_and_b32 v193, 7, v1
v_lshl_add_u32 v10, v193, 3, v10
s_lshl_b32 s63, s36, 6
s_add_u32 s63, s63, 0x100000
v_add_u32 v10, s63, v10
v_mov_b32 v80, 0xff800000
v_mov_b32 v81, 0
v_mov_b32 v64, 0
v_mov_b32 v65, 0
v_mov_b32 v82, 0xff800000
v_mov_b32 v83, 0
v_mov_b32 v66, 0
v_mov_b32 v67, 0
v_mov_b32 v84, 0xff800000
v_mov_b32 v85, 0
v_mov_b32 v68, 0
v_mov_b32 v69, 0
v_mov_b32 v86, 0xff800000
v_mov_b32 v87, 0
v_mov_b32 v70, 0
v_mov_b32 v71, 0
s_mov_b32 s66, -1
s_mov_b32 s67, 0xffff
s_mov_b32 s68, -1
s_mov_b32 s69, 0xffff
s_mov_b32 s70, -1
s_mov_b32 s71, 0xffff
s_mov_b32 s72, -1
s_mov_b32 s73, 0xffff
s_mov_b32 s64, 0
s_mov_b64 exec, s[66:67]
L_W_stt:
buffer_load_dwordx4 v[96:99], v9, s[52:55], 0 offen offset:0 sc1
buffer_load_dwordx4 v[100:103], v9, s[52:55], 0 offen offset:1024 sc1
buffer_load_dwordx4 v[104:107], v9, s[52:55], 0 offen offset:2048 sc1
buffer_load_dwordx4 v[108:111], v9, s[52:55], 0 offen offset:3072 sc1
s_waitcnt vmcnt(0)
v_xor_b32 v97, s88, v97
v_xor_b32 v99, s88, v99
v_xor_b32 v101, s88, v101
v_xor_b32 v103, s88, v103
v_xor_b32 v105, s88, v105
v_xor_b32 v107, s88, v107
v_xor_b32 v109, s88, v109
v_xor_b32 v111, s88, v111
v_or3_b32 v192, v97, v99, v101
v_or3_b32 v192, v192, v103, v105
v_or3_b32 v192, v192, v107, v109
v_or_b32 v192, v192, v111
v_cmp_ne_u32 vcc, 0, v192
s_add_u32 s64, s64, 1
s_nop 0
s_cmp_eq_u64 vcc, 0
s_cbranch_scc1 L_W_stt_done
s_sleep 16
s_cmp_lt_u32 s64, 65536
s_cbranch_scc1 L_W_stt
L_W_stt_done:
v_mov_b32 v80, v96
v_mov_b32 v81, v98
v_mov_b32 v82, v100
v_mov_b32 v83, v102
v_mov_b32 v84, v104
v_mov_b32 v85, v106
v_mov_b32 v86, v108
v_mov_b32 v87, v110
s_mov_b64 exec, -1
v_mov_b32 v192, v80
v_mov_b32 v193, v82
v_mov_b32 v194, v84
v_mov_b32 v195, v86
s_nop 1
v_max_f32_dpp v192, v192, v192 row_ror:8 row_mask:0xf bank_mask:0xf
v_max_f32_dpp v193, v193, v193 row_ror:8 row_mask:0xf bank_mask:0xf
v_max_f32_dpp v194, v194, v194 row_ror:8 row_mask:0xf bank_mask:0xf
v_max_f32_dpp v195, v195, v195 row_ror:8 row_mask:0xf bank_mask:0xf
v_mov_b32 v196, v192
v_mov_b32 v197, v193
v_mov_b32 v198, v194
v_mov_b32 v199, v195
s_nop 1
v_permlane16_swap_b32 v192, v196
v_permlane16_swap_b32 v193, v197
v_permlane16_swap_b32 v194, v198
v_permlane16_swap_b32 v195, v199
s_nop 0
v_max_f32 v192, v192, v196
v_max_f32 v193, v193, v197
v_max_f32 v194, v194, v198
v_max_f32 v195, v195, v199
v_mov_b32 v196, v192
v_mov_b32 v197, v193
v_mov_b32 v198, v194
v_mov_b32 v199, v195
s_nop 1
v_permlane32_swap_b32 v192, v196
v_permlane32_swap_b32 v193, v197
v_permlane32_swap_b32 v194, v198
v_permlane32_swap_b32 v195, v199
s_nop 0
v_max_f32 v192, v192, v196
v_max_f32 v193, v193, v197
v_max_f32 v194, v194, v198
v_max_f32 v195, v195, v199
v_sub_f32 v192, v80, v192
v_sub_f32 v193, v82, v193
v_sub_f32 v194, v84, v194
v_sub_f32 v195, v86, v195
v_exp_f32 v192, v192
v_exp_f32 v193, v193
v_exp_f32 v194, v194
v_exp_f32 v195, v195
s_nop 0
v_mul_f32 v200, v81, v192
v_mul_f32 v201, v83, v193
v_mul_f32 v202, v85, v194
v_mul_f32 v203, v87, v195
s_nop 1
v_add_f32_dpp v200, v200, v200 row_ror:8 row_mask:0xf bank_mask:0xf
v_add_f32_dpp v201, v201, v201 row_ror:8 row_mask:0xf bank_mask:0xf
v_add_f32_dpp v202, v202, v202 row_ror:8 row_mask:0xf bank_mask:0xf
v_add_f32_dpp v203, v203, v203 row_ror:8 row_mask:0xf bank_mask:0xf
v_mov_b32 v196, v200
v_mov_b32 v197, v201
v_mov_b32 v198, v202
v_mov_b32 v199, v203
s_nop 1
v_permlane16_swap_b32 v200, v196
v_permlane16_swap_b32 v201, v197
v_permlane16_swap_b32 v202, v198
v_permlane16_swap_b32 v203, v199
s_nop 0
v_add_f32 v200, v200, v196
v_add_f32 v201, v201, v197
v_add_f32 v202, v202, v198
v_add_f32 v203, v203, v199
v_mov_b32 v196, v200
v_mov_b32 v197, v201
v_mov_b32 v198, v202
v_mov_b32 v199, v203
s_nop 1
v_permlane32_swap_b32 v200, v196
v_permlane32_swap_b32 v201, v197
v_permlane32_swap_b32 v202, v198
v_permlane32_swap_b32 v203, v199
s_nop 0
v_add_f32 v200, v200, v196
v_add_f32 v201, v201, v197
v_add_f32 v202, v202, v198
v_add_f32 v203, v203, v199
v_rcp_f32 v200, v200
v_rcp_f32 v201, v201
v_rcp_f32 v202, v202
v_rcp_f32 v203, v203
s_nop 0
v_mul_f32 v80, v192, v200
v_mul_f32 v81, v193, v201
v_mul_f32 v82, v194, v202
v_mul_f32 v83, v195, v203
v_mov_b32 v232, 0
v_mov_b32 v233, 0
v_mov_b32 v234, 0
v_mov_b32 v235, 0
s_mov_b32 s64, 0
s_mov_b32 s74, 0x1010101
s_mov_b32 s75, 0x101
L_W_gate:
s_mov_b64 exec, s[74:75]
buffer_load_dword v192, v10, s[52:55], 0 offen sc1
s_waitcnt vmcnt(0)
v_cmp_ne_u32 vcc, -1, v192
s_mov_b64 exec, -1
s_add_u32 s64, s64, 1
s_cmp_lg_u64 vcc, 0
s_cbranch_scc1 L_W_gate_done
s_sleep 4
s_cmp_lt_u32 s64, 65536
s_cbranch_scc1 L_W_gate
L_W_gate_done:
s_mov_b32 s64, 0
s_mov_b32 s77, 65536
s_mov_b32 s78, 131072
s_mov_b32 s79, 196608
L_W_sweep:
s_mov_b64 exec, s[66:67]
s_cbranch_execz L_W_sw0
buffer_load_dwordx2 v[64:65], v10, s[52:55], 0 offen sc1
L_W_sw0:
s_mov_b64 exec, s[68:69]
s_cbranch_execz L_W_sw1
buffer_load_dwordx2 v[66:67], v10, s[52:55], s77 offen sc1
L_W_sw1:
s_mov_b64 exec, s[70:71]
s_cbranch_execz L_W_sw2
buffer_load_dwordx2 v[68:69], v10, s[52:55], s78 offen sc1
L_W_sw2:
s_mov_b64 exec, s[72:73]
s_cbranch_execz L_W_sw3
buffer_load_dwordx2 v[70:71], v10, s[52:55], s79 offen sc1
L_W_sw3:
s_waitcnt vmcnt(0)
s_mov_b64 exec, s[66:67]
s_cbranch_execz L_W_sx0
v_max_u32 v192, v64, v65
v_cmp_ne_u32 vcc, -1, v192
v_lshlrev_b32 v88, 16, v64
v_and_b32 v89, 0xffff0000, v64
v_lshlrev_b32 v90, 16, v65
v_and_b32 v91, 0xffff0000, v65
s_andn2_b64 s[66:67], exec, vcc
s_mov_b64 exec, vcc
v_fma_f32 v232, v80, v88, v232
v_fma_f32 v233, v80, v89, v233
v_fma_f32 v234, v80, v90, v234
v_fma_f32 v235, v80, v91, v235
L_W_sx0:
s_mov_b64 exec, s[68:69]
s_cbranch_execz L_W_sx1
v_max_u32 v192, v66, v67
v_cmp_ne_u32 vcc, -1, v192
v_lshlrev_b32 v88, 16, v66
v_and_b32 v89, 0xffff0000, v66
v_lshlrev_b32 v90, 16, v67
v_and_b32 v91, 0xffff0000, v67
s_andn2_b64 s[68:69], exec, vcc
s_mov_b64 exec, vcc
v_fma_f32 v232, v81, v88, v232
v_fma_f32 v233, v81, v89, v233
v_fma_f32 v234, v81, v90, v234
v_fma_f32 v235, v81, v91, v235
L_W_sx1:
s_mov_b64 exec, s[70:71]
s_cbranch_execz L_W_sx2
v_max_u32 v192, v68, v69
v_cmp_ne_u32 vcc, -1, v192
v_lshlrev_b32 v88, 16, v68
v_and_b32 v89, 0xffff0000, v68
v_lshlrev_b32 v90, 16, v69
v_and_b32 v91, 0xffff0000, v69
s_andn2_b64 s[70:71], exec, vcc
s_mov_b64 exec, vcc
v_fma_f32 v232, v82, v88, v232
v_fma_f32 v233, v82, v89, v233
v_fma_f32 v234, v82, v90, v234
v_fma_f32 v235, v82, v91, v235
L_W_sx2:
s_mov_b64 exec, s[72:73]
s_cbranch_execz L_W_sx3
v_max_u32 v192, v70, v71
v_cmp_ne_u32 vcc, -1, v192
v_lshlrev_b32 v88, 16, v70
v_and_b32 v89, 0xffff0000, v70
v_lshlrev_b32 v90, 16, v71
v_and_b32 v91, 0xffff0000, v71
s_andn2_b64 s[72:73], exec, vcc
s_mov_b64 exec, vcc
v_fma_f32 v232, v83, v88, v232
v_fma_f32 v233, v83, v89, v233
v_fma_f32 v234, v83, v90, v234
v_fma_f32 v235, v83, v91, v235
L_W_sx3:
s_mov_b64 exec, -1
s_or_b64 s[74:75], s[66:67], s[68:69]
s_or_b64 s[80:81], s[70:71], s[72:73]
s_or_b64 s[74:75], s[74:75], s[80:81]
s_cbranch_scc0 L_W_sweep_done
s_add_u32 s64, s64, 1
s_cmp_lt_u32 s64, 65536
s_cbranch_scc1 L_W_sweep
L_W_sweep_done:
s_nop 1
v_add_f32_dpp v232, v232, v232 row_ror:8 row_mask:0xf bank_mask:0xf
v_add_f32_dpp v233, v233, v233 row_ror:8 row_mask:0xf bank_mask:0xf
v_add_f32_dpp v234, v234, v234 row_ror:8 row_mask:0xf bank_mask:0xf
v_add_f32_dpp v235, v235, v235 row_ror:8 row_mask:0xf bank_mask:0xf
v_mov_b32 v204, v232
v_mov_b32 v205, v233
v_mov_b32 v206, v234
v_mov_b32 v207, v235
s_nop 1
v_permlane16_swap_b32 v232, v204
v_permlane16_swap_b32 v233, v205
v_permlane16_swap_b32 v234, v206
v_permlane16_swap_b32 v235, v207
s_nop 0
v_add_f32 v232, v232, v204
v_add_f32 v233, v233, v205
v_add_f32 v234, v234, v206
v_add_f32 v235, v235, v207
v_mov_b32 v204, v232
v_mov_b32 v205, v233
v_mov_b32 v206, v234
v_mov_b32 v207, v235
s_nop 1
v_permlane32_swap_b32 v232, v204
v_permlane32_swap_b32 v233, v205
v_permlane32_swap_b32 v234, v206
v_permlane32_swap_b32 v235, v207
s_nop 0
v_add_f32 v232, v232, v204
v_add_f32 v233, v233, v205
v_add_f32 v234, v234, v206
v_add_f32 v235, v235, v207
v_lshlrev_b32 v204, 4, v1
s_lshl_b32 s63, s34, 7
v_add_u32 v204, s63, v204
s_mov_b64 exec, 0xff
ds_write_b128 v204, v[232:235] offset:0
s_mov_b64 exec, -1
s_waitcnt lgkmcnt(0)
s_barrier
s_cmp_lg_u32 s34, 0
s_cbranch_scc1 L_Wa_fin
v_lshlrev_b32 v204, 2, v1
s_mov_b32 exec_hi, 0
ds_read_b32 v205, v204 offset:0
ds_read_b32 v206, v204 offset:128
ds_read_b32 v207, v204 offset:256
ds_read_b32 v208, v204 offset:384
ds_read_b32 v209, v204 offset:512
ds_read_b32 v210, v204 offset:640
ds_read_b32 v211, v204 offset:768
ds_read_b32 v212, v204 offset:896
s_waitcnt lgkmcnt(0)
v_add_f32 v205, v205, v206
v_add_f32 v205, v205, v207
v_add_f32 v205, v205, v208
v_add_f32 v205, v205, v209
v_add_f32 v205, v205, v210
v_add_f32 v205, v205, v211
v_add_f32 v205, v205, v212
v_cvt_pk_bf16_f32 v205, v205, v205
s_lshr_b32 s62, s32, 4
s_lshl_b32 s62, s62, 11
s_and_b32 s63, s32, 15
s_lshl_b32 s63, s63, 6
s_add_u32 s62, s62, s63
s_add_u32 s62, s62, 0
v_lshl_add_u32 v204, v1, 1, s62
global_store_short v204, v205, s[26:27]
s_mov_b64 exec, -1
L_Wa_fin:
s_or_b32 s62, s32, s34
s_cbranch_scc1 L_W_nonext
v_mov_b32 v192, 0x18000
v_mov_b32 v193, s88
s_mov_b64 exec, 1
buffer_store_dword v193, v192, s[52:55], 0 offen
s_mov_b64 exec, -1
L_W_nonext:
s_endpgm
L_roleC:
s_load_dword s88, s[30:31], 0x18000
v_mov_b32 v8, 0
s_lshr_b32 s35, s32, 4
s_lshr_b32 s36, s34, 1
s_and_b32 s37, s34, 1
s_lshl_b32 s60, s32, 19
s_mov_b32 s61, 0x80000
s_add_u32 s40, s16, s60
s_addc_u32 s41, s17, 0
s_and_b32 s41, s41, 0xffff
s_mov_b32 s42, s61
s_mov_b32 s43, 0x20000
s_mov_b32 s44, s30
s_and_b32 s45, s31, 0xffff
s_mov_b32 s46, 0x1000000
s_mov_b32 s47, 0x20000
s_lshl_b32 s60, s32, 8
s_sub_u32 s61, 0x400000, s60
s_add_u32 s52, s10, s60
s_addc_u32 s53, s11, 0
s_and_b32 s53, s53, 0xffff
s_mov_b32 s54, s61
s_mov_b32 s55, 0x20000
s_mov_b32 s56, s4
s_and_b32 s57, s5, 0xffff
s_mov_b32 s58, 0x800
s_mov_b32 s59, 0x20000
v_lshrrev_b32 v192, 3, v2
v_lshlrev_b32 v192, 10, v192
v_lshl_add_u32 v192, v3, 5, v192
s_lshl_b32 s62, s34, 7
v_add_u32 v192, s62, v192
buffer_load_dwordx4 v[12:15], v192, s[56:59], 0 offen
buffer_load_dwordx4 v[16:19], v192, s[56:59], 0 offen offset:16
v_lshlrev_b32 v9, 17, v3
v_lshl_add_u32 v9, v2, 4, v9
s_lshl_b32 s62, s34, 19
v_add_u32 v9, s62, v9
s_mov_b32 s62, 0
buffer_load_dwordx4 v[64:67], v9, s[52:55], s62 offen nt
s_mov_b32 s62, 8192
buffer_load_dwordx4 v[68:71], v9, s[52:55], s62 offen nt
s_mov_b32 s62, 16384
buffer_load_dwordx4 v[72:75], v9, s[52:55], s62 offen nt
s_mov_b32 s62, 24576
buffer_load_dwordx4 v[76:79], v9, s[52:55], s62 offen nt
s_mov_b32 s62, 32768
buffer_load_dwordx4 v[80:83], v9, s[52:55], s62 offen nt
s_mov_b32 s62, 40960
buffer_load_dwordx4 v[84:87], v9, s[52:55], s62 offen nt
v_lshrrev_b32 v192, 1, v3
v_lshlrev_b32 v192, 9, v192
v_lshl_add_u32 v192, v2, 5, v192
v_and_b32 v193, 1, v3
v_lshl_add_u32 v192, v193, 4, v192
s_lshl_b32 s63, s34, 10
s_add_u32 s63, s63, 140288
v_add_u32 v192, s63, v192
v_lshlrev_b32 v193, 4, v1
s_lshl_b32 s63, s32, 10
s_add_u32 s63, s63, 0x40000
v_add_u32 v194, s63, v193
v_add_u32 v193, 140288, v193
s_mov_b32 s66, 0x01000100
s_mov_b32 s67, 0x03020302
s_waitcnt vmcnt(5)
s_mov_b32 s62, 49152
buffer_load_dwordx4 v[88:91], v9, s[52:55], s62 offen nt
v_perm_b32 v195, v12, v12, s66
v_and_b32 v28, v195, v4
v_and_b32 v29, v195, v5
v_and_b32 v30, v195, v6
v_and_b32 v31, v195, v7
s_nop 1
v_mfma_f32_16x16x32_bf16 v[44:47], v[28:31], v[64:67], 0
s_waitcnt vmcnt(5)
s_mov_b32 s62, 57344
buffer_load_dwordx4 v[92:95], v9, s[52:55], s62 offen nt
v_perm_b32 v195, v12, v12, s67
v_and_b32 v32, v195, v4
v_and_b32 v33, v195, v5
v_and_b32 v34, v195, v6
v_and_b32 v35, v195, v7
s_nop 1
v_mfma_f32_16x16x32_bf16 v[44:47], v[32:35], v[68:71], v[44:47]
s_waitcnt vmcnt(5)
s_mov_b32 s62, 65536
buffer_load_dwordx4 v[96:99], v9, s[52:55], s62 offen nt
v_perm_b32 v195, v13, v13, s66
v_and_b32 v28, v195, v4
v_and_b32 v29, v195, v5
v_and_b32 v30, v195, v6
v_and_b32 v31, v195, v7
s_nop 1
v_mfma_f32_16x16x32_bf16 v[44:47], v[28:31], v[72:75], v[44:47]
s_waitcnt vmcnt(5)
s_mov_b32 s62, 73728
buffer_load_dwordx4 v[100:103], v9, s[52:55], s62 offen nt
v_perm_b32 v195, v13, v13, s67
v_and_b32 v32, v195, v4
v_and_b32 v33, v195, v5
v_and_b32 v34, v195, v6
v_and_b32 v35, v195, v7
s_nop 1
v_mfma_f32_16x16x32_bf16 v[44:47], v[32:35], v[76:79], v[44:47]
s_waitcnt vmcnt(5)
s_mov_b32 s62, 81920
buffer_load_dwordx4 v[104:107], v9, s[52:55], s62 offen nt
v_perm_b32 v195, v14, v14, s66
v_and_b32 v28, v195, v4
v_and_b32 v29, v195, v5
v_and_b32 v30, v195, v6
v_and_b32 v31, v195, v7
s_nop 1
v_mfma_f32_16x16x32_bf16 v[44:47], v[28:31], v[80:83], v[44:47]
s_waitcnt vmcnt(5)
s_mov_b32 s62, 90112
buffer_load_dwordx4 v[108:111], v9, s[52:55], s62 offen nt
v_perm_b32 v195, v14, v14, s67
v_and_b32 v32, v195, v4
v_and_b32 v33, v195, v5
v_and_b32 v34, v195, v6
v_and_b32 v35, v195, v7
s_nop 1
v_mfma_f32_16x16x32_bf16 v[44:47], v[32:35], v[84:87], v[44:47]
s_waitcnt vmcnt(5)
s_mov_b32 s62, 98304
buffer_load_dwordx4 v[112:115], v9, s[52:55], s62 offen nt
v_perm_b32 v195, v15, v15, s66
v_and_b32 v28, v195, v4
v_and_b32 v29, v195, v5
v_and_b32 v30, v195, v6
v_and_b32 v31, v195, v7
s_nop 1
v_mfma_f32_16x16x32_bf16 v[44:47], v[28:31], v[88:91], v[44:47]
s_waitcnt vmcnt(5)
s_mov_b32 s62, 106496
buffer_load_dwordx4 v[116:119], v9, s[52:55], s62 offen nt
v_perm_b32 v195, v15, v15, s67
v_and_b32 v32, v195, v4
v_and_b32 v33, v195, v5
v_and_b32 v34, v195, v6
v_and_b32 v35, v195, v7
s_nop 1
v_mfma_f32_16x16x32_bf16 v[44:47], v[32:35], v[92:95], v[44:47]
s_waitcnt vmcnt(5)
s_mov_b32 s62, 114688
buffer_load_dwordx4 v[120:123], v9, s[52:55], s62 offen nt
v_perm_b32 v195, v16, v16, s66
v_and_b32 v28, v195, v4
v_and_b32 v29, v195, v5
v_and_b32 v30, v195, v6
v_and_b32 v31, v195, v7
s_nop 1
v_mfma_f32_16x16x32_bf16 v[44:47], v[28:31], v[96:99], v[44:47]
s_waitcnt vmcnt(5)
s_mov_b32 s62, 122880
buffer_load_dwordx4 v[124:127], v9, s[52:55], s62 offen nt
v_perm_b32 v195, v16, v16, s67
v_and_b32 v32, v195, v4
v_and_b32 v33, v195, v5
v_and_b32 v34, v195, v6
v_and_b32 v35, v195, v7
s_nop 1
v_mfma_f32_16x16x32_bf16 v[44:47], v[32:35], v[100:103], v[44:47]
s_waitcnt vmcnt(5)
v_perm_b32 v195, v17, v17, s66
v_and_b32 v28, v195, v4
v_and_b32 v29, v195, v5
v_and_b32 v30, v195, v6
v_and_b32 v31, v195, v7
s_nop 1
v_mfma_f32_16x16x32_bf16 v[44:47], v[28:31], v[104:107], v[44:47]
s_waitcnt vmcnt(4)
v_perm_b32 v195, v17, v17, s67
v_and_b32 v32, v195, v4
v_and_b32 v33, v195, v5
v_and_b32 v34, v195, v6
v_and_b32 v35, v195, v7
s_nop 1
v_mfma_f32_16x16x32_bf16 v[44:47], v[32:35], v[108:111], v[44:47]
s_waitcnt vmcnt(3)
v_perm_b32 v195, v18, v18, s66
v_and_b32 v28, v195, v4
v_and_b32 v29, v195, v5
v_and_b32 v30, v195, v6
v_and_b32 v31, v195, v7
s_nop 1
v_mfma_f32_16x16x32_bf16 v[44:47], v[28:31], v[112:115], v[44:47]
s_waitcnt vmcnt(2)
v_perm_b32 v195, v18, v18, s67
v_and_b32 v32, v195, v4
v_and_b32 v33, v195, v5
v_and_b32 v34, v195, v6
v_and_b32 v35, v195, v7
s_nop 1
v_mfma_f32_16x16x32_bf16 v[44:47], v[32:35], v[116:119], v[44:47]
s_waitcnt vmcnt(1)
v_perm_b32 v195, v19, v19, s66
v_and_b32 v28, v195, v4
v_and_b32 v29, v195, v5
v_and_b32 v30, v195, v6
v_and_b32 v31, v195, v7
s_nop 1
v_mfma_f32_16x16x32_bf16 v[44:47], v[28:31], v[120:123], v[44:47]
s_waitcnt vmcnt(0)
v_perm_b32 v195, v19, v19, s67
v_and_b32 v32, v195, v4
v_and_b32 v33, v195, v5
v_and_b32 v34, v195, v6
v_and_b32 v35, v195, v7
s_nop 1
v_mfma_f32_16x16x32_bf16 v[44:47], v[32:35], v[124:127], v[44:47]
s_nop 7
ds_write_b128 v192, v[44:47]
s_waitcnt lgkmcnt(0)
s_add_u32 s88, s88, 0x9e3779b9
s_barrier
s_cmp_lg_u32 s34, 0
s_cbranch_scc1 L_C_qdone
ds_read_b128 v[64:67], v193 offset:0
ds_read_b128 v[68:71], v193 offset:1024
ds_read_b128 v[72:75], v193 offset:2048
ds_read_b128 v[76:79], v193 offset:3072
ds_read_b128 v[80:83], v193 offset:4096
ds_read_b128 v[84:87], v193 offset:5120
ds_read_b128 v[88:91], v193 offset:6144
ds_read_b128 v[92:95], v193 offset:7168
s_waitcnt lgkmcnt(6)
v_add_f32 v64, v64, v68
v_add_f32 v65, v65, v69
v_add_f32 v66, v66, v70
v_add_f32 v67, v67, v71
s_waitcnt lgkmcnt(5)
v_add_f32 v64, v64, v72
v_add_f32 v65, v65, v73
v_add_f32 v66, v66, v74
v_add_f32 v67, v67, v75
s_waitcnt lgkmcnt(4)
v_add_f32 v64, v64, v76
v_add_f32 v65, v65, v77
v_add_f32 v66, v66, v78
v_add_f32 v67, v67, v79
s_waitcnt lgkmcnt(3)
v_add_f32 v64, v64, v80
v_add_f32 v65, v65, v81
v_add_f32 v66, v66, v82
v_add_f32 v67, v67, v83
s_waitcnt lgkmcnt(2)
v_add_f32 v64, v64, v84
v_add_f32 v65, v65, v85
v_add_f32 v66, v66, v86
v_add_f32 v67, v67, v87
s_waitcnt lgkmcnt(1)
v_add_f32 v64, v64, v88
v_add_f32 v65, v65, v89
v_add_f32 v66, v66, v90
v_add_f32 v67, v67, v91
s_waitcnt lgkmcnt(0)
v_add_f32 v64, v64, v92
v_add_f32 v65, v65, v93
v_add_f32 v66, v66, v94
v_add_f32 v67, v67, v95
v_cvt_pk_bf16_f32 v64, v64, v65
v_cvt_pk_bf16_f32 v66, v66, v67
v_mov_b32 v65, s88
v_mov_b32 v67, s88
buffer_store_dwordx4 v[64:67], v194, s[44:47], 0 offen sc1
L_C_qdone:
s_barrier
v_lshlrev_b32 v9, 4, v1
s_lshl_b32 s62, s34, 13
v_add_u32 v9, s62, v9
s_mul_i32 s38, s34, 8448
s_mov_b32 s51, 4096
s_add_u32 s50, s38, 5120
s_waitcnt vmcnt(2)
s_add_u32 m0, s50, 0
s_nop 0
buffer_load_dwordx4 v9, s[40:43], 0 offen offset:0 nt lds
s_waitcnt vmcnt(2)
s_add_u32 m0, s50, 32
s_nop 0
buffer_load_dwordx4 v9, s[40:43], 0 offen offset:1024 nt lds
s_waitcnt vmcnt(2)
s_add_u32 m0, s50, 64
s_nop 0
buffer_load_dwordx4 v9, s[40:43], 0 offen offset:2048 nt lds
s_waitcnt vmcnt(2)
s_add_u32 m0, s50, 96
s_nop 0
buffer_load_dwordx4 v9, s[40:43], 0 offen offset:3072 nt lds
s_waitcnt vmcnt(2)
s_add_u32 m0, s50, 4224
s_nop 0
buffer_load_dwordx4 v9, s[40:43], s51 offen offset:0 nt lds
s_waitcnt vmcnt(2)
s_add_u32 m0, s50, 4256
s_nop 0
buffer_load_dwordx4 v9, s[40:43], s51 offen offset:1024 nt lds
s_waitcnt vmcnt(2)
s_add_u32 m0, s50, 4288
s_nop 0
buffer_load_dwordx4 v9, s[40:43], s51 offen offset:2048 nt lds
s_waitcnt vmcnt(2)
s_add_u32 m0, s50, 4320
s_nop 0
buffer_load_dwordx4 v9, s[40:43], s51 offen offset:3072 nt lds
v_add_u32 v9, 0x10000, v9
s_add_u32 s50, s38, 72704
s_waitcnt vmcnt(2)
s_add_u32 m0, s50, 0
s_nop 0
buffer_load_dwordx4 v9, s[40:43], 0 offen offset:0 nt lds
s_waitcnt vmcnt(2)
s_add_u32 m0, s50, 32
s_nop 0
buffer_load_dwordx4 v9, s[40:43], 0 offen offset:1024 nt lds
s_waitcnt vmcnt(2)
s_add_u32 m0, s50, 64
s_nop 0
buffer_load_dwordx4 v9, s[40:43], 0 offen offset:2048 nt lds
s_waitcnt vmcnt(2)
s_add_u32 m0, s50, 96
s_nop 0
buffer_load_dwordx4 v9, s[40:43], 0 offen offset:3072 nt lds
s_waitcnt vmcnt(2)
s_add_u32 m0, s50, 4224
s_nop 0
buffer_load_dwordx4 v9, s[40:43], s51 offen offset:0 nt lds
s_waitcnt vmcnt(2)
s_add_u32 m0, s50, 4256
s_nop 0
buffer_load_dwordx4 v9, s[40:43], s51 offen offset:1024 nt lds
s_waitcnt vmcnt(2)
s_add_u32 m0, s50, 4288
s_nop 0
buffer_load_dwordx4 v9, s[40:43], s51 offen offset:2048 nt lds
s_waitcnt vmcnt(2)
s_add_u32 m0, s50, 4320
s_nop 0
buffer_load_dwordx4 v9, s[40:43], s51 offen offset:3072 nt lds
v_add_u32 v9, 0x10000, v9
s_waitcnt vmcnt(2)
buffer_load_dwordx4 v[208:211], v9, s[40:43], 0 offen offset:0 nt
s_waitcnt vmcnt(2)
buffer_load_dwordx4 v[212:215], v9, s[40:43], 0 offen offset:1024 nt
s_waitcnt vmcnt(2)
buffer_load_dwordx4 v[216:219], v9, s[40:43], 0 offen offset:2048 nt
s_waitcnt vmcnt(2)
buffer_load_dwordx4 v[220:223], v9, s[40:43], 0 offen offset:3072 nt
s_waitcnt vmcnt(2)
buffer_load_dwordx4 v[224:227], v9, s[40:43], s51 offen offset:0 nt
s_waitcnt vmcnt(2)
buffer_load_dwordx4 v[228:231], v9, s[40:43], s51 offen offset:1024 nt
s_waitcnt vmcnt(2)
buffer_load_dwordx4 v[232:235], v9, s[40:43], s51 offen offset:2048 nt
s_waitcnt vmcnt(2)
buffer_load_dwordx4 v[236:239], v9, s[40:43], s51 offen offset:3072 nt
v_add_u32 v9, 0x10000, v9
s_add_u32 s62, s38, 5120
v_lshl_add_u32 v22, v1, 4, s62
s_lshl_b32 s62, s36, 4
v_add_u32 v240, s62, v2
v_mul_u32_u24 v10, 1056, v240
v_lshl_add_u32 v10, v3, 4, v10
v_add_u32 v10, 5120, v10
v_lshrrev_b32 v240, 1, v3
v_lshlrev_b32 v240, 3, v240
v_lshrrev_b32 v241, 2, v2
v_add_u32 v240, v240, v241
v_mul_u32_u24 v11, 1056, v240
v_and_b32 v240, 1, v3
v_lshl_add_u32 v11, v240, 5, v11
v_and_b32 v240, 3, v2
v_lshl_add_u32 v11, v240, 3, v11
s_lshl_b32 s62, s34, 7
s_add_u32 s62, s62, 5120
v_add_u32 v11, s62, v11
s_lshl_b32 s62, s37, 4
v_add_u32 v240, s62, v2
v_mul_u32_u24 v12, 144, v240
v_lshl_add_u32 v12, v3, 3, v12
s_lshl_b32 s62, s36, 5
v_add_u32 v12, s62, v12
v_lshlrev_b32 v15, 4, v240
s_lshl_b32 s62, s36, 2
v_add_u32 v14, s62, v15
v_and_b32 v240, 31, v1
v_mul_u32_u24 v13, 144, v240
v_lshrrev_b32 v241, 5, v1
v_lshl_add_u32 v13, v241, 4, v13
v_lshlrev_b32 v16, 4, v240
v_mov_b32 v17, 0x3e0293ee
v_mov_b32 v18, 0xff800000
v_mov_b32 v19, 0xff800000
v_mov_b32 v20, 0
v_mov_b32 v96, 0
v_mov_b32 v97, 0
v_mov_b32 v98, 0
v_mov_b32 v99, 0
v_mov_b32 v100, 0
v_mov_b32 v101, 0
v_mov_b32 v102, 0
v_mov_b32 v103, 0
v_mov_b32 v104, 0
v_mov_b32 v105, 0
v_mov_b32 v106, 0
v_mov_b32 v107, 0
v_mov_b32 v108, 0
v_mov_b32 v109, 0
v_mov_b32 v110, 0
v_mov_b32 v111, 0
v_mov_b32 v112, 0
v_mov_b32 v113, 0
v_mov_b32 v114, 0
v_mov_b32 v115, 0
v_mov_b32 v116, 0
v_mov_b32 v117, 0
v_mov_b32 v118, 0
v_mov_b32 v119, 0
v_mov_b32 v120, 0
v_mov_b32 v121, 0
v_mov_b32 v122, 0
v_mov_b32 v123, 0
v_mov_b32 v124, 0
v_mov_b32 v125, 0
v_mov_b32 v126, 0
v_mov_b32 v127, 0
s_cmp_lg_u32 s34, 0
s_cbranch_scc1 L_wc_Cq
s_lshl_b32 s62, s32, 8
s_add_u32 s62, s62, 0x1a000
v_lshl_add_u32 v240, v1, 2, s62
s_mov_b32 exec_hi, 0
s_mov_b32 s64, 0
L_tp_Cq:
buffer_load_dword v241, v240, s[44:47], 0 offen sc1
s_waitcnt vmcnt(0)
v_cmp_ne_u32 vcc, s88, v241
s_add_u32 s64, s64, 1
s_nop 0
s_or_b64 vcc, vcc, vcc
s_cbranch_scc0 L_tp_Cq_ok
s_sleep 16
s_cmp_lt_u32 s64, 65536
s_cbranch_scc1 L_tp_Cq
L_tp_Cq_ok:
s_mov_b64 exec, -1
L_wc_Cq:
s_barrier
s_lshl_b32 s62, s35, 5
s_lshl_b32 s63, s37, 4
s_add_u32 s62, s62, s63
v_add_u32 v240, s62, v2
v_lshlrev_b32 v240, 10, v240
v_lshl_add_u32 v240, v3, 4, v240
v_add_u32 v240, 0x0, v240
buffer_load_dwordx4 v[32:35], v240, s[44:47], 0 offen offset:0 sc1
buffer_load_dwordx4 v[36:39], v240, s[44:47], 0 offen offset:64 sc1
buffer_load_dwordx4 v[40:43], v240, s[44:47], 0 offen offset:128 sc1
buffer_load_dwordx4 v[44:47], v240, s[44:47], 0 offen offset:192 sc1
buffer_load_dwordx4 v[48:51], v240, s[44:47], 0 offen offset:256 sc1
buffer_load_dwordx4 v[52:55], v240, s[44:47], 0 offen offset:320 sc1
buffer_load_dwordx4 v[56:59], v240, s[44:47], 0 offen offset:384 sc1
buffer_load_dwordx4 v[60:63], v240, s[44:47], 0 offen offset:448 sc1
buffer_load_dwordx4 v[64:67], v240, s[44:47], 0 offen offset:512 sc1
buffer_load_dwordx4 v[68:71], v240, s[44:47], 0 offen offset:576 sc1
buffer_load_dwordx4 v[72:75], v240, s[44:47], 0 offen offset:640 sc1
buffer_load_dwordx4 v[76:79], v240, s[44:47], 0 offen offset:704 sc1
buffer_load_dwordx4 v[80:83], v240, s[44:47], 0 offen offset:768 sc1
buffer_load_dwordx4 v[84:87], v240, s[44:47], 0 offen offset:832 sc1
buffer_load_dwordx4 v[88:91], v240, s[44:47], 0 offen offset:896 sc1
buffer_load_dwordx4 v[92:95], v240, s[44:47], 0 offen offset:960 sc1
s_mov_b32 s39, 0
s_mov_b32 s48, 0
.p2align 6
L_C_loop:
s_cmp_lg_u32 s39, 0
s_cbranch_scc1 L_C_top
s_waitcnt vmcnt(0)
L_C_top:
s_waitcnt lgkmcnt(0)
s_barrier
s_mov_b32 s52, 1
s_cmp_eq_u32 s39, 0
s_cselect_b32 s52, 0, s52
s_cmp_ge_u32 s39, 7
s_cselect_b32 s52, 0, s52
s_sub_u32 s50, 67584, s48
v_add_u32 v23, s50, v22
s_cmp_eq_u32 s52, 0
s_cbranch_scc1 L_C_st0
s_waitcnt vmcnt(7)
ds_write_b128 v23, v[208:211] offset:0
buffer_load_dwordx4 v[208:211], v9, s[40:43], 0 offen offset:0 nt
s_waitcnt vmcnt(7)
ds_write_b128 v23, v[212:215] offset:1056
buffer_load_dwordx4 v[212:215], v9, s[40:43], 0 offen offset:1024 nt
L_C_st0:
v_add_u32 v240, s48, v10
v_add_u32 v241, s48, v11
ds_read_b128 v[128:131], v240 offset:0
ds_read_b128 v[132:135], v240 offset:64
ds_read_b128 v[136:139], v240 offset:128
ds_read_b128 v[140:143], v240 offset:192
ds_read_b128 v[144:147], v240 offset:256
ds_read_b128 v[148:151], v240 offset:320
ds_read_b128 v[152:155], v240 offset:384
ds_read_b128 v[156:159], v240 offset:448
ds_read_b128 v[160:163], v240 offset:512
ds_read_b128 v[164:167], v240 offset:576
ds_read_b128 v[168:171], v240 offset:640
ds_read_b128 v[172:175], v240 offset:704
ds_read_b128 v[176:179], v240 offset:768
ds_read_b128 v[180:183], v240 offset:832
ds_read_b128 v[184:187], v240 offset:896
ds_read_b128 v[188:191], v240 offset:960
s_waitcnt lgkmcnt(15)
v_mfma_f32_16x16x32_bf16 v[28:31], v[128:131], v[32:35], 0
s_waitcnt lgkmcnt(14)
v_mfma_f32_16x16x32_bf16 v[28:31], v[132:135], v[36:39], v[28:31]
s_waitcnt lgkmcnt(13)
v_mfma_f32_16x16x32_bf16 v[28:31], v[136:139], v[40:43], v[28:31]
s_waitcnt lgkmcnt(12)
v_mfma_f32_16x16x32_bf16 v[28:31], v[140:143], v[44:47], v[28:31]
s_waitcnt lgkmcnt(11)
v_mfma_f32_16x16x32_bf16 v[28:31], v[144:147], v[48:51], v[28:31]
s_waitcnt lgkmcnt(10)
v_mfma_f32_16x16x32_bf16 v[28:31], v[148:151], v[52:55], v[28:31]
s_waitcnt lgkmcnt(9)
v_mfma_f32_16x16x32_bf16 v[28:31], v[152:155], v[56:59], v[28:31]
s_waitcnt lgkmcnt(8)
v_mfma_f32_16x16x32_bf16 v[28:31], v[156:159], v[60:63], v[28:31]
s_waitcnt lgkmcnt(7)
v_mfma_f32_16x16x32_bf16 v[28:31], v[160:163], v[64:67], v[28:31]
s_waitcnt lgkmcnt(6)
v_mfma_f32_16x16x32_bf16 v[28:31], v[164:167], v[68:71], v[28:31]
s_waitcnt lgkmcnt(5)
v_mfma_f32_16x16x32_bf16 v[28:31], v[168:171], v[72:75], v[28:31]
s_waitcnt lgkmcnt(4)
v_mfma_f32_16x16x32_bf16 v[28:31], v[172:175], v[76:79], v[28:31]
s_waitcnt lgkmcnt(3)
v_mfma_f32_16x16x32_bf16 v[28:31], v[176:179], v[80:83], v[28:31]
s_waitcnt lgkmcnt(2)
v_mfma_f32_16x16x32_bf16 v[28:31], v[180:183], v[84:87], v[28:31]
s_waitcnt lgkmcnt(1)
v_mfma_f32_16x16x32_bf16 v[28:31], v[184:187], v[88:91], v[28:31]
s_waitcnt lgkmcnt(0)
v_mfma_f32_16x16x32_bf16 v[28:31], v[188:191], v[92:95], v[28:31]
s_cmp_eq_u32 s52, 0
s_cbranch_scc1 L_C_st1
s_waitcnt vmcnt(7)
ds_write_b128 v23, v[216:219] offset:2112
buffer_load_dwordx4 v[216:219], v9, s[40:43], 0 offen offset:2048 nt
s_waitcnt vmcnt(7)
ds_write_b128 v23, v[220:223] offset:3168
buffer_load_dwordx4 v[220:223], v9, s[40:43], 0 offen offset:3072 nt
L_C_st1:
s_nop 7
v_mul_f32 v24, v28, v17
v_mul_f32 v25, v29, v17
v_mul_f32 v26, v30, v17
v_mul_f32 v27, v31, v17
v_max3_f32 v242, v24, v25, v26
v_max_f32 v242, v242, v27
v_mov_b32 v243, v242
s_nop 1
v_permlane16_swap_b32 v242, v243
s_nop 0
v_max_f32 v242, v242, v243
v_mov_b32 v243, v242
s_nop 1
v_permlane32_swap_b32 v242, v243
s_nop 0
v_max_f32 v242, v242, v243
s_mov_b64 exec, 0xffff
ds_write_b32 v14, v242 offset:0
s_mov_b64 exec, -1
s_waitcnt lgkmcnt(0)
s_barrier
ds_read_b128 v[192:195], v15 offset:0
ds_read_b128 v[196:199], v16 offset:0
s_waitcnt lgkmcnt(1)
v_max3_f32 v242, v192, v193, v194
v_max3_f32 v242, v242, v195, v18
v_sub_f32 v21, v18, v242
v_sub_f32 v24, v24, v242
v_sub_f32 v25, v25, v242
v_sub_f32 v26, v26, v242
v_sub_f32 v27, v27, v242
v_exp_f32 v21, v21
v_exp_f32 v24, v24
v_exp_f32 v25, v25
v_exp_f32 v26, v26
v_exp_f32 v27, v27
v_mov_b32 v18, v242
v_cvt_pk_bf16_f32 v244, v24, v25
v_cvt_pk_bf16_f32 v245, v26, v27
ds_write_b64 v12, v[244:245] offset:512
v_add_f32 v24, v24, v25
v_add_f32 v26, v26, v27
v_fma_f32 v20, v20, v21, v24
v_add_f32 v20, v20, v26
s_waitcnt lgkmcnt(1)
v_max3_f32 v242, v196, v197, v198
v_max3_f32 v242, v242, v199, v19
v_sub_f32 v21, v19, v242
v_exp_f32 v21, v21
v_mov_b32 v19, v242
v_mul_f32 v96, v96, v21
v_mul_f32 v97, v97, v21
v_mul_f32 v98, v98, v21
v_mul_f32 v99, v99, v21
v_mul_f32 v100, v100, v21
v_mul_f32 v101, v101, v21
v_mul_f32 v102, v102, v21
v_mul_f32 v103, v103, v21
v_mul_f32 v104, v104, v21
v_mul_f32 v105, v105, v21
v_mul_f32 v106, v106, v21
v_mul_f32 v107, v107, v21
v_mul_f32 v108, v108, v21
v_mul_f32 v109, v109, v21
v_mul_f32 v110, v110, v21
v_mul_f32 v111, v111, v21
v_mul_f32 v112, v112, v21
v_mul_f32 v113, v113, v21
v_mul_f32 v114, v114, v21
v_mul_f32 v115, v115, v21
v_mul_f32 v116, v116, v21
v_mul_f32 v117, v117, v21
v_mul_f32 v118, v118, v21
v_mul_f32 v119, v119, v21
v_mul_f32 v120, v120, v21
v_mul_f32 v121, v121, v21
v_mul_f32 v122, v122, v21
v_mul_f32 v123, v123, v21
v_mul_f32 v124, v124, v21
v_mul_f32 v125, v125, v21
v_mul_f32 v126, v126, v21
v_mul_f32 v127, v127, v21
s_cmp_eq_u32 s52, 0
s_cbranch_scc1 L_C_st2
s_waitcnt vmcnt(7)
ds_write_b128 v23, v[224:227] offset:4224
buffer_load_dwordx4 v[224:227], v9, s[40:43], s51 offen offset:0 nt
s_waitcnt vmcnt(7)
ds_write_b128 v23, v[228:231] offset:5280
buffer_load_dwordx4 v[228:231], v9, s[40:43], s51 offen offset:1024 nt
L_C_st2:
s_waitcnt lgkmcnt(0)
s_barrier
ds_read_b128 v[192:195], v13 offset:512
ds_read_b128 v[196:199], v13 offset:544
ds_read_b128 v[200:203], v13 offset:576
ds_read_b128 v[204:207], v13 offset:608
ds_read_b64_tr_b16 v[128:129], v241 offset:0
ds_read_b64_tr_b16 v[130:131], v241 offset:4224
ds_read_b64_tr_b16 v[132:133], v241 offset:64
ds_read_b64_tr_b16 v[134:135], v241 offset:4288
ds_read_b64_tr_b16 v[136:137], v241 offset:16896
ds_read_b64_tr_b16 v[138:139], v241 offset:21120
ds_read_b64_tr_b16 v[140:141], v241 offset:16960
ds_read_b64_tr_b16 v[142:143], v241 offset:21184
ds_read_b64_tr_b16 v[144:145], v241 offset:33792
ds_read_b64_tr_b16 v[146:147], v241 offset:38016
ds_read_b64_tr_b16 v[148:149], v241 offset:33856
ds_read_b64_tr_b16 v[150:151], v241 offset:38080
ds_read_b64_tr_b16 v[152:153], v241 offset:50688
ds_read_b64_tr_b16 v[154:155], v241 offset:54912
ds_read_b64_tr_b16 v[156:157], v241 offset:50752
ds_read_b64_tr_b16 v[158:159], v241 offset:54976
s_waitcnt lgkmcnt(12)
v_mfma_f32_32x32x16_bf16 v[96:111], v[128:131], v[192:195], v[96:111]
v_mfma_f32_32x32x16_bf16 v[112:127], v[132:135], v[192:195], v[112:127]
s_waitcnt lgkmcnt(8)
v_mfma_f32_32x32x16_bf16 v[96:111], v[136:139], v[196:199], v[96:111]
v_mfma_f32_32x32x16_bf16 v[112:127], v[140:143], v[196:199], v[112:127]
s_waitcnt lgkmcnt(4)
v_mfma_f32_32x32x16_bf16 v[96:111], v[144:147], v[200:203], v[96:111]
v_mfma_f32_32x32x16_bf16 v[112:127], v[148:151], v[200:203], v[112:127]
s_waitcnt lgkmcnt(0)
v_mfma_f32_32x32x16_bf16 v[96:111], v[152:155], v[204:207], v[96:111]
v_mfma_f32_32x32x16_bf16 v[112:127], v[156:159], v[204:207], v[112:127]
s_cmp_eq_u32 s52, 0
s_cbranch_scc1 L_C_st3
s_waitcnt vmcnt(7)
ds_write_b128 v23, v[232:235] offset:6336
buffer_load_dwordx4 v[232:235], v9, s[40:43], s51 offen offset:2048 nt
s_waitcnt vmcnt(7)
ds_write_b128 v23, v[236:239] offset:7392
buffer_load_dwordx4 v[236:239], v9, s[40:43], s51 offen offset:3072 nt
v_add_u32 v9, 0x10000, v9
L_C_st3:
s_sub_u32 s48, 67584, s48
s_add_u32 s39, s39, 1
s_cmp_lt_u32 s39, 8
s_cbranch_scc1 L_C_loop
v_mov_b32 v243, v20
s_nop 1
v_permlane16_swap_b32 v20, v243
s_nop 0
v_add_f32 v20, v20, v243
v_mov_b32 v243, v20
s_nop 1
v_permlane32_swap_b32 v20, v243
s_nop 0
v_add_f32 v20, v20, v243
s_barrier
s_mov_b64 exec, 0xffff
ds_write_b32 v14, v20 offset:0
s_mov_b64 exec, -1
v_and_b32 v240, 31, v1
v_mul_u32_u24 v240, 2064, v240
v_lshrrev_b32 v241, 5, v1
v_lshl_add_u32 v240, v241, 4, v240
s_lshl_b32 s62, s34, 8
s_add_u32 s62, s62, 5120
v_add_u32 v240, s62, v240
s_nop 5
ds_write_b128 v240, v[96:99] offset:0
ds_write_b128 v240, v[100:103] offset:32
ds_write_b128 v240, v[104:107] offset:64
ds_write_b128 v240, v[108:111] offset:96
ds_write_b128 v240, v[112:115] offset:128
ds_write_b128 v240, v[116:119] offset:160
ds_write_b128 v240, v[120:123] offset:192
ds_write_b128 v240, v[124:127] offset:224
s_waitcnt lgkmcnt(0)
s_barrier
s_mul_i32 s62, s34, 8256
s_add_u32 s62, s62, 5120
v_lshl_add_u32 v240, v1, 5, s62
ds_read_b128 v[128:131], v240 offset:0
ds_read_b128 v[132:135], v240 offset:16
ds_read_b128 v[136:139], v240 offset:2064
ds_read_b128 v[140:143], v240 offset:2080
ds_read_b128 v[144:147], v240 offset:4128
ds_read_b128 v[148:151], v240 offset:4144
ds_read_b128 v[152:155], v240 offset:6192
ds_read_b128 v[156:159], v240 offset:6208
s_lshl_b32 s62, s35, 5
s_lshl_b32 s63, s34, 2
s_add_u32 s62, s62, s63
s_lshl_b32 s62, s62, 4
s_and_b32 s63, s32, 15
s_add_u32 s62, s62, s63
s_lshl_b32 s62, s62, 10
s_add_u32 s62, s62, 0x200000
v_lshl_add_u32 v241, v1, 4, s62
s_waitcnt lgkmcnt(6)
v_cvt_pk_bf16_f32 v160, v128, v129
v_cvt_pk_bf16_f32 v161, v130, v131
v_cvt_pk_bf16_f32 v162, v132, v133
v_cvt_pk_bf16_f32 v163, v134, v135
s_mov_b32 s63, 0
buffer_store_dwordx4 v[160:163], v241, s[44:47], s63 offen sc1
s_waitcnt lgkmcnt(4)
v_cvt_pk_bf16_f32 v164, v136, v137
v_cvt_pk_bf16_f32 v165, v138, v139
v_cvt_pk_bf16_f32 v166, v140, v141
v_cvt_pk_bf16_f32 v167, v142, v143
s_mov_b32 s63, 16384
buffer_store_dwordx4 v[164:167], v241, s[44:47], s63 offen sc1
s_waitcnt lgkmcnt(2)
v_cvt_pk_bf16_f32 v168, v144, v145
v_cvt_pk_bf16_f32 v169, v146, v147
v_cvt_pk_bf16_f32 v170, v148, v149
v_cvt_pk_bf16_f32 v171, v150, v151
s_mov_b32 s63, 32768
buffer_store_dwordx4 v[168:171], v241, s[44:47], s63 offen sc1
s_waitcnt lgkmcnt(0)
v_cvt_pk_bf16_f32 v172, v152, v153
v_cvt_pk_bf16_f32 v173, v154, v155
v_cvt_pk_bf16_f32 v174, v156, v157
v_cvt_pk_bf16_f32 v175, v158, v159
s_mov_b32 s63, 49152
buffer_store_dwordx4 v[172:175], v241, s[44:47], s63 offen sc1
ds_read_b128 v[192:195], v16 offset:0
v_and_b32 v240, 31, v1
s_lshl_b32 s63, s32, 4
s_add_u32 s63, s63, 0x10000
v_lshl_add_u32 v240, v240, 9, s63
s_waitcnt lgkmcnt(0)
v_add_f32 v192, v192, v193
v_add_f32 v194, v194, v195
v_add_f32 v194, v192, v194
v_mov_b32 v192, v19
v_mov_b32 v193, s88
v_mov_b32 v195, s88
s_waitcnt vmcnt(0)
s_barrier
s_cmp_lg_u32 s34, 0
s_cbranch_scc1 L_C_done
s_mov_b32 exec_hi, 0
buffer_store_dwordx4 v[192:195], v240, s[44:47], 0 offen sc1
s_mov_b64 exec, -1
s_cmp_ge_u32 s32, 8
s_cbranch_scc1 L_C_done
s_and_b32 s63, s32, 7
s_lshl_b32 s63, s63, 8
s_add_u32 s63, s63, 0xc0000
s_add_u32 s56, s30, s63
s_addc_u32 s57, s31, 0
s_mov_b32 s64, 0
s_mov_b32 s59, 0
s_lshl_b32 s62, s32, 8
s_add_u32 s62, s62, 0xc1000
v_lshl_add_u32 v132, v1, 4, s62
s_mov_b32 s62, 0xc1000
v_lshl_add_u32 v133, v1, 8, s62
v_lshlrev_b32 v134, 2, v1
v_mov_b32 v135, 96
L_gm_C:
s_mov_b64 exec, 0x1ffffff
global_load_dword v136, v134, s[56:57] nt
s_waitcnt vmcnt(0)
v_subrev_u32 v136, s88, v136
s_mov_b64 exec, 0xffffff
v_cmp_le_u32 vcc, 0x400, v136
v_readlane_b32 s62, v136, 24
v_add_u32_dpp v136, v136, v136 row_shr:1 row_mask:0xf bank_mask:0xf bound_ctrl:0
s_nop 1
v_add_u32_dpp v136, v136, v136 row_shr:2 row_mask:0xf bank_mask:0xf bound_ctrl:0
s_nop 1
v_add_u32_dpp v136, v136, v136 row_shr:4 row_mask:0xf bank_mask:0xf bound_ctrl:0
s_nop 1
v_add_u32_dpp v136, v136, v136 row_shr:8 row_mask:0xf bank_mask:0xf bound_ctrl:0
s_nop 0
v_readlane_b32 s61, v136, 15
v_readlane_b32 s63, v136, 23
s_add_u32 s61, s61, s63
s_mov_b64 exec, 0xff
s_cbranch_vccnz L_gm_C_x
s_add_u32 s63, s61, s88
v_mov_b32 v128, s63
v_mov_b32 v129, s63
v_mov_b32 v130, s63
v_mov_b32 v131, s63
global_store_dwordx4 v132, v[128:131], s[30:31] sc1
global_load_dword v137, v133, s[30:31] sc1
s_mul_i32 s63, s61, 4
s_mul_i32 s65, s59, 4
s_add_u32 s65, s65, s63
s_cmp_eq_u32 s59, 0
s_mov_b32 s59, s61
s_waitcnt vmcnt(0)
s_cbranch_scc1 L_gm_C_next
v_subrev_u32 v137, s88, v137
v_cmp_le_u32 vcc, 0x8000, v137
s_nop 0
v_add_u32_dpp v137, v137, v137 row_shr:1 row_mask:0xf bank_mask:0xf bound_ctrl:0
s_nop 1
v_add_u32_dpp v137, v137, v137 row_shr:2 row_mask:0xf bank_mask:0xf bound_ctrl:0
s_nop 1
v_add_u32_dpp v137, v137, v137 row_shr:4 row_mask:0xf bank_mask:0xf bound_ctrl:0
s_cbranch_vccnz L_gm_C_next
s_nop 0
v_readlane_b32 s63, v137, 7
s_sub_u32 s63, s63, s65
s_ashr_i32 s63, s63, 3
s_add_u32 s63, s63, 0x4000
s_add_u32 s63, s63, s88
v_mov_b32 v138, s63
global_store_dword v135, v138, s[56:57]
L_gm_C_next:
s_cmp_ge_u32 s61, 14400
s_cbranch_scc1 L_gm_C_x
s_add_u32 s64, s64, 1
s_cmp_lt_u32 s64, 64
s_cbranch_scc1 L_gm_C
L_gm_C_x:
s_mov_b64 exec, -1
L_C_done:
s_endpgm
L_exit:
s_endpgm
.section .rodata,"a"
.p2align 6
.amdhsa_kernel concat_heads__gqa_block_cached__compressed_kv_cla__decode_kernel
  .amdhsa_next_free_vgpr 256
  .amdhsa_next_free_sgpr 102
  .amdhsa_accum_offset 256
  .amdhsa_group_segment_fixed_size 0
  .amdhsa_kernarg_size 112
  .amdhsa_user_sgpr_count 2
  .amdhsa_user_sgpr_kernarg_segment_ptr 1
  .amdhsa_system_sgpr_workgroup_id_x 1
.end_amdhsa_kernel
```

```asm
; @launch grid=(256,1,1) block=(512,1,1) lds=153600
.amdgcn_target "amdgcn-amd-amdhsa--gfx950"
.text
.globl concat_heads__gqa_block_cached__compressed_kv_cla__decode_kernel
.p2align 8
.type concat_heads__gqa_block_cached__compressed_kv_cla__decode_kernel,@function
concat_heads__gqa_block_cached__compressed_kv_cla__decode_kernel:
s_cmp_ge_u32 s2, 256
s_cbranch_scc1 L_exit
s_load_dwordx16 s[4:19], s[0:1], 0
s_load_dwordx8 s[20:27], s[0:1], 64
s_load_dwordx4 s[28:31], s[0:1], 96
v_lshrrev_b32 v8, 6, v0
s_add_u32 s60, s2, 0
s_and_b32 s60, s60, 7
s_lshr_b32 s61, s2, 3
v_readfirstlane_b32 s34, v8
s_and_b32 s33, s61, 7
s_lshr_b32 s61, s61, 3
s_lshl_b32 s61, s61, 3
s_add_u32 s32, s60, s61
v_and_b32 v1, 63, v0
v_and_b32 v2, 15, v0
v_bfe_u32 v3, v0, 4, 2
v_and_b32 v8, 1, v0
v_lshlrev_b32 v8, 4, v8
v_mov_b32 v9, 0xffff
v_lshlrev_b32 v8, v8, v9
v_bfe_u32 v9, v0, 1, 2
v_cmp_eq_u32 vcc, 0, v9
s_nop 1
v_cndmask_b32 v4, 0, v8, vcc
v_cmp_eq_u32 vcc, 1, v9
s_nop 1
v_cndmask_b32 v5, 0, v8, vcc
v_cmp_eq_u32 vcc, 2, v9
s_nop 1
v_cndmask_b32 v6, 0, v8, vcc
v_cmp_eq_u32 vcc, 3, v9
s_nop 1
v_cndmask_b32 v7, 0, v8, vcc
s_waitcnt lgkmcnt(0)
s_cmp_eq_u32 s33, 6
s_cbranch_scc1 L_roleW
s_cmp_eq_u32 s33, 7
s_cbranch_scc1 L_roleC
L_roleA:
s_cmp_ge_u32 s34, 4
s_cbranch_scc1 L_A_helper
s_lshl_b32 s62, s32, 21
s_sub_u32 s63, 0x8000000, s62
s_add_u32 s40, s6, s62
s_addc_u32 s41, s7, 0
s_and_b32 s41, s41, 0xffff
s_mov_b32 s42, s63
s_mov_b32 s43, 0x20000
s_lshl_b32 s35, s33, 2
s_add_u32 s35, s35, s34
s_lshl_b32 s35, s35, 12
s_mov_b32 s36, s35
v_lshlrev_b32 v8, 4, v1
v_add_u32 v9, 0x4000000, v8
s_lshr_b32 s54, s35, 12
s_mov_b32 s57, 0xff
s_sub_u32 s55, s54, 8
s_cselect_b32 s60, 24, 0
s_add_u32 s55, s55, s60
s_sub_u32 s56, s55, 8
s_cselect_b32 s60, 24, 0
s_add_u32 s56, s56, s60
v_lshlrev_b32 v61, 4, v2
v_lshl_add_u32 v61, v3, 13, v61
s_lshl_b32 s60, s32, 8
s_sub_u32 s61, 0x400000, s60
s_add_u32 s68, s18, s60
s_addc_u32 s69, s19, 0
s_and_b32 s69, s69, 0xffff
s_mov_b32 s70, s61
s_mov_b32 s71, 0x20000
s_lshr_b32 s58, s54, 2
s_min_u32 s60, s58, 2
s_mul_i32 s59, s58, 5
s_add_u32 s59, s59, s60
s_lshl_b32 s59, s59, 2
s_add_u32 s59, s59, s34
s_lshr_b32 s60, s59, 1
s_xor_b32 s60, s60, s59
s_and_b32 s60, s60, 16
s_mul_i32 s60, s60, 3
s_xor_b32 s60, s60, s59
s_lshl_b32 s39, s60, 15
buffer_load_dwordx4 v[128:131], v61, s[68:71], s39 offen
s_add_u32 s59, s59, 4
s_lshr_b32 s60, s59, 1
s_xor_b32 s60, s60, s59
s_and_b32 s60, s60, 16
s_mul_i32 s60, s60, 3
s_xor_b32 s60, s60, s59
s_lshl_b32 s39, s60, 15
buffer_load_dwordx4 v[132:135], v61, s[68:71], s39 offen
s_add_u32 s59, s59, 4
s_lshr_b32 s60, s59, 1
s_xor_b32 s60, s60, s59
s_and_b32 s60, s60, 16
s_mul_i32 s60, s60, 3
s_xor_b32 s60, s60, s59
s_lshl_b32 s39, s60, 15
buffer_load_dwordx4 v[136:139], v61, s[68:71], s39 offen
s_add_u32 s59, s59, 4
s_lshr_b32 s60, s59, 1
s_xor_b32 s60, s60, s59
s_and_b32 s60, s60, 16
s_mul_i32 s60, s60, 3
s_xor_b32 s60, s60, s59
s_lshl_b32 s39, s60, 15
buffer_load_dwordx4 v[140:143], v61, s[68:71], s39 offen
s_add_u32 s59, s59, 4
s_lshr_b32 s60, s59, 1
s_xor_b32 s60, s60, s59
s_and_b32 s60, s60, 16
s_mul_i32 s60, s60, 3
s_xor_b32 s60, s60, s59
s_lshl_b32 s39, s60, 15
buffer_load_dwordx4 v[144:147], v61, s[68:71], s39 offen
s_add_u32 s59, s59, 4
s_cmp_lt_u32 s58, 2
s_cselect_b32 s59, s59, 128
s_lshr_b32 s60, s59, 1
s_xor_b32 s60, s60, s59
s_and_b32 s60, s60, 16
s_mul_i32 s60, s60, 3
s_xor_b32 s60, s60, s59
s_lshl_b32 s39, s60, 15
buffer_load_dwordx4 v[148:151], v61, s[68:71], s39 offen
s_lshl_b32 s60, s32, 8
s_sub_u32 s61, 0x400000, s60
s_add_u32 s72, s20, s60
s_addc_u32 s73, s21, 0
s_and_b32 s73, s73, 0xffff
s_mov_b32 s74, s61
s_mov_b32 s75, 0x20000
s_lshr_b32 s58, s55, 2
s_min_u32 s60, s58, 2
s_mul_i32 s59, s58, 5
s_add_u32 s59, s59, s60
s_lshl_b32 s59, s59, 2
s_add_u32 s59, s59, s34
s_lshr_b32 s60, s59, 1
s_xor_b32 s60, s60, s59
s_and_b32 s60, s60, 16
s_mul_i32 s60, s60, 3
s_xor_b32 s60, s60, s59
s_lshl_b32 s39, s60, 15
buffer_load_dwordx4 v[152:155], v61, s[72:75], s39 offen
s_add_u32 s59, s59, 4
s_lshr_b32 s60, s59, 1
s_xor_b32 s60, s60, s59
s_and_b32 s60, s60, 16
s_mul_i32 s60, s60, 3
s_xor_b32 s60, s60, s59
s_lshl_b32 s39, s60, 15
buffer_load_dwordx4 v[156:159], v61, s[72:75], s39 offen
s_lshl_b32 s62, s32, 21
s_sub_u32 s63, 0x8000000, s62
s_add_u32 s44, s8, s62
s_addc_u32 s45, s9, 0
s_and_b32 s45, s45, 0xffff
s_mov_b32 s46, s63
s_mov_b32 s47, 0x20000
s_mul_i32 s60, s34, 6
s_add_u32 s60, s60, s33
s_lshl_b32 s37, s60, 10
s_add_u32 s37, s37, 0x1f8000
s_mov_b32 s52, 0x555f
s_cmp_lt_u32 s60, 8
s_cselect_b32 s61, 0, 1
s_cselect_b32 s62, 0x200, 0
s_or_b32 s52, s52, s62
s_lshl_b32 s61, s61, 31
s_add_u32 s61, s61, 24576
v_add_u32 v10, s61, v8
s_sub_u32 s60, s60, 8
s_cmp_lt_u32 s60, 8
s_cselect_b32 s61, 0, 1
s_cselect_b32 s62, 0x800, 0
s_or_b32 s52, s52, s62
s_lshl_b32 s61, s61, 31
s_add_u32 s61, s61, 16384
v_add_u32 v11, s61, v9
s_mul_i32 s52, s52, 0x10001
s_mov_b32 s53, s52
s_mov_b32 s48, 0xcccccccc
s_mov_b32 s49, 0xcccccccc
s_mov_b32 s50, 0xaaaaaaaa
s_mov_b32 s51, 0xaaaaaaaa
v_cmp_gt_u32 vcc, 8, v2
v_mov_b32 v47, 0
v_mov_b32 v48, 0
v_mov_b32 v49, 0
v_mov_b32 v50, 0
v_mov_b32 v51, 0
v_cndmask_b32 v12, v4, v47, vcc
v_cndmask_b32 v13, v5, v47, vcc
v_cndmask_b32 v14, v6, v47, vcc
v_cndmask_b32 v15, v7, v47, vcc
v_cndmask_b32 v4, v47, v4, vcc
v_cndmask_b32 v5, v47, v5, vcc
v_cndmask_b32 v6, v47, v6, vcc
v_cndmask_b32 v7, v47, v7, vcc
v_lshlrev_b32 v192, 2, v1
v_mov_b32 v193, 1
s_mov_b64 vcc, 0
s_barrier
s_waitcnt vmcnt(7)
s_add_u32 s59, s59, 4
s_lshr_b32 s60, s59, 1
s_xor_b32 s60, s60, s59
s_and_b32 s60, s60, 16
s_mul_i32 s60, s60, 3
s_xor_b32 s60, s60, s59
s_lshl_b32 s39, s60, 15
buffer_load_dwordx4 v[128:131], v61, s[72:75], s39 offen
s_waitcnt vmcnt(7)
s_add_u32 s59, s59, 4
s_lshr_b32 s60, s59, 1
s_xor_b32 s60, s60, s59
s_and_b32 s60, s60, 16
s_mul_i32 s60, s60, 3
s_xor_b32 s60, s60, s59
s_lshl_b32 s39, s60, 15
buffer_load_dwordx4 v[132:135], v61, s[72:75], s39 offen
s_waitcnt vmcnt(7)
s_add_u32 s59, s59, 4
s_lshr_b32 s60, s59, 1
s_xor_b32 s60, s60, s59
s_and_b32 s60, s60, 16
s_mul_i32 s60, s60, 3
s_xor_b32 s60, s60, s59
s_lshl_b32 s39, s60, 15
buffer_load_dwordx4 v[136:139], v61, s[72:75], s39 offen
s_waitcnt vmcnt(7)
s_add_u32 s59, s59, 4
s_cmp_lt_u32 s58, 2
s_cselect_b32 s59, s59, 128
s_lshr_b32 s60, s59, 1
s_xor_b32 s60, s60, s59
s_and_b32 s60, s60, 16
s_mul_i32 s60, s60, 3
s_xor_b32 s60, s60, s59
s_lshl_b32 s39, s60, 15
buffer_load_dwordx4 v[140:143], v61, s[72:75], s39 offen
s_waitcnt vmcnt(7)
s_lshl_b32 s60, s32, 8
s_sub_u32 s61, 0x400000, s60
s_add_u32 s76, s10, s60
s_addc_u32 s77, s11, 0
s_and_b32 s77, s77, 0xffff
s_mov_b32 s78, s61
s_mov_b32 s79, 0x20000
s_lshr_b32 s58, s56, 2
s_min_u32 s60, s58, 2
s_mul_i32 s59, s58, 5
s_add_u32 s59, s59, s60
s_lshl_b32 s59, s59, 2
s_add_u32 s59, s59, s34
s_lshr_b32 s60, s59, 1
s_xor_b32 s60, s60, s59
s_and_b32 s60, s60, 16
s_mul_i32 s60, s60, 3
s_xor_b32 s60, s60, s59
s_lshl_b32 s39, s60, 15
buffer_load_dwordx4 v[144:147], v61, s[76:79], s39 offen
s_waitcnt vmcnt(7)
s_add_u32 s59, s59, 4
s_lshr_b32 s60, s59, 1
s_xor_b32 s60, s60, s59
s_and_b32 s60, s60, 16
s_mul_i32 s60, s60, 3
s_xor_b32 s60, s60, s59
s_lshl_b32 s39, s60, 15
buffer_load_dwordx4 v[148:151], v61, s[76:79], s39 offen
s_waitcnt vmcnt(7)
s_add_u32 s59, s59, 4
s_lshr_b32 s60, s59, 1
s_xor_b32 s60, s60, s59
s_and_b32 s60, s60, 16
s_mul_i32 s60, s60, 3
s_xor_b32 s60, s60, s59
s_lshl_b32 s39, s60, 15
buffer_load_dwordx4 v[152:155], v61, s[76:79], s39 offen
s_waitcnt vmcnt(7)
s_add_u32 s59, s59, 4
s_lshr_b32 s60, s59, 1
s_xor_b32 s60, s60, s59
s_and_b32 s60, s60, 16
s_mul_i32 s60, s60, 3
s_xor_b32 s60, s60, s59
s_lshl_b32 s39, s60, 15
buffer_load_dwordx4 v[156:159], v61, s[76:79], s39 offen
s_waitcnt vmcnt(7)
s_add_u32 s59, s59, 4
s_lshr_b32 s60, s59, 1
s_xor_b32 s60, s60, s59
s_and_b32 s60, s60, 16
s_mul_i32 s60, s60, 3
s_xor_b32 s60, s60, s59
s_lshl_b32 s39, s60, 15
buffer_load_dwordx4 v[128:131], v61, s[76:79], s39 offen
s_waitcnt vmcnt(7)
s_add_u32 s59, s59, 4
s_cmp_lt_u32 s58, 2
s_cselect_b32 s59, s59, 128
s_lshr_b32 s60, s59, 1
s_xor_b32 s60, s60, s59
s_and_b32 s60, s60, 16
s_mul_i32 s60, s60, 3
s_xor_b32 s60, s60, s59
s_lshl_b32 s39, s60, 15
buffer_load_dwordx4 v[132:135], v61, s[76:79], s39 offen
s_waitcnt vmcnt(7)
s_lshl_b32 s60, s32, 8
s_sub_u32 s61, 0x400000, s60
s_add_u32 s80, s22, s60
s_addc_u32 s81, s23, 0
s_and_b32 s81, s81, 0xffff
s_mov_b32 s82, s61
s_mov_b32 s83, 0x20000
s_lshr_b32 s58, s54, 2
s_min_u32 s60, s58, 2
s_mul_i32 s59, s58, 5
s_add_u32 s59, s59, s60
s_lshl_b32 s59, s59, 2
s_add_u32 s59, s59, s34
s_lshr_b32 s60, s59, 1
s_xor_b32 s60, s60, s59
s_and_b32 s60, s60, 16
s_mul_i32 s60, s60, 3
s_xor_b32 s60, s60, s59
s_lshl_b32 s39, s60, 15
buffer_load_dwordx4 v[136:139], v61, s[80:83], s39 offen
s_waitcnt vmcnt(7)
s_add_u32 s59, s59, 4
s_lshr_b32 s60, s59, 1
s_xor_b32 s60, s60, s59
s_and_b32 s60, s60, 16
s_mul_i32 s60, s60, 3
s_xor_b32 s60, s60, s59
s_lshl_b32 s39, s60, 15
buffer_load_dwordx4 v[140:143], v61, s[80:83], s39 offen
s_waitcnt vmcnt(7)
s_add_u32 s59, s59, 4
s_lshr_b32 s60, s59, 1
s_xor_b32 s60, s60, s59
s_and_b32 s60, s60, 16
s_mul_i32 s60, s60, 3
s_xor_b32 s60, s60, s59
s_lshl_b32 s39, s60, 15
buffer_load_dwordx4 v[144:147], v61, s[80:83], s39 offen
s_waitcnt vmcnt(7)
s_add_u32 s59, s59, 4
s_lshr_b32 s60, s59, 1
s_xor_b32 s60, s60, s59
s_and_b32 s60, s60, 16
s_mul_i32 s60, s60, 3
s_xor_b32 s60, s60, s59
s_lshl_b32 s39, s60, 15
buffer_load_dwordx4 v[148:151], v61, s[80:83], s39 offen
s_waitcnt vmcnt(7)
s_add_u32 s59, s59, 4
s_lshr_b32 s60, s59, 1
s_xor_b32 s60, s60, s59
s_and_b32 s60, s60, 16
s_mul_i32 s60, s60, 3
s_xor_b32 s60, s60, s59
s_lshl_b32 s39, s60, 15
buffer_load_dwordx4 v[152:155], v61, s[80:83], s39 offen
s_waitcnt vmcnt(7)
s_add_u32 s59, s59, 4
s_cmp_lt_u32 s58, 2
s_cselect_b32 s59, s59, 128
s_lshr_b32 s60, s59, 1
s_xor_b32 s60, s60, s59
s_and_b32 s60, s60, 16
s_mul_i32 s60, s60, 3
s_xor_b32 s60, s60, s59
s_lshl_b32 s39, s60, 15
buffer_load_dwordx4 v[156:159], v61, s[80:83], s39 offen
s_waitcnt vmcnt(7)
s_lshl_b32 s60, s32, 17
s_mov_b32 s61, 0x20000
s_add_u32 s68, s24, s60
s_addc_u32 s69, s25, 0
s_and_b32 s69, s69, 0xffff
s_mov_b32 s70, s61
s_mov_b32 s71, 0x20000
s_lshr_b32 s58, s55, 2
s_min_u32 s60, s58, 2
s_mul_i32 s59, s58, 5
s_add_u32 s59, s59, s60
s_lshl_b32 s59, s59, 2
s_add_u32 s59, s59, s34
s_lshl_b32 s39, s59, 10
buffer_load_dwordx4 v[128:131], v8, s[68:71], s39 offen
s_waitcnt vmcnt(7)
s_add_u32 s59, s59, 4
s_lshl_b32 s39, s59, 10
buffer_load_dwordx4 v[132:135], v8, s[68:71], s39 offen
s_waitcnt vmcnt(7)
s_add_u32 s59, s59, 4
s_lshl_b32 s39, s59, 10
buffer_load_dwordx4 v[136:139], v8, s[68:71], s39 offen
s_waitcnt vmcnt(7)
s_add_u32 s59, s59, 4
s_lshl_b32 s39, s59, 10
buffer_load_dwordx4 v[140:143], v8, s[68:71], s39 offen
s_waitcnt vmcnt(7)
s_add_u32 s59, s59, 4
s_lshl_b32 s39, s59, 10
buffer_load_dwordx4 v[144:147], v8, s[68:71], s39 offen
s_waitcnt vmcnt(7)
s_add_u32 s59, s59, 4
s_cmp_lt_u32 s58, 2
s_cselect_b32 s59, s59, 128
s_lshl_b32 s39, s59, 10
buffer_load_dwordx4 v[148:151], v8, s[68:71], s39 offen
s_waitcnt vmcnt(7)
s_lshl_b32 s60, s32, 19
s_add_u32 s60, s60, 0x30000
s_mov_b32 s61, 0x50000
s_add_u32 s72, s16, s60
s_addc_u32 s73, s17, 0
s_and_b32 s73, s73, 0xffff
s_mov_b32 s74, s61
s_mov_b32 s75, 0x20000
s_lshr_b32 s58, s56, 2
s_min_u32 s60, s58, 2
s_mul_i32 s59, s58, 13
s_add_u32 s59, s59, s60
s_lshl_b32 s59, s59, 2
s_add_u32 s59, s59, s34
s_lshl_b32 s39, s59, 10
buffer_load_dwordx4 v[152:155], v8, s[72:75], s39 offen
s_waitcnt vmcnt(7)
s_add_u32 s59, s59, 4
s_lshl_b32 s39, s59, 10
buffer_load_dwordx4 v[156:159], v8, s[72:75], s39 offen
s_waitcnt vmcnt(7)
s_add_u32 s59, s59, 4
s_lshl_b32 s39, s59, 10
buffer_load_dwordx4 v[128:131], v8, s[72:75], s39 offen
s_waitcnt vmcnt(7)
s_add_u32 s59, s59, 4
s_lshl_b32 s39, s59, 10
buffer_load_dwordx4 v[132:135], v8, s[72:75], s39 offen
s_waitcnt vmcnt(7)
s_add_u32 s59, s59, 4
s_lshl_b32 s39, s59, 10
buffer_load_dwordx4 v[136:139], v8, s[72:75], s39 offen
s_waitcnt vmcnt(7)
s_add_u32 s59, s59, 4
s_lshl_b32 s39, s59, 10
buffer_load_dwordx4 v[140:143], v8, s[72:75], s39 offen
s_waitcnt vmcnt(7)
s_add_u32 s59, s59, 4
s_lshl_b32 s39, s59, 10
buffer_load_dwordx4 v[144:147], v8, s[72:75], s39 offen
s_waitcnt vmcnt(7)
s_add_u32 s59, s59, 4
s_lshl_b32 s39, s59, 10
buffer_load_dwordx4 v[148:151], v8, s[72:75], s39 offen
s_waitcnt vmcnt(7)
s_add_u32 s59, s59, 4
s_lshl_b32 s39, s59, 10
buffer_load_dwordx4 v[152:155], v8, s[72:75], s39 offen
s_waitcnt vmcnt(7)
s_add_u32 s59, s59, 4
s_lshl_b32 s39, s59, 10
buffer_load_dwordx4 v[156:159], v8, s[72:75], s39 offen
s_waitcnt vmcnt(7)
s_add_u32 s59, s59, 4
s_lshl_b32 s39, s59, 10
buffer_load_dwordx4 v[128:131], v8, s[72:75], s39 offen
s_waitcnt vmcnt(7)
s_add_u32 s59, s59, 4
s_lshl_b32 s39, s59, 10
buffer_load_dwordx4 v[132:135], v8, s[72:75], s39 offen
s_waitcnt vmcnt(7)
s_add_u32 s59, s59, 4
s_lshl_b32 s39, s59, 10
buffer_load_dwordx4 v[136:139], v8, s[72:75], s39 offen
s_waitcnt vmcnt(7)
s_add_u32 s59, s59, 4
s_cmp_lt_u32 s58, 2
s_cselect_b32 s59, s59, 320
s_lshl_b32 s39, s59, 10
buffer_load_dwordx4 v[140:143], v8, s[72:75], s39 offen
s_waitcnt vmcnt(7)
buffer_load_dwordx4 v[64:67], v8, s[40:43], s36 offen offset:0 nt
s_waitcnt vmcnt(7)
buffer_load_dwordx4 v[68:71], v8, s[40:43], s36 offen offset:1024 nt
s_waitcnt vmcnt(7)
buffer_load_dwordx4 v[72:75], v8, s[40:43], s36 offen offset:2048 nt
s_waitcnt vmcnt(7)
buffer_load_dwordx4 v[76:79], v8, s[40:43], s36 offen offset:3072 nt
s_waitcnt vmcnt(7)
buffer_load_dwordx4 v[80:83], v9, s[40:43], s36 offen offset:0 nt
s_waitcnt vmcnt(7)
buffer_load_dwordx4 v[84:87], v9, s[40:43], s36 offen offset:1024 nt
s_waitcnt vmcnt(7)
buffer_load_dwordx4 v[88:91], v9, s[40:43], s36 offen offset:2048 nt
s_waitcnt vmcnt(7)
buffer_load_dwordx4 v[92:95], v9, s[40:43], s36 offen offset:3072 nt
s_waitcnt vmcnt(7)
s_add_u32 s36, s36, 0x18000
buffer_load_dwordx4 v[96:99], v8, s[40:43], s36 offen offset:0 nt
s_waitcnt vmcnt(7)
buffer_load_dwordx4 v[100:103], v8, s[40:43], s36 offen offset:1024 nt
ds_add_u32 v192, v193 offset:256
s_waitcnt vmcnt(7)
buffer_load_dwordx4 v[104:107], v8, s[40:43], s36 offen offset:2048 nt
s_waitcnt vmcnt(7)
buffer_load_dwordx4 v[108:111], v8, s[40:43], s36 offen offset:3072 nt
ds_add_u32 v192, v193 offset:256
s_waitcnt vmcnt(7)
buffer_load_dwordx4 v[112:115], v9, s[40:43], s36 offen offset:0 nt
s_waitcnt vmcnt(7)
buffer_load_dwordx4 v[116:119], v9, s[40:43], s36 offen offset:1024 nt
ds_add_u32 v192, v193 offset:256
s_waitcnt vmcnt(7)
buffer_load_dwordx4 v[120:123], v9, s[40:43], s36 offen offset:2048 nt
s_waitcnt vmcnt(7)
buffer_load_dwordx4 v[124:127], v9, s[40:43], s36 offen offset:3072 nt
ds_add_u32 v192, v193 offset:256
s_waitcnt vmcnt(7)
s_add_u32 s36, s36, 0x18000
buffer_load_dwordx4 v[128:131], v8, s[40:43], s36 offen offset:0 nt
s_waitcnt vmcnt(7)
buffer_load_dwordx4 v[132:135], v8, s[40:43], s36 offen offset:1024 nt
ds_add_u32 v192, v193 offset:256
s_waitcnt vmcnt(7)
buffer_load_dwordx4 v[136:139], v8, s[40:43], s36 offen offset:2048 nt
s_waitcnt vmcnt(7)
buffer_load_dwordx4 v[140:143], v8, s[40:43], s36 offen offset:3072 nt
ds_add_u32 v192, v193 offset:256
s_waitcnt vmcnt(7)
buffer_load_dwordx4 v[144:147], v9, s[40:43], s36 offen offset:0 nt
s_waitcnt vmcnt(7)
buffer_load_dwordx4 v[148:151], v9, s[40:43], s36 offen offset:1024 nt
ds_add_u32 v192, v193 offset:256
s_waitcnt vmcnt(7)
buffer_load_dwordx4 v[152:155], v9, s[40:43], s36 offen offset:2048 nt
s_waitcnt vmcnt(7)
buffer_load_dwordx4 v[156:159], v9, s[40:43], s36 offen offset:3072 nt
ds_add_u32 v192, v193 offset:256
s_waitcnt vmcnt(7)
s_add_u32 s36, s36, 0x18000
buffer_load_dwordx4 v[160:163], v8, s[40:43], s36 offen offset:0 nt
s_waitcnt vmcnt(7)
buffer_load_dwordx4 v[164:167], v8, s[40:43], s36 offen offset:1024 nt
ds_add_u32 v192, v193 offset:256
s_waitcnt vmcnt(7)
buffer_load_dwordx4 v[168:171], v8, s[40:43], s36 offen offset:2048 nt
s_waitcnt vmcnt(7)
buffer_load_dwordx4 v[172:175], v8, s[40:43], s36 offen offset:3072 nt
ds_add_u32 v192, v193 offset:256
s_waitcnt vmcnt(7)
buffer_load_dwordx4 v[176:179], v9, s[40:43], s36 offen offset:0 nt
s_waitcnt vmcnt(7)
buffer_load_dwordx4 v[180:183], v9, s[40:43], s36 offen offset:1024 nt
ds_add_u32 v192, v193 offset:256
s_waitcnt vmcnt(7)
buffer_load_dwordx4 v[184:187], v9, s[40:43], s36 offen offset:2048 nt
s_waitcnt vmcnt(7)
buffer_load_dwordx4 v[188:191], v9, s[40:43], s36 offen offset:3072 nt
ds_add_u32 v192, v193 offset:256
v_lshlrev_b32 v61, 4, v2
s_mov_b32 s64, 0
L_A_qw:
ds_read_b32 v60, v47 offset:0
s_waitcnt lgkmcnt(0)
v_readfirstlane_b32 s65, v60
s_add_u32 s64, s64, 1
s_nop 2
s_cmp_ge_u32 s65, 1
s_cbranch_scc1 L_A_qw_ok
s_sleep 1
s_cmp_lt_u32 s64, 1048576
s_cbranch_scc1 L_A_qw
L_A_qw_ok:
v_lshlrev_b32 v60, 5, v2
ds_read_b128 v[16:19], v61 offset:1024
ds_read_b128 v[20:23], v61 offset:1280
s_waitcnt lgkmcnt(0)
v_dot2_f32_bf16 v24, v64, v16, 0
v_dot2_f32_bf16 v24, v65, v17, v24
v_dot2_f32_bf16 v24, v66, v18, v24
v_dot2_f32_bf16 v24, v67, v19, v24
s_waitcnt vmcnt(6)
s_add_u32 s36, s36, 0x18000
buffer_load_dwordx4 v[64:67], v8, s[40:43], s36 offen offset:0 nt
v_dot2_f32_bf16 v25, v68, v16, 0
v_dot2_f32_bf16 v25, v69, v17, v25
v_dot2_f32_bf16 v25, v70, v18, v25
v_dot2_f32_bf16 v25, v71, v19, v25
s_waitcnt vmcnt(6)
buffer_load_dwordx4 v[68:71], v8, s[40:43], s36 offen offset:1024 nt
ds_add_u32 v192, v193 offset:256
v_add_f32_dpp v28, v24, v24 row_ror:8 row_mask:0xf bank_mask:0x3
v_dot2_f32_bf16 v26, v72, v16, 0
v_dot2_f32_bf16 v26, v73, v17, v26
v_dot2_f32_bf16 v26, v74, v18, v26
v_dot2_f32_bf16 v26, v75, v19, v26
v_add_f32_dpp v28, v25, v25 row_ror:8 row_mask:0xf bank_mask:0xc
s_waitcnt vmcnt(6)
buffer_load_dwordx4 v[72:75], v8, s[40:43], s36 offen offset:2048 nt
v_dot2_f32_bf16 v27, v76, v16, 0
v_dot2_f32_bf16 v27, v77, v17, v27
v_dot2_f32_bf16 v27, v78, v18, v27
v_dot2_f32_bf16 v27, v79, v19, v27
s_waitcnt vmcnt(6)
buffer_load_dwordx4 v[76:79], v8, s[40:43], s36 offen offset:3072 nt
ds_add_u32 v192, v193 offset:256
v_add_f32_dpp v29, v26, v26 row_ror:8 row_mask:0xf bank_mask:0x3
v_dot2_f32_bf16 v24, v80, v20, 0
v_dot2_f32_bf16 v24, v81, v21, v24
v_dot2_f32_bf16 v24, v82, v22, v24
v_dot2_f32_bf16 v24, v83, v23, v24
v_add_f32_dpp v29, v27, v27 row_ror:8 row_mask:0xf bank_mask:0xc
s_waitcnt vmcnt(6)
buffer_load_dwordx4 v[80:83], v9, s[40:43], s36 offen offset:0 nt
v_add_f32_dpp v30, v28, v28 row_shl:4 row_mask:0xf bank_mask:0x5
v_dot2_f32_bf16 v25, v84, v20, 0
v_dot2_f32_bf16 v25, v85, v21, v25
v_dot2_f32_bf16 v25, v86, v22, v25
v_dot2_f32_bf16 v25, v87, v23, v25
v_add_f32_dpp v30, v29, v29 row_shr:4 row_mask:0xf bank_mask:0xa
s_waitcnt vmcnt(6)
buffer_load_dwordx4 v[84:87], v9, s[40:43], s36 offen offset:1024 nt
ds_add_u32 v192, v193 offset:256
v_add_f32_dpp v28, v24, v24 row_ror:8 row_mask:0xf bank_mask:0x3
v_dot2_f32_bf16 v26, v88, v20, 0
v_dot2_f32_bf16 v26, v89, v21, v26
v_dot2_f32_bf16 v26, v90, v22, v26
v_dot2_f32_bf16 v26, v91, v23, v26
v_add_f32_dpp v28, v25, v25 row_ror:8 row_mask:0xf bank_mask:0xc
s_waitcnt vmcnt(6)
buffer_load_dwordx4 v[88:91], v9, s[40:43], s36 offen offset:2048 nt
v_dot2_f32_bf16 v27, v92, v20, 0
v_dot2_f32_bf16 v27, v93, v21, v27
v_dot2_f32_bf16 v27, v94, v22, v27
v_dot2_f32_bf16 v27, v95, v23, v27
v_add_f32_dpp v29, v26, v26 row_ror:8 row_mask:0xf bank_mask:0x3
v_dot2_f32_bf16 v24, v96, v16, 0
v_dot2_f32_bf16 v24, v97, v17, v24
v_dot2_f32_bf16 v24, v98, v18, v24
v_dot2_f32_bf16 v24, v99, v19, v24
v_add_f32_dpp v29, v27, v27 row_ror:8 row_mask:0xf bank_mask:0xc
v_add_f32_dpp v31, v28, v28 row_shl:4 row_mask:0xf bank_mask:0x5
v_dot2_f32_bf16 v25, v100, v16, 0
v_dot2_f32_bf16 v25, v101, v17, v25
v_dot2_f32_bf16 v25, v102, v18, v25
v_dot2_f32_bf16 v25, v103, v19, v25
v_add_f32_dpp v31, v29, v29 row_shr:4 row_mask:0xf bank_mask:0xa
s_waitcnt vmcnt(6)
buffer_load_dwordx4 v[92:95], v9, s[40:43], s36 offen offset:3072 nt
ds_add_u32 v192, v193 offset:256
v_add_f32_dpp v34, v30, v30 quad_perm:[2,3,0,1] row_mask:0xf bank_mask:0xf
v_add_f32_dpp v28, v24, v24 row_ror:8 row_mask:0xf bank_mask:0x3
v_dot2_f32_bf16 v26, v104, v16, 0
v_dot2_f32_bf16 v26, v105, v17, v26
v_dot2_f32_bf16 v26, v106, v18, v26
v_dot2_f32_bf16 v26, v107, v19, v26
v_add_f32_dpp v35, v31, v31 quad_perm:[2,3,0,1] row_mask:0xf bank_mask:0xf
v_cndmask_b32 v32, v34, v35, s[48:49]
v_add_f32_dpp v28, v25, v25 row_ror:8 row_mask:0xf bank_mask:0xc
v_dot2_f32_bf16 v27, v108, v16, 0
v_dot2_f32_bf16 v27, v109, v17, v27
v_dot2_f32_bf16 v27, v110, v18, v27
v_dot2_f32_bf16 v27, v111, v19, v27
v_add_f32_dpp v29, v26, v26 row_ror:8 row_mask:0xf bank_mask:0x3
v_dot2_f32_bf16 v24, v112, v20, 0
v_dot2_f32_bf16 v24, v113, v21, v24
v_dot2_f32_bf16 v24, v114, v22, v24
v_dot2_f32_bf16 v24, v115, v23, v24
v_add_f32_dpp v29, v27, v27 row_ror:8 row_mask:0xf bank_mask:0xc
s_waitcnt vmcnt(6)
s_add_u32 s36, s36, 0x18000
buffer_load_dwordx4 v[96:99], v8, s[40:43], s36 offen offset:0 nt
v_add_f32_dpp v30, v28, v28 row_shl:4 row_mask:0xf bank_mask:0x5
v_dot2_f32_bf16 v25, v116, v20, 0
v_dot2_f32_bf16 v25, v117, v21, v25
v_dot2_f32_bf16 v25, v118, v22, v25
v_dot2_f32_bf16 v25, v119, v23, v25
v_add_f32_dpp v30, v29, v29 row_shr:4 row_mask:0xf bank_mask:0xa
v_add_f32_dpp v28, v24, v24 row_ror:8 row_mask:0xf bank_mask:0x3
v_dot2_f32_bf16 v26, v120, v20, 0
v_dot2_f32_bf16 v26, v121, v21, v26
v_dot2_f32_bf16 v26, v122, v22, v26
v_dot2_f32_bf16 v26, v123, v23, v26
v_add_f32_dpp v28, v25, v25 row_ror:8 row_mask:0xf bank_mask:0xc
v_dot2_f32_bf16 v27, v124, v20, 0
v_dot2_f32_bf16 v27, v125, v21, v27
v_dot2_f32_bf16 v27, v126, v22, v27
v_dot2_f32_bf16 v27, v127, v23, v27
s_waitcnt vmcnt(6)
buffer_load_dwordx4 v[100:103], v8, s[40:43], s36 offen offset:1024 nt
ds_add_u32 v192, v193 offset:256
v_add_f32_dpp v29, v26, v26 row_ror:8 row_mask:0xf bank_mask:0x3
v_dot2_f32_bf16 v24, v128, v16, 0
v_dot2_f32_bf16 v24, v129, v17, v24
v_dot2_f32_bf16 v24, v130, v18, v24
v_dot2_f32_bf16 v24, v131, v19, v24
v_add_f32_dpp v29, v27, v27 row_ror:8 row_mask:0xf bank_mask:0xc
v_add_f32_dpp v31, v28, v28 row_shl:4 row_mask:0xf bank_mask:0x5
v_dot2_f32_bf16 v25, v132, v16, 0
v_dot2_f32_bf16 v25, v133, v17, v25
v_dot2_f32_bf16 v25, v134, v18, v25
v_dot2_f32_bf16 v25, v135, v19, v25
v_add_f32_dpp v31, v29, v29 row_shr:4 row_mask:0xf bank_mask:0xa
v_add_f32_dpp v34, v30, v30 quad_perm:[2,3,0,1] row_mask:0xf bank_mask:0xf
v_add_f32_dpp v28, v24, v24 row_ror:8 row_mask:0xf bank_mask:0x3
v_dot2_f32_bf16 v26, v136, v16, 0
v_dot2_f32_bf16 v26, v137, v17, v26
v_dot2_f32_bf16 v26, v138, v18, v26
v_dot2_f32_bf16 v26, v139, v19, v26
v_add_f32_dpp v35, v31, v31 quad_perm:[2,3,0,1] row_mask:0xf bank_mask:0xf
v_cndmask_b32 v33, v34, v35, s[48:49]
v_add_f32_dpp v28, v25, v25 row_ror:8 row_mask:0xf bank_mask:0xc
s_waitcnt vmcnt(6)
buffer_load_dwordx4 v[104:107], v8, s[40:43], s36 offen offset:2048 nt
v_add_f32_dpp v34, v32, v32 quad_perm:[1,0,3,2] row_mask:0xf bank_mask:0xf
v_mov_b32 v36, v37
v_mov_b32 v37, v38
v_mov_b32 v38, v39
v_mov_b32 v39, v40
v_mov_b32 v40, v41
v_mov_b32 v41, v42
v_mov_b32 v42, v43
v_mov_b32 v43, v44
v_mov_b32 v44, v45
v_mov_b32 v45, v46
v_dot2_f32_bf16 v27, v140, v16, 0
v_dot2_f32_bf16 v27, v141, v17, v27
v_dot2_f32_bf16 v27, v142, v18, v27
v_dot2_f32_bf16 v27, v143, v19, v27
v_add_f32_dpp v35, v33, v33 quad_perm:[1,0,3,2] row_mask:0xf bank_mask:0xf
v_cndmask_b32 v46, v34, v35, s[50:51]
v_add_f32_dpp v29, v26, v26 row_ror:8 row_mask:0xf bank_mask:0x3
v_dot2_f32_bf16 v24, v144, v20, 0
v_dot2_f32_bf16 v24, v145, v21, v24
v_dot2_f32_bf16 v24, v146, v22, v24
v_dot2_f32_bf16 v24, v147, v23, v24
v_add_f32_dpp v29, v27, v27 row_ror:8 row_mask:0xf bank_mask:0xc
v_add_f32_dpp v30, v28, v28 row_shl:4 row_mask:0xf bank_mask:0x5
v_dot2_f32_bf16 v25, v148, v20, 0
v_dot2_f32_bf16 v25, v149, v21, v25
v_dot2_f32_bf16 v25, v150, v22, v25
v_dot2_f32_bf16 v25, v151, v23, v25
v_add_f32_dpp v30, v29, v29 row_shr:4 row_mask:0xf bank_mask:0xa
s_waitcnt vmcnt(6)
buffer_load_dwordx4 v[108:111], v8, s[40:43], s36 offen offset:3072 nt
ds_add_u32 v192, v193 offset:256
v_add_f32_dpp v28, v24, v24 row_ror:8 row_mask:0xf bank_mask:0x3
v_dot2_f32_bf16 v26, v152, v20, 0
v_dot2_f32_bf16 v26, v153, v21, v26
v_dot2_f32_bf16 v26, v154, v22, v26
v_dot2_f32_bf16 v26, v155, v23, v26
v_add_f32_dpp v28, v25, v25 row_ror:8 row_mask:0xf bank_mask:0xc
v_dot2_f32_bf16 v27, v156, v20, 0
v_dot2_f32_bf16 v27, v157, v21, v27
v_dot2_f32_bf16 v27, v158, v22, v27
v_dot2_f32_bf16 v27, v159, v23, v27
v_add_f32_dpp v29, v26, v26 row_ror:8 row_mask:0xf bank_mask:0x3
v_dot2_f32_bf16 v24, v160, v16, 0
v_dot2_f32_bf16 v24, v161, v17, v24
v_dot2_f32_bf16 v24, v162, v18, v24
v_dot2_f32_bf16 v24, v163, v19, v24
v_add_f32_dpp v29, v27, v27 row_ror:8 row_mask:0xf bank_mask:0xc
s_waitcnt vmcnt(6)
buffer_load_dwordx4 v[112:115], v9, s[40:43], s36 offen offset:0 nt
v_add_f32_dpp v31, v28, v28 row_shl:4 row_mask:0xf bank_mask:0x5
v_dot2_f32_bf16 v25, v164, v16, 0
v_dot2_f32_bf16 v25, v165, v17, v25
v_dot2_f32_bf16 v25, v166, v18, v25
v_dot2_f32_bf16 v25, v167, v19, v25
v_add_f32_dpp v31, v29, v29 row_shr:4 row_mask:0xf bank_mask:0xa
v_add_f32_dpp v34, v30, v30 quad_perm:[2,3,0,1] row_mask:0xf bank_mask:0xf
v_add_f32_dpp v28, v24, v24 row_ror:8 row_mask:0xf bank_mask:0x3
v_dot2_f32_bf16 v26, v168, v16, 0
v_dot2_f32_bf16 v26, v169, v17, v26
v_dot2_f32_bf16 v26, v170, v18, v26
v_dot2_f32_bf16 v26, v171, v19, v26
v_add_f32_dpp v35, v31, v31 quad_perm:[2,3,0,1] row_mask:0xf bank_mask:0xf
v_cndmask_b32 v32, v34, v35, s[48:49]
v_add_f32_dpp v28, v25, v25 row_ror:8 row_mask:0xf bank_mask:0xc
v_dot2_f32_bf16 v27, v172, v16, 0
v_dot2_f32_bf16 v27, v173, v17, v27
v_dot2_f32_bf16 v27, v174, v18, v27
v_dot2_f32_bf16 v27, v175, v19, v27
s_waitcnt vmcnt(6)
buffer_load_dwordx4 v[116:119], v9, s[40:43], s36 offen offset:1024 nt
ds_add_u32 v192, v193 offset:256
v_add_f32_dpp v29, v26, v26 row_ror:8 row_mask:0xf bank_mask:0x3
v_dot2_f32_bf16 v24, v176, v20, 0
v_dot2_f32_bf16 v24, v177, v21, v24
v_dot2_f32_bf16 v24, v178, v22, v24
v_dot2_f32_bf16 v24, v179, v23, v24
v_add_f32_dpp v29, v27, v27 row_ror:8 row_mask:0xf bank_mask:0xc
v_add_f32_dpp v30, v28, v28 row_shl:4 row_mask:0xf bank_mask:0x5
v_dot2_f32_bf16 v25, v180, v20, 0
v_dot2_f32_bf16 v25, v181, v21, v25
v_dot2_f32_bf16 v25, v182, v22, v25
v_dot2_f32_bf16 v25, v183, v23, v25
v_add_f32_dpp v30, v29, v29 row_shr:4 row_mask:0xf bank_mask:0xa
v_add_f32_dpp v28, v24, v24 row_ror:8 row_mask:0xf bank_mask:0x3
v_dot2_f32_bf16 v26, v184, v20, 0
v_dot2_f32_bf16 v26, v185, v21, v26
v_dot2_f32_bf16 v26, v186, v22, v26
v_dot2_f32_bf16 v26, v187, v23, v26
v_add_f32_dpp v28, v25, v25 row_ror:8 row_mask:0xf bank_mask:0xc
s_waitcnt vmcnt(6)
buffer_load_dwordx4 v[120:123], v9, s[40:43], s36 offen offset:2048 nt
v_dot2_f32_bf16 v27, v188, v20, 0
v_dot2_f32_bf16 v27, v189, v21, v27
v_dot2_f32_bf16 v27, v190, v22, v27
v_dot2_f32_bf16 v27, v191, v23, v27
v_add_f32_dpp v29, v26, v26 row_ror:8 row_mask:0xf bank_mask:0x3
v_dot2_f32_bf16 v24, v64, v16, 0
v_dot2_f32_bf16 v24, v65, v17, v24
v_dot2_f32_bf16 v24, v66, v18, v24
v_dot2_f32_bf16 v24, v67, v19, v24
v_add_f32_dpp v29, v27, v27 row_ror:8 row_mask:0xf bank_mask:0xc
v_add_f32_dpp v31, v28, v28 row_shl:4 row_mask:0xf bank_mask:0x5
v_dot2_f32_bf16 v25, v68, v16, 0
v_dot2_f32_bf16 v25, v69, v17, v25
v_dot2_f32_bf16 v25, v70, v18, v25
v_dot2_f32_bf16 v25, v71, v19, v25
v_add_f32_dpp v31, v29, v29 row_shr:4 row_mask:0xf bank_mask:0xa
s_waitcnt vmcnt(6)
buffer_load_dwordx4 v[124:127], v9, s[40:43], s36 offen offset:3072 nt
ds_add_u32 v192, v193 offset:256
v_add_f32_dpp v34, v30, v30 quad_perm:[2,3,0,1] row_mask:0xf bank_mask:0xf
v_add_f32_dpp v28, v24, v24 row_ror:8 row_mask:0xf bank_mask:0x3
v_dot2_f32_bf16 v26, v72, v16, 0
v_dot2_f32_bf16 v26, v73, v17, v26
v_dot2_f32_bf16 v26, v74, v18, v26
v_dot2_f32_bf16 v26, v75, v19, v26
v_add_f32_dpp v35, v31, v31 quad_perm:[2,3,0,1] row_mask:0xf bank_mask:0xf
v_cndmask_b32 v33, v34, v35, s[48:49]
v_add_f32_dpp v28, v25, v25 row_ror:8 row_mask:0xf bank_mask:0xc
v_add_f32_dpp v34, v32, v32 quad_perm:[1,0,3,2] row_mask:0xf bank_mask:0xf
v_mov_b32 v36, v37
v_mov_b32 v37, v38
v_mov_b32 v38, v39
v_mov_b32 v39, v40
v_mov_b32 v40, v41
v_mov_b32 v41, v42
v_mov_b32 v42, v43
v_mov_b32 v43, v44
v_mov_b32 v44, v45
v_mov_b32 v45, v46
v_dot2_f32_bf16 v27, v76, v16, 0
v_dot2_f32_bf16 v27, v77, v17, v27
v_dot2_f32_bf16 v27, v78, v18, v27
v_dot2_f32_bf16 v27, v79, v19, v27
v_add_f32_dpp v35, v33, v33 quad_perm:[1,0,3,2] row_mask:0xf bank_mask:0xf
v_cndmask_b32 v46, v34, v35, s[50:51]
v_add_f32_dpp v29, v26, v26 row_ror:8 row_mask:0xf bank_mask:0x3
v_dot2_f32_bf16 v24, v80, v20, 0
v_dot2_f32_bf16 v24, v81, v21, v24
v_dot2_f32_bf16 v24, v82, v22, v24
v_dot2_f32_bf16 v24, v83, v23, v24
v_add_f32_dpp v29, v27, v27 row_ror:8 row_mask:0xf bank_mask:0xc
s_waitcnt vmcnt(6)
s_add_u32 s36, s36, 0x18000
buffer_load_dwordx4 v[64:67], v8, s[40:43], s36 offen offset:0 nt
v_add_f32_dpp v30, v28, v28 row_shl:4 row_mask:0xf bank_mask:0x5
v_dot2_f32_bf16 v25, v84, v20, 0
v_dot2_f32_bf16 v25, v85, v21, v25
v_dot2_f32_bf16 v25, v86, v22, v25
v_dot2_f32_bf16 v25, v87, v23, v25
v_add_f32_dpp v30, v29, v29 row_shr:4 row_mask:0xf bank_mask:0xa
v_add_f32_dpp v28, v24, v24 row_ror:8 row_mask:0xf bank_mask:0x3
v_dot2_f32_bf16 v26, v88, v20, 0
v_dot2_f32_bf16 v26, v89, v21, v26
v_dot2_f32_bf16 v26, v90, v22, v26
v_dot2_f32_bf16 v26, v91, v23, v26
v_add_f32_dpp v28, v25, v25 row_ror:8 row_mask:0xf bank_mask:0xc
v_dot2_f32_bf16 v27, v92, v20, 0
v_dot2_f32_bf16 v27, v93, v21, v27
v_dot2_f32_bf16 v27, v94, v22, v27
v_dot2_f32_bf16 v27, v95, v23, v27
s_waitcnt vmcnt(6)
buffer_load_dwordx4 v[68:71], v8, s[40:43], s36 offen offset:1024 nt
ds_add_u32 v192, v193 offset:256
v_add_f32_dpp v29, v26, v26 row_ror:8 row_mask:0xf bank_mask:0x3
v_dot2_f32_bf16 v24, v96, v16, 0
v_dot2_f32_bf16 v24, v97, v17, v24
v_dot2_f32_bf16 v24, v98, v18, v24
v_dot2_f32_bf16 v24, v99, v19, v24
v_add_f32_dpp v29, v27, v27 row_ror:8 row_mask:0xf bank_mask:0xc
v_add_f32_dpp v31, v28, v28 row_shl:4 row_mask:0xf bank_mask:0x5
v_dot2_f32_bf16 v25, v100, v16, 0
v_dot2_f32_bf16 v25, v101, v17, v25
v_dot2_f32_bf16 v25, v102, v18, v25
v_dot2_f32_bf16 v25, v103, v19, v25
v_add_f32_dpp v31, v29, v29 row_shr:4 row_mask:0xf bank_mask:0xa
s_waitcnt vmcnt(6)
buffer_load_dwordx4 v[72:75], v8, s[40:43], s36 offen offset:2048 nt
v_add_f32_dpp v34, v30, v30 quad_perm:[2,3,0,1] row_mask:0xf bank_mask:0xf
v_add_f32_dpp v28, v24, v24 row_ror:8 row_mask:0xf bank_mask:0x3
v_dot2_f32_bf16 v26, v104, v16, 0
v_dot2_f32_bf16 v26, v105, v17, v26
v_dot2_f32_bf16 v26, v106, v18, v26
v_dot2_f32_bf16 v26, v107, v19, v26
v_add_f32_dpp v35, v31, v31 quad_perm:[2,3,0,1] row_mask:0xf bank_mask:0xf
v_cndmask_b32 v32, v34, v35, s[48:49]
v_add_f32_dpp v28, v25, v25 row_ror:8 row_mask:0xf bank_mask:0xc
s_waitcnt vmcnt(6)
buffer_load_dwordx4 v[76:79], v8, s[40:43], s36 offen offset:3072 nt
ds_add_u32 v192, v193 offset:256
v_dot2_f32_bf16 v27, v108, v16, 0
v_dot2_f32_bf16 v27, v109, v17, v27
v_dot2_f32_bf16 v27, v110, v18, v27
v_dot2_f32_bf16 v27, v111, v19, v27
s_waitcnt vmcnt(6)
buffer_load_dwordx4 v[80:83], v9, s[40:43], s36 offen offset:0 nt
v_add_f32_dpp v29, v26, v26 row_ror:8 row_mask:0xf bank_mask:0x3
v_dot2_f32_bf16 v24, v112, v20, 0
v_dot2_f32_bf16 v24, v113, v21, v24
v_dot2_f32_bf16 v24, v114, v22, v24
v_dot2_f32_bf16 v24, v115, v23, v24
v_add_f32_dpp v29, v27, v27 row_ror:8 row_mask:0xf bank_mask:0xc
s_waitcnt vmcnt(6)
buffer_load_dwordx4 v[84:87], v9, s[40:43], s36 offen offset:1024 nt
ds_add_u32 v192, v193 offset:256
v_add_f32_dpp v30, v28, v28 row_shl:4 row_mask:0xf bank_mask:0x5
v_dot2_f32_bf16 v25, v116, v20, 0
v_dot2_f32_bf16 v25, v117, v21, v25
v_dot2_f32_bf16 v25, v118, v22, v25
v_dot2_f32_bf16 v25, v119, v23, v25
v_add_f32_dpp v30, v29, v29 row_shr:4 row_mask:0xf bank_mask:0xa
s_waitcnt vmcnt(6)
buffer_load_dwordx4 v[88:91], v9, s[40:43], s36 offen offset:2048 nt
v_add_f32_dpp v28, v24, v24 row_ror:8 row_mask:0xf bank_mask:0x3
v_dot2_f32_bf16 v26, v120, v20, 0
v_dot2_f32_bf16 v26, v121, v21, v26
v_dot2_f32_bf16 v26, v122, v22, v26
v_dot2_f32_bf16 v26, v123, v23, v26
v_add_f32_dpp v28, v25, v25 row_ror:8 row_mask:0xf bank_mask:0xc
s_waitcnt vmcnt(6)
buffer_load_dwordx4 v[92:95], v9, s[40:43], s36 offen offset:3072 nt
ds_add_u32 v192, v193 offset:256
v_dot2_f32_bf16 v27, v124, v20, 0
v_dot2_f32_bf16 v27, v125, v21, v27
v_dot2_f32_bf16 v27, v126, v22, v27
v_dot2_f32_bf16 v27, v127, v23, v27
s_mov_b32 s38, 7
.p2align 6
L_A_ka:
s_cbranch_vccnz L_A_w1
s_waitcnt vmcnt(6)
L_A_w1:
s_waitcnt vmcnt(7)
s_add_u32 s36, s36, 0x18000
buffer_load_dwordx4 v[96:99], v8, s[40:43], s36 offen offset:0 nt
ds_read_b32 v194, v47 offset:8
v_add_f32_dpp v29, v26, v26 row_ror:8 row_mask:0xf bank_mask:0x3
v_dot2_f32_bf16 v24, v64, v16, 0
v_dot2_f32_bf16 v24, v65, v17, v24
v_dot2_f32_bf16 v24, v66, v18, v24
v_dot2_f32_bf16 v24, v67, v19, v24
v_add_f32_dpp v29, v27, v27 row_ror:8 row_mask:0xf bank_mask:0xc
s_cbranch_vccnz L_A_w2
s_waitcnt vmcnt(6)
L_A_w2:
s_waitcnt vmcnt(7)
buffer_load_dwordx4 v[100:103], v8, s[40:43], s36 offen offset:1024 nt
ds_add_u32 v192, v193 offset:256
s_waitcnt lgkmcnt(1)
v_cmp_ne_u32 vcc, 0, v194
v_add_f32_dpp v31, v28, v28 row_shl:4 row_mask:0xf bank_mask:0x5
v_dot2_f32_bf16 v25, v68, v16, 0
v_dot2_f32_bf16 v25, v69, v17, v25
v_dot2_f32_bf16 v25, v70, v18, v25
v_dot2_f32_bf16 v25, v71, v19, v25
v_add_f32_dpp v31, v29, v29 row_shr:4 row_mask:0xf bank_mask:0xa
s_cbranch_vccnz L_A_w3
s_waitcnt vmcnt(6)
L_A_w3:
s_waitcnt vmcnt(7)
buffer_load_dwordx4 v[104:107], v8, s[40:43], s36 offen offset:2048 nt
v_add_f32_dpp v34, v30, v30 quad_perm:[2,3,0,1] row_mask:0xf bank_mask:0xf
v_add_f32_dpp v28, v24, v24 row_ror:8 row_mask:0xf bank_mask:0x3
v_dot2_f32_bf16 v26, v72, v16, 0
v_dot2_f32_bf16 v26, v73, v17, v26
v_dot2_f32_bf16 v26, v74, v18, v26
v_dot2_f32_bf16 v26, v75, v19, v26
v_add_f32_dpp v35, v31, v31 quad_perm:[2,3,0,1] row_mask:0xf bank_mask:0xf
v_cndmask_b32 v33, v34, v35, s[48:49]
v_add_f32_dpp v28, v25, v25 row_ror:8 row_mask:0xf bank_mask:0xc
s_cbranch_vccnz L_A_w4
s_waitcnt vmcnt(6)
L_A_w4:
s_waitcnt vmcnt(7)
buffer_load_dwordx4 v[108:111], v8, s[40:43], s36 offen offset:3072 nt
ds_add_u32 v192, v193 offset:256
v_add_f32_dpp v34, v32, v32 quad_perm:[1,0,3,2] row_mask:0xf bank_mask:0xf
v_mov_b32 v36, v37
v_mov_b32 v37, v38
v_mov_b32 v38, v39
v_mov_b32 v39, v40
v_mov_b32 v40, v41
v_mov_b32 v41, v42
v_mov_b32 v42, v43
v_mov_b32 v43, v44
v_mov_b32 v44, v45
v_mov_b32 v45, v46
v_dot2_f32_bf16 v27, v76, v16, 0
v_dot2_f32_bf16 v27, v77, v17, v27
v_dot2_f32_bf16 v27, v78, v18, v27
v_dot2_f32_bf16 v27, v79, v19, v27
v_add_f32_dpp v35, v33, v33 quad_perm:[1,0,3,2] row_mask:0xf bank_mask:0xf
v_cndmask_b32 v46, v34, v35, s[50:51]
s_cbranch_vccnz L_A_w5
s_waitcnt vmcnt(6)
L_A_w5:
s_waitcnt vmcnt(7)
buffer_load_dwordx4 v[112:115], v9, s[40:43], s36 offen offset:0 nt
v_add_f32_dpp v29, v26, v26 row_ror:8 row_mask:0xf bank_mask:0x3
v_dot2_f32_bf16 v24, v80, v20, 0
v_dot2_f32_bf16 v24, v81, v21, v24
v_dot2_f32_bf16 v24, v82, v22, v24
v_dot2_f32_bf16 v24, v83, v23, v24
v_add_f32_dpp v29, v27, v27 row_ror:8 row_mask:0xf bank_mask:0xc
s_cbranch_vccnz L_A_w6
s_waitcnt vmcnt(6)
L_A_w6:
s_waitcnt vmcnt(7)
buffer_load_dwordx4 v[116:119], v9, s[40:43], s36 offen offset:1024 nt
ds_add_u32 v192, v193 offset:256
v_add_f32_dpp v30, v28, v28 row_shl:4 row_mask:0xf bank_mask:0x5
v_dot2_f32_bf16 v25, v84, v20, 0
v_dot2_f32_bf16 v25, v85, v21, v25
v_dot2_f32_bf16 v25, v86, v22, v25
v_dot2_f32_bf16 v25, v87, v23, v25
v_add_f32_dpp v30, v29, v29 row_shr:4 row_mask:0xf bank_mask:0xa
s_cbranch_vccnz L_A_w7
s_waitcnt vmcnt(6)
L_A_w7:
s_waitcnt vmcnt(7)
buffer_load_dwordx4 v[120:123], v9, s[40:43], s36 offen offset:2048 nt
v_add_f32_dpp v28, v24, v24 row_ror:8 row_mask:0xf bank_mask:0x3
v_dot2_f32_bf16 v26, v88, v20, 0
v_dot2_f32_bf16 v26, v89, v21, v26
v_dot2_f32_bf16 v26, v90, v22, v26
v_dot2_f32_bf16 v26, v91, v23, v26
v_add_f32_dpp v28, v25, v25 row_ror:8 row_mask:0xf bank_mask:0xc
s_cbranch_vccnz L_A_w8
s_waitcnt vmcnt(6)
L_A_w8:
s_waitcnt vmcnt(7)
buffer_load_dwordx4 v[124:127], v9, s[40:43], s36 offen offset:3072 nt
ds_add_u32 v192, v193 offset:256
v_dot2_f32_bf16 v27, v92, v20, 0
v_dot2_f32_bf16 v27, v93, v21, v27
v_dot2_f32_bf16 v27, v94, v22, v27
v_dot2_f32_bf16 v27, v95, v23, v27
s_cbranch_vccnz L_A_w9
s_waitcnt vmcnt(6)
L_A_w9:
s_waitcnt vmcnt(7)
s_add_u32 s36, s36, 0x18000
buffer_load_dwordx4 v[64:67], v8, s[40:43], s36 offen offset:0 nt
ds_read_b32 v194, v47 offset:8
v_add_f32_dpp v29, v26, v26 row_ror:8 row_mask:0xf bank_mask:0x3
v_dot2_f32_bf16 v24, v96, v16, 0
v_dot2_f32_bf16 v24, v97, v17, v24
v_dot2_f32_bf16 v24, v98, v18, v24
v_dot2_f32_bf16 v24, v99, v19, v24
v_add_f32_dpp v29, v27, v27 row_ror:8 row_mask:0xf bank_mask:0xc
s_cbranch_vccnz L_A_w10
s_waitcnt vmcnt(6)
L_A_w10:
s_waitcnt vmcnt(7)
buffer_load_dwordx4 v[68:71], v8, s[40:43], s36 offen offset:1024 nt
ds_add_u32 v192, v193 offset:256
s_waitcnt lgkmcnt(1)
v_cmp_ne_u32 vcc, 0, v194
v_add_f32_dpp v31, v28, v28 row_shl:4 row_mask:0xf bank_mask:0x5
v_dot2_f32_bf16 v25, v100, v16, 0
v_dot2_f32_bf16 v25, v101, v17, v25
v_dot2_f32_bf16 v25, v102, v18, v25
v_dot2_f32_bf16 v25, v103, v19, v25
v_add_f32_dpp v31, v29, v29 row_shr:4 row_mask:0xf bank_mask:0xa
s_cbranch_vccnz L_A_w11
s_waitcnt vmcnt(6)
L_A_w11:
s_waitcnt vmcnt(7)
buffer_load_dwordx4 v[72:75], v8, s[40:43], s36 offen offset:2048 nt
v_add_f32_dpp v34, v30, v30 quad_perm:[2,3,0,1] row_mask:0xf bank_mask:0xf
v_add_f32_dpp v28, v24, v24 row_ror:8 row_mask:0xf bank_mask:0x3
v_dot2_f32_bf16 v26, v104, v16, 0
v_dot2_f32_bf16 v26, v105, v17, v26
v_dot2_f32_bf16 v26, v106, v18, v26
v_dot2_f32_bf16 v26, v107, v19, v26
v_add_f32_dpp v35, v31, v31 quad_perm:[2,3,0,1] row_mask:0xf bank_mask:0xf
v_cndmask_b32 v32, v34, v35, s[48:49]
v_add_f32_dpp v28, v25, v25 row_ror:8 row_mask:0xf bank_mask:0xc
s_cbranch_vccnz L_A_w12
s_waitcnt vmcnt(6)
L_A_w12:
s_waitcnt vmcnt(7)
buffer_load_dwordx4 v[76:79], v8, s[40:43], s36 offen offset:3072 nt
ds_add_u32 v192, v193 offset:256
v_dot2_f32_bf16 v27, v108, v16, 0
v_dot2_f32_bf16 v27, v109, v17, v27
v_dot2_f32_bf16 v27, v110, v18, v27
v_dot2_f32_bf16 v27, v111, v19, v27
s_cbranch_vccnz L_A_w13
s_waitcnt vmcnt(6)
L_A_w13:
s_waitcnt vmcnt(7)
buffer_load_dwordx4 v[80:83], v9, s[40:43], s36 offen offset:0 nt
v_add_f32_dpp v29, v26, v26 row_ror:8 row_mask:0xf bank_mask:0x3
v_dot2_f32_bf16 v24, v112, v20, 0
v_dot2_f32_bf16 v24, v113, v21, v24
v_dot2_f32_bf16 v24, v114, v22, v24
v_dot2_f32_bf16 v24, v115, v23, v24
v_add_f32_dpp v29, v27, v27 row_ror:8 row_mask:0xf bank_mask:0xc
s_cbranch_vccnz L_A_w14
s_waitcnt vmcnt(6)
L_A_w14:
s_waitcnt vmcnt(7)
buffer_load_dwordx4 v[84:87], v9, s[40:43], s36 offen offset:1024 nt
ds_add_u32 v192, v193 offset:256
v_add_f32_dpp v30, v28, v28 row_shl:4 row_mask:0xf bank_mask:0x5
v_dot2_f32_bf16 v25, v116, v20, 0
v_dot2_f32_bf16 v25, v117, v21, v25
v_dot2_f32_bf16 v25, v118, v22, v25
v_dot2_f32_bf16 v25, v119, v23, v25
v_add_f32_dpp v30, v29, v29 row_shr:4 row_mask:0xf bank_mask:0xa
s_cbranch_vccnz L_A_w15
s_waitcnt vmcnt(6)
L_A_w15:
s_waitcnt vmcnt(7)
buffer_load_dwordx4 v[88:91], v9, s[40:43], s36 offen offset:2048 nt
v_add_f32_dpp v28, v24, v24 row_ror:8 row_mask:0xf bank_mask:0x3
v_dot2_f32_bf16 v26, v120, v20, 0
v_dot2_f32_bf16 v26, v121, v21, v26
v_dot2_f32_bf16 v26, v122, v22, v26
v_dot2_f32_bf16 v26, v123, v23, v26
v_add_f32_dpp v28, v25, v25 row_ror:8 row_mask:0xf bank_mask:0xc
s_cbranch_vccnz L_A_w16
s_waitcnt vmcnt(6)
L_A_w16:
s_waitcnt vmcnt(7)
buffer_load_dwordx4 v[92:95], v9, s[40:43], s36 offen offset:3072 nt
ds_add_u32 v192, v193 offset:256
v_dot2_f32_bf16 v27, v124, v20, 0
v_dot2_f32_bf16 v27, v125, v21, v27
v_dot2_f32_bf16 v27, v126, v22, v27
v_dot2_f32_bf16 v27, v127, v23, v27
s_sub_u32 s38, s38, 1
s_cmp_lg_u32 s38, 0
s_cbranch_scc1 L_A_ka
s_cbranch_vccnz L_A_w17
s_waitcnt vmcnt(5)
L_A_w17:
s_waitcnt vmcnt(7)
buffer_load_dwordx4 v[96:99], v8, s[40:43], s37 offen nt
v_add_f32_dpp v29, v26, v26 row_ror:8 row_mask:0xf bank_mask:0x3
v_dot2_f32_bf16 v24, v64, v16, 0
v_dot2_f32_bf16 v24, v65, v17, v24
v_dot2_f32_bf16 v24, v66, v18, v24
v_dot2_f32_bf16 v24, v67, v19, v24
v_add_f32_dpp v29, v27, v27 row_ror:8 row_mask:0xf bank_mask:0xc
s_cbranch_vccnz L_A_w18
s_waitcnt vmcnt(5)
L_A_w18:
s_waitcnt vmcnt(7)
buffer_load_dwordx4 v[100:103], v10, s[40:43], s37 offen nt
ds_add_u32 v192, v193 offset:256
v_add_f32_dpp v31, v28, v28 row_shl:4 row_mask:0xf bank_mask:0x5
v_dot2_f32_bf16 v25, v68, v16, 0
v_dot2_f32_bf16 v25, v69, v17, v25
v_dot2_f32_bf16 v25, v70, v18, v25
v_dot2_f32_bf16 v25, v71, v19, v25
v_add_f32_dpp v31, v29, v29 row_shr:4 row_mask:0xf bank_mask:0xa
s_cbranch_vccnz L_A_w19
s_waitcnt vmcnt(5)
L_A_w19:
s_waitcnt vmcnt(7)
buffer_load_dwordx4 v[104:107], v9, s[40:43], s37 offen nt
v_add_f32_dpp v34, v30, v30 quad_perm:[2,3,0,1] row_mask:0xf bank_mask:0xf
v_add_f32_dpp v28, v24, v24 row_ror:8 row_mask:0xf bank_mask:0x3
v_dot2_f32_bf16 v26, v72, v16, 0
v_dot2_f32_bf16 v26, v73, v17, v26
v_dot2_f32_bf16 v26, v74, v18, v26
v_dot2_f32_bf16 v26, v75, v19, v26
v_add_f32_dpp v35, v31, v31 quad_perm:[2,3,0,1] row_mask:0xf bank_mask:0xf
v_cndmask_b32 v33, v34, v35, s[48:49]
v_add_f32_dpp v28, v25, v25 row_ror:8 row_mask:0xf bank_mask:0xc
s_cbranch_vccnz L_A_w20
s_waitcnt vmcnt(5)
L_A_w20:
s_waitcnt vmcnt(7)
buffer_load_dwordx4 v[108:111], v11, s[40:43], s37 offen nt
ds_add_u32 v192, v193 offset:256
v_add_f32_dpp v34, v32, v32 quad_perm:[1,0,3,2] row_mask:0xf bank_mask:0xf
v_mov_b32 v36, v37
v_mov_b32 v37, v38
v_mov_b32 v38, v39
v_mov_b32 v39, v40
v_mov_b32 v40, v41
v_mov_b32 v41, v42
v_mov_b32 v42, v43
v_mov_b32 v43, v44
v_mov_b32 v44, v45
v_mov_b32 v45, v46
v_dot2_f32_bf16 v27, v76, v16, 0
v_dot2_f32_bf16 v27, v77, v17, v27
v_dot2_f32_bf16 v27, v78, v18, v27
v_dot2_f32_bf16 v27, v79, v19, v27
v_add_f32_dpp v35, v33, v33 quad_perm:[1,0,3,2] row_mask:0xf bank_mask:0xf
v_cndmask_b32 v46, v34, v35, s[50:51]
s_cbranch_vccnz L_A_w21
s_waitcnt vmcnt(5)
L_A_w21:
s_waitcnt vmcnt(7)
s_mov_b32 s36, s35
buffer_load_dwordx4 v[112:115], v8, s[44:47], s36 offen offset:0 nt
v_add_f32_dpp v29, v26, v26 row_ror:8 row_mask:0xf bank_mask:0x3
v_dot2_f32_bf16 v24, v80, v20, 0
v_dot2_f32_bf16 v24, v81, v21, v24
v_dot2_f32_bf16 v24, v82, v22, v24
v_dot2_f32_bf16 v24, v83, v23, v24
v_add_f32_dpp v29, v27, v27 row_ror:8 row_mask:0xf bank_mask:0xc
s_cbranch_vccnz L_A_w22
s_waitcnt vmcnt(5)
L_A_w22:
s_waitcnt vmcnt(7)
buffer_load_dwordx4 v[116:119], v8, s[44:47], s36 offen offset:1024 nt
ds_add_u32 v192, v193 offset:256
v_add_f32_dpp v30, v28, v28 row_shl:4 row_mask:0xf bank_mask:0x5
v_dot2_f32_bf16 v25, v84, v20, 0
v_dot2_f32_bf16 v25, v85, v21, v25
v_dot2_f32_bf16 v25, v86, v22, v25
v_dot2_f32_bf16 v25, v87, v23, v25
v_add_f32_dpp v30, v29, v29 row_shr:4 row_mask:0xf bank_mask:0xa
s_cbranch_vccnz L_A_w23
s_waitcnt vmcnt(5)
L_A_w23:
s_waitcnt vmcnt(7)
buffer_load_dwordx4 v[120:123], v8, s[44:47], s36 offen offset:2048 nt
v_add_f32_dpp v28, v24, v24 row_ror:8 row_mask:0xf bank_mask:0x3
v_dot2_f32_bf16 v26, v88, v20, 0
v_dot2_f32_bf16 v26, v89, v21, v26
v_dot2_f32_bf16 v26, v90, v22, v26
v_dot2_f32_bf16 v26, v91, v23, v26
v_add_f32_dpp v28, v25, v25 row_ror:8 row_mask:0xf bank_mask:0xc
s_cbranch_vccnz L_A_w24
s_waitcnt vmcnt(5)
L_A_w24:
s_waitcnt vmcnt(7)
buffer_load_dwordx4 v[124:127], v8, s[44:47], s36 offen offset:3072 nt
ds_add_u32 v192, v193 offset:256
v_dot2_f32_bf16 v27, v92, v20, 0
v_dot2_f32_bf16 v27, v93, v21, v27
v_dot2_f32_bf16 v27, v94, v22, v27
v_dot2_f32_bf16 v27, v95, v23, v27
s_cbranch_vccnz L_A_w25
s_waitcnt vmcnt(5)
L_A_w25:
s_waitcnt vmcnt(7)
buffer_load_dwordx4 v[64:67], v9, s[44:47], s36 offen offset:0 nt
v_add_f32_dpp v29, v26, v26 row_ror:8 row_mask:0xf bank_mask:0x3
v_dot2_f32_bf16 v24, v96, v16, 0
v_dot2_f32_bf16 v24, v97, v17, v24
v_dot2_f32_bf16 v24, v98, v18, v24
v_dot2_f32_bf16 v24, v99, v19, v24
v_add_f32_dpp v29, v27, v27 row_ror:8 row_mask:0xf bank_mask:0xc
s_cbranch_vccnz L_A_w26
s_waitcnt vmcnt(5)
L_A_w26:
s_waitcnt vmcnt(7)
buffer_load_dwordx4 v[68:71], v9, s[44:47], s36 offen offset:1024 nt
ds_add_u32 v192, v193 offset:256
v_add_f32_dpp v31, v28, v28 row_shl:4 row_mask:0xf bank_mask:0x5
v_dot2_f32_bf16 v25, v100, v16, 0
v_dot2_f32_bf16 v25, v101, v17, v25
v_dot2_f32_bf16 v25, v102, v18, v25
v_dot2_f32_bf16 v25, v103, v19, v25
v_add_f32_dpp v31, v29, v29 row_shr:4 row_mask:0xf bank_mask:0xa
s_cbranch_vccnz L_A_w27
s_waitcnt vmcnt(5)
L_A_w27:
s_waitcnt vmcnt(7)
buffer_load_dwordx4 v[72:75], v9, s[44:47], s36 offen offset:2048 nt
v_add_f32_dpp v34, v30, v30 quad_perm:[2,3,0,1] row_mask:0xf bank_mask:0xf
v_add_f32_dpp v28, v24, v24 row_ror:8 row_mask:0xf bank_mask:0x3
v_dot2_f32_bf16 v26, v104, v20, 0
v_dot2_f32_bf16 v26, v105, v21, v26
v_dot2_f32_bf16 v26, v106, v22, v26
v_dot2_f32_bf16 v26, v107, v23, v26
v_add_f32_dpp v35, v31, v31 quad_perm:[2,3,0,1] row_mask:0xf bank_mask:0xf
v_cndmask_b32 v32, v34, v35, s[48:49]
v_add_f32_dpp v28, v25, v25 row_ror:8 row_mask:0xf bank_mask:0xc
s_cbranch_vccnz L_A_w28
s_waitcnt vmcnt(5)
L_A_w28:
s_waitcnt vmcnt(7)
buffer_load_dwordx4 v[76:79], v9, s[44:47], s36 offen offset:3072 nt
ds_add_u32 v192, v193 offset:256
v_dot2_f32_bf16 v27, v108, v20, 0
v_dot2_f32_bf16 v27, v109, v21, v27
v_dot2_f32_bf16 v27, v110, v22, v27
v_dot2_f32_bf16 v27, v111, v23, v27
v_add_f32_dpp v30, v28, v28 row_shl:4 row_mask:0xf bank_mask:0x5
s_nop 2
v_add_f32_dpp v28, v26, v26 row_ror:8 row_mask:0xf bank_mask:0x3
s_nop 1
v_add_f32_dpp v28, v27, v27 row_ror:8 row_mask:0xf bank_mask:0xc
s_nop 2
s_nop 1
v_add_f32_dpp v31, v28, v28 row_shl:4 row_mask:0xf bank_mask:0x5
s_nop 2
v_add_f32_dpp v34, v30, v30 quad_perm:[2,3,0,1] row_mask:0xf bank_mask:0xf
s_nop 1
v_add_f32_dpp v35, v31, v31 quad_perm:[2,3,0,1] row_mask:0xf bank_mask:0xf
v_cndmask_b32 v33, v34, v35, s[48:49]
s_nop 2
v_add_f32_dpp v34, v32, v32 quad_perm:[1,0,3,2] row_mask:0xf bank_mask:0xf
v_mov_b32 v36, v37
v_mov_b32 v37, v38
v_mov_b32 v38, v39
v_mov_b32 v39, v40
v_mov_b32 v40, v41
v_mov_b32 v41, v42
v_mov_b32 v42, v43
v_mov_b32 v43, v44
v_mov_b32 v44, v45
v_mov_b32 v45, v46
s_nop 1
v_add_f32_dpp v35, v33, v33 quad_perm:[1,0,3,2] row_mask:0xf bank_mask:0xf
v_cndmask_b32 v46, v34, v35, s[50:51]
v_mov_b32 v60, 0xff800000
v_cndmask_b32 v46, v60, v46, s[52:53]
v_max3_f32 v60, v36, v37, v38
v_max3_f32 v60, v60, v39, v40
v_max3_f32 v60, v60, v41, v42
v_max3_f32 v60, v60, v43, v44
v_max3_f32 v60, v60, v45, v46
s_waitcnt vmcnt(5)
s_add_u32 s36, s36, 0x18000
buffer_load_dwordx4 v[80:83], v8, s[44:47], s36 offen offset:0 nt
s_nop 1
v_max_f32_dpp v60, v60, v60 quad_perm:[1,0,3,2] row_mask:0xf bank_mask:0xf
s_nop 1
v_max_f32_dpp v60, v60, v60 row_ror:4 row_mask:0xf bank_mask:0xf
s_nop 1
v_max_f32_dpp v60, v60, v60 row_ror:8 row_mask:0xf bank_mask:0xf
v_mov_b32 v34, v60
s_nop 1
v_permlane16_swap_b32 v60, v34
s_nop 0
v_max_f32 v60, v60, v34
v_mov_b32 v34, v60
s_nop 1
v_permlane32_swap_b32 v60, v34
s_nop 0
v_max_f32 v60, v60, v34
s_mov_b32 s62, 0x3e0293ee
v_mul_f32 v60, s62, v60
s_waitcnt vmcnt(5)
buffer_load_dwordx4 v[84:87], v8, s[44:47], s36 offen offset:1024 nt
ds_add_u32 v192, v193 offset:256
v_fma_f32 v36, v36, s62, -v60
v_fma_f32 v37, v37, s62, -v60
v_fma_f32 v38, v38, s62, -v60
v_fma_f32 v39, v39, s62, -v60
v_fma_f32 v40, v40, s62, -v60
v_fma_f32 v41, v41, s62, -v60
v_fma_f32 v42, v42, s62, -v60
v_fma_f32 v43, v43, s62, -v60
v_fma_f32 v44, v44, s62, -v60
v_fma_f32 v45, v45, s62, -v60
v_fma_f32 v46, v46, s62, -v60
v_exp_f32 v36, v36
v_exp_f32 v37, v37
v_exp_f32 v38, v38
v_exp_f32 v39, v39
v_exp_f32 v40, v40
v_exp_f32 v41, v41
v_exp_f32 v42, v42
v_exp_f32 v43, v43
v_exp_f32 v44, v44
v_exp_f32 v45, v45
v_exp_f32 v46, v46
s_waitcnt vmcnt(5)
buffer_load_dwordx4 v[88:91], v8, s[44:47], s36 offen offset:2048 nt
v_add_f32 v61, v36, v37
v_add_f32 v61, v61, v38
v_add_f32 v61, v61, v39
v_add_f32 v61, v61, v40
v_add_f32 v61, v61, v41
v_add_f32 v61, v61, v42
v_add_f32 v61, v61, v43
v_add_f32 v61, v61, v44
v_add_f32 v61, v61, v45
v_add_f32 v61, v61, v46
v_cvt_pk_bf16_f32 v36, v36, v36
v_cvt_pk_bf16_f32 v37, v37, v37
v_cvt_pk_bf16_f32 v38, v38, v38
v_cvt_pk_bf16_f32 v39, v39, v39
v_cvt_pk_bf16_f32 v40, v40, v40
v_cvt_pk_bf16_f32 v41, v41, v41
v_cvt_pk_bf16_f32 v42, v42, v42
v_cvt_pk_bf16_f32 v43, v43, v43
v_cvt_pk_bf16_f32 v44, v44, v44
v_cvt_pk_bf16_f32 v45, v45, v45
v_cvt_pk_bf16_f32 v46, v46, v46
s_waitcnt vmcnt(5)
buffer_load_dwordx4 v[92:95], v8, s[44:47], s36 offen offset:3072 nt
ds_add_u32 v192, v193 offset:256
s_nop 1
v_add_f32_dpp v61, v61, v61 quad_perm:[1,0,3,2] row_mask:0xf bank_mask:0xf
s_nop 1
v_add_f32_dpp v61, v61, v61 row_ror:4 row_mask:0xf bank_mask:0xf
s_nop 1
v_add_f32_dpp v61, v61, v61 row_ror:8 row_mask:0xf bank_mask:0xf
v_mov_b32 v34, v61
s_nop 1
v_permlane16_swap_b32 v61, v34
s_nop 0
v_add_f32 v61, v61, v34
v_mov_b32 v34, v61
s_nop 1
v_permlane32_swap_b32 v61, v34
s_nop 0
v_add_f32 v61, v61, v34
s_lshl_b32 s62, s34, 2
v_lshl_add_u32 v62, v1, 3, s62
v_mov_b32 v63, 1
s_mov_b64 exec, 5
ds_write_b32 v62, v60 offset:64
ds_write_b32 v62, v61 offset:96
s_mov_b64 exec, 1
ds_add_u32 v47, v63 offset:4
s_mov_b64 exec, -1
v_and_b32_dpp v52, v36, v4 row_newbcast:0 row_mask:0xf bank_mask:0xf
v_and_b32_dpp v53, v36, v5 row_newbcast:0 row_mask:0xf bank_mask:0xf
v_and_b32_dpp v54, v36, v6 row_newbcast:0 row_mask:0xf bank_mask:0xf
v_and_b32_dpp v55, v36, v7 row_newbcast:0 row_mask:0xf bank_mask:0xf
s_mov_b32 s38, 9
.p2align 6
L_A_va:
s_cbranch_vccnz L_A_w29
s_waitcnt vmcnt(5)
L_A_w29:
s_waitcnt vmcnt(7)
buffer_load_dwordx4 v[96:99], v9, s[44:47], s36 offen offset:0 nt
v_mfma_f32_16x16x32_bf16 v[48:51], v[52:55], v[112:115], v[48:51]
ds_read_b32 v194, v47 offset:8
v_and_b32_dpp v56, v36, v4 row_newbcast:8 row_mask:0xf bank_mask:0xf
v_and_b32_dpp v57, v36, v5 row_newbcast:8 row_mask:0xf bank_mask:0xf
v_and_b32_dpp v58, v36, v6 row_newbcast:8 row_mask:0xf bank_mask:0xf
v_and_b32_dpp v59, v36, v7 row_newbcast:8 row_mask:0xf bank_mask:0xf
s_cbranch_vccnz L_A_w30
s_waitcnt vmcnt(5)
L_A_w30:
s_waitcnt vmcnt(7)
buffer_load_dwordx4 v[100:103], v9, s[44:47], s36 offen offset:1024 nt
ds_add_u32 v192, v193 offset:256
v_mfma_f32_16x16x32_bf16 v[48:51], v[56:59], v[116:119], v[48:51]
s_waitcnt lgkmcnt(1)
v_cmp_ne_u32 vcc, 0, v194
v_and_b32_dpp v52, v36, v4 row_newbcast:4 row_mask:0xf bank_mask:0xf
v_and_b32_dpp v53, v36, v5 row_newbcast:4 row_mask:0xf bank_mask:0xf
v_and_b32_dpp v54, v36, v6 row_newbcast:4 row_mask:0xf bank_mask:0xf
v_and_b32_dpp v55, v36, v7 row_newbcast:4 row_mask:0xf bank_mask:0xf
s_cbranch_vccnz L_A_w31
s_waitcnt vmcnt(5)
L_A_w31:
s_waitcnt vmcnt(7)
buffer_load_dwordx4 v[104:107], v9, s[44:47], s36 offen offset:2048 nt
v_mfma_f32_16x16x32_bf16 v[48:51], v[52:55], v[120:123], v[48:51]
v_and_b32_dpp v56, v36, v4 row_newbcast:12 row_mask:0xf bank_mask:0xf
v_and_b32_dpp v57, v36, v5 row_newbcast:12 row_mask:0xf bank_mask:0xf
v_and_b32_dpp v58, v36, v6 row_newbcast:12 row_mask:0xf bank_mask:0xf
v_and_b32_dpp v59, v36, v7 row_newbcast:12 row_mask:0xf bank_mask:0xf
s_cbranch_vccnz L_A_w32
s_waitcnt vmcnt(5)
L_A_w32:
s_waitcnt vmcnt(7)
buffer_load_dwordx4 v[108:111], v9, s[44:47], s36 offen offset:3072 nt
ds_add_u32 v192, v193 offset:256
v_mfma_f32_16x16x32_bf16 v[48:51], v[56:59], v[124:127], v[48:51]
v_and_b32_dpp v52, v36, v12 row_newbcast:2 row_mask:0xf bank_mask:0xf
v_and_b32_dpp v53, v36, v13 row_newbcast:2 row_mask:0xf bank_mask:0xf
v_and_b32_dpp v54, v36, v14 row_newbcast:2 row_mask:0xf bank_mask:0xf
v_and_b32_dpp v55, v36, v15 row_newbcast:2 row_mask:0xf bank_mask:0xf
s_cbranch_vccnz L_A_w33
s_waitcnt vmcnt(5)
L_A_w33:
s_waitcnt vmcnt(7)
s_add_u32 s36, s36, 0x18000
buffer_load_dwordx4 v[112:115], v8, s[44:47], s36 offen offset:0 nt
v_mfma_f32_16x16x32_bf16 v[48:51], v[52:55], v[64:67], v[48:51]
v_and_b32_dpp v56, v36, v12 row_newbcast:10 row_mask:0xf bank_mask:0xf
v_and_b32_dpp v57, v36, v13 row_newbcast:10 row_mask:0xf bank_mask:0xf
v_and_b32_dpp v58, v36, v14 row_newbcast:10 row_mask:0xf bank_mask:0xf
v_and_b32_dpp v59, v36, v15 row_newbcast:10 row_mask:0xf bank_mask:0xf
s_cbranch_vccnz L_A_w34
s_waitcnt vmcnt(5)
L_A_w34:
s_waitcnt vmcnt(7)
buffer_load_dwordx4 v[116:119], v8, s[44:47], s36 offen offset:1024 nt
ds_add_u32 v192, v193 offset:256
v_mfma_f32_16x16x32_bf16 v[48:51], v[56:59], v[68:71], v[48:51]
v_and_b32_dpp v52, v36, v12 row_newbcast:6 row_mask:0xf bank_mask:0xf
v_and_b32_dpp v53, v36, v13 row_newbcast:6 row_mask:0xf bank_mask:0xf
v_and_b32_dpp v54, v36, v14 row_newbcast:6 row_mask:0xf bank_mask:0xf
v_and_b32_dpp v55, v36, v15 row_newbcast:6 row_mask:0xf bank_mask:0xf
s_cbranch_vccnz L_A_w35
s_waitcnt vmcnt(5)
L_A_w35:
s_waitcnt vmcnt(7)
buffer_load_dwordx4 v[120:123], v8, s[44:47], s36 offen offset:2048 nt
v_mfma_f32_16x16x32_bf16 v[48:51], v[52:55], v[72:75], v[48:51]
v_and_b32_dpp v56, v36, v12 row_newbcast:14 row_mask:0xf bank_mask:0xf
v_and_b32_dpp v57, v36, v13 row_newbcast:14 row_mask:0xf bank_mask:0xf
v_and_b32_dpp v58, v36, v14 row_newbcast:14 row_mask:0xf bank_mask:0xf
v_and_b32_dpp v59, v36, v15 row_newbcast:14 row_mask:0xf bank_mask:0xf
s_cbranch_vccnz L_A_w36
s_waitcnt vmcnt(5)
L_A_w36:
s_waitcnt vmcnt(7)
buffer_load_dwordx4 v[124:127], v8, s[44:47], s36 offen offset:3072 nt
ds_add_u32 v192, v193 offset:256
v_mfma_f32_16x16x32_bf16 v[48:51], v[56:59], v[76:79], v[48:51]
v_and_b32_dpp v52, v36, v4 row_newbcast:1 row_mask:0xf bank_mask:0xf
v_and_b32_dpp v53, v36, v5 row_newbcast:1 row_mask:0xf bank_mask:0xf
v_and_b32_dpp v54, v36, v6 row_newbcast:1 row_mask:0xf bank_mask:0xf
v_and_b32_dpp v55, v36, v7 row_newbcast:1 row_mask:0xf bank_mask:0xf
s_cbranch_vccnz L_A_w37
s_waitcnt vmcnt(5)
L_A_w37:
s_waitcnt vmcnt(7)
buffer_load_dwordx4 v[64:67], v9, s[44:47], s36 offen offset:0 nt
v_mfma_f32_16x16x32_bf16 v[48:51], v[52:55], v[80:83], v[48:51]
ds_read_b32 v194, v47 offset:8
v_and_b32_dpp v56, v36, v4 row_newbcast:9 row_mask:0xf bank_mask:0xf
v_and_b32_dpp v57, v36, v5 row_newbcast:9 row_mask:0xf bank_mask:0xf
v_and_b32_dpp v58, v36, v6 row_newbcast:9 row_mask:0xf bank_mask:0xf
v_and_b32_dpp v59, v36, v7 row_newbcast:9 row_mask:0xf bank_mask:0xf
s_cbranch_vccnz L_A_w38
s_waitcnt vmcnt(5)
L_A_w38:
s_waitcnt vmcnt(7)
buffer_load_dwordx4 v[68:71], v9, s[44:47], s36 offen offset:1024 nt
ds_add_u32 v192, v193 offset:256
v_mfma_f32_16x16x32_bf16 v[48:51], v[56:59], v[84:87], v[48:51]
s_waitcnt lgkmcnt(1)
v_cmp_ne_u32 vcc, 0, v194
v_and_b32_dpp v52, v36, v4 row_newbcast:5 row_mask:0xf bank_mask:0xf
v_and_b32_dpp v53, v36, v5 row_newbcast:5 row_mask:0xf bank_mask:0xf
v_and_b32_dpp v54, v36, v6 row_newbcast:5 row_mask:0xf bank_mask:0xf
v_and_b32_dpp v55, v36, v7 row_newbcast:5 row_mask:0xf bank_mask:0xf
s_cbranch_vccnz L_A_w39
s_waitcnt vmcnt(5)
L_A_w39:
s_waitcnt vmcnt(7)
buffer_load_dwordx4 v[72:75], v9, s[44:47], s36 offen offset:2048 nt
v_mfma_f32_16x16x32_bf16 v[48:51], v[52:55], v[88:91], v[48:51]
v_and_b32_dpp v56, v36, v4 row_newbcast:13 row_mask:0xf bank_mask:0xf
v_and_b32_dpp v57, v36, v5 row_newbcast:13 row_mask:0xf bank_mask:0xf
v_and_b32_dpp v58, v36, v6 row_newbcast:13 row_mask:0xf bank_mask:0xf
v_and_b32_dpp v59, v36, v7 row_newbcast:13 row_mask:0xf bank_mask:0xf
s_cbranch_vccnz L_A_w40
s_waitcnt vmcnt(5)
L_A_w40:
s_waitcnt vmcnt(7)
buffer_load_dwordx4 v[76:79], v9, s[44:47], s36 offen offset:3072 nt
ds_add_u32 v192, v193 offset:256
v_mfma_f32_16x16x32_bf16 v[48:51], v[56:59], v[92:95], v[48:51]
v_and_b32_dpp v52, v36, v12 row_newbcast:3 row_mask:0xf bank_mask:0xf
v_and_b32_dpp v53, v36, v13 row_newbcast:3 row_mask:0xf bank_mask:0xf
v_and_b32_dpp v54, v36, v14 row_newbcast:3 row_mask:0xf bank_mask:0xf
v_and_b32_dpp v55, v36, v15 row_newbcast:3 row_mask:0xf bank_mask:0xf
s_cbranch_vccnz L_A_w41
s_waitcnt vmcnt(5)
L_A_w41:
s_waitcnt vmcnt(7)
s_add_u32 s36, s36, 0x18000
buffer_load_dwordx4 v[80:83], v8, s[44:47], s36 offen offset:0 nt
v_mfma_f32_16x16x32_bf16 v[48:51], v[52:55], v[96:99], v[48:51]
v_and_b32_dpp v56, v36, v12 row_newbcast:11 row_mask:0xf bank_mask:0xf
v_and_b32_dpp v57, v36, v13 row_newbcast:11 row_mask:0xf bank_mask:0xf
v_and_b32_dpp v58, v36, v14 row_newbcast:11 row_mask:0xf bank_mask:0xf
v_and_b32_dpp v59, v36, v15 row_newbcast:11 row_mask:0xf bank_mask:0xf
s_cbranch_vccnz L_A_w42
s_waitcnt vmcnt(5)
L_A_w42:
s_waitcnt vmcnt(7)
buffer_load_dwordx4 v[84:87], v8, s[44:47], s36 offen offset:1024 nt
ds_add_u32 v192, v193 offset:256
v_mfma_f32_16x16x32_bf16 v[48:51], v[56:59], v[100:103], v[48:51]
v_and_b32_dpp v52, v36, v12 row_newbcast:7 row_mask:0xf bank_mask:0xf
v_and_b32_dpp v53, v36, v13 row_newbcast:7 row_mask:0xf bank_mask:0xf
v_and_b32_dpp v54, v36, v14 row_newbcast:7 row_mask:0xf bank_mask:0xf
v_and_b32_dpp v55, v36, v15 row_newbcast:7 row_mask:0xf bank_mask:0xf
s_cbranch_vccnz L_A_w43
s_waitcnt vmcnt(5)
L_A_w43:
s_waitcnt vmcnt(7)
buffer_load_dwordx4 v[88:91], v8, s[44:47], s36 offen offset:2048 nt
v_mfma_f32_16x16x32_bf16 v[48:51], v[52:55], v[104:107], v[48:51]
v_and_b32_dpp v56, v36, v12 row_newbcast:15 row_mask:0xf bank_mask:0xf
v_and_b32_dpp v57, v36, v13 row_newbcast:15 row_mask:0xf bank_mask:0xf
v_and_b32_dpp v58, v36, v14 row_newbcast:15 row_mask:0xf bank_mask:0xf
v_and_b32_dpp v59, v36, v15 row_newbcast:15 row_mask:0xf bank_mask:0xf
s_cbranch_vccnz L_A_w44
s_waitcnt vmcnt(5)
L_A_w44:
s_waitcnt vmcnt(7)
buffer_load_dwordx4 v[92:95], v8, s[44:47], s36 offen offset:3072 nt
ds_add_u32 v192, v193 offset:256
v_mfma_f32_16x16x32_bf16 v[48:51], v[56:59], v[108:111], v[48:51]
v_mov_b32 v36, v37
v_mov_b32 v37, v38
v_mov_b32 v38, v39
v_mov_b32 v39, v40
v_mov_b32 v40, v41
v_mov_b32 v41, v42
v_mov_b32 v42, v43
v_mov_b32 v43, v44
v_mov_b32 v44, v45
v_mov_b32 v45, v46
v_and_b32_dpp v52, v36, v4 row_newbcast:0 row_mask:0xf bank_mask:0xf
v_and_b32_dpp v53, v36, v5 row_newbcast:0 row_mask:0xf bank_mask:0xf
v_and_b32_dpp v54, v36, v6 row_newbcast:0 row_mask:0xf bank_mask:0xf
v_and_b32_dpp v55, v36, v7 row_newbcast:0 row_mask:0xf bank_mask:0xf
s_sub_u32 s38, s38, 1
s_cmp_lg_u32 s38, 0
s_cbranch_scc1 L_A_va
s_waitcnt vmcnt(8)
buffer_load_dwordx4 v[96:99], v9, s[44:47], s36 offen offset:0 nt
v_mfma_f32_16x16x32_bf16 v[48:51], v[52:55], v[112:115], v[48:51]
v_and_b32_dpp v56, v36, v4 row_newbcast:8 row_mask:0xf bank_mask:0xf
v_and_b32_dpp v57, v36, v5 row_newbcast:8 row_mask:0xf bank_mask:0xf
v_and_b32_dpp v58, v36, v6 row_newbcast:8 row_mask:0xf bank_mask:0xf
v_and_b32_dpp v59, v36, v7 row_newbcast:8 row_mask:0xf bank_mask:0xf
s_mov_b32 s64, 0
L_A_sw:
ds_read_b32 v60, v47 offset:4
s_waitcnt lgkmcnt(0)
v_readfirstlane_b32 s65, v60
s_add_u32 s64, s64, 1
s_nop 2
s_cmp_ge_u32 s65, 4
s_cbranch_scc1 L_A_sw_ok
s_sleep 1
s_cmp_lt_u32 s64, 1048576
s_cbranch_scc1 L_A_sw
L_A_sw_ok:
v_lshrrev_b32 v60, 1, v3
v_lshlrev_b32 v60, 4, v60
s_lshl_b32 s62, s34, 2
v_add_u32 v61, s62, v60
ds_read_b128 v[24:27], v60 offset:64
ds_read_b32 v63, v61 offset:64
s_waitcnt vmcnt(8)
buffer_load_dwordx4 v[100:103], v9, s[44:47], s36 offen offset:1024 nt
ds_add_u32 v192, v193 offset:256
v_mfma_f32_16x16x32_bf16 v[48:51], v[56:59], v[116:119], v[48:51]
v_and_b32_dpp v52, v36, v4 row_newbcast:4 row_mask:0xf bank_mask:0xf
v_and_b32_dpp v53, v36, v5 row_newbcast:4 row_mask:0xf bank_mask:0xf
v_and_b32_dpp v54, v36, v6 row_newbcast:4 row_mask:0xf bank_mask:0xf
v_and_b32_dpp v55, v36, v7 row_newbcast:4 row_mask:0xf bank_mask:0xf
s_waitcnt vmcnt(8)
buffer_load_dwordx4 v[104:107], v9, s[44:47], s36 offen offset:2048 nt
v_mfma_f32_16x16x32_bf16 v[48:51], v[52:55], v[120:123], v[48:51]
v_and_b32_dpp v56, v36, v4 row_newbcast:12 row_mask:0xf bank_mask:0xf
v_and_b32_dpp v57, v36, v5 row_newbcast:12 row_mask:0xf bank_mask:0xf
v_and_b32_dpp v58, v36, v6 row_newbcast:12 row_mask:0xf bank_mask:0xf
v_and_b32_dpp v59, v36, v7 row_newbcast:12 row_mask:0xf bank_mask:0xf
s_waitcnt lgkmcnt(0)
v_max3_f32 v60, v24, v25, v26
v_max_f32 v60, v60, v27
v_sub_f32 v63, v63, v60
v_exp_f32 v63, v63
v_lshrrev_b32 v62, 1, v3
v_mul_u32_u24 v62, 1088, v62
v_lshl_add_u32 v62, v2, 4, v62
v_and_b32 v61, 1, v3
v_lshl_add_u32 v62, v61, 3, v62
s_mul_i32 s62, s34, 272
v_add_u32 v62, s62, v62
s_waitcnt vmcnt(8)
buffer_load_dwordx4 v[108:111], v9, s[44:47], s36 offen offset:3072 nt
ds_add_u32 v192, v193 offset:256
v_mfma_f32_16x16x32_bf16 v[48:51], v[56:59], v[124:127], v[48:51]
v_and_b32_dpp v52, v36, v12 row_newbcast:2 row_mask:0xf bank_mask:0xf
v_and_b32_dpp v53, v36, v13 row_newbcast:2 row_mask:0xf bank_mask:0xf
v_and_b32_dpp v54, v36, v14 row_newbcast:2 row_mask:0xf bank_mask:0xf
v_and_b32_dpp v55, v36, v15 row_newbcast:2 row_mask:0xf bank_mask:0xf
s_waitcnt vmcnt(8)
s_add_u32 s36, s36, 0x18000
buffer_load_dwordx4 v[112:115], v8, s[44:47], s36 offen offset:0 nt
v_mfma_f32_16x16x32_bf16 v[48:51], v[52:55], v[64:67], v[48:51]
v_and_b32_dpp v56, v36, v12 row_newbcast:10 row_mask:0xf bank_mask:0xf
v_and_b32_dpp v57, v36, v13 row_newbcast:10 row_mask:0xf bank_mask:0xf
v_and_b32_dpp v58, v36, v14 row_newbcast:10 row_mask:0xf bank_mask:0xf
v_and_b32_dpp v59, v36, v15 row_newbcast:10 row_mask:0xf bank_mask:0xf
s_waitcnt vmcnt(8)
buffer_load_dwordx4 v[116:119], v8, s[44:47], s36 offen offset:1024 nt
ds_add_u32 v192, v193 offset:256
v_mfma_f32_16x16x32_bf16 v[48:51], v[56:59], v[68:71], v[48:51]
v_and_b32_dpp v52, v36, v12 row_newbcast:6 row_mask:0xf bank_mask:0xf
v_and_b32_dpp v53, v36, v13 row_newbcast:6 row_mask:0xf bank_mask:0xf
v_and_b32_dpp v54, v36, v14 row_newbcast:6 row_mask:0xf bank_mask:0xf
v_and_b32_dpp v55, v36, v15 row_newbcast:6 row_mask:0xf bank_mask:0xf
s_waitcnt vmcnt(8)
buffer_load_dwordx4 v[120:123], v8, s[44:47], s36 offen offset:2048 nt
v_mfma_f32_16x16x32_bf16 v[48:51], v[52:55], v[72:75], v[48:51]
v_and_b32_dpp v56, v36, v12 row_newbcast:14 row_mask:0xf bank_mask:0xf
v_and_b32_dpp v57, v36, v13 row_newbcast:14 row_mask:0xf bank_mask:0xf
v_and_b32_dpp v58, v36, v14 row_newbcast:14 row_mask:0xf bank_mask:0xf
v_and_b32_dpp v59, v36, v15 row_newbcast:14 row_mask:0xf bank_mask:0xf
s_waitcnt vmcnt(8)
buffer_load_dwordx4 v[124:127], v8, s[44:47], s36 offen offset:3072 nt
ds_add_u32 v192, v193 offset:256
v_mfma_f32_16x16x32_bf16 v[48:51], v[56:59], v[76:79], v[48:51]
v_and_b32_dpp v52, v36, v4 row_newbcast:1 row_mask:0xf bank_mask:0xf
v_and_b32_dpp v53, v36, v5 row_newbcast:1 row_mask:0xf bank_mask:0xf
v_and_b32_dpp v54, v36, v6 row_newbcast:1 row_mask:0xf bank_mask:0xf
v_and_b32_dpp v55, v36, v7 row_newbcast:1 row_mask:0xf bank_mask:0xf
s_waitcnt vmcnt(8)
buffer_load_dwordx4 v[64:67], v9, s[44:47], s36 offen offset:0 nt
v_mfma_f32_16x16x32_bf16 v[48:51], v[52:55], v[80:83], v[48:51]
v_and_b32_dpp v56, v36, v4 row_newbcast:9 row_mask:0xf bank_mask:0xf
v_and_b32_dpp v57, v36, v5 row_newbcast:9 row_mask:0xf bank_mask:0xf
v_and_b32_dpp v58, v36, v6 row_newbcast:9 row_mask:0xf bank_mask:0xf
v_and_b32_dpp v59, v36, v7 row_newbcast:9 row_mask:0xf bank_mask:0xf
s_waitcnt vmcnt(8)
buffer_load_dwordx4 v[68:71], v9, s[44:47], s36 offen offset:1024 nt
ds_add_u32 v192, v193 offset:256
v_mfma_f32_16x16x32_bf16 v[48:51], v[56:59], v[84:87], v[48:51]
v_and_b32_dpp v52, v36, v4 row_newbcast:5 row_mask:0xf bank_mask:0xf
v_and_b32_dpp v53, v36, v5 row_newbcast:5 row_mask:0xf bank_mask:0xf
v_and_b32_dpp v54, v36, v6 row_newbcast:5 row_mask:0xf bank_mask:0xf
v_and_b32_dpp v55, v36, v7 row_newbcast:5 row_mask:0xf bank_mask:0xf
s_waitcnt vmcnt(8)
buffer_load_dwordx4 v[72:75], v9, s[44:47], s36 offen offset:2048 nt
v_mfma_f32_16x16x32_bf16 v[48:51], v[52:55], v[88:91], v[48:51]
v_and_b32_dpp v56, v36, v4 row_newbcast:13 row_mask:0xf bank_mask:0xf
v_and_b32_dpp v57, v36, v5 row_newbcast:13 row_mask:0xf bank_mask:0xf
v_and_b32_dpp v58, v36, v6 row_newbcast:13 row_mask:0xf bank_mask:0xf
v_and_b32_dpp v59, v36, v7 row_newbcast:13 row_mask:0xf bank_mask:0xf
s_waitcnt vmcnt(8)
buffer_load_dwordx4 v[76:79], v9, s[44:47], s36 offen offset:3072 nt
ds_add_u32 v192, v193 offset:256
v_mfma_f32_16x16x32_bf16 v[48:51], v[56:59], v[92:95], v[48:51]
v_and_b32_dpp v52, v36, v12 row_newbcast:3 row_mask:0xf bank_mask:0xf
v_and_b32_dpp v53, v36, v13 row_newbcast:3 row_mask:0xf bank_mask:0xf
v_and_b32_dpp v54, v36, v14 row_newbcast:3 row_mask:0xf bank_mask:0xf
v_and_b32_dpp v55, v36, v15 row_newbcast:3 row_mask:0xf bank_mask:0xf
s_waitcnt vmcnt(8)
buffer_load_dwordx4 v[80:83], v8, s[44:47], s37 offen nt
v_mfma_f32_16x16x32_bf16 v[48:51], v[52:55], v[96:99], v[48:51]
v_and_b32_dpp v56, v36, v12 row_newbcast:11 row_mask:0xf bank_mask:0xf
v_and_b32_dpp v57, v36, v13 row_newbcast:11 row_mask:0xf bank_mask:0xf
v_and_b32_dpp v58, v36, v14 row_newbcast:11 row_mask:0xf bank_mask:0xf
v_and_b32_dpp v59, v36, v15 row_newbcast:11 row_mask:0xf bank_mask:0xf
s_waitcnt vmcnt(8)
buffer_load_dwordx4 v[84:87], v10, s[44:47], s37 offen nt
ds_add_u32 v192, v193 offset:256
v_mfma_f32_16x16x32_bf16 v[48:51], v[56:59], v[100:103], v[48:51]
v_and_b32_dpp v52, v36, v12 row_newbcast:7 row_mask:0xf bank_mask:0xf
v_and_b32_dpp v53, v36, v13 row_newbcast:7 row_mask:0xf bank_mask:0xf
v_and_b32_dpp v54, v36, v14 row_newbcast:7 row_mask:0xf bank_mask:0xf
v_and_b32_dpp v55, v36, v15 row_newbcast:7 row_mask:0xf bank_mask:0xf
s_waitcnt vmcnt(8)
buffer_load_dwordx4 v[88:91], v9, s[44:47], s37 offen nt
v_mfma_f32_16x16x32_bf16 v[48:51], v[52:55], v[104:107], v[48:51]
v_and_b32_dpp v56, v36, v12 row_newbcast:15 row_mask:0xf bank_mask:0xf
v_and_b32_dpp v57, v36, v13 row_newbcast:15 row_mask:0xf bank_mask:0xf
v_and_b32_dpp v58, v36, v14 row_newbcast:15 row_mask:0xf bank_mask:0xf
v_and_b32_dpp v59, v36, v15 row_newbcast:15 row_mask:0xf bank_mask:0xf
s_waitcnt vmcnt(8)
buffer_load_dwordx4 v[92:95], v11, s[44:47], s37 offen nt
ds_add_u32 v192, v193 offset:256
v_mfma_f32_16x16x32_bf16 v[48:51], v[56:59], v[108:111], v[48:51]
v_mov_b32 v36, v37
v_mov_b32 v37, v38
v_mov_b32 v38, v39
v_mov_b32 v39, v40
v_mov_b32 v40, v41
v_mov_b32 v41, v42
v_mov_b32 v42, v43
v_mov_b32 v43, v44
v_mov_b32 v44, v45
v_mov_b32 v45, v46
v_and_b32_dpp v52, v36, v4 row_newbcast:0 row_mask:0xf bank_mask:0xf
v_and_b32_dpp v53, v36, v5 row_newbcast:0 row_mask:0xf bank_mask:0xf
v_and_b32_dpp v54, v36, v6 row_newbcast:0 row_mask:0xf bank_mask:0xf
v_and_b32_dpp v55, v36, v7 row_newbcast:0 row_mask:0xf bank_mask:0xf
s_nop 0
s_nop 0
v_mfma_f32_16x16x32_bf16 v[48:51], v[52:55], v[112:115], v[48:51]
v_and_b32_dpp v56, v36, v4 row_newbcast:8 row_mask:0xf bank_mask:0xf
v_and_b32_dpp v57, v36, v5 row_newbcast:8 row_mask:0xf bank_mask:0xf
v_and_b32_dpp v58, v36, v6 row_newbcast:8 row_mask:0xf bank_mask:0xf
v_and_b32_dpp v59, v36, v7 row_newbcast:8 row_mask:0xf bank_mask:0xf
s_nop 0
s_nop 0
v_mfma_f32_16x16x32_bf16 v[48:51], v[56:59], v[116:119], v[48:51]
v_and_b32_dpp v52, v36, v4 row_newbcast:4 row_mask:0xf bank_mask:0xf
v_and_b32_dpp v53, v36, v5 row_newbcast:4 row_mask:0xf bank_mask:0xf
v_and_b32_dpp v54, v36, v6 row_newbcast:4 row_mask:0xf bank_mask:0xf
v_and_b32_dpp v55, v36, v7 row_newbcast:4 row_mask:0xf bank_mask:0xf
s_nop 0
s_nop 0
v_mfma_f32_16x16x32_bf16 v[48:51], v[52:55], v[120:123], v[48:51]
v_and_b32_dpp v56, v36, v4 row_newbcast:12 row_mask:0xf bank_mask:0xf
v_and_b32_dpp v57, v36, v5 row_newbcast:12 row_mask:0xf bank_mask:0xf
v_and_b32_dpp v58, v36, v6 row_newbcast:12 row_mask:0xf bank_mask:0xf
v_and_b32_dpp v59, v36, v7 row_newbcast:12 row_mask:0xf bank_mask:0xf
s_waitcnt vmcnt(8)
s_nop 0
v_mfma_f32_16x16x32_bf16 v[48:51], v[56:59], v[124:127], v[48:51]
v_and_b32_dpp v52, v36, v12 row_newbcast:2 row_mask:0xf bank_mask:0xf
v_and_b32_dpp v53, v36, v13 row_newbcast:2 row_mask:0xf bank_mask:0xf
v_and_b32_dpp v54, v36, v14 row_newbcast:2 row_mask:0xf bank_mask:0xf
v_and_b32_dpp v55, v36, v15 row_newbcast:2 row_mask:0xf bank_mask:0xf
s_waitcnt vmcnt(7)
s_nop 0
v_mfma_f32_16x16x32_bf16 v[48:51], v[52:55], v[64:67], v[48:51]
v_and_b32_dpp v56, v36, v12 row_newbcast:10 row_mask:0xf bank_mask:0xf
v_and_b32_dpp v57, v36, v13 row_newbcast:10 row_mask:0xf bank_mask:0xf
v_and_b32_dpp v58, v36, v14 row_newbcast:10 row_mask:0xf bank_mask:0xf
v_and_b32_dpp v59, v36, v15 row_newbcast:10 row_mask:0xf bank_mask:0xf
s_waitcnt vmcnt(6)
s_nop 0
v_mfma_f32_16x16x32_bf16 v[48:51], v[56:59], v[68:71], v[48:51]
v_and_b32_dpp v52, v36, v12 row_newbcast:6 row_mask:0xf bank_mask:0xf
v_and_b32_dpp v53, v36, v13 row_newbcast:6 row_mask:0xf bank_mask:0xf
v_and_b32_dpp v54, v36, v14 row_newbcast:6 row_mask:0xf bank_mask:0xf
v_and_b32_dpp v55, v36, v15 row_newbcast:6 row_mask:0xf bank_mask:0xf
s_waitcnt vmcnt(5)
s_nop 0
v_mfma_f32_16x16x32_bf16 v[48:51], v[52:55], v[72:75], v[48:51]
v_and_b32_dpp v56, v36, v12 row_newbcast:14 row_mask:0xf bank_mask:0xf
v_and_b32_dpp v57, v36, v13 row_newbcast:14 row_mask:0xf bank_mask:0xf
v_and_b32_dpp v58, v36, v14 row_newbcast:14 row_mask:0xf bank_mask:0xf
v_and_b32_dpp v59, v36, v15 row_newbcast:14 row_mask:0xf bank_mask:0xf
s_waitcnt vmcnt(4)
s_nop 0
v_mfma_f32_16x16x32_bf16 v[48:51], v[56:59], v[76:79], v[48:51]
v_and_b32_dpp v52, v36, v4 row_newbcast:1 row_mask:0xf bank_mask:0xf
v_and_b32_dpp v53, v36, v5 row_newbcast:1 row_mask:0xf bank_mask:0xf
v_and_b32_dpp v54, v36, v6 row_newbcast:1 row_mask:0xf bank_mask:0xf
v_and_b32_dpp v55, v36, v7 row_newbcast:1 row_mask:0xf bank_mask:0xf
s_waitcnt vmcnt(3)
s_nop 0
v_mfma_f32_16x16x32_bf16 v[48:51], v[52:55], v[80:83], v[48:51]
v_and_b32_dpp v56, v36, v4 row_newbcast:9 row_mask:0xf bank_mask:0xf
v_and_b32_dpp v57, v36, v5 row_newbcast:9 row_mask:0xf bank_mask:0xf
v_and_b32_dpp v58, v36, v6 row_newbcast:9 row_mask:0xf bank_mask:0xf
v_and_b32_dpp v59, v36, v7 row_newbcast:9 row_mask:0xf bank_mask:0xf
s_waitcnt vmcnt(2)
s_nop 0
v_mfma_f32_16x16x32_bf16 v[48:51], v[56:59], v[84:87], v[48:51]
v_and_b32_dpp v52, v36, v12 row_newbcast:3 row_mask:0xf bank_mask:0xf
v_and_b32_dpp v53, v36, v13 row_newbcast:3 row_mask:0xf bank_mask:0xf
v_and_b32_dpp v54, v36, v14 row_newbcast:3 row_mask:0xf bank_mask:0xf
v_and_b32_dpp v55, v36, v15 row_newbcast:3 row_mask:0xf bank_mask:0xf
s_waitcnt vmcnt(1)
s_nop 0
v_mfma_f32_16x16x32_bf16 v[48:51], v[52:55], v[88:91], v[48:51]
v_and_b32_dpp v56, v36, v12 row_newbcast:11 row_mask:0xf bank_mask:0xf
v_and_b32_dpp v57, v36, v13 row_newbcast:11 row_mask:0xf bank_mask:0xf
v_and_b32_dpp v58, v36, v14 row_newbcast:11 row_mask:0xf bank_mask:0xf
v_and_b32_dpp v59, v36, v15 row_newbcast:11 row_mask:0xf bank_mask:0xf
s_waitcnt vmcnt(0)
s_nop 0
v_mfma_f32_16x16x32_bf16 v[48:51], v[56:59], v[92:95], v[48:51]
s_nop 7
v_mul_f32 v48, v48, v63
v_mul_f32 v49, v49, v63
v_mul_f32 v50, v50, v63
v_mul_f32 v51, v51, v63
v_cvt_pk_bf16_f32 v48, v48, v49
v_cvt_pk_bf16_f32 v49, v50, v51
ds_write_b64 v62, v[48:49] offset:8192
s_waitcnt lgkmcnt(0)
s_barrier
s_endpgm
L_A_helper:
s_sub_u32 s35, s34, 4
s_lshl_b32 s37, s32, 3
s_add_u32 s37, s37, s33
s_cmp_lg_u32 s35, 0
s_cbranch_scc1 L_A_noclr
s_lshl_b32 s63, s37, 10
s_add_u32 s63, s63, 0x100000
v_lshl_add_u32 v10, v1, 4, s63
v_add_u32 v11, 0x40000, v10
v_mov_b32 v44, -1
v_mov_b32 v45, -1
v_mov_b32 v46, -1
v_mov_b32 v47, -1
global_store_dwordx4 v10, v[44:47], s[30:31] sc1
global_store_dwordx4 v11, v[44:47], s[30:31] sc1
L_A_noclr:
s_lshl_b32 s62, s32, 17
s_mov_b32 s63, 0x20000
s_add_u32 s40, s12, s62
s_addc_u32 s41, s13, 0
s_and_b32 s41, s41, 0xffff
s_mov_b32 s42, s63
s_mov_b32 s43, 0x20000
v_lshlrev_b32 v9, 13, v3
v_lshl_add_u32 v9, v2, 4, v9
s_lshl_b32 s62, s35, 8
v_add_u32 v9, s62, v9
s_mov_b32 s61, 0
buffer_load_dwordx4 v[184:187], v9, s[40:43], s61 offen offset:0 nt
buffer_load_dwordx4 v[188:191], v9, s[40:43], s61 offen offset:1024 nt
buffer_load_dwordx4 v[192:195], v9, s[40:43], s61 offen offset:2048 nt
buffer_load_dwordx4 v[196:199], v9, s[40:43], s61 offen offset:3072 nt
v_mov_b32 v8, 0
v_mov_b32 v11, 0
ds_write_b32 v8, v8 offset:0
ds_write_b32 v8, v8 offset:4
ds_write_b32 v8, v8 offset:8
ds_write_b32 v8, v8 offset:256
s_waitcnt lgkmcnt(0)
s_barrier
s_load_dword s88, s[30:31], 0x18000
s_mov_b32 s66, 0x05040100
s_mov_b32 s67, 0x07060302
s_mov_b32 s44, s30
s_and_b32 s45, s31, 0xffff
s_mov_b32 s46, 0x1000000
s_mov_b32 s47, 0x20000
s_lshl_b32 s63, s32, 10
s_add_u32 s63, s63, 0x40000
v_lshl_add_u32 v10, v1, 4, s63
v_lshlrev_b32 v11, 3, v1
s_mov_b32 s38, s35
s_waitcnt lgkmcnt(0)
s_add_u32 s88, s88, 0x9e3779b9
s_waitcnt vmcnt(3)
s_mov_b32 s61, 4096
buffer_load_dwordx4 v[200:203], v9, s[40:43], s61 offen offset:0 nt
s_waitcnt vmcnt(3)
buffer_load_dwordx4 v[204:207], v9, s[40:43], s61 offen offset:1024 nt
v_perm_b32 v56, v188, v184, s66
v_perm_b32 v60, v188, v184, s67
v_perm_b32 v64, v189, v185, s66
v_perm_b32 v68, v189, v185, s67
v_perm_b32 v72, v190, v186, s66
v_perm_b32 v76, v190, v186, s67
v_perm_b32 v80, v191, v187, s66
v_perm_b32 v84, v191, v187, s67
s_waitcnt vmcnt(3)
buffer_load_dwordx4 v[208:211], v9, s[40:43], s61 offen offset:2048 nt
s_waitcnt vmcnt(3)
buffer_load_dwordx4 v[212:215], v9, s[40:43], s61 offen offset:3072 nt
v_perm_b32 v57, v196, v192, s66
v_perm_b32 v61, v196, v192, s67
v_perm_b32 v65, v197, v193, s66
v_perm_b32 v69, v197, v193, s67
v_perm_b32 v73, v198, v194, s66
v_perm_b32 v77, v198, v194, s67
v_perm_b32 v81, v199, v195, s66
v_perm_b32 v85, v199, v195, s67
s_waitcnt vmcnt(3)
s_mov_b32 s61, 32768
buffer_load_dwordx4 v[216:219], v9, s[40:43], s61 offen offset:0 nt
s_waitcnt vmcnt(3)
buffer_load_dwordx4 v[220:223], v9, s[40:43], s61 offen offset:1024 nt
v_perm_b32 v58, v204, v200, s66
v_perm_b32 v62, v204, v200, s67
v_perm_b32 v66, v205, v201, s66
v_perm_b32 v70, v205, v201, s67
v_perm_b32 v74, v206, v202, s66
v_perm_b32 v78, v206, v202, s67
v_perm_b32 v82, v207, v203, s66
v_perm_b32 v86, v207, v203, s67
s_waitcnt vmcnt(3)
buffer_load_dwordx4 v[224:227], v9, s[40:43], s61 offen offset:2048 nt
s_waitcnt vmcnt(3)
buffer_load_dwordx4 v[228:231], v9, s[40:43], s61 offen offset:3072 nt
v_perm_b32 v59, v212, v208, s66
v_perm_b32 v63, v212, v208, s67
v_perm_b32 v67, v213, v209, s66
v_perm_b32 v71, v213, v209, s67
v_perm_b32 v75, v214, v210, s66
v_perm_b32 v79, v214, v210, s67
v_perm_b32 v83, v215, v211, s66
v_perm_b32 v87, v215, v211, s67
s_waitcnt vmcnt(3)
s_mov_b32 s61, 36864
buffer_load_dwordx4 v[232:235], v9, s[40:43], s61 offen offset:0 nt
s_waitcnt vmcnt(3)
buffer_load_dwordx4 v[236:239], v9, s[40:43], s61 offen offset:1024 nt
v_perm_b32 v88, v220, v216, s66
v_perm_b32 v92, v220, v216, s67
v_perm_b32 v96, v221, v217, s66
v_perm_b32 v100, v221, v217, s67
v_perm_b32 v104, v222, v218, s66
v_perm_b32 v108, v222, v218, s67
v_perm_b32 v112, v223, v219, s66
v_perm_b32 v116, v223, v219, s67
s_waitcnt vmcnt(3)
buffer_load_dwordx4 v[240:243], v9, s[40:43], s61 offen offset:2048 nt
s_waitcnt vmcnt(3)
buffer_load_dwordx4 v[244:247], v9, s[40:43], s61 offen offset:3072 nt
v_perm_b32 v89, v228, v224, s66
v_perm_b32 v93, v228, v224, s67
v_perm_b32 v97, v229, v225, s66
v_perm_b32 v101, v229, v225, s67
v_perm_b32 v105, v230, v226, s66
v_perm_b32 v109, v230, v226, s67
v_perm_b32 v113, v231, v227, s66
v_perm_b32 v117, v231, v227, s67
s_waitcnt vmcnt(3)
s_mov_b32 s61, 65536
buffer_load_dwordx4 v[184:187], v9, s[40:43], s61 offen offset:0 nt
s_waitcnt vmcnt(3)
buffer_load_dwordx4 v[188:191], v9, s[40:43], s61 offen offset:1024 nt
v_perm_b32 v90, v236, v232, s66
v_perm_b32 v94, v236, v232, s67
v_perm_b32 v98, v237, v233, s66
v_perm_b32 v102, v237, v233, s67
v_perm_b32 v106, v238, v234, s66
v_perm_b32 v110, v238, v234, s67
v_perm_b32 v114, v239, v235, s66
v_perm_b32 v118, v239, v235, s67
s_waitcnt vmcnt(3)
buffer_load_dwordx4 v[192:195], v9, s[40:43], s61 offen offset:2048 nt
s_waitcnt vmcnt(3)
buffer_load_dwordx4 v[196:199], v9, s[40:43], s61 offen offset:3072 nt
v_perm_b32 v91, v244, v240, s66
v_perm_b32 v95, v244, v240, s67
v_perm_b32 v99, v245, v241, s66
v_perm_b32 v103, v245, v241, s67
v_perm_b32 v107, v246, v242, s66
v_perm_b32 v111, v246, v242, s67
v_perm_b32 v115, v247, v243, s66
v_perm_b32 v119, v247, v243, s67
s_waitcnt vmcnt(3)
s_mov_b32 s61, 69632
buffer_load_dwordx4 v[200:203], v9, s[40:43], s61 offen offset:0 nt
s_waitcnt vmcnt(3)
buffer_load_dwordx4 v[204:207], v9, s[40:43], s61 offen offset:1024 nt
v_perm_b32 v120, v188, v184, s66
v_perm_b32 v124, v188, v184, s67
v_perm_b32 v128, v189, v185, s66
v_perm_b32 v132, v189, v185, s67
v_perm_b32 v136, v190, v186, s66
v_perm_b32 v140, v190, v186, s67
v_perm_b32 v144, v191, v187, s66
v_perm_b32 v148, v191, v187, s67
s_waitcnt vmcnt(3)
buffer_load_dwordx4 v[208:211], v9, s[40:43], s61 offen offset:2048 nt
s_waitcnt vmcnt(3)
buffer_load_dwordx4 v[212:215], v9, s[40:43], s61 offen offset:3072 nt
v_perm_b32 v121, v196, v192, s66
v_perm_b32 v125, v196, v192, s67
v_perm_b32 v129, v197, v193, s66
v_perm_b32 v133, v197, v193, s67
v_perm_b32 v137, v198, v194, s66
v_perm_b32 v141, v198, v194, s67
v_perm_b32 v145, v199, v195, s66
v_perm_b32 v149, v199, v195, s67
s_waitcnt vmcnt(3)
s_cmp_lg_u32 s38, 0
s_cbranch_scc1 L_A_qt20
buffer_load_dwordx4 v[44:47], v10, s[44:47], 0 offen sc1
L_A_qt20:
s_mov_b32 s61, 98304
buffer_load_dwordx4 v[216:219], v9, s[40:43], s61 offen offset:0 nt
s_waitcnt vmcnt(3)
buffer_load_dwordx4 v[220:223], v9, s[40:43], s61 offen offset:1024 nt
v_perm_b32 v122, v204, v200, s66
v_perm_b32 v126, v204, v200, s67
v_perm_b32 v130, v205, v201, s66
v_perm_b32 v134, v205, v201, s67
v_perm_b32 v138, v206, v202, s66
v_perm_b32 v142, v206, v202, s67
v_perm_b32 v146, v207, v203, s66
v_perm_b32 v150, v207, v203, s67
s_waitcnt vmcnt(3)
buffer_load_dwordx4 v[224:227], v9, s[40:43], s61 offen offset:2048 nt
s_waitcnt vmcnt(3)
buffer_load_dwordx4 v[228:231], v9, s[40:43], s61 offen offset:3072 nt
v_perm_b32 v123, v212, v208, s66
v_perm_b32 v127, v212, v208, s67
v_perm_b32 v131, v213, v209, s66
v_perm_b32 v135, v213, v209, s67
v_perm_b32 v139, v214, v210, s66
v_perm_b32 v143, v214, v210, s67
v_perm_b32 v147, v215, v211, s66
v_perm_b32 v151, v215, v211, s67
s_waitcnt vmcnt(3)
s_cmp_lg_u32 s38, 0
s_cbranch_scc1 L_A_qc24
v_cmp_ne_u32 s[62:63], s88, v45
v_cmp_ne_u32 vcc, s88, v47
s_nop 1
s_or_b64 vcc, vcc, s[62:63]
s_cbranch_scc1 L_A_qc24
s_mov_b32 s38, 1
v_mov_b32 v45, v46
v_mov_b32 v46, 1
ds_write_b64 v11, v[44:45] offset:1024
ds_write_b32 v8, v46 offset:0
L_A_qc24:
s_cmp_lg_u32 s38, 0
s_cbranch_scc1 L_A_qt24
buffer_load_dwordx4 v[44:47], v10, s[44:47], 0 offen sc1
L_A_qt24:
s_mov_b32 s61, 102400
buffer_load_dwordx4 v[232:235], v9, s[40:43], s61 offen offset:0 nt
s_waitcnt vmcnt(3)
buffer_load_dwordx4 v[236:239], v9, s[40:43], s61 offen offset:1024 nt
v_perm_b32 v152, v220, v216, s66
v_perm_b32 v156, v220, v216, s67
v_perm_b32 v160, v221, v217, s66
v_perm_b32 v164, v221, v217, s67
v_perm_b32 v168, v222, v218, s66
v_perm_b32 v172, v222, v218, s67
v_perm_b32 v176, v223, v219, s66
v_perm_b32 v180, v223, v219, s67
s_waitcnt vmcnt(3)
buffer_load_dwordx4 v[240:243], v9, s[40:43], s61 offen offset:2048 nt
s_waitcnt vmcnt(3)
buffer_load_dwordx4 v[244:247], v9, s[40:43], s61 offen offset:3072 nt
v_perm_b32 v153, v228, v224, s66
v_perm_b32 v157, v228, v224, s67
v_perm_b32 v161, v229, v225, s66
v_perm_b32 v165, v229, v225, s67
v_perm_b32 v169, v230, v226, s66
v_perm_b32 v173, v230, v226, s67
v_perm_b32 v177, v231, v227, s66
v_perm_b32 v181, v231, v227, s67
s_waitcnt vmcnt(3)
s_cmp_lg_u32 s38, 0
s_cbranch_scc1 L_A_qc28
v_cmp_ne_u32 s[62:63], s88, v45
v_cmp_ne_u32 vcc, s88, v47
s_nop 1
s_or_b64 vcc, vcc, s[62:63]
s_cbranch_scc1 L_A_qc28
s_mov_b32 s38, 1
v_mov_b32 v45, v46
v_mov_b32 v46, 1
ds_write_b64 v11, v[44:45] offset:1024
ds_write_b32 v8, v46 offset:0
L_A_qc28:
s_waitcnt vmcnt(2)
v_perm_b32 v154, v236, v232, s66
v_perm_b32 v158, v236, v232, s67
v_perm_b32 v162, v237, v233, s66
v_perm_b32 v166, v237, v233, s67
v_perm_b32 v170, v238, v234, s66
v_perm_b32 v174, v238, v234, s67
v_perm_b32 v178, v239, v235, s66
v_perm_b32 v182, v239, v235, s67
s_waitcnt vmcnt(1)
s_waitcnt vmcnt(0)
v_perm_b32 v155, v244, v240, s66
v_perm_b32 v159, v244, v240, s67
v_perm_b32 v163, v245, v241, s66
v_perm_b32 v167, v245, v241, s67
v_perm_b32 v171, v246, v242, s66
v_perm_b32 v175, v246, v242, s67
v_perm_b32 v179, v247, v243, s66
v_perm_b32 v183, v247, v243, s67
s_mov_b32 s60, s37
s_cmp_lg_u32 s35, 0
s_cbranch_scc1 L_A_nostat
s_cmp_lg_u32 s38, 0
s_cbranch_scc1 L_A_qdone
s_mov_b32 s64, 0
L_tp_Aq:
buffer_load_dwordx4 v[44:47], v10, s[44:47], 0 offen sc1
s_waitcnt vmcnt(0)
v_cmp_ne_u32 s[62:63], s88, v45
v_cmp_ne_u32 vcc, s88, v47
s_add_u32 s64, s64, 1
s_nop 0
s_or_b64 vcc, vcc, s[62:63]
s_cbranch_scc0 L_tp_Aq_ok
s_cmp_lt_u32 s64, 65536
s_cbranch_scc1 L_tp_Aq
L_tp_Aq_ok:
v_mov_b32 v45, v46
v_mov_b32 v46, 1
ds_write_b64 v11, v[44:45] offset:1024
ds_write_b32 v8, v46 offset:0
L_A_qdone:
s_mov_b32 s64, 0
L_A_hs:
ds_read_b32 v10, v8 offset:4
s_waitcnt lgkmcnt(0)
v_readfirstlane_b32 s65, v10
s_add_u32 s64, s64, 1
s_nop 2
s_cmp_ge_u32 s65, 4
s_cbranch_scc1 L_A_hs_ok
s_sleep 16
s_cmp_lt_u32 s64, 1048576
s_cbranch_scc1 L_A_hs
L_A_hs_ok:
s_waitcnt vmcnt(0)
v_and_b32 v10, 1, v1
v_lshlrev_b32 v11, 4, v10
ds_read_b128 v[44:47], v11 offset:64
ds_read_b128 v[48:51], v11 offset:96
v_lshlrev_b32 v10, 12, v10
s_lshl_b32 s63, s60, 4
s_add_u32 s63, s63, 0x14000
v_add_u32 v10, s63, v10
s_lshl_b32 s63, s60, 7
s_add_u32 s63, s63, 0x50000
v_lshl_add_u32 v10, v1, 4, s63
s_waitcnt lgkmcnt(0)
v_max3_f32 v52, v44, v45, v46
v_max_f32 v52, v52, v47
v_sub_f32 v44, v44, v52
v_sub_f32 v45, v45, v52
v_sub_f32 v46, v46, v52
v_sub_f32 v47, v47, v52
v_exp_f32 v44, v44
v_exp_f32 v45, v45
v_exp_f32 v46, v46
v_exp_f32 v47, v47
s_nop 0
v_mul_f32 v54, v44, v48
v_fma_f32 v54, v45, v49, v54
v_fma_f32 v54, v46, v50, v54
v_fma_f32 v54, v47, v51, v54
v_mov_b32 v53, s88
v_mov_b32 v55, s88
s_mov_b64 exec, 255
global_store_dwordx4 v10, v[52:55], s[30:31] sc1
s_mov_b64 exec, -1
L_A_nostat:
s_sub_u32 s63, s35, 1
s_cmp_gt_u32 s63, 1
s_cbranch_scc1 L_A_monx
s_and_b32 s63, s32, 7
s_lshl_b32 s63, s63, 8
s_add_u32 s63, s63, 0xc0000
s_add_u32 s56, s30, s63
s_addc_u32 s57, s31, 0
s_mov_b32 s64, 0
s_mov_b32 s59, 0
s_lshr_b32 s62, s32, 3
s_mul_i32 s62, s62, 6
s_add_u32 s62, s62, s33
s_lshl_b32 s62, s62, 2
v_mov_b32 v44, s62
v_lshlrev_b32 v48, 2, v1
s_lshr_b32 s65, s62, 2
s_cmp_eq_u32 s35, 1
s_cbranch_scc1 L_A_mon
s_mov_b64 exec, 1
s_mov_b32 s59, -4
L_A_post:
ds_read_b32 v45, v8 offset:256
s_waitcnt lgkmcnt(0)
v_readfirstlane_b32 s58, v45
v_add_u32 v46, s88, v45
s_sub_u32 s63, s58, s59
s_cmp_lt_u32 s63, 4
s_cbranch_scc1 L_A_postn
global_store_dword v44, v46, s[56:57]
s_mov_b32 s59, s58
s_cmp_ge_u32 s58, 640
s_cbranch_scc1 L_A_monx
L_A_postn:
s_sleep 2
s_add_u32 s64, s64, 1
s_cmp_lt_u32 s64, 65536
s_cbranch_scc1 L_A_post
s_branch L_A_monx
L_A_mon:
s_mov_b64 exec, 1
ds_read_b32 v45, v8 offset:256
s_waitcnt lgkmcnt(0)
v_add_u32 v46, s88, v45
v_readfirstlane_b32 s58, v45
s_mov_b64 exec, 0x1ffffff
global_load_dword v49, v48, s[56:57] nt
s_waitcnt vmcnt(0)
v_subrev_u32 v49, s88, v49
s_mov_b64 exec, 0xffffff
v_cmp_le_u32 vcc, 0x400, v49
v_readlane_b32 s62, v49, 24
v_readlane_b32 s59, v49, s65
v_add_u32_dpp v49, v49, v49 row_shr:1 row_mask:0xf bank_mask:0xf bound_ctrl:0
s_nop 1
v_add_u32_dpp v49, v49, v49 row_shr:2 row_mask:0xf bank_mask:0xf bound_ctrl:0
s_nop 1
v_add_u32_dpp v49, v49, v49 row_shr:4 row_mask:0xf bank_mask:0xf bound_ctrl:0
s_nop 1
v_add_u32_dpp v49, v49, v49 row_shr:8 row_mask:0xf bank_mask:0xf bound_ctrl:0
s_nop 0
v_readlane_b32 s61, v49, 15
v_readlane_b32 s63, v49, 23
s_add_u32 s61, s61, s63
s_mul_i32 s63, s59, 24
s_sub_u32 s61, s61, s63
s_cmp_lt_u32 s62, 0x8000
s_cselect_b32 s62, s62, 0x4000
s_add_u32 s61, s61, s62
s_sub_u32 s61, s61, 0x4000
s_mov_b32 s63, -48
s_cmp_lt_u32 s58, 400
s_cselect_b32 s63, s63, -48
s_cmp_gt_i32 s61, s63
s_cselect_b32 s63, 1, 0
s_cmp_eq_u64 vcc, 0
s_cselect_b32 s63, s63, 0
s_cmp_lt_u32 s58, 620
s_cselect_b32 s63, s63, 1
v_mov_b32 v47, s63
ds_write_b32 v8, v47 offset:8
s_mov_b32 s59, s58
s_cmp_ge_u32 s58, 620
s_cbranch_scc1 L_A_monx
s_add_u32 s64, s64, 1
s_cmp_lt_u32 s64, 4096
s_cbranch_scc1 L_A_mon
L_A_monx:
s_mov_b64 exec, -1
v_and_b32 v10, 7, v2
v_mul_u32_u24 v10, 272, v10
v_lshl_add_u32 v10, v3, 4, v10
v_lshlrev_b32 v11, 18, v3
v_lshl_add_u32 v11, v2, 4, v11
s_lshl_b32 s63, s60, 10
s_lshl_b32 s62, s35, 8
s_add_u32 s63, s63, s62
s_add_u32 s63, s63, 0x100000
v_add_u32 v11, s63, v11
s_barrier
ds_read_b128 v[12:15], v10 offset:8192
ds_read_b128 v[16:19], v10 offset:8256
ds_read_b128 v[20:23], v10 offset:8320
ds_read_b128 v[24:27], v10 offset:8384
s_waitcnt lgkmcnt(3)
v_mfma_f32_16x16x32_bf16 v[184:187], v[12:15], v[56:59], 0
v_mfma_f32_16x16x32_bf16 v[188:191], v[12:15], v[60:63], 0
s_waitcnt lgkmcnt(2)
v_mfma_f32_16x16x32_bf16 v[184:187], v[16:19], v[88:91], v[184:187]
v_mfma_f32_16x16x32_bf16 v[188:191], v[16:19], v[92:95], v[188:191]
s_waitcnt lgkmcnt(1)
v_mfma_f32_16x16x32_bf16 v[184:187], v[20:23], v[120:123], v[184:187]
v_mfma_f32_16x16x32_bf16 v[188:191], v[20:23], v[124:127], v[188:191]
s_waitcnt lgkmcnt(0)
v_mfma_f32_16x16x32_bf16 v[184:187], v[24:27], v[152:155], v[184:187]
v_mfma_f32_16x16x32_bf16 v[188:191], v[24:27], v[156:159], v[188:191]
v_mfma_f32_16x16x32_bf16 v[192:195], v[12:15], v[64:67], 0
v_mfma_f32_16x16x32_bf16 v[196:199], v[12:15], v[68:71], 0
v_mfma_f32_16x16x32_bf16 v[192:195], v[16:19], v[96:99], v[192:195]
v_mfma_f32_16x16x32_bf16 v[196:199], v[16:19], v[100:103], v[196:199]
v_mfma_f32_16x16x32_bf16 v[192:195], v[20:23], v[128:131], v[192:195]
v_mfma_f32_16x16x32_bf16 v[196:199], v[20:23], v[132:135], v[196:199]
v_mfma_f32_16x16x32_bf16 v[192:195], v[24:27], v[160:163], v[192:195]
v_mfma_f32_16x16x32_bf16 v[196:199], v[24:27], v[164:167], v[196:199]
v_add_f32 v184, v184, v185
v_add_f32 v186, v186, v187
v_add_f32 v184, v184, v186
v_add_f32 v188, v188, v189
v_add_f32 v190, v190, v191
v_add_f32 v188, v188, v190
v_cvt_pk_bf16_f32 v36, v184, v188
v_min_u32 v36, 0xfffffffe, v36
v_mfma_f32_16x16x32_bf16 v[200:203], v[12:15], v[72:75], 0
v_mfma_f32_16x16x32_bf16 v[204:207], v[12:15], v[76:79], 0
v_mfma_f32_16x16x32_bf16 v[200:203], v[16:19], v[104:107], v[200:203]
v_mfma_f32_16x16x32_bf16 v[204:207], v[16:19], v[108:111], v[204:207]
v_mfma_f32_16x16x32_bf16 v[200:203], v[20:23], v[136:139], v[200:203]
v_mfma_f32_16x16x32_bf16 v[204:207], v[20:23], v[140:143], v[204:207]
v_mfma_f32_16x16x32_bf16 v[200:203], v[24:27], v[168:171], v[200:203]
v_mfma_f32_16x16x32_bf16 v[204:207], v[24:27], v[172:175], v[204:207]
v_add_f32 v192, v192, v193
v_add_f32 v194, v194, v195
v_add_f32 v192, v192, v194
v_add_f32 v196, v196, v197
v_add_f32 v198, v198, v199
v_add_f32 v196, v196, v198
v_cvt_pk_bf16_f32 v37, v192, v196
v_min_u32 v37, 0xfffffffe, v37
v_mfma_f32_16x16x32_bf16 v[208:211], v[12:15], v[80:83], 0
v_mfma_f32_16x16x32_bf16 v[212:215], v[12:15], v[84:87], 0
v_mfma_f32_16x16x32_bf16 v[208:211], v[16:19], v[112:115], v[208:211]
v_mfma_f32_16x16x32_bf16 v[212:215], v[16:19], v[116:119], v[212:215]
v_mfma_f32_16x16x32_bf16 v[208:211], v[20:23], v[144:147], v[208:211]
v_mfma_f32_16x16x32_bf16 v[212:215], v[20:23], v[148:151], v[212:215]
v_mfma_f32_16x16x32_bf16 v[208:211], v[24:27], v[176:179], v[208:211]
v_mfma_f32_16x16x32_bf16 v[212:215], v[24:27], v[180:183], v[212:215]
v_add_f32 v200, v200, v201
v_add_f32 v202, v202, v203
v_add_f32 v200, v200, v202
v_add_f32 v204, v204, v205
v_add_f32 v206, v206, v207
v_add_f32 v204, v204, v206
v_cvt_pk_bf16_f32 v38, v200, v204
v_min_u32 v38, 0xfffffffe, v38
s_nop 0
v_add_f32 v208, v208, v209
v_add_f32 v210, v210, v211
v_add_f32 v208, v208, v210
v_add_f32 v212, v212, v213
v_add_f32 v214, v214, v215
v_add_f32 v212, v212, v214
v_cvt_pk_bf16_f32 v39, v208, v212
v_min_u32 v39, 0xfffffffe, v39
s_mov_b32 exec_hi, 0
global_store_dwordx4 v11, v[36:39], s[30:31] sc1
s_endpgm
L_roleW:
s_load_dword s88, s[30:31], 0x18000
v_mov_b32 v8, 0
s_mov_b32 s52, s30
s_and_b32 s53, s31, 0xffff
s_mov_b32 s54, 0x1000000
s_mov_b32 s55, 0x20000
s_lshl_b32 s60, s32, 8
s_sub_u32 s61, 0x400000, s60
s_add_u32 s40, s18, s60
s_addc_u32 s41, s19, 0
s_and_b32 s41, s41, 0xffff
s_mov_b32 s42, s61
s_mov_b32 s43, 0x20000
s_add_u32 s44, s20, s60
s_addc_u32 s45, s21, 0
s_and_b32 s45, s45, 0xffff
s_mov_b32 s46, s61
s_mov_b32 s47, 0x20000
s_mov_b32 s48, s14
s_and_b32 s49, s15, 0xffff
s_mov_b32 s50, 0x800
s_mov_b32 s51, 0x20000
v_lshrrev_b32 v192, 3, v2
v_lshlrev_b32 v192, 10, v192
v_lshl_add_u32 v192, v3, 5, v192
s_lshl_b32 s62, s34, 7
v_add_u32 v192, s62, v192
buffer_load_dwordx4 v[12:15], v192, s[48:51], 0 offen
buffer_load_dwordx4 v[16:19], v192, s[48:51], 0 offen offset:16
v_lshlrev_b32 v9, 17, v3
v_lshl_add_u32 v9, v2, 4, v9
s_lshl_b32 s62, s34, 19
v_add_u32 v9, s62, v9
s_waitcnt vmcnt(2)
s_mov_b32 s62, 0
buffer_load_dwordx4 v[64:67], v9, s[40:43], s62 offen nt
s_waitcnt vmcnt(2)
s_mov_b32 s62, 8192
buffer_load_dwordx4 v[68:71], v9, s[40:43], s62 offen nt
s_waitcnt vmcnt(2)
s_mov_b32 s62, 16384
buffer_load_dwordx4 v[72:75], v9, s[40:43], s62 offen nt
s_waitcnt vmcnt(2)
s_mov_b32 s62, 24576
buffer_load_dwordx4 v[76:79], v9, s[40:43], s62 offen nt
s_waitcnt vmcnt(2)
s_mov_b32 s62, 32768
buffer_load_dwordx4 v[80:83], v9, s[40:43], s62 offen nt
s_waitcnt vmcnt(2)
s_mov_b32 s62, 40960
buffer_load_dwordx4 v[84:87], v9, s[40:43], s62 offen nt
s_waitcnt vmcnt(2)
s_mov_b32 s62, 49152
buffer_load_dwordx4 v[88:91], v9, s[40:43], s62 offen nt
s_waitcnt vmcnt(2)
s_mov_b32 s62, 57344
buffer_load_dwordx4 v[92:95], v9, s[40:43], s62 offen nt
s_waitcnt vmcnt(2)
s_mov_b32 s62, 65536
buffer_load_dwordx4 v[96:99], v9, s[40:43], s62 offen nt
s_waitcnt vmcnt(2)
s_mov_b32 s62, 73728
buffer_load_dwordx4 v[100:103], v9, s[40:43], s62 offen nt
s_waitcnt vmcnt(2)
s_mov_b32 s62, 81920
buffer_load_dwordx4 v[104:107], v9, s[40:43], s62 offen nt
s_waitcnt vmcnt(2)
s_mov_b32 s62, 90112
buffer_load_dwordx4 v[108:111], v9, s[40:43], s62 offen nt
s_waitcnt vmcnt(2)
s_mov_b32 s62, 98304
buffer_load_dwordx4 v[112:115], v9, s[40:43], s62 offen nt
s_waitcnt vmcnt(2)
s_mov_b32 s62, 106496
buffer_load_dwordx4 v[116:119], v9, s[40:43], s62 offen nt
s_waitcnt vmcnt(2)
s_mov_b32 s62, 114688
buffer_load_dwordx4 v[120:123], v9, s[40:43], s62 offen nt
s_waitcnt vmcnt(2)
s_mov_b32 s62, 122880
buffer_load_dwordx4 v[124:127], v9, s[40:43], s62 offen nt
s_barrier
s_waitcnt vmcnt(16)
s_mov_b32 s60, 0x01000100
v_perm_b32 v192, v12, v12, s60
v_and_b32 v28, v192, v4
v_and_b32 v29, v192, v5
v_and_b32 v30, v192, v6
v_and_b32 v31, v192, v7
s_waitcnt vmcnt(15)
s_nop 0
v_mfma_f32_16x16x32_bf16 v[44:47], v[28:31], v[64:67], 0
s_mov_b32 s62, 0
buffer_load_dwordx4 v[128:131], v9, s[44:47], s62 offen nt
s_mov_b32 s60, 0x03020302
v_perm_b32 v193, v12, v12, s60
v_and_b32 v32, v193, v4
v_and_b32 v33, v193, v5
v_and_b32 v34, v193, v6
v_and_b32 v35, v193, v7
s_waitcnt vmcnt(15)
s_nop 0
v_mfma_f32_16x16x32_bf16 v[44:47], v[32:35], v[68:71], v[44:47]
s_mov_b32 s62, 8192
buffer_load_dwordx4 v[132:135], v9, s[44:47], s62 offen nt
s_mov_b32 s60, 0x01000100
v_perm_b32 v192, v13, v13, s60
v_and_b32 v28, v192, v4
v_and_b32 v29, v192, v5
v_and_b32 v30, v192, v6
v_and_b32 v31, v192, v7
s_waitcnt vmcnt(15)
s_nop 0
v_mfma_f32_16x16x32_bf16 v[44:47], v[28:31], v[72:75], v[44:47]
s_mov_b32 s62, 16384
buffer_load_dwordx4 v[136:139], v9, s[44:47], s62 offen nt
s_mov_b32 s60, 0x03020302
v_perm_b32 v193, v13, v13, s60
v_and_b32 v32, v193, v4
v_and_b32 v33, v193, v5
v_and_b32 v34, v193, v6
v_and_b32 v35, v193, v7
s_waitcnt vmcnt(15)
s_nop 0
v_mfma_f32_16x16x32_bf16 v[44:47], v[32:35], v[76:79], v[44:47]
s_mov_b32 s62, 24576
buffer_load_dwordx4 v[140:143], v9, s[44:47], s62 offen nt
s_mov_b32 s60, 0x01000100
v_perm_b32 v192, v14, v14, s60
v_and_b32 v28, v192, v4
v_and_b32 v29, v192, v5
v_and_b32 v30, v192, v6
v_and_b32 v31, v192, v7
s_waitcnt vmcnt(15)
s_nop 0
v_mfma_f32_16x16x32_bf16 v[44:47], v[28:31], v[80:83], v[44:47]
s_mov_b32 s62, 32768
buffer_load_dwordx4 v[144:147], v9, s[44:47], s62 offen nt
s_mov_b32 s60, 0x03020302
v_perm_b32 v193, v14, v14, s60
v_and_b32 v32, v193, v4
v_and_b32 v33, v193, v5
v_and_b32 v34, v193, v6
v_and_b32 v35, v193, v7
s_waitcnt vmcnt(15)
s_nop 0
v_mfma_f32_16x16x32_bf16 v[44:47], v[32:35], v[84:87], v[44:47]
s_mov_b32 s62, 40960
buffer_load_dwordx4 v[148:151], v9, s[44:47], s62 offen nt
s_mov_b32 s60, 0x01000100
v_perm_b32 v192, v15, v15, s60
v_and_b32 v28, v192, v4
v_and_b32 v29, v192, v5
v_and_b32 v30, v192, v6
v_and_b32 v31, v192, v7
s_waitcnt vmcnt(15)
s_nop 0
v_mfma_f32_16x16x32_bf16 v[44:47], v[28:31], v[88:91], v[44:47]
s_mov_b32 s62, 49152
buffer_load_dwordx4 v[152:155], v9, s[44:47], s62 offen nt
s_mov_b32 s60, 0x03020302
v_perm_b32 v193, v15, v15, s60
v_and_b32 v32, v193, v4
v_and_b32 v33, v193, v5
v_and_b32 v34, v193, v6
v_and_b32 v35, v193, v7
s_waitcnt vmcnt(15)
s_nop 0
v_mfma_f32_16x16x32_bf16 v[44:47], v[32:35], v[92:95], v[44:47]
s_mov_b32 s62, 57344
buffer_load_dwordx4 v[156:159], v9, s[44:47], s62 offen nt
s_mov_b32 s60, 0x01000100
v_perm_b32 v192, v16, v16, s60
v_and_b32 v28, v192, v4
v_and_b32 v29, v192, v5
v_and_b32 v30, v192, v6
v_and_b32 v31, v192, v7
s_waitcnt vmcnt(15)
s_nop 0
v_mfma_f32_16x16x32_bf16 v[44:47], v[28:31], v[96:99], v[44:47]
s_mov_b32 s62, 65536
buffer_load_dwordx4 v[160:163], v9, s[44:47], s62 offen nt
s_mov_b32 s60, 0x03020302
v_perm_b32 v193, v16, v16, s60
v_and_b32 v32, v193, v4
v_and_b32 v33, v193, v5
v_and_b32 v34, v193, v6
v_and_b32 v35, v193, v7
s_waitcnt vmcnt(15)
s_nop 0
v_mfma_f32_16x16x32_bf16 v[44:47], v[32:35], v[100:103], v[44:47]
s_mov_b32 s62, 73728
buffer_load_dwordx4 v[164:167], v9, s[44:47], s62 offen nt
s_mov_b32 s60, 0x01000100
v_perm_b32 v192, v17, v17, s60
v_and_b32 v28, v192, v4
v_and_b32 v29, v192, v5
v_and_b32 v30, v192, v6
v_and_b32 v31, v192, v7
s_waitcnt vmcnt(15)
s_nop 0
v_mfma_f32_16x16x32_bf16 v[44:47], v[28:31], v[104:107], v[44:47]
s_mov_b32 s62, 81920
buffer_load_dwordx4 v[168:171], v9, s[44:47], s62 offen nt
s_mov_b32 s60, 0x03020302
v_perm_b32 v193, v17, v17, s60
v_and_b32 v32, v193, v4
v_and_b32 v33, v193, v5
v_and_b32 v34, v193, v6
v_and_b32 v35, v193, v7
s_waitcnt vmcnt(15)
s_nop 0
v_mfma_f32_16x16x32_bf16 v[44:47], v[32:35], v[108:111], v[44:47]
s_mov_b32 s62, 90112
buffer_load_dwordx4 v[172:175], v9, s[44:47], s62 offen nt
s_mov_b32 s60, 0x01000100
v_perm_b32 v192, v18, v18, s60
v_and_b32 v28, v192, v4
v_and_b32 v29, v192, v5
v_and_b32 v30, v192, v6
v_and_b32 v31, v192, v7
s_waitcnt vmcnt(15)
s_nop 0
v_mfma_f32_16x16x32_bf16 v[44:47], v[28:31], v[112:115], v[44:47]
s_mov_b32 s62, 98304
buffer_load_dwordx4 v[176:179], v9, s[44:47], s62 offen nt
s_mov_b32 s60, 0x03020302
v_perm_b32 v193, v18, v18, s60
v_and_b32 v32, v193, v4
v_and_b32 v33, v193, v5
v_and_b32 v34, v193, v6
v_and_b32 v35, v193, v7
s_waitcnt vmcnt(15)
s_nop 0
v_mfma_f32_16x16x32_bf16 v[44:47], v[32:35], v[116:119], v[44:47]
s_mov_b32 s62, 106496
buffer_load_dwordx4 v[180:183], v9, s[44:47], s62 offen nt
s_mov_b32 s60, 0x01000100
v_perm_b32 v192, v19, v19, s60
v_and_b32 v28, v192, v4
v_and_b32 v29, v192, v5
v_and_b32 v30, v192, v6
v_and_b32 v31, v192, v7
s_waitcnt vmcnt(15)
s_nop 0
v_mfma_f32_16x16x32_bf16 v[44:47], v[28:31], v[120:123], v[44:47]
s_mov_b32 s62, 114688
buffer_load_dwordx4 v[184:187], v9, s[44:47], s62 offen nt
s_mov_b32 s60, 0x03020302
v_perm_b32 v193, v19, v19, s60
v_and_b32 v32, v193, v4
v_and_b32 v33, v193, v5
v_and_b32 v34, v193, v6
v_and_b32 v35, v193, v7
s_waitcnt vmcnt(15)
s_nop 0
v_mfma_f32_16x16x32_bf16 v[44:47], v[32:35], v[124:127], v[44:47]
s_mov_b32 s62, 122880
buffer_load_dwordx4 v[188:191], v9, s[44:47], s62 offen nt
s_nop 1
v_lshrrev_b32 v192, 1, v3
v_lshlrev_b32 v192, 9, v192
v_lshl_add_u32 v192, v2, 5, v192
v_and_b32 v193, 1, v3
v_lshl_add_u32 v192, v193, 4, v192
s_lshl_b32 s63, s34, 10
v_add_u32 v192, s63, v192
s_nop 1
s_nop 5
ds_write_b128 v192, v[44:47] offset:0
s_waitcnt lgkmcnt(0)
s_barrier
s_cmp_ge_u32 s34, 4
s_cbranch_scc1 L_W_qskip
v_lshlrev_b32 v194, 2, v0
ds_read_b32 v196, v194 offset:0
ds_read_b32 v197, v194 offset:1024
ds_read_b32 v198, v194 offset:2048
ds_read_b32 v199, v194 offset:3072
ds_read_b32 v200, v194 offset:4096
ds_read_b32 v201, v194 offset:5120
ds_read_b32 v202, v194 offset:6144
ds_read_b32 v203, v194 offset:7168
s_waitcnt lgkmcnt(0)
v_add_f32 v196, v196, v197
v_add_f32 v196, v196, v198
v_add_f32 v196, v196, v199
v_add_f32 v196, v196, v200
v_add_f32 v196, v196, v201
v_add_f32 v196, v196, v202
v_add_f32 v196, v196, v203
v_cvt_pk_bf16_f32 v196, v196, v196
v_lshlrev_b32 v194, 1, v0
ds_write_b16 v194, v196 offset:8192
s_waitcnt lgkmcnt(0)
L_W_qskip:
s_barrier
s_waitcnt lgkmcnt(0)
s_add_u32 s88, s88, 0x9e3779b9
v_lshlrev_b32 v194, 4, v2
ds_read_b128 v[20:23], v194 offset:8192
ds_read_b128 v[24:27], v194 offset:8448
v_mov_b32 v200, 0
v_mov_b32 v201, 0
s_waitcnt lgkmcnt(0)
s_waitcnt vmcnt(14)
v_dot2_f32_bf16 v60, v128, v20, 0
v_dot2_f32_bf16 v61, v128, v24, 0
v_dot2_f32_bf16 v62, v132, v20, 0
v_dot2_f32_bf16 v63, v132, v24, 0
v_dot2_f32_bf16 v60, v129, v21, v60
v_dot2_f32_bf16 v61, v129, v25, v61
v_dot2_f32_bf16 v62, v133, v21, v62
v_dot2_f32_bf16 v63, v133, v25, v63
v_dot2_f32_bf16 v60, v130, v22, v60
v_dot2_f32_bf16 v61, v130, v26, v61
v_dot2_f32_bf16 v62, v134, v22, v62
v_dot2_f32_bf16 v63, v134, v26, v63
v_dot2_f32_bf16 v60, v131, v23, v60
v_dot2_f32_bf16 v61, v131, v27, v61
v_dot2_f32_bf16 v62, v135, v23, v62
v_dot2_f32_bf16 v63, v135, v27, v63
v_add_f32_dpp v60, v60, v60 row_ror:8 row_mask:0xf bank_mask:0xf
v_add_f32_dpp v61, v61, v61 row_ror:8 row_mask:0xf bank_mask:0xf
v_add_f32_dpp v62, v62, v62 row_ror:8 row_mask:0xf bank_mask:0xf
v_add_f32_dpp v63, v63, v63 row_ror:8 row_mask:0xf bank_mask:0xf
v_add_f32_dpp v60, v60, v60 row_ror:4 row_mask:0xf bank_mask:0xf
v_add_f32_dpp v61, v61, v61 row_ror:4 row_mask:0xf bank_mask:0xf
v_add_f32_dpp v62, v62, v62 row_ror:4 row_mask:0xf bank_mask:0xf
v_add_f32_dpp v63, v63, v63 row_ror:4 row_mask:0xf bank_mask:0xf
v_add_f32_dpp v60, v60, v60 row_ror:2 row_mask:0xf bank_mask:0xf
v_add_f32_dpp v61, v61, v61 row_ror:2 row_mask:0xf bank_mask:0xf
v_add_f32_dpp v62, v62, v62 row_ror:2 row_mask:0xf bank_mask:0xf
v_add_f32_dpp v63, v63, v63 row_ror:2 row_mask:0xf bank_mask:0xf
v_add_f32_dpp v60, v60, v60 row_ror:1 row_mask:0xf bank_mask:0xf
v_add_f32_dpp v61, v61, v61 row_ror:1 row_mask:0xf bank_mask:0xf
v_add_f32_dpp v62, v62, v62 row_ror:1 row_mask:0xf bank_mask:0xf
v_add_f32_dpp v63, v63, v63 row_ror:1 row_mask:0xf bank_mask:0xf
v_cmp_eq_u32 vcc, 0, v2
s_nop 1
v_cndmask_b32 v200, v200, v60, vcc
v_cndmask_b32 v201, v201, v61, vcc
v_cmp_eq_u32 vcc, 1, v2
s_nop 1
v_cndmask_b32 v200, v200, v62, vcc
v_cndmask_b32 v201, v201, v63, vcc
s_waitcnt vmcnt(12)
v_dot2_f32_bf16 v60, v136, v20, 0
v_dot2_f32_bf16 v61, v136, v24, 0
v_dot2_f32_bf16 v62, v140, v20, 0
v_dot2_f32_bf16 v63, v140, v24, 0
v_dot2_f32_bf16 v60, v137, v21, v60
v_dot2_f32_bf16 v61, v137, v25, v61
v_dot2_f32_bf16 v62, v141, v21, v62
v_dot2_f32_bf16 v63, v141, v25, v63
v_dot2_f32_bf16 v60, v138, v22, v60
v_dot2_f32_bf16 v61, v138, v26, v61
v_dot2_f32_bf16 v62, v142, v22, v62
v_dot2_f32_bf16 v63, v142, v26, v63
v_dot2_f32_bf16 v60, v139, v23, v60
v_dot2_f32_bf16 v61, v139, v27, v61
v_dot2_f32_bf16 v62, v143, v23, v62
v_dot2_f32_bf16 v63, v143, v27, v63
v_add_f32_dpp v60, v60, v60 row_ror:8 row_mask:0xf bank_mask:0xf
v_add_f32_dpp v61, v61, v61 row_ror:8 row_mask:0xf bank_mask:0xf
v_add_f32_dpp v62, v62, v62 row_ror:8 row_mask:0xf bank_mask:0xf
v_add_f32_dpp v63, v63, v63 row_ror:8 row_mask:0xf bank_mask:0xf
v_add_f32_dpp v60, v60, v60 row_ror:4 row_mask:0xf bank_mask:0xf
v_add_f32_dpp v61, v61, v61 row_ror:4 row_mask:0xf bank_mask:0xf
v_add_f32_dpp v62, v62, v62 row_ror:4 row_mask:0xf bank_mask:0xf
v_add_f32_dpp v63, v63, v63 row_ror:4 row_mask:0xf bank_mask:0xf
v_add_f32_dpp v60, v60, v60 row_ror:2 row_mask:0xf bank_mask:0xf
v_add_f32_dpp v61, v61, v61 row_ror:2 row_mask:0xf bank_mask:0xf
v_add_f32_dpp v62, v62, v62 row_ror:2 row_mask:0xf bank_mask:0xf
v_add_f32_dpp v63, v63, v63 row_ror:2 row_mask:0xf bank_mask:0xf
v_add_f32_dpp v60, v60, v60 row_ror:1 row_mask:0xf bank_mask:0xf
v_add_f32_dpp v61, v61, v61 row_ror:1 row_mask:0xf bank_mask:0xf
v_add_f32_dpp v62, v62, v62 row_ror:1 row_mask:0xf bank_mask:0xf
v_add_f32_dpp v63, v63, v63 row_ror:1 row_mask:0xf bank_mask:0xf
v_cmp_eq_u32 vcc, 2, v2
s_nop 1
v_cndmask_b32 v200, v200, v60, vcc
v_cndmask_b32 v201, v201, v61, vcc
v_cmp_eq_u32 vcc, 3, v2
s_nop 1
v_cndmask_b32 v200, v200, v62, vcc
v_cndmask_b32 v201, v201, v63, vcc
s_waitcnt vmcnt(10)
v_dot2_f32_bf16 v60, v144, v20, 0
v_dot2_f32_bf16 v61, v144, v24, 0
v_dot2_f32_bf16 v62, v148, v20, 0
v_dot2_f32_bf16 v63, v148, v24, 0
v_dot2_f32_bf16 v60, v145, v21, v60
v_dot2_f32_bf16 v61, v145, v25, v61
v_dot2_f32_bf16 v62, v149, v21, v62
v_dot2_f32_bf16 v63, v149, v25, v63
v_dot2_f32_bf16 v60, v146, v22, v60
v_dot2_f32_bf16 v61, v146, v26, v61
v_dot2_f32_bf16 v62, v150, v22, v62
v_dot2_f32_bf16 v63, v150, v26, v63
v_dot2_f32_bf16 v60, v147, v23, v60
v_dot2_f32_bf16 v61, v147, v27, v61
v_dot2_f32_bf16 v62, v151, v23, v62
v_dot2_f32_bf16 v63, v151, v27, v63
v_add_f32_dpp v60, v60, v60 row_ror:8 row_mask:0xf bank_mask:0xf
v_add_f32_dpp v61, v61, v61 row_ror:8 row_mask:0xf bank_mask:0xf
v_add_f32_dpp v62, v62, v62 row_ror:8 row_mask:0xf bank_mask:0xf
v_add_f32_dpp v63, v63, v63 row_ror:8 row_mask:0xf bank_mask:0xf
v_add_f32_dpp v60, v60, v60 row_ror:4 row_mask:0xf bank_mask:0xf
v_add_f32_dpp v61, v61, v61 row_ror:4 row_mask:0xf bank_mask:0xf
v_add_f32_dpp v62, v62, v62 row_ror:4 row_mask:0xf bank_mask:0xf
v_add_f32_dpp v63, v63, v63 row_ror:4 row_mask:0xf bank_mask:0xf
v_add_f32_dpp v60, v60, v60 row_ror:2 row_mask:0xf bank_mask:0xf
v_add_f32_dpp v61, v61, v61 row_ror:2 row_mask:0xf bank_mask:0xf
v_add_f32_dpp v62, v62, v62 row_ror:2 row_mask:0xf bank_mask:0xf
v_add_f32_dpp v63, v63, v63 row_ror:2 row_mask:0xf bank_mask:0xf
v_add_f32_dpp v60, v60, v60 row_ror:1 row_mask:0xf bank_mask:0xf
v_add_f32_dpp v61, v61, v61 row_ror:1 row_mask:0xf bank_mask:0xf
v_add_f32_dpp v62, v62, v62 row_ror:1 row_mask:0xf bank_mask:0xf
v_add_f32_dpp v63, v63, v63 row_ror:1 row_mask:0xf bank_mask:0xf
v_cmp_eq_u32 vcc, 4, v2
s_nop 1
v_cndmask_b32 v200, v200, v60, vcc
v_cndmask_b32 v201, v201, v61, vcc
v_cmp_eq_u32 vcc, 5, v2
s_nop 1
v_cndmask_b32 v200, v200, v62, vcc
v_cndmask_b32 v201, v201, v63, vcc
s_waitcnt vmcnt(8)
v_dot2_f32_bf16 v60, v152, v20, 0
v_dot2_f32_bf16 v61, v152, v24, 0
v_dot2_f32_bf16 v62, v156, v20, 0
v_dot2_f32_bf16 v63, v156, v24, 0
v_dot2_f32_bf16 v60, v153, v21, v60
v_dot2_f32_bf16 v61, v153, v25, v61
v_dot2_f32_bf16 v62, v157, v21, v62
v_dot2_f32_bf16 v63, v157, v25, v63
v_dot2_f32_bf16 v60, v154, v22, v60
v_dot2_f32_bf16 v61, v154, v26, v61
v_dot2_f32_bf16 v62, v158, v22, v62
v_dot2_f32_bf16 v63, v158, v26, v63
v_dot2_f32_bf16 v60, v155, v23, v60
v_dot2_f32_bf16 v61, v155, v27, v61
v_dot2_f32_bf16 v62, v159, v23, v62
v_dot2_f32_bf16 v63, v159, v27, v63
v_add_f32_dpp v60, v60, v60 row_ror:8 row_mask:0xf bank_mask:0xf
v_add_f32_dpp v61, v61, v61 row_ror:8 row_mask:0xf bank_mask:0xf
v_add_f32_dpp v62, v62, v62 row_ror:8 row_mask:0xf bank_mask:0xf
v_add_f32_dpp v63, v63, v63 row_ror:8 row_mask:0xf bank_mask:0xf
v_add_f32_dpp v60, v60, v60 row_ror:4 row_mask:0xf bank_mask:0xf
v_add_f32_dpp v61, v61, v61 row_ror:4 row_mask:0xf bank_mask:0xf
v_add_f32_dpp v62, v62, v62 row_ror:4 row_mask:0xf bank_mask:0xf
v_add_f32_dpp v63, v63, v63 row_ror:4 row_mask:0xf bank_mask:0xf
v_add_f32_dpp v60, v60, v60 row_ror:2 row_mask:0xf bank_mask:0xf
v_add_f32_dpp v61, v61, v61 row_ror:2 row_mask:0xf bank_mask:0xf
v_add_f32_dpp v62, v62, v62 row_ror:2 row_mask:0xf bank_mask:0xf
v_add_f32_dpp v63, v63, v63 row_ror:2 row_mask:0xf bank_mask:0xf
v_add_f32_dpp v60, v60, v60 row_ror:1 row_mask:0xf bank_mask:0xf
v_add_f32_dpp v61, v61, v61 row_ror:1 row_mask:0xf bank_mask:0xf
v_add_f32_dpp v62, v62, v62 row_ror:1 row_mask:0xf bank_mask:0xf
v_add_f32_dpp v63, v63, v63 row_ror:1 row_mask:0xf bank_mask:0xf
v_cmp_eq_u32 vcc, 6, v2
s_nop 1
v_cndmask_b32 v200, v200, v60, vcc
v_cndmask_b32 v201, v201, v61, vcc
v_cmp_eq_u32 vcc, 7, v2
s_nop 1
v_cndmask_b32 v200, v200, v62, vcc
v_cndmask_b32 v201, v201, v63, vcc
s_waitcnt vmcnt(6)
v_dot2_f32_bf16 v60, v160, v20, 0
v_dot2_f32_bf16 v61, v160, v24, 0
v_dot2_f32_bf16 v62, v164, v20, 0
v_dot2_f32_bf16 v63, v164, v24, 0
v_dot2_f32_bf16 v60, v161, v21, v60
v_dot2_f32_bf16 v61, v161, v25, v61
v_dot2_f32_bf16 v62, v165, v21, v62
v_dot2_f32_bf16 v63, v165, v25, v63
v_dot2_f32_bf16 v60, v162, v22, v60
v_dot2_f32_bf16 v61, v162, v26, v61
v_dot2_f32_bf16 v62, v166, v22, v62
v_dot2_f32_bf16 v63, v166, v26, v63
v_dot2_f32_bf16 v60, v163, v23, v60
v_dot2_f32_bf16 v61, v163, v27, v61
v_dot2_f32_bf16 v62, v167, v23, v62
v_dot2_f32_bf16 v63, v167, v27, v63
v_add_f32_dpp v60, v60, v60 row_ror:8 row_mask:0xf bank_mask:0xf
v_add_f32_dpp v61, v61, v61 row_ror:8 row_mask:0xf bank_mask:0xf
v_add_f32_dpp v62, v62, v62 row_ror:8 row_mask:0xf bank_mask:0xf
v_add_f32_dpp v63, v63, v63 row_ror:8 row_mask:0xf bank_mask:0xf
v_add_f32_dpp v60, v60, v60 row_ror:4 row_mask:0xf bank_mask:0xf
v_add_f32_dpp v61, v61, v61 row_ror:4 row_mask:0xf bank_mask:0xf
v_add_f32_dpp v62, v62, v62 row_ror:4 row_mask:0xf bank_mask:0xf
v_add_f32_dpp v63, v63, v63 row_ror:4 row_mask:0xf bank_mask:0xf
v_add_f32_dpp v60, v60, v60 row_ror:2 row_mask:0xf bank_mask:0xf
v_add_f32_dpp v61, v61, v61 row_ror:2 row_mask:0xf bank_mask:0xf
v_add_f32_dpp v62, v62, v62 row_ror:2 row_mask:0xf bank_mask:0xf
v_add_f32_dpp v63, v63, v63 row_ror:2 row_mask:0xf bank_mask:0xf
v_add_f32_dpp v60, v60, v60 row_ror:1 row_mask:0xf bank_mask:0xf
v_add_f32_dpp v61, v61, v61 row_ror:1 row_mask:0xf bank_mask:0xf
v_add_f32_dpp v62, v62, v62 row_ror:1 row_mask:0xf bank_mask:0xf
v_add_f32_dpp v63, v63, v63 row_ror:1 row_mask:0xf bank_mask:0xf
v_cmp_eq_u32 vcc, 8, v2
s_nop 1
v_cndmask_b32 v200, v200, v60, vcc
v_cndmask_b32 v201, v201, v61, vcc
v_cmp_eq_u32 vcc, 9, v2
s_nop 1
v_cndmask_b32 v200, v200, v62, vcc
v_cndmask_b32 v201, v201, v63, vcc
s_waitcnt vmcnt(4)
v_dot2_f32_bf16 v60, v168, v20, 0
v_dot2_f32_bf16 v61, v168, v24, 0
v_dot2_f32_bf16 v62, v172, v20, 0
v_dot2_f32_bf16 v63, v172, v24, 0
v_dot2_f32_bf16 v60, v169, v21, v60
v_dot2_f32_bf16 v61, v169, v25, v61
v_dot2_f32_bf16 v62, v173, v21, v62
v_dot2_f32_bf16 v63, v173, v25, v63
v_dot2_f32_bf16 v60, v170, v22, v60
v_dot2_f32_bf16 v61, v170, v26, v61
v_dot2_f32_bf16 v62, v174, v22, v62
v_dot2_f32_bf16 v63, v174, v26, v63
v_dot2_f32_bf16 v60, v171, v23, v60
v_dot2_f32_bf16 v61, v171, v27, v61
v_dot2_f32_bf16 v62, v175, v23, v62
v_dot2_f32_bf16 v63, v175, v27, v63
v_add_f32_dpp v60, v60, v60 row_ror:8 row_mask:0xf bank_mask:0xf
v_add_f32_dpp v61, v61, v61 row_ror:8 row_mask:0xf bank_mask:0xf
v_add_f32_dpp v62, v62, v62 row_ror:8 row_mask:0xf bank_mask:0xf
v_add_f32_dpp v63, v63, v63 row_ror:8 row_mask:0xf bank_mask:0xf
v_add_f32_dpp v60, v60, v60 row_ror:4 row_mask:0xf bank_mask:0xf
v_add_f32_dpp v61, v61, v61 row_ror:4 row_mask:0xf bank_mask:0xf
v_add_f32_dpp v62, v62, v62 row_ror:4 row_mask:0xf bank_mask:0xf
v_add_f32_dpp v63, v63, v63 row_ror:4 row_mask:0xf bank_mask:0xf
v_add_f32_dpp v60, v60, v60 row_ror:2 row_mask:0xf bank_mask:0xf
v_add_f32_dpp v61, v61, v61 row_ror:2 row_mask:0xf bank_mask:0xf
v_add_f32_dpp v62, v62, v62 row_ror:2 row_mask:0xf bank_mask:0xf
v_add_f32_dpp v63, v63, v63 row_ror:2 row_mask:0xf bank_mask:0xf
v_add_f32_dpp v60, v60, v60 row_ror:1 row_mask:0xf bank_mask:0xf
v_add_f32_dpp v61, v61, v61 row_ror:1 row_mask:0xf bank_mask:0xf
v_add_f32_dpp v62, v62, v62 row_ror:1 row_mask:0xf bank_mask:0xf
v_add_f32_dpp v63, v63, v63 row_ror:1 row_mask:0xf bank_mask:0xf
v_cmp_eq_u32 vcc, 10, v2
s_nop 1
v_cndmask_b32 v200, v200, v60, vcc
v_cndmask_b32 v201, v201, v61, vcc
v_cmp_eq_u32 vcc, 11, v2
s_nop 1
v_cndmask_b32 v200, v200, v62, vcc
v_cndmask_b32 v201, v201, v63, vcc
s_waitcnt vmcnt(2)
v_dot2_f32_bf16 v60, v176, v20, 0
v_dot2_f32_bf16 v61, v176, v24, 0
v_dot2_f32_bf16 v62, v180, v20, 0
v_dot2_f32_bf16 v63, v180, v24, 0
v_dot2_f32_bf16 v60, v177, v21, v60
v_dot2_f32_bf16 v61, v177, v25, v61
v_dot2_f32_bf16 v62, v181, v21, v62
v_dot2_f32_bf16 v63, v181, v25, v63
v_dot2_f32_bf16 v60, v178, v22, v60
v_dot2_f32_bf16 v61, v178, v26, v61
v_dot2_f32_bf16 v62, v182, v22, v62
v_dot2_f32_bf16 v63, v182, v26, v63
v_dot2_f32_bf16 v60, v179, v23, v60
v_dot2_f32_bf16 v61, v179, v27, v61
v_dot2_f32_bf16 v62, v183, v23, v62
v_dot2_f32_bf16 v63, v183, v27, v63
v_add_f32_dpp v60, v60, v60 row_ror:8 row_mask:0xf bank_mask:0xf
v_add_f32_dpp v61, v61, v61 row_ror:8 row_mask:0xf bank_mask:0xf
v_add_f32_dpp v62, v62, v62 row_ror:8 row_mask:0xf bank_mask:0xf
v_add_f32_dpp v63, v63, v63 row_ror:8 row_mask:0xf bank_mask:0xf
v_add_f32_dpp v60, v60, v60 row_ror:4 row_mask:0xf bank_mask:0xf
v_add_f32_dpp v61, v61, v61 row_ror:4 row_mask:0xf bank_mask:0xf
v_add_f32_dpp v62, v62, v62 row_ror:4 row_mask:0xf bank_mask:0xf
v_add_f32_dpp v63, v63, v63 row_ror:4 row_mask:0xf bank_mask:0xf
v_add_f32_dpp v60, v60, v60 row_ror:2 row_mask:0xf bank_mask:0xf
v_add_f32_dpp v61, v61, v61 row_ror:2 row_mask:0xf bank_mask:0xf
v_add_f32_dpp v62, v62, v62 row_ror:2 row_mask:0xf bank_mask:0xf
v_add_f32_dpp v63, v63, v63 row_ror:2 row_mask:0xf bank_mask:0xf
v_add_f32_dpp v60, v60, v60 row_ror:1 row_mask:0xf bank_mask:0xf
v_add_f32_dpp v61, v61, v61 row_ror:1 row_mask:0xf bank_mask:0xf
v_add_f32_dpp v62, v62, v62 row_ror:1 row_mask:0xf bank_mask:0xf
v_add_f32_dpp v63, v63, v63 row_ror:1 row_mask:0xf bank_mask:0xf
v_cmp_eq_u32 vcc, 12, v2
s_nop 1
v_cndmask_b32 v200, v200, v60, vcc
v_cndmask_b32 v201, v201, v61, vcc
v_cmp_eq_u32 vcc, 13, v2
s_nop 1
v_cndmask_b32 v200, v200, v62, vcc
v_cndmask_b32 v201, v201, v63, vcc
s_waitcnt vmcnt(0)
v_dot2_f32_bf16 v60, v184, v20, 0
v_dot2_f32_bf16 v61, v184, v24, 0
v_dot2_f32_bf16 v62, v188, v20, 0
v_dot2_f32_bf16 v63, v188, v24, 0
v_dot2_f32_bf16 v60, v185, v21, v60
v_dot2_f32_bf16 v61, v185, v25, v61
v_dot2_f32_bf16 v62, v189, v21, v62
v_dot2_f32_bf16 v63, v189, v25, v63
v_dot2_f32_bf16 v60, v186, v22, v60
v_dot2_f32_bf16 v61, v186, v26, v61
v_dot2_f32_bf16 v62, v190, v22, v62
v_dot2_f32_bf16 v63, v190, v26, v63
v_dot2_f32_bf16 v60, v187, v23, v60
v_dot2_f32_bf16 v61, v187, v27, v61
v_dot2_f32_bf16 v62, v191, v23, v62
v_dot2_f32_bf16 v63, v191, v27, v63
v_add_f32_dpp v60, v60, v60 row_ror:8 row_mask:0xf bank_mask:0xf
v_add_f32_dpp v61, v61, v61 row_ror:8 row_mask:0xf bank_mask:0xf
v_add_f32_dpp v62, v62, v62 row_ror:8 row_mask:0xf bank_mask:0xf
v_add_f32_dpp v63, v63, v63 row_ror:8 row_mask:0xf bank_mask:0xf
v_add_f32_dpp v60, v60, v60 row_ror:4 row_mask:0xf bank_mask:0xf
v_add_f32_dpp v61, v61, v61 row_ror:4 row_mask:0xf bank_mask:0xf
v_add_f32_dpp v62, v62, v62 row_ror:4 row_mask:0xf bank_mask:0xf
v_add_f32_dpp v63, v63, v63 row_ror:4 row_mask:0xf bank_mask:0xf
v_add_f32_dpp v60, v60, v60 row_ror:2 row_mask:0xf bank_mask:0xf
v_add_f32_dpp v61, v61, v61 row_ror:2 row_mask:0xf bank_mask:0xf
v_add_f32_dpp v62, v62, v62 row_ror:2 row_mask:0xf bank_mask:0xf
v_add_f32_dpp v63, v63, v63 row_ror:2 row_mask:0xf bank_mask:0xf
v_add_f32_dpp v60, v60, v60 row_ror:1 row_mask:0xf bank_mask:0xf
v_add_f32_dpp v61, v61, v61 row_ror:1 row_mask:0xf bank_mask:0xf
v_add_f32_dpp v62, v62, v62 row_ror:1 row_mask:0xf bank_mask:0xf
v_add_f32_dpp v63, v63, v63 row_ror:1 row_mask:0xf bank_mask:0xf
v_cmp_eq_u32 vcc, 14, v2
s_nop 1
v_cndmask_b32 v200, v200, v60, vcc
v_cndmask_b32 v201, v201, v61, vcc
v_cmp_eq_u32 vcc, 15, v2
s_nop 1
v_cndmask_b32 v200, v200, v62, vcc
v_cndmask_b32 v201, v201, v63, vcc
v_cvt_pk_bf16_f32 v200, v200, v200
v_cvt_pk_bf16_f32 v201, v201, v201
s_lshl_b32 s62, s32, 10
s_lshl_b32 s63, s34, 7
s_add_u32 s62, s62, s63
s_add_u32 s62, s62, 0x0
v_lshl_add_u32 v192, v1, 1, s62
buffer_store_short v200, v192, s[52:55], 0 offen sc1
s_mov_b32 s62, 32768
buffer_store_short v201, v192, s[52:55], s62 offen sc1
s_lshl_b32 s62, s32, 8
s_add_u32 s62, s62, 0x1a000
v_lshl_add_u32 v192, v1, 2, s62
v_mov_b32 v193, s88
s_waitcnt vmcnt(0)
s_barrier
s_cmp_lg_u32 s34, 0
s_cbranch_scc1 L_sig_Wq
s_mov_b32 exec_hi, 0
buffer_store_dword v193, v192, s[52:55], 0 offen sc1
s_mov_b64 exec, -1
L_sig_Wq:
s_lshl_b32 s60, s32, 8
s_sub_u32 s61, 0x400000, s60
s_add_u32 s40, s22, s60
s_addc_u32 s41, s23, 0
s_and_b32 s41, s41, 0xffff
s_mov_b32 s42, s61
s_mov_b32 s43, 0x20000
s_lshl_b32 s60, s32, 17
s_mov_b32 s61, 0x20000
s_add_u32 s44, s24, s60
s_addc_u32 s45, s25, 0
s_and_b32 s45, s45, 0xffff
s_mov_b32 s46, s61
s_mov_b32 s47, 0x20000
v_lshlrev_b32 v10, 12, v3
v_lshl_add_u32 v10, v2, 4, v10
s_lshl_b32 s62, s34, 14
v_add_u32 v10, s62, v10
s_waitcnt vmcnt(2)
s_mov_b32 s62, 0
buffer_load_dwordx4 v[64:67], v9, s[40:43], s62 offen nt
s_waitcnt vmcnt(2)
s_mov_b32 s62, 8192
buffer_load_dwordx4 v[68:71], v9, s[40:43], s62 offen nt
s_waitcnt vmcnt(2)
s_mov_b32 s62, 16384
buffer_load_dwordx4 v[72:75], v9, s[40:43], s62 offen nt
s_waitcnt vmcnt(2)
s_mov_b32 s62, 24576
buffer_load_dwordx4 v[76:79], v9, s[40:43], s62 offen nt
s_waitcnt vmcnt(2)
s_mov_b32 s62, 32768
buffer_load_dwordx4 v[80:83], v9, s[40:43], s62 offen nt
s_waitcnt vmcnt(2)
s_mov_b32 s62, 40960
buffer_load_dwordx4 v[84:87], v9, s[40:43], s62 offen nt
s_waitcnt vmcnt(2)
s_mov_b32 s62, 49152
buffer_load_dwordx4 v[88:91], v9, s[40:43], s62 offen nt
s_waitcnt vmcnt(2)
s_mov_b32 s62, 57344
buffer_load_dwordx4 v[92:95], v9, s[40:43], s62 offen nt
s_waitcnt vmcnt(2)
s_mov_b32 s62, 65536
buffer_load_dwordx4 v[96:99], v9, s[40:43], s62 offen nt
s_waitcnt vmcnt(2)
s_mov_b32 s62, 73728
buffer_load_dwordx4 v[100:103], v9, s[40:43], s62 offen nt
s_waitcnt vmcnt(2)
s_mov_b32 s62, 81920
buffer_load_dwordx4 v[104:107], v9, s[40:43], s62 offen nt
s_waitcnt vmcnt(2)
s_mov_b32 s62, 90112
buffer_load_dwordx4 v[108:111], v9, s[40:43], s62 offen nt
s_waitcnt vmcnt(2)
s_mov_b32 s62, 98304
buffer_load_dwordx4 v[112:115], v9, s[40:43], s62 offen nt
s_waitcnt vmcnt(2)
s_mov_b32 s62, 106496
buffer_load_dwordx4 v[116:119], v9, s[40:43], s62 offen nt
s_waitcnt vmcnt(2)
s_mov_b32 s62, 114688
buffer_load_dwordx4 v[120:123], v9, s[40:43], s62 offen nt
s_waitcnt vmcnt(2)
s_mov_b32 s62, 122880
buffer_load_dwordx4 v[124:127], v9, s[40:43], s62 offen nt
s_waitcnt vmcnt(2)
buffer_load_dwordx4 v[128:131], v10, s[44:47], 0 offen offset:0 nt
s_waitcnt vmcnt(2)
buffer_load_dwordx4 v[132:135], v10, s[44:47], 0 offen offset:256 nt
s_waitcnt vmcnt(2)
buffer_load_dwordx4 v[136:139], v10, s[44:47], 0 offen offset:512 nt
s_waitcnt vmcnt(2)
buffer_load_dwordx4 v[140:143], v10, s[44:47], 0 offen offset:768 nt
s_waitcnt vmcnt(2)
buffer_load_dwordx4 v[144:147], v10, s[44:47], 0 offen offset:1024 nt
s_waitcnt vmcnt(2)
buffer_load_dwordx4 v[148:151], v10, s[44:47], 0 offen offset:1280 nt
s_waitcnt vmcnt(2)
buffer_load_dwordx4 v[152:155], v10, s[44:47], 0 offen offset:1536 nt
s_waitcnt vmcnt(2)
buffer_load_dwordx4 v[156:159], v10, s[44:47], 0 offen offset:1792 nt
s_waitcnt vmcnt(2)
buffer_load_dwordx4 v[160:163], v10, s[44:47], 0 offen offset:2048 nt
s_waitcnt vmcnt(2)
buffer_load_dwordx4 v[164:167], v10, s[44:47], 0 offen offset:2304 nt
s_waitcnt vmcnt(2)
buffer_load_dwordx4 v[168:171], v10, s[44:47], 0 offen offset:2560 nt
s_waitcnt vmcnt(2)
buffer_load_dwordx4 v[172:175], v10, s[44:47], 0 offen offset:2816 nt
s_waitcnt vmcnt(2)
buffer_load_dwordx4 v[176:179], v10, s[44:47], 0 offen offset:3072 nt
s_waitcnt vmcnt(2)
buffer_load_dwordx4 v[180:183], v10, s[44:47], 0 offen offset:3328 nt
s_waitcnt vmcnt(2)
buffer_load_dwordx4 v[184:187], v10, s[44:47], 0 offen offset:3584 nt
s_waitcnt vmcnt(2)
buffer_load_dwordx4 v[188:191], v10, s[44:47], 0 offen offset:3840 nt
s_cmp_lg_u32 s34, 7
s_cbranch_scc1 L_W_nogm
s_cmp_ge_u32 s32, 8
s_cbranch_scc1 L_W_nogm
s_and_b32 s63, s32, 7
s_lshl_b32 s63, s63, 8
s_add_u32 s63, s63, 0xc0000
s_add_u32 s56, s30, s63
s_addc_u32 s57, s31, 0
s_mov_b32 s64, 0
s_mov_b32 s59, 0
s_lshl_b32 s62, s32, 8
s_add_u32 s62, s62, 0xc1000
v_lshl_add_u32 v204, v1, 4, s62
s_mov_b32 s62, 0xc1000
v_lshl_add_u32 v205, v1, 8, s62
v_lshlrev_b32 v206, 2, v1
v_mov_b32 v207, 96
L_gm_W:
s_mov_b64 exec, 0xff
global_load_dword v209, v205, s[30:31] sc1
s_mov_b64 exec, 0x1ffffff
global_load_dword v208, v206, s[56:57] nt
s_waitcnt vmcnt(0)
v_subrev_u32 v208, s88, v208
s_mov_b64 exec, 0xffffff
v_cmp_le_u32 vcc, 0x400, v208
v_readlane_b32 s62, v208, 24
v_add_u32_dpp v208, v208, v208 row_shr:1 row_mask:0xf bank_mask:0xf bound_ctrl:0
s_nop 1
v_add_u32_dpp v208, v208, v208 row_shr:2 row_mask:0xf bank_mask:0xf bound_ctrl:0
s_nop 1
v_add_u32_dpp v208, v208, v208 row_shr:4 row_mask:0xf bank_mask:0xf bound_ctrl:0
s_nop 1
v_add_u32_dpp v208, v208, v208 row_shr:8 row_mask:0xf bank_mask:0xf bound_ctrl:0
s_nop 0
v_readlane_b32 s61, v208, 15
v_readlane_b32 s63, v208, 23
s_add_u32 s61, s61, s63
s_mov_b64 exec, 0xff
s_cbranch_vccnz L_gm_W_next
s_add_u32 s63, s61, s88
v_mov_b32 v200, s63
v_mov_b32 v201, s63
v_mov_b32 v202, s63
v_mov_b32 v203, s63
global_store_dwordx4 v204, v[200:203], s[30:31] sc1
s_mul_i32 s63, s61, 0
s_mul_i32 s65, s59, 8
s_add_u32 s65, s65, s63
s_cmp_eq_u32 s59, 0
s_mov_b32 s59, s61
s_cbranch_scc1 L_gm_W_next
v_subrev_u32 v209, s88, v209
v_cmp_le_u32 vcc, 0x8000, v209
s_nop 0
v_add_u32_dpp v209, v209, v209 row_shr:1 row_mask:0xf bank_mask:0xf bound_ctrl:0
s_nop 1
v_add_u32_dpp v209, v209, v209 row_shr:2 row_mask:0xf bank_mask:0xf bound_ctrl:0
s_nop 1
v_add_u32_dpp v209, v209, v209 row_shr:4 row_mask:0xf bank_mask:0xf bound_ctrl:0
s_cbranch_vccnz L_gm_W_next
s_nop 0
v_readlane_b32 s63, v209, 7
s_sub_u32 s63, s63, s65
s_ashr_i32 s63, s63, 3
s_add_u32 s63, s63, 0x4000
s_add_u32 s63, s63, s88
v_mov_b32 v210, s63
global_store_dword v207, v210, s[56:57]
L_gm_W_next:
ds_read_b32 v211, v8 offset:8704
s_waitcnt lgkmcnt(0)
v_readfirstlane_b32 s63, v211
s_cmp_eq_u32 s63, s88
s_cbranch_scc1 L_gm_W_x
s_add_u32 s64, s64, 1
s_cmp_lt_u32 s64, 128
s_cbranch_scc1 L_gm_W
L_gm_W_x:
s_mov_b64 exec, -1
L_W_nogm:
s_cmp_lg_u32 s34, 6
s_cbranch_scc1 L_W_noas
s_and_b32 s63, s32, 7
s_lshl_b32 s63, s63, 8
s_add_u32 s63, s63, 0xc0000
s_add_u32 s56, s30, s63
s_addc_u32 s57, s31, 0
s_lshl_b32 s62, s32, 21
s_sub_u32 s63, 0x8000000, s62
s_add_u32 s68, s6, s62
s_addc_u32 s69, s7, 0
s_and_b32 s69, s69, 0xffff
s_mov_b32 s70, s63
s_mov_b32 s71, 0x20000
s_add_u32 s72, s8, s62
s_addc_u32 s73, s9, 0
s_and_b32 s73, s73, 0xffff
s_mov_b32 s74, s63
s_mov_b32 s75, 0x20000
s_mov_b64 s[76:77], s[68:69]
s_mov_b64 s[78:79], s[70:71]
s_lshr_b32 s62, s32, 3
s_mul_i32 s62, s62, 6
s_sub_u32 s62, s62, 32
v_add_u32 v208, s62, v1
v_cmp_gt_u32 vcc, 32, v1
v_lshlrev_b32 v205, 7, v1
v_add_u32 v206, 0x4000000, v205
v_cndmask_b32 v200, v208, v1, vcc
v_lshlrev_b32 v200, 2, v200
v_mov_b32 v204, 0
s_mov_b32 s64, 0
L_as_W:
s_mov_b64 exec, 0x1ffffff
s_mov_b32 exec_hi, 0x3f
global_load_dword v201, v200, s[56:57] nt
s_waitcnt vmcnt(0)
v_subrev_u32 v201, s88, v201
s_mov_b64 exec, 0xffffff
v_cmp_le_u32 vcc, 0x400, v201
v_readlane_b32 s62, v201, 24
v_add_u32_dpp v201, v201, v201 row_shr:1 row_mask:0xf bank_mask:0xf bound_ctrl:0
s_nop 1
v_add_u32_dpp v201, v201, v201 row_shr:2 row_mask:0xf bank_mask:0xf bound_ctrl:0
s_nop 1
v_add_u32_dpp v201, v201, v201 row_shr:4 row_mask:0xf bank_mask:0xf bound_ctrl:0
s_nop 1
v_add_u32_dpp v201, v201, v201 row_shr:8 row_mask:0xf bank_mask:0xf bound_ctrl:0
s_nop 0
v_readlane_b32 s61, v201, 15
v_readlane_b32 s63, v201, 23
s_add_u32 s61, s61, s63
s_cbranch_vccnz L_as_W_idle
s_sub_u32 s61, s61, 120
s_mov_b32 exec_lo, 0
s_mov_b32 exec_hi, 0x3f
v_cmp_gt_u32 vcc, 280, v201
v_add_u32 v202, 56, v201
s_nop 0
v_cndmask_b32 v208, 0, 8, vcc
v_add_u32 v202, v202, v208
v_lshrrev_b32 v202, 4, v202
v_sub_u32 v208, v202, v204
v_cmp_gt_i32 vcc, 4, v208
v_cmp_le_i32 s[66:67], 2, v208
s_nop 0
v_cndmask_b32 v203, 0, 7, vcc
v_cmp_ge_u32 vcc, 41, v202
v_add_u32 v203, v203, v201
v_lshl_add_u32 v203, v203, 6, v1
s_and_b64 vcc, vcc, s[66:67]
v_cndmask_b32 v203, -1, v203, vcc
s_nop 1
v_min_u32_dpp v203, v203, v203 row_shr:1 row_mask:0xf bank_mask:0xf
s_nop 1
v_min_u32_dpp v203, v203, v203 row_shr:2 row_mask:0xf bank_mask:0xf
s_nop 1
v_min_u32_dpp v203, v203, v203 row_shr:4 row_mask:0xf bank_mask:0xf
s_nop 0
v_readlane_b32 s63, v203, 37
s_lshr_b32 s65, s63, 6
s_and_b32 s63, s63, 63
s_mul_i32 s65, s65, 24
s_cmp_ge_i32 s65, s61
s_cbranch_scc1 L_as_W_idle
v_readlane_b32 s65, v202, s63
s_mov_b32 m0, s63
s_mov_b64 exec, -1
s_cmp_lt_u32 s65, 21
s_cselect_b64 s[76:77], s[68:69], s[72:73]
v_writelane_b32 v204, s65, m0
s_cselect_b32 s66, 0, 21
s_sub_u32 s65, s65, s66
s_mul_i32 s65, s65, 0x18000
s_and_b32 s63, s63, 7
s_lshl_b32 s63, s63, 14
s_add_u32 s65, s65, s63
s_add_u32 s66, s65, 0x2000
buffer_load_dword v207, v205, s[76:79], s65 offen
buffer_load_dword v207, v205, s[76:79], s66 offen
buffer_load_dword v207, v206, s[76:79], s65 offen
buffer_load_dword v207, v206, s[76:79], s66 offen
s_waitcnt vmcnt(1)
s_branch L_as_W_next
L_as_W_idle:
s_sleep 4
L_as_W_next:
s_mov_b64 exec, 1
ds_read_b32 v208, v8 offset:8704
s_waitcnt lgkmcnt(0)
v_readfirstlane_b32 s63, v208
s_cmp_eq_u32 s63, s88
s_cbranch_scc1 L_as_W_x
s_add_u32 s64, s64, 1
s_cmp_lt_u32 s64, 96
s_cbranch_scc1 L_as_W
L_as_W_x:
s_mov_b64 exec, -1
s_waitcnt vmcnt(0)
L_W_noas:
s_cmp_lg_u32 s34, 0
s_cbranch_scc1 L_wc_Wc
s_lshl_b32 s62, s32, 4
s_add_u32 s62, s62, 0x10000
v_and_b32 v193, 31, v1
v_lshl_add_u32 v192, v193, 9, s62
s_lshl_b64 exec, 1, s32
s_mov_b32 s64, 0
L_tp_Wc0:
buffer_load_dwordx4 v[196:199], v192, s[52:55], 0 offen sc1
s_waitcnt vmcnt(0)
v_cmp_ne_u32 s[62:63], s88, v197
v_cmp_ne_u32 vcc, s88, v199
s_add_u32 s64, s64, 1
s_nop 0
s_or_b64 vcc, vcc, s[62:63]
s_cbranch_scc0 L_tp_Wc0_ok
s_sleep 32
s_cmp_lt_u32 s64, 65536
s_cbranch_scc1 L_tp_Wc0
L_tp_Wc0_ok:
s_mov_b32 exec_lo, -1
s_mov_b32 exec_hi, 0
s_mov_b32 s64, 0
L_tp_Wc:
buffer_load_dwordx4 v[196:199], v192, s[52:55], 0 offen sc1
s_waitcnt vmcnt(0)
v_cmp_ne_u32 s[62:63], s88, v197
v_cmp_ne_u32 vcc, s88, v199
s_add_u32 s64, s64, 1
s_nop 0
s_or_b64 vcc, vcc, s[62:63]
s_cbranch_scc0 L_tp_Wc_ok
s_mov_b64 exec, vcc
s_sleep 8
s_cmp_lt_u32 s64, 65536
s_cbranch_scc1 L_tp_Wc
L_tp_Wc_ok:
s_mov_b32 exec_lo, -1
s_mov_b32 exec_hi, 0
v_lshlrev_b32 v193, 3, v193
v_mov_b32 v197, v198
ds_write_b64 v193, v[196:197] offset:8192
v_mov_b32 v199, s88
ds_write_b32 v8, v199 offset:8704
s_mov_b64 exec, -1
s_waitcnt lgkmcnt(0)
L_wc_Wc:
s_barrier
s_lshr_b32 s35, s34, 2
s_and_b32 s36, s34, 3
s_lshl_b32 s62, s35, 5
s_add_u32 s62, s62, s32
s_lshl_b32 s63, s62, 7
s_add_u32 s63, s63, 0x10000
v_lshl_add_u32 v192, v2, 3, s63
s_lshl_b32 s63, s35, 7
v_lshl_add_u32 v192, v2, 3, s63
ds_read_b64 v[194:195], v192 offset:8192
s_lshl_b32 s63, s62, 14
s_add_u32 s63, s63, 0x200000
s_lshl_b32 s64, s36, 12
s_add_u32 s63, s63, s64
v_lshl_add_u32 v193, v1, 4, s63
buffer_load_dwordx4 v[200:203], v193, s[52:55], 0 offen offset:0 sc1
buffer_load_dwordx4 v[204:207], v193, s[52:55], 0 offen offset:1024 sc1
buffer_load_dwordx4 v[208:211], v193, s[52:55], 0 offen offset:2048 sc1
buffer_load_dwordx4 v[212:215], v193, s[52:55], 0 offen offset:3072 sc1
s_waitcnt vmcnt(4) lgkmcnt(0)
v_mov_b32 v196, v194
s_nop 1
v_max_f32_dpp v196, v196, v196 row_ror:8 row_mask:0xf bank_mask:0xf
s_nop 1
v_max_f32_dpp v196, v196, v196 row_ror:4 row_mask:0xf bank_mask:0xf
s_nop 1
v_max_f32_dpp v196, v196, v196 row_ror:2 row_mask:0xf bank_mask:0xf
s_nop 1
v_max_f32_dpp v196, v196, v196 row_ror:1 row_mask:0xf bank_mask:0xf
v_sub_f32 v197, v194, v196
v_exp_f32 v197, v197
s_nop 0
v_mul_f32 v195, v195, v197
s_nop 1
v_add_f32_dpp v195, v195, v195 row_ror:8 row_mask:0xf bank_mask:0xf
s_nop 1
v_add_f32_dpp v195, v195, v195 row_ror:4 row_mask:0xf bank_mask:0xf
s_nop 1
v_add_f32_dpp v195, v195, v195 row_ror:2 row_mask:0xf bank_mask:0xf
s_nop 1
v_add_f32_dpp v195, v195, v195 row_ror:1 row_mask:0xf bank_mask:0xf
v_rcp_f32 v195, v195
s_nop 0
v_mul_f32 v197, v197, v195
s_lshl_b32 s64, s36, 2
s_add_u32 s65, s64, 0
v_readlane_b32 s66, v197, s65
s_add_u32 s65, s64, 1
v_readlane_b32 s67, v197, s65
s_add_u32 s65, s64, 2
v_readlane_b32 s68, v197, s65
s_add_u32 s65, s64, 3
v_readlane_b32 s69, v197, s65
s_waitcnt vmcnt(3)
v_lshlrev_b32 v216, 16, v200
v_and_b32 v217, 0xffff0000, v200
v_lshlrev_b32 v218, 16, v201
v_and_b32 v219, 0xffff0000, v201
v_lshlrev_b32 v220, 16, v202
v_and_b32 v221, 0xffff0000, v202
v_lshlrev_b32 v222, 16, v203
v_and_b32 v223, 0xffff0000, v203
v_mul_f32 v232, s66, v216
v_mul_f32 v233, s66, v217
v_mul_f32 v234, s66, v218
v_mul_f32 v235, s66, v219
v_mul_f32 v236, s66, v220
v_mul_f32 v237, s66, v221
v_mul_f32 v238, s66, v222
v_mul_f32 v239, s66, v223
s_waitcnt vmcnt(2)
v_lshlrev_b32 v216, 16, v204
v_and_b32 v217, 0xffff0000, v204
v_lshlrev_b32 v218, 16, v205
v_and_b32 v219, 0xffff0000, v205
v_lshlrev_b32 v220, 16, v206
v_and_b32 v221, 0xffff0000, v206
v_lshlrev_b32 v222, 16, v207
v_and_b32 v223, 0xffff0000, v207
v_fma_f32 v232, v216, s67, v232
v_fma_f32 v233, v217, s67, v233
v_fma_f32 v234, v218, s67, v234
v_fma_f32 v235, v219, s67, v235
v_fma_f32 v236, v220, s67, v236
v_fma_f32 v237, v221, s67, v237
v_fma_f32 v238, v222, s67, v238
v_fma_f32 v239, v223, s67, v239
s_waitcnt vmcnt(1)
v_lshlrev_b32 v216, 16, v208
v_and_b32 v217, 0xffff0000, v208
v_lshlrev_b32 v218, 16, v209
v_and_b32 v219, 0xffff0000, v209
v_lshlrev_b32 v220, 16, v210
v_and_b32 v221, 0xffff0000, v210
v_lshlrev_b32 v222, 16, v211
v_and_b32 v223, 0xffff0000, v211
v_fma_f32 v232, v216, s68, v232
v_fma_f32 v233, v217, s68, v233
v_fma_f32 v234, v218, s68, v234
v_fma_f32 v235, v219, s68, v235
v_fma_f32 v236, v220, s68, v236
v_fma_f32 v237, v221, s68, v237
v_fma_f32 v238, v222, s68, v238
v_fma_f32 v239, v223, s68, v239
s_waitcnt vmcnt(0)
v_lshlrev_b32 v216, 16, v212
v_and_b32 v217, 0xffff0000, v212
v_lshlrev_b32 v218, 16, v213
v_and_b32 v219, 0xffff0000, v213
v_lshlrev_b32 v220, 16, v214
v_and_b32 v221, 0xffff0000, v214
v_lshlrev_b32 v222, 16, v215
v_and_b32 v223, 0xffff0000, v215
v_fma_f32 v232, v216, s69, v232
v_fma_f32 v233, v217, s69, v233
v_fma_f32 v234, v218, s69, v234
v_fma_f32 v235, v219, s69, v235
v_fma_f32 v236, v220, s69, v236
v_fma_f32 v237, v221, s69, v237
v_fma_f32 v238, v222, s69, v238
v_fma_f32 v239, v223, s69, v239
s_lshl_b32 s62, s34, 11
v_lshl_add_u32 v192, v1, 5, s62
ds_write_b128 v192, v[232:235] offset:18432
ds_write_b128 v192, v[236:239] offset:18448
s_waitcnt lgkmcnt(0)
s_barrier
v_lshrrev_b32 v192, 3, v2
v_lshlrev_b32 v192, 13, v192
v_lshl_add_u32 v192, v3, 6, v192
s_lshl_b32 s62, s34, 8
v_add_u32 v192, s62, v192
ds_read_b128 v[200:203], v192 offset:18432
ds_read_b128 v[204:207], v192 offset:18448
ds_read_b128 v[208:211], v192 offset:18464
ds_read_b128 v[212:215], v192 offset:18480
ds_read_b128 v[216:219], v192 offset:20480
ds_read_b128 v[220:223], v192 offset:20496
ds_read_b128 v[224:227], v192 offset:20512
ds_read_b128 v[228:231], v192 offset:20528
s_waitcnt lgkmcnt(0)
v_add_f32 v200, v200, v216
v_add_f32 v201, v201, v217
v_add_f32 v202, v202, v218
v_add_f32 v203, v203, v219
v_add_f32 v204, v204, v220
v_add_f32 v205, v205, v221
v_add_f32 v206, v206, v222
v_add_f32 v207, v207, v223
v_add_f32 v208, v208, v224
v_add_f32 v209, v209, v225
v_add_f32 v210, v210, v226
v_add_f32 v211, v211, v227
v_add_f32 v212, v212, v228
v_add_f32 v213, v213, v229
v_add_f32 v214, v214, v230
v_add_f32 v215, v215, v231
ds_read_b128 v[216:219], v192 offset:22528
ds_read_b128 v[220:223], v192 offset:22544
ds_read_b128 v[224:227], v192 offset:22560
ds_read_b128 v[228:231], v192 offset:22576
s_waitcnt lgkmcnt(0)
v_add_f32 v200, v200, v216
v_add_f32 v201, v201, v217
v_add_f32 v202, v202, v218
v_add_f32 v203, v203, v219
v_add_f32 v204, v204, v220
v_add_f32 v205, v205, v221
v_add_f32 v206, v206, v222
v_add_f32 v207, v207, v223
v_add_f32 v208, v208, v224
v_add_f32 v209, v209, v225
v_add_f32 v210, v210, v226
v_add_f32 v211, v211, v227
v_add_f32 v212, v212, v228
v_add_f32 v213, v213, v229
v_add_f32 v214, v214, v230
v_add_f32 v215, v215, v231
ds_read_b128 v[216:219], v192 offset:24576
ds_read_b128 v[220:223], v192 offset:24592
ds_read_b128 v[224:227], v192 offset:24608
ds_read_b128 v[228:231], v192 offset:24624
s_waitcnt lgkmcnt(0)
v_add_f32 v200, v200, v216
v_add_f32 v201, v201, v217
v_add_f32 v202, v202, v218
v_add_f32 v203, v203, v219
v_add_f32 v204, v204, v220
v_add_f32 v205, v205, v221
v_add_f32 v206, v206, v222
v_add_f32 v207, v207, v223
v_add_f32 v208, v208, v224
v_add_f32 v209, v209, v225
v_add_f32 v210, v210, v226
v_add_f32 v211, v211, v227
v_add_f32 v212, v212, v228
v_add_f32 v213, v213, v229
v_add_f32 v214, v214, v230
v_add_f32 v215, v215, v231
v_cvt_pk_bf16_f32 v12, v200, v201
v_cvt_pk_bf16_f32 v13, v202, v203
v_cvt_pk_bf16_f32 v14, v204, v205
v_cvt_pk_bf16_f32 v15, v206, v207
v_cvt_pk_bf16_f32 v16, v208, v209
v_cvt_pk_bf16_f32 v17, v210, v211
v_cvt_pk_bf16_f32 v18, v212, v213
v_cvt_pk_bf16_f32 v19, v214, v215
s_mov_b32 s60, 0x01000100
v_perm_b32 v192, v12, v12, s60
v_and_b32 v28, v192, v4
v_and_b32 v29, v192, v5
v_and_b32 v30, v192, v6
v_and_b32 v31, v192, v7
s_waitcnt vmcnt(63)
s_nop 0
v_mfma_f32_16x16x32_bf16 v[44:47], v[28:31], v[64:67], 0
s_mov_b32 s60, 0x03020302
v_perm_b32 v193, v12, v12, s60
v_and_b32 v32, v193, v4
v_and_b32 v33, v193, v5
v_and_b32 v34, v193, v6
v_and_b32 v35, v193, v7
s_waitcnt vmcnt(63)
s_nop 0
v_mfma_f32_16x16x32_bf16 v[44:47], v[32:35], v[68:71], v[44:47]
s_mov_b32 s60, 0x01000100
v_perm_b32 v192, v13, v13, s60
v_and_b32 v28, v192, v4
v_and_b32 v29, v192, v5
v_and_b32 v30, v192, v6
v_and_b32 v31, v192, v7
s_waitcnt vmcnt(63)
s_nop 0
v_mfma_f32_16x16x32_bf16 v[44:47], v[28:31], v[72:75], v[44:47]
s_mov_b32 s60, 0x03020302
v_perm_b32 v193, v13, v13, s60
v_and_b32 v32, v193, v4
v_and_b32 v33, v193, v5
v_and_b32 v34, v193, v6
v_and_b32 v35, v193, v7
s_waitcnt vmcnt(63)
s_nop 0
v_mfma_f32_16x16x32_bf16 v[44:47], v[32:35], v[76:79], v[44:47]
s_mov_b32 s60, 0x01000100
v_perm_b32 v192, v14, v14, s60
v_and_b32 v28, v192, v4
v_and_b32 v29, v192, v5
v_and_b32 v30, v192, v6
v_and_b32 v31, v192, v7
s_waitcnt vmcnt(63)
s_nop 0
v_mfma_f32_16x16x32_bf16 v[44:47], v[28:31], v[80:83], v[44:47]
s_mov_b32 s60, 0x03020302
v_perm_b32 v193, v14, v14, s60
v_and_b32 v32, v193, v4
v_and_b32 v33, v193, v5
v_and_b32 v34, v193, v6
v_and_b32 v35, v193, v7
s_waitcnt vmcnt(63)
s_nop 0
v_mfma_f32_16x16x32_bf16 v[44:47], v[32:35], v[84:87], v[44:47]
s_mov_b32 s60, 0x01000100
v_perm_b32 v192, v15, v15, s60
v_and_b32 v28, v192, v4
v_and_b32 v29, v192, v5
v_and_b32 v30, v192, v6
v_and_b32 v31, v192, v7
s_waitcnt vmcnt(63)
s_nop 0
v_mfma_f32_16x16x32_bf16 v[44:47], v[28:31], v[88:91], v[44:47]
s_mov_b32 s60, 0x03020302
v_perm_b32 v193, v15, v15, s60
v_and_b32 v32, v193, v4
v_and_b32 v33, v193, v5
v_and_b32 v34, v193, v6
v_and_b32 v35, v193, v7
s_waitcnt vmcnt(63)
s_nop 0
v_mfma_f32_16x16x32_bf16 v[44:47], v[32:35], v[92:95], v[44:47]
s_mov_b32 s60, 0x01000100
v_perm_b32 v192, v16, v16, s60
v_and_b32 v28, v192, v4
v_and_b32 v29, v192, v5
v_and_b32 v30, v192, v6
v_and_b32 v31, v192, v7
s_waitcnt vmcnt(63)
s_nop 0
v_mfma_f32_16x16x32_bf16 v[44:47], v[28:31], v[96:99], v[44:47]
s_mov_b32 s60, 0x03020302
v_perm_b32 v193, v16, v16, s60
v_and_b32 v32, v193, v4
v_and_b32 v33, v193, v5
v_and_b32 v34, v193, v6
v_and_b32 v35, v193, v7
s_waitcnt vmcnt(63)
s_nop 0
v_mfma_f32_16x16x32_bf16 v[44:47], v[32:35], v[100:103], v[44:47]
s_mov_b32 s60, 0x01000100
v_perm_b32 v192, v17, v17, s60
v_and_b32 v28, v192, v4
v_and_b32 v29, v192, v5
v_and_b32 v30, v192, v6
v_and_b32 v31, v192, v7
s_waitcnt vmcnt(63)
s_nop 0
v_mfma_f32_16x16x32_bf16 v[44:47], v[28:31], v[104:107], v[44:47]
s_mov_b32 s60, 0x03020302
v_perm_b32 v193, v17, v17, s60
v_and_b32 v32, v193, v4
v_and_b32 v33, v193, v5
v_and_b32 v34, v193, v6
v_and_b32 v35, v193, v7
s_waitcnt vmcnt(63)
s_nop 0
v_mfma_f32_16x16x32_bf16 v[44:47], v[32:35], v[108:111], v[44:47]
s_mov_b32 s60, 0x01000100
v_perm_b32 v192, v18, v18, s60
v_and_b32 v28, v192, v4
v_and_b32 v29, v192, v5
v_and_b32 v30, v192, v6
v_and_b32 v31, v192, v7
s_waitcnt vmcnt(63)
s_nop 0
v_mfma_f32_16x16x32_bf16 v[44:47], v[28:31], v[112:115], v[44:47]
s_mov_b32 s60, 0x03020302
v_perm_b32 v193, v18, v18, s60
v_and_b32 v32, v193, v4
v_and_b32 v33, v193, v5
v_and_b32 v34, v193, v6
v_and_b32 v35, v193, v7
s_waitcnt vmcnt(63)
s_nop 0
v_mfma_f32_16x16x32_bf16 v[44:47], v[32:35], v[116:119], v[44:47]
s_mov_b32 s60, 0x01000100
v_perm_b32 v192, v19, v19, s60
v_and_b32 v28, v192, v4
v_and_b32 v29, v192, v5
v_and_b32 v30, v192, v6
v_and_b32 v31, v192, v7
s_waitcnt vmcnt(63)
s_nop 0
v_mfma_f32_16x16x32_bf16 v[44:47], v[28:31], v[120:123], v[44:47]
s_mov_b32 s60, 0x03020302
v_perm_b32 v193, v19, v19, s60
v_and_b32 v32, v193, v4
v_and_b32 v33, v193, v5
v_and_b32 v34, v193, v6
v_and_b32 v35, v193, v7
s_waitcnt vmcnt(63)
s_nop 0
v_mfma_f32_16x16x32_bf16 v[44:47], v[32:35], v[124:127], v[44:47]
v_lshrrev_b32 v192, 1, v3
v_lshlrev_b32 v192, 9, v192
v_lshl_add_u32 v192, v2, 5, v192
v_and_b32 v193, 1, v3
v_lshl_add_u32 v192, v193, 4, v192
s_lshl_b32 s63, s34, 10
v_add_u32 v192, s63, v192
s_nop 1
s_nop 5
ds_write_b128 v192, v[44:47] offset:9216
s_waitcnt lgkmcnt(0)
s_barrier
v_lshrrev_b32 v192, 3, v2
v_lshlrev_b32 v192, 9, v192
v_lshl_add_u32 v192, v3, 4, v192
s_lshl_b32 s62, s34, 6
v_add_u32 v192, s62, v192
ds_read_b128 v[200:203], v192 offset:9216
ds_read_b128 v[204:207], v192 offset:10240
ds_read_b128 v[208:211], v192 offset:11264
ds_read_b128 v[212:215], v192 offset:12288
ds_read_b128 v[216:219], v192 offset:13312
ds_read_b128 v[220:223], v192 offset:14336
ds_read_b128 v[224:227], v192 offset:15360
ds_read_b128 v[228:231], v192 offset:16384
s_waitcnt lgkmcnt(6)
v_add_f32 v200, v200, v204
v_add_f32 v201, v201, v205
v_add_f32 v202, v202, v206
v_add_f32 v203, v203, v207
s_waitcnt lgkmcnt(5)
v_add_f32 v200, v200, v208
v_add_f32 v201, v201, v209
v_add_f32 v202, v202, v210
v_add_f32 v203, v203, v211
s_waitcnt lgkmcnt(4)
v_add_f32 v200, v200, v212
v_add_f32 v201, v201, v213
v_add_f32 v202, v202, v214
v_add_f32 v203, v203, v215
s_waitcnt lgkmcnt(3)
v_add_f32 v200, v200, v216
v_add_f32 v201, v201, v217
v_add_f32 v202, v202, v218
v_add_f32 v203, v203, v219
s_waitcnt lgkmcnt(2)
v_add_f32 v200, v200, v220
v_add_f32 v201, v201, v221
v_add_f32 v202, v202, v222
v_add_f32 v203, v203, v223
s_waitcnt lgkmcnt(1)
v_add_f32 v200, v200, v224
v_add_f32 v201, v201, v225
v_add_f32 v202, v202, v226
v_add_f32 v203, v203, v227
s_waitcnt lgkmcnt(0)
v_add_f32 v200, v200, v228
v_add_f32 v201, v201, v229
v_add_f32 v202, v202, v230
v_add_f32 v203, v203, v231
v_cvt_pk_bf16_f32 v60, v200, v200
v_cvt_pk_bf16_f32 v61, v201, v201
v_cvt_pk_bf16_f32 v62, v202, v202
v_cvt_pk_bf16_f32 v63, v203, v203
v_and_b32 v28, v60, v4
v_and_b32 v29, v60, v5
v_and_b32 v30, v60, v6
v_and_b32 v31, v60, v7
v_and_b32 v32, v61, v4
v_and_b32 v33, v61, v5
v_and_b32 v34, v61, v6
v_and_b32 v35, v61, v7
v_and_b32 v36, v62, v4
v_and_b32 v37, v62, v5
v_and_b32 v38, v62, v6
v_and_b32 v39, v62, v7
v_and_b32 v40, v63, v4
v_and_b32 v41, v63, v5
v_and_b32 v42, v63, v6
v_and_b32 v43, v63, v7
s_nop 1
v_mfma_f32_16x16x32_bf16 v[44:47], v[28:31], v[128:131], 0
v_mfma_f32_16x16x32_bf16 v[48:51], v[28:31], v[132:135], 0
v_mfma_f32_16x16x32_bf16 v[52:55], v[28:31], v[136:139], 0
v_mfma_f32_16x16x32_bf16 v[56:59], v[28:31], v[140:143], 0
v_mfma_f32_16x16x32_bf16 v[44:47], v[32:35], v[144:147], v[44:47]
v_mfma_f32_16x16x32_bf16 v[48:51], v[32:35], v[148:151], v[48:51]
v_mfma_f32_16x16x32_bf16 v[52:55], v[32:35], v[152:155], v[52:55]
v_mfma_f32_16x16x32_bf16 v[56:59], v[32:35], v[156:159], v[56:59]
v_mfma_f32_16x16x32_bf16 v[44:47], v[36:39], v[160:163], v[44:47]
v_mfma_f32_16x16x32_bf16 v[48:51], v[36:39], v[164:167], v[48:51]
v_mfma_f32_16x16x32_bf16 v[52:55], v[36:39], v[168:171], v[52:55]
v_mfma_f32_16x16x32_bf16 v[56:59], v[36:39], v[172:175], v[56:59]
v_mfma_f32_16x16x32_bf16 v[44:47], v[40:43], v[176:179], v[44:47]
v_mfma_f32_16x16x32_bf16 v[48:51], v[40:43], v[180:183], v[48:51]
v_mfma_f32_16x16x32_bf16 v[52:55], v[40:43], v[184:187], v[52:55]
v_mfma_f32_16x16x32_bf16 v[56:59], v[40:43], v[188:191], v[56:59]
v_lshrrev_b32 v192, 1, v3
v_lshlrev_b32 v192, 11, v192
v_lshl_add_u32 v192, v2, 5, v192
v_and_b32 v193, 1, v3
v_lshl_add_u32 v192, v193, 4, v192
s_lshl_b32 s63, s34, 12
v_add_u32 v192, s63, v192
s_nop 1
ds_write_b128 v192, v[44:47] offset:18432
ds_write_b128 v192, v[48:51] offset:18944
ds_write_b128 v192, v[52:55] offset:19456
s_nop 5
ds_write_b128 v192, v[56:59] offset:19968
s_waitcnt lgkmcnt(0)
s_barrier
s_cmp_ge_u32 s34, 4
s_cbranch_scc1 L_W_yskip
v_lshlrev_b32 v192, 4, v0
ds_read_b128 v[200:203], v192 offset:18432
ds_read_b128 v[204:207], v192 offset:22528
ds_read_b128 v[208:211], v192 offset:26624
ds_read_b128 v[212:215], v192 offset:30720
ds_read_b128 v[216:219], v192 offset:34816
ds_read_b128 v[220:223], v192 offset:38912
ds_read_b128 v[224:227], v192 offset:43008
ds_read_b128 v[228:231], v192 offset:47104
v_lshrrev_b32 v193, 7, v0
v_lshlrev_b32 v193, 16, v193
v_and_b32 v194, 127, v0
v_lshl_add_u32 v193, v194, 4, v193
s_lshl_b32 s63, s32, 11
s_add_u32 s63, s63, 0x20000
v_add_u32 v193, s63, v193
s_waitcnt lgkmcnt(6)
v_add_f32 v200, v200, v204
v_add_f32 v201, v201, v205
v_add_f32 v202, v202, v206
v_add_f32 v203, v203, v207
s_waitcnt lgkmcnt(5)
v_add_f32 v200, v200, v208
v_add_f32 v201, v201, v209
v_add_f32 v202, v202, v210
v_add_f32 v203, v203, v211
s_waitcnt lgkmcnt(4)
v_add_f32 v200, v200, v212
v_add_f32 v201, v201, v213
v_add_f32 v202, v202, v214
v_add_f32 v203, v203, v215
s_waitcnt lgkmcnt(3)
v_add_f32 v200, v200, v216
v_add_f32 v201, v201, v217
v_add_f32 v202, v202, v218
v_add_f32 v203, v203, v219
s_waitcnt lgkmcnt(2)
v_add_f32 v200, v200, v220
v_add_f32 v201, v201, v221
v_add_f32 v202, v202, v222
v_add_f32 v203, v203, v223
s_waitcnt lgkmcnt(1)
v_add_f32 v200, v200, v224
v_add_f32 v201, v201, v225
v_add_f32 v202, v202, v226
v_add_f32 v203, v203, v227
s_waitcnt lgkmcnt(0)
v_add_f32 v200, v200, v228
v_add_f32 v201, v201, v229
v_add_f32 v202, v202, v230
v_add_f32 v203, v203, v231
v_cvt_pk_bf16_f32 v200, v200, v201
v_cvt_pk_bf16_f32 v202, v202, v203
v_mov_b32 v201, s88
v_mov_b32 v203, s88
buffer_store_dwordx4 v[200:203], v193, s[52:55], 0 offen sc1
L_W_yskip:
s_lshr_b32 s35, s32, 4
s_and_b32 s36, s32, 15
v_mov_b32 v232, 0
v_mov_b32 v233, 0
v_mov_b32 v234, 0
v_mov_b32 v235, 0
s_cmp_ge_u32 s34, 4
s_cbranch_scc1 L_W_bskip
v_lshrrev_b32 v192, 3, v0
v_lshlrev_b32 v192, 11, v192
v_and_b32 v193, 7, v0
v_lshl_add_u32 v192, v193, 4, v192
s_lshl_b32 s62, s35, 16
s_lshl_b32 s63, s36, 7
s_add_u32 s62, s62, s63
s_add_u32 s62, s62, 0x20000
v_add_u32 v192, s62, v192
s_mov_b32 s64, 0
L_tp_Wyb:
buffer_load_dwordx4 v[232:235], v192, s[52:55], 0 offen sc1
s_waitcnt vmcnt(0)
v_cmp_ne_u32 s[62:63], s88, v233
v_cmp_ne_u32 vcc, s88, v235
s_add_u32 s64, s64, 1
s_nop 0
s_or_b64 vcc, vcc, s[62:63]
s_cbranch_scc0 L_tp_Wyb_ok
s_mov_b64 exec, vcc
s_sleep 8
s_cmp_lt_u32 s64, 65536
s_cbranch_scc1 L_tp_Wyb
L_tp_Wyb_ok:
s_mov_b64 exec, -1
v_and_b32 v233, 0xffff0000, v232
v_lshlrev_b32 v232, 16, v232
v_and_b32 v235, 0xffff0000, v234
v_lshlrev_b32 v234, 16, v234
L_W_bskip:
s_nop 1
v_add_f32_dpp v232, v232, v232 row_ror:8 row_mask:0xf bank_mask:0xf
v_add_f32_dpp v233, v233, v233 row_ror:8 row_mask:0xf bank_mask:0xf
v_add_f32_dpp v234, v234, v234 row_ror:8 row_mask:0xf bank_mask:0xf
v_add_f32_dpp v235, v235, v235 row_ror:8 row_mask:0xf bank_mask:0xf
v_mov_b32 v192, v232
v_mov_b32 v193, v233
v_mov_b32 v194, v234
v_mov_b32 v195, v235
s_nop 1
v_permlane16_swap_b32 v232, v192
v_permlane16_swap_b32 v233, v193
v_permlane16_swap_b32 v234, v194
v_permlane16_swap_b32 v235, v195
s_nop 0
v_add_f32 v232, v232, v192
v_add_f32 v233, v233, v193
v_add_f32 v234, v234, v194
v_add_f32 v235, v235, v195
v_mov_b32 v192, v232
v_mov_b32 v193, v233
v_mov_b32 v194, v234
v_mov_b32 v195, v235
s_nop 1
v_permlane32_swap_b32 v232, v192
v_permlane32_swap_b32 v233, v193
v_permlane32_swap_b32 v234, v194
v_permlane32_swap_b32 v235, v195
s_nop 0
v_add_f32 v232, v232, v192
v_add_f32 v233, v233, v193
v_add_f32 v234, v234, v194
v_add_f32 v235, v235, v195
v_lshlrev_b32 v192, 4, v1
s_lshl_b32 s63, s34, 7
v_add_u32 v192, s63, v192
s_mov_b64 exec, 0xff
ds_write_b128 v192, v[232:235] offset:17408
s_mov_b64 exec, -1
s_waitcnt lgkmcnt(0)
s_barrier
s_cmp_lg_u32 s34, 0
s_cbranch_scc1 L_Wb_fin
v_lshlrev_b32 v192, 2, v1
s_mov_b32 exec_hi, 0
ds_read_b32 v193, v192 offset:17408
ds_read_b32 v194, v192 offset:17536
ds_read_b32 v195, v192 offset:17664
ds_read_b32 v196, v192 offset:17792
s_waitcnt lgkmcnt(0)
v_add_f32 v193, v193, v194
v_add_f32 v193, v193, v195
v_add_f32 v193, v193, v196
v_cvt_pk_bf16_f32 v193, v193, v193
s_lshr_b32 s62, s32, 4
s_lshl_b32 s62, s62, 11
s_and_b32 s63, s32, 15
s_lshl_b32 s63, s63, 6
s_add_u32 s62, s62, s63
s_add_u32 s62, s62, 1024
v_lshl_add_u32 v192, v1, 1, s62
global_store_short v192, v193, s[26:27]
s_mov_b64 exec, -1
L_Wb_fin:
v_lshrrev_b32 v192, 3, v1
s_lshl_b32 s62, s35, 8
s_lshl_b32 s63, s34, 3
s_add_u32 s62, s62, s63
v_add_u32 v192, s62, v192
v_lshlrev_b32 v9, 4, v192
v_add_u32 v9, 0x14000, v9
v_and_b32 v9, 255, v192
s_lshl_b32 s63, s35, 4
s_add_u32 s63, s63, 0x50000
v_lshl_add_u32 v9, v9, 7, s63
v_lshlrev_b32 v10, 10, v192
v_and_b32 v193, 7, v1
v_lshl_add_u32 v10, v193, 3, v10
s_lshl_b32 s63, s36, 6
s_add_u32 s63, s63, 0x100000
v_add_u32 v10, s63, v10
v_mov_b32 v80, 0xff800000
v_mov_b32 v81, 0
v_mov_b32 v64, 0
v_mov_b32 v65, 0
v_mov_b32 v82, 0xff800000
v_mov_b32 v83, 0
v_mov_b32 v66, 0
v_mov_b32 v67, 0
v_mov_b32 v84, 0xff800000
v_mov_b32 v85, 0
v_mov_b32 v68, 0
v_mov_b32 v69, 0
v_mov_b32 v86, 0xff800000
v_mov_b32 v87, 0
v_mov_b32 v70, 0
v_mov_b32 v71, 0
s_mov_b32 s66, -1
s_mov_b32 s67, 0xffff
s_mov_b32 s68, -1
s_mov_b32 s69, 0xffff
s_mov_b32 s70, -1
s_mov_b32 s71, 0xffff
s_mov_b32 s72, -1
s_mov_b32 s73, 0xffff
s_mov_b32 s64, 0
s_mov_b64 exec, s[66:67]
L_W_stt:
s_mov_b32 s63, 0
buffer_load_dwordx4 v[96:99], v9, s[52:55], s63 offen sc1
s_mov_b32 s63, 8192
buffer_load_dwordx4 v[100:103], v9, s[52:55], s63 offen sc1
s_mov_b32 s63, 16384
buffer_load_dwordx4 v[104:107], v9, s[52:55], s63 offen sc1
s_mov_b32 s63, 24576
buffer_load_dwordx4 v[108:111], v9, s[52:55], s63 offen sc1
s_waitcnt vmcnt(0)
v_xor_b32 v97, s88, v97
v_xor_b32 v99, s88, v99
v_xor_b32 v101, s88, v101
v_xor_b32 v103, s88, v103
v_xor_b32 v105, s88, v105
v_xor_b32 v107, s88, v107
v_xor_b32 v109, s88, v109
v_xor_b32 v111, s88, v111
v_or3_b32 v192, v97, v99, v101
v_or3_b32 v192, v192, v103, v105
v_or3_b32 v192, v192, v107, v109
v_or_b32 v192, v192, v111
v_cmp_ne_u32 vcc, 0, v192
s_add_u32 s64, s64, 1
s_nop 0
s_cmp_eq_u64 vcc, 0
s_cbranch_scc1 L_W_stt_done
s_sleep 16
s_cmp_lt_u32 s64, 65536
s_cbranch_scc1 L_W_stt
L_W_stt_done:
v_mov_b32 v80, v96
v_mov_b32 v81, v98
v_mov_b32 v82, v100
v_mov_b32 v83, v102
v_mov_b32 v84, v104
v_mov_b32 v85, v106
v_mov_b32 v86, v108
v_mov_b32 v87, v110
s_mov_b64 exec, -1
v_mov_b32 v192, v80
v_mov_b32 v193, v82
v_mov_b32 v194, v84
v_mov_b32 v195, v86
s_nop 1
v_max_f32_dpp v192, v192, v192 row_ror:8 row_mask:0xf bank_mask:0xf
v_max_f32_dpp v193, v193, v193 row_ror:8 row_mask:0xf bank_mask:0xf
v_max_f32_dpp v194, v194, v194 row_ror:8 row_mask:0xf bank_mask:0xf
v_max_f32_dpp v195, v195, v195 row_ror:8 row_mask:0xf bank_mask:0xf
v_mov_b32 v196, v192
v_mov_b32 v197, v193
v_mov_b32 v198, v194
v_mov_b32 v199, v195
s_nop 1
v_permlane16_swap_b32 v192, v196
v_permlane16_swap_b32 v193, v197
v_permlane16_swap_b32 v194, v198
v_permlane16_swap_b32 v195, v199
s_nop 0
v_max_f32 v192, v192, v196
v_max_f32 v193, v193, v197
v_max_f32 v194, v194, v198
v_max_f32 v195, v195, v199
v_mov_b32 v196, v192
v_mov_b32 v197, v193
v_mov_b32 v198, v194
v_mov_b32 v199, v195
s_nop 1
v_permlane32_swap_b32 v192, v196
v_permlane32_swap_b32 v193, v197
v_permlane32_swap_b32 v194, v198
v_permlane32_swap_b32 v195, v199
s_nop 0
v_max_f32 v192, v192, v196
v_max_f32 v193, v193, v197
v_max_f32 v194, v194, v198
v_max_f32 v195, v195, v199
v_sub_f32 v192, v80, v192
v_sub_f32 v193, v82, v193
v_sub_f32 v194, v84, v194
v_sub_f32 v195, v86, v195
v_exp_f32 v192, v192
v_exp_f32 v193, v193
v_exp_f32 v194, v194
v_exp_f32 v195, v195
s_nop 0
v_mul_f32 v200, v81, v192
v_mul_f32 v201, v83, v193
v_mul_f32 v202, v85, v194
v_mul_f32 v203, v87, v195
s_nop 1
v_add_f32_dpp v200, v200, v200 row_ror:8 row_mask:0xf bank_mask:0xf
v_add_f32_dpp v201, v201, v201 row_ror:8 row_mask:0xf bank_mask:0xf
v_add_f32_dpp v202, v202, v202 row_ror:8 row_mask:0xf bank_mask:0xf
v_add_f32_dpp v203, v203, v203 row_ror:8 row_mask:0xf bank_mask:0xf
v_mov_b32 v196, v200
v_mov_b32 v197, v201
v_mov_b32 v198, v202
v_mov_b32 v199, v203
s_nop 1
v_permlane16_swap_b32 v200, v196
v_permlane16_swap_b32 v201, v197
v_permlane16_swap_b32 v202, v198
v_permlane16_swap_b32 v203, v199
s_nop 0
v_add_f32 v200, v200, v196
v_add_f32 v201, v201, v197
v_add_f32 v202, v202, v198
v_add_f32 v203, v203, v199
v_mov_b32 v196, v200
v_mov_b32 v197, v201
v_mov_b32 v198, v202
v_mov_b32 v199, v203
s_nop 1
v_permlane32_swap_b32 v200, v196
v_permlane32_swap_b32 v201, v197
v_permlane32_swap_b32 v202, v198
v_permlane32_swap_b32 v203, v199
s_nop 0
v_add_f32 v200, v200, v196
v_add_f32 v201, v201, v197
v_add_f32 v202, v202, v198
v_add_f32 v203, v203, v199
v_rcp_f32 v200, v200
v_rcp_f32 v201, v201
v_rcp_f32 v202, v202
v_rcp_f32 v203, v203
s_nop 0
v_mul_f32 v80, v192, v200
v_mul_f32 v81, v193, v201
v_mul_f32 v82, v194, v202
v_mul_f32 v83, v195, v203
v_mov_b32 v232, 0
v_mov_b32 v233, 0
v_mov_b32 v234, 0
v_mov_b32 v235, 0
s_mov_b32 s64, 0
s_mov_b32 s74, 0x1010101
s_mov_b32 s75, 0x101
L_W_gate:
s_mov_b64 exec, s[74:75]
buffer_load_dword v192, v10, s[52:55], 0 offen sc1
s_waitcnt vmcnt(0)
v_cmp_ne_u32 vcc, -1, v192
s_mov_b64 exec, -1
s_add_u32 s64, s64, 1
s_cmp_lg_u64 vcc, 0
s_cbranch_scc1 L_W_gate_done
s_sleep 4
s_cmp_lt_u32 s64, 65536
s_cbranch_scc1 L_W_gate
L_W_gate_done:
s_mov_b32 s64, 0
s_mov_b32 s77, 65536
s_mov_b32 s78, 131072
s_mov_b32 s79, 196608
L_W_sweep:
s_mov_b64 exec, s[66:67]
s_cbranch_execz L_W_sw0
buffer_load_dwordx2 v[64:65], v10, s[52:55], 0 offen sc1
L_W_sw0:
s_mov_b64 exec, s[68:69]
s_cbranch_execz L_W_sw1
buffer_load_dwordx2 v[66:67], v10, s[52:55], s77 offen sc1
L_W_sw1:
s_mov_b64 exec, s[70:71]
s_cbranch_execz L_W_sw2
buffer_load_dwordx2 v[68:69], v10, s[52:55], s78 offen sc1
L_W_sw2:
s_mov_b64 exec, s[72:73]
s_cbranch_execz L_W_sw3
buffer_load_dwordx2 v[70:71], v10, s[52:55], s79 offen sc1
L_W_sw3:
s_waitcnt vmcnt(0)
s_mov_b64 exec, s[66:67]
s_cbranch_execz L_W_sx0
v_max_u32 v192, v64, v65
v_cmp_ne_u32 vcc, -1, v192
v_lshlrev_b32 v88, 16, v64
v_and_b32 v89, 0xffff0000, v64
v_lshlrev_b32 v90, 16, v65
v_and_b32 v91, 0xffff0000, v65
s_andn2_b64 s[66:67], exec, vcc
s_mov_b64 exec, vcc
v_fma_f32 v232, v80, v88, v232
v_fma_f32 v233, v80, v89, v233
v_fma_f32 v234, v80, v90, v234
v_fma_f32 v235, v80, v91, v235
L_W_sx0:
s_mov_b64 exec, s[68:69]
s_cbranch_execz L_W_sx1
v_max_u32 v192, v66, v67
v_cmp_ne_u32 vcc, -1, v192
v_lshlrev_b32 v88, 16, v66
v_and_b32 v89, 0xffff0000, v66
v_lshlrev_b32 v90, 16, v67
v_and_b32 v91, 0xffff0000, v67
s_andn2_b64 s[68:69], exec, vcc
s_mov_b64 exec, vcc
v_fma_f32 v232, v81, v88, v232
v_fma_f32 v233, v81, v89, v233
v_fma_f32 v234, v81, v90, v234
v_fma_f32 v235, v81, v91, v235
L_W_sx1:
s_mov_b64 exec, s[70:71]
s_cbranch_execz L_W_sx2
v_max_u32 v192, v68, v69
v_cmp_ne_u32 vcc, -1, v192
v_lshlrev_b32 v88, 16, v68
v_and_b32 v89, 0xffff0000, v68
v_lshlrev_b32 v90, 16, v69
v_and_b32 v91, 0xffff0000, v69
s_andn2_b64 s[70:71], exec, vcc
s_mov_b64 exec, vcc
v_fma_f32 v232, v82, v88, v232
v_fma_f32 v233, v82, v89, v233
v_fma_f32 v234, v82, v90, v234
v_fma_f32 v235, v82, v91, v235
L_W_sx2:
s_mov_b64 exec, s[72:73]
s_cbranch_execz L_W_sx3
v_max_u32 v192, v70, v71
v_cmp_ne_u32 vcc, -1, v192
v_lshlrev_b32 v88, 16, v70
v_and_b32 v89, 0xffff0000, v70
v_lshlrev_b32 v90, 16, v71
v_and_b32 v91, 0xffff0000, v71
s_andn2_b64 s[72:73], exec, vcc
s_mov_b64 exec, vcc
v_fma_f32 v232, v83, v88, v232
v_fma_f32 v233, v83, v89, v233
v_fma_f32 v234, v83, v90, v234
v_fma_f32 v235, v83, v91, v235
L_W_sx3:
s_mov_b64 exec, -1
s_or_b64 s[74:75], s[66:67], s[68:69]
s_or_b64 s[80:81], s[70:71], s[72:73]
s_or_b64 s[74:75], s[74:75], s[80:81]
s_cbranch_scc0 L_W_sweep_done
s_add_u32 s64, s64, 1
s_cmp_lt_u32 s64, 65536
s_cbranch_scc1 L_W_sweep
L_W_sweep_done:
s_nop 1
v_add_f32_dpp v232, v232, v232 row_ror:8 row_mask:0xf bank_mask:0xf
v_add_f32_dpp v233, v233, v233 row_ror:8 row_mask:0xf bank_mask:0xf
v_add_f32_dpp v234, v234, v234 row_ror:8 row_mask:0xf bank_mask:0xf
v_add_f32_dpp v235, v235, v235 row_ror:8 row_mask:0xf bank_mask:0xf
v_mov_b32 v204, v232
v_mov_b32 v205, v233
v_mov_b32 v206, v234
v_mov_b32 v207, v235
s_nop 1
v_permlane16_swap_b32 v232, v204
v_permlane16_swap_b32 v233, v205
v_permlane16_swap_b32 v234, v206
v_permlane16_swap_b32 v235, v207
s_nop 0
v_add_f32 v232, v232, v204
v_add_f32 v233, v233, v205
v_add_f32 v234, v234, v206
v_add_f32 v235, v235, v207
v_mov_b32 v204, v232
v_mov_b32 v205, v233
v_mov_b32 v206, v234
v_mov_b32 v207, v235
s_nop 1
v_permlane32_swap_b32 v232, v204
v_permlane32_swap_b32 v233, v205
v_permlane32_swap_b32 v234, v206
v_permlane32_swap_b32 v235, v207
s_nop 0
v_add_f32 v232, v232, v204
v_add_f32 v233, v233, v205
v_add_f32 v234, v234, v206
v_add_f32 v235, v235, v207
v_lshlrev_b32 v204, 4, v1
s_lshl_b32 s63, s34, 7
v_add_u32 v204, s63, v204
s_mov_b64 exec, 0xff
ds_write_b128 v204, v[232:235] offset:0
s_mov_b64 exec, -1
s_waitcnt lgkmcnt(0)
s_barrier
s_cmp_lg_u32 s34, 0
s_cbranch_scc1 L_Wa_fin
v_lshlrev_b32 v204, 2, v1
s_mov_b32 exec_hi, 0
ds_read_b32 v205, v204 offset:0
ds_read_b32 v206, v204 offset:128
ds_read_b32 v207, v204 offset:256
ds_read_b32 v208, v204 offset:384
ds_read_b32 v209, v204 offset:512
ds_read_b32 v210, v204 offset:640
ds_read_b32 v211, v204 offset:768
ds_read_b32 v212, v204 offset:896
s_waitcnt lgkmcnt(0)
v_add_f32 v205, v205, v206
v_add_f32 v205, v205, v207
v_add_f32 v205, v205, v208
v_add_f32 v205, v205, v209
v_add_f32 v205, v205, v210
v_add_f32 v205, v205, v211
v_add_f32 v205, v205, v212
v_cvt_pk_bf16_f32 v205, v205, v205
s_lshr_b32 s62, s32, 4
s_lshl_b32 s62, s62, 11
s_and_b32 s63, s32, 15
s_lshl_b32 s63, s63, 6
s_add_u32 s62, s62, s63
s_add_u32 s62, s62, 0
v_lshl_add_u32 v204, v1, 1, s62
global_store_short v204, v205, s[26:27]
s_mov_b64 exec, -1
L_Wa_fin:
s_or_b32 s62, s32, s34
s_cbranch_scc1 L_W_nonext
v_mov_b32 v192, 0x18000
v_mov_b32 v193, s88
s_mov_b64 exec, 1
buffer_store_dword v193, v192, s[52:55], 0 offen
s_mov_b64 exec, -1
L_W_nonext:
s_endpgm
L_roleC:
s_load_dword s88, s[30:31], 0x18000
v_mov_b32 v8, 0
s_lshr_b32 s35, s32, 4
s_lshr_b32 s36, s34, 1
s_and_b32 s37, s34, 1
s_lshl_b32 s60, s32, 19
s_mov_b32 s61, 0x80000
s_add_u32 s40, s16, s60
s_addc_u32 s41, s17, 0
s_and_b32 s41, s41, 0xffff
s_mov_b32 s42, s61
s_mov_b32 s43, 0x20000
s_mov_b32 s44, s30
s_and_b32 s45, s31, 0xffff
s_mov_b32 s46, 0x1000000
s_mov_b32 s47, 0x20000
v_lshlrev_b32 v9, 4, v1
s_lshl_b32 s62, s34, 13
v_add_u32 v9, s62, v9
s_mul_i32 s38, s34, 8448
s_mov_b32 s51, 4096
s_add_u32 s50, s38, 5120
s_waitcnt vmcnt(3)
s_add_u32 m0, s50, 0
s_nop 0
buffer_load_dwordx4 v9, s[40:43], 0 offen offset:0 nt lds
s_waitcnt vmcnt(3)
s_add_u32 m0, s50, 32
s_nop 0
buffer_load_dwordx4 v9, s[40:43], 0 offen offset:1024 nt lds
s_waitcnt vmcnt(3)
s_add_u32 m0, s50, 64
s_nop 0
buffer_load_dwordx4 v9, s[40:43], 0 offen offset:2048 nt lds
s_waitcnt vmcnt(3)
s_add_u32 m0, s50, 96
s_nop 0
buffer_load_dwordx4 v9, s[40:43], 0 offen offset:3072 nt lds
s_waitcnt vmcnt(3)
s_add_u32 m0, s50, 4224
s_nop 0
buffer_load_dwordx4 v9, s[40:43], s51 offen offset:0 nt lds
s_waitcnt vmcnt(3)
s_add_u32 m0, s50, 4256
s_nop 0
buffer_load_dwordx4 v9, s[40:43], s51 offen offset:1024 nt lds
s_waitcnt vmcnt(3)
s_add_u32 m0, s50, 4288
s_nop 0
buffer_load_dwordx4 v9, s[40:43], s51 offen offset:2048 nt lds
s_waitcnt vmcnt(3)
s_add_u32 m0, s50, 4320
s_nop 0
buffer_load_dwordx4 v9, s[40:43], s51 offen offset:3072 nt lds
v_add_u32 v9, 0x10000, v9
s_lshl_b32 s60, s32, 8
s_sub_u32 s61, 0x400000, s60
s_add_u32 s52, s10, s60
s_addc_u32 s53, s11, 0
s_and_b32 s53, s53, 0xffff
s_mov_b32 s54, s61
s_mov_b32 s55, 0x20000
s_mov_b32 s56, s4
s_and_b32 s57, s5, 0xffff
s_mov_b32 s58, 0x800
s_mov_b32 s59, 0x20000
v_lshrrev_b32 v192, 3, v2
v_lshlrev_b32 v192, 10, v192
v_lshl_add_u32 v192, v3, 5, v192
s_lshl_b32 s62, s34, 7
v_add_u32 v192, s62, v192
buffer_load_dwordx4 v[12:15], v192, s[56:59], 0 offen
buffer_load_dwordx4 v[16:19], v192, s[56:59], 0 offen offset:16
v_lshlrev_b32 v10, 17, v3
v_lshl_add_u32 v10, v2, 4, v10
s_lshl_b32 s62, s34, 19
v_add_u32 v10, s62, v10
s_mov_b32 s62, 0
buffer_load_dwordx4 v[64:67], v10, s[52:55], s62 offen nt
s_mov_b32 s62, 8192
buffer_load_dwordx4 v[68:71], v10, s[52:55], s62 offen nt
s_mov_b32 s62, 16384
buffer_load_dwordx4 v[72:75], v10, s[52:55], s62 offen nt
s_mov_b32 s62, 24576
buffer_load_dwordx4 v[76:79], v10, s[52:55], s62 offen nt
s_mov_b32 s62, 32768
buffer_load_dwordx4 v[80:83], v10, s[52:55], s62 offen nt
s_mov_b32 s62, 40960
buffer_load_dwordx4 v[84:87], v10, s[52:55], s62 offen nt
v_lshrrev_b32 v192, 1, v3
v_lshlrev_b32 v192, 9, v192
v_lshl_add_u32 v192, v2, 5, v192
v_and_b32 v193, 1, v3
v_lshl_add_u32 v192, v193, 4, v192
s_lshl_b32 s63, s34, 10
s_add_u32 s63, s63, 140288
v_add_u32 v192, s63, v192
v_lshlrev_b32 v193, 4, v1
s_lshl_b32 s63, s32, 10
s_add_u32 s63, s63, 0x40000
v_add_u32 v194, s63, v193
v_add_u32 v193, 140288, v193
s_mov_b32 s66, 0x01000100
s_mov_b32 s67, 0x03020302
s_waitcnt vmcnt(5)
s_mov_b32 s62, 49152
buffer_load_dwordx4 v[88:91], v10, s[52:55], s62 offen nt
v_perm_b32 v195, v12, v12, s66
v_and_b32 v28, v195, v4
v_and_b32 v29, v195, v5
v_and_b32 v30, v195, v6
v_and_b32 v31, v195, v7
s_nop 1
v_mfma_f32_16x16x32_bf16 v[44:47], v[28:31], v[64:67], 0
s_waitcnt vmcnt(5)
s_mov_b32 s62, 57344
buffer_load_dwordx4 v[92:95], v10, s[52:55], s62 offen nt
v_perm_b32 v195, v12, v12, s67
v_and_b32 v32, v195, v4
v_and_b32 v33, v195, v5
v_and_b32 v34, v195, v6
v_and_b32 v35, v195, v7
s_nop 1
v_mfma_f32_16x16x32_bf16 v[44:47], v[32:35], v[68:71], v[44:47]
s_waitcnt vmcnt(5)
s_mov_b32 s62, 65536
buffer_load_dwordx4 v[96:99], v10, s[52:55], s62 offen nt
v_perm_b32 v195, v13, v13, s66
v_and_b32 v28, v195, v4
v_and_b32 v29, v195, v5
v_and_b32 v30, v195, v6
v_and_b32 v31, v195, v7
s_nop 1
v_mfma_f32_16x16x32_bf16 v[44:47], v[28:31], v[72:75], v[44:47]
s_waitcnt vmcnt(5)
s_mov_b32 s62, 73728
buffer_load_dwordx4 v[100:103], v10, s[52:55], s62 offen nt
v_perm_b32 v195, v13, v13, s67
v_and_b32 v32, v195, v4
v_and_b32 v33, v195, v5
v_and_b32 v34, v195, v6
v_and_b32 v35, v195, v7
s_nop 1
v_mfma_f32_16x16x32_bf16 v[44:47], v[32:35], v[76:79], v[44:47]
s_waitcnt vmcnt(5)
s_mov_b32 s62, 81920
buffer_load_dwordx4 v[104:107], v10, s[52:55], s62 offen nt
v_perm_b32 v195, v14, v14, s66
v_and_b32 v28, v195, v4
v_and_b32 v29, v195, v5
v_and_b32 v30, v195, v6
v_and_b32 v31, v195, v7
s_nop 1
v_mfma_f32_16x16x32_bf16 v[44:47], v[28:31], v[80:83], v[44:47]
s_waitcnt vmcnt(5)
s_mov_b32 s62, 90112
buffer_load_dwordx4 v[108:111], v10, s[52:55], s62 offen nt
v_perm_b32 v195, v14, v14, s67
v_and_b32 v32, v195, v4
v_and_b32 v33, v195, v5
v_and_b32 v34, v195, v6
v_and_b32 v35, v195, v7
s_nop 1
v_mfma_f32_16x16x32_bf16 v[44:47], v[32:35], v[84:87], v[44:47]
s_waitcnt vmcnt(5)
s_mov_b32 s62, 98304
buffer_load_dwordx4 v[112:115], v10, s[52:55], s62 offen nt
v_perm_b32 v195, v15, v15, s66
v_and_b32 v28, v195, v4
v_and_b32 v29, v195, v5
v_and_b32 v30, v195, v6
v_and_b32 v31, v195, v7
s_nop 1
v_mfma_f32_16x16x32_bf16 v[44:47], v[28:31], v[88:91], v[44:47]
s_waitcnt vmcnt(5)
s_mov_b32 s62, 106496
buffer_load_dwordx4 v[116:119], v10, s[52:55], s62 offen nt
v_perm_b32 v195, v15, v15, s67
v_and_b32 v32, v195, v4
v_and_b32 v33, v195, v5
v_and_b32 v34, v195, v6
v_and_b32 v35, v195, v7
s_nop 1
v_mfma_f32_16x16x32_bf16 v[44:47], v[32:35], v[92:95], v[44:47]
s_waitcnt vmcnt(5)
s_mov_b32 s62, 114688
buffer_load_dwordx4 v[120:123], v10, s[52:55], s62 offen nt
v_perm_b32 v195, v16, v16, s66
v_and_b32 v28, v195, v4
v_and_b32 v29, v195, v5
v_and_b32 v30, v195, v6
v_and_b32 v31, v195, v7
s_nop 1
v_mfma_f32_16x16x32_bf16 v[44:47], v[28:31], v[96:99], v[44:47]
s_waitcnt vmcnt(5)
s_mov_b32 s62, 122880
buffer_load_dwordx4 v[124:127], v10, s[52:55], s62 offen nt
v_perm_b32 v195, v16, v16, s67
v_and_b32 v32, v195, v4
v_and_b32 v33, v195, v5
v_and_b32 v34, v195, v6
v_and_b32 v35, v195, v7
s_nop 1
v_mfma_f32_16x16x32_bf16 v[44:47], v[32:35], v[100:103], v[44:47]
s_waitcnt vmcnt(5)
v_perm_b32 v195, v17, v17, s66
v_and_b32 v28, v195, v4
v_and_b32 v29, v195, v5
v_and_b32 v30, v195, v6
v_and_b32 v31, v195, v7
s_nop 1
v_mfma_f32_16x16x32_bf16 v[44:47], v[28:31], v[104:107], v[44:47]
s_waitcnt vmcnt(4)
v_perm_b32 v195, v17, v17, s67
v_and_b32 v32, v195, v4
v_and_b32 v33, v195, v5
v_and_b32 v34, v195, v6
v_and_b32 v35, v195, v7
s_nop 1
v_mfma_f32_16x16x32_bf16 v[44:47], v[32:35], v[108:111], v[44:47]
s_waitcnt vmcnt(3)
v_perm_b32 v195, v18, v18, s66
v_and_b32 v28, v195, v4
v_and_b32 v29, v195, v5
v_and_b32 v30, v195, v6
v_and_b32 v31, v195, v7
s_nop 1
v_mfma_f32_16x16x32_bf16 v[44:47], v[28:31], v[112:115], v[44:47]
s_waitcnt vmcnt(2)
v_perm_b32 v195, v18, v18, s67
v_and_b32 v32, v195, v4
v_and_b32 v33, v195, v5
v_and_b32 v34, v195, v6
v_and_b32 v35, v195, v7
s_nop 1
v_mfma_f32_16x16x32_bf16 v[44:47], v[32:35], v[116:119], v[44:47]
s_waitcnt vmcnt(1)
v_perm_b32 v195, v19, v19, s66
v_and_b32 v28, v195, v4
v_and_b32 v29, v195, v5
v_and_b32 v30, v195, v6
v_and_b32 v31, v195, v7
s_nop 1
v_mfma_f32_16x16x32_bf16 v[44:47], v[28:31], v[120:123], v[44:47]
s_waitcnt vmcnt(0)
v_perm_b32 v195, v19, v19, s67
v_and_b32 v32, v195, v4
v_and_b32 v33, v195, v5
v_and_b32 v34, v195, v6
v_and_b32 v35, v195, v7
s_nop 1
v_mfma_f32_16x16x32_bf16 v[44:47], v[32:35], v[124:127], v[44:47]
s_nop 7
ds_write_b128 v192, v[44:47]
s_waitcnt lgkmcnt(0)
s_add_u32 s88, s88, 0x9e3779b9
s_barrier
s_cmp_lg_u32 s34, 0
s_cbranch_scc1 L_C_qdone
ds_read_b128 v[64:67], v193 offset:0
ds_read_b128 v[68:71], v193 offset:1024
ds_read_b128 v[72:75], v193 offset:2048
ds_read_b128 v[76:79], v193 offset:3072
ds_read_b128 v[80:83], v193 offset:4096
ds_read_b128 v[84:87], v193 offset:5120
ds_read_b128 v[88:91], v193 offset:6144
ds_read_b128 v[92:95], v193 offset:7168
s_waitcnt lgkmcnt(6)
v_add_f32 v64, v64, v68
v_add_f32 v65, v65, v69
v_add_f32 v66, v66, v70
v_add_f32 v67, v67, v71
s_waitcnt lgkmcnt(5)
v_add_f32 v64, v64, v72
v_add_f32 v65, v65, v73
v_add_f32 v66, v66, v74
v_add_f32 v67, v67, v75
s_waitcnt lgkmcnt(4)
v_add_f32 v64, v64, v76
v_add_f32 v65, v65, v77
v_add_f32 v66, v66, v78
v_add_f32 v67, v67, v79
s_waitcnt lgkmcnt(3)
v_add_f32 v64, v64, v80
v_add_f32 v65, v65, v81
v_add_f32 v66, v66, v82
v_add_f32 v67, v67, v83
s_waitcnt lgkmcnt(2)
v_add_f32 v64, v64, v84
v_add_f32 v65, v65, v85
v_add_f32 v66, v66, v86
v_add_f32 v67, v67, v87
s_waitcnt lgkmcnt(1)
v_add_f32 v64, v64, v88
v_add_f32 v65, v65, v89
v_add_f32 v66, v66, v90
v_add_f32 v67, v67, v91
s_waitcnt lgkmcnt(0)
v_add_f32 v64, v64, v92
v_add_f32 v65, v65, v93
v_add_f32 v66, v66, v94
v_add_f32 v67, v67, v95
v_cvt_pk_bf16_f32 v64, v64, v65
v_cvt_pk_bf16_f32 v66, v66, v67
v_mov_b32 v65, s88
v_mov_b32 v67, s88
buffer_store_dwordx4 v[64:67], v194, s[44:47], 0 offen sc1
L_C_qdone:
s_barrier
s_add_u32 s50, s38, 72704
s_waitcnt vmcnt(3)
s_add_u32 m0, s50, 0
s_nop 0
buffer_load_dwordx4 v9, s[40:43], 0 offen offset:0 nt lds
s_waitcnt vmcnt(3)
s_add_u32 m0, s50, 32
s_nop 0
buffer_load_dwordx4 v9, s[40:43], 0 offen offset:1024 nt lds
s_waitcnt vmcnt(3)
s_add_u32 m0, s50, 64
s_nop 0
buffer_load_dwordx4 v9, s[40:43], 0 offen offset:2048 nt lds
s_waitcnt vmcnt(3)
s_add_u32 m0, s50, 96
s_nop 0
buffer_load_dwordx4 v9, s[40:43], 0 offen offset:3072 nt lds
s_waitcnt vmcnt(3)
s_add_u32 m0, s50, 4224
s_nop 0
buffer_load_dwordx4 v9, s[40:43], s51 offen offset:0 nt lds
s_waitcnt vmcnt(3)
s_add_u32 m0, s50, 4256
s_nop 0
buffer_load_dwordx4 v9, s[40:43], s51 offen offset:1024 nt lds
s_waitcnt vmcnt(3)
s_add_u32 m0, s50, 4288
s_nop 0
buffer_load_dwordx4 v9, s[40:43], s51 offen offset:2048 nt lds
s_waitcnt vmcnt(3)
s_add_u32 m0, s50, 4320
s_nop 0
buffer_load_dwordx4 v9, s[40:43], s51 offen offset:3072 nt lds
v_add_u32 v9, 0x10000, v9
s_waitcnt vmcnt(3)
buffer_load_dwordx4 v[208:211], v9, s[40:43], 0 offen offset:0 nt
s_waitcnt vmcnt(3)
buffer_load_dwordx4 v[212:215], v9, s[40:43], 0 offen offset:1024 nt
s_waitcnt vmcnt(3)
buffer_load_dwordx4 v[216:219], v9, s[40:43], 0 offen offset:2048 nt
s_waitcnt vmcnt(3)
buffer_load_dwordx4 v[220:223], v9, s[40:43], 0 offen offset:3072 nt
s_waitcnt vmcnt(3)
buffer_load_dwordx4 v[224:227], v9, s[40:43], s51 offen offset:0 nt
s_waitcnt vmcnt(3)
buffer_load_dwordx4 v[228:231], v9, s[40:43], s51 offen offset:1024 nt
s_waitcnt vmcnt(3)
buffer_load_dwordx4 v[232:235], v9, s[40:43], s51 offen offset:2048 nt
s_waitcnt vmcnt(3)
buffer_load_dwordx4 v[236:239], v9, s[40:43], s51 offen offset:3072 nt
v_add_u32 v9, 0x10000, v9
s_add_u32 s62, s38, 5120
v_lshl_add_u32 v22, v1, 4, s62
s_lshl_b32 s62, s36, 4
v_add_u32 v240, s62, v2
v_mul_u32_u24 v10, 1056, v240
v_lshl_add_u32 v10, v3, 4, v10
v_add_u32 v10, 5120, v10
v_lshrrev_b32 v240, 1, v3
v_lshlrev_b32 v240, 3, v240
v_lshrrev_b32 v241, 2, v2
v_add_u32 v240, v240, v241
v_mul_u32_u24 v11, 1056, v240
v_and_b32 v240, 1, v3
v_lshl_add_u32 v11, v240, 5, v11
v_and_b32 v240, 3, v2
v_lshl_add_u32 v11, v240, 3, v11
s_lshl_b32 s62, s34, 7
s_add_u32 s62, s62, 5120
v_add_u32 v11, s62, v11
s_lshl_b32 s62, s37, 4
v_add_u32 v240, s62, v2
v_mul_u32_u24 v12, 144, v240
v_lshl_add_u32 v12, v3, 3, v12
s_lshl_b32 s62, s36, 5
v_add_u32 v12, s62, v12
v_lshlrev_b32 v15, 4, v240
s_lshl_b32 s62, s36, 2
v_add_u32 v14, s62, v15
v_and_b32 v240, 31, v1
v_mul_u32_u24 v13, 144, v240
v_lshrrev_b32 v241, 5, v1
v_lshl_add_u32 v13, v241, 4, v13
v_lshlrev_b32 v16, 4, v240
v_mov_b32 v17, 0x3e0293ee
v_mov_b32 v18, 0xff800000
v_mov_b32 v19, 0xff800000
v_mov_b32 v20, 0
v_mov_b32 v96, 0
v_mov_b32 v97, 0
v_mov_b32 v98, 0
v_mov_b32 v99, 0
v_mov_b32 v100, 0
v_mov_b32 v101, 0
v_mov_b32 v102, 0
v_mov_b32 v103, 0
v_mov_b32 v104, 0
v_mov_b32 v105, 0
v_mov_b32 v106, 0
v_mov_b32 v107, 0
v_mov_b32 v108, 0
v_mov_b32 v109, 0
v_mov_b32 v110, 0
v_mov_b32 v111, 0
v_mov_b32 v112, 0
v_mov_b32 v113, 0
v_mov_b32 v114, 0
v_mov_b32 v115, 0
v_mov_b32 v116, 0
v_mov_b32 v117, 0
v_mov_b32 v118, 0
v_mov_b32 v119, 0
v_mov_b32 v120, 0
v_mov_b32 v121, 0
v_mov_b32 v122, 0
v_mov_b32 v123, 0
v_mov_b32 v124, 0
v_mov_b32 v125, 0
v_mov_b32 v126, 0
v_mov_b32 v127, 0
s_cmp_lg_u32 s34, 0
s_cbranch_scc1 L_wc_Cq
s_mov_b32 s62, 0x1a000
v_lshl_add_u32 v240, v1, 8, s62
s_lshl_b64 exec, 1, s32
s_mov_b32 s64, 0
L_tp_Cq0:
buffer_load_dword v241, v240, s[44:47], 0 offen sc1
s_waitcnt vmcnt(0)
v_cmp_ne_u32 vcc, s88, v241
s_add_u32 s64, s64, 1
s_nop 0
s_or_b64 vcc, vcc, vcc
s_cbranch_scc0 L_tp_Cq0_ok
s_sleep 32
s_cmp_lt_u32 s64, 65536
s_cbranch_scc1 L_tp_Cq0
L_tp_Cq0_ok:
s_mov_b32 exec_lo, -1
s_mov_b32 exec_hi, 0
s_mov_b32 s64, 0
L_tp_Cq:
buffer_load_dword v241, v240, s[44:47], 0 offen sc1
s_waitcnt vmcnt(0)
v_cmp_ne_u32 vcc, s88, v241
s_add_u32 s64, s64, 1
s_nop 0
s_or_b64 vcc, vcc, vcc
s_cbranch_scc0 L_tp_Cq_ok
s_mov_b64 exec, vcc
s_sleep 8
s_cmp_lt_u32 s64, 65536
s_cbranch_scc1 L_tp_Cq
L_tp_Cq_ok:
s_mov_b64 exec, -1
L_wc_Cq:
s_barrier
s_lshl_b32 s62, s35, 5
s_lshl_b32 s63, s37, 4
s_add_u32 s62, s62, s63
v_add_u32 v240, s62, v2
v_lshlrev_b32 v240, 10, v240
v_lshl_add_u32 v240, v3, 4, v240
v_add_u32 v240, 0x0, v240
buffer_load_dwordx4 v[32:35], v240, s[44:47], 0 offen offset:0 sc1
buffer_load_dwordx4 v[36:39], v240, s[44:47], 0 offen offset:64 sc1
buffer_load_dwordx4 v[40:43], v240, s[44:47], 0 offen offset:128 sc1
buffer_load_dwordx4 v[44:47], v240, s[44:47], 0 offen offset:192 sc1
buffer_load_dwordx4 v[48:51], v240, s[44:47], 0 offen offset:256 sc1
buffer_load_dwordx4 v[52:55], v240, s[44:47], 0 offen offset:320 sc1
buffer_load_dwordx4 v[56:59], v240, s[44:47], 0 offen offset:384 sc1
buffer_load_dwordx4 v[60:63], v240, s[44:47], 0 offen offset:448 sc1
buffer_load_dwordx4 v[64:67], v240, s[44:47], 0 offen offset:512 sc1
buffer_load_dwordx4 v[68:71], v240, s[44:47], 0 offen offset:576 sc1
buffer_load_dwordx4 v[72:75], v240, s[44:47], 0 offen offset:640 sc1
buffer_load_dwordx4 v[76:79], v240, s[44:47], 0 offen offset:704 sc1
buffer_load_dwordx4 v[80:83], v240, s[44:47], 0 offen offset:768 sc1
buffer_load_dwordx4 v[84:87], v240, s[44:47], 0 offen offset:832 sc1
buffer_load_dwordx4 v[88:91], v240, s[44:47], 0 offen offset:896 sc1
buffer_load_dwordx4 v[92:95], v240, s[44:47], 0 offen offset:960 sc1
s_mov_b32 s39, 0
s_mov_b32 s48, 0
.p2align 6
L_C_loop:
s_cmp_lg_u32 s39, 0
s_cbranch_scc1 L_C_top
s_waitcnt vmcnt(0)
L_C_top:
s_waitcnt lgkmcnt(0)
s_barrier
s_mov_b32 s52, 1
s_cmp_eq_u32 s39, 0
s_cselect_b32 s52, 0, s52
s_cmp_ge_u32 s39, 7
s_cselect_b32 s52, 0, s52
s_sub_u32 s50, 67584, s48
v_add_u32 v23, s50, v22
s_cmp_eq_u32 s52, 0
s_cbranch_scc1 L_C_st0
s_waitcnt vmcnt(7)
ds_write_b128 v23, v[208:211] offset:0
buffer_load_dwordx4 v[208:211], v9, s[40:43], 0 offen offset:0 nt
s_waitcnt vmcnt(7)
ds_write_b128 v23, v[212:215] offset:1056
buffer_load_dwordx4 v[212:215], v9, s[40:43], 0 offen offset:1024 nt
s_waitcnt vmcnt(7)
ds_write_b128 v23, v[216:219] offset:2112
buffer_load_dwordx4 v[216:219], v9, s[40:43], 0 offen offset:2048 nt
s_waitcnt vmcnt(7)
ds_write_b128 v23, v[220:223] offset:3168
buffer_load_dwordx4 v[220:223], v9, s[40:43], 0 offen offset:3072 nt
s_waitcnt vmcnt(7)
ds_write_b128 v23, v[224:227] offset:4224
buffer_load_dwordx4 v[224:227], v9, s[40:43], s51 offen offset:0 nt
s_waitcnt vmcnt(7)
ds_write_b128 v23, v[228:231] offset:5280
buffer_load_dwordx4 v[228:231], v9, s[40:43], s51 offen offset:1024 nt
s_waitcnt vmcnt(7)
ds_write_b128 v23, v[232:235] offset:6336
buffer_load_dwordx4 v[232:235], v9, s[40:43], s51 offen offset:2048 nt
s_waitcnt vmcnt(7)
ds_write_b128 v23, v[236:239] offset:7392
buffer_load_dwordx4 v[236:239], v9, s[40:43], s51 offen offset:3072 nt
v_add_u32 v9, 0x10000, v9
L_C_st0:
v_add_u32 v240, s48, v10
v_add_u32 v241, s48, v11
ds_read_b128 v[128:131], v240 offset:0
ds_read_b128 v[132:135], v240 offset:64
ds_read_b128 v[136:139], v240 offset:128
ds_read_b128 v[140:143], v240 offset:192
ds_read_b128 v[144:147], v240 offset:256
ds_read_b128 v[148:151], v240 offset:320
ds_read_b128 v[152:155], v240 offset:384
ds_read_b128 v[156:159], v240 offset:448
ds_read_b128 v[160:163], v240 offset:512
ds_read_b128 v[164:167], v240 offset:576
ds_read_b128 v[168:171], v240 offset:640
ds_read_b128 v[172:175], v240 offset:704
ds_read_b128 v[176:179], v240 offset:768
ds_read_b128 v[180:183], v240 offset:832
ds_read_b128 v[184:187], v240 offset:896
ds_read_b128 v[188:191], v240 offset:960
s_waitcnt lgkmcnt(15)
v_mfma_f32_16x16x32_bf16 v[28:31], v[128:131], v[32:35], 0
s_waitcnt lgkmcnt(14)
v_mfma_f32_16x16x32_bf16 v[28:31], v[132:135], v[36:39], v[28:31]
s_waitcnt lgkmcnt(13)
v_mfma_f32_16x16x32_bf16 v[28:31], v[136:139], v[40:43], v[28:31]
s_waitcnt lgkmcnt(12)
v_mfma_f32_16x16x32_bf16 v[28:31], v[140:143], v[44:47], v[28:31]
s_waitcnt lgkmcnt(11)
v_mfma_f32_16x16x32_bf16 v[28:31], v[144:147], v[48:51], v[28:31]
s_waitcnt lgkmcnt(10)
v_mfma_f32_16x16x32_bf16 v[28:31], v[148:151], v[52:55], v[28:31]
s_waitcnt lgkmcnt(9)
v_mfma_f32_16x16x32_bf16 v[28:31], v[152:155], v[56:59], v[28:31]
s_waitcnt lgkmcnt(8)
v_mfma_f32_16x16x32_bf16 v[28:31], v[156:159], v[60:63], v[28:31]
s_waitcnt lgkmcnt(7)
v_mfma_f32_16x16x32_bf16 v[28:31], v[160:163], v[64:67], v[28:31]
s_waitcnt lgkmcnt(6)
v_mfma_f32_16x16x32_bf16 v[28:31], v[164:167], v[68:71], v[28:31]
s_waitcnt lgkmcnt(5)
v_mfma_f32_16x16x32_bf16 v[28:31], v[168:171], v[72:75], v[28:31]
s_waitcnt lgkmcnt(4)
v_mfma_f32_16x16x32_bf16 v[28:31], v[172:175], v[76:79], v[28:31]
s_waitcnt lgkmcnt(3)
v_mfma_f32_16x16x32_bf16 v[28:31], v[176:179], v[80:83], v[28:31]
s_waitcnt lgkmcnt(2)
v_mfma_f32_16x16x32_bf16 v[28:31], v[180:183], v[84:87], v[28:31]
s_waitcnt lgkmcnt(1)
v_mfma_f32_16x16x32_bf16 v[28:31], v[184:187], v[88:91], v[28:31]
s_waitcnt lgkmcnt(0)
v_mfma_f32_16x16x32_bf16 v[28:31], v[188:191], v[92:95], v[28:31]
s_nop 7
v_mul_f32 v24, v28, v17
v_mul_f32 v25, v29, v17
v_mul_f32 v26, v30, v17
v_mul_f32 v27, v31, v17
v_max3_f32 v242, v24, v25, v26
v_max_f32 v242, v242, v27
v_mov_b32 v243, v242
s_nop 1
v_permlane16_swap_b32 v242, v243
s_nop 0
v_max_f32 v242, v242, v243
v_mov_b32 v243, v242
s_nop 1
v_permlane32_swap_b32 v242, v243
s_nop 0
v_max_f32 v242, v242, v243
s_mov_b64 exec, 0xffff
ds_write_b32 v14, v242 offset:0
s_mov_b64 exec, -1
s_waitcnt lgkmcnt(0)
s_barrier
ds_read_b128 v[192:195], v15 offset:0
ds_read_b128 v[196:199], v16 offset:0
s_waitcnt lgkmcnt(1)
v_max3_f32 v242, v192, v193, v194
v_max3_f32 v242, v242, v195, v18
v_sub_f32 v21, v18, v242
v_sub_f32 v24, v24, v242
v_sub_f32 v25, v25, v242
v_sub_f32 v26, v26, v242
v_sub_f32 v27, v27, v242
v_exp_f32 v21, v21
v_exp_f32 v24, v24
v_exp_f32 v25, v25
v_exp_f32 v26, v26
v_exp_f32 v27, v27
v_mov_b32 v18, v242
v_cvt_pk_bf16_f32 v244, v24, v25
v_cvt_pk_bf16_f32 v245, v26, v27
ds_write_b64 v12, v[244:245] offset:512
v_add_f32 v24, v24, v25
v_add_f32 v26, v26, v27
v_fma_f32 v20, v20, v21, v24
v_add_f32 v20, v20, v26
s_waitcnt lgkmcnt(1)
v_max3_f32 v242, v196, v197, v198
v_max3_f32 v242, v242, v199, v19
v_sub_f32 v21, v19, v242
v_exp_f32 v21, v21
v_mov_b32 v19, v242
v_mul_f32 v96, v96, v21
v_mul_f32 v97, v97, v21
v_mul_f32 v98, v98, v21
v_mul_f32 v99, v99, v21
v_mul_f32 v100, v100, v21
v_mul_f32 v101, v101, v21
v_mul_f32 v102, v102, v21
v_mul_f32 v103, v103, v21
v_mul_f32 v104, v104, v21
v_mul_f32 v105, v105, v21
v_mul_f32 v106, v106, v21
v_mul_f32 v107, v107, v21
v_mul_f32 v108, v108, v21
v_mul_f32 v109, v109, v21
v_mul_f32 v110, v110, v21
v_mul_f32 v111, v111, v21
v_mul_f32 v112, v112, v21
v_mul_f32 v113, v113, v21
v_mul_f32 v114, v114, v21
v_mul_f32 v115, v115, v21
v_mul_f32 v116, v116, v21
v_mul_f32 v117, v117, v21
v_mul_f32 v118, v118, v21
v_mul_f32 v119, v119, v21
v_mul_f32 v120, v120, v21
v_mul_f32 v121, v121, v21
v_mul_f32 v122, v122, v21
v_mul_f32 v123, v123, v21
v_mul_f32 v124, v124, v21
v_mul_f32 v125, v125, v21
v_mul_f32 v126, v126, v21
v_mul_f32 v127, v127, v21
s_waitcnt lgkmcnt(0)
s_barrier
ds_read_b128 v[192:195], v13 offset:512
ds_read_b128 v[196:199], v13 offset:544
ds_read_b128 v[200:203], v13 offset:576
ds_read_b128 v[204:207], v13 offset:608
ds_read_b64_tr_b16 v[128:129], v241 offset:0
ds_read_b64_tr_b16 v[130:131], v241 offset:4224
ds_read_b64_tr_b16 v[132:133], v241 offset:64
ds_read_b64_tr_b16 v[134:135], v241 offset:4288
ds_read_b64_tr_b16 v[136:137], v241 offset:16896
ds_read_b64_tr_b16 v[138:139], v241 offset:21120
ds_read_b64_tr_b16 v[140:141], v241 offset:16960
ds_read_b64_tr_b16 v[142:143], v241 offset:21184
ds_read_b64_tr_b16 v[144:145], v241 offset:33792
ds_read_b64_tr_b16 v[146:147], v241 offset:38016
ds_read_b64_tr_b16 v[148:149], v241 offset:33856
ds_read_b64_tr_b16 v[150:151], v241 offset:38080
ds_read_b64_tr_b16 v[152:153], v241 offset:50688
ds_read_b64_tr_b16 v[154:155], v241 offset:54912
ds_read_b64_tr_b16 v[156:157], v241 offset:50752
ds_read_b64_tr_b16 v[158:159], v241 offset:54976
s_waitcnt lgkmcnt(12)
v_mfma_f32_32x32x16_bf16 v[96:111], v[128:131], v[192:195], v[96:111]
v_mfma_f32_32x32x16_bf16 v[112:127], v[132:135], v[192:195], v[112:127]
s_waitcnt lgkmcnt(8)
v_mfma_f32_32x32x16_bf16 v[96:111], v[136:139], v[196:199], v[96:111]
v_mfma_f32_32x32x16_bf16 v[112:127], v[140:143], v[196:199], v[112:127]
s_waitcnt lgkmcnt(4)
v_mfma_f32_32x32x16_bf16 v[96:111], v[144:147], v[200:203], v[96:111]
v_mfma_f32_32x32x16_bf16 v[112:127], v[148:151], v[200:203], v[112:127]
s_waitcnt lgkmcnt(0)
v_mfma_f32_32x32x16_bf16 v[96:111], v[152:155], v[204:207], v[96:111]
v_mfma_f32_32x32x16_bf16 v[112:127], v[156:159], v[204:207], v[112:127]
s_sub_u32 s48, 67584, s48
s_add_u32 s39, s39, 1
s_cmp_lt_u32 s39, 8
s_cbranch_scc1 L_C_loop
v_mov_b32 v243, v20
s_nop 1
v_permlane16_swap_b32 v20, v243
s_nop 0
v_add_f32 v20, v20, v243
v_mov_b32 v243, v20
s_nop 1
v_permlane32_swap_b32 v20, v243
s_nop 0
v_add_f32 v20, v20, v243
s_barrier
s_mov_b64 exec, 0xffff
ds_write_b32 v14, v20 offset:0
s_mov_b64 exec, -1
v_and_b32 v240, 31, v1
v_mul_u32_u24 v240, 2064, v240
v_lshrrev_b32 v241, 5, v1
v_lshl_add_u32 v240, v241, 4, v240
s_lshl_b32 s62, s34, 8
s_add_u32 s62, s62, 5120
v_add_u32 v240, s62, v240
s_nop 5
ds_write_b128 v240, v[96:99] offset:0
ds_write_b128 v240, v[100:103] offset:32
ds_write_b128 v240, v[104:107] offset:64
ds_write_b128 v240, v[108:111] offset:96
ds_write_b128 v240, v[112:115] offset:128
ds_write_b128 v240, v[116:119] offset:160
ds_write_b128 v240, v[120:123] offset:192
ds_write_b128 v240, v[124:127] offset:224
s_waitcnt lgkmcnt(0)
s_barrier
s_mul_i32 s62, s34, 8256
s_add_u32 s62, s62, 5120
v_lshl_add_u32 v240, v1, 5, s62
ds_read_b128 v[128:131], v240 offset:0
ds_read_b128 v[132:135], v240 offset:16
ds_read_b128 v[136:139], v240 offset:2064
ds_read_b128 v[140:143], v240 offset:2080
ds_read_b128 v[144:147], v240 offset:4128
ds_read_b128 v[148:151], v240 offset:4144
ds_read_b128 v[152:155], v240 offset:6192
ds_read_b128 v[156:159], v240 offset:6208
s_lshl_b32 s62, s35, 5
s_lshl_b32 s63, s34, 2
s_add_u32 s62, s62, s63
s_lshl_b32 s62, s62, 4
s_and_b32 s63, s32, 15
s_add_u32 s62, s62, s63
s_lshl_b32 s62, s62, 10
s_add_u32 s62, s62, 0x200000
v_lshl_add_u32 v241, v1, 4, s62
s_waitcnt lgkmcnt(6)
v_cvt_pk_bf16_f32 v160, v128, v129
v_cvt_pk_bf16_f32 v161, v130, v131
v_cvt_pk_bf16_f32 v162, v132, v133
v_cvt_pk_bf16_f32 v163, v134, v135
s_mov_b32 s63, 0
buffer_store_dwordx4 v[160:163], v241, s[44:47], s63 offen sc1
s_waitcnt lgkmcnt(4)
v_cvt_pk_bf16_f32 v164, v136, v137
v_cvt_pk_bf16_f32 v165, v138, v139
v_cvt_pk_bf16_f32 v166, v140, v141
v_cvt_pk_bf16_f32 v167, v142, v143
s_mov_b32 s63, 16384
buffer_store_dwordx4 v[164:167], v241, s[44:47], s63 offen sc1
s_waitcnt lgkmcnt(2)
v_cvt_pk_bf16_f32 v168, v144, v145
v_cvt_pk_bf16_f32 v169, v146, v147
v_cvt_pk_bf16_f32 v170, v148, v149
v_cvt_pk_bf16_f32 v171, v150, v151
s_mov_b32 s63, 32768
buffer_store_dwordx4 v[168:171], v241, s[44:47], s63 offen sc1
s_waitcnt lgkmcnt(0)
v_cvt_pk_bf16_f32 v172, v152, v153
v_cvt_pk_bf16_f32 v173, v154, v155
v_cvt_pk_bf16_f32 v174, v156, v157
v_cvt_pk_bf16_f32 v175, v158, v159
s_mov_b32 s63, 49152
buffer_store_dwordx4 v[172:175], v241, s[44:47], s63 offen sc1
ds_read_b128 v[192:195], v16 offset:0
v_and_b32 v240, 31, v1
s_lshl_b32 s63, s32, 9
s_add_u32 s63, s63, 0x10000
v_lshl_add_u32 v240, v240, 4, s63
s_waitcnt lgkmcnt(0)
v_add_f32 v192, v192, v193
v_add_f32 v194, v194, v195
v_add_f32 v194, v192, v194
v_mov_b32 v192, v19
v_mov_b32 v193, s88
v_mov_b32 v195, s88
s_waitcnt vmcnt(0)
s_barrier
s_cmp_lg_u32 s34, 1
s_cbranch_scc1 L_C_noas
s_and_b32 s63, s32, 7
s_lshl_b32 s63, s63, 8
s_add_u32 s63, s63, 0xc0000
s_add_u32 s56, s30, s63
s_addc_u32 s57, s31, 0
s_lshl_b32 s62, s32, 21
s_sub_u32 s63, 0x8000000, s62
s_add_u32 s68, s6, s62
s_addc_u32 s69, s7, 0
s_and_b32 s69, s69, 0xffff
s_mov_b32 s70, s63
s_mov_b32 s71, 0x20000
s_add_u32 s72, s8, s62
s_addc_u32 s73, s9, 0
s_and_b32 s73, s73, 0xffff
s_mov_b32 s74, s63
s_mov_b32 s75, 0x20000
s_mov_b64 s[76:77], s[68:69]
s_mov_b64 s[78:79], s[70:71]
s_lshr_b32 s62, s32, 3
s_mul_i32 s62, s62, 6
s_sub_u32 s62, s62, 32
v_add_u32 v136, s62, v1
v_cmp_gt_u32 vcc, 32, v1
v_lshlrev_b32 v133, 7, v1
v_add_u32 v134, 0x4000000, v133
v_cndmask_b32 v128, v136, v1, vcc
v_lshlrev_b32 v128, 2, v128
v_mov_b32 v132, 0
s_mov_b32 s64, 0
L_as_C:
s_mov_b64 exec, 0x1ffffff
s_mov_b32 exec_hi, 0x3f
global_load_dword v129, v128, s[56:57] nt
s_waitcnt vmcnt(0)
v_subrev_u32 v129, s88, v129
s_mov_b64 exec, 0xffffff
v_cmp_le_u32 vcc, 0x400, v129
v_readlane_b32 s62, v129, 24
v_add_u32_dpp v129, v129, v129 row_shr:1 row_mask:0xf bank_mask:0xf bound_ctrl:0
s_nop 1
v_add_u32_dpp v129, v129, v129 row_shr:2 row_mask:0xf bank_mask:0xf bound_ctrl:0
s_nop 1
v_add_u32_dpp v129, v129, v129 row_shr:4 row_mask:0xf bank_mask:0xf bound_ctrl:0
s_nop 1
v_add_u32_dpp v129, v129, v129 row_shr:8 row_mask:0xf bank_mask:0xf bound_ctrl:0
s_nop 0
v_readlane_b32 s61, v129, 15
v_readlane_b32 s63, v129, 23
s_add_u32 s61, s61, s63
s_cbranch_vccnz L_as_C_x
s_cmp_ge_u32 s61, 15168
s_cbranch_scc1 L_as_C_x
s_sub_u32 s61, s61, 120
s_mov_b32 exec_lo, 0
s_mov_b32 exec_hi, 0x3f
v_cmp_gt_u32 vcc, 280, v129
v_add_u32 v130, 56, v129
s_nop 0
v_cndmask_b32 v136, 0, 8, vcc
v_add_u32 v130, v130, v136
v_lshrrev_b32 v130, 4, v130
v_sub_u32 v136, v130, v132
v_cmp_gt_i32 vcc, 4, v136
v_cmp_le_i32 s[66:67], 2, v136
s_nop 0
v_cndmask_b32 v131, 0, 7, vcc
v_cmp_ge_u32 vcc, 41, v130
v_add_u32 v131, v131, v129
v_lshl_add_u32 v131, v131, 6, v1
s_and_b64 vcc, vcc, s[66:67]
v_cndmask_b32 v131, -1, v131, vcc
s_nop 1
v_min_u32_dpp v131, v131, v131 row_shr:1 row_mask:0xf bank_mask:0xf
s_nop 1
v_min_u32_dpp v131, v131, v131 row_shr:2 row_mask:0xf bank_mask:0xf
s_nop 1
v_min_u32_dpp v131, v131, v131 row_shr:4 row_mask:0xf bank_mask:0xf
s_nop 0
v_readlane_b32 s63, v131, 37
s_lshr_b32 s65, s63, 6
s_and_b32 s63, s63, 63
s_mul_i32 s65, s65, 24
s_cmp_ge_i32 s65, s61
s_cbranch_scc1 L_as_C_idle
v_readlane_b32 s65, v130, s63
s_mov_b32 m0, s63
s_mov_b64 exec, -1
s_cmp_lt_u32 s65, 21
s_cselect_b64 s[76:77], s[68:69], s[72:73]
v_writelane_b32 v132, s65, m0
s_cselect_b32 s66, 0, 21
s_sub_u32 s65, s65, s66
s_mul_i32 s65, s65, 0x18000
s_and_b32 s63, s63, 7
s_lshl_b32 s63, s63, 14
s_add_u32 s65, s65, s63
s_add_u32 s66, s65, 0x2000
buffer_load_dword v135, v133, s[76:79], s65 offen
buffer_load_dword v135, v133, s[76:79], s66 offen
buffer_load_dword v135, v134, s[76:79], s65 offen
buffer_load_dword v135, v134, s[76:79], s66 offen
s_waitcnt vmcnt(1)
s_branch L_as_C_next
L_as_C_idle:
s_sleep 4
L_as_C_next:
s_add_u32 s64, s64, 1
s_cmp_lt_u32 s64, 96
s_cbranch_scc1 L_as_C
L_as_C_x:
s_mov_b64 exec, -1
s_waitcnt vmcnt(0)
L_C_noas:
s_cmp_lg_u32 s34, 0
s_cbranch_scc1 L_C_done
s_mov_b32 exec_hi, 0
buffer_store_dwordx4 v[192:195], v240, s[44:47], 0 offen sc1
s_mov_b64 exec, -1
s_cmp_ge_u32 s32, 8
s_cbranch_scc1 L_C_done
s_and_b32 s63, s32, 7
s_lshl_b32 s63, s63, 8
s_add_u32 s63, s63, 0xc0000
s_add_u32 s56, s30, s63
s_addc_u32 s57, s31, 0
s_mov_b32 s64, 0
s_mov_b32 s59, 0
s_lshl_b32 s62, s32, 8
s_add_u32 s62, s62, 0xc1000
v_lshl_add_u32 v132, v1, 4, s62
s_mov_b32 s62, 0xc1000
v_lshl_add_u32 v133, v1, 8, s62
v_lshlrev_b32 v134, 2, v1
v_mov_b32 v135, 96
L_gm_C:
s_mov_b64 exec, 0xff
global_load_dword v137, v133, s[30:31] sc1
s_mov_b64 exec, 0x1ffffff
global_load_dword v136, v134, s[56:57] nt
s_waitcnt vmcnt(0)
v_subrev_u32 v136, s88, v136
s_mov_b64 exec, 0xffffff
v_cmp_le_u32 vcc, 0x400, v136
v_readlane_b32 s62, v136, 24
v_add_u32_dpp v136, v136, v136 row_shr:1 row_mask:0xf bank_mask:0xf bound_ctrl:0
s_nop 1
v_add_u32_dpp v136, v136, v136 row_shr:2 row_mask:0xf bank_mask:0xf bound_ctrl:0
s_nop 1
v_add_u32_dpp v136, v136, v136 row_shr:4 row_mask:0xf bank_mask:0xf bound_ctrl:0
s_nop 1
v_add_u32_dpp v136, v136, v136 row_shr:8 row_mask:0xf bank_mask:0xf bound_ctrl:0
s_nop 0
v_readlane_b32 s61, v136, 15
v_readlane_b32 s63, v136, 23
s_add_u32 s61, s61, s63
s_mov_b64 exec, 0xff
s_cbranch_vccnz L_gm_C_x
s_add_u32 s63, s61, s88
v_mov_b32 v128, s63
v_mov_b32 v129, s63
v_mov_b32 v130, s63
v_mov_b32 v131, s63
global_store_dwordx4 v132, v[128:131], s[30:31] sc1
s_mul_i32 s63, s61, 0
s_mul_i32 s65, s59, 8
s_add_u32 s65, s65, s63
s_cmp_eq_u32 s59, 0
s_mov_b32 s59, s61
s_cbranch_scc1 L_gm_C_next
v_subrev_u32 v137, s88, v137
v_cmp_le_u32 vcc, 0x8000, v137
s_nop 0
v_add_u32_dpp v137, v137, v137 row_shr:1 row_mask:0xf bank_mask:0xf bound_ctrl:0
s_nop 1
v_add_u32_dpp v137, v137, v137 row_shr:2 row_mask:0xf bank_mask:0xf bound_ctrl:0
s_nop 1
v_add_u32_dpp v137, v137, v137 row_shr:4 row_mask:0xf bank_mask:0xf bound_ctrl:0
s_cbranch_vccnz L_gm_C_next
s_nop 0
v_readlane_b32 s63, v137, 7
s_sub_u32 s63, s63, s65
s_ashr_i32 s63, s63, 3
s_add_u32 s63, s63, 0x4000
s_add_u32 s63, s63, s88
v_mov_b32 v138, s63
global_store_dword v135, v138, s[56:57]
L_gm_C_next:
s_cmp_ge_u32 s61, 14400
s_cbranch_scc1 L_gm_C_x
s_add_u32 s64, s64, 1
s_cmp_lt_u32 s64, 128
s_cbranch_scc1 L_gm_C
L_gm_C_x:
s_mov_b64 exec, -1
L_C_done:
s_endpgm
L_exit:
s_endpgm
.section .rodata,"a"
.p2align 6
.amdhsa_kernel concat_heads__gqa_block_cached__compressed_kv_cla__decode_kernel
  .amdhsa_next_free_vgpr 256
  .amdhsa_next_free_sgpr 102
  .amdhsa_accum_offset 256
  .amdhsa_group_segment_fixed_size 0
  .amdhsa_kernarg_size 112
  .amdhsa_user_sgpr_count 2
  .amdhsa_user_sgpr_kernarg_segment_ptr 1
  .amdhsa_system_sgpr_workgroup_id_x 1
.end_amdhsa_kernel
```

```asm
; @launch grid=(256,1,1) block=(512,1,1) lds=153600
.amdgcn_target "amdgcn-amd-amdhsa--gfx950"
.text
.globl concat_heads__gqa_block_cached__compressed_kv_cla__decode_kernel
.p2align 8
.type concat_heads__gqa_block_cached__compressed_kv_cla__decode_kernel,@function
concat_heads__gqa_block_cached__compressed_kv_cla__decode_kernel:
s_cmp_ge_u32 s2, 256
s_cbranch_scc1 L_exit
s_load_dwordx16 s[4:19], s[0:1], 0
s_load_dwordx8 s[20:27], s[0:1], 64
s_load_dwordx4 s[28:31], s[0:1], 96
v_lshrrev_b32 v8, 6, v0
s_add_u32 s60, s2, 0
s_and_b32 s60, s60, 7
s_lshr_b32 s61, s2, 3
v_readfirstlane_b32 s34, v8
s_and_b32 s33, s61, 7
s_lshr_b32 s61, s61, 3
s_lshl_b32 s61, s61, 3
s_add_u32 s32, s60, s61
v_and_b32 v1, 63, v0
v_and_b32 v2, 15, v0
v_bfe_u32 v3, v0, 4, 2
v_and_b32 v8, 1, v0
v_lshlrev_b32 v8, 4, v8
v_mov_b32 v9, 0xffff
v_lshlrev_b32 v8, v8, v9
v_bfe_u32 v9, v0, 1, 2
v_cmp_eq_u32 vcc, 0, v9
s_nop 1
v_cndmask_b32 v4, 0, v8, vcc
v_cmp_eq_u32 vcc, 1, v9
s_nop 1
v_cndmask_b32 v5, 0, v8, vcc
v_cmp_eq_u32 vcc, 2, v9
s_nop 1
v_cndmask_b32 v6, 0, v8, vcc
v_cmp_eq_u32 vcc, 3, v9
s_nop 1
v_cndmask_b32 v7, 0, v8, vcc
s_waitcnt lgkmcnt(0)
s_cmp_eq_u32 s33, 6
s_cbranch_scc1 L_roleW
s_cmp_eq_u32 s33, 7
s_cbranch_scc1 L_roleC
L_roleA:
s_cmp_ge_u32 s34, 4
s_cbranch_scc1 L_A_helper
s_lshl_b32 s62, s32, 21
s_sub_u32 s63, 0x8000000, s62
s_add_u32 s40, s6, s62
s_addc_u32 s41, s7, 0
s_and_b32 s41, s41, 0xffff
s_mov_b32 s42, s63
s_mov_b32 s43, 0x20000
s_lshl_b32 s35, s33, 2
s_add_u32 s35, s35, s34
s_lshl_b32 s35, s35, 12
s_mov_b32 s36, s35
v_lshlrev_b32 v8, 4, v1
v_add_u32 v9, 0x4000000, v8
s_lshr_b32 s54, s35, 12
s_mov_b32 s57, 0xff
s_sub_u32 s55, s54, 8
s_cselect_b32 s60, 24, 0
s_add_u32 s55, s55, s60
s_sub_u32 s56, s55, 8
s_cselect_b32 s60, 24, 0
s_add_u32 s56, s56, s60
v_lshlrev_b32 v61, 4, v2
v_lshl_add_u32 v61, v3, 13, v61
s_lshl_b32 s60, s32, 8
s_sub_u32 s61, 0x400000, s60
s_add_u32 s68, s18, s60
s_addc_u32 s69, s19, 0
s_and_b32 s69, s69, 0xffff
s_mov_b32 s70, s61
s_mov_b32 s71, 0x20000
s_lshr_b32 s58, s54, 2
s_min_u32 s60, s58, 2
s_mul_i32 s59, s58, 5
s_add_u32 s59, s59, s60
s_lshl_b32 s59, s59, 2
s_add_u32 s59, s59, s34
s_lshr_b32 s60, s59, 1
s_xor_b32 s60, s60, s59
s_and_b32 s60, s60, 16
s_mul_i32 s60, s60, 3
s_xor_b32 s60, s60, s59
s_lshl_b32 s39, s60, 15
buffer_load_dwordx4 v[128:131], v61, s[68:71], s39 offen
s_add_u32 s59, s59, 4
s_lshr_b32 s60, s59, 1
s_xor_b32 s60, s60, s59
s_and_b32 s60, s60, 16
s_mul_i32 s60, s60, 3
s_xor_b32 s60, s60, s59
s_lshl_b32 s39, s60, 15
buffer_load_dwordx4 v[132:135], v61, s[68:71], s39 offen
s_add_u32 s59, s59, 4
s_lshr_b32 s60, s59, 1
s_xor_b32 s60, s60, s59
s_and_b32 s60, s60, 16
s_mul_i32 s60, s60, 3
s_xor_b32 s60, s60, s59
s_lshl_b32 s39, s60, 15
buffer_load_dwordx4 v[136:139], v61, s[68:71], s39 offen
s_add_u32 s59, s59, 4
s_lshr_b32 s60, s59, 1
s_xor_b32 s60, s60, s59
s_and_b32 s60, s60, 16
s_mul_i32 s60, s60, 3
s_xor_b32 s60, s60, s59
s_lshl_b32 s39, s60, 15
buffer_load_dwordx4 v[140:143], v61, s[68:71], s39 offen
s_add_u32 s59, s59, 4
s_lshr_b32 s60, s59, 1
s_xor_b32 s60, s60, s59
s_and_b32 s60, s60, 16
s_mul_i32 s60, s60, 3
s_xor_b32 s60, s60, s59
s_lshl_b32 s39, s60, 15
buffer_load_dwordx4 v[144:147], v61, s[68:71], s39 offen
s_add_u32 s59, s59, 4
s_cmp_lt_u32 s58, 2
s_cselect_b32 s59, s59, 128
s_lshr_b32 s60, s59, 1
s_xor_b32 s60, s60, s59
s_and_b32 s60, s60, 16
s_mul_i32 s60, s60, 3
s_xor_b32 s60, s60, s59
s_lshl_b32 s39, s60, 15
buffer_load_dwordx4 v[148:151], v61, s[68:71], s39 offen
s_lshl_b32 s60, s32, 8
s_sub_u32 s61, 0x400000, s60
s_add_u32 s72, s20, s60
s_addc_u32 s73, s21, 0
s_and_b32 s73, s73, 0xffff
s_mov_b32 s74, s61
s_mov_b32 s75, 0x20000
s_lshr_b32 s58, s55, 2
s_min_u32 s60, s58, 2
s_mul_i32 s59, s58, 5
s_add_u32 s59, s59, s60
s_lshl_b32 s59, s59, 2
s_add_u32 s59, s59, s34
s_lshr_b32 s60, s59, 1
s_xor_b32 s60, s60, s59
s_and_b32 s60, s60, 16
s_mul_i32 s60, s60, 3
s_xor_b32 s60, s60, s59
s_lshl_b32 s39, s60, 15
buffer_load_dwordx4 v[152:155], v61, s[72:75], s39 offen
s_add_u32 s59, s59, 4
s_lshr_b32 s60, s59, 1
s_xor_b32 s60, s60, s59
s_and_b32 s60, s60, 16
s_mul_i32 s60, s60, 3
s_xor_b32 s60, s60, s59
s_lshl_b32 s39, s60, 15
buffer_load_dwordx4 v[156:159], v61, s[72:75], s39 offen
s_lshl_b32 s62, s32, 21
s_sub_u32 s63, 0x8000000, s62
s_add_u32 s44, s8, s62
s_addc_u32 s45, s9, 0
s_and_b32 s45, s45, 0xffff
s_mov_b32 s46, s63
s_mov_b32 s47, 0x20000
s_mul_i32 s60, s34, 6
s_add_u32 s60, s60, s33
s_lshl_b32 s37, s60, 10
s_add_u32 s37, s37, 0x1f8000
s_mov_b32 s52, 0x555f
s_cmp_lt_u32 s60, 8
s_cselect_b32 s61, 0, 1
s_cselect_b32 s62, 0x200, 0
s_or_b32 s52, s52, s62
s_lshl_b32 s61, s61, 31
s_add_u32 s61, s61, 24576
v_add_u32 v10, s61, v8
s_sub_u32 s60, s60, 8
s_cmp_lt_u32 s60, 8
s_cselect_b32 s61, 0, 1
s_cselect_b32 s62, 0x800, 0
s_or_b32 s52, s52, s62
s_lshl_b32 s61, s61, 31
s_add_u32 s61, s61, 16384
v_add_u32 v11, s61, v9
s_mul_i32 s52, s52, 0x10001
s_mov_b32 s53, s52
s_mov_b32 s48, 0xcccccccc
s_mov_b32 s49, 0xcccccccc
s_mov_b32 s50, 0xaaaaaaaa
s_mov_b32 s51, 0xaaaaaaaa
v_cmp_gt_u32 vcc, 8, v2
v_mov_b32 v47, 0
v_mov_b32 v48, 0
v_mov_b32 v49, 0
v_mov_b32 v50, 0
v_mov_b32 v51, 0
v_cndmask_b32 v12, v4, v47, vcc
v_cndmask_b32 v13, v5, v47, vcc
v_cndmask_b32 v14, v6, v47, vcc
v_cndmask_b32 v15, v7, v47, vcc
v_cndmask_b32 v4, v47, v4, vcc
v_cndmask_b32 v5, v47, v5, vcc
v_cndmask_b32 v6, v47, v6, vcc
v_cndmask_b32 v7, v47, v7, vcc
v_lshlrev_b32 v192, 2, v1
v_mov_b32 v193, 1
s_mov_b64 vcc, 0
s_barrier
s_waitcnt vmcnt(7)
s_add_u32 s59, s59, 4
s_lshr_b32 s60, s59, 1
s_xor_b32 s60, s60, s59
s_and_b32 s60, s60, 16
s_mul_i32 s60, s60, 3
s_xor_b32 s60, s60, s59
s_lshl_b32 s39, s60, 15
buffer_load_dwordx4 v[128:131], v61, s[72:75], s39 offen
s_waitcnt vmcnt(7)
s_add_u32 s59, s59, 4
s_lshr_b32 s60, s59, 1
s_xor_b32 s60, s60, s59
s_and_b32 s60, s60, 16
s_mul_i32 s60, s60, 3
s_xor_b32 s60, s60, s59
s_lshl_b32 s39, s60, 15
buffer_load_dwordx4 v[132:135], v61, s[72:75], s39 offen
s_waitcnt vmcnt(7)
s_add_u32 s59, s59, 4
s_lshr_b32 s60, s59, 1
s_xor_b32 s60, s60, s59
s_and_b32 s60, s60, 16
s_mul_i32 s60, s60, 3
s_xor_b32 s60, s60, s59
s_lshl_b32 s39, s60, 15
buffer_load_dwordx4 v[136:139], v61, s[72:75], s39 offen
s_waitcnt vmcnt(7)
s_add_u32 s59, s59, 4
s_cmp_lt_u32 s58, 2
s_cselect_b32 s59, s59, 128
s_lshr_b32 s60, s59, 1
s_xor_b32 s60, s60, s59
s_and_b32 s60, s60, 16
s_mul_i32 s60, s60, 3
s_xor_b32 s60, s60, s59
s_lshl_b32 s39, s60, 15
buffer_load_dwordx4 v[140:143], v61, s[72:75], s39 offen
s_waitcnt vmcnt(7)
s_lshl_b32 s60, s32, 8
s_sub_u32 s61, 0x400000, s60
s_add_u32 s76, s10, s60
s_addc_u32 s77, s11, 0
s_and_b32 s77, s77, 0xffff
s_mov_b32 s78, s61
s_mov_b32 s79, 0x20000
s_lshr_b32 s58, s56, 2
s_min_u32 s60, s58, 2
s_mul_i32 s59, s58, 5
s_add_u32 s59, s59, s60
s_lshl_b32 s59, s59, 2
s_add_u32 s59, s59, s34
s_lshr_b32 s60, s59, 1
s_xor_b32 s60, s60, s59
s_and_b32 s60, s60, 16
s_mul_i32 s60, s60, 3
s_xor_b32 s60, s60, s59
s_lshl_b32 s39, s60, 15
buffer_load_dwordx4 v[144:147], v61, s[76:79], s39 offen
s_waitcnt vmcnt(7)
s_add_u32 s59, s59, 4
s_lshr_b32 s60, s59, 1
s_xor_b32 s60, s60, s59
s_and_b32 s60, s60, 16
s_mul_i32 s60, s60, 3
s_xor_b32 s60, s60, s59
s_lshl_b32 s39, s60, 15
buffer_load_dwordx4 v[148:151], v61, s[76:79], s39 offen
s_waitcnt vmcnt(7)
s_add_u32 s59, s59, 4
s_lshr_b32 s60, s59, 1
s_xor_b32 s60, s60, s59
s_and_b32 s60, s60, 16
s_mul_i32 s60, s60, 3
s_xor_b32 s60, s60, s59
s_lshl_b32 s39, s60, 15
buffer_load_dwordx4 v[152:155], v61, s[76:79], s39 offen
s_waitcnt vmcnt(7)
s_add_u32 s59, s59, 4
s_lshr_b32 s60, s59, 1
s_xor_b32 s60, s60, s59
s_and_b32 s60, s60, 16
s_mul_i32 s60, s60, 3
s_xor_b32 s60, s60, s59
s_lshl_b32 s39, s60, 15
buffer_load_dwordx4 v[156:159], v61, s[76:79], s39 offen
s_waitcnt vmcnt(7)
s_add_u32 s59, s59, 4
s_lshr_b32 s60, s59, 1
s_xor_b32 s60, s60, s59
s_and_b32 s60, s60, 16
s_mul_i32 s60, s60, 3
s_xor_b32 s60, s60, s59
s_lshl_b32 s39, s60, 15
buffer_load_dwordx4 v[128:131], v61, s[76:79], s39 offen
s_waitcnt vmcnt(7)
s_add_u32 s59, s59, 4
s_cmp_lt_u32 s58, 2
s_cselect_b32 s59, s59, 128
s_lshr_b32 s60, s59, 1
s_xor_b32 s60, s60, s59
s_and_b32 s60, s60, 16
s_mul_i32 s60, s60, 3
s_xor_b32 s60, s60, s59
s_lshl_b32 s39, s60, 15
buffer_load_dwordx4 v[132:135], v61, s[76:79], s39 offen
s_waitcnt vmcnt(7)
s_lshl_b32 s60, s32, 8
s_sub_u32 s61, 0x400000, s60
s_add_u32 s80, s22, s60
s_addc_u32 s81, s23, 0
s_and_b32 s81, s81, 0xffff
s_mov_b32 s82, s61
s_mov_b32 s83, 0x20000
s_lshr_b32 s58, s54, 2
s_min_u32 s60, s58, 2
s_mul_i32 s59, s58, 5
s_add_u32 s59, s59, s60
s_lshl_b32 s59, s59, 2
s_add_u32 s59, s59, s34
s_lshr_b32 s60, s59, 1
s_xor_b32 s60, s60, s59
s_and_b32 s60, s60, 16
s_mul_i32 s60, s60, 3
s_xor_b32 s60, s60, s59
s_lshl_b32 s39, s60, 15
buffer_load_dwordx4 v[136:139], v61, s[80:83], s39 offen
s_waitcnt vmcnt(7)
s_add_u32 s59, s59, 4
s_lshr_b32 s60, s59, 1
s_xor_b32 s60, s60, s59
s_and_b32 s60, s60, 16
s_mul_i32 s60, s60, 3
s_xor_b32 s60, s60, s59
s_lshl_b32 s39, s60, 15
buffer_load_dwordx4 v[140:143], v61, s[80:83], s39 offen
s_waitcnt vmcnt(7)
s_add_u32 s59, s59, 4
s_lshr_b32 s60, s59, 1
s_xor_b32 s60, s60, s59
s_and_b32 s60, s60, 16
s_mul_i32 s60, s60, 3
s_xor_b32 s60, s60, s59
s_lshl_b32 s39, s60, 15
buffer_load_dwordx4 v[144:147], v61, s[80:83], s39 offen
s_waitcnt vmcnt(7)
s_add_u32 s59, s59, 4
s_lshr_b32 s60, s59, 1
s_xor_b32 s60, s60, s59
s_and_b32 s60, s60, 16
s_mul_i32 s60, s60, 3
s_xor_b32 s60, s60, s59
s_lshl_b32 s39, s60, 15
buffer_load_dwordx4 v[148:151], v61, s[80:83], s39 offen
s_waitcnt vmcnt(7)
s_add_u32 s59, s59, 4
s_lshr_b32 s60, s59, 1
s_xor_b32 s60, s60, s59
s_and_b32 s60, s60, 16
s_mul_i32 s60, s60, 3
s_xor_b32 s60, s60, s59
s_lshl_b32 s39, s60, 15
buffer_load_dwordx4 v[152:155], v61, s[80:83], s39 offen
s_waitcnt vmcnt(7)
s_add_u32 s59, s59, 4
s_cmp_lt_u32 s58, 2
s_cselect_b32 s59, s59, 128
s_lshr_b32 s60, s59, 1
s_xor_b32 s60, s60, s59
s_and_b32 s60, s60, 16
s_mul_i32 s60, s60, 3
s_xor_b32 s60, s60, s59
s_lshl_b32 s39, s60, 15
buffer_load_dwordx4 v[156:159], v61, s[80:83], s39 offen
s_waitcnt vmcnt(7)
s_lshl_b32 s60, s32, 17
s_mov_b32 s61, 0x20000
s_add_u32 s68, s24, s60
s_addc_u32 s69, s25, 0
s_and_b32 s69, s69, 0xffff
s_mov_b32 s70, s61
s_mov_b32 s71, 0x20000
s_lshr_b32 s58, s55, 2
s_min_u32 s60, s58, 2
s_mul_i32 s59, s58, 5
s_add_u32 s59, s59, s60
s_lshl_b32 s59, s59, 2
s_add_u32 s59, s59, s34
s_lshl_b32 s39, s59, 10
buffer_load_dwordx4 v[128:131], v8, s[68:71], s39 offen
s_waitcnt vmcnt(7)
s_add_u32 s59, s59, 4
s_lshl_b32 s39, s59, 10
buffer_load_dwordx4 v[132:135], v8, s[68:71], s39 offen
s_waitcnt vmcnt(7)
s_add_u32 s59, s59, 4
s_lshl_b32 s39, s59, 10
buffer_load_dwordx4 v[136:139], v8, s[68:71], s39 offen
s_waitcnt vmcnt(7)
s_add_u32 s59, s59, 4
s_lshl_b32 s39, s59, 10
buffer_load_dwordx4 v[140:143], v8, s[68:71], s39 offen
s_waitcnt vmcnt(7)
s_add_u32 s59, s59, 4
s_lshl_b32 s39, s59, 10
buffer_load_dwordx4 v[144:147], v8, s[68:71], s39 offen
s_waitcnt vmcnt(7)
s_add_u32 s59, s59, 4
s_cmp_lt_u32 s58, 2
s_cselect_b32 s59, s59, 128
s_lshl_b32 s39, s59, 10
buffer_load_dwordx4 v[148:151], v8, s[68:71], s39 offen
s_waitcnt vmcnt(7)
s_lshl_b32 s60, s32, 19
s_add_u32 s60, s60, 0x30000
s_mov_b32 s61, 0x50000
s_add_u32 s72, s16, s60
s_addc_u32 s73, s17, 0
s_and_b32 s73, s73, 0xffff
s_mov_b32 s74, s61
s_mov_b32 s75, 0x20000
s_lshr_b32 s58, s56, 2
s_min_u32 s60, s58, 2
s_mul_i32 s59, s58, 13
s_add_u32 s59, s59, s60
s_lshl_b32 s59, s59, 2
s_add_u32 s59, s59, s34
s_lshl_b32 s39, s59, 10
buffer_load_dwordx4 v[152:155], v8, s[72:75], s39 offen
s_waitcnt vmcnt(7)
s_add_u32 s59, s59, 4
s_lshl_b32 s39, s59, 10
buffer_load_dwordx4 v[156:159], v8, s[72:75], s39 offen
s_waitcnt vmcnt(7)
s_add_u32 s59, s59, 4
s_lshl_b32 s39, s59, 10
buffer_load_dwordx4 v[128:131], v8, s[72:75], s39 offen
s_waitcnt vmcnt(7)
s_add_u32 s59, s59, 4
s_lshl_b32 s39, s59, 10
buffer_load_dwordx4 v[132:135], v8, s[72:75], s39 offen
s_waitcnt vmcnt(7)
s_add_u32 s59, s59, 4
s_lshl_b32 s39, s59, 10
buffer_load_dwordx4 v[136:139], v8, s[72:75], s39 offen
s_waitcnt vmcnt(7)
s_add_u32 s59, s59, 4
s_lshl_b32 s39, s59, 10
buffer_load_dwordx4 v[140:143], v8, s[72:75], s39 offen
s_waitcnt vmcnt(7)
s_add_u32 s59, s59, 4
s_lshl_b32 s39, s59, 10
buffer_load_dwordx4 v[144:147], v8, s[72:75], s39 offen
s_waitcnt vmcnt(7)
s_add_u32 s59, s59, 4
s_lshl_b32 s39, s59, 10
buffer_load_dwordx4 v[148:151], v8, s[72:75], s39 offen
s_waitcnt vmcnt(7)
s_add_u32 s59, s59, 4
s_lshl_b32 s39, s59, 10
buffer_load_dwordx4 v[152:155], v8, s[72:75], s39 offen
s_waitcnt vmcnt(7)
s_add_u32 s59, s59, 4
s_lshl_b32 s39, s59, 10
buffer_load_dwordx4 v[156:159], v8, s[72:75], s39 offen
s_waitcnt vmcnt(7)
s_add_u32 s59, s59, 4
s_lshl_b32 s39, s59, 10
buffer_load_dwordx4 v[128:131], v8, s[72:75], s39 offen
s_waitcnt vmcnt(7)
s_add_u32 s59, s59, 4
s_lshl_b32 s39, s59, 10
buffer_load_dwordx4 v[132:135], v8, s[72:75], s39 offen
s_waitcnt vmcnt(7)
s_add_u32 s59, s59, 4
s_lshl_b32 s39, s59, 10
buffer_load_dwordx4 v[136:139], v8, s[72:75], s39 offen
s_waitcnt vmcnt(7)
s_add_u32 s59, s59, 4
s_cmp_lt_u32 s58, 2
s_cselect_b32 s59, s59, 320
s_lshl_b32 s39, s59, 10
buffer_load_dwordx4 v[140:143], v8, s[72:75], s39 offen
s_waitcnt vmcnt(7)
buffer_load_dwordx4 v[64:67], v8, s[40:43], s36 offen offset:0 nt
s_waitcnt vmcnt(7)
buffer_load_dwordx4 v[68:71], v8, s[40:43], s36 offen offset:1024 nt
s_waitcnt vmcnt(7)
buffer_load_dwordx4 v[72:75], v8, s[40:43], s36 offen offset:2048 nt
s_waitcnt vmcnt(7)
buffer_load_dwordx4 v[76:79], v8, s[40:43], s36 offen offset:3072 nt
s_waitcnt vmcnt(7)
buffer_load_dwordx4 v[80:83], v9, s[40:43], s36 offen offset:0 nt
s_waitcnt vmcnt(7)
buffer_load_dwordx4 v[84:87], v9, s[40:43], s36 offen offset:1024 nt
s_waitcnt vmcnt(7)
buffer_load_dwordx4 v[88:91], v9, s[40:43], s36 offen offset:2048 nt
s_waitcnt vmcnt(7)
buffer_load_dwordx4 v[92:95], v9, s[40:43], s36 offen offset:3072 nt
s_waitcnt vmcnt(7)
s_add_u32 s36, s36, 0x18000
buffer_load_dwordx4 v[96:99], v8, s[40:43], s36 offen offset:0 nt
s_waitcnt vmcnt(7)
buffer_load_dwordx4 v[100:103], v8, s[40:43], s36 offen offset:1024 nt
ds_add_u32 v192, v193 offset:256
s_waitcnt vmcnt(7)
buffer_load_dwordx4 v[104:107], v8, s[40:43], s36 offen offset:2048 nt
s_waitcnt vmcnt(7)
buffer_load_dwordx4 v[108:111], v8, s[40:43], s36 offen offset:3072 nt
ds_add_u32 v192, v193 offset:256
s_waitcnt vmcnt(7)
buffer_load_dwordx4 v[112:115], v9, s[40:43], s36 offen offset:0 nt
s_waitcnt vmcnt(7)
buffer_load_dwordx4 v[116:119], v9, s[40:43], s36 offen offset:1024 nt
ds_add_u32 v192, v193 offset:256
s_waitcnt vmcnt(7)
buffer_load_dwordx4 v[120:123], v9, s[40:43], s36 offen offset:2048 nt
s_waitcnt vmcnt(7)
buffer_load_dwordx4 v[124:127], v9, s[40:43], s36 offen offset:3072 nt
ds_add_u32 v192, v193 offset:256
s_waitcnt vmcnt(7)
s_add_u32 s36, s36, 0x18000
buffer_load_dwordx4 v[128:131], v8, s[40:43], s36 offen offset:0 nt
s_waitcnt vmcnt(7)
buffer_load_dwordx4 v[132:135], v8, s[40:43], s36 offen offset:1024 nt
ds_add_u32 v192, v193 offset:256
s_waitcnt vmcnt(7)
buffer_load_dwordx4 v[136:139], v8, s[40:43], s36 offen offset:2048 nt
s_waitcnt vmcnt(7)
buffer_load_dwordx4 v[140:143], v8, s[40:43], s36 offen offset:3072 nt
ds_add_u32 v192, v193 offset:256
s_waitcnt vmcnt(7)
buffer_load_dwordx4 v[144:147], v9, s[40:43], s36 offen offset:0 nt
s_waitcnt vmcnt(7)
buffer_load_dwordx4 v[148:151], v9, s[40:43], s36 offen offset:1024 nt
ds_add_u32 v192, v193 offset:256
s_waitcnt vmcnt(7)
buffer_load_dwordx4 v[152:155], v9, s[40:43], s36 offen offset:2048 nt
s_waitcnt vmcnt(7)
buffer_load_dwordx4 v[156:159], v9, s[40:43], s36 offen offset:3072 nt
ds_add_u32 v192, v193 offset:256
s_waitcnt vmcnt(7)
s_add_u32 s36, s36, 0x18000
buffer_load_dwordx4 v[160:163], v8, s[40:43], s36 offen offset:0 nt
s_waitcnt vmcnt(7)
buffer_load_dwordx4 v[164:167], v8, s[40:43], s36 offen offset:1024 nt
ds_add_u32 v192, v193 offset:256
s_waitcnt vmcnt(7)
buffer_load_dwordx4 v[168:171], v8, s[40:43], s36 offen offset:2048 nt
s_waitcnt vmcnt(7)
buffer_load_dwordx4 v[172:175], v8, s[40:43], s36 offen offset:3072 nt
ds_add_u32 v192, v193 offset:256
s_waitcnt vmcnt(7)
buffer_load_dwordx4 v[176:179], v9, s[40:43], s36 offen offset:0 nt
s_waitcnt vmcnt(7)
buffer_load_dwordx4 v[180:183], v9, s[40:43], s36 offen offset:1024 nt
ds_add_u32 v192, v193 offset:256
s_waitcnt vmcnt(7)
buffer_load_dwordx4 v[184:187], v9, s[40:43], s36 offen offset:2048 nt
s_waitcnt vmcnt(7)
buffer_load_dwordx4 v[188:191], v9, s[40:43], s36 offen offset:3072 nt
ds_add_u32 v192, v193 offset:256
v_lshlrev_b32 v61, 4, v2
s_mov_b32 s64, 0
L_A_qw:
ds_read_b32 v60, v47 offset:0
s_waitcnt lgkmcnt(0)
v_readfirstlane_b32 s65, v60
s_add_u32 s64, s64, 1
s_nop 2
s_cmp_ge_u32 s65, 1
s_cbranch_scc1 L_A_qw_ok
s_sleep 1
s_cmp_lt_u32 s64, 1048576
s_cbranch_scc1 L_A_qw
L_A_qw_ok:
v_lshlrev_b32 v60, 5, v2
ds_read_b128 v[16:19], v61 offset:1024
ds_read_b128 v[20:23], v61 offset:1280
s_waitcnt lgkmcnt(0)
v_dot2_f32_bf16 v24, v64, v16, 0
v_dot2_f32_bf16 v24, v65, v17, v24
v_dot2_f32_bf16 v24, v66, v18, v24
v_dot2_f32_bf16 v24, v67, v19, v24
s_waitcnt vmcnt(6)
s_add_u32 s36, s36, 0x18000
buffer_load_dwordx4 v[64:67], v8, s[40:43], s36 offen offset:0 nt
v_dot2_f32_bf16 v25, v68, v16, 0
v_dot2_f32_bf16 v25, v69, v17, v25
v_dot2_f32_bf16 v25, v70, v18, v25
v_dot2_f32_bf16 v25, v71, v19, v25
s_waitcnt vmcnt(6)
buffer_load_dwordx4 v[68:71], v8, s[40:43], s36 offen offset:1024 nt
ds_add_u32 v192, v193 offset:256
v_add_f32_dpp v28, v24, v24 row_ror:8 row_mask:0xf bank_mask:0x3
v_dot2_f32_bf16 v26, v72, v16, 0
v_dot2_f32_bf16 v26, v73, v17, v26
v_dot2_f32_bf16 v26, v74, v18, v26
v_dot2_f32_bf16 v26, v75, v19, v26
v_add_f32_dpp v28, v25, v25 row_ror:8 row_mask:0xf bank_mask:0xc
s_waitcnt vmcnt(6)
buffer_load_dwordx4 v[72:75], v8, s[40:43], s36 offen offset:2048 nt
v_dot2_f32_bf16 v27, v76, v16, 0
v_dot2_f32_bf16 v27, v77, v17, v27
v_dot2_f32_bf16 v27, v78, v18, v27
v_dot2_f32_bf16 v27, v79, v19, v27
s_waitcnt vmcnt(6)
buffer_load_dwordx4 v[76:79], v8, s[40:43], s36 offen offset:3072 nt
ds_add_u32 v192, v193 offset:256
v_add_f32_dpp v29, v26, v26 row_ror:8 row_mask:0xf bank_mask:0x3
v_dot2_f32_bf16 v24, v80, v20, 0
v_dot2_f32_bf16 v24, v81, v21, v24
v_dot2_f32_bf16 v24, v82, v22, v24
v_dot2_f32_bf16 v24, v83, v23, v24
v_add_f32_dpp v29, v27, v27 row_ror:8 row_mask:0xf bank_mask:0xc
s_waitcnt vmcnt(6)
buffer_load_dwordx4 v[80:83], v9, s[40:43], s36 offen offset:0 nt
v_add_f32_dpp v30, v28, v28 row_shl:4 row_mask:0xf bank_mask:0x5
v_dot2_f32_bf16 v25, v84, v20, 0
v_dot2_f32_bf16 v25, v85, v21, v25
v_dot2_f32_bf16 v25, v86, v22, v25
v_dot2_f32_bf16 v25, v87, v23, v25
v_add_f32_dpp v30, v29, v29 row_shr:4 row_mask:0xf bank_mask:0xa
s_waitcnt vmcnt(6)
buffer_load_dwordx4 v[84:87], v9, s[40:43], s36 offen offset:1024 nt
ds_add_u32 v192, v193 offset:256
v_add_f32_dpp v28, v24, v24 row_ror:8 row_mask:0xf bank_mask:0x3
v_dot2_f32_bf16 v26, v88, v20, 0
v_dot2_f32_bf16 v26, v89, v21, v26
v_dot2_f32_bf16 v26, v90, v22, v26
v_dot2_f32_bf16 v26, v91, v23, v26
v_add_f32_dpp v28, v25, v25 row_ror:8 row_mask:0xf bank_mask:0xc
s_waitcnt vmcnt(6)
buffer_load_dwordx4 v[88:91], v9, s[40:43], s36 offen offset:2048 nt
v_dot2_f32_bf16 v27, v92, v20, 0
v_dot2_f32_bf16 v27, v93, v21, v27
v_dot2_f32_bf16 v27, v94, v22, v27
v_dot2_f32_bf16 v27, v95, v23, v27
v_add_f32_dpp v29, v26, v26 row_ror:8 row_mask:0xf bank_mask:0x3
v_dot2_f32_bf16 v24, v96, v16, 0
v_dot2_f32_bf16 v24, v97, v17, v24
v_dot2_f32_bf16 v24, v98, v18, v24
v_dot2_f32_bf16 v24, v99, v19, v24
v_add_f32_dpp v29, v27, v27 row_ror:8 row_mask:0xf bank_mask:0xc
v_add_f32_dpp v31, v28, v28 row_shl:4 row_mask:0xf bank_mask:0x5
v_dot2_f32_bf16 v25, v100, v16, 0
v_dot2_f32_bf16 v25, v101, v17, v25
v_dot2_f32_bf16 v25, v102, v18, v25
v_dot2_f32_bf16 v25, v103, v19, v25
v_add_f32_dpp v31, v29, v29 row_shr:4 row_mask:0xf bank_mask:0xa
s_waitcnt vmcnt(6)
buffer_load_dwordx4 v[92:95], v9, s[40:43], s36 offen offset:3072 nt
ds_add_u32 v192, v193 offset:256
v_add_f32_dpp v34, v30, v30 quad_perm:[2,3,0,1] row_mask:0xf bank_mask:0xf
v_add_f32_dpp v28, v24, v24 row_ror:8 row_mask:0xf bank_mask:0x3
v_dot2_f32_bf16 v26, v104, v16, 0
v_dot2_f32_bf16 v26, v105, v17, v26
v_dot2_f32_bf16 v26, v106, v18, v26
v_dot2_f32_bf16 v26, v107, v19, v26
v_add_f32_dpp v35, v31, v31 quad_perm:[2,3,0,1] row_mask:0xf bank_mask:0xf
v_cndmask_b32 v32, v34, v35, s[48:49]
v_add_f32_dpp v28, v25, v25 row_ror:8 row_mask:0xf bank_mask:0xc
v_dot2_f32_bf16 v27, v108, v16, 0
v_dot2_f32_bf16 v27, v109, v17, v27
v_dot2_f32_bf16 v27, v110, v18, v27
v_dot2_f32_bf16 v27, v111, v19, v27
v_add_f32_dpp v29, v26, v26 row_ror:8 row_mask:0xf bank_mask:0x3
v_dot2_f32_bf16 v24, v112, v20, 0
v_dot2_f32_bf16 v24, v113, v21, v24
v_dot2_f32_bf16 v24, v114, v22, v24
v_dot2_f32_bf16 v24, v115, v23, v24
v_add_f32_dpp v29, v27, v27 row_ror:8 row_mask:0xf bank_mask:0xc
s_waitcnt vmcnt(6)
s_add_u32 s36, s36, 0x18000
buffer_load_dwordx4 v[96:99], v8, s[40:43], s36 offen offset:0 nt
v_add_f32_dpp v30, v28, v28 row_shl:4 row_mask:0xf bank_mask:0x5
v_dot2_f32_bf16 v25, v116, v20, 0
v_dot2_f32_bf16 v25, v117, v21, v25
v_dot2_f32_bf16 v25, v118, v22, v25
v_dot2_f32_bf16 v25, v119, v23, v25
v_add_f32_dpp v30, v29, v29 row_shr:4 row_mask:0xf bank_mask:0xa
v_add_f32_dpp v28, v24, v24 row_ror:8 row_mask:0xf bank_mask:0x3
v_dot2_f32_bf16 v26, v120, v20, 0
v_dot2_f32_bf16 v26, v121, v21, v26
v_dot2_f32_bf16 v26, v122, v22, v26
v_dot2_f32_bf16 v26, v123, v23, v26
v_add_f32_dpp v28, v25, v25 row_ror:8 row_mask:0xf bank_mask:0xc
v_dot2_f32_bf16 v27, v124, v20, 0
v_dot2_f32_bf16 v27, v125, v21, v27
v_dot2_f32_bf16 v27, v126, v22, v27
v_dot2_f32_bf16 v27, v127, v23, v27
s_waitcnt vmcnt(6)
buffer_load_dwordx4 v[100:103], v8, s[40:43], s36 offen offset:1024 nt
ds_add_u32 v192, v193 offset:256
v_add_f32_dpp v29, v26, v26 row_ror:8 row_mask:0xf bank_mask:0x3
v_dot2_f32_bf16 v24, v128, v16, 0
v_dot2_f32_bf16 v24, v129, v17, v24
v_dot2_f32_bf16 v24, v130, v18, v24
v_dot2_f32_bf16 v24, v131, v19, v24
v_add_f32_dpp v29, v27, v27 row_ror:8 row_mask:0xf bank_mask:0xc
v_add_f32_dpp v31, v28, v28 row_shl:4 row_mask:0xf bank_mask:0x5
v_dot2_f32_bf16 v25, v132, v16, 0
v_dot2_f32_bf16 v25, v133, v17, v25
v_dot2_f32_bf16 v25, v134, v18, v25
v_dot2_f32_bf16 v25, v135, v19, v25
v_add_f32_dpp v31, v29, v29 row_shr:4 row_mask:0xf bank_mask:0xa
v_add_f32_dpp v34, v30, v30 quad_perm:[2,3,0,1] row_mask:0xf bank_mask:0xf
v_add_f32_dpp v28, v24, v24 row_ror:8 row_mask:0xf bank_mask:0x3
v_dot2_f32_bf16 v26, v136, v16, 0
v_dot2_f32_bf16 v26, v137, v17, v26
v_dot2_f32_bf16 v26, v138, v18, v26
v_dot2_f32_bf16 v26, v139, v19, v26
v_add_f32_dpp v35, v31, v31 quad_perm:[2,3,0,1] row_mask:0xf bank_mask:0xf
v_cndmask_b32 v33, v34, v35, s[48:49]
v_add_f32_dpp v28, v25, v25 row_ror:8 row_mask:0xf bank_mask:0xc
s_waitcnt vmcnt(6)
buffer_load_dwordx4 v[104:107], v8, s[40:43], s36 offen offset:2048 nt
v_add_f32_dpp v34, v32, v32 quad_perm:[1,0,3,2] row_mask:0xf bank_mask:0xf
v_mov_b32 v36, v37
v_mov_b32 v37, v38
v_mov_b32 v38, v39
v_mov_b32 v39, v40
v_mov_b32 v40, v41
v_mov_b32 v41, v42
v_mov_b32 v42, v43
v_mov_b32 v43, v44
v_mov_b32 v44, v45
v_mov_b32 v45, v46
v_dot2_f32_bf16 v27, v140, v16, 0
v_dot2_f32_bf16 v27, v141, v17, v27
v_dot2_f32_bf16 v27, v142, v18, v27
v_dot2_f32_bf16 v27, v143, v19, v27
v_add_f32_dpp v35, v33, v33 quad_perm:[1,0,3,2] row_mask:0xf bank_mask:0xf
v_cndmask_b32 v46, v34, v35, s[50:51]
v_add_f32_dpp v29, v26, v26 row_ror:8 row_mask:0xf bank_mask:0x3
v_dot2_f32_bf16 v24, v144, v20, 0
v_dot2_f32_bf16 v24, v145, v21, v24
v_dot2_f32_bf16 v24, v146, v22, v24
v_dot2_f32_bf16 v24, v147, v23, v24
v_add_f32_dpp v29, v27, v27 row_ror:8 row_mask:0xf bank_mask:0xc
v_add_f32_dpp v30, v28, v28 row_shl:4 row_mask:0xf bank_mask:0x5
v_dot2_f32_bf16 v25, v148, v20, 0
v_dot2_f32_bf16 v25, v149, v21, v25
v_dot2_f32_bf16 v25, v150, v22, v25
v_dot2_f32_bf16 v25, v151, v23, v25
v_add_f32_dpp v30, v29, v29 row_shr:4 row_mask:0xf bank_mask:0xa
s_waitcnt vmcnt(6)
buffer_load_dwordx4 v[108:111], v8, s[40:43], s36 offen offset:3072 nt
ds_add_u32 v192, v193 offset:256
v_add_f32_dpp v28, v24, v24 row_ror:8 row_mask:0xf bank_mask:0x3
v_dot2_f32_bf16 v26, v152, v20, 0
v_dot2_f32_bf16 v26, v153, v21, v26
v_dot2_f32_bf16 v26, v154, v22, v26
v_dot2_f32_bf16 v26, v155, v23, v26
v_add_f32_dpp v28, v25, v25 row_ror:8 row_mask:0xf bank_mask:0xc
v_dot2_f32_bf16 v27, v156, v20, 0
v_dot2_f32_bf16 v27, v157, v21, v27
v_dot2_f32_bf16 v27, v158, v22, v27
v_dot2_f32_bf16 v27, v159, v23, v27
v_add_f32_dpp v29, v26, v26 row_ror:8 row_mask:0xf bank_mask:0x3
v_dot2_f32_bf16 v24, v160, v16, 0
v_dot2_f32_bf16 v24, v161, v17, v24
v_dot2_f32_bf16 v24, v162, v18, v24
v_dot2_f32_bf16 v24, v163, v19, v24
v_add_f32_dpp v29, v27, v27 row_ror:8 row_mask:0xf bank_mask:0xc
s_waitcnt vmcnt(6)
buffer_load_dwordx4 v[112:115], v9, s[40:43], s36 offen offset:0 nt
v_add_f32_dpp v31, v28, v28 row_shl:4 row_mask:0xf bank_mask:0x5
v_dot2_f32_bf16 v25, v164, v16, 0
v_dot2_f32_bf16 v25, v165, v17, v25
v_dot2_f32_bf16 v25, v166, v18, v25
v_dot2_f32_bf16 v25, v167, v19, v25
v_add_f32_dpp v31, v29, v29 row_shr:4 row_mask:0xf bank_mask:0xa
v_add_f32_dpp v34, v30, v30 quad_perm:[2,3,0,1] row_mask:0xf bank_mask:0xf
v_add_f32_dpp v28, v24, v24 row_ror:8 row_mask:0xf bank_mask:0x3
v_dot2_f32_bf16 v26, v168, v16, 0
v_dot2_f32_bf16 v26, v169, v17, v26
v_dot2_f32_bf16 v26, v170, v18, v26
v_dot2_f32_bf16 v26, v171, v19, v26
v_add_f32_dpp v35, v31, v31 quad_perm:[2,3,0,1] row_mask:0xf bank_mask:0xf
v_cndmask_b32 v32, v34, v35, s[48:49]
v_add_f32_dpp v28, v25, v25 row_ror:8 row_mask:0xf bank_mask:0xc
v_dot2_f32_bf16 v27, v172, v16, 0
v_dot2_f32_bf16 v27, v173, v17, v27
v_dot2_f32_bf16 v27, v174, v18, v27
v_dot2_f32_bf16 v27, v175, v19, v27
s_waitcnt vmcnt(6)
buffer_load_dwordx4 v[116:119], v9, s[40:43], s36 offen offset:1024 nt
ds_add_u32 v192, v193 offset:256
v_add_f32_dpp v29, v26, v26 row_ror:8 row_mask:0xf bank_mask:0x3
v_dot2_f32_bf16 v24, v176, v20, 0
v_dot2_f32_bf16 v24, v177, v21, v24
v_dot2_f32_bf16 v24, v178, v22, v24
v_dot2_f32_bf16 v24, v179, v23, v24
v_add_f32_dpp v29, v27, v27 row_ror:8 row_mask:0xf bank_mask:0xc
v_add_f32_dpp v30, v28, v28 row_shl:4 row_mask:0xf bank_mask:0x5
v_dot2_f32_bf16 v25, v180, v20, 0
v_dot2_f32_bf16 v25, v181, v21, v25
v_dot2_f32_bf16 v25, v182, v22, v25
v_dot2_f32_bf16 v25, v183, v23, v25
v_add_f32_dpp v30, v29, v29 row_shr:4 row_mask:0xf bank_mask:0xa
v_add_f32_dpp v28, v24, v24 row_ror:8 row_mask:0xf bank_mask:0x3
v_dot2_f32_bf16 v26, v184, v20, 0
v_dot2_f32_bf16 v26, v185, v21, v26
v_dot2_f32_bf16 v26, v186, v22, v26
v_dot2_f32_bf16 v26, v187, v23, v26
v_add_f32_dpp v28, v25, v25 row_ror:8 row_mask:0xf bank_mask:0xc
s_waitcnt vmcnt(6)
buffer_load_dwordx4 v[120:123], v9, s[40:43], s36 offen offset:2048 nt
v_dot2_f32_bf16 v27, v188, v20, 0
v_dot2_f32_bf16 v27, v189, v21, v27
v_dot2_f32_bf16 v27, v190, v22, v27
v_dot2_f32_bf16 v27, v191, v23, v27
v_add_f32_dpp v29, v26, v26 row_ror:8 row_mask:0xf bank_mask:0x3
v_dot2_f32_bf16 v24, v64, v16, 0
v_dot2_f32_bf16 v24, v65, v17, v24
v_dot2_f32_bf16 v24, v66, v18, v24
v_dot2_f32_bf16 v24, v67, v19, v24
v_add_f32_dpp v29, v27, v27 row_ror:8 row_mask:0xf bank_mask:0xc
v_add_f32_dpp v31, v28, v28 row_shl:4 row_mask:0xf bank_mask:0x5
v_dot2_f32_bf16 v25, v68, v16, 0
v_dot2_f32_bf16 v25, v69, v17, v25
v_dot2_f32_bf16 v25, v70, v18, v25
v_dot2_f32_bf16 v25, v71, v19, v25
v_add_f32_dpp v31, v29, v29 row_shr:4 row_mask:0xf bank_mask:0xa
s_waitcnt vmcnt(6)
buffer_load_dwordx4 v[124:127], v9, s[40:43], s36 offen offset:3072 nt
ds_add_u32 v192, v193 offset:256
v_add_f32_dpp v34, v30, v30 quad_perm:[2,3,0,1] row_mask:0xf bank_mask:0xf
v_add_f32_dpp v28, v24, v24 row_ror:8 row_mask:0xf bank_mask:0x3
v_dot2_f32_bf16 v26, v72, v16, 0
v_dot2_f32_bf16 v26, v73, v17, v26
v_dot2_f32_bf16 v26, v74, v18, v26
v_dot2_f32_bf16 v26, v75, v19, v26
v_add_f32_dpp v35, v31, v31 quad_perm:[2,3,0,1] row_mask:0xf bank_mask:0xf
v_cndmask_b32 v33, v34, v35, s[48:49]
v_add_f32_dpp v28, v25, v25 row_ror:8 row_mask:0xf bank_mask:0xc
v_add_f32_dpp v34, v32, v32 quad_perm:[1,0,3,2] row_mask:0xf bank_mask:0xf
v_mov_b32 v36, v37
v_mov_b32 v37, v38
v_mov_b32 v38, v39
v_mov_b32 v39, v40
v_mov_b32 v40, v41
v_mov_b32 v41, v42
v_mov_b32 v42, v43
v_mov_b32 v43, v44
v_mov_b32 v44, v45
v_mov_b32 v45, v46
v_dot2_f32_bf16 v27, v76, v16, 0
v_dot2_f32_bf16 v27, v77, v17, v27
v_dot2_f32_bf16 v27, v78, v18, v27
v_dot2_f32_bf16 v27, v79, v19, v27
v_add_f32_dpp v35, v33, v33 quad_perm:[1,0,3,2] row_mask:0xf bank_mask:0xf
v_cndmask_b32 v46, v34, v35, s[50:51]
v_add_f32_dpp v29, v26, v26 row_ror:8 row_mask:0xf bank_mask:0x3
v_dot2_f32_bf16 v24, v80, v20, 0
v_dot2_f32_bf16 v24, v81, v21, v24
v_dot2_f32_bf16 v24, v82, v22, v24
v_dot2_f32_bf16 v24, v83, v23, v24
v_add_f32_dpp v29, v27, v27 row_ror:8 row_mask:0xf bank_mask:0xc
s_waitcnt vmcnt(6)
s_add_u32 s36, s36, 0x18000
buffer_load_dwordx4 v[64:67], v8, s[40:43], s36 offen offset:0 nt
v_add_f32_dpp v30, v28, v28 row_shl:4 row_mask:0xf bank_mask:0x5
v_dot2_f32_bf16 v25, v84, v20, 0
v_dot2_f32_bf16 v25, v85, v21, v25
v_dot2_f32_bf16 v25, v86, v22, v25
v_dot2_f32_bf16 v25, v87, v23, v25
v_add_f32_dpp v30, v29, v29 row_shr:4 row_mask:0xf bank_mask:0xa
v_add_f32_dpp v28, v24, v24 row_ror:8 row_mask:0xf bank_mask:0x3
v_dot2_f32_bf16 v26, v88, v20, 0
v_dot2_f32_bf16 v26, v89, v21, v26
v_dot2_f32_bf16 v26, v90, v22, v26
v_dot2_f32_bf16 v26, v91, v23, v26
v_add_f32_dpp v28, v25, v25 row_ror:8 row_mask:0xf bank_mask:0xc
v_dot2_f32_bf16 v27, v92, v20, 0
v_dot2_f32_bf16 v27, v93, v21, v27
v_dot2_f32_bf16 v27, v94, v22, v27
v_dot2_f32_bf16 v27, v95, v23, v27
s_waitcnt vmcnt(6)
buffer_load_dwordx4 v[68:71], v8, s[40:43], s36 offen offset:1024 nt
ds_add_u32 v192, v193 offset:256
v_add_f32_dpp v29, v26, v26 row_ror:8 row_mask:0xf bank_mask:0x3
v_dot2_f32_bf16 v24, v96, v16, 0
v_dot2_f32_bf16 v24, v97, v17, v24
v_dot2_f32_bf16 v24, v98, v18, v24
v_dot2_f32_bf16 v24, v99, v19, v24
v_add_f32_dpp v29, v27, v27 row_ror:8 row_mask:0xf bank_mask:0xc
v_add_f32_dpp v31, v28, v28 row_shl:4 row_mask:0xf bank_mask:0x5
v_dot2_f32_bf16 v25, v100, v16, 0
v_dot2_f32_bf16 v25, v101, v17, v25
v_dot2_f32_bf16 v25, v102, v18, v25
v_dot2_f32_bf16 v25, v103, v19, v25
v_add_f32_dpp v31, v29, v29 row_shr:4 row_mask:0xf bank_mask:0xa
s_waitcnt vmcnt(6)
buffer_load_dwordx4 v[72:75], v8, s[40:43], s36 offen offset:2048 nt
v_add_f32_dpp v34, v30, v30 quad_perm:[2,3,0,1] row_mask:0xf bank_mask:0xf
v_add_f32_dpp v28, v24, v24 row_ror:8 row_mask:0xf bank_mask:0x3
v_dot2_f32_bf16 v26, v104, v16, 0
v_dot2_f32_bf16 v26, v105, v17, v26
v_dot2_f32_bf16 v26, v106, v18, v26
v_dot2_f32_bf16 v26, v107, v19, v26
v_add_f32_dpp v35, v31, v31 quad_perm:[2,3,0,1] row_mask:0xf bank_mask:0xf
v_cndmask_b32 v32, v34, v35, s[48:49]
v_add_f32_dpp v28, v25, v25 row_ror:8 row_mask:0xf bank_mask:0xc
s_waitcnt vmcnt(6)
buffer_load_dwordx4 v[76:79], v8, s[40:43], s36 offen offset:3072 nt
ds_add_u32 v192, v193 offset:256
v_dot2_f32_bf16 v27, v108, v16, 0
v_dot2_f32_bf16 v27, v109, v17, v27
v_dot2_f32_bf16 v27, v110, v18, v27
v_dot2_f32_bf16 v27, v111, v19, v27
s_waitcnt vmcnt(6)
buffer_load_dwordx4 v[80:83], v9, s[40:43], s36 offen offset:0 nt
v_add_f32_dpp v29, v26, v26 row_ror:8 row_mask:0xf bank_mask:0x3
v_dot2_f32_bf16 v24, v112, v20, 0
v_dot2_f32_bf16 v24, v113, v21, v24
v_dot2_f32_bf16 v24, v114, v22, v24
v_dot2_f32_bf16 v24, v115, v23, v24
v_add_f32_dpp v29, v27, v27 row_ror:8 row_mask:0xf bank_mask:0xc
s_waitcnt vmcnt(6)
buffer_load_dwordx4 v[84:87], v9, s[40:43], s36 offen offset:1024 nt
ds_add_u32 v192, v193 offset:256
v_add_f32_dpp v30, v28, v28 row_shl:4 row_mask:0xf bank_mask:0x5
v_dot2_f32_bf16 v25, v116, v20, 0
v_dot2_f32_bf16 v25, v117, v21, v25
v_dot2_f32_bf16 v25, v118, v22, v25
v_dot2_f32_bf16 v25, v119, v23, v25
v_add_f32_dpp v30, v29, v29 row_shr:4 row_mask:0xf bank_mask:0xa
s_waitcnt vmcnt(6)
buffer_load_dwordx4 v[88:91], v9, s[40:43], s36 offen offset:2048 nt
v_add_f32_dpp v28, v24, v24 row_ror:8 row_mask:0xf bank_mask:0x3
v_dot2_f32_bf16 v26, v120, v20, 0
v_dot2_f32_bf16 v26, v121, v21, v26
v_dot2_f32_bf16 v26, v122, v22, v26
v_dot2_f32_bf16 v26, v123, v23, v26
v_add_f32_dpp v28, v25, v25 row_ror:8 row_mask:0xf bank_mask:0xc
s_waitcnt vmcnt(6)
buffer_load_dwordx4 v[92:95], v9, s[40:43], s36 offen offset:3072 nt
ds_add_u32 v192, v193 offset:256
v_dot2_f32_bf16 v27, v124, v20, 0
v_dot2_f32_bf16 v27, v125, v21, v27
v_dot2_f32_bf16 v27, v126, v22, v27
v_dot2_f32_bf16 v27, v127, v23, v27
s_mov_b32 s38, 7
.p2align 6
L_A_ka:
s_cbranch_vccnz L_A_w1
s_waitcnt vmcnt(6)
L_A_w1:
s_waitcnt vmcnt(7)
s_add_u32 s36, s36, 0x18000
buffer_load_dwordx4 v[96:99], v8, s[40:43], s36 offen offset:0 nt
ds_read_b32 v194, v47 offset:8
v_add_f32_dpp v29, v26, v26 row_ror:8 row_mask:0xf bank_mask:0x3
v_dot2_f32_bf16 v24, v64, v16, 0
v_dot2_f32_bf16 v24, v65, v17, v24
v_dot2_f32_bf16 v24, v66, v18, v24
v_dot2_f32_bf16 v24, v67, v19, v24
v_add_f32_dpp v29, v27, v27 row_ror:8 row_mask:0xf bank_mask:0xc
s_cbranch_vccnz L_A_w2
s_waitcnt vmcnt(6)
L_A_w2:
s_waitcnt vmcnt(7)
buffer_load_dwordx4 v[100:103], v8, s[40:43], s36 offen offset:1024 nt
ds_add_u32 v192, v193 offset:256
s_waitcnt lgkmcnt(1)
v_cmp_ne_u32 vcc, 0, v194
v_add_f32_dpp v31, v28, v28 row_shl:4 row_mask:0xf bank_mask:0x5
v_dot2_f32_bf16 v25, v68, v16, 0
v_dot2_f32_bf16 v25, v69, v17, v25
v_dot2_f32_bf16 v25, v70, v18, v25
v_dot2_f32_bf16 v25, v71, v19, v25
v_add_f32_dpp v31, v29, v29 row_shr:4 row_mask:0xf bank_mask:0xa
s_cbranch_vccnz L_A_w3
s_waitcnt vmcnt(6)
L_A_w3:
s_waitcnt vmcnt(7)
buffer_load_dwordx4 v[104:107], v8, s[40:43], s36 offen offset:2048 nt
v_add_f32_dpp v34, v30, v30 quad_perm:[2,3,0,1] row_mask:0xf bank_mask:0xf
v_add_f32_dpp v28, v24, v24 row_ror:8 row_mask:0xf bank_mask:0x3
v_dot2_f32_bf16 v26, v72, v16, 0
v_dot2_f32_bf16 v26, v73, v17, v26
v_dot2_f32_bf16 v26, v74, v18, v26
v_dot2_f32_bf16 v26, v75, v19, v26
v_add_f32_dpp v35, v31, v31 quad_perm:[2,3,0,1] row_mask:0xf bank_mask:0xf
v_cndmask_b32 v33, v34, v35, s[48:49]
v_add_f32_dpp v28, v25, v25 row_ror:8 row_mask:0xf bank_mask:0xc
s_cbranch_vccnz L_A_w4
s_waitcnt vmcnt(6)
L_A_w4:
s_waitcnt vmcnt(7)
buffer_load_dwordx4 v[108:111], v8, s[40:43], s36 offen offset:3072 nt
ds_add_u32 v192, v193 offset:256
v_add_f32_dpp v34, v32, v32 quad_perm:[1,0,3,2] row_mask:0xf bank_mask:0xf
v_mov_b32 v36, v37
v_mov_b32 v37, v38
v_mov_b32 v38, v39
v_mov_b32 v39, v40
v_mov_b32 v40, v41
v_mov_b32 v41, v42
v_mov_b32 v42, v43
v_mov_b32 v43, v44
v_mov_b32 v44, v45
v_mov_b32 v45, v46
v_dot2_f32_bf16 v27, v76, v16, 0
v_dot2_f32_bf16 v27, v77, v17, v27
v_dot2_f32_bf16 v27, v78, v18, v27
v_dot2_f32_bf16 v27, v79, v19, v27
v_add_f32_dpp v35, v33, v33 quad_perm:[1,0,3,2] row_mask:0xf bank_mask:0xf
v_cndmask_b32 v46, v34, v35, s[50:51]
s_cbranch_vccnz L_A_w5
s_waitcnt vmcnt(6)
L_A_w5:
s_waitcnt vmcnt(7)
buffer_load_dwordx4 v[112:115], v9, s[40:43], s36 offen offset:0 nt
v_add_f32_dpp v29, v26, v26 row_ror:8 row_mask:0xf bank_mask:0x3
v_dot2_f32_bf16 v24, v80, v20, 0
v_dot2_f32_bf16 v24, v81, v21, v24
v_dot2_f32_bf16 v24, v82, v22, v24
v_dot2_f32_bf16 v24, v83, v23, v24
v_add_f32_dpp v29, v27, v27 row_ror:8 row_mask:0xf bank_mask:0xc
s_cbranch_vccnz L_A_w6
s_waitcnt vmcnt(6)
L_A_w6:
s_waitcnt vmcnt(7)
buffer_load_dwordx4 v[116:119], v9, s[40:43], s36 offen offset:1024 nt
ds_add_u32 v192, v193 offset:256
v_add_f32_dpp v30, v28, v28 row_shl:4 row_mask:0xf bank_mask:0x5
v_dot2_f32_bf16 v25, v84, v20, 0
v_dot2_f32_bf16 v25, v85, v21, v25
v_dot2_f32_bf16 v25, v86, v22, v25
v_dot2_f32_bf16 v25, v87, v23, v25
v_add_f32_dpp v30, v29, v29 row_shr:4 row_mask:0xf bank_mask:0xa
s_cbranch_vccnz L_A_w7
s_waitcnt vmcnt(6)
L_A_w7:
s_waitcnt vmcnt(7)
buffer_load_dwordx4 v[120:123], v9, s[40:43], s36 offen offset:2048 nt
v_add_f32_dpp v28, v24, v24 row_ror:8 row_mask:0xf bank_mask:0x3
v_dot2_f32_bf16 v26, v88, v20, 0
v_dot2_f32_bf16 v26, v89, v21, v26
v_dot2_f32_bf16 v26, v90, v22, v26
v_dot2_f32_bf16 v26, v91, v23, v26
v_add_f32_dpp v28, v25, v25 row_ror:8 row_mask:0xf bank_mask:0xc
s_cbranch_vccnz L_A_w8
s_waitcnt vmcnt(6)
L_A_w8:
s_waitcnt vmcnt(7)
buffer_load_dwordx4 v[124:127], v9, s[40:43], s36 offen offset:3072 nt
ds_add_u32 v192, v193 offset:256
v_dot2_f32_bf16 v27, v92, v20, 0
v_dot2_f32_bf16 v27, v93, v21, v27
v_dot2_f32_bf16 v27, v94, v22, v27
v_dot2_f32_bf16 v27, v95, v23, v27
s_cbranch_vccnz L_A_w9
s_waitcnt vmcnt(6)
L_A_w9:
s_waitcnt vmcnt(7)
s_add_u32 s36, s36, 0x18000
buffer_load_dwordx4 v[64:67], v8, s[40:43], s36 offen offset:0 nt
ds_read_b32 v194, v47 offset:8
v_add_f32_dpp v29, v26, v26 row_ror:8 row_mask:0xf bank_mask:0x3
v_dot2_f32_bf16 v24, v96, v16, 0
v_dot2_f32_bf16 v24, v97, v17, v24
v_dot2_f32_bf16 v24, v98, v18, v24
v_dot2_f32_bf16 v24, v99, v19, v24
v_add_f32_dpp v29, v27, v27 row_ror:8 row_mask:0xf bank_mask:0xc
s_cbranch_vccnz L_A_w10
s_waitcnt vmcnt(6)
L_A_w10:
s_waitcnt vmcnt(7)
buffer_load_dwordx4 v[68:71], v8, s[40:43], s36 offen offset:1024 nt
ds_add_u32 v192, v193 offset:256
s_waitcnt lgkmcnt(1)
v_cmp_ne_u32 vcc, 0, v194
v_add_f32_dpp v31, v28, v28 row_shl:4 row_mask:0xf bank_mask:0x5
v_dot2_f32_bf16 v25, v100, v16, 0
v_dot2_f32_bf16 v25, v101, v17, v25
v_dot2_f32_bf16 v25, v102, v18, v25
v_dot2_f32_bf16 v25, v103, v19, v25
v_add_f32_dpp v31, v29, v29 row_shr:4 row_mask:0xf bank_mask:0xa
s_cbranch_vccnz L_A_w11
s_waitcnt vmcnt(6)
L_A_w11:
s_waitcnt vmcnt(7)
buffer_load_dwordx4 v[72:75], v8, s[40:43], s36 offen offset:2048 nt
v_add_f32_dpp v34, v30, v30 quad_perm:[2,3,0,1] row_mask:0xf bank_mask:0xf
v_add_f32_dpp v28, v24, v24 row_ror:8 row_mask:0xf bank_mask:0x3
v_dot2_f32_bf16 v26, v104, v16, 0
v_dot2_f32_bf16 v26, v105, v17, v26
v_dot2_f32_bf16 v26, v106, v18, v26
v_dot2_f32_bf16 v26, v107, v19, v26
v_add_f32_dpp v35, v31, v31 quad_perm:[2,3,0,1] row_mask:0xf bank_mask:0xf
v_cndmask_b32 v32, v34, v35, s[48:49]
v_add_f32_dpp v28, v25, v25 row_ror:8 row_mask:0xf bank_mask:0xc
s_cbranch_vccnz L_A_w12
s_waitcnt vmcnt(6)
L_A_w12:
s_waitcnt vmcnt(7)
buffer_load_dwordx4 v[76:79], v8, s[40:43], s36 offen offset:3072 nt
ds_add_u32 v192, v193 offset:256
v_dot2_f32_bf16 v27, v108, v16, 0
v_dot2_f32_bf16 v27, v109, v17, v27
v_dot2_f32_bf16 v27, v110, v18, v27
v_dot2_f32_bf16 v27, v111, v19, v27
s_cbranch_vccnz L_A_w13
s_waitcnt vmcnt(6)
L_A_w13:
s_waitcnt vmcnt(7)
buffer_load_dwordx4 v[80:83], v9, s[40:43], s36 offen offset:0 nt
v_add_f32_dpp v29, v26, v26 row_ror:8 row_mask:0xf bank_mask:0x3
v_dot2_f32_bf16 v24, v112, v20, 0
v_dot2_f32_bf16 v24, v113, v21, v24
v_dot2_f32_bf16 v24, v114, v22, v24
v_dot2_f32_bf16 v24, v115, v23, v24
v_add_f32_dpp v29, v27, v27 row_ror:8 row_mask:0xf bank_mask:0xc
s_cbranch_vccnz L_A_w14
s_waitcnt vmcnt(6)
L_A_w14:
s_waitcnt vmcnt(7)
buffer_load_dwordx4 v[84:87], v9, s[40:43], s36 offen offset:1024 nt
ds_add_u32 v192, v193 offset:256
v_add_f32_dpp v30, v28, v28 row_shl:4 row_mask:0xf bank_mask:0x5
v_dot2_f32_bf16 v25, v116, v20, 0
v_dot2_f32_bf16 v25, v117, v21, v25
v_dot2_f32_bf16 v25, v118, v22, v25
v_dot2_f32_bf16 v25, v119, v23, v25
v_add_f32_dpp v30, v29, v29 row_shr:4 row_mask:0xf bank_mask:0xa
s_cbranch_vccnz L_A_w15
s_waitcnt vmcnt(6)
L_A_w15:
s_waitcnt vmcnt(7)
buffer_load_dwordx4 v[88:91], v9, s[40:43], s36 offen offset:2048 nt
v_add_f32_dpp v28, v24, v24 row_ror:8 row_mask:0xf bank_mask:0x3
v_dot2_f32_bf16 v26, v120, v20, 0
v_dot2_f32_bf16 v26, v121, v21, v26
v_dot2_f32_bf16 v26, v122, v22, v26
v_dot2_f32_bf16 v26, v123, v23, v26
v_add_f32_dpp v28, v25, v25 row_ror:8 row_mask:0xf bank_mask:0xc
s_cbranch_vccnz L_A_w16
s_waitcnt vmcnt(6)
L_A_w16:
s_waitcnt vmcnt(7)
buffer_load_dwordx4 v[92:95], v9, s[40:43], s36 offen offset:3072 nt
ds_add_u32 v192, v193 offset:256
v_dot2_f32_bf16 v27, v124, v20, 0
v_dot2_f32_bf16 v27, v125, v21, v27
v_dot2_f32_bf16 v27, v126, v22, v27
v_dot2_f32_bf16 v27, v127, v23, v27
s_sub_u32 s38, s38, 1
s_cmp_lg_u32 s38, 0
s_cbranch_scc1 L_A_ka
s_cbranch_vccnz L_A_w17
s_waitcnt vmcnt(5)
L_A_w17:
s_waitcnt vmcnt(7)
buffer_load_dwordx4 v[96:99], v8, s[40:43], s37 offen nt
v_add_f32_dpp v29, v26, v26 row_ror:8 row_mask:0xf bank_mask:0x3
v_dot2_f32_bf16 v24, v64, v16, 0
v_dot2_f32_bf16 v24, v65, v17, v24
v_dot2_f32_bf16 v24, v66, v18, v24
v_dot2_f32_bf16 v24, v67, v19, v24
v_add_f32_dpp v29, v27, v27 row_ror:8 row_mask:0xf bank_mask:0xc
s_cbranch_vccnz L_A_w18
s_waitcnt vmcnt(5)
L_A_w18:
s_waitcnt vmcnt(7)
buffer_load_dwordx4 v[100:103], v10, s[40:43], s37 offen nt
ds_add_u32 v192, v193 offset:256
v_add_f32_dpp v31, v28, v28 row_shl:4 row_mask:0xf bank_mask:0x5
v_dot2_f32_bf16 v25, v68, v16, 0
v_dot2_f32_bf16 v25, v69, v17, v25
v_dot2_f32_bf16 v25, v70, v18, v25
v_dot2_f32_bf16 v25, v71, v19, v25
v_add_f32_dpp v31, v29, v29 row_shr:4 row_mask:0xf bank_mask:0xa
s_cbranch_vccnz L_A_w19
s_waitcnt vmcnt(5)
L_A_w19:
s_waitcnt vmcnt(7)
buffer_load_dwordx4 v[104:107], v9, s[40:43], s37 offen nt
v_add_f32_dpp v34, v30, v30 quad_perm:[2,3,0,1] row_mask:0xf bank_mask:0xf
v_add_f32_dpp v28, v24, v24 row_ror:8 row_mask:0xf bank_mask:0x3
v_dot2_f32_bf16 v26, v72, v16, 0
v_dot2_f32_bf16 v26, v73, v17, v26
v_dot2_f32_bf16 v26, v74, v18, v26
v_dot2_f32_bf16 v26, v75, v19, v26
v_add_f32_dpp v35, v31, v31 quad_perm:[2,3,0,1] row_mask:0xf bank_mask:0xf
v_cndmask_b32 v33, v34, v35, s[48:49]
v_add_f32_dpp v28, v25, v25 row_ror:8 row_mask:0xf bank_mask:0xc
s_cbranch_vccnz L_A_w20
s_waitcnt vmcnt(5)
L_A_w20:
s_waitcnt vmcnt(7)
buffer_load_dwordx4 v[108:111], v11, s[40:43], s37 offen nt
ds_add_u32 v192, v193 offset:256
v_add_f32_dpp v34, v32, v32 quad_perm:[1,0,3,2] row_mask:0xf bank_mask:0xf
v_mov_b32 v36, v37
v_mov_b32 v37, v38
v_mov_b32 v38, v39
v_mov_b32 v39, v40
v_mov_b32 v40, v41
v_mov_b32 v41, v42
v_mov_b32 v42, v43
v_mov_b32 v43, v44
v_mov_b32 v44, v45
v_mov_b32 v45, v46
v_dot2_f32_bf16 v27, v76, v16, 0
v_dot2_f32_bf16 v27, v77, v17, v27
v_dot2_f32_bf16 v27, v78, v18, v27
v_dot2_f32_bf16 v27, v79, v19, v27
v_add_f32_dpp v35, v33, v33 quad_perm:[1,0,3,2] row_mask:0xf bank_mask:0xf
v_cndmask_b32 v46, v34, v35, s[50:51]
s_cbranch_vccnz L_A_w21
s_waitcnt vmcnt(5)
L_A_w21:
s_waitcnt vmcnt(7)
s_mov_b32 s36, s35
buffer_load_dwordx4 v[112:115], v8, s[44:47], s36 offen offset:0 nt
v_add_f32_dpp v29, v26, v26 row_ror:8 row_mask:0xf bank_mask:0x3
v_dot2_f32_bf16 v24, v80, v20, 0
v_dot2_f32_bf16 v24, v81, v21, v24
v_dot2_f32_bf16 v24, v82, v22, v24
v_dot2_f32_bf16 v24, v83, v23, v24
v_add_f32_dpp v29, v27, v27 row_ror:8 row_mask:0xf bank_mask:0xc
s_cbranch_vccnz L_A_w22
s_waitcnt vmcnt(5)
L_A_w22:
s_waitcnt vmcnt(7)
buffer_load_dwordx4 v[116:119], v8, s[44:47], s36 offen offset:1024 nt
ds_add_u32 v192, v193 offset:256
v_add_f32_dpp v30, v28, v28 row_shl:4 row_mask:0xf bank_mask:0x5
v_dot2_f32_bf16 v25, v84, v20, 0
v_dot2_f32_bf16 v25, v85, v21, v25
v_dot2_f32_bf16 v25, v86, v22, v25
v_dot2_f32_bf16 v25, v87, v23, v25
v_add_f32_dpp v30, v29, v29 row_shr:4 row_mask:0xf bank_mask:0xa
s_cbranch_vccnz L_A_w23
s_waitcnt vmcnt(5)
L_A_w23:
s_waitcnt vmcnt(7)
buffer_load_dwordx4 v[120:123], v8, s[44:47], s36 offen offset:2048 nt
v_add_f32_dpp v28, v24, v24 row_ror:8 row_mask:0xf bank_mask:0x3
v_dot2_f32_bf16 v26, v88, v20, 0
v_dot2_f32_bf16 v26, v89, v21, v26
v_dot2_f32_bf16 v26, v90, v22, v26
v_dot2_f32_bf16 v26, v91, v23, v26
v_add_f32_dpp v28, v25, v25 row_ror:8 row_mask:0xf bank_mask:0xc
s_cbranch_vccnz L_A_w24
s_waitcnt vmcnt(5)
L_A_w24:
s_waitcnt vmcnt(7)
buffer_load_dwordx4 v[124:127], v8, s[44:47], s36 offen offset:3072 nt
ds_add_u32 v192, v193 offset:256
v_dot2_f32_bf16 v27, v92, v20, 0
v_dot2_f32_bf16 v27, v93, v21, v27
v_dot2_f32_bf16 v27, v94, v22, v27
v_dot2_f32_bf16 v27, v95, v23, v27
s_cbranch_vccnz L_A_w25
s_waitcnt vmcnt(5)
L_A_w25:
s_waitcnt vmcnt(7)
buffer_load_dwordx4 v[64:67], v9, s[44:47], s36 offen offset:0 nt
v_add_f32_dpp v29, v26, v26 row_ror:8 row_mask:0xf bank_mask:0x3
v_dot2_f32_bf16 v24, v96, v16, 0
v_dot2_f32_bf16 v24, v97, v17, v24
v_dot2_f32_bf16 v24, v98, v18, v24
v_dot2_f32_bf16 v24, v99, v19, v24
v_add_f32_dpp v29, v27, v27 row_ror:8 row_mask:0xf bank_mask:0xc
s_cbranch_vccnz L_A_w26
s_waitcnt vmcnt(5)
L_A_w26:
s_waitcnt vmcnt(7)
buffer_load_dwordx4 v[68:71], v9, s[44:47], s36 offen offset:1024 nt
ds_add_u32 v192, v193 offset:256
v_add_f32_dpp v31, v28, v28 row_shl:4 row_mask:0xf bank_mask:0x5
v_dot2_f32_bf16 v25, v100, v16, 0
v_dot2_f32_bf16 v25, v101, v17, v25
v_dot2_f32_bf16 v25, v102, v18, v25
v_dot2_f32_bf16 v25, v103, v19, v25
v_add_f32_dpp v31, v29, v29 row_shr:4 row_mask:0xf bank_mask:0xa
s_cbranch_vccnz L_A_w27
s_waitcnt vmcnt(5)
L_A_w27:
s_waitcnt vmcnt(7)
buffer_load_dwordx4 v[72:75], v9, s[44:47], s36 offen offset:2048 nt
v_add_f32_dpp v34, v30, v30 quad_perm:[2,3,0,1] row_mask:0xf bank_mask:0xf
v_add_f32_dpp v28, v24, v24 row_ror:8 row_mask:0xf bank_mask:0x3
v_dot2_f32_bf16 v26, v104, v20, 0
v_dot2_f32_bf16 v26, v105, v21, v26
v_dot2_f32_bf16 v26, v106, v22, v26
v_dot2_f32_bf16 v26, v107, v23, v26
v_add_f32_dpp v35, v31, v31 quad_perm:[2,3,0,1] row_mask:0xf bank_mask:0xf
v_cndmask_b32 v32, v34, v35, s[48:49]
v_add_f32_dpp v28, v25, v25 row_ror:8 row_mask:0xf bank_mask:0xc
s_cbranch_vccnz L_A_w28
s_waitcnt vmcnt(5)
L_A_w28:
s_waitcnt vmcnt(7)
buffer_load_dwordx4 v[76:79], v9, s[44:47], s36 offen offset:3072 nt
ds_add_u32 v192, v193 offset:256
v_dot2_f32_bf16 v27, v108, v20, 0
v_dot2_f32_bf16 v27, v109, v21, v27
v_dot2_f32_bf16 v27, v110, v22, v27
v_dot2_f32_bf16 v27, v111, v23, v27
v_add_f32_dpp v30, v28, v28 row_shl:4 row_mask:0xf bank_mask:0x5
s_nop 2
v_add_f32_dpp v28, v26, v26 row_ror:8 row_mask:0xf bank_mask:0x3
s_nop 1
v_add_f32_dpp v28, v27, v27 row_ror:8 row_mask:0xf bank_mask:0xc
s_nop 2
s_nop 1
v_add_f32_dpp v31, v28, v28 row_shl:4 row_mask:0xf bank_mask:0x5
s_nop 2
v_add_f32_dpp v34, v30, v30 quad_perm:[2,3,0,1] row_mask:0xf bank_mask:0xf
s_nop 1
v_add_f32_dpp v35, v31, v31 quad_perm:[2,3,0,1] row_mask:0xf bank_mask:0xf
v_cndmask_b32 v33, v34, v35, s[48:49]
s_nop 2
v_add_f32_dpp v34, v32, v32 quad_perm:[1,0,3,2] row_mask:0xf bank_mask:0xf
v_mov_b32 v36, v37
v_mov_b32 v37, v38
v_mov_b32 v38, v39
v_mov_b32 v39, v40
v_mov_b32 v40, v41
v_mov_b32 v41, v42
v_mov_b32 v42, v43
v_mov_b32 v43, v44
v_mov_b32 v44, v45
v_mov_b32 v45, v46
s_nop 1
v_add_f32_dpp v35, v33, v33 quad_perm:[1,0,3,2] row_mask:0xf bank_mask:0xf
v_cndmask_b32 v46, v34, v35, s[50:51]
v_mov_b32 v60, 0xff800000
v_cndmask_b32 v46, v60, v46, s[52:53]
v_max3_f32 v60, v36, v37, v38
v_max3_f32 v60, v60, v39, v40
v_max3_f32 v60, v60, v41, v42
v_max3_f32 v60, v60, v43, v44
v_max3_f32 v60, v60, v45, v46
s_waitcnt vmcnt(5)
s_add_u32 s36, s36, 0x18000
buffer_load_dwordx4 v[80:83], v8, s[44:47], s36 offen offset:0 nt
s_nop 1
v_max_f32_dpp v60, v60, v60 quad_perm:[1,0,3,2] row_mask:0xf bank_mask:0xf
s_nop 1
v_max_f32_dpp v60, v60, v60 row_ror:4 row_mask:0xf bank_mask:0xf
s_nop 1
v_max_f32_dpp v60, v60, v60 row_ror:8 row_mask:0xf bank_mask:0xf
v_mov_b32 v34, v60
s_nop 1
v_permlane16_swap_b32 v60, v34
s_nop 0
v_max_f32 v60, v60, v34
v_mov_b32 v34, v60
s_nop 1
v_permlane32_swap_b32 v60, v34
s_nop 0
v_max_f32 v60, v60, v34
s_mov_b32 s62, 0x3e0293ee
v_mul_f32 v60, s62, v60
s_waitcnt vmcnt(5)
buffer_load_dwordx4 v[84:87], v8, s[44:47], s36 offen offset:1024 nt
ds_add_u32 v192, v193 offset:256
v_fma_f32 v36, v36, s62, -v60
v_fma_f32 v37, v37, s62, -v60
v_fma_f32 v38, v38, s62, -v60
v_fma_f32 v39, v39, s62, -v60
v_fma_f32 v40, v40, s62, -v60
v_fma_f32 v41, v41, s62, -v60
v_fma_f32 v42, v42, s62, -v60
v_fma_f32 v43, v43, s62, -v60
v_fma_f32 v44, v44, s62, -v60
v_fma_f32 v45, v45, s62, -v60
v_fma_f32 v46, v46, s62, -v60
v_exp_f32 v36, v36
v_exp_f32 v37, v37
v_exp_f32 v38, v38
v_exp_f32 v39, v39
v_exp_f32 v40, v40
v_exp_f32 v41, v41
v_exp_f32 v42, v42
v_exp_f32 v43, v43
v_exp_f32 v44, v44
v_exp_f32 v45, v45
v_exp_f32 v46, v46
s_waitcnt vmcnt(5)
buffer_load_dwordx4 v[88:91], v8, s[44:47], s36 offen offset:2048 nt
v_add_f32 v61, v36, v37
v_add_f32 v61, v61, v38
v_add_f32 v61, v61, v39
v_add_f32 v61, v61, v40
v_add_f32 v61, v61, v41
v_add_f32 v61, v61, v42
v_add_f32 v61, v61, v43
v_add_f32 v61, v61, v44
v_add_f32 v61, v61, v45
v_add_f32 v61, v61, v46
v_cvt_pk_bf16_f32 v36, v36, v36
v_cvt_pk_bf16_f32 v37, v37, v37
v_cvt_pk_bf16_f32 v38, v38, v38
v_cvt_pk_bf16_f32 v39, v39, v39
v_cvt_pk_bf16_f32 v40, v40, v40
v_cvt_pk_bf16_f32 v41, v41, v41
v_cvt_pk_bf16_f32 v42, v42, v42
v_cvt_pk_bf16_f32 v43, v43, v43
v_cvt_pk_bf16_f32 v44, v44, v44
v_cvt_pk_bf16_f32 v45, v45, v45
v_cvt_pk_bf16_f32 v46, v46, v46
s_waitcnt vmcnt(5)
buffer_load_dwordx4 v[92:95], v8, s[44:47], s36 offen offset:3072 nt
ds_add_u32 v192, v193 offset:256
s_nop 1
v_add_f32_dpp v61, v61, v61 quad_perm:[1,0,3,2] row_mask:0xf bank_mask:0xf
s_nop 1
v_add_f32_dpp v61, v61, v61 row_ror:4 row_mask:0xf bank_mask:0xf
s_nop 1
v_add_f32_dpp v61, v61, v61 row_ror:8 row_mask:0xf bank_mask:0xf
v_mov_b32 v34, v61
s_nop 1
v_permlane16_swap_b32 v61, v34
s_nop 0
v_add_f32 v61, v61, v34
v_mov_b32 v34, v61
s_nop 1
v_permlane32_swap_b32 v61, v34
s_nop 0
v_add_f32 v61, v61, v34
s_lshl_b32 s62, s34, 2
v_lshl_add_u32 v62, v1, 3, s62
v_mov_b32 v63, 1
s_mov_b64 exec, 5
ds_write_b32 v62, v60 offset:64
ds_write_b32 v62, v61 offset:96
s_mov_b64 exec, 1
ds_add_u32 v47, v63 offset:4
s_mov_b64 exec, -1
v_and_b32_dpp v52, v36, v4 row_newbcast:0 row_mask:0xf bank_mask:0xf
v_and_b32_dpp v53, v36, v5 row_newbcast:0 row_mask:0xf bank_mask:0xf
v_and_b32_dpp v54, v36, v6 row_newbcast:0 row_mask:0xf bank_mask:0xf
v_and_b32_dpp v55, v36, v7 row_newbcast:0 row_mask:0xf bank_mask:0xf
s_mov_b32 s38, 9
.p2align 6
L_A_va:
s_cbranch_vccnz L_A_w29
s_waitcnt vmcnt(5)
L_A_w29:
s_waitcnt vmcnt(7)
buffer_load_dwordx4 v[96:99], v9, s[44:47], s36 offen offset:0 nt
v_mfma_f32_16x16x32_bf16 v[48:51], v[52:55], v[112:115], v[48:51]
ds_read_b32 v194, v47 offset:8
v_and_b32_dpp v56, v36, v4 row_newbcast:8 row_mask:0xf bank_mask:0xf
v_and_b32_dpp v57, v36, v5 row_newbcast:8 row_mask:0xf bank_mask:0xf
v_and_b32_dpp v58, v36, v6 row_newbcast:8 row_mask:0xf bank_mask:0xf
v_and_b32_dpp v59, v36, v7 row_newbcast:8 row_mask:0xf bank_mask:0xf
s_cbranch_vccnz L_A_w30
s_waitcnt vmcnt(5)
L_A_w30:
s_waitcnt vmcnt(7)
buffer_load_dwordx4 v[100:103], v9, s[44:47], s36 offen offset:1024 nt
ds_add_u32 v192, v193 offset:256
v_mfma_f32_16x16x32_bf16 v[48:51], v[56:59], v[116:119], v[48:51]
s_waitcnt lgkmcnt(1)
v_cmp_ne_u32 vcc, 0, v194
v_and_b32_dpp v52, v36, v4 row_newbcast:4 row_mask:0xf bank_mask:0xf
v_and_b32_dpp v53, v36, v5 row_newbcast:4 row_mask:0xf bank_mask:0xf
v_and_b32_dpp v54, v36, v6 row_newbcast:4 row_mask:0xf bank_mask:0xf
v_and_b32_dpp v55, v36, v7 row_newbcast:4 row_mask:0xf bank_mask:0xf
s_cbranch_vccnz L_A_w31
s_waitcnt vmcnt(5)
L_A_w31:
s_waitcnt vmcnt(7)
buffer_load_dwordx4 v[104:107], v9, s[44:47], s36 offen offset:2048 nt
v_mfma_f32_16x16x32_bf16 v[48:51], v[52:55], v[120:123], v[48:51]
v_and_b32_dpp v56, v36, v4 row_newbcast:12 row_mask:0xf bank_mask:0xf
v_and_b32_dpp v57, v36, v5 row_newbcast:12 row_mask:0xf bank_mask:0xf
v_and_b32_dpp v58, v36, v6 row_newbcast:12 row_mask:0xf bank_mask:0xf
v_and_b32_dpp v59, v36, v7 row_newbcast:12 row_mask:0xf bank_mask:0xf
s_cbranch_vccnz L_A_w32
s_waitcnt vmcnt(5)
L_A_w32:
s_waitcnt vmcnt(7)
buffer_load_dwordx4 v[108:111], v9, s[44:47], s36 offen offset:3072 nt
ds_add_u32 v192, v193 offset:256
v_mfma_f32_16x16x32_bf16 v[48:51], v[56:59], v[124:127], v[48:51]
v_and_b32_dpp v52, v36, v12 row_newbcast:2 row_mask:0xf bank_mask:0xf
v_and_b32_dpp v53, v36, v13 row_newbcast:2 row_mask:0xf bank_mask:0xf
v_and_b32_dpp v54, v36, v14 row_newbcast:2 row_mask:0xf bank_mask:0xf
v_and_b32_dpp v55, v36, v15 row_newbcast:2 row_mask:0xf bank_mask:0xf
s_cbranch_vccnz L_A_w33
s_waitcnt vmcnt(5)
L_A_w33:
s_waitcnt vmcnt(7)
s_add_u32 s36, s36, 0x18000
buffer_load_dwordx4 v[112:115], v8, s[44:47], s36 offen offset:0 nt
v_mfma_f32_16x16x32_bf16 v[48:51], v[52:55], v[64:67], v[48:51]
v_and_b32_dpp v56, v36, v12 row_newbcast:10 row_mask:0xf bank_mask:0xf
v_and_b32_dpp v57, v36, v13 row_newbcast:10 row_mask:0xf bank_mask:0xf
v_and_b32_dpp v58, v36, v14 row_newbcast:10 row_mask:0xf bank_mask:0xf
v_and_b32_dpp v59, v36, v15 row_newbcast:10 row_mask:0xf bank_mask:0xf
s_cbranch_vccnz L_A_w34
s_waitcnt vmcnt(5)
L_A_w34:
s_waitcnt vmcnt(7)
buffer_load_dwordx4 v[116:119], v8, s[44:47], s36 offen offset:1024 nt
ds_add_u32 v192, v193 offset:256
v_mfma_f32_16x16x32_bf16 v[48:51], v[56:59], v[68:71], v[48:51]
v_and_b32_dpp v52, v36, v12 row_newbcast:6 row_mask:0xf bank_mask:0xf
v_and_b32_dpp v53, v36, v13 row_newbcast:6 row_mask:0xf bank_mask:0xf
v_and_b32_dpp v54, v36, v14 row_newbcast:6 row_mask:0xf bank_mask:0xf
v_and_b32_dpp v55, v36, v15 row_newbcast:6 row_mask:0xf bank_mask:0xf
s_cbranch_vccnz L_A_w35
s_waitcnt vmcnt(5)
L_A_w35:
s_waitcnt vmcnt(7)
buffer_load_dwordx4 v[120:123], v8, s[44:47], s36 offen offset:2048 nt
v_mfma_f32_16x16x32_bf16 v[48:51], v[52:55], v[72:75], v[48:51]
v_and_b32_dpp v56, v36, v12 row_newbcast:14 row_mask:0xf bank_mask:0xf
v_and_b32_dpp v57, v36, v13 row_newbcast:14 row_mask:0xf bank_mask:0xf
v_and_b32_dpp v58, v36, v14 row_newbcast:14 row_mask:0xf bank_mask:0xf
v_and_b32_dpp v59, v36, v15 row_newbcast:14 row_mask:0xf bank_mask:0xf
s_cbranch_vccnz L_A_w36
s_waitcnt vmcnt(5)
L_A_w36:
s_waitcnt vmcnt(7)
buffer_load_dwordx4 v[124:127], v8, s[44:47], s36 offen offset:3072 nt
ds_add_u32 v192, v193 offset:256
v_mfma_f32_16x16x32_bf16 v[48:51], v[56:59], v[76:79], v[48:51]
v_and_b32_dpp v52, v36, v4 row_newbcast:1 row_mask:0xf bank_mask:0xf
v_and_b32_dpp v53, v36, v5 row_newbcast:1 row_mask:0xf bank_mask:0xf
v_and_b32_dpp v54, v36, v6 row_newbcast:1 row_mask:0xf bank_mask:0xf
v_and_b32_dpp v55, v36, v7 row_newbcast:1 row_mask:0xf bank_mask:0xf
s_cbranch_vccnz L_A_w37
s_waitcnt vmcnt(5)
L_A_w37:
s_waitcnt vmcnt(7)
buffer_load_dwordx4 v[64:67], v9, s[44:47], s36 offen offset:0 nt
v_mfma_f32_16x16x32_bf16 v[48:51], v[52:55], v[80:83], v[48:51]
ds_read_b32 v194, v47 offset:8
v_and_b32_dpp v56, v36, v4 row_newbcast:9 row_mask:0xf bank_mask:0xf
v_and_b32_dpp v57, v36, v5 row_newbcast:9 row_mask:0xf bank_mask:0xf
v_and_b32_dpp v58, v36, v6 row_newbcast:9 row_mask:0xf bank_mask:0xf
v_and_b32_dpp v59, v36, v7 row_newbcast:9 row_mask:0xf bank_mask:0xf
s_cbranch_vccnz L_A_w38
s_waitcnt vmcnt(5)
L_A_w38:
s_waitcnt vmcnt(7)
buffer_load_dwordx4 v[68:71], v9, s[44:47], s36 offen offset:1024 nt
ds_add_u32 v192, v193 offset:256
v_mfma_f32_16x16x32_bf16 v[48:51], v[56:59], v[84:87], v[48:51]
s_waitcnt lgkmcnt(1)
v_cmp_ne_u32 vcc, 0, v194
v_and_b32_dpp v52, v36, v4 row_newbcast:5 row_mask:0xf bank_mask:0xf
v_and_b32_dpp v53, v36, v5 row_newbcast:5 row_mask:0xf bank_mask:0xf
v_and_b32_dpp v54, v36, v6 row_newbcast:5 row_mask:0xf bank_mask:0xf
v_and_b32_dpp v55, v36, v7 row_newbcast:5 row_mask:0xf bank_mask:0xf
s_cbranch_vccnz L_A_w39
s_waitcnt vmcnt(5)
L_A_w39:
s_waitcnt vmcnt(7)
buffer_load_dwordx4 v[72:75], v9, s[44:47], s36 offen offset:2048 nt
v_mfma_f32_16x16x32_bf16 v[48:51], v[52:55], v[88:91], v[48:51]
v_and_b32_dpp v56, v36, v4 row_newbcast:13 row_mask:0xf bank_mask:0xf
v_and_b32_dpp v57, v36, v5 row_newbcast:13 row_mask:0xf bank_mask:0xf
v_and_b32_dpp v58, v36, v6 row_newbcast:13 row_mask:0xf bank_mask:0xf
v_and_b32_dpp v59, v36, v7 row_newbcast:13 row_mask:0xf bank_mask:0xf
s_cbranch_vccnz L_A_w40
s_waitcnt vmcnt(5)
L_A_w40:
s_waitcnt vmcnt(7)
buffer_load_dwordx4 v[76:79], v9, s[44:47], s36 offen offset:3072 nt
ds_add_u32 v192, v193 offset:256
v_mfma_f32_16x16x32_bf16 v[48:51], v[56:59], v[92:95], v[48:51]
v_and_b32_dpp v52, v36, v12 row_newbcast:3 row_mask:0xf bank_mask:0xf
v_and_b32_dpp v53, v36, v13 row_newbcast:3 row_mask:0xf bank_mask:0xf
v_and_b32_dpp v54, v36, v14 row_newbcast:3 row_mask:0xf bank_mask:0xf
v_and_b32_dpp v55, v36, v15 row_newbcast:3 row_mask:0xf bank_mask:0xf
s_cbranch_vccnz L_A_w41
s_waitcnt vmcnt(5)
L_A_w41:
s_waitcnt vmcnt(7)
s_add_u32 s36, s36, 0x18000
buffer_load_dwordx4 v[80:83], v8, s[44:47], s36 offen offset:0 nt
v_mfma_f32_16x16x32_bf16 v[48:51], v[52:55], v[96:99], v[48:51]
v_and_b32_dpp v56, v36, v12 row_newbcast:11 row_mask:0xf bank_mask:0xf
v_and_b32_dpp v57, v36, v13 row_newbcast:11 row_mask:0xf bank_mask:0xf
v_and_b32_dpp v58, v36, v14 row_newbcast:11 row_mask:0xf bank_mask:0xf
v_and_b32_dpp v59, v36, v15 row_newbcast:11 row_mask:0xf bank_mask:0xf
s_cbranch_vccnz L_A_w42
s_waitcnt vmcnt(5)
L_A_w42:
s_waitcnt vmcnt(7)
buffer_load_dwordx4 v[84:87], v8, s[44:47], s36 offen offset:1024 nt
ds_add_u32 v192, v193 offset:256
v_mfma_f32_16x16x32_bf16 v[48:51], v[56:59], v[100:103], v[48:51]
v_and_b32_dpp v52, v36, v12 row_newbcast:7 row_mask:0xf bank_mask:0xf
v_and_b32_dpp v53, v36, v13 row_newbcast:7 row_mask:0xf bank_mask:0xf
v_and_b32_dpp v54, v36, v14 row_newbcast:7 row_mask:0xf bank_mask:0xf
v_and_b32_dpp v55, v36, v15 row_newbcast:7 row_mask:0xf bank_mask:0xf
s_cbranch_vccnz L_A_w43
s_waitcnt vmcnt(5)
L_A_w43:
s_waitcnt vmcnt(7)
buffer_load_dwordx4 v[88:91], v8, s[44:47], s36 offen offset:2048 nt
v_mfma_f32_16x16x32_bf16 v[48:51], v[52:55], v[104:107], v[48:51]
v_and_b32_dpp v56, v36, v12 row_newbcast:15 row_mask:0xf bank_mask:0xf
v_and_b32_dpp v57, v36, v13 row_newbcast:15 row_mask:0xf bank_mask:0xf
v_and_b32_dpp v58, v36, v14 row_newbcast:15 row_mask:0xf bank_mask:0xf
v_and_b32_dpp v59, v36, v15 row_newbcast:15 row_mask:0xf bank_mask:0xf
s_cbranch_vccnz L_A_w44
s_waitcnt vmcnt(5)
L_A_w44:
s_waitcnt vmcnt(7)
buffer_load_dwordx4 v[92:95], v8, s[44:47], s36 offen offset:3072 nt
ds_add_u32 v192, v193 offset:256
v_mfma_f32_16x16x32_bf16 v[48:51], v[56:59], v[108:111], v[48:51]
v_mov_b32 v36, v37
v_mov_b32 v37, v38
v_mov_b32 v38, v39
v_mov_b32 v39, v40
v_mov_b32 v40, v41
v_mov_b32 v41, v42
v_mov_b32 v42, v43
v_mov_b32 v43, v44
v_mov_b32 v44, v45
v_mov_b32 v45, v46
v_and_b32_dpp v52, v36, v4 row_newbcast:0 row_mask:0xf bank_mask:0xf
v_and_b32_dpp v53, v36, v5 row_newbcast:0 row_mask:0xf bank_mask:0xf
v_and_b32_dpp v54, v36, v6 row_newbcast:0 row_mask:0xf bank_mask:0xf
v_and_b32_dpp v55, v36, v7 row_newbcast:0 row_mask:0xf bank_mask:0xf
s_sub_u32 s38, s38, 1
s_cmp_lg_u32 s38, 0
s_cbranch_scc1 L_A_va
s_waitcnt vmcnt(8)
buffer_load_dwordx4 v[96:99], v9, s[44:47], s36 offen offset:0 nt
v_mfma_f32_16x16x32_bf16 v[48:51], v[52:55], v[112:115], v[48:51]
v_and_b32_dpp v56, v36, v4 row_newbcast:8 row_mask:0xf bank_mask:0xf
v_and_b32_dpp v57, v36, v5 row_newbcast:8 row_mask:0xf bank_mask:0xf
v_and_b32_dpp v58, v36, v6 row_newbcast:8 row_mask:0xf bank_mask:0xf
v_and_b32_dpp v59, v36, v7 row_newbcast:8 row_mask:0xf bank_mask:0xf
s_mov_b32 s64, 0
L_A_sw:
ds_read_b32 v60, v47 offset:4
s_waitcnt lgkmcnt(0)
v_readfirstlane_b32 s65, v60
s_add_u32 s64, s64, 1
s_nop 2
s_cmp_ge_u32 s65, 4
s_cbranch_scc1 L_A_sw_ok
s_sleep 1
s_cmp_lt_u32 s64, 1048576
s_cbranch_scc1 L_A_sw
L_A_sw_ok:
v_lshrrev_b32 v60, 1, v3
v_lshlrev_b32 v60, 4, v60
s_lshl_b32 s62, s34, 2
v_add_u32 v61, s62, v60
ds_read_b128 v[24:27], v60 offset:64
ds_read_b32 v63, v61 offset:64
s_waitcnt vmcnt(8)
buffer_load_dwordx4 v[100:103], v9, s[44:47], s36 offen offset:1024 nt
ds_add_u32 v192, v193 offset:256
v_mfma_f32_16x16x32_bf16 v[48:51], v[56:59], v[116:119], v[48:51]
v_and_b32_dpp v52, v36, v4 row_newbcast:4 row_mask:0xf bank_mask:0xf
v_and_b32_dpp v53, v36, v5 row_newbcast:4 row_mask:0xf bank_mask:0xf
v_and_b32_dpp v54, v36, v6 row_newbcast:4 row_mask:0xf bank_mask:0xf
v_and_b32_dpp v55, v36, v7 row_newbcast:4 row_mask:0xf bank_mask:0xf
s_waitcnt vmcnt(8)
buffer_load_dwordx4 v[104:107], v9, s[44:47], s36 offen offset:2048 nt
v_mfma_f32_16x16x32_bf16 v[48:51], v[52:55], v[120:123], v[48:51]
v_and_b32_dpp v56, v36, v4 row_newbcast:12 row_mask:0xf bank_mask:0xf
v_and_b32_dpp v57, v36, v5 row_newbcast:12 row_mask:0xf bank_mask:0xf
v_and_b32_dpp v58, v36, v6 row_newbcast:12 row_mask:0xf bank_mask:0xf
v_and_b32_dpp v59, v36, v7 row_newbcast:12 row_mask:0xf bank_mask:0xf
s_waitcnt lgkmcnt(0)
v_max3_f32 v60, v24, v25, v26
v_max_f32 v60, v60, v27
v_sub_f32 v63, v63, v60
v_exp_f32 v63, v63
v_lshrrev_b32 v62, 1, v3
v_mul_u32_u24 v62, 1088, v62
v_lshl_add_u32 v62, v2, 4, v62
v_and_b32 v61, 1, v3
v_lshl_add_u32 v62, v61, 3, v62
s_mul_i32 s62, s34, 272
v_add_u32 v62, s62, v62
s_waitcnt vmcnt(8)
buffer_load_dwordx4 v[108:111], v9, s[44:47], s36 offen offset:3072 nt
ds_add_u32 v192, v193 offset:256
v_mfma_f32_16x16x32_bf16 v[48:51], v[56:59], v[124:127], v[48:51]
v_and_b32_dpp v52, v36, v12 row_newbcast:2 row_mask:0xf bank_mask:0xf
v_and_b32_dpp v53, v36, v13 row_newbcast:2 row_mask:0xf bank_mask:0xf
v_and_b32_dpp v54, v36, v14 row_newbcast:2 row_mask:0xf bank_mask:0xf
v_and_b32_dpp v55, v36, v15 row_newbcast:2 row_mask:0xf bank_mask:0xf
s_waitcnt vmcnt(8)
s_add_u32 s36, s36, 0x18000
buffer_load_dwordx4 v[112:115], v8, s[44:47], s36 offen offset:0 nt
v_mfma_f32_16x16x32_bf16 v[48:51], v[52:55], v[64:67], v[48:51]
v_and_b32_dpp v56, v36, v12 row_newbcast:10 row_mask:0xf bank_mask:0xf
v_and_b32_dpp v57, v36, v13 row_newbcast:10 row_mask:0xf bank_mask:0xf
v_and_b32_dpp v58, v36, v14 row_newbcast:10 row_mask:0xf bank_mask:0xf
v_and_b32_dpp v59, v36, v15 row_newbcast:10 row_mask:0xf bank_mask:0xf
s_waitcnt vmcnt(8)
buffer_load_dwordx4 v[116:119], v8, s[44:47], s36 offen offset:1024 nt
ds_add_u32 v192, v193 offset:256
v_mfma_f32_16x16x32_bf16 v[48:51], v[56:59], v[68:71], v[48:51]
v_and_b32_dpp v52, v36, v12 row_newbcast:6 row_mask:0xf bank_mask:0xf
v_and_b32_dpp v53, v36, v13 row_newbcast:6 row_mask:0xf bank_mask:0xf
v_and_b32_dpp v54, v36, v14 row_newbcast:6 row_mask:0xf bank_mask:0xf
v_and_b32_dpp v55, v36, v15 row_newbcast:6 row_mask:0xf bank_mask:0xf
s_waitcnt vmcnt(8)
buffer_load_dwordx4 v[120:123], v8, s[44:47], s36 offen offset:2048 nt
v_mfma_f32_16x16x32_bf16 v[48:51], v[52:55], v[72:75], v[48:51]
v_and_b32_dpp v56, v36, v12 row_newbcast:14 row_mask:0xf bank_mask:0xf
v_and_b32_dpp v57, v36, v13 row_newbcast:14 row_mask:0xf bank_mask:0xf
v_and_b32_dpp v58, v36, v14 row_newbcast:14 row_mask:0xf bank_mask:0xf
v_and_b32_dpp v59, v36, v15 row_newbcast:14 row_mask:0xf bank_mask:0xf
s_waitcnt vmcnt(8)
buffer_load_dwordx4 v[124:127], v8, s[44:47], s36 offen offset:3072 nt
ds_add_u32 v192, v193 offset:256
v_mfma_f32_16x16x32_bf16 v[48:51], v[56:59], v[76:79], v[48:51]
v_and_b32_dpp v52, v36, v4 row_newbcast:1 row_mask:0xf bank_mask:0xf
v_and_b32_dpp v53, v36, v5 row_newbcast:1 row_mask:0xf bank_mask:0xf
v_and_b32_dpp v54, v36, v6 row_newbcast:1 row_mask:0xf bank_mask:0xf
v_and_b32_dpp v55, v36, v7 row_newbcast:1 row_mask:0xf bank_mask:0xf
s_waitcnt vmcnt(8)
buffer_load_dwordx4 v[64:67], v9, s[44:47], s36 offen offset:0 nt
v_mfma_f32_16x16x32_bf16 v[48:51], v[52:55], v[80:83], v[48:51]
v_and_b32_dpp v56, v36, v4 row_newbcast:9 row_mask:0xf bank_mask:0xf
v_and_b32_dpp v57, v36, v5 row_newbcast:9 row_mask:0xf bank_mask:0xf
v_and_b32_dpp v58, v36, v6 row_newbcast:9 row_mask:0xf bank_mask:0xf
v_and_b32_dpp v59, v36, v7 row_newbcast:9 row_mask:0xf bank_mask:0xf
s_waitcnt vmcnt(8)
buffer_load_dwordx4 v[68:71], v9, s[44:47], s36 offen offset:1024 nt
ds_add_u32 v192, v193 offset:256
v_mfma_f32_16x16x32_bf16 v[48:51], v[56:59], v[84:87], v[48:51]
v_and_b32_dpp v52, v36, v4 row_newbcast:5 row_mask:0xf bank_mask:0xf
v_and_b32_dpp v53, v36, v5 row_newbcast:5 row_mask:0xf bank_mask:0xf
v_and_b32_dpp v54, v36, v6 row_newbcast:5 row_mask:0xf bank_mask:0xf
v_and_b32_dpp v55, v36, v7 row_newbcast:5 row_mask:0xf bank_mask:0xf
s_waitcnt vmcnt(8)
buffer_load_dwordx4 v[72:75], v9, s[44:47], s36 offen offset:2048 nt
v_mfma_f32_16x16x32_bf16 v[48:51], v[52:55], v[88:91], v[48:51]
v_and_b32_dpp v56, v36, v4 row_newbcast:13 row_mask:0xf bank_mask:0xf
v_and_b32_dpp v57, v36, v5 row_newbcast:13 row_mask:0xf bank_mask:0xf
v_and_b32_dpp v58, v36, v6 row_newbcast:13 row_mask:0xf bank_mask:0xf
v_and_b32_dpp v59, v36, v7 row_newbcast:13 row_mask:0xf bank_mask:0xf
s_waitcnt vmcnt(8)
buffer_load_dwordx4 v[76:79], v9, s[44:47], s36 offen offset:3072 nt
ds_add_u32 v192, v193 offset:256
v_mfma_f32_16x16x32_bf16 v[48:51], v[56:59], v[92:95], v[48:51]
v_and_b32_dpp v52, v36, v12 row_newbcast:3 row_mask:0xf bank_mask:0xf
v_and_b32_dpp v53, v36, v13 row_newbcast:3 row_mask:0xf bank_mask:0xf
v_and_b32_dpp v54, v36, v14 row_newbcast:3 row_mask:0xf bank_mask:0xf
v_and_b32_dpp v55, v36, v15 row_newbcast:3 row_mask:0xf bank_mask:0xf
s_waitcnt vmcnt(8)
buffer_load_dwordx4 v[80:83], v8, s[44:47], s37 offen nt
v_mfma_f32_16x16x32_bf16 v[48:51], v[52:55], v[96:99], v[48:51]
v_and_b32_dpp v56, v36, v12 row_newbcast:11 row_mask:0xf bank_mask:0xf
v_and_b32_dpp v57, v36, v13 row_newbcast:11 row_mask:0xf bank_mask:0xf
v_and_b32_dpp v58, v36, v14 row_newbcast:11 row_mask:0xf bank_mask:0xf
v_and_b32_dpp v59, v36, v15 row_newbcast:11 row_mask:0xf bank_mask:0xf
s_waitcnt vmcnt(8)
buffer_load_dwordx4 v[84:87], v10, s[44:47], s37 offen nt
ds_add_u32 v192, v193 offset:256
v_mfma_f32_16x16x32_bf16 v[48:51], v[56:59], v[100:103], v[48:51]
v_and_b32_dpp v52, v36, v12 row_newbcast:7 row_mask:0xf bank_mask:0xf
v_and_b32_dpp v53, v36, v13 row_newbcast:7 row_mask:0xf bank_mask:0xf
v_and_b32_dpp v54, v36, v14 row_newbcast:7 row_mask:0xf bank_mask:0xf
v_and_b32_dpp v55, v36, v15 row_newbcast:7 row_mask:0xf bank_mask:0xf
s_waitcnt vmcnt(8)
buffer_load_dwordx4 v[88:91], v9, s[44:47], s37 offen nt
v_mfma_f32_16x16x32_bf16 v[48:51], v[52:55], v[104:107], v[48:51]
v_and_b32_dpp v56, v36, v12 row_newbcast:15 row_mask:0xf bank_mask:0xf
v_and_b32_dpp v57, v36, v13 row_newbcast:15 row_mask:0xf bank_mask:0xf
v_and_b32_dpp v58, v36, v14 row_newbcast:15 row_mask:0xf bank_mask:0xf
v_and_b32_dpp v59, v36, v15 row_newbcast:15 row_mask:0xf bank_mask:0xf
s_waitcnt vmcnt(8)
buffer_load_dwordx4 v[92:95], v11, s[44:47], s37 offen nt
ds_add_u32 v192, v193 offset:256
v_mfma_f32_16x16x32_bf16 v[48:51], v[56:59], v[108:111], v[48:51]
v_mov_b32 v36, v37
v_mov_b32 v37, v38
v_mov_b32 v38, v39
v_mov_b32 v39, v40
v_mov_b32 v40, v41
v_mov_b32 v41, v42
v_mov_b32 v42, v43
v_mov_b32 v43, v44
v_mov_b32 v44, v45
v_mov_b32 v45, v46
v_and_b32_dpp v52, v36, v4 row_newbcast:0 row_mask:0xf bank_mask:0xf
v_and_b32_dpp v53, v36, v5 row_newbcast:0 row_mask:0xf bank_mask:0xf
v_and_b32_dpp v54, v36, v6 row_newbcast:0 row_mask:0xf bank_mask:0xf
v_and_b32_dpp v55, v36, v7 row_newbcast:0 row_mask:0xf bank_mask:0xf
s_nop 0
s_nop 0
v_mfma_f32_16x16x32_bf16 v[48:51], v[52:55], v[112:115], v[48:51]
v_and_b32_dpp v56, v36, v4 row_newbcast:8 row_mask:0xf bank_mask:0xf
v_and_b32_dpp v57, v36, v5 row_newbcast:8 row_mask:0xf bank_mask:0xf
v_and_b32_dpp v58, v36, v6 row_newbcast:8 row_mask:0xf bank_mask:0xf
v_and_b32_dpp v59, v36, v7 row_newbcast:8 row_mask:0xf bank_mask:0xf
s_nop 0
s_nop 0
v_mfma_f32_16x16x32_bf16 v[48:51], v[56:59], v[116:119], v[48:51]
v_and_b32_dpp v52, v36, v4 row_newbcast:4 row_mask:0xf bank_mask:0xf
v_and_b32_dpp v53, v36, v5 row_newbcast:4 row_mask:0xf bank_mask:0xf
v_and_b32_dpp v54, v36, v6 row_newbcast:4 row_mask:0xf bank_mask:0xf
v_and_b32_dpp v55, v36, v7 row_newbcast:4 row_mask:0xf bank_mask:0xf
s_nop 0
s_nop 0
v_mfma_f32_16x16x32_bf16 v[48:51], v[52:55], v[120:123], v[48:51]
v_and_b32_dpp v56, v36, v4 row_newbcast:12 row_mask:0xf bank_mask:0xf
v_and_b32_dpp v57, v36, v5 row_newbcast:12 row_mask:0xf bank_mask:0xf
v_and_b32_dpp v58, v36, v6 row_newbcast:12 row_mask:0xf bank_mask:0xf
v_and_b32_dpp v59, v36, v7 row_newbcast:12 row_mask:0xf bank_mask:0xf
s_waitcnt vmcnt(8)
s_nop 0
v_mfma_f32_16x16x32_bf16 v[48:51], v[56:59], v[124:127], v[48:51]
v_and_b32_dpp v52, v36, v12 row_newbcast:2 row_mask:0xf bank_mask:0xf
v_and_b32_dpp v53, v36, v13 row_newbcast:2 row_mask:0xf bank_mask:0xf
v_and_b32_dpp v54, v36, v14 row_newbcast:2 row_mask:0xf bank_mask:0xf
v_and_b32_dpp v55, v36, v15 row_newbcast:2 row_mask:0xf bank_mask:0xf
s_waitcnt vmcnt(7)
s_nop 0
v_mfma_f32_16x16x32_bf16 v[48:51], v[52:55], v[64:67], v[48:51]
v_and_b32_dpp v56, v36, v12 row_newbcast:10 row_mask:0xf bank_mask:0xf
v_and_b32_dpp v57, v36, v13 row_newbcast:10 row_mask:0xf bank_mask:0xf
v_and_b32_dpp v58, v36, v14 row_newbcast:10 row_mask:0xf bank_mask:0xf
v_and_b32_dpp v59, v36, v15 row_newbcast:10 row_mask:0xf bank_mask:0xf
s_waitcnt vmcnt(6)
s_nop 0
v_mfma_f32_16x16x32_bf16 v[48:51], v[56:59], v[68:71], v[48:51]
v_and_b32_dpp v52, v36, v12 row_newbcast:6 row_mask:0xf bank_mask:0xf
v_and_b32_dpp v53, v36, v13 row_newbcast:6 row_mask:0xf bank_mask:0xf
v_and_b32_dpp v54, v36, v14 row_newbcast:6 row_mask:0xf bank_mask:0xf
v_and_b32_dpp v55, v36, v15 row_newbcast:6 row_mask:0xf bank_mask:0xf
s_waitcnt vmcnt(5)
s_nop 0
v_mfma_f32_16x16x32_bf16 v[48:51], v[52:55], v[72:75], v[48:51]
v_and_b32_dpp v56, v36, v12 row_newbcast:14 row_mask:0xf bank_mask:0xf
v_and_b32_dpp v57, v36, v13 row_newbcast:14 row_mask:0xf bank_mask:0xf
v_and_b32_dpp v58, v36, v14 row_newbcast:14 row_mask:0xf bank_mask:0xf
v_and_b32_dpp v59, v36, v15 row_newbcast:14 row_mask:0xf bank_mask:0xf
s_waitcnt vmcnt(4)
s_nop 0
v_mfma_f32_16x16x32_bf16 v[48:51], v[56:59], v[76:79], v[48:51]
v_and_b32_dpp v52, v36, v4 row_newbcast:1 row_mask:0xf bank_mask:0xf
v_and_b32_dpp v53, v36, v5 row_newbcast:1 row_mask:0xf bank_mask:0xf
v_and_b32_dpp v54, v36, v6 row_newbcast:1 row_mask:0xf bank_mask:0xf
v_and_b32_dpp v55, v36, v7 row_newbcast:1 row_mask:0xf bank_mask:0xf
s_waitcnt vmcnt(3)
s_nop 0
v_mfma_f32_16x16x32_bf16 v[48:51], v[52:55], v[80:83], v[48:51]
v_and_b32_dpp v56, v36, v4 row_newbcast:9 row_mask:0xf bank_mask:0xf
v_and_b32_dpp v57, v36, v5 row_newbcast:9 row_mask:0xf bank_mask:0xf
v_and_b32_dpp v58, v36, v6 row_newbcast:9 row_mask:0xf bank_mask:0xf
v_and_b32_dpp v59, v36, v7 row_newbcast:9 row_mask:0xf bank_mask:0xf
s_waitcnt vmcnt(2)
s_nop 0
v_mfma_f32_16x16x32_bf16 v[48:51], v[56:59], v[84:87], v[48:51]
v_and_b32_dpp v52, v36, v12 row_newbcast:3 row_mask:0xf bank_mask:0xf
v_and_b32_dpp v53, v36, v13 row_newbcast:3 row_mask:0xf bank_mask:0xf
v_and_b32_dpp v54, v36, v14 row_newbcast:3 row_mask:0xf bank_mask:0xf
v_and_b32_dpp v55, v36, v15 row_newbcast:3 row_mask:0xf bank_mask:0xf
s_waitcnt vmcnt(1)
s_nop 0
v_mfma_f32_16x16x32_bf16 v[48:51], v[52:55], v[88:91], v[48:51]
v_and_b32_dpp v56, v36, v12 row_newbcast:11 row_mask:0xf bank_mask:0xf
v_and_b32_dpp v57, v36, v13 row_newbcast:11 row_mask:0xf bank_mask:0xf
v_and_b32_dpp v58, v36, v14 row_newbcast:11 row_mask:0xf bank_mask:0xf
v_and_b32_dpp v59, v36, v15 row_newbcast:11 row_mask:0xf bank_mask:0xf
s_waitcnt vmcnt(0)
s_nop 0
v_mfma_f32_16x16x32_bf16 v[48:51], v[56:59], v[92:95], v[48:51]
s_nop 7
v_mul_f32 v48, v48, v63
v_mul_f32 v49, v49, v63
v_mul_f32 v50, v50, v63
v_mul_f32 v51, v51, v63
v_cvt_pk_bf16_f32 v48, v48, v49
v_cvt_pk_bf16_f32 v49, v50, v51
ds_write_b64 v62, v[48:49] offset:8192
s_waitcnt lgkmcnt(0)
s_barrier
s_endpgm
L_A_helper:
s_sub_u32 s35, s34, 4
s_lshl_b32 s37, s32, 3
s_add_u32 s37, s37, s33
s_cmp_lg_u32 s35, 0
s_cbranch_scc1 L_A_noclr
s_lshl_b32 s63, s37, 10
s_add_u32 s63, s63, 0x100000
v_lshl_add_u32 v10, v1, 4, s63
v_add_u32 v11, 0x40000, v10
v_mov_b32 v44, -1
v_mov_b32 v45, -1
v_mov_b32 v46, -1
v_mov_b32 v47, -1
global_store_dwordx4 v10, v[44:47], s[30:31] sc1
global_store_dwordx4 v11, v[44:47], s[30:31] sc1
L_A_noclr:
s_lshl_b32 s62, s32, 17
s_mov_b32 s63, 0x20000
s_add_u32 s40, s12, s62
s_addc_u32 s41, s13, 0
s_and_b32 s41, s41, 0xffff
s_mov_b32 s42, s63
s_mov_b32 s43, 0x20000
v_lshlrev_b32 v9, 13, v3
v_lshl_add_u32 v9, v2, 4, v9
s_lshl_b32 s62, s35, 8
v_add_u32 v9, s62, v9
s_mov_b32 s61, 0
buffer_load_dwordx4 v[184:187], v9, s[40:43], s61 offen offset:0
buffer_load_dwordx4 v[188:191], v9, s[40:43], s61 offen offset:1024
buffer_load_dwordx4 v[192:195], v9, s[40:43], s61 offen offset:2048
buffer_load_dwordx4 v[196:199], v9, s[40:43], s61 offen offset:3072
v_mov_b32 v8, 0
v_mov_b32 v11, 0
ds_write_b32 v8, v8 offset:0
ds_write_b32 v8, v8 offset:4
ds_write_b32 v8, v8 offset:8
ds_write_b32 v8, v8 offset:256
s_waitcnt lgkmcnt(0)
s_barrier
s_load_dword s88, s[30:31], 0x18000
s_mov_b32 s66, 0x05040100
s_mov_b32 s67, 0x07060302
s_mov_b32 s44, s30
s_and_b32 s45, s31, 0xffff
s_mov_b32 s46, 0x1000000
s_mov_b32 s47, 0x20000
s_lshl_b32 s63, s32, 10
s_add_u32 s63, s63, 0x40000
v_lshl_add_u32 v10, v1, 4, s63
v_lshlrev_b32 v11, 3, v1
s_mov_b32 s38, s35
s_waitcnt lgkmcnt(0)
s_add_u32 s88, s88, 0x9e3779b9
s_waitcnt vmcnt(3)
s_mov_b32 s61, 4096
buffer_load_dwordx4 v[200:203], v9, s[40:43], s61 offen offset:0
s_waitcnt vmcnt(3)
buffer_load_dwordx4 v[204:207], v9, s[40:43], s61 offen offset:1024
v_perm_b32 v56, v188, v184, s66
v_perm_b32 v60, v188, v184, s67
v_perm_b32 v64, v189, v185, s66
v_perm_b32 v68, v189, v185, s67
v_perm_b32 v72, v190, v186, s66
v_perm_b32 v76, v190, v186, s67
v_perm_b32 v80, v191, v187, s66
v_perm_b32 v84, v191, v187, s67
s_waitcnt vmcnt(3)
buffer_load_dwordx4 v[208:211], v9, s[40:43], s61 offen offset:2048
s_waitcnt vmcnt(3)
buffer_load_dwordx4 v[212:215], v9, s[40:43], s61 offen offset:3072
v_perm_b32 v57, v196, v192, s66
v_perm_b32 v61, v196, v192, s67
v_perm_b32 v65, v197, v193, s66
v_perm_b32 v69, v197, v193, s67
v_perm_b32 v73, v198, v194, s66
v_perm_b32 v77, v198, v194, s67
v_perm_b32 v81, v199, v195, s66
v_perm_b32 v85, v199, v195, s67
s_waitcnt vmcnt(3)
s_mov_b32 s61, 32768
buffer_load_dwordx4 v[216:219], v9, s[40:43], s61 offen offset:0
s_waitcnt vmcnt(3)
buffer_load_dwordx4 v[220:223], v9, s[40:43], s61 offen offset:1024
v_perm_b32 v58, v204, v200, s66
v_perm_b32 v62, v204, v200, s67
v_perm_b32 v66, v205, v201, s66
v_perm_b32 v70, v205, v201, s67
v_perm_b32 v74, v206, v202, s66
v_perm_b32 v78, v206, v202, s67
v_perm_b32 v82, v207, v203, s66
v_perm_b32 v86, v207, v203, s67
s_waitcnt vmcnt(3)
buffer_load_dwordx4 v[224:227], v9, s[40:43], s61 offen offset:2048
s_waitcnt vmcnt(3)
buffer_load_dwordx4 v[228:231], v9, s[40:43], s61 offen offset:3072
v_perm_b32 v59, v212, v208, s66
v_perm_b32 v63, v212, v208, s67
v_perm_b32 v67, v213, v209, s66
v_perm_b32 v71, v213, v209, s67
v_perm_b32 v75, v214, v210, s66
v_perm_b32 v79, v214, v210, s67
v_perm_b32 v83, v215, v211, s66
v_perm_b32 v87, v215, v211, s67
s_waitcnt vmcnt(3)
s_mov_b32 s61, 36864
buffer_load_dwordx4 v[232:235], v9, s[40:43], s61 offen offset:0
s_waitcnt vmcnt(3)
buffer_load_dwordx4 v[236:239], v9, s[40:43], s61 offen offset:1024
v_perm_b32 v88, v220, v216, s66
v_perm_b32 v92, v220, v216, s67
v_perm_b32 v96, v221, v217, s66
v_perm_b32 v100, v221, v217, s67
v_perm_b32 v104, v222, v218, s66
v_perm_b32 v108, v222, v218, s67
v_perm_b32 v112, v223, v219, s66
v_perm_b32 v116, v223, v219, s67
s_waitcnt vmcnt(3)
buffer_load_dwordx4 v[240:243], v9, s[40:43], s61 offen offset:2048
s_waitcnt vmcnt(3)
buffer_load_dwordx4 v[244:247], v9, s[40:43], s61 offen offset:3072
v_perm_b32 v89, v228, v224, s66
v_perm_b32 v93, v228, v224, s67
v_perm_b32 v97, v229, v225, s66
v_perm_b32 v101, v229, v225, s67
v_perm_b32 v105, v230, v226, s66
v_perm_b32 v109, v230, v226, s67
v_perm_b32 v113, v231, v227, s66
v_perm_b32 v117, v231, v227, s67
s_waitcnt vmcnt(3)
s_mov_b32 s61, 65536
buffer_load_dwordx4 v[184:187], v9, s[40:43], s61 offen offset:0
s_waitcnt vmcnt(3)
buffer_load_dwordx4 v[188:191], v9, s[40:43], s61 offen offset:1024
v_perm_b32 v90, v236, v232, s66
v_perm_b32 v94, v236, v232, s67
v_perm_b32 v98, v237, v233, s66
v_perm_b32 v102, v237, v233, s67
v_perm_b32 v106, v238, v234, s66
v_perm_b32 v110, v238, v234, s67
v_perm_b32 v114, v239, v235, s66
v_perm_b32 v118, v239, v235, s67
s_waitcnt vmcnt(3)
buffer_load_dwordx4 v[192:195], v9, s[40:43], s61 offen offset:2048
s_waitcnt vmcnt(3)
buffer_load_dwordx4 v[196:199], v9, s[40:43], s61 offen offset:3072
v_perm_b32 v91, v244, v240, s66
v_perm_b32 v95, v244, v240, s67
v_perm_b32 v99, v245, v241, s66
v_perm_b32 v103, v245, v241, s67
v_perm_b32 v107, v246, v242, s66
v_perm_b32 v111, v246, v242, s67
v_perm_b32 v115, v247, v243, s66
v_perm_b32 v119, v247, v243, s67
s_waitcnt vmcnt(3)
s_mov_b32 s61, 69632
buffer_load_dwordx4 v[200:203], v9, s[40:43], s61 offen offset:0
s_waitcnt vmcnt(3)
buffer_load_dwordx4 v[204:207], v9, s[40:43], s61 offen offset:1024
v_perm_b32 v120, v188, v184, s66
v_perm_b32 v124, v188, v184, s67
v_perm_b32 v128, v189, v185, s66
v_perm_b32 v132, v189, v185, s67
v_perm_b32 v136, v190, v186, s66
v_perm_b32 v140, v190, v186, s67
v_perm_b32 v144, v191, v187, s66
v_perm_b32 v148, v191, v187, s67
s_waitcnt vmcnt(3)
buffer_load_dwordx4 v[208:211], v9, s[40:43], s61 offen offset:2048
s_waitcnt vmcnt(3)
buffer_load_dwordx4 v[212:215], v9, s[40:43], s61 offen offset:3072
v_perm_b32 v121, v196, v192, s66
v_perm_b32 v125, v196, v192, s67
v_perm_b32 v129, v197, v193, s66
v_perm_b32 v133, v197, v193, s67
v_perm_b32 v137, v198, v194, s66
v_perm_b32 v141, v198, v194, s67
v_perm_b32 v145, v199, v195, s66
v_perm_b32 v149, v199, v195, s67
s_waitcnt vmcnt(3)
s_cmp_lg_u32 s38, 0
s_cbranch_scc1 L_A_qt20
buffer_load_dwordx4 v[44:47], v10, s[44:47], 0 offen sc1
L_A_qt20:
s_mov_b32 s61, 98304
buffer_load_dwordx4 v[216:219], v9, s[40:43], s61 offen offset:0
s_waitcnt vmcnt(3)
buffer_load_dwordx4 v[220:223], v9, s[40:43], s61 offen offset:1024
v_perm_b32 v122, v204, v200, s66
v_perm_b32 v126, v204, v200, s67
v_perm_b32 v130, v205, v201, s66
v_perm_b32 v134, v205, v201, s67
v_perm_b32 v138, v206, v202, s66
v_perm_b32 v142, v206, v202, s67
v_perm_b32 v146, v207, v203, s66
v_perm_b32 v150, v207, v203, s67
s_waitcnt vmcnt(3)
buffer_load_dwordx4 v[224:227], v9, s[40:43], s61 offen offset:2048
s_waitcnt vmcnt(3)
buffer_load_dwordx4 v[228:231], v9, s[40:43], s61 offen offset:3072
v_perm_b32 v123, v212, v208, s66
v_perm_b32 v127, v212, v208, s67
v_perm_b32 v131, v213, v209, s66
v_perm_b32 v135, v213, v209, s67
v_perm_b32 v139, v214, v210, s66
v_perm_b32 v143, v214, v210, s67
v_perm_b32 v147, v215, v211, s66
v_perm_b32 v151, v215, v211, s67
s_waitcnt vmcnt(3)
s_cmp_lg_u32 s38, 0
s_cbranch_scc1 L_A_qc24
v_cmp_ne_u32 s[62:63], s88, v45
v_cmp_ne_u32 vcc, s88, v47
s_nop 1
s_or_b64 vcc, vcc, s[62:63]
s_cbranch_scc1 L_A_qc24
s_mov_b32 s38, 1
v_mov_b32 v45, v46
v_mov_b32 v46, 1
ds_write_b64 v11, v[44:45] offset:1024
ds_write_b32 v8, v46 offset:0
L_A_qc24:
s_cmp_lg_u32 s38, 0
s_cbranch_scc1 L_A_qt24
buffer_load_dwordx4 v[44:47], v10, s[44:47], 0 offen sc1
L_A_qt24:
s_mov_b32 s61, 102400
buffer_load_dwordx4 v[232:235], v9, s[40:43], s61 offen offset:0
s_waitcnt vmcnt(3)
buffer_load_dwordx4 v[236:239], v9, s[40:43], s61 offen offset:1024
v_perm_b32 v152, v220, v216, s66
v_perm_b32 v156, v220, v216, s67
v_perm_b32 v160, v221, v217, s66
v_perm_b32 v164, v221, v217, s67
v_perm_b32 v168, v222, v218, s66
v_perm_b32 v172, v222, v218, s67
v_perm_b32 v176, v223, v219, s66
v_perm_b32 v180, v223, v219, s67
s_waitcnt vmcnt(3)
buffer_load_dwordx4 v[240:243], v9, s[40:43], s61 offen offset:2048
s_waitcnt vmcnt(3)
buffer_load_dwordx4 v[244:247], v9, s[40:43], s61 offen offset:3072
v_perm_b32 v153, v228, v224, s66
v_perm_b32 v157, v228, v224, s67
v_perm_b32 v161, v229, v225, s66
v_perm_b32 v165, v229, v225, s67
v_perm_b32 v169, v230, v226, s66
v_perm_b32 v173, v230, v226, s67
v_perm_b32 v177, v231, v227, s66
v_perm_b32 v181, v231, v227, s67
s_waitcnt vmcnt(3)
s_cmp_lg_u32 s38, 0
s_cbranch_scc1 L_A_qc28
v_cmp_ne_u32 s[62:63], s88, v45
v_cmp_ne_u32 vcc, s88, v47
s_nop 1
s_or_b64 vcc, vcc, s[62:63]
s_cbranch_scc1 L_A_qc28
s_mov_b32 s38, 1
v_mov_b32 v45, v46
v_mov_b32 v46, 1
ds_write_b64 v11, v[44:45] offset:1024
ds_write_b32 v8, v46 offset:0
L_A_qc28:
s_waitcnt vmcnt(2)
v_perm_b32 v154, v236, v232, s66
v_perm_b32 v158, v236, v232, s67
v_perm_b32 v162, v237, v233, s66
v_perm_b32 v166, v237, v233, s67
v_perm_b32 v170, v238, v234, s66
v_perm_b32 v174, v238, v234, s67
v_perm_b32 v178, v239, v235, s66
v_perm_b32 v182, v239, v235, s67
s_waitcnt vmcnt(1)
s_waitcnt vmcnt(0)
v_perm_b32 v155, v244, v240, s66
v_perm_b32 v159, v244, v240, s67
v_perm_b32 v163, v245, v241, s66
v_perm_b32 v167, v245, v241, s67
v_perm_b32 v171, v246, v242, s66
v_perm_b32 v175, v246, v242, s67
v_perm_b32 v179, v247, v243, s66
v_perm_b32 v183, v247, v243, s67
s_mov_b32 s60, s37
s_cmp_lg_u32 s35, 0
s_cbranch_scc1 L_A_nostat
s_cmp_lg_u32 s38, 0
s_cbranch_scc1 L_A_qdone
s_mov_b32 s64, 0
L_tp_Aq:
buffer_load_dwordx4 v[44:47], v10, s[44:47], 0 offen sc1
s_waitcnt vmcnt(0)
v_cmp_ne_u32 s[62:63], s88, v45
v_cmp_ne_u32 vcc, s88, v47
s_add_u32 s64, s64, 1
s_nop 0
s_or_b64 vcc, vcc, s[62:63]
s_cbranch_scc0 L_tp_Aq_ok
s_cmp_lt_u32 s64, 65536
s_cbranch_scc1 L_tp_Aq
L_tp_Aq_ok:
v_mov_b32 v45, v46
v_mov_b32 v46, 1
ds_write_b64 v11, v[44:45] offset:1024
ds_write_b32 v8, v46 offset:0
L_A_qdone:
s_mov_b32 s64, 0
L_A_hs:
ds_read_b32 v10, v8 offset:4
s_waitcnt lgkmcnt(0)
v_readfirstlane_b32 s65, v10
s_add_u32 s64, s64, 1
s_nop 2
s_cmp_ge_u32 s65, 4
s_cbranch_scc1 L_A_hs_ok
s_sleep 16
s_cmp_lt_u32 s64, 1048576
s_cbranch_scc1 L_A_hs
L_A_hs_ok:
s_waitcnt vmcnt(0)
v_and_b32 v10, 1, v1
v_lshlrev_b32 v11, 4, v10
ds_read_b128 v[44:47], v11 offset:64
ds_read_b128 v[48:51], v11 offset:96
v_lshlrev_b32 v10, 12, v10
s_lshl_b32 s63, s60, 4
s_add_u32 s63, s63, 0x14000
v_add_u32 v10, s63, v10
s_lshl_b32 s63, s60, 7
s_add_u32 s63, s63, 0x50000
v_lshl_add_u32 v10, v1, 4, s63
s_waitcnt lgkmcnt(0)
v_max3_f32 v52, v44, v45, v46
v_max_f32 v52, v52, v47
v_sub_f32 v44, v44, v52
v_sub_f32 v45, v45, v52
v_sub_f32 v46, v46, v52
v_sub_f32 v47, v47, v52
v_exp_f32 v44, v44
v_exp_f32 v45, v45
v_exp_f32 v46, v46
v_exp_f32 v47, v47
s_nop 0
v_mul_f32 v54, v44, v48
v_fma_f32 v54, v45, v49, v54
v_fma_f32 v54, v46, v50, v54
v_fma_f32 v54, v47, v51, v54
v_mov_b32 v53, s88
v_mov_b32 v55, s88
s_mov_b64 exec, 255
global_store_dwordx4 v10, v[52:55], s[30:31] sc1
s_mov_b64 exec, -1
L_A_nostat:
s_sub_u32 s63, s35, 1
s_cmp_gt_u32 s63, 1
s_cbranch_scc1 L_A_monx
s_and_b32 s63, s32, 7
s_mul_i32 s63, s63, 0x100
s_add_u32 s63, s63, 0xc0000
s_add_u32 s56, s30, s63
s_addc_u32 s57, s31, 0
s_mov_b32 s64, 0
s_mov_b32 s59, 0
s_lshr_b32 s62, s32, 3
s_mul_i32 s62, s62, 6
s_add_u32 s62, s62, s33
s_lshl_b32 s62, s62, 2
v_mov_b32 v44, s62
v_lshlrev_b32 v48, 2, v1
s_lshr_b32 s65, s62, 2
s_cmp_eq_u32 s35, 1
s_cbranch_scc1 L_A_mon
s_mov_b64 exec, 1
s_mov_b32 s59, -4
L_A_post:
ds_read_b32 v45, v8 offset:256
s_waitcnt lgkmcnt(0)
v_readfirstlane_b32 s58, v45
v_add_u32 v46, s88, v45
s_sub_u32 s63, s58, s59
s_cmp_lt_u32 s63, 4
s_cbranch_scc1 L_A_postn
global_store_dword v44, v46, s[56:57]
s_mov_b32 s59, s58
s_cmp_ge_u32 s58, 640
s_cbranch_scc1 L_A_monx
L_A_postn:
s_sleep 2
s_add_u32 s64, s64, 1
s_cmp_lt_u32 s64, 65536
s_cbranch_scc1 L_A_post
s_branch L_A_monx
L_A_mon:
s_mov_b64 exec, 1
ds_read_b32 v45, v8 offset:256
s_waitcnt lgkmcnt(0)
v_add_u32 v46, s88, v45
v_readfirstlane_b32 s58, v45
s_mov_b64 exec, 0x1ffffff
global_load_dword v49, v48, s[56:57] nt
s_waitcnt vmcnt(0)
v_subrev_u32 v49, s88, v49
s_mov_b64 exec, 0xffffff
v_cmp_le_u32 vcc, 0x400, v49
v_readlane_b32 s62, v49, 24
v_readlane_b32 s59, v49, s65
v_add_u32_dpp v49, v49, v49 row_shr:1 row_mask:0xf bank_mask:0xf bound_ctrl:0
s_nop 1
v_add_u32_dpp v49, v49, v49 row_shr:2 row_mask:0xf bank_mask:0xf bound_ctrl:0
s_nop 1
v_add_u32_dpp v49, v49, v49 row_shr:4 row_mask:0xf bank_mask:0xf bound_ctrl:0
s_nop 1
v_add_u32_dpp v49, v49, v49 row_shr:8 row_mask:0xf bank_mask:0xf bound_ctrl:0
s_nop 0
v_readlane_b32 s61, v49, 15
v_readlane_b32 s63, v49, 23
s_add_u32 s61, s61, s63
s_mul_i32 s63, s59, 24
s_sub_u32 s61, s61, s63
s_cmp_lt_u32 s62, 0x8000
s_cselect_b32 s62, s62, 0x4000
s_add_u32 s61, s61, s62
s_sub_u32 s61, s61, 0x4000
s_mov_b32 s63, -48
s_cmp_lt_u32 s58, 400
s_cselect_b32 s63, s63, -48
s_cmp_gt_i32 s61, s63
s_cselect_b32 s63, 1, 0
s_cmp_eq_u64 vcc, 0
s_cselect_b32 s63, s63, 0
s_cmp_lt_u32 s58, 620
s_cselect_b32 s63, s63, 1
v_mov_b32 v47, s63
ds_write_b32 v8, v47 offset:8
s_mov_b32 s59, s58
s_cmp_ge_u32 s58, 620
s_cbranch_scc1 L_A_monx
s_add_u32 s64, s64, 1
s_cmp_lt_u32 s64, 4096
s_cbranch_scc1 L_A_mon
L_A_monx:
s_mov_b64 exec, -1
v_and_b32 v10, 7, v2
v_mul_u32_u24 v10, 272, v10
v_lshl_add_u32 v10, v3, 4, v10
v_lshlrev_b32 v11, 18, v3
v_lshl_add_u32 v11, v2, 4, v11
s_lshl_b32 s63, s60, 10
s_lshl_b32 s62, s35, 8
s_add_u32 s63, s63, s62
s_add_u32 s63, s63, 0x100000
v_add_u32 v11, s63, v11
s_barrier
ds_read_b128 v[12:15], v10 offset:8192
ds_read_b128 v[16:19], v10 offset:8256
ds_read_b128 v[20:23], v10 offset:8320
ds_read_b128 v[24:27], v10 offset:8384
s_waitcnt lgkmcnt(3)
v_mfma_f32_16x16x32_bf16 v[184:187], v[12:15], v[56:59], 0
v_mfma_f32_16x16x32_bf16 v[188:191], v[12:15], v[60:63], 0
s_waitcnt lgkmcnt(2)
v_mfma_f32_16x16x32_bf16 v[184:187], v[16:19], v[88:91], v[184:187]
v_mfma_f32_16x16x32_bf16 v[188:191], v[16:19], v[92:95], v[188:191]
s_waitcnt lgkmcnt(1)
v_mfma_f32_16x16x32_bf16 v[184:187], v[20:23], v[120:123], v[184:187]
v_mfma_f32_16x16x32_bf16 v[188:191], v[20:23], v[124:127], v[188:191]
s_waitcnt lgkmcnt(0)
v_mfma_f32_16x16x32_bf16 v[184:187], v[24:27], v[152:155], v[184:187]
v_mfma_f32_16x16x32_bf16 v[188:191], v[24:27], v[156:159], v[188:191]
v_mfma_f32_16x16x32_bf16 v[192:195], v[12:15], v[64:67], 0
v_mfma_f32_16x16x32_bf16 v[196:199], v[12:15], v[68:71], 0
v_mfma_f32_16x16x32_bf16 v[192:195], v[16:19], v[96:99], v[192:195]
v_mfma_f32_16x16x32_bf16 v[196:199], v[16:19], v[100:103], v[196:199]
v_mfma_f32_16x16x32_bf16 v[192:195], v[20:23], v[128:131], v[192:195]
v_mfma_f32_16x16x32_bf16 v[196:199], v[20:23], v[132:135], v[196:199]
v_mfma_f32_16x16x32_bf16 v[192:195], v[24:27], v[160:163], v[192:195]
v_mfma_f32_16x16x32_bf16 v[196:199], v[24:27], v[164:167], v[196:199]
v_add_f32 v184, v184, v185
v_add_f32 v186, v186, v187
v_add_f32 v184, v184, v186
v_add_f32 v188, v188, v189
v_add_f32 v190, v190, v191
v_add_f32 v188, v188, v190
v_cvt_pk_bf16_f32 v36, v184, v188
v_min_u32 v36, 0xfffffffe, v36
v_mfma_f32_16x16x32_bf16 v[200:203], v[12:15], v[72:75], 0
v_mfma_f32_16x16x32_bf16 v[204:207], v[12:15], v[76:79], 0
v_mfma_f32_16x16x32_bf16 v[200:203], v[16:19], v[104:107], v[200:203]
v_mfma_f32_16x16x32_bf16 v[204:207], v[16:19], v[108:111], v[204:207]
v_mfma_f32_16x16x32_bf16 v[200:203], v[20:23], v[136:139], v[200:203]
v_mfma_f32_16x16x32_bf16 v[204:207], v[20:23], v[140:143], v[204:207]
v_mfma_f32_16x16x32_bf16 v[200:203], v[24:27], v[168:171], v[200:203]
v_mfma_f32_16x16x32_bf16 v[204:207], v[24:27], v[172:175], v[204:207]
v_add_f32 v192, v192, v193
v_add_f32 v194, v194, v195
v_add_f32 v192, v192, v194
v_add_f32 v196, v196, v197
v_add_f32 v198, v198, v199
v_add_f32 v196, v196, v198
v_cvt_pk_bf16_f32 v37, v192, v196
v_min_u32 v37, 0xfffffffe, v37
v_mfma_f32_16x16x32_bf16 v[208:211], v[12:15], v[80:83], 0
v_mfma_f32_16x16x32_bf16 v[212:215], v[12:15], v[84:87], 0
v_mfma_f32_16x16x32_bf16 v[208:211], v[16:19], v[112:115], v[208:211]
v_mfma_f32_16x16x32_bf16 v[212:215], v[16:19], v[116:119], v[212:215]
v_mfma_f32_16x16x32_bf16 v[208:211], v[20:23], v[144:147], v[208:211]
v_mfma_f32_16x16x32_bf16 v[212:215], v[20:23], v[148:151], v[212:215]
v_mfma_f32_16x16x32_bf16 v[208:211], v[24:27], v[176:179], v[208:211]
v_mfma_f32_16x16x32_bf16 v[212:215], v[24:27], v[180:183], v[212:215]
v_add_f32 v200, v200, v201
v_add_f32 v202, v202, v203
v_add_f32 v200, v200, v202
v_add_f32 v204, v204, v205
v_add_f32 v206, v206, v207
v_add_f32 v204, v204, v206
v_cvt_pk_bf16_f32 v38, v200, v204
v_min_u32 v38, 0xfffffffe, v38
s_nop 0
v_add_f32 v208, v208, v209
v_add_f32 v210, v210, v211
v_add_f32 v208, v208, v210
v_add_f32 v212, v212, v213
v_add_f32 v214, v214, v215
v_add_f32 v212, v212, v214
v_cvt_pk_bf16_f32 v39, v208, v212
v_min_u32 v39, 0xfffffffe, v39
s_mov_b32 exec_hi, 0
global_store_dwordx4 v11, v[36:39], s[30:31] sc1
s_endpgm
L_roleW:
s_load_dword s88, s[30:31], 0x18000
v_mov_b32 v8, 0
s_mov_b32 s52, s30
s_and_b32 s53, s31, 0xffff
s_mov_b32 s54, 0x1000000
s_mov_b32 s55, 0x20000
s_lshl_b32 s60, s32, 8
s_sub_u32 s61, 0x400000, s60
s_add_u32 s40, s18, s60
s_addc_u32 s41, s19, 0
s_and_b32 s41, s41, 0xffff
s_mov_b32 s42, s61
s_mov_b32 s43, 0x20000
s_add_u32 s44, s20, s60
s_addc_u32 s45, s21, 0
s_and_b32 s45, s45, 0xffff
s_mov_b32 s46, s61
s_mov_b32 s47, 0x20000
s_mov_b32 s48, s14
s_and_b32 s49, s15, 0xffff
s_mov_b32 s50, 0x800
s_mov_b32 s51, 0x20000
v_lshrrev_b32 v192, 3, v2
v_lshlrev_b32 v192, 10, v192
v_lshl_add_u32 v192, v3, 5, v192
s_lshl_b32 s62, s34, 7
v_add_u32 v192, s62, v192
buffer_load_dwordx4 v[12:15], v192, s[48:51], 0 offen
buffer_load_dwordx4 v[16:19], v192, s[48:51], 0 offen offset:16
v_lshlrev_b32 v9, 17, v3
v_lshl_add_u32 v9, v2, 4, v9
s_lshl_b32 s62, s34, 19
v_add_u32 v9, s62, v9
s_waitcnt vmcnt(2)
s_mov_b32 s62, 0
buffer_load_dwordx4 v[64:67], v9, s[40:43], s62 offen nt
s_waitcnt vmcnt(2)
s_mov_b32 s62, 8192
buffer_load_dwordx4 v[68:71], v9, s[40:43], s62 offen nt
s_waitcnt vmcnt(2)
s_mov_b32 s62, 16384
buffer_load_dwordx4 v[72:75], v9, s[40:43], s62 offen nt
s_waitcnt vmcnt(2)
s_mov_b32 s62, 24576
buffer_load_dwordx4 v[76:79], v9, s[40:43], s62 offen nt
s_waitcnt vmcnt(2)
s_mov_b32 s62, 32768
buffer_load_dwordx4 v[80:83], v9, s[40:43], s62 offen nt
s_waitcnt vmcnt(2)
s_mov_b32 s62, 40960
buffer_load_dwordx4 v[84:87], v9, s[40:43], s62 offen nt
s_waitcnt vmcnt(2)
s_mov_b32 s62, 49152
buffer_load_dwordx4 v[88:91], v9, s[40:43], s62 offen nt
s_waitcnt vmcnt(2)
s_mov_b32 s62, 57344
buffer_load_dwordx4 v[92:95], v9, s[40:43], s62 offen nt
s_waitcnt vmcnt(2)
s_mov_b32 s62, 65536
buffer_load_dwordx4 v[96:99], v9, s[40:43], s62 offen nt
s_waitcnt vmcnt(2)
s_mov_b32 s62, 73728
buffer_load_dwordx4 v[100:103], v9, s[40:43], s62 offen nt
s_waitcnt vmcnt(2)
s_mov_b32 s62, 81920
buffer_load_dwordx4 v[104:107], v9, s[40:43], s62 offen nt
s_waitcnt vmcnt(2)
s_mov_b32 s62, 90112
buffer_load_dwordx4 v[108:111], v9, s[40:43], s62 offen nt
s_waitcnt vmcnt(2)
s_mov_b32 s62, 98304
buffer_load_dwordx4 v[112:115], v9, s[40:43], s62 offen nt
s_waitcnt vmcnt(2)
s_mov_b32 s62, 106496
buffer_load_dwordx4 v[116:119], v9, s[40:43], s62 offen nt
s_waitcnt vmcnt(2)
s_mov_b32 s62, 114688
buffer_load_dwordx4 v[120:123], v9, s[40:43], s62 offen nt
s_waitcnt vmcnt(2)
s_mov_b32 s62, 122880
buffer_load_dwordx4 v[124:127], v9, s[40:43], s62 offen nt
s_barrier
s_waitcnt vmcnt(16)
s_mov_b32 s60, 0x01000100
v_perm_b32 v192, v12, v12, s60
v_and_b32 v28, v192, v4
v_and_b32 v29, v192, v5
v_and_b32 v30, v192, v6
v_and_b32 v31, v192, v7
s_waitcnt vmcnt(15)
s_nop 0
v_mfma_f32_16x16x32_bf16 v[44:47], v[28:31], v[64:67], 0
s_mov_b32 s62, 0
buffer_load_dwordx4 v[128:131], v9, s[44:47], s62 offen nt
s_mov_b32 s60, 0x03020302
v_perm_b32 v193, v12, v12, s60
v_and_b32 v32, v193, v4
v_and_b32 v33, v193, v5
v_and_b32 v34, v193, v6
v_and_b32 v35, v193, v7
s_waitcnt vmcnt(15)
s_nop 0
v_mfma_f32_16x16x32_bf16 v[44:47], v[32:35], v[68:71], v[44:47]
s_mov_b32 s62, 8192
buffer_load_dwordx4 v[132:135], v9, s[44:47], s62 offen nt
s_mov_b32 s60, 0x01000100
v_perm_b32 v192, v13, v13, s60
v_and_b32 v28, v192, v4
v_and_b32 v29, v192, v5
v_and_b32 v30, v192, v6
v_and_b32 v31, v192, v7
s_waitcnt vmcnt(15)
s_nop 0
v_mfma_f32_16x16x32_bf16 v[44:47], v[28:31], v[72:75], v[44:47]
s_mov_b32 s62, 16384
buffer_load_dwordx4 v[136:139], v9, s[44:47], s62 offen nt
s_mov_b32 s60, 0x03020302
v_perm_b32 v193, v13, v13, s60
v_and_b32 v32, v193, v4
v_and_b32 v33, v193, v5
v_and_b32 v34, v193, v6
v_and_b32 v35, v193, v7
s_waitcnt vmcnt(15)
s_nop 0
v_mfma_f32_16x16x32_bf16 v[44:47], v[32:35], v[76:79], v[44:47]
s_mov_b32 s62, 24576
buffer_load_dwordx4 v[140:143], v9, s[44:47], s62 offen nt
s_mov_b32 s60, 0x01000100
v_perm_b32 v192, v14, v14, s60
v_and_b32 v28, v192, v4
v_and_b32 v29, v192, v5
v_and_b32 v30, v192, v6
v_and_b32 v31, v192, v7
s_waitcnt vmcnt(15)
s_nop 0
v_mfma_f32_16x16x32_bf16 v[44:47], v[28:31], v[80:83], v[44:47]
s_mov_b32 s62, 32768
buffer_load_dwordx4 v[144:147], v9, s[44:47], s62 offen nt
s_mov_b32 s60, 0x03020302
v_perm_b32 v193, v14, v14, s60
v_and_b32 v32, v193, v4
v_and_b32 v33, v193, v5
v_and_b32 v34, v193, v6
v_and_b32 v35, v193, v7
s_waitcnt vmcnt(15)
s_nop 0
v_mfma_f32_16x16x32_bf16 v[44:47], v[32:35], v[84:87], v[44:47]
s_mov_b32 s62, 40960
buffer_load_dwordx4 v[148:151], v9, s[44:47], s62 offen nt
s_mov_b32 s60, 0x01000100
v_perm_b32 v192, v15, v15, s60
v_and_b32 v28, v192, v4
v_and_b32 v29, v192, v5
v_and_b32 v30, v192, v6
v_and_b32 v31, v192, v7
s_waitcnt vmcnt(15)
s_nop 0
v_mfma_f32_16x16x32_bf16 v[44:47], v[28:31], v[88:91], v[44:47]
s_mov_b32 s62, 49152
buffer_load_dwordx4 v[152:155], v9, s[44:47], s62 offen nt
s_mov_b32 s60, 0x03020302
v_perm_b32 v193, v15, v15, s60
v_and_b32 v32, v193, v4
v_and_b32 v33, v193, v5
v_and_b32 v34, v193, v6
v_and_b32 v35, v193, v7
s_waitcnt vmcnt(15)
s_nop 0
v_mfma_f32_16x16x32_bf16 v[44:47], v[32:35], v[92:95], v[44:47]
s_mov_b32 s62, 57344
buffer_load_dwordx4 v[156:159], v9, s[44:47], s62 offen nt
s_mov_b32 s60, 0x01000100
v_perm_b32 v192, v16, v16, s60
v_and_b32 v28, v192, v4
v_and_b32 v29, v192, v5
v_and_b32 v30, v192, v6
v_and_b32 v31, v192, v7
s_waitcnt vmcnt(15)
s_nop 0
v_mfma_f32_16x16x32_bf16 v[44:47], v[28:31], v[96:99], v[44:47]
s_mov_b32 s62, 65536
buffer_load_dwordx4 v[160:163], v9, s[44:47], s62 offen nt
s_mov_b32 s60, 0x03020302
v_perm_b32 v193, v16, v16, s60
v_and_b32 v32, v193, v4
v_and_b32 v33, v193, v5
v_and_b32 v34, v193, v6
v_and_b32 v35, v193, v7
s_waitcnt vmcnt(15)
s_nop 0
v_mfma_f32_16x16x32_bf16 v[44:47], v[32:35], v[100:103], v[44:47]
s_mov_b32 s62, 73728
buffer_load_dwordx4 v[164:167], v9, s[44:47], s62 offen nt
s_mov_b32 s60, 0x01000100
v_perm_b32 v192, v17, v17, s60
v_and_b32 v28, v192, v4
v_and_b32 v29, v192, v5
v_and_b32 v30, v192, v6
v_and_b32 v31, v192, v7
s_waitcnt vmcnt(15)
s_nop 0
v_mfma_f32_16x16x32_bf16 v[44:47], v[28:31], v[104:107], v[44:47]
s_mov_b32 s62, 81920
buffer_load_dwordx4 v[168:171], v9, s[44:47], s62 offen nt
s_mov_b32 s60, 0x03020302
v_perm_b32 v193, v17, v17, s60
v_and_b32 v32, v193, v4
v_and_b32 v33, v193, v5
v_and_b32 v34, v193, v6
v_and_b32 v35, v193, v7
s_waitcnt vmcnt(15)
s_nop 0
v_mfma_f32_16x16x32_bf16 v[44:47], v[32:35], v[108:111], v[44:47]
s_mov_b32 s62, 90112
buffer_load_dwordx4 v[172:175], v9, s[44:47], s62 offen nt
s_mov_b32 s60, 0x01000100
v_perm_b32 v192, v18, v18, s60
v_and_b32 v28, v192, v4
v_and_b32 v29, v192, v5
v_and_b32 v30, v192, v6
v_and_b32 v31, v192, v7
s_waitcnt vmcnt(15)
s_nop 0
v_mfma_f32_16x16x32_bf16 v[44:47], v[28:31], v[112:115], v[44:47]
s_mov_b32 s62, 98304
buffer_load_dwordx4 v[176:179], v9, s[44:47], s62 offen nt
s_mov_b32 s60, 0x03020302
v_perm_b32 v193, v18, v18, s60
v_and_b32 v32, v193, v4
v_and_b32 v33, v193, v5
v_and_b32 v34, v193, v6
v_and_b32 v35, v193, v7
s_waitcnt vmcnt(15)
s_nop 0
v_mfma_f32_16x16x32_bf16 v[44:47], v[32:35], v[116:119], v[44:47]
s_mov_b32 s62, 106496
buffer_load_dwordx4 v[180:183], v9, s[44:47], s62 offen nt
s_mov_b32 s60, 0x01000100
v_perm_b32 v192, v19, v19, s60
v_and_b32 v28, v192, v4
v_and_b32 v29, v192, v5
v_and_b32 v30, v192, v6
v_and_b32 v31, v192, v7
s_waitcnt vmcnt(15)
s_nop 0
v_mfma_f32_16x16x32_bf16 v[44:47], v[28:31], v[120:123], v[44:47]
s_mov_b32 s62, 114688
buffer_load_dwordx4 v[184:187], v9, s[44:47], s62 offen nt
s_mov_b32 s60, 0x03020302
v_perm_b32 v193, v19, v19, s60
v_and_b32 v32, v193, v4
v_and_b32 v33, v193, v5
v_and_b32 v34, v193, v6
v_and_b32 v35, v193, v7
s_waitcnt vmcnt(15)
s_nop 0
v_mfma_f32_16x16x32_bf16 v[44:47], v[32:35], v[124:127], v[44:47]
s_mov_b32 s62, 122880
buffer_load_dwordx4 v[188:191], v9, s[44:47], s62 offen nt
s_nop 1
v_lshrrev_b32 v192, 1, v3
v_lshlrev_b32 v192, 9, v192
v_lshl_add_u32 v192, v2, 5, v192
v_and_b32 v193, 1, v3
v_lshl_add_u32 v192, v193, 4, v192
s_lshl_b32 s63, s34, 10
v_add_u32 v192, s63, v192
s_nop 1
s_nop 5
ds_write_b128 v192, v[44:47] offset:0
s_waitcnt lgkmcnt(0)
s_barrier
s_cmp_ge_u32 s34, 4
s_cbranch_scc1 L_W_qskip
v_lshlrev_b32 v194, 2, v0
ds_read_b32 v196, v194 offset:0
ds_read_b32 v197, v194 offset:1024
ds_read_b32 v198, v194 offset:2048
ds_read_b32 v199, v194 offset:3072
ds_read_b32 v200, v194 offset:4096
ds_read_b32 v201, v194 offset:5120
ds_read_b32 v202, v194 offset:6144
ds_read_b32 v203, v194 offset:7168
s_waitcnt lgkmcnt(0)
v_add_f32 v196, v196, v197
v_add_f32 v196, v196, v198
v_add_f32 v196, v196, v199
v_add_f32 v196, v196, v200
v_add_f32 v196, v196, v201
v_add_f32 v196, v196, v202
v_add_f32 v196, v196, v203
v_cvt_pk_bf16_f32 v196, v196, v196
v_lshlrev_b32 v194, 1, v0
ds_write_b16 v194, v196 offset:8192
s_waitcnt lgkmcnt(0)
L_W_qskip:
s_barrier
s_waitcnt lgkmcnt(0)
s_add_u32 s88, s88, 0x9e3779b9
v_lshlrev_b32 v194, 4, v2
ds_read_b128 v[20:23], v194 offset:8192
ds_read_b128 v[24:27], v194 offset:8448
v_mov_b32 v200, 0
v_mov_b32 v201, 0
s_waitcnt lgkmcnt(0)
s_waitcnt vmcnt(14)
v_dot2_f32_bf16 v60, v128, v20, 0
v_dot2_f32_bf16 v61, v128, v24, 0
v_dot2_f32_bf16 v62, v132, v20, 0
v_dot2_f32_bf16 v63, v132, v24, 0
v_dot2_f32_bf16 v60, v129, v21, v60
v_dot2_f32_bf16 v61, v129, v25, v61
v_dot2_f32_bf16 v62, v133, v21, v62
v_dot2_f32_bf16 v63, v133, v25, v63
v_dot2_f32_bf16 v60, v130, v22, v60
v_dot2_f32_bf16 v61, v130, v26, v61
v_dot2_f32_bf16 v62, v134, v22, v62
v_dot2_f32_bf16 v63, v134, v26, v63
v_dot2_f32_bf16 v60, v131, v23, v60
v_dot2_f32_bf16 v61, v131, v27, v61
v_dot2_f32_bf16 v62, v135, v23, v62
v_dot2_f32_bf16 v63, v135, v27, v63
v_add_f32_dpp v60, v60, v60 row_ror:8 row_mask:0xf bank_mask:0xf
v_add_f32_dpp v61, v61, v61 row_ror:8 row_mask:0xf bank_mask:0xf
v_add_f32_dpp v62, v62, v62 row_ror:8 row_mask:0xf bank_mask:0xf
v_add_f32_dpp v63, v63, v63 row_ror:8 row_mask:0xf bank_mask:0xf
v_add_f32_dpp v60, v60, v60 row_ror:4 row_mask:0xf bank_mask:0xf
v_add_f32_dpp v61, v61, v61 row_ror:4 row_mask:0xf bank_mask:0xf
v_add_f32_dpp v62, v62, v62 row_ror:4 row_mask:0xf bank_mask:0xf
v_add_f32_dpp v63, v63, v63 row_ror:4 row_mask:0xf bank_mask:0xf
v_add_f32_dpp v60, v60, v60 row_ror:2 row_mask:0xf bank_mask:0xf
v_add_f32_dpp v61, v61, v61 row_ror:2 row_mask:0xf bank_mask:0xf
v_add_f32_dpp v62, v62, v62 row_ror:2 row_mask:0xf bank_mask:0xf
v_add_f32_dpp v63, v63, v63 row_ror:2 row_mask:0xf bank_mask:0xf
v_add_f32_dpp v60, v60, v60 row_ror:1 row_mask:0xf bank_mask:0xf
v_add_f32_dpp v61, v61, v61 row_ror:1 row_mask:0xf bank_mask:0xf
v_add_f32_dpp v62, v62, v62 row_ror:1 row_mask:0xf bank_mask:0xf
v_add_f32_dpp v63, v63, v63 row_ror:1 row_mask:0xf bank_mask:0xf
v_cmp_eq_u32 vcc, 0, v2
s_nop 1
v_cndmask_b32 v200, v200, v60, vcc
v_cndmask_b32 v201, v201, v61, vcc
v_cmp_eq_u32 vcc, 1, v2
s_nop 1
v_cndmask_b32 v200, v200, v62, vcc
v_cndmask_b32 v201, v201, v63, vcc
s_waitcnt vmcnt(12)
v_dot2_f32_bf16 v60, v136, v20, 0
v_dot2_f32_bf16 v61, v136, v24, 0
v_dot2_f32_bf16 v62, v140, v20, 0
v_dot2_f32_bf16 v63, v140, v24, 0
v_dot2_f32_bf16 v60, v137, v21, v60
v_dot2_f32_bf16 v61, v137, v25, v61
v_dot2_f32_bf16 v62, v141, v21, v62
v_dot2_f32_bf16 v63, v141, v25, v63
v_dot2_f32_bf16 v60, v138, v22, v60
v_dot2_f32_bf16 v61, v138, v26, v61
v_dot2_f32_bf16 v62, v142, v22, v62
v_dot2_f32_bf16 v63, v142, v26, v63
v_dot2_f32_bf16 v60, v139, v23, v60
v_dot2_f32_bf16 v61, v139, v27, v61
v_dot2_f32_bf16 v62, v143, v23, v62
v_dot2_f32_bf16 v63, v143, v27, v63
v_add_f32_dpp v60, v60, v60 row_ror:8 row_mask:0xf bank_mask:0xf
v_add_f32_dpp v61, v61, v61 row_ror:8 row_mask:0xf bank_mask:0xf
v_add_f32_dpp v62, v62, v62 row_ror:8 row_mask:0xf bank_mask:0xf
v_add_f32_dpp v63, v63, v63 row_ror:8 row_mask:0xf bank_mask:0xf
v_add_f32_dpp v60, v60, v60 row_ror:4 row_mask:0xf bank_mask:0xf
v_add_f32_dpp v61, v61, v61 row_ror:4 row_mask:0xf bank_mask:0xf
v_add_f32_dpp v62, v62, v62 row_ror:4 row_mask:0xf bank_mask:0xf
v_add_f32_dpp v63, v63, v63 row_ror:4 row_mask:0xf bank_mask:0xf
v_add_f32_dpp v60, v60, v60 row_ror:2 row_mask:0xf bank_mask:0xf
v_add_f32_dpp v61, v61, v61 row_ror:2 row_mask:0xf bank_mask:0xf
v_add_f32_dpp v62, v62, v62 row_ror:2 row_mask:0xf bank_mask:0xf
v_add_f32_dpp v63, v63, v63 row_ror:2 row_mask:0xf bank_mask:0xf
v_add_f32_dpp v60, v60, v60 row_ror:1 row_mask:0xf bank_mask:0xf
v_add_f32_dpp v61, v61, v61 row_ror:1 row_mask:0xf bank_mask:0xf
v_add_f32_dpp v62, v62, v62 row_ror:1 row_mask:0xf bank_mask:0xf
v_add_f32_dpp v63, v63, v63 row_ror:1 row_mask:0xf bank_mask:0xf
v_cmp_eq_u32 vcc, 2, v2
s_nop 1
v_cndmask_b32 v200, v200, v60, vcc
v_cndmask_b32 v201, v201, v61, vcc
v_cmp_eq_u32 vcc, 3, v2
s_nop 1
v_cndmask_b32 v200, v200, v62, vcc
v_cndmask_b32 v201, v201, v63, vcc
s_waitcnt vmcnt(10)
v_dot2_f32_bf16 v60, v144, v20, 0
v_dot2_f32_bf16 v61, v144, v24, 0
v_dot2_f32_bf16 v62, v148, v20, 0
v_dot2_f32_bf16 v63, v148, v24, 0
v_dot2_f32_bf16 v60, v145, v21, v60
v_dot2_f32_bf16 v61, v145, v25, v61
v_dot2_f32_bf16 v62, v149, v21, v62
v_dot2_f32_bf16 v63, v149, v25, v63
v_dot2_f32_bf16 v60, v146, v22, v60
v_dot2_f32_bf16 v61, v146, v26, v61
v_dot2_f32_bf16 v62, v150, v22, v62
v_dot2_f32_bf16 v63, v150, v26, v63
v_dot2_f32_bf16 v60, v147, v23, v60
v_dot2_f32_bf16 v61, v147, v27, v61
v_dot2_f32_bf16 v62, v151, v23, v62
v_dot2_f32_bf16 v63, v151, v27, v63
v_add_f32_dpp v60, v60, v60 row_ror:8 row_mask:0xf bank_mask:0xf
v_add_f32_dpp v61, v61, v61 row_ror:8 row_mask:0xf bank_mask:0xf
v_add_f32_dpp v62, v62, v62 row_ror:8 row_mask:0xf bank_mask:0xf
v_add_f32_dpp v63, v63, v63 row_ror:8 row_mask:0xf bank_mask:0xf
v_add_f32_dpp v60, v60, v60 row_ror:4 row_mask:0xf bank_mask:0xf
v_add_f32_dpp v61, v61, v61 row_ror:4 row_mask:0xf bank_mask:0xf
v_add_f32_dpp v62, v62, v62 row_ror:4 row_mask:0xf bank_mask:0xf
v_add_f32_dpp v63, v63, v63 row_ror:4 row_mask:0xf bank_mask:0xf
v_add_f32_dpp v60, v60, v60 row_ror:2 row_mask:0xf bank_mask:0xf
v_add_f32_dpp v61, v61, v61 row_ror:2 row_mask:0xf bank_mask:0xf
v_add_f32_dpp v62, v62, v62 row_ror:2 row_mask:0xf bank_mask:0xf
v_add_f32_dpp v63, v63, v63 row_ror:2 row_mask:0xf bank_mask:0xf
v_add_f32_dpp v60, v60, v60 row_ror:1 row_mask:0xf bank_mask:0xf
v_add_f32_dpp v61, v61, v61 row_ror:1 row_mask:0xf bank_mask:0xf
v_add_f32_dpp v62, v62, v62 row_ror:1 row_mask:0xf bank_mask:0xf
v_add_f32_dpp v63, v63, v63 row_ror:1 row_mask:0xf bank_mask:0xf
v_cmp_eq_u32 vcc, 4, v2
s_nop 1
v_cndmask_b32 v200, v200, v60, vcc
v_cndmask_b32 v201, v201, v61, vcc
v_cmp_eq_u32 vcc, 5, v2
s_nop 1
v_cndmask_b32 v200, v200, v62, vcc
v_cndmask_b32 v201, v201, v63, vcc
s_waitcnt vmcnt(8)
v_dot2_f32_bf16 v60, v152, v20, 0
v_dot2_f32_bf16 v61, v152, v24, 0
v_dot2_f32_bf16 v62, v156, v20, 0
v_dot2_f32_bf16 v63, v156, v24, 0
v_dot2_f32_bf16 v60, v153, v21, v60
v_dot2_f32_bf16 v61, v153, v25, v61
v_dot2_f32_bf16 v62, v157, v21, v62
v_dot2_f32_bf16 v63, v157, v25, v63
v_dot2_f32_bf16 v60, v154, v22, v60
v_dot2_f32_bf16 v61, v154, v26, v61
v_dot2_f32_bf16 v62, v158, v22, v62
v_dot2_f32_bf16 v63, v158, v26, v63
v_dot2_f32_bf16 v60, v155, v23, v60
v_dot2_f32_bf16 v61, v155, v27, v61
v_dot2_f32_bf16 v62, v159, v23, v62
v_dot2_f32_bf16 v63, v159, v27, v63
v_add_f32_dpp v60, v60, v60 row_ror:8 row_mask:0xf bank_mask:0xf
v_add_f32_dpp v61, v61, v61 row_ror:8 row_mask:0xf bank_mask:0xf
v_add_f32_dpp v62, v62, v62 row_ror:8 row_mask:0xf bank_mask:0xf
v_add_f32_dpp v63, v63, v63 row_ror:8 row_mask:0xf bank_mask:0xf
v_add_f32_dpp v60, v60, v60 row_ror:4 row_mask:0xf bank_mask:0xf
v_add_f32_dpp v61, v61, v61 row_ror:4 row_mask:0xf bank_mask:0xf
v_add_f32_dpp v62, v62, v62 row_ror:4 row_mask:0xf bank_mask:0xf
v_add_f32_dpp v63, v63, v63 row_ror:4 row_mask:0xf bank_mask:0xf
v_add_f32_dpp v60, v60, v60 row_ror:2 row_mask:0xf bank_mask:0xf
v_add_f32_dpp v61, v61, v61 row_ror:2 row_mask:0xf bank_mask:0xf
v_add_f32_dpp v62, v62, v62 row_ror:2 row_mask:0xf bank_mask:0xf
v_add_f32_dpp v63, v63, v63 row_ror:2 row_mask:0xf bank_mask:0xf
v_add_f32_dpp v60, v60, v60 row_ror:1 row_mask:0xf bank_mask:0xf
v_add_f32_dpp v61, v61, v61 row_ror:1 row_mask:0xf bank_mask:0xf
v_add_f32_dpp v62, v62, v62 row_ror:1 row_mask:0xf bank_mask:0xf
v_add_f32_dpp v63, v63, v63 row_ror:1 row_mask:0xf bank_mask:0xf
v_cmp_eq_u32 vcc, 6, v2
s_nop 1
v_cndmask_b32 v200, v200, v60, vcc
v_cndmask_b32 v201, v201, v61, vcc
v_cmp_eq_u32 vcc, 7, v2
s_nop 1
v_cndmask_b32 v200, v200, v62, vcc
v_cndmask_b32 v201, v201, v63, vcc
s_waitcnt vmcnt(6)
v_dot2_f32_bf16 v60, v160, v20, 0
v_dot2_f32_bf16 v61, v160, v24, 0
v_dot2_f32_bf16 v62, v164, v20, 0
v_dot2_f32_bf16 v63, v164, v24, 0
v_dot2_f32_bf16 v60, v161, v21, v60
v_dot2_f32_bf16 v61, v161, v25, v61
v_dot2_f32_bf16 v62, v165, v21, v62
v_dot2_f32_bf16 v63, v165, v25, v63
v_dot2_f32_bf16 v60, v162, v22, v60
v_dot2_f32_bf16 v61, v162, v26, v61
v_dot2_f32_bf16 v62, v166, v22, v62
v_dot2_f32_bf16 v63, v166, v26, v63
v_dot2_f32_bf16 v60, v163, v23, v60
v_dot2_f32_bf16 v61, v163, v27, v61
v_dot2_f32_bf16 v62, v167, v23, v62
v_dot2_f32_bf16 v63, v167, v27, v63
v_add_f32_dpp v60, v60, v60 row_ror:8 row_mask:0xf bank_mask:0xf
v_add_f32_dpp v61, v61, v61 row_ror:8 row_mask:0xf bank_mask:0xf
v_add_f32_dpp v62, v62, v62 row_ror:8 row_mask:0xf bank_mask:0xf
v_add_f32_dpp v63, v63, v63 row_ror:8 row_mask:0xf bank_mask:0xf
v_add_f32_dpp v60, v60, v60 row_ror:4 row_mask:0xf bank_mask:0xf
v_add_f32_dpp v61, v61, v61 row_ror:4 row_mask:0xf bank_mask:0xf
v_add_f32_dpp v62, v62, v62 row_ror:4 row_mask:0xf bank_mask:0xf
v_add_f32_dpp v63, v63, v63 row_ror:4 row_mask:0xf bank_mask:0xf
v_add_f32_dpp v60, v60, v60 row_ror:2 row_mask:0xf bank_mask:0xf
v_add_f32_dpp v61, v61, v61 row_ror:2 row_mask:0xf bank_mask:0xf
v_add_f32_dpp v62, v62, v62 row_ror:2 row_mask:0xf bank_mask:0xf
v_add_f32_dpp v63, v63, v63 row_ror:2 row_mask:0xf bank_mask:0xf
v_add_f32_dpp v60, v60, v60 row_ror:1 row_mask:0xf bank_mask:0xf
v_add_f32_dpp v61, v61, v61 row_ror:1 row_mask:0xf bank_mask:0xf
v_add_f32_dpp v62, v62, v62 row_ror:1 row_mask:0xf bank_mask:0xf
v_add_f32_dpp v63, v63, v63 row_ror:1 row_mask:0xf bank_mask:0xf
v_cmp_eq_u32 vcc, 8, v2
s_nop 1
v_cndmask_b32 v200, v200, v60, vcc
v_cndmask_b32 v201, v201, v61, vcc
v_cmp_eq_u32 vcc, 9, v2
s_nop 1
v_cndmask_b32 v200, v200, v62, vcc
v_cndmask_b32 v201, v201, v63, vcc
s_waitcnt vmcnt(4)
v_dot2_f32_bf16 v60, v168, v20, 0
v_dot2_f32_bf16 v61, v168, v24, 0
v_dot2_f32_bf16 v62, v172, v20, 0
v_dot2_f32_bf16 v63, v172, v24, 0
v_dot2_f32_bf16 v60, v169, v21, v60
v_dot2_f32_bf16 v61, v169, v25, v61
v_dot2_f32_bf16 v62, v173, v21, v62
v_dot2_f32_bf16 v63, v173, v25, v63
v_dot2_f32_bf16 v60, v170, v22, v60
v_dot2_f32_bf16 v61, v170, v26, v61
v_dot2_f32_bf16 v62, v174, v22, v62
v_dot2_f32_bf16 v63, v174, v26, v63
v_dot2_f32_bf16 v60, v171, v23, v60
v_dot2_f32_bf16 v61, v171, v27, v61
v_dot2_f32_bf16 v62, v175, v23, v62
v_dot2_f32_bf16 v63, v175, v27, v63
v_add_f32_dpp v60, v60, v60 row_ror:8 row_mask:0xf bank_mask:0xf
v_add_f32_dpp v61, v61, v61 row_ror:8 row_mask:0xf bank_mask:0xf
v_add_f32_dpp v62, v62, v62 row_ror:8 row_mask:0xf bank_mask:0xf
v_add_f32_dpp v63, v63, v63 row_ror:8 row_mask:0xf bank_mask:0xf
v_add_f32_dpp v60, v60, v60 row_ror:4 row_mask:0xf bank_mask:0xf
v_add_f32_dpp v61, v61, v61 row_ror:4 row_mask:0xf bank_mask:0xf
v_add_f32_dpp v62, v62, v62 row_ror:4 row_mask:0xf bank_mask:0xf
v_add_f32_dpp v63, v63, v63 row_ror:4 row_mask:0xf bank_mask:0xf
v_add_f32_dpp v60, v60, v60 row_ror:2 row_mask:0xf bank_mask:0xf
v_add_f32_dpp v61, v61, v61 row_ror:2 row_mask:0xf bank_mask:0xf
v_add_f32_dpp v62, v62, v62 row_ror:2 row_mask:0xf bank_mask:0xf
v_add_f32_dpp v63, v63, v63 row_ror:2 row_mask:0xf bank_mask:0xf
v_add_f32_dpp v60, v60, v60 row_ror:1 row_mask:0xf bank_mask:0xf
v_add_f32_dpp v61, v61, v61 row_ror:1 row_mask:0xf bank_mask:0xf
v_add_f32_dpp v62, v62, v62 row_ror:1 row_mask:0xf bank_mask:0xf
v_add_f32_dpp v63, v63, v63 row_ror:1 row_mask:0xf bank_mask:0xf
v_cmp_eq_u32 vcc, 10, v2
s_nop 1
v_cndmask_b32 v200, v200, v60, vcc
v_cndmask_b32 v201, v201, v61, vcc
v_cmp_eq_u32 vcc, 11, v2
s_nop 1
v_cndmask_b32 v200, v200, v62, vcc
v_cndmask_b32 v201, v201, v63, vcc
s_waitcnt vmcnt(2)
v_dot2_f32_bf16 v60, v176, v20, 0
v_dot2_f32_bf16 v61, v176, v24, 0
v_dot2_f32_bf16 v62, v180, v20, 0
v_dot2_f32_bf16 v63, v180, v24, 0
v_dot2_f32_bf16 v60, v177, v21, v60
v_dot2_f32_bf16 v61, v177, v25, v61
v_dot2_f32_bf16 v62, v181, v21, v62
v_dot2_f32_bf16 v63, v181, v25, v63
v_dot2_f32_bf16 v60, v178, v22, v60
v_dot2_f32_bf16 v61, v178, v26, v61
v_dot2_f32_bf16 v62, v182, v22, v62
v_dot2_f32_bf16 v63, v182, v26, v63
v_dot2_f32_bf16 v60, v179, v23, v60
v_dot2_f32_bf16 v61, v179, v27, v61
v_dot2_f32_bf16 v62, v183, v23, v62
v_dot2_f32_bf16 v63, v183, v27, v63
v_add_f32_dpp v60, v60, v60 row_ror:8 row_mask:0xf bank_mask:0xf
v_add_f32_dpp v61, v61, v61 row_ror:8 row_mask:0xf bank_mask:0xf
v_add_f32_dpp v62, v62, v62 row_ror:8 row_mask:0xf bank_mask:0xf
v_add_f32_dpp v63, v63, v63 row_ror:8 row_mask:0xf bank_mask:0xf
v_add_f32_dpp v60, v60, v60 row_ror:4 row_mask:0xf bank_mask:0xf
v_add_f32_dpp v61, v61, v61 row_ror:4 row_mask:0xf bank_mask:0xf
v_add_f32_dpp v62, v62, v62 row_ror:4 row_mask:0xf bank_mask:0xf
v_add_f32_dpp v63, v63, v63 row_ror:4 row_mask:0xf bank_mask:0xf
v_add_f32_dpp v60, v60, v60 row_ror:2 row_mask:0xf bank_mask:0xf
v_add_f32_dpp v61, v61, v61 row_ror:2 row_mask:0xf bank_mask:0xf
v_add_f32_dpp v62, v62, v62 row_ror:2 row_mask:0xf bank_mask:0xf
v_add_f32_dpp v63, v63, v63 row_ror:2 row_mask:0xf bank_mask:0xf
v_add_f32_dpp v60, v60, v60 row_ror:1 row_mask:0xf bank_mask:0xf
v_add_f32_dpp v61, v61, v61 row_ror:1 row_mask:0xf bank_mask:0xf
v_add_f32_dpp v62, v62, v62 row_ror:1 row_mask:0xf bank_mask:0xf
v_add_f32_dpp v63, v63, v63 row_ror:1 row_mask:0xf bank_mask:0xf
v_cmp_eq_u32 vcc, 12, v2
s_nop 1
v_cndmask_b32 v200, v200, v60, vcc
v_cndmask_b32 v201, v201, v61, vcc
v_cmp_eq_u32 vcc, 13, v2
s_nop 1
v_cndmask_b32 v200, v200, v62, vcc
v_cndmask_b32 v201, v201, v63, vcc
s_waitcnt vmcnt(0)
v_dot2_f32_bf16 v60, v184, v20, 0
v_dot2_f32_bf16 v61, v184, v24, 0
v_dot2_f32_bf16 v62, v188, v20, 0
v_dot2_f32_bf16 v63, v188, v24, 0
v_dot2_f32_bf16 v60, v185, v21, v60
v_dot2_f32_bf16 v61, v185, v25, v61
v_dot2_f32_bf16 v62, v189, v21, v62
v_dot2_f32_bf16 v63, v189, v25, v63
v_dot2_f32_bf16 v60, v186, v22, v60
v_dot2_f32_bf16 v61, v186, v26, v61
v_dot2_f32_bf16 v62, v190, v22, v62
v_dot2_f32_bf16 v63, v190, v26, v63
v_dot2_f32_bf16 v60, v187, v23, v60
v_dot2_f32_bf16 v61, v187, v27, v61
v_dot2_f32_bf16 v62, v191, v23, v62
v_dot2_f32_bf16 v63, v191, v27, v63
v_add_f32_dpp v60, v60, v60 row_ror:8 row_mask:0xf bank_mask:0xf
v_add_f32_dpp v61, v61, v61 row_ror:8 row_mask:0xf bank_mask:0xf
v_add_f32_dpp v62, v62, v62 row_ror:8 row_mask:0xf bank_mask:0xf
v_add_f32_dpp v63, v63, v63 row_ror:8 row_mask:0xf bank_mask:0xf
v_add_f32_dpp v60, v60, v60 row_ror:4 row_mask:0xf bank_mask:0xf
v_add_f32_dpp v61, v61, v61 row_ror:4 row_mask:0xf bank_mask:0xf
v_add_f32_dpp v62, v62, v62 row_ror:4 row_mask:0xf bank_mask:0xf
v_add_f32_dpp v63, v63, v63 row_ror:4 row_mask:0xf bank_mask:0xf
v_add_f32_dpp v60, v60, v60 row_ror:2 row_mask:0xf bank_mask:0xf
v_add_f32_dpp v61, v61, v61 row_ror:2 row_mask:0xf bank_mask:0xf
v_add_f32_dpp v62, v62, v62 row_ror:2 row_mask:0xf bank_mask:0xf
v_add_f32_dpp v63, v63, v63 row_ror:2 row_mask:0xf bank_mask:0xf
v_add_f32_dpp v60, v60, v60 row_ror:1 row_mask:0xf bank_mask:0xf
v_add_f32_dpp v61, v61, v61 row_ror:1 row_mask:0xf bank_mask:0xf
v_add_f32_dpp v62, v62, v62 row_ror:1 row_mask:0xf bank_mask:0xf
v_add_f32_dpp v63, v63, v63 row_ror:1 row_mask:0xf bank_mask:0xf
v_cmp_eq_u32 vcc, 14, v2
s_nop 1
v_cndmask_b32 v200, v200, v60, vcc
v_cndmask_b32 v201, v201, v61, vcc
v_cmp_eq_u32 vcc, 15, v2
s_nop 1
v_cndmask_b32 v200, v200, v62, vcc
v_cndmask_b32 v201, v201, v63, vcc
v_cvt_pk_bf16_f32 v200, v200, v200
v_cvt_pk_bf16_f32 v201, v201, v201
s_lshl_b32 s62, s32, 10
s_lshl_b32 s63, s34, 7
s_add_u32 s62, s62, s63
s_add_u32 s62, s62, 0x0
v_lshl_add_u32 v192, v1, 1, s62
buffer_store_short v200, v192, s[52:55], 0 offen sc1
s_mov_b32 s62, 32768
buffer_store_short v201, v192, s[52:55], s62 offen sc1
s_lshl_b32 s62, s32, 8
s_add_u32 s62, s62, 0x1a000
v_lshl_add_u32 v192, v1, 2, s62
v_mov_b32 v193, s88
s_waitcnt vmcnt(0)
s_barrier
s_cmp_lg_u32 s34, 0
s_cbranch_scc1 L_sig_Wq
s_mov_b32 exec_hi, 0
buffer_store_dword v193, v192, s[52:55], 0 offen sc1
s_mov_b64 exec, -1
L_sig_Wq:
s_lshl_b32 s60, s32, 8
s_sub_u32 s61, 0x400000, s60
s_add_u32 s40, s22, s60
s_addc_u32 s41, s23, 0
s_and_b32 s41, s41, 0xffff
s_mov_b32 s42, s61
s_mov_b32 s43, 0x20000
s_lshl_b32 s60, s32, 17
s_mov_b32 s61, 0x20000
s_add_u32 s44, s24, s60
s_addc_u32 s45, s25, 0
s_and_b32 s45, s45, 0xffff
s_mov_b32 s46, s61
s_mov_b32 s47, 0x20000
v_lshlrev_b32 v10, 12, v3
v_lshl_add_u32 v10, v2, 4, v10
s_lshl_b32 s62, s34, 14
v_add_u32 v10, s62, v10
s_waitcnt vmcnt(2)
s_mov_b32 s62, 0
buffer_load_dwordx4 v[64:67], v9, s[40:43], s62 offen nt
s_waitcnt vmcnt(2)
s_mov_b32 s62, 8192
buffer_load_dwordx4 v[68:71], v9, s[40:43], s62 offen nt
s_waitcnt vmcnt(2)
s_mov_b32 s62, 16384
buffer_load_dwordx4 v[72:75], v9, s[40:43], s62 offen nt
s_waitcnt vmcnt(2)
s_mov_b32 s62, 24576
buffer_load_dwordx4 v[76:79], v9, s[40:43], s62 offen nt
s_waitcnt vmcnt(2)
s_mov_b32 s62, 32768
buffer_load_dwordx4 v[80:83], v9, s[40:43], s62 offen nt
s_waitcnt vmcnt(2)
s_mov_b32 s62, 40960
buffer_load_dwordx4 v[84:87], v9, s[40:43], s62 offen nt
s_waitcnt vmcnt(2)
s_mov_b32 s62, 49152
buffer_load_dwordx4 v[88:91], v9, s[40:43], s62 offen nt
s_waitcnt vmcnt(2)
s_mov_b32 s62, 57344
buffer_load_dwordx4 v[92:95], v9, s[40:43], s62 offen nt
s_waitcnt vmcnt(2)
s_mov_b32 s62, 65536
buffer_load_dwordx4 v[96:99], v9, s[40:43], s62 offen nt
s_waitcnt vmcnt(2)
s_mov_b32 s62, 73728
buffer_load_dwordx4 v[100:103], v9, s[40:43], s62 offen nt
s_waitcnt vmcnt(2)
s_mov_b32 s62, 81920
buffer_load_dwordx4 v[104:107], v9, s[40:43], s62 offen nt
s_waitcnt vmcnt(2)
s_mov_b32 s62, 90112
buffer_load_dwordx4 v[108:111], v9, s[40:43], s62 offen nt
s_waitcnt vmcnt(2)
s_mov_b32 s62, 98304
buffer_load_dwordx4 v[112:115], v9, s[40:43], s62 offen nt
s_waitcnt vmcnt(2)
s_mov_b32 s62, 106496
buffer_load_dwordx4 v[116:119], v9, s[40:43], s62 offen nt
s_waitcnt vmcnt(2)
s_mov_b32 s62, 114688
buffer_load_dwordx4 v[120:123], v9, s[40:43], s62 offen nt
s_waitcnt vmcnt(2)
s_mov_b32 s62, 122880
buffer_load_dwordx4 v[124:127], v9, s[40:43], s62 offen nt
s_waitcnt vmcnt(2)
buffer_load_dwordx4 v[128:131], v10, s[44:47], 0 offen offset:0 nt
s_waitcnt vmcnt(2)
buffer_load_dwordx4 v[132:135], v10, s[44:47], 0 offen offset:256 nt
s_waitcnt vmcnt(2)
buffer_load_dwordx4 v[136:139], v10, s[44:47], 0 offen offset:512 nt
s_waitcnt vmcnt(2)
buffer_load_dwordx4 v[140:143], v10, s[44:47], 0 offen offset:768 nt
s_waitcnt vmcnt(2)
buffer_load_dwordx4 v[144:147], v10, s[44:47], 0 offen offset:1024 nt
s_waitcnt vmcnt(2)
buffer_load_dwordx4 v[148:151], v10, s[44:47], 0 offen offset:1280 nt
s_waitcnt vmcnt(2)
buffer_load_dwordx4 v[152:155], v10, s[44:47], 0 offen offset:1536 nt
s_waitcnt vmcnt(2)
buffer_load_dwordx4 v[156:159], v10, s[44:47], 0 offen offset:1792 nt
s_waitcnt vmcnt(2)
buffer_load_dwordx4 v[160:163], v10, s[44:47], 0 offen offset:2048 nt
s_waitcnt vmcnt(2)
buffer_load_dwordx4 v[164:167], v10, s[44:47], 0 offen offset:2304 nt
s_waitcnt vmcnt(2)
buffer_load_dwordx4 v[168:171], v10, s[44:47], 0 offen offset:2560 nt
s_waitcnt vmcnt(2)
buffer_load_dwordx4 v[172:175], v10, s[44:47], 0 offen offset:2816 nt
s_waitcnt vmcnt(2)
buffer_load_dwordx4 v[176:179], v10, s[44:47], 0 offen offset:3072 nt
s_waitcnt vmcnt(2)
buffer_load_dwordx4 v[180:183], v10, s[44:47], 0 offen offset:3328 nt
s_waitcnt vmcnt(2)
buffer_load_dwordx4 v[184:187], v10, s[44:47], 0 offen offset:3584 nt
s_waitcnt vmcnt(2)
buffer_load_dwordx4 v[188:191], v10, s[44:47], 0 offen offset:3840 nt
s_cmp_lg_u32 s34, 7
s_cbranch_scc1 L_W_nogm
s_cmp_ge_u32 s32, 8
s_cbranch_scc1 L_W_nogm
s_and_b32 s63, s32, 7
s_mul_i32 s63, s63, 0x100
s_add_u32 s63, s63, 0xc0000
s_add_u32 s56, s30, s63
s_addc_u32 s57, s31, 0
s_mov_b32 s64, 0
s_mov_b32 s59, 0
s_mov_b32 s58, 0
s_lshl_b32 s62, s32, 12
s_add_u32 s62, s62, 0xd0000
v_lshl_add_u32 v204, v1, 4, s62
v_lshrrev_b32 v205, 2, v1
s_mov_b32 s62, 0xd0000
v_lshl_add_u32 v205, v205, 12, s62
v_and_b32 v206, 3, v1
v_lshlrev_b32 v208, 2, v1
v_mov_b32 v211, 0
L_gm_W:
s_mov_b32 exec_lo, -1
s_mov_b32 exec_hi, 0
v_add_u32 v207, s58, v206
v_and_b32 v207, 15, v207
v_lshl_add_u32 v207, v207, 8, v205
global_load_dword v210, v207, s[30:31] sc1
s_mov_b64 exec, 0x1ffffff
global_load_dword v209, v208, s[56:57] nt
s_waitcnt vmcnt(0)
v_subrev_u32 v209, s88, v209
s_mov_b64 exec, 0xffffff
v_cmp_le_u32 vcc, 0x400, v209
v_readlane_b32 s62, v209, 24
v_add_u32_dpp v209, v209, v209 row_shr:1 row_mask:0xf bank_mask:0xf bound_ctrl:0
s_nop 1
v_add_u32_dpp v209, v209, v209 row_shr:2 row_mask:0xf bank_mask:0xf bound_ctrl:0
s_nop 1
v_add_u32_dpp v209, v209, v209 row_shr:4 row_mask:0xf bank_mask:0xf bound_ctrl:0
s_nop 1
v_add_u32_dpp v209, v209, v209 row_shr:8 row_mask:0xf bank_mask:0xf bound_ctrl:0
s_nop 0
v_readlane_b32 s61, v209, 15
v_readlane_b32 s63, v209, 23
s_add_u32 s61, s61, s63
s_mov_b64 exec, 0xff
s_cbranch_vccnz L_gm_W_next
s_add_u32 s63, s61, s88
v_mov_b32 v200, s63
v_mov_b32 v201, s63
v_mov_b32 v202, s63
v_mov_b32 v203, s63
s_lshr_b32 s58, s61, 9
s_and_b32 s63, s58, 15
s_lshl_b32 s63, s63, 8
v_add_u32 v207, s63, v204
s_sub_u32 s58, s58, 2
global_store_dwordx4 v207, v[200:203], s[30:31] sc1
s_mul_i32 s63, s61, 0
s_mul_i32 s65, s59, 8
s_add_u32 s65, s65, s63
s_cmp_eq_u32 s59, 0
s_mov_b32 s59, s61
s_cbranch_scc1 L_gm_W_next
s_mov_b32 exec_lo, -1
v_subrev_u32 v210, s88, v210
v_cmp_gt_u32 vcc, 0x8000, v210
s_nop 1
v_cndmask_b32 v210, 0, v210, vcc
v_max_u32 v211, v211, v210
s_nop 1
v_max_u32_dpp v211, v211, v211 quad_perm:[1,0,3,2] row_mask:0xf bank_mask:0xf
s_nop 1
v_max_u32_dpp v211, v211, v211 quad_perm:[2,3,0,1] row_mask:0xf bank_mask:0xf
v_cmp_eq_u32 vcc, 0, v211
s_nop 0
v_add_u32_dpp v210, v211, v211 row_shr:4 row_mask:0xf bank_mask:0xf bound_ctrl:0
s_nop 1
v_add_u32_dpp v210, v210, v210 row_shr:8 row_mask:0xf bank_mask:0xf bound_ctrl:0
s_cbranch_vccnz L_gm_W_next
s_nop 0
v_readlane_b32 s63, v210, 15
v_readlane_b32 s62, v210, 31
s_add_u32 s63, s63, s62
s_sub_u32 s63, s63, s65
s_ashr_i32 s63, s63, 3
s_add_u32 s63, s63, 0x4000
s_add_u32 s63, s63, s88
s_mov_b64 exec, 0x1000000
v_mov_b32 v212, s63
global_store_dword v208, v212, s[56:57]
L_gm_W_next:
ds_read_b32 v209, v8 offset:8704
s_waitcnt lgkmcnt(0)
v_readfirstlane_b32 s63, v209
s_cmp_eq_u32 s63, s88
s_cbranch_scc1 L_gm_W_x
s_add_u32 s64, s64, 1
s_cmp_lt_u32 s64, 128
s_cbranch_scc1 L_gm_W
L_gm_W_x:
s_mov_b64 exec, -1
L_W_nogm:
s_cmp_lg_u32 s34, 6
s_cbranch_scc1 L_W_noas
s_and_b32 s63, s32, 7
s_mul_i32 s63, s63, 0x100
s_add_u32 s63, s63, 0xc0000
s_add_u32 s56, s30, s63
s_addc_u32 s57, s31, 0
s_lshl_b32 s62, s32, 21
s_sub_u32 s63, 0x8000000, s62
s_add_u32 s68, s6, s62
s_addc_u32 s69, s7, 0
s_and_b32 s69, s69, 0xffff
s_mov_b32 s70, s63
s_mov_b32 s71, 0x20000
s_add_u32 s72, s8, s62
s_addc_u32 s73, s9, 0
s_and_b32 s73, s73, 0xffff
s_mov_b32 s74, s63
s_mov_b32 s75, 0x20000
s_mov_b64 s[76:77], s[68:69]
s_mov_b64 s[78:79], s[70:71]
s_lshr_b32 s62, s32, 3
s_mul_i32 s62, s62, 6
s_sub_u32 s62, s62, 32
v_add_u32 v208, s62, v1
v_cmp_gt_u32 vcc, 32, v1
v_lshlrev_b32 v205, 7, v1
v_add_u32 v206, 0x4000000, v205
v_cndmask_b32 v200, v208, v1, vcc
v_lshlrev_b32 v200, 2, v200
v_mov_b32 v204, 0
s_mov_b32 s64, 0
L_as_W:
s_mov_b64 exec, 0x1ffffff
s_mov_b32 exec_hi, 0x3f
global_load_dword v201, v200, s[56:57] nt
s_waitcnt vmcnt(0)
v_subrev_u32 v201, s88, v201
s_mov_b64 exec, 0xffffff
v_cmp_le_u32 vcc, 0x400, v201
v_readlane_b32 s62, v201, 24
v_add_u32_dpp v201, v201, v201 row_shr:1 row_mask:0xf bank_mask:0xf bound_ctrl:0
s_nop 1
v_add_u32_dpp v201, v201, v201 row_shr:2 row_mask:0xf bank_mask:0xf bound_ctrl:0
s_nop 1
v_add_u32_dpp v201, v201, v201 row_shr:4 row_mask:0xf bank_mask:0xf bound_ctrl:0
s_nop 1
v_add_u32_dpp v201, v201, v201 row_shr:8 row_mask:0xf bank_mask:0xf bound_ctrl:0
s_nop 0
v_readlane_b32 s61, v201, 15
v_readlane_b32 s63, v201, 23
s_add_u32 s61, s61, s63
s_cbranch_vccnz L_as_W_idle
s_sub_u32 s61, s61, 120
s_mov_b32 exec_lo, 0
s_mov_b32 exec_hi, 0x3f
v_cmp_gt_u32 vcc, 280, v201
v_add_u32 v202, 56, v201
s_nop 0
v_cndmask_b32 v208, 0, 8, vcc
v_add_u32 v202, v202, v208
v_lshrrev_b32 v202, 4, v202
v_sub_u32 v208, v202, v204
v_cmp_gt_i32 vcc, 4, v208
v_cmp_le_i32 s[66:67], 2, v208
s_nop 0
v_cndmask_b32 v203, 0, 7, vcc
v_cmp_ge_u32 vcc, 41, v202
v_add_u32 v203, v203, v201
v_lshl_add_u32 v203, v203, 6, v1
s_and_b64 vcc, vcc, s[66:67]
v_cndmask_b32 v203, -1, v203, vcc
s_nop 1
v_min_u32_dpp v203, v203, v203 row_shr:1 row_mask:0xf bank_mask:0xf
s_nop 1
v_min_u32_dpp v203, v203, v203 row_shr:2 row_mask:0xf bank_mask:0xf
s_nop 1
v_min_u32_dpp v203, v203, v203 row_shr:4 row_mask:0xf bank_mask:0xf
s_nop 0
v_readlane_b32 s63, v203, 37
s_lshr_b32 s65, s63, 6
s_and_b32 s63, s63, 63
s_mul_i32 s65, s65, 24
s_cmp_ge_i32 s65, s61
s_cbranch_scc1 L_as_W_idle
v_readlane_b32 s65, v202, s63
s_mov_b32 m0, s63
s_mov_b64 exec, -1
s_cmp_lt_u32 s65, 21
s_cselect_b64 s[76:77], s[68:69], s[72:73]
v_writelane_b32 v204, s65, m0
s_cselect_b32 s66, 0, 21
s_sub_u32 s65, s65, s66
s_mul_i32 s65, s65, 0x18000
s_and_b32 s63, s63, 7
s_lshl_b32 s63, s63, 14
s_add_u32 s65, s65, s63
s_add_u32 s66, s65, 0x2000
buffer_load_dword v207, v205, s[76:79], s65 offen
buffer_load_dword v207, v205, s[76:79], s66 offen
buffer_load_dword v207, v206, s[76:79], s65 offen
buffer_load_dword v207, v206, s[76:79], s66 offen
s_waitcnt vmcnt(1)
s_branch L_as_W_next
L_as_W_idle:
s_sleep 4
L_as_W_next:
s_mov_b64 exec, 1
ds_read_b32 v208, v8 offset:8704
s_waitcnt lgkmcnt(0)
v_readfirstlane_b32 s63, v208
s_cmp_eq_u32 s63, s88
s_cbranch_scc1 L_as_W_x
s_add_u32 s64, s64, 1
s_cmp_lt_u32 s64, 96
s_cbranch_scc1 L_as_W
L_as_W_x:
s_mov_b64 exec, -1
s_waitcnt vmcnt(0)
L_W_noas:
s_cmp_lg_u32 s34, 0
s_cbranch_scc1 L_wc_Wc
s_lshl_b32 s62, s32, 4
s_add_u32 s62, s62, 0x10000
v_and_b32 v193, 31, v1
v_lshl_add_u32 v192, v193, 9, s62
s_lshl_b64 exec, 1, s32
s_mov_b32 s64, 0
L_tp_Wc0:
buffer_load_dwordx4 v[196:199], v192, s[52:55], 0 offen sc1
s_waitcnt vmcnt(0)
v_cmp_ne_u32 s[62:63], s88, v197
v_cmp_ne_u32 vcc, s88, v199
s_add_u32 s64, s64, 1
s_nop 0
s_or_b64 vcc, vcc, s[62:63]
s_cbranch_scc0 L_tp_Wc0_ok
s_sleep 32
s_cmp_lt_u32 s64, 65536
s_cbranch_scc1 L_tp_Wc0
L_tp_Wc0_ok:
s_mov_b32 exec_lo, -1
s_mov_b32 exec_hi, 0
s_mov_b32 s64, 0
L_tp_Wc:
buffer_load_dwordx4 v[196:199], v192, s[52:55], 0 offen sc1
s_waitcnt vmcnt(0)
v_cmp_ne_u32 s[62:63], s88, v197
v_cmp_ne_u32 vcc, s88, v199
s_add_u32 s64, s64, 1
s_nop 0
s_or_b64 vcc, vcc, s[62:63]
s_cbranch_scc0 L_tp_Wc_ok
s_mov_b64 exec, vcc
s_sleep 8
s_cmp_lt_u32 s64, 65536
s_cbranch_scc1 L_tp_Wc
L_tp_Wc_ok:
s_mov_b32 exec_lo, -1
s_mov_b32 exec_hi, 0
v_lshlrev_b32 v193, 3, v193
v_mov_b32 v197, v198
ds_write_b64 v193, v[196:197] offset:8192
v_mov_b32 v199, s88
ds_write_b32 v8, v199 offset:8704
s_mov_b64 exec, -1
s_waitcnt lgkmcnt(0)
L_wc_Wc:
s_barrier
s_lshr_b32 s35, s34, 2
s_and_b32 s36, s34, 3
s_lshl_b32 s62, s35, 5
s_add_u32 s62, s62, s32
s_lshl_b32 s63, s62, 7
s_add_u32 s63, s63, 0x10000
v_lshl_add_u32 v192, v2, 3, s63
s_lshl_b32 s63, s35, 7
v_lshl_add_u32 v192, v2, 3, s63
ds_read_b64 v[194:195], v192 offset:8192
s_lshl_b32 s63, s62, 14
s_add_u32 s63, s63, 0x200000
s_lshl_b32 s64, s36, 12
s_add_u32 s63, s63, s64
v_lshl_add_u32 v193, v1, 4, s63
buffer_load_dwordx4 v[200:203], v193, s[52:55], 0 offen offset:0 sc1
buffer_load_dwordx4 v[204:207], v193, s[52:55], 0 offen offset:1024 sc1
buffer_load_dwordx4 v[208:211], v193, s[52:55], 0 offen offset:2048 sc1
buffer_load_dwordx4 v[212:215], v193, s[52:55], 0 offen offset:3072 sc1
s_waitcnt vmcnt(4) lgkmcnt(0)
v_mov_b32 v196, v194
s_nop 1
v_max_f32_dpp v196, v196, v196 row_ror:8 row_mask:0xf bank_mask:0xf
s_nop 1
v_max_f32_dpp v196, v196, v196 row_ror:4 row_mask:0xf bank_mask:0xf
s_nop 1
v_max_f32_dpp v196, v196, v196 row_ror:2 row_mask:0xf bank_mask:0xf
s_nop 1
v_max_f32_dpp v196, v196, v196 row_ror:1 row_mask:0xf bank_mask:0xf
v_sub_f32 v197, v194, v196
v_exp_f32 v197, v197
s_nop 0
v_mul_f32 v195, v195, v197
s_nop 1
v_add_f32_dpp v195, v195, v195 row_ror:8 row_mask:0xf bank_mask:0xf
s_nop 1
v_add_f32_dpp v195, v195, v195 row_ror:4 row_mask:0xf bank_mask:0xf
s_nop 1
v_add_f32_dpp v195, v195, v195 row_ror:2 row_mask:0xf bank_mask:0xf
s_nop 1
v_add_f32_dpp v195, v195, v195 row_ror:1 row_mask:0xf bank_mask:0xf
v_rcp_f32 v195, v195
s_nop 0
v_mul_f32 v197, v197, v195
s_lshl_b32 s64, s36, 2
s_add_u32 s65, s64, 0
v_readlane_b32 s66, v197, s65
s_add_u32 s65, s64, 1
v_readlane_b32 s67, v197, s65
s_add_u32 s65, s64, 2
v_readlane_b32 s68, v197, s65
s_add_u32 s65, s64, 3
v_readlane_b32 s69, v197, s65
s_waitcnt vmcnt(3)
v_lshlrev_b32 v216, 16, v200
v_and_b32 v217, 0xffff0000, v200
v_lshlrev_b32 v218, 16, v201
v_and_b32 v219, 0xffff0000, v201
v_lshlrev_b32 v220, 16, v202
v_and_b32 v221, 0xffff0000, v202
v_lshlrev_b32 v222, 16, v203
v_and_b32 v223, 0xffff0000, v203
v_mul_f32 v232, s66, v216
v_mul_f32 v233, s66, v217
v_mul_f32 v234, s66, v218
v_mul_f32 v235, s66, v219
v_mul_f32 v236, s66, v220
v_mul_f32 v237, s66, v221
v_mul_f32 v238, s66, v222
v_mul_f32 v239, s66, v223
s_waitcnt vmcnt(2)
v_lshlrev_b32 v216, 16, v204
v_and_b32 v217, 0xffff0000, v204
v_lshlrev_b32 v218, 16, v205
v_and_b32 v219, 0xffff0000, v205
v_lshlrev_b32 v220, 16, v206
v_and_b32 v221, 0xffff0000, v206
v_lshlrev_b32 v222, 16, v207
v_and_b32 v223, 0xffff0000, v207
v_fma_f32 v232, v216, s67, v232
v_fma_f32 v233, v217, s67, v233
v_fma_f32 v234, v218, s67, v234
v_fma_f32 v235, v219, s67, v235
v_fma_f32 v236, v220, s67, v236
v_fma_f32 v237, v221, s67, v237
v_fma_f32 v238, v222, s67, v238
v_fma_f32 v239, v223, s67, v239
s_waitcnt vmcnt(1)
v_lshlrev_b32 v216, 16, v208
v_and_b32 v217, 0xffff0000, v208
v_lshlrev_b32 v218, 16, v209
v_and_b32 v219, 0xffff0000, v209
v_lshlrev_b32 v220, 16, v210
v_and_b32 v221, 0xffff0000, v210
v_lshlrev_b32 v222, 16, v211
v_and_b32 v223, 0xffff0000, v211
v_fma_f32 v232, v216, s68, v232
v_fma_f32 v233, v217, s68, v233
v_fma_f32 v234, v218, s68, v234
v_fma_f32 v235, v219, s68, v235
v_fma_f32 v236, v220, s68, v236
v_fma_f32 v237, v221, s68, v237
v_fma_f32 v238, v222, s68, v238
v_fma_f32 v239, v223, s68, v239
s_waitcnt vmcnt(0)
v_lshlrev_b32 v216, 16, v212
v_and_b32 v217, 0xffff0000, v212
v_lshlrev_b32 v218, 16, v213
v_and_b32 v219, 0xffff0000, v213
v_lshlrev_b32 v220, 16, v214
v_and_b32 v221, 0xffff0000, v214
v_lshlrev_b32 v222, 16, v215
v_and_b32 v223, 0xffff0000, v215
v_fma_f32 v232, v216, s69, v232
v_fma_f32 v233, v217, s69, v233
v_fma_f32 v234, v218, s69, v234
v_fma_f32 v235, v219, s69, v235
v_fma_f32 v236, v220, s69, v236
v_fma_f32 v237, v221, s69, v237
v_fma_f32 v238, v222, s69, v238
v_fma_f32 v239, v223, s69, v239
s_lshl_b32 s62, s34, 11
v_lshl_add_u32 v192, v1, 5, s62
ds_write_b128 v192, v[232:235] offset:18432
ds_write_b128 v192, v[236:239] offset:18448
s_waitcnt lgkmcnt(0)
s_barrier
v_lshrrev_b32 v192, 3, v2
v_lshlrev_b32 v192, 13, v192
v_lshl_add_u32 v192, v3, 6, v192
s_lshl_b32 s62, s34, 8
v_add_u32 v192, s62, v192
ds_read_b128 v[200:203], v192 offset:18432
ds_read_b128 v[204:207], v192 offset:18448
ds_read_b128 v[208:211], v192 offset:18464
ds_read_b128 v[212:215], v192 offset:18480
ds_read_b128 v[216:219], v192 offset:20480
ds_read_b128 v[220:223], v192 offset:20496
ds_read_b128 v[224:227], v192 offset:20512
ds_read_b128 v[228:231], v192 offset:20528
s_waitcnt lgkmcnt(0)
v_add_f32 v200, v200, v216
v_add_f32 v201, v201, v217
v_add_f32 v202, v202, v218
v_add_f32 v203, v203, v219
v_add_f32 v204, v204, v220
v_add_f32 v205, v205, v221
v_add_f32 v206, v206, v222
v_add_f32 v207, v207, v223
v_add_f32 v208, v208, v224
v_add_f32 v209, v209, v225
v_add_f32 v210, v210, v226
v_add_f32 v211, v211, v227
v_add_f32 v212, v212, v228
v_add_f32 v213, v213, v229
v_add_f32 v214, v214, v230
v_add_f32 v215, v215, v231
ds_read_b128 v[216:219], v192 offset:22528
ds_read_b128 v[220:223], v192 offset:22544
ds_read_b128 v[224:227], v192 offset:22560
ds_read_b128 v[228:231], v192 offset:22576
s_waitcnt lgkmcnt(0)
v_add_f32 v200, v200, v216
v_add_f32 v201, v201, v217
v_add_f32 v202, v202, v218
v_add_f32 v203, v203, v219
v_add_f32 v204, v204, v220
v_add_f32 v205, v205, v221
v_add_f32 v206, v206, v222
v_add_f32 v207, v207, v223
v_add_f32 v208, v208, v224
v_add_f32 v209, v209, v225
v_add_f32 v210, v210, v226
v_add_f32 v211, v211, v227
v_add_f32 v212, v212, v228
v_add_f32 v213, v213, v229
v_add_f32 v214, v214, v230
v_add_f32 v215, v215, v231
ds_read_b128 v[216:219], v192 offset:24576
ds_read_b128 v[220:223], v192 offset:24592
ds_read_b128 v[224:227], v192 offset:24608
ds_read_b128 v[228:231], v192 offset:24624
s_waitcnt lgkmcnt(0)
v_add_f32 v200, v200, v216
v_add_f32 v201, v201, v217
v_add_f32 v202, v202, v218
v_add_f32 v203, v203, v219
v_add_f32 v204, v204, v220
v_add_f32 v205, v205, v221
v_add_f32 v206, v206, v222
v_add_f32 v207, v207, v223
v_add_f32 v208, v208, v224
v_add_f32 v209, v209, v225
v_add_f32 v210, v210, v226
v_add_f32 v211, v211, v227
v_add_f32 v212, v212, v228
v_add_f32 v213, v213, v229
v_add_f32 v214, v214, v230
v_add_f32 v215, v215, v231
v_cvt_pk_bf16_f32 v12, v200, v201
v_cvt_pk_bf16_f32 v13, v202, v203
v_cvt_pk_bf16_f32 v14, v204, v205
v_cvt_pk_bf16_f32 v15, v206, v207
v_cvt_pk_bf16_f32 v16, v208, v209
v_cvt_pk_bf16_f32 v17, v210, v211
v_cvt_pk_bf16_f32 v18, v212, v213
v_cvt_pk_bf16_f32 v19, v214, v215
s_mov_b32 s60, 0x01000100
v_perm_b32 v192, v12, v12, s60
v_and_b32 v28, v192, v4
v_and_b32 v29, v192, v5
v_and_b32 v30, v192, v6
v_and_b32 v31, v192, v7
s_waitcnt vmcnt(63)
s_nop 0
v_mfma_f32_16x16x32_bf16 v[44:47], v[28:31], v[64:67], 0
s_mov_b32 s60, 0x03020302
v_perm_b32 v193, v12, v12, s60
v_and_b32 v32, v193, v4
v_and_b32 v33, v193, v5
v_and_b32 v34, v193, v6
v_and_b32 v35, v193, v7
s_waitcnt vmcnt(63)
s_nop 0
v_mfma_f32_16x16x32_bf16 v[44:47], v[32:35], v[68:71], v[44:47]
s_mov_b32 s60, 0x01000100
v_perm_b32 v192, v13, v13, s60
v_and_b32 v28, v192, v4
v_and_b32 v29, v192, v5
v_and_b32 v30, v192, v6
v_and_b32 v31, v192, v7
s_waitcnt vmcnt(63)
s_nop 0
v_mfma_f32_16x16x32_bf16 v[44:47], v[28:31], v[72:75], v[44:47]
s_mov_b32 s60, 0x03020302
v_perm_b32 v193, v13, v13, s60
v_and_b32 v32, v193, v4
v_and_b32 v33, v193, v5
v_and_b32 v34, v193, v6
v_and_b32 v35, v193, v7
s_waitcnt vmcnt(63)
s_nop 0
v_mfma_f32_16x16x32_bf16 v[44:47], v[32:35], v[76:79], v[44:47]
s_mov_b32 s60, 0x01000100
v_perm_b32 v192, v14, v14, s60
v_and_b32 v28, v192, v4
v_and_b32 v29, v192, v5
v_and_b32 v30, v192, v6
v_and_b32 v31, v192, v7
s_waitcnt vmcnt(63)
s_nop 0
v_mfma_f32_16x16x32_bf16 v[44:47], v[28:31], v[80:83], v[44:47]
s_mov_b32 s60, 0x03020302
v_perm_b32 v193, v14, v14, s60
v_and_b32 v32, v193, v4
v_and_b32 v33, v193, v5
v_and_b32 v34, v193, v6
v_and_b32 v35, v193, v7
s_waitcnt vmcnt(63)
s_nop 0
v_mfma_f32_16x16x32_bf16 v[44:47], v[32:35], v[84:87], v[44:47]
s_mov_b32 s60, 0x01000100
v_perm_b32 v192, v15, v15, s60
v_and_b32 v28, v192, v4
v_and_b32 v29, v192, v5
v_and_b32 v30, v192, v6
v_and_b32 v31, v192, v7
s_waitcnt vmcnt(63)
s_nop 0
v_mfma_f32_16x16x32_bf16 v[44:47], v[28:31], v[88:91], v[44:47]
s_mov_b32 s60, 0x03020302
v_perm_b32 v193, v15, v15, s60
v_and_b32 v32, v193, v4
v_and_b32 v33, v193, v5
v_and_b32 v34, v193, v6
v_and_b32 v35, v193, v7
s_waitcnt vmcnt(63)
s_nop 0
v_mfma_f32_16x16x32_bf16 v[44:47], v[32:35], v[92:95], v[44:47]
s_mov_b32 s60, 0x01000100
v_perm_b32 v192, v16, v16, s60
v_and_b32 v28, v192, v4
v_and_b32 v29, v192, v5
v_and_b32 v30, v192, v6
v_and_b32 v31, v192, v7
s_waitcnt vmcnt(63)
s_nop 0
v_mfma_f32_16x16x32_bf16 v[44:47], v[28:31], v[96:99], v[44:47]
s_mov_b32 s60, 0x03020302
v_perm_b32 v193, v16, v16, s60
v_and_b32 v32, v193, v4
v_and_b32 v33, v193, v5
v_and_b32 v34, v193, v6
v_and_b32 v35, v193, v7
s_waitcnt vmcnt(63)
s_nop 0
v_mfma_f32_16x16x32_bf16 v[44:47], v[32:35], v[100:103], v[44:47]
s_mov_b32 s60, 0x01000100
v_perm_b32 v192, v17, v17, s60
v_and_b32 v28, v192, v4
v_and_b32 v29, v192, v5
v_and_b32 v30, v192, v6
v_and_b32 v31, v192, v7
s_waitcnt vmcnt(63)
s_nop 0
v_mfma_f32_16x16x32_bf16 v[44:47], v[28:31], v[104:107], v[44:47]
s_mov_b32 s60, 0x03020302
v_perm_b32 v193, v17, v17, s60
v_and_b32 v32, v193, v4
v_and_b32 v33, v193, v5
v_and_b32 v34, v193, v6
v_and_b32 v35, v193, v7
s_waitcnt vmcnt(63)
s_nop 0
v_mfma_f32_16x16x32_bf16 v[44:47], v[32:35], v[108:111], v[44:47]
s_mov_b32 s60, 0x01000100
v_perm_b32 v192, v18, v18, s60
v_and_b32 v28, v192, v4
v_and_b32 v29, v192, v5
v_and_b32 v30, v192, v6
v_and_b32 v31, v192, v7
s_waitcnt vmcnt(63)
s_nop 0
v_mfma_f32_16x16x32_bf16 v[44:47], v[28:31], v[112:115], v[44:47]
s_mov_b32 s60, 0x03020302
v_perm_b32 v193, v18, v18, s60
v_and_b32 v32, v193, v4
v_and_b32 v33, v193, v5
v_and_b32 v34, v193, v6
v_and_b32 v35, v193, v7
s_waitcnt vmcnt(63)
s_nop 0
v_mfma_f32_16x16x32_bf16 v[44:47], v[32:35], v[116:119], v[44:47]
s_mov_b32 s60, 0x01000100
v_perm_b32 v192, v19, v19, s60
v_and_b32 v28, v192, v4
v_and_b32 v29, v192, v5
v_and_b32 v30, v192, v6
v_and_b32 v31, v192, v7
s_waitcnt vmcnt(63)
s_nop 0
v_mfma_f32_16x16x32_bf16 v[44:47], v[28:31], v[120:123], v[44:47]
s_mov_b32 s60, 0x03020302
v_perm_b32 v193, v19, v19, s60
v_and_b32 v32, v193, v4
v_and_b32 v33, v193, v5
v_and_b32 v34, v193, v6
v_and_b32 v35, v193, v7
s_waitcnt vmcnt(63)
s_nop 0
v_mfma_f32_16x16x32_bf16 v[44:47], v[32:35], v[124:127], v[44:47]
v_lshrrev_b32 v192, 1, v3
v_lshlrev_b32 v192, 9, v192
v_lshl_add_u32 v192, v2, 5, v192
v_and_b32 v193, 1, v3
v_lshl_add_u32 v192, v193, 4, v192
s_lshl_b32 s63, s34, 10
v_add_u32 v192, s63, v192
s_nop 1
s_nop 5
ds_write_b128 v192, v[44:47] offset:9216
s_waitcnt lgkmcnt(0)
s_barrier
v_lshrrev_b32 v192, 3, v2
v_lshlrev_b32 v192, 9, v192
v_lshl_add_u32 v192, v3, 4, v192
s_lshl_b32 s62, s34, 6
v_add_u32 v192, s62, v192
ds_read_b128 v[200:203], v192 offset:9216
ds_read_b128 v[204:207], v192 offset:10240
ds_read_b128 v[208:211], v192 offset:11264
ds_read_b128 v[212:215], v192 offset:12288
ds_read_b128 v[216:219], v192 offset:13312
ds_read_b128 v[220:223], v192 offset:14336
ds_read_b128 v[224:227], v192 offset:15360
ds_read_b128 v[228:231], v192 offset:16384
s_waitcnt lgkmcnt(6)
v_add_f32 v200, v200, v204
v_add_f32 v201, v201, v205
v_add_f32 v202, v202, v206
v_add_f32 v203, v203, v207
s_waitcnt lgkmcnt(5)
v_add_f32 v200, v200, v208
v_add_f32 v201, v201, v209
v_add_f32 v202, v202, v210
v_add_f32 v203, v203, v211
s_waitcnt lgkmcnt(4)
v_add_f32 v200, v200, v212
v_add_f32 v201, v201, v213
v_add_f32 v202, v202, v214
v_add_f32 v203, v203, v215
s_waitcnt lgkmcnt(3)
v_add_f32 v200, v200, v216
v_add_f32 v201, v201, v217
v_add_f32 v202, v202, v218
v_add_f32 v203, v203, v219
s_waitcnt lgkmcnt(2)
v_add_f32 v200, v200, v220
v_add_f32 v201, v201, v221
v_add_f32 v202, v202, v222
v_add_f32 v203, v203, v223
s_waitcnt lgkmcnt(1)
v_add_f32 v200, v200, v224
v_add_f32 v201, v201, v225
v_add_f32 v202, v202, v226
v_add_f32 v203, v203, v227
s_waitcnt lgkmcnt(0)
v_add_f32 v200, v200, v228
v_add_f32 v201, v201, v229
v_add_f32 v202, v202, v230
v_add_f32 v203, v203, v231
v_cvt_pk_bf16_f32 v60, v200, v200
v_cvt_pk_bf16_f32 v61, v201, v201
v_cvt_pk_bf16_f32 v62, v202, v202
v_cvt_pk_bf16_f32 v63, v203, v203
v_and_b32 v28, v60, v4
v_and_b32 v29, v60, v5
v_and_b32 v30, v60, v6
v_and_b32 v31, v60, v7
v_and_b32 v32, v61, v4
v_and_b32 v33, v61, v5
v_and_b32 v34, v61, v6
v_and_b32 v35, v61, v7
v_and_b32 v36, v62, v4
v_and_b32 v37, v62, v5
v_and_b32 v38, v62, v6
v_and_b32 v39, v62, v7
v_and_b32 v40, v63, v4
v_and_b32 v41, v63, v5
v_and_b32 v42, v63, v6
v_and_b32 v43, v63, v7
s_nop 1
v_mfma_f32_16x16x32_bf16 v[44:47], v[28:31], v[128:131], 0
v_mfma_f32_16x16x32_bf16 v[48:51], v[28:31], v[132:135], 0
v_mfma_f32_16x16x32_bf16 v[52:55], v[28:31], v[136:139], 0
v_mfma_f32_16x16x32_bf16 v[56:59], v[28:31], v[140:143], 0
v_mfma_f32_16x16x32_bf16 v[44:47], v[32:35], v[144:147], v[44:47]
v_mfma_f32_16x16x32_bf16 v[48:51], v[32:35], v[148:151], v[48:51]
v_mfma_f32_16x16x32_bf16 v[52:55], v[32:35], v[152:155], v[52:55]
v_mfma_f32_16x16x32_bf16 v[56:59], v[32:35], v[156:159], v[56:59]
v_mfma_f32_16x16x32_bf16 v[44:47], v[36:39], v[160:163], v[44:47]
v_mfma_f32_16x16x32_bf16 v[48:51], v[36:39], v[164:167], v[48:51]
v_mfma_f32_16x16x32_bf16 v[52:55], v[36:39], v[168:171], v[52:55]
v_mfma_f32_16x16x32_bf16 v[56:59], v[36:39], v[172:175], v[56:59]
v_mfma_f32_16x16x32_bf16 v[44:47], v[40:43], v[176:179], v[44:47]
v_mfma_f32_16x16x32_bf16 v[48:51], v[40:43], v[180:183], v[48:51]
v_mfma_f32_16x16x32_bf16 v[52:55], v[40:43], v[184:187], v[52:55]
v_mfma_f32_16x16x32_bf16 v[56:59], v[40:43], v[188:191], v[56:59]
v_lshrrev_b32 v192, 1, v3
v_lshlrev_b32 v192, 11, v192
v_lshl_add_u32 v192, v2, 5, v192
v_and_b32 v193, 1, v3
v_lshl_add_u32 v192, v193, 4, v192
s_lshl_b32 s63, s34, 12
v_add_u32 v192, s63, v192
s_nop 1
ds_write_b128 v192, v[44:47] offset:18432
ds_write_b128 v192, v[48:51] offset:18944
ds_write_b128 v192, v[52:55] offset:19456
s_nop 5
ds_write_b128 v192, v[56:59] offset:19968
s_waitcnt lgkmcnt(0)
s_barrier
s_cmp_ge_u32 s34, 4
s_cbranch_scc1 L_W_yskip
v_lshlrev_b32 v192, 4, v0
ds_read_b128 v[200:203], v192 offset:18432
ds_read_b128 v[204:207], v192 offset:22528
ds_read_b128 v[208:211], v192 offset:26624
ds_read_b128 v[212:215], v192 offset:30720
ds_read_b128 v[216:219], v192 offset:34816
ds_read_b128 v[220:223], v192 offset:38912
ds_read_b128 v[224:227], v192 offset:43008
ds_read_b128 v[228:231], v192 offset:47104
v_lshrrev_b32 v193, 7, v0
v_lshlrev_b32 v193, 16, v193
v_and_b32 v194, 127, v0
v_lshl_add_u32 v193, v194, 4, v193
s_lshl_b32 s63, s32, 11
s_add_u32 s63, s63, 0x20000
v_add_u32 v193, s63, v193
s_waitcnt lgkmcnt(6)
v_add_f32 v200, v200, v204
v_add_f32 v201, v201, v205
v_add_f32 v202, v202, v206
v_add_f32 v203, v203, v207
s_waitcnt lgkmcnt(5)
v_add_f32 v200, v200, v208
v_add_f32 v201, v201, v209
v_add_f32 v202, v202, v210
v_add_f32 v203, v203, v211
s_waitcnt lgkmcnt(4)
v_add_f32 v200, v200, v212
v_add_f32 v201, v201, v213
v_add_f32 v202, v202, v214
v_add_f32 v203, v203, v215
s_waitcnt lgkmcnt(3)
v_add_f32 v200, v200, v216
v_add_f32 v201, v201, v217
v_add_f32 v202, v202, v218
v_add_f32 v203, v203, v219
s_waitcnt lgkmcnt(2)
v_add_f32 v200, v200, v220
v_add_f32 v201, v201, v221
v_add_f32 v202, v202, v222
v_add_f32 v203, v203, v223
s_waitcnt lgkmcnt(1)
v_add_f32 v200, v200, v224
v_add_f32 v201, v201, v225
v_add_f32 v202, v202, v226
v_add_f32 v203, v203, v227
s_waitcnt lgkmcnt(0)
v_add_f32 v200, v200, v228
v_add_f32 v201, v201, v229
v_add_f32 v202, v202, v230
v_add_f32 v203, v203, v231
v_cvt_pk_bf16_f32 v200, v200, v201
v_cvt_pk_bf16_f32 v202, v202, v203
v_mov_b32 v201, s88
v_mov_b32 v203, s88
buffer_store_dwordx4 v[200:203], v193, s[52:55], 0 offen sc1
L_W_yskip:
s_lshr_b32 s35, s32, 4
s_and_b32 s36, s32, 15
v_mov_b32 v232, 0
v_mov_b32 v233, 0
v_mov_b32 v234, 0
v_mov_b32 v235, 0
s_cmp_ge_u32 s34, 4
s_cbranch_scc1 L_W_bskip
v_lshrrev_b32 v192, 3, v0
v_lshlrev_b32 v192, 11, v192
v_and_b32 v193, 7, v0
v_lshl_add_u32 v192, v193, 4, v192
s_lshl_b32 s62, s35, 16
s_lshl_b32 s63, s36, 7
s_add_u32 s62, s62, s63
s_add_u32 s62, s62, 0x20000
v_add_u32 v192, s62, v192
s_mov_b32 s64, 0
L_tp_Wyb:
buffer_load_dwordx4 v[232:235], v192, s[52:55], 0 offen sc1
s_waitcnt vmcnt(0)
v_cmp_ne_u32 s[62:63], s88, v233
v_cmp_ne_u32 vcc, s88, v235
s_add_u32 s64, s64, 1
s_nop 0
s_or_b64 vcc, vcc, s[62:63]
s_cbranch_scc0 L_tp_Wyb_ok
s_mov_b64 exec, vcc
s_sleep 8
s_cmp_lt_u32 s64, 65536
s_cbranch_scc1 L_tp_Wyb
L_tp_Wyb_ok:
s_mov_b64 exec, -1
v_and_b32 v233, 0xffff0000, v232
v_lshlrev_b32 v232, 16, v232
v_and_b32 v235, 0xffff0000, v234
v_lshlrev_b32 v234, 16, v234
L_W_bskip:
s_nop 1
v_add_f32_dpp v232, v232, v232 row_ror:8 row_mask:0xf bank_mask:0xf
v_add_f32_dpp v233, v233, v233 row_ror:8 row_mask:0xf bank_mask:0xf
v_add_f32_dpp v234, v234, v234 row_ror:8 row_mask:0xf bank_mask:0xf
v_add_f32_dpp v235, v235, v235 row_ror:8 row_mask:0xf bank_mask:0xf
v_mov_b32 v192, v232
v_mov_b32 v193, v233
v_mov_b32 v194, v234
v_mov_b32 v195, v235
s_nop 1
v_permlane16_swap_b32 v232, v192
v_permlane16_swap_b32 v233, v193
v_permlane16_swap_b32 v234, v194
v_permlane16_swap_b32 v235, v195
s_nop 0
v_add_f32 v232, v232, v192
v_add_f32 v233, v233, v193
v_add_f32 v234, v234, v194
v_add_f32 v235, v235, v195
v_mov_b32 v192, v232
v_mov_b32 v193, v233
v_mov_b32 v194, v234
v_mov_b32 v195, v235
s_nop 1
v_permlane32_swap_b32 v232, v192
v_permlane32_swap_b32 v233, v193
v_permlane32_swap_b32 v234, v194
v_permlane32_swap_b32 v235, v195
s_nop 0
v_add_f32 v232, v232, v192
v_add_f32 v233, v233, v193
v_add_f32 v234, v234, v194
v_add_f32 v235, v235, v195
v_lshlrev_b32 v192, 4, v1
s_lshl_b32 s63, s34, 7
v_add_u32 v192, s63, v192
s_mov_b64 exec, 0xff
ds_write_b128 v192, v[232:235] offset:17408
s_mov_b64 exec, -1
s_waitcnt lgkmcnt(0)
s_barrier
s_cmp_lg_u32 s34, 0
s_cbranch_scc1 L_Wb_fin
v_lshlrev_b32 v192, 2, v1
s_mov_b32 exec_hi, 0
ds_read_b32 v193, v192 offset:17408
ds_read_b32 v194, v192 offset:17536
ds_read_b32 v195, v192 offset:17664
ds_read_b32 v196, v192 offset:17792
s_waitcnt lgkmcnt(0)
v_add_f32 v193, v193, v194
v_add_f32 v193, v193, v195
v_add_f32 v193, v193, v196
v_cvt_pk_bf16_f32 v193, v193, v193
s_lshr_b32 s62, s32, 4
s_lshl_b32 s62, s62, 11
s_and_b32 s63, s32, 15
s_lshl_b32 s63, s63, 6
s_add_u32 s62, s62, s63
s_add_u32 s62, s62, 1024
v_lshl_add_u32 v192, v1, 1, s62
global_store_short v192, v193, s[26:27]
s_mov_b64 exec, -1
L_Wb_fin:
v_lshrrev_b32 v192, 3, v1
s_lshl_b32 s62, s35, 8
s_lshl_b32 s63, s34, 3
s_add_u32 s62, s62, s63
v_add_u32 v192, s62, v192
v_lshlrev_b32 v9, 4, v192
v_add_u32 v9, 0x14000, v9
v_and_b32 v9, 255, v192
s_lshl_b32 s63, s35, 4
s_add_u32 s63, s63, 0x50000
v_lshl_add_u32 v9, v9, 7, s63
v_lshlrev_b32 v10, 10, v192
v_and_b32 v193, 7, v1
v_lshl_add_u32 v10, v193, 3, v10
s_lshl_b32 s63, s36, 6
s_add_u32 s63, s63, 0x100000
v_add_u32 v10, s63, v10
v_mov_b32 v80, 0xff800000
v_mov_b32 v81, 0
v_mov_b32 v64, 0
v_mov_b32 v65, 0
v_mov_b32 v82, 0xff800000
v_mov_b32 v83, 0
v_mov_b32 v66, 0
v_mov_b32 v67, 0
v_mov_b32 v84, 0xff800000
v_mov_b32 v85, 0
v_mov_b32 v68, 0
v_mov_b32 v69, 0
v_mov_b32 v86, 0xff800000
v_mov_b32 v87, 0
v_mov_b32 v70, 0
v_mov_b32 v71, 0
s_mov_b32 s66, -1
s_mov_b32 s67, 0xffff
s_mov_b32 s68, -1
s_mov_b32 s69, 0xffff
s_mov_b32 s70, -1
s_mov_b32 s71, 0xffff
s_mov_b32 s72, -1
s_mov_b32 s73, 0xffff
s_mov_b32 s64, 0
s_mov_b64 exec, s[66:67]
L_W_stt:
s_mov_b32 s63, 0
buffer_load_dwordx4 v[96:99], v9, s[52:55], s63 offen sc1
s_mov_b32 s63, 8192
buffer_load_dwordx4 v[100:103], v9, s[52:55], s63 offen sc1
s_mov_b32 s63, 16384
buffer_load_dwordx4 v[104:107], v9, s[52:55], s63 offen sc1
s_mov_b32 s63, 24576
buffer_load_dwordx4 v[108:111], v9, s[52:55], s63 offen sc1
s_waitcnt vmcnt(0)
v_xor_b32 v97, s88, v97
v_xor_b32 v99, s88, v99
v_xor_b32 v101, s88, v101
v_xor_b32 v103, s88, v103
v_xor_b32 v105, s88, v105
v_xor_b32 v107, s88, v107
v_xor_b32 v109, s88, v109
v_xor_b32 v111, s88, v111
v_or3_b32 v192, v97, v99, v101
v_or3_b32 v192, v192, v103, v105
v_or3_b32 v192, v192, v107, v109
v_or_b32 v192, v192, v111
v_cmp_ne_u32 vcc, 0, v192
s_add_u32 s64, s64, 1
s_nop 0
s_cmp_eq_u64 vcc, 0
s_cbranch_scc1 L_W_stt_done
s_sleep 16
s_cmp_lt_u32 s64, 65536
s_cbranch_scc1 L_W_stt
L_W_stt_done:
v_mov_b32 v80, v96
v_mov_b32 v81, v98
v_mov_b32 v82, v100
v_mov_b32 v83, v102
v_mov_b32 v84, v104
v_mov_b32 v85, v106
v_mov_b32 v86, v108
v_mov_b32 v87, v110
s_mov_b64 exec, -1
v_mov_b32 v192, v80
v_mov_b32 v193, v82
v_mov_b32 v194, v84
v_mov_b32 v195, v86
s_nop 1
v_max_f32_dpp v192, v192, v192 row_ror:8 row_mask:0xf bank_mask:0xf
v_max_f32_dpp v193, v193, v193 row_ror:8 row_mask:0xf bank_mask:0xf
v_max_f32_dpp v194, v194, v194 row_ror:8 row_mask:0xf bank_mask:0xf
v_max_f32_dpp v195, v195, v195 row_ror:8 row_mask:0xf bank_mask:0xf
v_mov_b32 v196, v192
v_mov_b32 v197, v193
v_mov_b32 v198, v194
v_mov_b32 v199, v195
s_nop 1
v_permlane16_swap_b32 v192, v196
v_permlane16_swap_b32 v193, v197
v_permlane16_swap_b32 v194, v198
v_permlane16_swap_b32 v195, v199
s_nop 0
v_max_f32 v192, v192, v196
v_max_f32 v193, v193, v197
v_max_f32 v194, v194, v198
v_max_f32 v195, v195, v199
v_mov_b32 v196, v192
v_mov_b32 v197, v193
v_mov_b32 v198, v194
v_mov_b32 v199, v195
s_nop 1
v_permlane32_swap_b32 v192, v196
v_permlane32_swap_b32 v193, v197
v_permlane32_swap_b32 v194, v198
v_permlane32_swap_b32 v195, v199
s_nop 0
v_max_f32 v192, v192, v196
v_max_f32 v193, v193, v197
v_max_f32 v194, v194, v198
v_max_f32 v195, v195, v199
v_sub_f32 v192, v80, v192
v_sub_f32 v193, v82, v193
v_sub_f32 v194, v84, v194
v_sub_f32 v195, v86, v195
v_exp_f32 v192, v192
v_exp_f32 v193, v193
v_exp_f32 v194, v194
v_exp_f32 v195, v195
s_nop 0
v_mul_f32 v200, v81, v192
v_mul_f32 v201, v83, v193
v_mul_f32 v202, v85, v194
v_mul_f32 v203, v87, v195
s_nop 1
v_add_f32_dpp v200, v200, v200 row_ror:8 row_mask:0xf bank_mask:0xf
v_add_f32_dpp v201, v201, v201 row_ror:8 row_mask:0xf bank_mask:0xf
v_add_f32_dpp v202, v202, v202 row_ror:8 row_mask:0xf bank_mask:0xf
v_add_f32_dpp v203, v203, v203 row_ror:8 row_mask:0xf bank_mask:0xf
v_mov_b32 v196, v200
v_mov_b32 v197, v201
v_mov_b32 v198, v202
v_mov_b32 v199, v203
s_nop 1
v_permlane16_swap_b32 v200, v196
v_permlane16_swap_b32 v201, v197
v_permlane16_swap_b32 v202, v198
v_permlane16_swap_b32 v203, v199
s_nop 0
v_add_f32 v200, v200, v196
v_add_f32 v201, v201, v197
v_add_f32 v202, v202, v198
v_add_f32 v203, v203, v199
v_mov_b32 v196, v200
v_mov_b32 v197, v201
v_mov_b32 v198, v202
v_mov_b32 v199, v203
s_nop 1
v_permlane32_swap_b32 v200, v196
v_permlane32_swap_b32 v201, v197
v_permlane32_swap_b32 v202, v198
v_permlane32_swap_b32 v203, v199
s_nop 0
v_add_f32 v200, v200, v196
v_add_f32 v201, v201, v197
v_add_f32 v202, v202, v198
v_add_f32 v203, v203, v199
v_rcp_f32 v200, v200
v_rcp_f32 v201, v201
v_rcp_f32 v202, v202
v_rcp_f32 v203, v203
s_nop 0
v_mul_f32 v80, v192, v200
v_mul_f32 v81, v193, v201
v_mul_f32 v82, v194, v202
v_mul_f32 v83, v195, v203
v_mov_b32 v232, 0
v_mov_b32 v233, 0
v_mov_b32 v234, 0
v_mov_b32 v235, 0
s_mov_b32 s64, 0
s_mov_b32 s74, 0x1010101
s_mov_b32 s75, 0x101
L_W_gate:
s_mov_b64 exec, s[74:75]
buffer_load_dword v192, v10, s[52:55], 0 offen sc1
s_waitcnt vmcnt(0)
v_cmp_ne_u32 vcc, -1, v192
s_mov_b64 exec, -1
s_add_u32 s64, s64, 1
s_cmp_lg_u64 vcc, 0
s_cbranch_scc1 L_W_gate_done
s_sleep 4
s_cmp_lt_u32 s64, 65536
s_cbranch_scc1 L_W_gate
L_W_gate_done:
s_mov_b32 s64, 0
s_mov_b32 s77, 65536
s_mov_b32 s78, 131072
s_mov_b32 s79, 196608
L_W_sweep:
s_mov_b64 exec, s[66:67]
s_cbranch_execz L_W_sw0
buffer_load_dwordx2 v[64:65], v10, s[52:55], 0 offen sc1
L_W_sw0:
s_mov_b64 exec, s[68:69]
s_cbranch_execz L_W_sw1
buffer_load_dwordx2 v[66:67], v10, s[52:55], s77 offen sc1
L_W_sw1:
s_mov_b64 exec, s[70:71]
s_cbranch_execz L_W_sw2
buffer_load_dwordx2 v[68:69], v10, s[52:55], s78 offen sc1
L_W_sw2:
s_mov_b64 exec, s[72:73]
s_cbranch_execz L_W_sw3
buffer_load_dwordx2 v[70:71], v10, s[52:55], s79 offen sc1
L_W_sw3:
s_waitcnt vmcnt(0)
s_mov_b64 exec, s[66:67]
s_cbranch_execz L_W_sx0
v_max_u32 v192, v64, v65
v_cmp_ne_u32 vcc, -1, v192
v_lshlrev_b32 v88, 16, v64
v_and_b32 v89, 0xffff0000, v64
v_lshlrev_b32 v90, 16, v65
v_and_b32 v91, 0xffff0000, v65
s_andn2_b64 s[66:67], exec, vcc
s_mov_b64 exec, vcc
v_fma_f32 v232, v80, v88, v232
v_fma_f32 v233, v80, v89, v233
v_fma_f32 v234, v80, v90, v234
v_fma_f32 v235, v80, v91, v235
L_W_sx0:
s_mov_b64 exec, s[68:69]
s_cbranch_execz L_W_sx1
v_max_u32 v192, v66, v67
v_cmp_ne_u32 vcc, -1, v192
v_lshlrev_b32 v88, 16, v66
v_and_b32 v89, 0xffff0000, v66
v_lshlrev_b32 v90, 16, v67
v_and_b32 v91, 0xffff0000, v67
s_andn2_b64 s[68:69], exec, vcc
s_mov_b64 exec, vcc
v_fma_f32 v232, v81, v88, v232
v_fma_f32 v233, v81, v89, v233
v_fma_f32 v234, v81, v90, v234
v_fma_f32 v235, v81, v91, v235
L_W_sx1:
s_mov_b64 exec, s[70:71]
s_cbranch_execz L_W_sx2
v_max_u32 v192, v68, v69
v_cmp_ne_u32 vcc, -1, v192
v_lshlrev_b32 v88, 16, v68
v_and_b32 v89, 0xffff0000, v68
v_lshlrev_b32 v90, 16, v69
v_and_b32 v91, 0xffff0000, v69
s_andn2_b64 s[70:71], exec, vcc
s_mov_b64 exec, vcc
v_fma_f32 v232, v82, v88, v232
v_fma_f32 v233, v82, v89, v233
v_fma_f32 v234, v82, v90, v234
v_fma_f32 v235, v82, v91, v235
L_W_sx2:
s_mov_b64 exec, s[72:73]
s_cbranch_execz L_W_sx3
v_max_u32 v192, v70, v71
v_cmp_ne_u32 vcc, -1, v192
v_lshlrev_b32 v88, 16, v70
v_and_b32 v89, 0xffff0000, v70
v_lshlrev_b32 v90, 16, v71
v_and_b32 v91, 0xffff0000, v71
s_andn2_b64 s[72:73], exec, vcc
s_mov_b64 exec, vcc
v_fma_f32 v232, v83, v88, v232
v_fma_f32 v233, v83, v89, v233
v_fma_f32 v234, v83, v90, v234
v_fma_f32 v235, v83, v91, v235
L_W_sx3:
s_mov_b64 exec, -1
s_or_b64 s[74:75], s[66:67], s[68:69]
s_or_b64 s[80:81], s[70:71], s[72:73]
s_or_b64 s[74:75], s[74:75], s[80:81]
s_cbranch_scc0 L_W_sweep_done
s_add_u32 s64, s64, 1
s_cmp_lt_u32 s64, 65536
s_cbranch_scc1 L_W_sweep
L_W_sweep_done:
s_nop 1
v_add_f32_dpp v232, v232, v232 row_ror:8 row_mask:0xf bank_mask:0xf
v_add_f32_dpp v233, v233, v233 row_ror:8 row_mask:0xf bank_mask:0xf
v_add_f32_dpp v234, v234, v234 row_ror:8 row_mask:0xf bank_mask:0xf
v_add_f32_dpp v235, v235, v235 row_ror:8 row_mask:0xf bank_mask:0xf
v_mov_b32 v204, v232
v_mov_b32 v205, v233
v_mov_b32 v206, v234
v_mov_b32 v207, v235
s_nop 1
v_permlane16_swap_b32 v232, v204
v_permlane16_swap_b32 v233, v205
v_permlane16_swap_b32 v234, v206
v_permlane16_swap_b32 v235, v207
s_nop 0
v_add_f32 v232, v232, v204
v_add_f32 v233, v233, v205
v_add_f32 v234, v234, v206
v_add_f32 v235, v235, v207
v_mov_b32 v204, v232
v_mov_b32 v205, v233
v_mov_b32 v206, v234
v_mov_b32 v207, v235
s_nop 1
v_permlane32_swap_b32 v232, v204
v_permlane32_swap_b32 v233, v205
v_permlane32_swap_b32 v234, v206
v_permlane32_swap_b32 v235, v207
s_nop 0
v_add_f32 v232, v232, v204
v_add_f32 v233, v233, v205
v_add_f32 v234, v234, v206
v_add_f32 v235, v235, v207
v_lshlrev_b32 v204, 4, v1
s_lshl_b32 s63, s34, 7
v_add_u32 v204, s63, v204
s_mov_b64 exec, 0xff
ds_write_b128 v204, v[232:235] offset:0
s_mov_b64 exec, -1
s_waitcnt lgkmcnt(0)
s_barrier
s_cmp_lg_u32 s34, 0
s_cbranch_scc1 L_Wa_fin
v_lshlrev_b32 v204, 2, v1
s_mov_b32 exec_hi, 0
ds_read_b32 v205, v204 offset:0
ds_read_b32 v206, v204 offset:128
ds_read_b32 v207, v204 offset:256
ds_read_b32 v208, v204 offset:384
ds_read_b32 v209, v204 offset:512
ds_read_b32 v210, v204 offset:640
ds_read_b32 v211, v204 offset:768
ds_read_b32 v212, v204 offset:896
s_waitcnt lgkmcnt(0)
v_add_f32 v205, v205, v206
v_add_f32 v205, v205, v207
v_add_f32 v205, v205, v208
v_add_f32 v205, v205, v209
v_add_f32 v205, v205, v210
v_add_f32 v205, v205, v211
v_add_f32 v205, v205, v212
v_cvt_pk_bf16_f32 v205, v205, v205
s_lshr_b32 s62, s32, 4
s_lshl_b32 s62, s62, 11
s_and_b32 s63, s32, 15
s_lshl_b32 s63, s63, 6
s_add_u32 s62, s62, s63
s_add_u32 s62, s62, 0
v_lshl_add_u32 v204, v1, 1, s62
global_store_short v204, v205, s[26:27]
s_mov_b64 exec, -1
L_Wa_fin:
s_or_b32 s62, s32, s34
s_cbranch_scc1 L_W_nonext
v_mov_b32 v192, 0x18000
v_mov_b32 v193, s88
s_mov_b64 exec, 1
buffer_store_dword v193, v192, s[52:55], 0 offen
s_mov_b64 exec, -1
L_W_nonext:
s_endpgm
L_roleC:
s_load_dword s88, s[30:31], 0x18000
v_mov_b32 v8, 0
s_lshr_b32 s35, s32, 4
s_lshr_b32 s36, s34, 1
s_and_b32 s37, s34, 1
s_lshl_b32 s60, s32, 19
s_mov_b32 s61, 0x80000
s_add_u32 s40, s16, s60
s_addc_u32 s41, s17, 0
s_and_b32 s41, s41, 0xffff
s_mov_b32 s42, s61
s_mov_b32 s43, 0x20000
s_mov_b32 s44, s30
s_and_b32 s45, s31, 0xffff
s_mov_b32 s46, 0x1000000
s_mov_b32 s47, 0x20000
v_lshlrev_b32 v9, 4, v1
s_lshl_b32 s62, s34, 13
v_add_u32 v9, s62, v9
s_mul_i32 s38, s34, 8448
s_mov_b32 s51, 4096
s_add_u32 s50, s38, 5120
s_waitcnt vmcnt(3)
s_add_u32 m0, s50, 0
s_nop 0
buffer_load_dwordx4 v9, s[40:43], 0 offen offset:0 nt lds
s_waitcnt vmcnt(3)
s_add_u32 m0, s50, 32
s_nop 0
buffer_load_dwordx4 v9, s[40:43], 0 offen offset:1024 nt lds
s_waitcnt vmcnt(3)
s_add_u32 m0, s50, 64
s_nop 0
buffer_load_dwordx4 v9, s[40:43], 0 offen offset:2048 nt lds
s_waitcnt vmcnt(3)
s_add_u32 m0, s50, 96
s_nop 0
buffer_load_dwordx4 v9, s[40:43], 0 offen offset:3072 nt lds
s_waitcnt vmcnt(3)
s_add_u32 m0, s50, 4224
s_nop 0
buffer_load_dwordx4 v9, s[40:43], s51 offen offset:0 nt lds
s_waitcnt vmcnt(3)
s_add_u32 m0, s50, 4256
s_nop 0
buffer_load_dwordx4 v9, s[40:43], s51 offen offset:1024 nt lds
s_waitcnt vmcnt(3)
s_add_u32 m0, s50, 4288
s_nop 0
buffer_load_dwordx4 v9, s[40:43], s51 offen offset:2048 nt lds
s_waitcnt vmcnt(3)
s_add_u32 m0, s50, 4320
s_nop 0
buffer_load_dwordx4 v9, s[40:43], s51 offen offset:3072 nt lds
v_add_u32 v9, 0x10000, v9
s_lshl_b32 s60, s32, 8
s_sub_u32 s61, 0x400000, s60
s_add_u32 s52, s10, s60
s_addc_u32 s53, s11, 0
s_and_b32 s53, s53, 0xffff
s_mov_b32 s54, s61
s_mov_b32 s55, 0x20000
s_mov_b32 s56, s4
s_and_b32 s57, s5, 0xffff
s_mov_b32 s58, 0x800
s_mov_b32 s59, 0x20000
v_lshrrev_b32 v192, 3, v2
v_lshlrev_b32 v192, 10, v192
v_lshl_add_u32 v192, v3, 5, v192
s_lshl_b32 s62, s34, 7
v_add_u32 v192, s62, v192
buffer_load_dwordx4 v[12:15], v192, s[56:59], 0 offen
buffer_load_dwordx4 v[16:19], v192, s[56:59], 0 offen offset:16
v_lshlrev_b32 v10, 17, v3
v_lshl_add_u32 v10, v2, 4, v10
s_lshl_b32 s62, s34, 19
v_add_u32 v10, s62, v10
s_mov_b32 s62, 0
buffer_load_dwordx4 v[64:67], v10, s[52:55], s62 offen nt
s_mov_b32 s62, 8192
buffer_load_dwordx4 v[68:71], v10, s[52:55], s62 offen nt
s_mov_b32 s62, 16384
buffer_load_dwordx4 v[72:75], v10, s[52:55], s62 offen nt
s_mov_b32 s62, 24576
buffer_load_dwordx4 v[76:79], v10, s[52:55], s62 offen nt
s_mov_b32 s62, 32768
buffer_load_dwordx4 v[80:83], v10, s[52:55], s62 offen nt
s_mov_b32 s62, 40960
buffer_load_dwordx4 v[84:87], v10, s[52:55], s62 offen nt
v_lshrrev_b32 v192, 1, v3
v_lshlrev_b32 v192, 9, v192
v_lshl_add_u32 v192, v2, 5, v192
v_and_b32 v193, 1, v3
v_lshl_add_u32 v192, v193, 4, v192
s_lshl_b32 s63, s34, 10
s_add_u32 s63, s63, 140288
v_add_u32 v192, s63, v192
v_lshlrev_b32 v193, 4, v1
s_lshl_b32 s63, s32, 10
s_add_u32 s63, s63, 0x40000
v_add_u32 v194, s63, v193
v_add_u32 v193, 140288, v193
s_mov_b32 s66, 0x01000100
s_mov_b32 s67, 0x03020302
s_waitcnt vmcnt(5)
s_mov_b32 s62, 49152
buffer_load_dwordx4 v[88:91], v10, s[52:55], s62 offen nt
v_perm_b32 v195, v12, v12, s66
v_and_b32 v28, v195, v4
v_and_b32 v29, v195, v5
v_and_b32 v30, v195, v6
v_and_b32 v31, v195, v7
s_nop 1
v_mfma_f32_16x16x32_bf16 v[44:47], v[28:31], v[64:67], 0
s_waitcnt vmcnt(5)
s_mov_b32 s62, 57344
buffer_load_dwordx4 v[92:95], v10, s[52:55], s62 offen nt
v_perm_b32 v195, v12, v12, s67
v_and_b32 v32, v195, v4
v_and_b32 v33, v195, v5
v_and_b32 v34, v195, v6
v_and_b32 v35, v195, v7
s_nop 1
v_mfma_f32_16x16x32_bf16 v[44:47], v[32:35], v[68:71], v[44:47]
s_waitcnt vmcnt(5)
s_mov_b32 s62, 65536
buffer_load_dwordx4 v[96:99], v10, s[52:55], s62 offen nt
v_perm_b32 v195, v13, v13, s66
v_and_b32 v28, v195, v4
v_and_b32 v29, v195, v5
v_and_b32 v30, v195, v6
v_and_b32 v31, v195, v7
s_nop 1
v_mfma_f32_16x16x32_bf16 v[44:47], v[28:31], v[72:75], v[44:47]
s_waitcnt vmcnt(5)
s_mov_b32 s62, 73728
buffer_load_dwordx4 v[100:103], v10, s[52:55], s62 offen nt
v_perm_b32 v195, v13, v13, s67
v_and_b32 v32, v195, v4
v_and_b32 v33, v195, v5
v_and_b32 v34, v195, v6
v_and_b32 v35, v195, v7
s_nop 1
v_mfma_f32_16x16x32_bf16 v[44:47], v[32:35], v[76:79], v[44:47]
s_waitcnt vmcnt(5)
s_mov_b32 s62, 81920
buffer_load_dwordx4 v[104:107], v10, s[52:55], s62 offen nt
v_perm_b32 v195, v14, v14, s66
v_and_b32 v28, v195, v4
v_and_b32 v29, v195, v5
v_and_b32 v30, v195, v6
v_and_b32 v31, v195, v7
s_nop 1
v_mfma_f32_16x16x32_bf16 v[44:47], v[28:31], v[80:83], v[44:47]
s_waitcnt vmcnt(5)
s_mov_b32 s62, 90112
buffer_load_dwordx4 v[108:111], v10, s[52:55], s62 offen nt
v_perm_b32 v195, v14, v14, s67
v_and_b32 v32, v195, v4
v_and_b32 v33, v195, v5
v_and_b32 v34, v195, v6
v_and_b32 v35, v195, v7
s_nop 1
v_mfma_f32_16x16x32_bf16 v[44:47], v[32:35], v[84:87], v[44:47]
s_waitcnt vmcnt(5)
s_mov_b32 s62, 98304
buffer_load_dwordx4 v[112:115], v10, s[52:55], s62 offen nt
v_perm_b32 v195, v15, v15, s66
v_and_b32 v28, v195, v4
v_and_b32 v29, v195, v5
v_and_b32 v30, v195, v6
v_and_b32 v31, v195, v7
s_nop 1
v_mfma_f32_16x16x32_bf16 v[44:47], v[28:31], v[88:91], v[44:47]
s_waitcnt vmcnt(5)
s_mov_b32 s62, 106496
buffer_load_dwordx4 v[116:119], v10, s[52:55], s62 offen nt
v_perm_b32 v195, v15, v15, s67
v_and_b32 v32, v195, v4
v_and_b32 v33, v195, v5
v_and_b32 v34, v195, v6
v_and_b32 v35, v195, v7
s_nop 1
v_mfma_f32_16x16x32_bf16 v[44:47], v[32:35], v[92:95], v[44:47]
s_waitcnt vmcnt(5)
s_mov_b32 s62, 114688
buffer_load_dwordx4 v[120:123], v10, s[52:55], s62 offen nt
v_perm_b32 v195, v16, v16, s66
v_and_b32 v28, v195, v4
v_and_b32 v29, v195, v5
v_and_b32 v30, v195, v6
v_and_b32 v31, v195, v7
s_nop 1
v_mfma_f32_16x16x32_bf16 v[44:47], v[28:31], v[96:99], v[44:47]
s_waitcnt vmcnt(5)
s_mov_b32 s62, 122880
buffer_load_dwordx4 v[124:127], v10, s[52:55], s62 offen nt
v_perm_b32 v195, v16, v16, s67
v_and_b32 v32, v195, v4
v_and_b32 v33, v195, v5
v_and_b32 v34, v195, v6
v_and_b32 v35, v195, v7
s_nop 1
v_mfma_f32_16x16x32_bf16 v[44:47], v[32:35], v[100:103], v[44:47]
s_waitcnt vmcnt(5)
v_perm_b32 v195, v17, v17, s66
v_and_b32 v28, v195, v4
v_and_b32 v29, v195, v5
v_and_b32 v30, v195, v6
v_and_b32 v31, v195, v7
s_nop 1
v_mfma_f32_16x16x32_bf16 v[44:47], v[28:31], v[104:107], v[44:47]
s_waitcnt vmcnt(4)
v_perm_b32 v195, v17, v17, s67
v_and_b32 v32, v195, v4
v_and_b32 v33, v195, v5
v_and_b32 v34, v195, v6
v_and_b32 v35, v195, v7
s_nop 1
v_mfma_f32_16x16x32_bf16 v[44:47], v[32:35], v[108:111], v[44:47]
s_waitcnt vmcnt(3)
v_perm_b32 v195, v18, v18, s66
v_and_b32 v28, v195, v4
v_and_b32 v29, v195, v5
v_and_b32 v30, v195, v6
v_and_b32 v31, v195, v7
s_nop 1
v_mfma_f32_16x16x32_bf16 v[44:47], v[28:31], v[112:115], v[44:47]
s_waitcnt vmcnt(2)
v_perm_b32 v195, v18, v18, s67
v_and_b32 v32, v195, v4
v_and_b32 v33, v195, v5
v_and_b32 v34, v195, v6
v_and_b32 v35, v195, v7
s_nop 1
v_mfma_f32_16x16x32_bf16 v[44:47], v[32:35], v[116:119], v[44:47]
s_waitcnt vmcnt(1)
v_perm_b32 v195, v19, v19, s66
v_and_b32 v28, v195, v4
v_and_b32 v29, v195, v5
v_and_b32 v30, v195, v6
v_and_b32 v31, v195, v7
s_nop 1
v_mfma_f32_16x16x32_bf16 v[44:47], v[28:31], v[120:123], v[44:47]
s_waitcnt vmcnt(0)
v_perm_b32 v195, v19, v19, s67
v_and_b32 v32, v195, v4
v_and_b32 v33, v195, v5
v_and_b32 v34, v195, v6
v_and_b32 v35, v195, v7
s_nop 1
v_mfma_f32_16x16x32_bf16 v[44:47], v[32:35], v[124:127], v[44:47]
s_nop 7
ds_write_b128 v192, v[44:47]
s_waitcnt lgkmcnt(0)
s_add_u32 s88, s88, 0x9e3779b9
s_barrier
s_cmp_lg_u32 s34, 0
s_cbranch_scc1 L_C_qdone
ds_read_b128 v[64:67], v193 offset:0
ds_read_b128 v[68:71], v193 offset:1024
ds_read_b128 v[72:75], v193 offset:2048
ds_read_b128 v[76:79], v193 offset:3072
ds_read_b128 v[80:83], v193 offset:4096
ds_read_b128 v[84:87], v193 offset:5120
ds_read_b128 v[88:91], v193 offset:6144
ds_read_b128 v[92:95], v193 offset:7168
s_waitcnt lgkmcnt(6)
v_add_f32 v64, v64, v68
v_add_f32 v65, v65, v69
v_add_f32 v66, v66, v70
v_add_f32 v67, v67, v71
s_waitcnt lgkmcnt(5)
v_add_f32 v64, v64, v72
v_add_f32 v65, v65, v73
v_add_f32 v66, v66, v74
v_add_f32 v67, v67, v75
s_waitcnt lgkmcnt(4)
v_add_f32 v64, v64, v76
v_add_f32 v65, v65, v77
v_add_f32 v66, v66, v78
v_add_f32 v67, v67, v79
s_waitcnt lgkmcnt(3)
v_add_f32 v64, v64, v80
v_add_f32 v65, v65, v81
v_add_f32 v66, v66, v82
v_add_f32 v67, v67, v83
s_waitcnt lgkmcnt(2)
v_add_f32 v64, v64, v84
v_add_f32 v65, v65, v85
v_add_f32 v66, v66, v86
v_add_f32 v67, v67, v87
s_waitcnt lgkmcnt(1)
v_add_f32 v64, v64, v88
v_add_f32 v65, v65, v89
v_add_f32 v66, v66, v90
v_add_f32 v67, v67, v91
s_waitcnt lgkmcnt(0)
v_add_f32 v64, v64, v92
v_add_f32 v65, v65, v93
v_add_f32 v66, v66, v94
v_add_f32 v67, v67, v95
v_cvt_pk_bf16_f32 v64, v64, v65
v_cvt_pk_bf16_f32 v66, v66, v67
v_mov_b32 v65, s88
v_mov_b32 v67, s88
buffer_store_dwordx4 v[64:67], v194, s[44:47], 0 offen sc1
L_C_qdone:
s_barrier
s_add_u32 s50, s38, 72704
s_waitcnt vmcnt(3)
s_add_u32 m0, s50, 0
s_nop 0
buffer_load_dwordx4 v9, s[40:43], 0 offen offset:0 nt lds
s_waitcnt vmcnt(3)
s_add_u32 m0, s50, 32
s_nop 0
buffer_load_dwordx4 v9, s[40:43], 0 offen offset:1024 nt lds
s_waitcnt vmcnt(3)
s_add_u32 m0, s50, 64
s_nop 0
buffer_load_dwordx4 v9, s[40:43], 0 offen offset:2048 nt lds
s_waitcnt vmcnt(3)
s_add_u32 m0, s50, 96
s_nop 0
buffer_load_dwordx4 v9, s[40:43], 0 offen offset:3072 nt lds
s_waitcnt vmcnt(3)
s_add_u32 m0, s50, 4224
s_nop 0
buffer_load_dwordx4 v9, s[40:43], s51 offen offset:0 nt lds
s_waitcnt vmcnt(3)
s_add_u32 m0, s50, 4256
s_nop 0
buffer_load_dwordx4 v9, s[40:43], s51 offen offset:1024 nt lds
s_waitcnt vmcnt(3)
s_add_u32 m0, s50, 4288
s_nop 0
buffer_load_dwordx4 v9, s[40:43], s51 offen offset:2048 nt lds
s_waitcnt vmcnt(3)
s_add_u32 m0, s50, 4320
s_nop 0
buffer_load_dwordx4 v9, s[40:43], s51 offen offset:3072 nt lds
v_add_u32 v9, 0x10000, v9
s_waitcnt vmcnt(3)
buffer_load_dwordx4 v[208:211], v9, s[40:43], 0 offen offset:0 nt
s_waitcnt vmcnt(3)
buffer_load_dwordx4 v[212:215], v9, s[40:43], 0 offen offset:1024 nt
s_waitcnt vmcnt(3)
buffer_load_dwordx4 v[216:219], v9, s[40:43], 0 offen offset:2048 nt
s_waitcnt vmcnt(3)
buffer_load_dwordx4 v[220:223], v9, s[40:43], 0 offen offset:3072 nt
s_waitcnt vmcnt(3)
buffer_load_dwordx4 v[224:227], v9, s[40:43], s51 offen offset:0 nt
s_waitcnt vmcnt(3)
buffer_load_dwordx4 v[228:231], v9, s[40:43], s51 offen offset:1024 nt
s_waitcnt vmcnt(3)
buffer_load_dwordx4 v[232:235], v9, s[40:43], s51 offen offset:2048 nt
s_waitcnt vmcnt(3)
buffer_load_dwordx4 v[236:239], v9, s[40:43], s51 offen offset:3072 nt
v_add_u32 v9, 0x10000, v9
s_add_u32 s62, s38, 5120
v_lshl_add_u32 v22, v1, 4, s62
s_lshl_b32 s62, s36, 4
v_add_u32 v240, s62, v2
v_mul_u32_u24 v10, 1056, v240
v_lshl_add_u32 v10, v3, 4, v10
v_add_u32 v10, 5120, v10
v_lshrrev_b32 v240, 1, v3
v_lshlrev_b32 v240, 3, v240
v_lshrrev_b32 v241, 2, v2
v_add_u32 v240, v240, v241
v_mul_u32_u24 v11, 1056, v240
v_and_b32 v240, 1, v3
v_lshl_add_u32 v11, v240, 5, v11
v_and_b32 v240, 3, v2
v_lshl_add_u32 v11, v240, 3, v11
s_lshl_b32 s62, s34, 7
s_add_u32 s62, s62, 5120
v_add_u32 v11, s62, v11
s_lshl_b32 s62, s37, 4
v_add_u32 v240, s62, v2
v_mul_u32_u24 v12, 144, v240
v_lshl_add_u32 v12, v3, 3, v12
s_lshl_b32 s62, s36, 5
v_add_u32 v12, s62, v12
v_lshlrev_b32 v15, 4, v240
s_lshl_b32 s62, s36, 2
v_add_u32 v14, s62, v15
v_and_b32 v240, 31, v1
v_mul_u32_u24 v13, 144, v240
v_lshrrev_b32 v241, 5, v1
v_lshl_add_u32 v13, v241, 4, v13
v_lshlrev_b32 v16, 4, v240
v_mov_b32 v17, 0x3e0293ee
v_mov_b32 v18, 0xff800000
v_mov_b32 v19, 0xff800000
v_mov_b32 v20, 0
v_mov_b32 v96, 0
v_mov_b32 v97, 0
v_mov_b32 v98, 0
v_mov_b32 v99, 0
v_mov_b32 v100, 0
v_mov_b32 v101, 0
v_mov_b32 v102, 0
v_mov_b32 v103, 0
v_mov_b32 v104, 0
v_mov_b32 v105, 0
v_mov_b32 v106, 0
v_mov_b32 v107, 0
v_mov_b32 v108, 0
v_mov_b32 v109, 0
v_mov_b32 v110, 0
v_mov_b32 v111, 0
v_mov_b32 v112, 0
v_mov_b32 v113, 0
v_mov_b32 v114, 0
v_mov_b32 v115, 0
v_mov_b32 v116, 0
v_mov_b32 v117, 0
v_mov_b32 v118, 0
v_mov_b32 v119, 0
v_mov_b32 v120, 0
v_mov_b32 v121, 0
v_mov_b32 v122, 0
v_mov_b32 v123, 0
v_mov_b32 v124, 0
v_mov_b32 v125, 0
v_mov_b32 v126, 0
v_mov_b32 v127, 0
s_cmp_lg_u32 s34, 0
s_cbranch_scc1 L_wc_Cq
s_mov_b32 s62, 0x1a000
v_lshl_add_u32 v240, v1, 8, s62
s_lshl_b64 exec, 1, s32
s_mov_b32 s64, 0
L_tp_Cq0:
buffer_load_dword v241, v240, s[44:47], 0 offen sc1
s_waitcnt vmcnt(0)
v_cmp_ne_u32 vcc, s88, v241
s_add_u32 s64, s64, 1
s_nop 0
s_or_b64 vcc, vcc, vcc
s_cbranch_scc0 L_tp_Cq0_ok
s_sleep 32
s_cmp_lt_u32 s64, 65536
s_cbranch_scc1 L_tp_Cq0
L_tp_Cq0_ok:
s_mov_b32 exec_lo, -1
s_mov_b32 exec_hi, 0
s_mov_b32 s64, 0
L_tp_Cq:
buffer_load_dword v241, v240, s[44:47], 0 offen sc1
s_waitcnt vmcnt(0)
v_cmp_ne_u32 vcc, s88, v241
s_add_u32 s64, s64, 1
s_nop 0
s_or_b64 vcc, vcc, vcc
s_cbranch_scc0 L_tp_Cq_ok
s_mov_b64 exec, vcc
s_sleep 8
s_cmp_lt_u32 s64, 65536
s_cbranch_scc1 L_tp_Cq
L_tp_Cq_ok:
s_mov_b64 exec, -1
L_wc_Cq:
s_barrier
s_lshl_b32 s62, s35, 5
s_lshl_b32 s63, s37, 4
s_add_u32 s62, s62, s63
v_add_u32 v240, s62, v2
v_lshlrev_b32 v240, 10, v240
v_lshl_add_u32 v240, v3, 4, v240
v_add_u32 v240, 0x0, v240
buffer_load_dwordx4 v[32:35], v240, s[44:47], 0 offen offset:0 sc1
buffer_load_dwordx4 v[36:39], v240, s[44:47], 0 offen offset:64 sc1
buffer_load_dwordx4 v[40:43], v240, s[44:47], 0 offen offset:128 sc1
buffer_load_dwordx4 v[44:47], v240, s[44:47], 0 offen offset:192 sc1
buffer_load_dwordx4 v[48:51], v240, s[44:47], 0 offen offset:256 sc1
buffer_load_dwordx4 v[52:55], v240, s[44:47], 0 offen offset:320 sc1
buffer_load_dwordx4 v[56:59], v240, s[44:47], 0 offen offset:384 sc1
buffer_load_dwordx4 v[60:63], v240, s[44:47], 0 offen offset:448 sc1
buffer_load_dwordx4 v[64:67], v240, s[44:47], 0 offen offset:512 sc1
buffer_load_dwordx4 v[68:71], v240, s[44:47], 0 offen offset:576 sc1
buffer_load_dwordx4 v[72:75], v240, s[44:47], 0 offen offset:640 sc1
buffer_load_dwordx4 v[76:79], v240, s[44:47], 0 offen offset:704 sc1
buffer_load_dwordx4 v[80:83], v240, s[44:47], 0 offen offset:768 sc1
buffer_load_dwordx4 v[84:87], v240, s[44:47], 0 offen offset:832 sc1
buffer_load_dwordx4 v[88:91], v240, s[44:47], 0 offen offset:896 sc1
buffer_load_dwordx4 v[92:95], v240, s[44:47], 0 offen offset:960 sc1
s_mov_b32 s39, 0
s_mov_b32 s48, 0
.p2align 6
L_C_loop:
s_cmp_lg_u32 s39, 0
s_cbranch_scc1 L_C_top
s_waitcnt vmcnt(0)
L_C_top:
s_waitcnt lgkmcnt(0)
s_barrier
s_mov_b32 s52, 1
s_cmp_eq_u32 s39, 0
s_cselect_b32 s52, 0, s52
s_cmp_ge_u32 s39, 7
s_cselect_b32 s52, 0, s52
s_sub_u32 s50, 67584, s48
v_add_u32 v23, s50, v22
s_cmp_eq_u32 s52, 0
s_cbranch_scc1 L_C_st0
s_waitcnt vmcnt(7)
ds_write_b128 v23, v[208:211] offset:0
buffer_load_dwordx4 v[208:211], v9, s[40:43], 0 offen offset:0 nt
s_waitcnt vmcnt(7)
ds_write_b128 v23, v[212:215] offset:1056
buffer_load_dwordx4 v[212:215], v9, s[40:43], 0 offen offset:1024 nt
s_waitcnt vmcnt(7)
ds_write_b128 v23, v[216:219] offset:2112
buffer_load_dwordx4 v[216:219], v9, s[40:43], 0 offen offset:2048 nt
s_waitcnt vmcnt(7)
ds_write_b128 v23, v[220:223] offset:3168
buffer_load_dwordx4 v[220:223], v9, s[40:43], 0 offen offset:3072 nt
s_waitcnt vmcnt(7)
ds_write_b128 v23, v[224:227] offset:4224
buffer_load_dwordx4 v[224:227], v9, s[40:43], s51 offen offset:0 nt
s_waitcnt vmcnt(7)
ds_write_b128 v23, v[228:231] offset:5280
buffer_load_dwordx4 v[228:231], v9, s[40:43], s51 offen offset:1024 nt
s_waitcnt vmcnt(7)
ds_write_b128 v23, v[232:235] offset:6336
buffer_load_dwordx4 v[232:235], v9, s[40:43], s51 offen offset:2048 nt
s_waitcnt vmcnt(7)
ds_write_b128 v23, v[236:239] offset:7392
buffer_load_dwordx4 v[236:239], v9, s[40:43], s51 offen offset:3072 nt
v_add_u32 v9, 0x10000, v9
L_C_st0:
v_add_u32 v240, s48, v10
v_add_u32 v241, s48, v11
ds_read_b128 v[128:131], v240 offset:0
ds_read_b128 v[132:135], v240 offset:64
ds_read_b128 v[136:139], v240 offset:128
ds_read_b128 v[140:143], v240 offset:192
ds_read_b128 v[144:147], v240 offset:256
ds_read_b128 v[148:151], v240 offset:320
ds_read_b128 v[152:155], v240 offset:384
ds_read_b128 v[156:159], v240 offset:448
ds_read_b128 v[160:163], v240 offset:512
ds_read_b128 v[164:167], v240 offset:576
ds_read_b128 v[168:171], v240 offset:640
ds_read_b128 v[172:175], v240 offset:704
ds_read_b128 v[176:179], v240 offset:768
ds_read_b128 v[180:183], v240 offset:832
ds_read_b128 v[184:187], v240 offset:896
ds_read_b128 v[188:191], v240 offset:960
s_waitcnt lgkmcnt(15)
v_mfma_f32_16x16x32_bf16 v[28:31], v[128:131], v[32:35], 0
s_waitcnt lgkmcnt(14)
v_mfma_f32_16x16x32_bf16 v[28:31], v[132:135], v[36:39], v[28:31]
s_waitcnt lgkmcnt(13)
v_mfma_f32_16x16x32_bf16 v[28:31], v[136:139], v[40:43], v[28:31]
s_waitcnt lgkmcnt(12)
v_mfma_f32_16x16x32_bf16 v[28:31], v[140:143], v[44:47], v[28:31]
s_waitcnt lgkmcnt(11)
v_mfma_f32_16x16x32_bf16 v[28:31], v[144:147], v[48:51], v[28:31]
s_waitcnt lgkmcnt(10)
v_mfma_f32_16x16x32_bf16 v[28:31], v[148:151], v[52:55], v[28:31]
s_waitcnt lgkmcnt(9)
v_mfma_f32_16x16x32_bf16 v[28:31], v[152:155], v[56:59], v[28:31]
s_waitcnt lgkmcnt(8)
v_mfma_f32_16x16x32_bf16 v[28:31], v[156:159], v[60:63], v[28:31]
s_waitcnt lgkmcnt(7)
v_mfma_f32_16x16x32_bf16 v[28:31], v[160:163], v[64:67], v[28:31]
s_waitcnt lgkmcnt(6)
v_mfma_f32_16x16x32_bf16 v[28:31], v[164:167], v[68:71], v[28:31]
s_waitcnt lgkmcnt(5)
v_mfma_f32_16x16x32_bf16 v[28:31], v[168:171], v[72:75], v[28:31]
s_waitcnt lgkmcnt(4)
v_mfma_f32_16x16x32_bf16 v[28:31], v[172:175], v[76:79], v[28:31]
s_waitcnt lgkmcnt(3)
v_mfma_f32_16x16x32_bf16 v[28:31], v[176:179], v[80:83], v[28:31]
s_waitcnt lgkmcnt(2)
v_mfma_f32_16x16x32_bf16 v[28:31], v[180:183], v[84:87], v[28:31]
s_waitcnt lgkmcnt(1)
v_mfma_f32_16x16x32_bf16 v[28:31], v[184:187], v[88:91], v[28:31]
s_waitcnt lgkmcnt(0)
v_mfma_f32_16x16x32_bf16 v[28:31], v[188:191], v[92:95], v[28:31]
s_nop 7
v_mul_f32 v24, v28, v17
v_mul_f32 v25, v29, v17
v_mul_f32 v26, v30, v17
v_mul_f32 v27, v31, v17
v_max3_f32 v242, v24, v25, v26
v_max_f32 v242, v242, v27
v_mov_b32 v243, v242
s_nop 1
v_permlane16_swap_b32 v242, v243
s_nop 0
v_max_f32 v242, v242, v243
v_mov_b32 v243, v242
s_nop 1
v_permlane32_swap_b32 v242, v243
s_nop 0
v_max_f32 v242, v242, v243
s_mov_b64 exec, 0xffff
ds_write_b32 v14, v242 offset:0
s_mov_b64 exec, -1
s_waitcnt lgkmcnt(0)
s_barrier
ds_read_b128 v[192:195], v15 offset:0
ds_read_b128 v[196:199], v16 offset:0
s_waitcnt lgkmcnt(1)
v_max3_f32 v242, v192, v193, v194
v_max3_f32 v242, v242, v195, v18
v_sub_f32 v21, v18, v242
v_sub_f32 v24, v24, v242
v_sub_f32 v25, v25, v242
v_sub_f32 v26, v26, v242
v_sub_f32 v27, v27, v242
v_exp_f32 v21, v21
v_exp_f32 v24, v24
v_exp_f32 v25, v25
v_exp_f32 v26, v26
v_exp_f32 v27, v27
v_mov_b32 v18, v242
v_cvt_pk_bf16_f32 v244, v24, v25
v_cvt_pk_bf16_f32 v245, v26, v27
ds_write_b64 v12, v[244:245] offset:512
v_add_f32 v24, v24, v25
v_add_f32 v26, v26, v27
v_fma_f32 v20, v20, v21, v24
v_add_f32 v20, v20, v26
s_waitcnt lgkmcnt(1)
v_max3_f32 v242, v196, v197, v198
v_max3_f32 v242, v242, v199, v19
v_sub_f32 v21, v19, v242
v_exp_f32 v21, v21
v_mov_b32 v19, v242
v_mul_f32 v96, v96, v21
v_mul_f32 v97, v97, v21
v_mul_f32 v98, v98, v21
v_mul_f32 v99, v99, v21
v_mul_f32 v100, v100, v21
v_mul_f32 v101, v101, v21
v_mul_f32 v102, v102, v21
v_mul_f32 v103, v103, v21
v_mul_f32 v104, v104, v21
v_mul_f32 v105, v105, v21
v_mul_f32 v106, v106, v21
v_mul_f32 v107, v107, v21
v_mul_f32 v108, v108, v21
v_mul_f32 v109, v109, v21
v_mul_f32 v110, v110, v21
v_mul_f32 v111, v111, v21
v_mul_f32 v112, v112, v21
v_mul_f32 v113, v113, v21
v_mul_f32 v114, v114, v21
v_mul_f32 v115, v115, v21
v_mul_f32 v116, v116, v21
v_mul_f32 v117, v117, v21
v_mul_f32 v118, v118, v21
v_mul_f32 v119, v119, v21
v_mul_f32 v120, v120, v21
v_mul_f32 v121, v121, v21
v_mul_f32 v122, v122, v21
v_mul_f32 v123, v123, v21
v_mul_f32 v124, v124, v21
v_mul_f32 v125, v125, v21
v_mul_f32 v126, v126, v21
v_mul_f32 v127, v127, v21
s_waitcnt lgkmcnt(0)
s_barrier
ds_read_b128 v[192:195], v13 offset:512
ds_read_b128 v[196:199], v13 offset:544
ds_read_b128 v[200:203], v13 offset:576
ds_read_b128 v[204:207], v13 offset:608
ds_read_b64_tr_b16 v[128:129], v241 offset:0
ds_read_b64_tr_b16 v[130:131], v241 offset:4224
ds_read_b64_tr_b16 v[132:133], v241 offset:64
ds_read_b64_tr_b16 v[134:135], v241 offset:4288
ds_read_b64_tr_b16 v[136:137], v241 offset:16896
ds_read_b64_tr_b16 v[138:139], v241 offset:21120
ds_read_b64_tr_b16 v[140:141], v241 offset:16960
ds_read_b64_tr_b16 v[142:143], v241 offset:21184
ds_read_b64_tr_b16 v[144:145], v241 offset:33792
ds_read_b64_tr_b16 v[146:147], v241 offset:38016
ds_read_b64_tr_b16 v[148:149], v241 offset:33856
ds_read_b64_tr_b16 v[150:151], v241 offset:38080
ds_read_b64_tr_b16 v[152:153], v241 offset:50688
ds_read_b64_tr_b16 v[154:155], v241 offset:54912
ds_read_b64_tr_b16 v[156:157], v241 offset:50752
ds_read_b64_tr_b16 v[158:159], v241 offset:54976
s_waitcnt lgkmcnt(12)
v_mfma_f32_32x32x16_bf16 v[96:111], v[128:131], v[192:195], v[96:111]
v_mfma_f32_32x32x16_bf16 v[112:127], v[132:135], v[192:195], v[112:127]
s_waitcnt lgkmcnt(8)
v_mfma_f32_32x32x16_bf16 v[96:111], v[136:139], v[196:199], v[96:111]
v_mfma_f32_32x32x16_bf16 v[112:127], v[140:143], v[196:199], v[112:127]
s_waitcnt lgkmcnt(4)
v_mfma_f32_32x32x16_bf16 v[96:111], v[144:147], v[200:203], v[96:111]
v_mfma_f32_32x32x16_bf16 v[112:127], v[148:151], v[200:203], v[112:127]
s_waitcnt lgkmcnt(0)
v_mfma_f32_32x32x16_bf16 v[96:111], v[152:155], v[204:207], v[96:111]
v_mfma_f32_32x32x16_bf16 v[112:127], v[156:159], v[204:207], v[112:127]
s_sub_u32 s48, 67584, s48
s_add_u32 s39, s39, 1
s_cmp_lt_u32 s39, 8
s_cbranch_scc1 L_C_loop
v_mov_b32 v243, v20
s_nop 1
v_permlane16_swap_b32 v20, v243
s_nop 0
v_add_f32 v20, v20, v243
v_mov_b32 v243, v20
s_nop 1
v_permlane32_swap_b32 v20, v243
s_nop 0
v_add_f32 v20, v20, v243
s_barrier
s_mov_b64 exec, 0xffff
ds_write_b32 v14, v20 offset:0
s_mov_b64 exec, -1
v_and_b32 v240, 31, v1
v_mul_u32_u24 v240, 2064, v240
v_lshrrev_b32 v241, 5, v1
v_lshl_add_u32 v240, v241, 4, v240
s_lshl_b32 s62, s34, 8
s_add_u32 s62, s62, 5120
v_add_u32 v240, s62, v240
s_nop 5
ds_write_b128 v240, v[96:99] offset:0
ds_write_b128 v240, v[100:103] offset:32
ds_write_b128 v240, v[104:107] offset:64
ds_write_b128 v240, v[108:111] offset:96
ds_write_b128 v240, v[112:115] offset:128
ds_write_b128 v240, v[116:119] offset:160
ds_write_b128 v240, v[120:123] offset:192
ds_write_b128 v240, v[124:127] offset:224
s_waitcnt lgkmcnt(0)
s_barrier
s_mul_i32 s62, s34, 8256
s_add_u32 s62, s62, 5120
v_lshl_add_u32 v240, v1, 5, s62
ds_read_b128 v[128:131], v240 offset:0
ds_read_b128 v[132:135], v240 offset:16
ds_read_b128 v[136:139], v240 offset:2064
ds_read_b128 v[140:143], v240 offset:2080
ds_read_b128 v[144:147], v240 offset:4128
ds_read_b128 v[148:151], v240 offset:4144
ds_read_b128 v[152:155], v240 offset:6192
ds_read_b128 v[156:159], v240 offset:6208
s_lshl_b32 s62, s35, 5
s_lshl_b32 s63, s34, 2
s_add_u32 s62, s62, s63
s_lshl_b32 s62, s62, 4
s_and_b32 s63, s32, 15
s_add_u32 s62, s62, s63
s_lshl_b32 s62, s62, 10
s_add_u32 s62, s62, 0x200000
v_lshl_add_u32 v241, v1, 4, s62
s_waitcnt lgkmcnt(6)
v_cvt_pk_bf16_f32 v160, v128, v129
v_cvt_pk_bf16_f32 v161, v130, v131
v_cvt_pk_bf16_f32 v162, v132, v133
v_cvt_pk_bf16_f32 v163, v134, v135
s_mov_b32 s63, 0
buffer_store_dwordx4 v[160:163], v241, s[44:47], s63 offen sc1
s_waitcnt lgkmcnt(4)
v_cvt_pk_bf16_f32 v164, v136, v137
v_cvt_pk_bf16_f32 v165, v138, v139
v_cvt_pk_bf16_f32 v166, v140, v141
v_cvt_pk_bf16_f32 v167, v142, v143
s_mov_b32 s63, 16384
buffer_store_dwordx4 v[164:167], v241, s[44:47], s63 offen sc1
s_waitcnt lgkmcnt(2)
v_cvt_pk_bf16_f32 v168, v144, v145
v_cvt_pk_bf16_f32 v169, v146, v147
v_cvt_pk_bf16_f32 v170, v148, v149
v_cvt_pk_bf16_f32 v171, v150, v151
s_mov_b32 s63, 32768
buffer_store_dwordx4 v[168:171], v241, s[44:47], s63 offen sc1
s_waitcnt lgkmcnt(0)
v_cvt_pk_bf16_f32 v172, v152, v153
v_cvt_pk_bf16_f32 v173, v154, v155
v_cvt_pk_bf16_f32 v174, v156, v157
v_cvt_pk_bf16_f32 v175, v158, v159
s_mov_b32 s63, 49152
buffer_store_dwordx4 v[172:175], v241, s[44:47], s63 offen sc1
ds_read_b128 v[192:195], v16 offset:0
v_and_b32 v240, 31, v1
s_lshl_b32 s63, s32, 9
s_add_u32 s63, s63, 0x10000
v_lshl_add_u32 v240, v240, 4, s63
s_waitcnt lgkmcnt(0)
v_add_f32 v192, v192, v193
v_add_f32 v194, v194, v195
v_add_f32 v194, v192, v194
v_mov_b32 v192, v19
v_mov_b32 v193, s88
v_mov_b32 v195, s88
s_waitcnt vmcnt(0)
s_barrier
s_cmp_lg_u32 s34, 1
s_cbranch_scc1 L_C_noas
s_and_b32 s63, s32, 7
s_mul_i32 s63, s63, 0x100
s_add_u32 s63, s63, 0xc0000
s_add_u32 s56, s30, s63
s_addc_u32 s57, s31, 0
s_lshl_b32 s62, s32, 21
s_sub_u32 s63, 0x8000000, s62
s_add_u32 s68, s6, s62
s_addc_u32 s69, s7, 0
s_and_b32 s69, s69, 0xffff
s_mov_b32 s70, s63
s_mov_b32 s71, 0x20000
s_add_u32 s72, s8, s62
s_addc_u32 s73, s9, 0
s_and_b32 s73, s73, 0xffff
s_mov_b32 s74, s63
s_mov_b32 s75, 0x20000
s_mov_b64 s[76:77], s[68:69]
s_mov_b64 s[78:79], s[70:71]
s_lshr_b32 s62, s32, 3
s_mul_i32 s62, s62, 6
s_sub_u32 s62, s62, 32
v_add_u32 v136, s62, v1
v_cmp_gt_u32 vcc, 32, v1
v_lshlrev_b32 v133, 7, v1
v_add_u32 v134, 0x4000000, v133
v_cndmask_b32 v128, v136, v1, vcc
v_lshlrev_b32 v128, 2, v128
v_mov_b32 v132, 0
s_mov_b32 s64, 0
L_as_C:
s_mov_b64 exec, 0x1ffffff
s_mov_b32 exec_hi, 0x3f
global_load_dword v129, v128, s[56:57] nt
s_waitcnt vmcnt(0)
v_subrev_u32 v129, s88, v129
s_mov_b64 exec, 0xffffff
v_cmp_le_u32 vcc, 0x400, v129
v_readlane_b32 s62, v129, 24
v_add_u32_dpp v129, v129, v129 row_shr:1 row_mask:0xf bank_mask:0xf bound_ctrl:0
s_nop 1
v_add_u32_dpp v129, v129, v129 row_shr:2 row_mask:0xf bank_mask:0xf bound_ctrl:0
s_nop 1
v_add_u32_dpp v129, v129, v129 row_shr:4 row_mask:0xf bank_mask:0xf bound_ctrl:0
s_nop 1
v_add_u32_dpp v129, v129, v129 row_shr:8 row_mask:0xf bank_mask:0xf bound_ctrl:0
s_nop 0
v_readlane_b32 s61, v129, 15
v_readlane_b32 s63, v129, 23
s_add_u32 s61, s61, s63
s_cbranch_vccnz L_as_C_x
s_cmp_ge_u32 s61, 15168
s_cbranch_scc1 L_as_C_x
s_sub_u32 s61, s61, 120
s_mov_b32 exec_lo, 0
s_mov_b32 exec_hi, 0x3f
v_cmp_gt_u32 vcc, 280, v129
v_add_u32 v130, 56, v129
s_nop 0
v_cndmask_b32 v136, 0, 8, vcc
v_add_u32 v130, v130, v136
v_lshrrev_b32 v130, 4, v130
v_sub_u32 v136, v130, v132
v_cmp_gt_i32 vcc, 4, v136
v_cmp_le_i32 s[66:67], 2, v136
s_nop 0
v_cndmask_b32 v131, 0, 7, vcc
v_cmp_ge_u32 vcc, 41, v130
v_add_u32 v131, v131, v129
v_lshl_add_u32 v131, v131, 6, v1
s_and_b64 vcc, vcc, s[66:67]
v_cndmask_b32 v131, -1, v131, vcc
s_nop 1
v_min_u32_dpp v131, v131, v131 row_shr:1 row_mask:0xf bank_mask:0xf
s_nop 1
v_min_u32_dpp v131, v131, v131 row_shr:2 row_mask:0xf bank_mask:0xf
s_nop 1
v_min_u32_dpp v131, v131, v131 row_shr:4 row_mask:0xf bank_mask:0xf
s_nop 0
v_readlane_b32 s63, v131, 37
s_lshr_b32 s65, s63, 6
s_and_b32 s63, s63, 63
s_mul_i32 s65, s65, 24
s_cmp_ge_i32 s65, s61
s_cbranch_scc1 L_as_C_idle
v_readlane_b32 s65, v130, s63
s_mov_b32 m0, s63
s_mov_b64 exec, -1
s_cmp_lt_u32 s65, 21
s_cselect_b64 s[76:77], s[68:69], s[72:73]
v_writelane_b32 v132, s65, m0
s_cselect_b32 s66, 0, 21
s_sub_u32 s65, s65, s66
s_mul_i32 s65, s65, 0x18000
s_and_b32 s63, s63, 7
s_lshl_b32 s63, s63, 14
s_add_u32 s65, s65, s63
s_add_u32 s66, s65, 0x2000
buffer_load_dword v135, v133, s[76:79], s65 offen
buffer_load_dword v135, v133, s[76:79], s66 offen
buffer_load_dword v135, v134, s[76:79], s65 offen
buffer_load_dword v135, v134, s[76:79], s66 offen
s_waitcnt vmcnt(1)
s_branch L_as_C_next
L_as_C_idle:
s_sleep 4
L_as_C_next:
s_add_u32 s64, s64, 1
s_cmp_lt_u32 s64, 96
s_cbranch_scc1 L_as_C
L_as_C_x:
s_mov_b64 exec, -1
s_waitcnt vmcnt(0)
L_C_noas:
s_cmp_lg_u32 s34, 0
s_cbranch_scc1 L_C_done
s_mov_b32 exec_hi, 0
buffer_store_dwordx4 v[192:195], v240, s[44:47], 0 offen sc1
s_mov_b64 exec, -1
s_cmp_ge_u32 s32, 8
s_cbranch_scc1 L_C_done
s_and_b32 s63, s32, 7
s_mul_i32 s63, s63, 0x100
s_add_u32 s63, s63, 0xc0000
s_add_u32 s56, s30, s63
s_addc_u32 s57, s31, 0
s_mov_b32 s64, 0
s_mov_b32 s59, 0
s_mov_b32 s58, 0
s_lshl_b32 s62, s32, 12
s_add_u32 s62, s62, 0xd0000
v_lshl_add_u32 v132, v1, 4, s62
v_lshrrev_b32 v133, 2, v1
s_mov_b32 s62, 0xd0000
v_lshl_add_u32 v133, v133, 12, s62
v_and_b32 v134, 3, v1
v_lshlrev_b32 v136, 2, v1
v_mov_b32 v139, 0
L_gm_C:
s_mov_b32 exec_lo, -1
s_mov_b32 exec_hi, 0
v_add_u32 v135, s58, v134
v_and_b32 v135, 15, v135
v_lshl_add_u32 v135, v135, 8, v133
global_load_dword v138, v135, s[30:31] sc1
s_mov_b64 exec, 0x1ffffff
global_load_dword v137, v136, s[56:57] nt
s_waitcnt vmcnt(0)
v_subrev_u32 v137, s88, v137
s_mov_b64 exec, 0xffffff
v_cmp_le_u32 vcc, 0x400, v137
v_readlane_b32 s62, v137, 24
v_add_u32_dpp v137, v137, v137 row_shr:1 row_mask:0xf bank_mask:0xf bound_ctrl:0
s_nop 1
v_add_u32_dpp v137, v137, v137 row_shr:2 row_mask:0xf bank_mask:0xf bound_ctrl:0
s_nop 1
v_add_u32_dpp v137, v137, v137 row_shr:4 row_mask:0xf bank_mask:0xf bound_ctrl:0
s_nop 1
v_add_u32_dpp v137, v137, v137 row_shr:8 row_mask:0xf bank_mask:0xf bound_ctrl:0
s_nop 0
v_readlane_b32 s61, v137, 15
v_readlane_b32 s63, v137, 23
s_add_u32 s61, s61, s63
s_mov_b64 exec, 0xff
s_cbranch_vccnz L_gm_C_x
s_add_u32 s63, s61, s88
v_mov_b32 v128, s63
v_mov_b32 v129, s63
v_mov_b32 v130, s63
v_mov_b32 v131, s63
s_lshr_b32 s58, s61, 9
s_and_b32 s63, s58, 15
s_lshl_b32 s63, s63, 8
v_add_u32 v135, s63, v132
s_sub_u32 s58, s58, 2
global_store_dwordx4 v135, v[128:131], s[30:31] sc1
s_mul_i32 s63, s61, 0
s_mul_i32 s65, s59, 8
s_add_u32 s65, s65, s63
s_cmp_eq_u32 s59, 0
s_mov_b32 s59, s61
s_cbranch_scc1 L_gm_C_next
s_mov_b32 exec_lo, -1
v_subrev_u32 v138, s88, v138
v_cmp_gt_u32 vcc, 0x8000, v138
s_nop 1
v_cndmask_b32 v138, 0, v138, vcc
v_max_u32 v139, v139, v138
s_nop 1
v_max_u32_dpp v139, v139, v139 quad_perm:[1,0,3,2] row_mask:0xf bank_mask:0xf
s_nop 1
v_max_u32_dpp v139, v139, v139 quad_perm:[2,3,0,1] row_mask:0xf bank_mask:0xf
v_cmp_eq_u32 vcc, 0, v139
s_nop 0
v_add_u32_dpp v138, v139, v139 row_shr:4 row_mask:0xf bank_mask:0xf bound_ctrl:0
s_nop 1
v_add_u32_dpp v138, v138, v138 row_shr:8 row_mask:0xf bank_mask:0xf bound_ctrl:0
s_cbranch_vccnz L_gm_C_next
s_nop 0
v_readlane_b32 s63, v138, 15
v_readlane_b32 s62, v138, 31
s_add_u32 s63, s63, s62
s_sub_u32 s63, s63, s65
s_ashr_i32 s63, s63, 3
s_add_u32 s63, s63, 0x4000
s_add_u32 s63, s63, s88
s_mov_b64 exec, 0x1000000
v_mov_b32 v140, s63
global_store_dword v136, v140, s[56:57]
L_gm_C_next:
s_cmp_ge_u32 s61, 14400
s_cbranch_scc1 L_gm_C_x
s_add_u32 s64, s64, 1
s_cmp_lt_u32 s64, 128
s_cbranch_scc1 L_gm_C
L_gm_C_x:
s_mov_b64 exec, -1
L_C_done:
s_endpgm
L_exit:
s_endpgm
.section .rodata,"a"
.p2align 6
.amdhsa_kernel concat_heads__gqa_block_cached__compressed_kv_cla__decode_kernel
  .amdhsa_next_free_vgpr 256
  .amdhsa_next_free_sgpr 102
  .amdhsa_accum_offset 256
  .amdhsa_group_segment_fixed_size 0
  .amdhsa_kernarg_size 112
  .amdhsa_user_sgpr_count 2
  .amdhsa_user_sgpr_kernarg_segment_ptr 1
  .amdhsa_system_sgpr_workgroup_id_x 1
.end_amdhsa_kernel
```

```asm
; @launch grid=(256,1,1) block=(512,1,1) lds=153600
.amdgcn_target "amdgcn-amd-amdhsa--gfx950"
.text
.globl concat_heads__gqa_block_cached__compressed_kv_cla__decode_kernel
.p2align 8
.type concat_heads__gqa_block_cached__compressed_kv_cla__decode_kernel,@function
concat_heads__gqa_block_cached__compressed_kv_cla__decode_kernel:
s_cmp_ge_u32 s2, 256
s_cbranch_scc1 L_exit
s_load_dwordx16 s[4:19], s[0:1], 0
s_load_dwordx8 s[20:27], s[0:1], 64
s_load_dwordx4 s[28:31], s[0:1], 96
v_lshrrev_b32 v8, 6, v0
s_and_b32 s60, s2, 7
s_lshr_b32 s61, s2, 3
v_readfirstlane_b32 s34, v8
s_and_b32 s33, s61, 7
s_and_b32 s61, s61, 24
s_add_u32 s32, s60, s61
s_mov_b32 s89, s32
v_and_b32 v1, 63, v0
v_and_b32 v2, 15, v0
v_bfe_u32 v3, v0, 4, 2
s_cmp_eq_u32 s33, 6
s_cbranch_scc1 L_roleW
s_cmp_eq_u32 s33, 7
s_cbranch_scc1 L_roleC
L_roleA:
s_cmp_ge_u32 s34, 4
s_cbranch_scc1 L_A_helper
v_bfe_u32 v24, v0, 3, 2
v_mad_i32_i24 v24, v24, -2, s33
v_add_u32 v25, 6, v24
v_min_u32 v24, v24, v25
v_min_u32 v25, 2, v24
v_mad_u32_u24 v24, v24, 5, v25
v_and_b32 v63, 7, v0
v_add_u32 v24, v24, v63
v_lshrrev_b32 v62, 1, v24
v_add_u32 v25, v25, v63
v_xor_b32 v62, v62, v24
v_cmp_gt_u32 vcc, 7, v25
v_and_b32 v62, 4, v62
v_mul_u32_u24 v62, 3, v62
v_xor_b32 v62, v62, v24
v_cndmask_b32 v62, 32, v62, vcc
v_lshlrev_b32 v62, 17, v62
v_lshrrev_b32 v24, 4, v0
v_lshlrev_b32 v61, 4, v2
v_lshl_add_u32 v61, v24, 13, v61
s_lshl_b32 s60, s89, 8
s_sub_u32 s61, 0x400000, s60
s_mov_b32 s68, s60
s_mov_b32 s70, s61
s_mov_b32 s71, 0x20000
v_readlane_b32 s44, v62, 0
v_readlane_b32 s45, v62, 1
v_readlane_b32 s46, v62, 2
v_readlane_b32 s47, v62, 3
v_readlane_b32 s48, v62, 4
v_readlane_b32 s49, v62, 5
s_lshl_b32 s60, s89, 8
s_sub_u32 s61, 0x400000, s60
s_mov_b32 s72, s60
s_mov_b32 s74, s61
s_mov_b32 s75, 0x20000
v_readlane_b32 s50, v62, 8
v_readlane_b32 s51, v62, 9
s_waitcnt lgkmcnt(0)
s_add_u32 s68, s18, s68
s_addc_u32 s69, s19, 0
s_and_b32 s69, s69, 0xffff
buffer_load_dwordx4 v[128:131], v61, s[68:71], s44 offen
buffer_load_dwordx4 v[132:135], v61, s[68:71], s45 offen
buffer_load_dwordx4 v[136:139], v61, s[68:71], s46 offen
buffer_load_dwordx4 v[140:143], v61, s[68:71], s47 offen
buffer_load_dwordx4 v[144:147], v61, s[68:71], s48 offen
buffer_load_dwordx4 v[148:151], v61, s[68:71], s49 offen
s_add_u32 s72, s20, s72
s_addc_u32 s73, s21, 0
s_and_b32 s73, s73, 0xffff
buffer_load_dwordx4 v[152:155], v61, s[72:75], s50 offen
buffer_load_dwordx4 v[156:159], v61, s[72:75], s51 offen
s_lshl_b32 s35, s33, 2
s_add_u32 s35, s35, s34
s_lshl_b32 s35, s35, 12
s_mov_b32 s36, s35
v_lshlrev_b32 v8, 4, v1
v_add_u32 v9, 0x4000000, v8
s_lshr_b32 s54, s35, 12
s_mov_b32 s57, 0xff
s_sub_u32 s55, s54, 8
s_cselect_b32 s60, 24, 0
s_add_u32 s55, s55, s60
s_sub_u32 s56, s55, 8
s_cselect_b32 s60, 24, 0
s_add_u32 s56, s56, s60
v_and_b32 v24, 1, v0
v_lshlrev_b32 v24, 4, v24
v_mov_b32 v25, 0xffff
v_lshlrev_b32 v24, v24, v25
v_bfe_u32 v25, v0, 1, 2
v_cmp_eq_u32 vcc, 0, v25
s_nop 1
v_cndmask_b32 v4, 0, v24, vcc
v_cmp_eq_u32 vcc, 1, v25
s_nop 1
v_cndmask_b32 v5, 0, v24, vcc
v_cmp_eq_u32 vcc, 2, v25
s_nop 1
v_cndmask_b32 v6, 0, v24, vcc
v_cmp_eq_u32 vcc, 3, v25
s_nop 1
v_cndmask_b32 v7, 0, v24, vcc
s_lshl_b32 s62, s89, 21
s_sub_u32 s63, 0x8000000, s62
s_add_u32 s40, s6, s62
s_addc_u32 s41, s7, 0
s_and_b32 s41, s41, 0xffff
s_mov_b32 s42, s63
s_mov_b32 s43, 0x20000
s_add_u32 s44, s8, s62
s_addc_u32 s45, s9, 0
s_and_b32 s45, s45, 0xffff
s_mov_b32 s46, s63
s_mov_b32 s47, 0x20000
s_mul_i32 s60, s34, 6
s_add_u32 s60, s60, s33
s_lshl_b32 s37, s60, 10
s_add_u32 s37, s37, 0x1f8000
s_mov_b32 s52, 0x555f
s_cmp_lt_u32 s60, 8
s_cselect_b32 s61, 0, 1
s_cselect_b32 s62, 0x200, 0
s_or_b32 s52, s52, s62
s_lshl_b32 s61, s61, 31
s_add_u32 s61, s61, 24576
v_add_u32 v10, s61, v8
s_sub_u32 s60, s60, 8
s_cmp_lt_u32 s60, 8
s_cselect_b32 s61, 0, 1
s_cselect_b32 s62, 0x800, 0
s_or_b32 s52, s52, s62
s_lshl_b32 s61, s61, 31
s_add_u32 s61, s61, 16384
v_add_u32 v11, s61, v9
s_mul_i32 s52, s52, 0x10001
s_mov_b32 s53, s52
s_mov_b32 s48, 0xcccccccc
s_mov_b32 s49, 0xcccccccc
s_mov_b32 s50, 0xaaaaaaaa
s_mov_b32 s51, 0xaaaaaaaa
v_cmp_gt_u32 vcc, 8, v2
v_mov_b32 v47, 0
v_mov_b32 v48, 0
v_mov_b32 v49, 0
v_mov_b32 v50, 0
v_mov_b32 v51, 0
v_cndmask_b32 v12, v4, v47, vcc
v_cndmask_b32 v13, v5, v47, vcc
v_cndmask_b32 v14, v6, v47, vcc
v_cndmask_b32 v15, v7, v47, vcc
v_cndmask_b32 v4, v47, v4, vcc
v_cndmask_b32 v5, v47, v5, vcc
v_cndmask_b32 v6, v47, v6, vcc
v_cndmask_b32 v7, v47, v7, vcc
v_lshlrev_b32 v192, 2, v1
v_mov_b32 v193, 1
s_mov_b64 vcc, 0
s_barrier
v_readlane_b32 s39, v62, 10
s_nop 3
s_waitcnt vmcnt(7)
buffer_load_dwordx4 v[128:131], v61, s[72:75], s39 offen
v_readlane_b32 s39, v62, 11
s_nop 3
s_waitcnt vmcnt(7)
buffer_load_dwordx4 v[132:135], v61, s[72:75], s39 offen
v_readlane_b32 s39, v62, 12
s_nop 3
s_waitcnt vmcnt(7)
buffer_load_dwordx4 v[136:139], v61, s[72:75], s39 offen
v_readlane_b32 s39, v62, 13
s_nop 3
s_waitcnt vmcnt(7)
buffer_load_dwordx4 v[140:143], v61, s[72:75], s39 offen
s_lshl_b32 s60, s89, 8
s_sub_u32 s61, 0x400000, s60
s_add_u32 s76, s10, s60
s_addc_u32 s77, s11, 0
s_and_b32 s77, s77, 0xffff
s_mov_b32 s78, s61
s_mov_b32 s79, 0x20000
v_readlane_b32 s39, v62, 16
s_nop 3
s_waitcnt vmcnt(7)
buffer_load_dwordx4 v[144:147], v61, s[76:79], s39 offen
v_readlane_b32 s39, v62, 17
s_nop 3
s_waitcnt vmcnt(7)
buffer_load_dwordx4 v[148:151], v61, s[76:79], s39 offen
v_readlane_b32 s39, v62, 18
s_nop 3
s_waitcnt vmcnt(7)
buffer_load_dwordx4 v[152:155], v61, s[76:79], s39 offen
v_readlane_b32 s39, v62, 19
s_nop 3
s_waitcnt vmcnt(7)
buffer_load_dwordx4 v[156:159], v61, s[76:79], s39 offen
v_readlane_b32 s39, v62, 20
s_nop 3
s_waitcnt vmcnt(7)
buffer_load_dwordx4 v[128:131], v61, s[76:79], s39 offen
v_readlane_b32 s39, v62, 21
s_nop 3
s_waitcnt vmcnt(7)
buffer_load_dwordx4 v[132:135], v61, s[76:79], s39 offen
s_lshl_b32 s60, s89, 8
s_sub_u32 s61, 0x400000, s60
s_add_u32 s80, s22, s60
s_addc_u32 s81, s23, 0
s_and_b32 s81, s81, 0xffff
s_mov_b32 s82, s61
s_mov_b32 s83, 0x20000
v_readlane_b32 s39, v62, 0
s_nop 3
s_waitcnt vmcnt(7)
buffer_load_dwordx4 v[136:139], v61, s[80:83], s39 offen
v_readlane_b32 s39, v62, 1
s_nop 3
s_waitcnt vmcnt(7)
buffer_load_dwordx4 v[140:143], v61, s[80:83], s39 offen
v_readlane_b32 s39, v62, 2
s_nop 3
s_waitcnt vmcnt(7)
buffer_load_dwordx4 v[144:147], v61, s[80:83], s39 offen
v_readlane_b32 s39, v62, 3
s_nop 3
s_waitcnt vmcnt(7)
buffer_load_dwordx4 v[148:151], v61, s[80:83], s39 offen
v_readlane_b32 s39, v62, 4
s_nop 3
s_waitcnt vmcnt(7)
buffer_load_dwordx4 v[152:155], v61, s[80:83], s39 offen
v_readlane_b32 s39, v62, 5
s_nop 3
s_waitcnt vmcnt(7)
buffer_load_dwordx4 v[156:159], v61, s[80:83], s39 offen
s_lshl_b32 s60, s89, 17
s_mov_b32 s61, 0x20000
s_add_u32 s68, s24, s60
s_addc_u32 s69, s25, 0
s_and_b32 s69, s69, 0xffff
s_mov_b32 s70, s61
s_mov_b32 s71, 0x20000
s_lshr_b32 s58, s55, 2
s_min_u32 s60, s58, 2
s_mul_i32 s59, s58, 5
s_add_u32 s59, s59, s60
s_lshl_b32 s59, s59, 2
s_add_u32 s59, s59, s34
s_lshl_b32 s39, s59, 10
s_waitcnt vmcnt(7)
buffer_load_dwordx4 v[128:131], v8, s[68:71], s39 offen
s_add_u32 s59, s59, 4
s_lshl_b32 s39, s59, 10
s_waitcnt vmcnt(7)
buffer_load_dwordx4 v[132:135], v8, s[68:71], s39 offen
s_add_u32 s59, s59, 4
s_lshl_b32 s39, s59, 10
s_waitcnt vmcnt(7)
buffer_load_dwordx4 v[136:139], v8, s[68:71], s39 offen
s_add_u32 s59, s59, 4
s_lshl_b32 s39, s59, 10
s_waitcnt vmcnt(7)
buffer_load_dwordx4 v[140:143], v8, s[68:71], s39 offen
s_add_u32 s59, s59, 4
s_lshl_b32 s39, s59, 10
s_waitcnt vmcnt(7)
buffer_load_dwordx4 v[144:147], v8, s[68:71], s39 offen
s_add_u32 s59, s59, 4
s_cmp_lt_u32 s58, 2
s_cselect_b32 s59, s59, 128
s_lshl_b32 s39, s59, 10
s_waitcnt vmcnt(7)
buffer_load_dwordx4 v[148:151], v8, s[68:71], s39 offen
s_lshl_b32 s60, s32, 19
s_add_u32 s60, s60, 0x30000
s_mov_b32 s61, 0x50000
s_add_u32 s72, s16, s60
s_addc_u32 s73, s17, 0
s_and_b32 s73, s73, 0xffff
s_mov_b32 s74, s61
s_mov_b32 s75, 0x20000
s_lshr_b32 s58, s56, 2
s_min_u32 s60, s58, 2
s_mul_i32 s59, s58, 13
s_add_u32 s59, s59, s60
s_lshl_b32 s59, s59, 2
s_add_u32 s59, s59, s34
s_lshl_b32 s39, s59, 10
s_waitcnt vmcnt(7)
buffer_load_dwordx4 v[152:155], v8, s[72:75], s39 offen
s_add_u32 s59, s59, 4
s_lshl_b32 s39, s59, 10
s_waitcnt vmcnt(7)
buffer_load_dwordx4 v[156:159], v8, s[72:75], s39 offen
s_add_u32 s59, s59, 4
s_lshl_b32 s39, s59, 10
s_waitcnt vmcnt(7)
buffer_load_dwordx4 v[128:131], v8, s[72:75], s39 offen
s_add_u32 s59, s59, 4
s_lshl_b32 s39, s59, 10
s_waitcnt vmcnt(7)
buffer_load_dwordx4 v[132:135], v8, s[72:75], s39 offen
s_add_u32 s59, s59, 4
s_lshl_b32 s39, s59, 10
s_waitcnt vmcnt(7)
buffer_load_dwordx4 v[136:139], v8, s[72:75], s39 offen
s_add_u32 s59, s59, 4
s_lshl_b32 s39, s59, 10
s_waitcnt vmcnt(7)
buffer_load_dwordx4 v[140:143], v8, s[72:75], s39 offen
s_add_u32 s59, s59, 4
s_lshl_b32 s39, s59, 10
s_waitcnt vmcnt(7)
buffer_load_dwordx4 v[144:147], v8, s[72:75], s39 offen
s_add_u32 s59, s59, 4
s_lshl_b32 s39, s59, 10
s_waitcnt vmcnt(7)
buffer_load_dwordx4 v[148:151], v8, s[72:75], s39 offen
s_add_u32 s59, s59, 4
s_lshl_b32 s39, s59, 10
s_waitcnt vmcnt(7)
buffer_load_dwordx4 v[152:155], v8, s[72:75], s39 offen
s_add_u32 s59, s59, 4
s_lshl_b32 s39, s59, 10
s_waitcnt vmcnt(7)
buffer_load_dwordx4 v[156:159], v8, s[72:75], s39 offen
s_add_u32 s59, s59, 4
s_lshl_b32 s39, s59, 10
s_waitcnt vmcnt(7)
buffer_load_dwordx4 v[128:131], v8, s[72:75], s39 offen
s_add_u32 s59, s59, 4
s_lshl_b32 s39, s59, 10
s_waitcnt vmcnt(7)
buffer_load_dwordx4 v[132:135], v8, s[72:75], s39 offen
s_add_u32 s59, s59, 4
s_lshl_b32 s39, s59, 10
s_waitcnt vmcnt(7)
buffer_load_dwordx4 v[136:139], v8, s[72:75], s39 offen
s_add_u32 s59, s59, 4
s_cmp_lt_u32 s58, 2
s_cselect_b32 s59, s59, 320
s_lshl_b32 s39, s59, 10
s_waitcnt vmcnt(7)
buffer_load_dwordx4 v[140:143], v8, s[72:75], s39 offen
s_waitcnt vmcnt(7)
buffer_load_dwordx4 v[64:67], v8, s[40:43], s36 offen offset:0 nt
s_waitcnt vmcnt(7)
buffer_load_dwordx4 v[68:71], v8, s[40:43], s36 offen offset:1024 nt
s_waitcnt vmcnt(7)
buffer_load_dwordx4 v[72:75], v8, s[40:43], s36 offen offset:2048 nt
s_waitcnt vmcnt(7)
buffer_load_dwordx4 v[76:79], v8, s[40:43], s36 offen offset:3072 nt
s_waitcnt vmcnt(7)
buffer_load_dwordx4 v[80:83], v9, s[40:43], s36 offen offset:0 nt
s_waitcnt vmcnt(7)
buffer_load_dwordx4 v[84:87], v9, s[40:43], s36 offen offset:1024 nt
s_waitcnt vmcnt(7)
buffer_load_dwordx4 v[88:91], v9, s[40:43], s36 offen offset:2048 nt
s_waitcnt vmcnt(7)
buffer_load_dwordx4 v[92:95], v9, s[40:43], s36 offen offset:3072 nt
s_add_u32 s36, s36, 0x18000
s_waitcnt vmcnt(7)
buffer_load_dwordx4 v[96:99], v8, s[40:43], s36 offen offset:0 nt
s_waitcnt vmcnt(7)
buffer_load_dwordx4 v[100:103], v8, s[40:43], s36 offen offset:1024 nt
ds_add_u32 v192, v193 offset:256
s_waitcnt vmcnt(7)
buffer_load_dwordx4 v[104:107], v8, s[40:43], s36 offen offset:2048 nt
s_waitcnt vmcnt(7)
buffer_load_dwordx4 v[108:111], v8, s[40:43], s36 offen offset:3072 nt
ds_add_u32 v192, v193 offset:256
s_waitcnt vmcnt(7)
buffer_load_dwordx4 v[112:115], v9, s[40:43], s36 offen offset:0 nt
s_waitcnt vmcnt(7)
buffer_load_dwordx4 v[116:119], v9, s[40:43], s36 offen offset:1024 nt
ds_add_u32 v192, v193 offset:256
s_waitcnt vmcnt(7)
buffer_load_dwordx4 v[120:123], v9, s[40:43], s36 offen offset:2048 nt
s_waitcnt vmcnt(7)
buffer_load_dwordx4 v[124:127], v9, s[40:43], s36 offen offset:3072 nt
ds_add_u32 v192, v193 offset:256
s_add_u32 s36, s36, 0x18000
s_waitcnt vmcnt(7)
buffer_load_dwordx4 v[128:131], v8, s[40:43], s36 offen offset:0 nt
s_waitcnt vmcnt(7)
buffer_load_dwordx4 v[132:135], v8, s[40:43], s36 offen offset:1024 nt
ds_add_u32 v192, v193 offset:256
s_waitcnt vmcnt(7)
buffer_load_dwordx4 v[136:139], v8, s[40:43], s36 offen offset:2048 nt
s_waitcnt vmcnt(7)
buffer_load_dwordx4 v[140:143], v8, s[40:43], s36 offen offset:3072 nt
ds_add_u32 v192, v193 offset:256
s_waitcnt vmcnt(7)
buffer_load_dwordx4 v[144:147], v9, s[40:43], s36 offen offset:0 nt
s_waitcnt vmcnt(7)
buffer_load_dwordx4 v[148:151], v9, s[40:43], s36 offen offset:1024 nt
ds_add_u32 v192, v193 offset:256
s_waitcnt vmcnt(7)
buffer_load_dwordx4 v[152:155], v9, s[40:43], s36 offen offset:2048 nt
s_waitcnt vmcnt(7)
buffer_load_dwordx4 v[156:159], v9, s[40:43], s36 offen offset:3072 nt
ds_add_u32 v192, v193 offset:256
s_add_u32 s36, s36, 0x18000
s_waitcnt vmcnt(7)
buffer_load_dwordx4 v[160:163], v8, s[40:43], s36 offen offset:0 nt
s_waitcnt vmcnt(7)
buffer_load_dwordx4 v[164:167], v8, s[40:43], s36 offen offset:1024 nt
ds_add_u32 v192, v193 offset:256
s_waitcnt vmcnt(7)
buffer_load_dwordx4 v[168:171], v8, s[40:43], s36 offen offset:2048 nt
s_waitcnt vmcnt(7)
buffer_load_dwordx4 v[172:175], v8, s[40:43], s36 offen offset:3072 nt
ds_add_u32 v192, v193 offset:256
s_waitcnt vmcnt(7)
buffer_load_dwordx4 v[176:179], v9, s[40:43], s36 offen offset:0 nt
s_waitcnt vmcnt(7)
buffer_load_dwordx4 v[180:183], v9, s[40:43], s36 offen offset:1024 nt
ds_add_u32 v192, v193 offset:256
s_waitcnt vmcnt(7)
buffer_load_dwordx4 v[184:187], v9, s[40:43], s36 offen offset:2048 nt
s_waitcnt vmcnt(7)
buffer_load_dwordx4 v[188:191], v9, s[40:43], s36 offen offset:3072 nt
ds_add_u32 v192, v193 offset:256
v_lshlrev_b32 v61, 4, v2
s_mov_b32 s64, 0
L_A_qw:
ds_read_b32 v60, v47 offset:0
s_waitcnt lgkmcnt(0)
v_readfirstlane_b32 s65, v60
s_add_u32 s64, s64, 1
s_nop 2
s_cmp_ge_u32 s65, 1
s_cbranch_scc1 L_A_qw_ok
s_sleep 1
s_cmp_lt_u32 s64, 1048576
s_cbranch_scc1 L_A_qw
L_A_qw_ok:
v_lshlrev_b32 v60, 5, v2
ds_read_b128 v[16:19], v61 offset:1024
ds_read_b128 v[20:23], v61 offset:1280
s_waitcnt lgkmcnt(0)
v_dot2_f32_bf16 v24, v64, v16, 0
v_dot2_f32_bf16 v24, v65, v17, v24
v_dot2_f32_bf16 v24, v66, v18, v24
v_dot2_f32_bf16 v24, v67, v19, v24
s_waitcnt vmcnt(6)
s_add_u32 s36, s36, 0x18000
buffer_load_dwordx4 v[64:67], v8, s[40:43], s36 offen offset:0 nt
v_dot2_f32_bf16 v25, v68, v16, 0
v_dot2_f32_bf16 v25, v69, v17, v25
v_dot2_f32_bf16 v25, v70, v18, v25
v_dot2_f32_bf16 v25, v71, v19, v25
s_waitcnt vmcnt(6)
buffer_load_dwordx4 v[68:71], v8, s[40:43], s36 offen offset:1024 nt
ds_add_u32 v192, v193 offset:256
v_add_f32_dpp v28, v24, v24 row_ror:8 row_mask:0xf bank_mask:0x3
v_dot2_f32_bf16 v26, v72, v16, 0
v_dot2_f32_bf16 v26, v73, v17, v26
v_dot2_f32_bf16 v26, v74, v18, v26
v_dot2_f32_bf16 v26, v75, v19, v26
v_add_f32_dpp v28, v25, v25 row_ror:8 row_mask:0xf bank_mask:0xc
s_waitcnt vmcnt(6)
buffer_load_dwordx4 v[72:75], v8, s[40:43], s36 offen offset:2048 nt
v_dot2_f32_bf16 v27, v76, v16, 0
v_dot2_f32_bf16 v27, v77, v17, v27
v_dot2_f32_bf16 v27, v78, v18, v27
v_dot2_f32_bf16 v27, v79, v19, v27
s_waitcnt vmcnt(6)
buffer_load_dwordx4 v[76:79], v8, s[40:43], s36 offen offset:3072 nt
ds_add_u32 v192, v193 offset:256
v_add_f32_dpp v29, v26, v26 row_ror:8 row_mask:0xf bank_mask:0x3
v_dot2_f32_bf16 v24, v80, v20, 0
v_dot2_f32_bf16 v24, v81, v21, v24
v_dot2_f32_bf16 v24, v82, v22, v24
v_dot2_f32_bf16 v24, v83, v23, v24
v_add_f32_dpp v29, v27, v27 row_ror:8 row_mask:0xf bank_mask:0xc
s_waitcnt vmcnt(6)
buffer_load_dwordx4 v[80:83], v9, s[40:43], s36 offen offset:0 nt
v_add_f32_dpp v30, v28, v28 row_shl:4 row_mask:0xf bank_mask:0x5
v_dot2_f32_bf16 v25, v84, v20, 0
v_dot2_f32_bf16 v25, v85, v21, v25
v_dot2_f32_bf16 v25, v86, v22, v25
v_dot2_f32_bf16 v25, v87, v23, v25
v_add_f32_dpp v30, v29, v29 row_shr:4 row_mask:0xf bank_mask:0xa
s_waitcnt vmcnt(6)
buffer_load_dwordx4 v[84:87], v9, s[40:43], s36 offen offset:1024 nt
ds_add_u32 v192, v193 offset:256
v_add_f32_dpp v28, v24, v24 row_ror:8 row_mask:0xf bank_mask:0x3
v_dot2_f32_bf16 v26, v88, v20, 0
v_dot2_f32_bf16 v26, v89, v21, v26
v_dot2_f32_bf16 v26, v90, v22, v26
v_dot2_f32_bf16 v26, v91, v23, v26
v_add_f32_dpp v28, v25, v25 row_ror:8 row_mask:0xf bank_mask:0xc
s_waitcnt vmcnt(6)
buffer_load_dwordx4 v[88:91], v9, s[40:43], s36 offen offset:2048 nt
v_dot2_f32_bf16 v27, v92, v20, 0
v_dot2_f32_bf16 v27, v93, v21, v27
v_dot2_f32_bf16 v27, v94, v22, v27
v_dot2_f32_bf16 v27, v95, v23, v27
v_add_f32_dpp v29, v26, v26 row_ror:8 row_mask:0xf bank_mask:0x3
v_dot2_f32_bf16 v24, v96, v16, 0
v_dot2_f32_bf16 v24, v97, v17, v24
v_dot2_f32_bf16 v24, v98, v18, v24
v_dot2_f32_bf16 v24, v99, v19, v24
v_add_f32_dpp v29, v27, v27 row_ror:8 row_mask:0xf bank_mask:0xc
v_add_f32_dpp v31, v28, v28 row_shl:4 row_mask:0xf bank_mask:0x5
v_dot2_f32_bf16 v25, v100, v16, 0
v_dot2_f32_bf16 v25, v101, v17, v25
v_dot2_f32_bf16 v25, v102, v18, v25
v_dot2_f32_bf16 v25, v103, v19, v25
v_add_f32_dpp v31, v29, v29 row_shr:4 row_mask:0xf bank_mask:0xa
s_waitcnt vmcnt(6)
buffer_load_dwordx4 v[92:95], v9, s[40:43], s36 offen offset:3072 nt
ds_add_u32 v192, v193 offset:256
v_add_f32_dpp v34, v30, v30 quad_perm:[2,3,0,1] row_mask:0xf bank_mask:0xf
v_add_f32_dpp v28, v24, v24 row_ror:8 row_mask:0xf bank_mask:0x3
v_dot2_f32_bf16 v26, v104, v16, 0
v_dot2_f32_bf16 v26, v105, v17, v26
v_dot2_f32_bf16 v26, v106, v18, v26
v_dot2_f32_bf16 v26, v107, v19, v26
v_add_f32_dpp v35, v31, v31 quad_perm:[2,3,0,1] row_mask:0xf bank_mask:0xf
v_cndmask_b32 v32, v34, v35, s[48:49]
v_add_f32_dpp v28, v25, v25 row_ror:8 row_mask:0xf bank_mask:0xc
v_dot2_f32_bf16 v27, v108, v16, 0
v_dot2_f32_bf16 v27, v109, v17, v27
v_dot2_f32_bf16 v27, v110, v18, v27
v_dot2_f32_bf16 v27, v111, v19, v27
v_add_f32_dpp v29, v26, v26 row_ror:8 row_mask:0xf bank_mask:0x3
v_dot2_f32_bf16 v24, v112, v20, 0
v_dot2_f32_bf16 v24, v113, v21, v24
v_dot2_f32_bf16 v24, v114, v22, v24
v_dot2_f32_bf16 v24, v115, v23, v24
v_add_f32_dpp v29, v27, v27 row_ror:8 row_mask:0xf bank_mask:0xc
s_waitcnt vmcnt(6)
s_add_u32 s36, s36, 0x18000
buffer_load_dwordx4 v[96:99], v8, s[40:43], s36 offen offset:0 nt
v_add_f32_dpp v30, v28, v28 row_shl:4 row_mask:0xf bank_mask:0x5
v_dot2_f32_bf16 v25, v116, v20, 0
v_dot2_f32_bf16 v25, v117, v21, v25
v_dot2_f32_bf16 v25, v118, v22, v25
v_dot2_f32_bf16 v25, v119, v23, v25
v_add_f32_dpp v30, v29, v29 row_shr:4 row_mask:0xf bank_mask:0xa
v_add_f32_dpp v28, v24, v24 row_ror:8 row_mask:0xf bank_mask:0x3
v_dot2_f32_bf16 v26, v120, v20, 0
v_dot2_f32_bf16 v26, v121, v21, v26
v_dot2_f32_bf16 v26, v122, v22, v26
v_dot2_f32_bf16 v26, v123, v23, v26
v_add_f32_dpp v28, v25, v25 row_ror:8 row_mask:0xf bank_mask:0xc
v_dot2_f32_bf16 v27, v124, v20, 0
v_dot2_f32_bf16 v27, v125, v21, v27
v_dot2_f32_bf16 v27, v126, v22, v27
v_dot2_f32_bf16 v27, v127, v23, v27
s_waitcnt vmcnt(6)
buffer_load_dwordx4 v[100:103], v8, s[40:43], s36 offen offset:1024 nt
ds_add_u32 v192, v193 offset:256
v_add_f32_dpp v29, v26, v26 row_ror:8 row_mask:0xf bank_mask:0x3
v_dot2_f32_bf16 v24, v128, v16, 0
v_dot2_f32_bf16 v24, v129, v17, v24
v_dot2_f32_bf16 v24, v130, v18, v24
v_dot2_f32_bf16 v24, v131, v19, v24
v_add_f32_dpp v29, v27, v27 row_ror:8 row_mask:0xf bank_mask:0xc
v_add_f32_dpp v31, v28, v28 row_shl:4 row_mask:0xf bank_mask:0x5
v_dot2_f32_bf16 v25, v132, v16, 0
v_dot2_f32_bf16 v25, v133, v17, v25
v_dot2_f32_bf16 v25, v134, v18, v25
v_dot2_f32_bf16 v25, v135, v19, v25
v_add_f32_dpp v31, v29, v29 row_shr:4 row_mask:0xf bank_mask:0xa
v_add_f32_dpp v34, v30, v30 quad_perm:[2,3,0,1] row_mask:0xf bank_mask:0xf
v_add_f32_dpp v28, v24, v24 row_ror:8 row_mask:0xf bank_mask:0x3
v_dot2_f32_bf16 v26, v136, v16, 0
v_dot2_f32_bf16 v26, v137, v17, v26
v_dot2_f32_bf16 v26, v138, v18, v26
v_dot2_f32_bf16 v26, v139, v19, v26
v_add_f32_dpp v35, v31, v31 quad_perm:[2,3,0,1] row_mask:0xf bank_mask:0xf
v_cndmask_b32 v33, v34, v35, s[48:49]
v_add_f32_dpp v28, v25, v25 row_ror:8 row_mask:0xf bank_mask:0xc
s_waitcnt vmcnt(6)
buffer_load_dwordx4 v[104:107], v8, s[40:43], s36 offen offset:2048 nt
v_add_f32_dpp v34, v32, v32 quad_perm:[1,0,3,2] row_mask:0xf bank_mask:0xf
v_mov_b32 v36, v37
v_mov_b32 v37, v38
v_mov_b32 v38, v39
v_mov_b32 v39, v40
v_mov_b32 v40, v41
v_mov_b32 v41, v42
v_mov_b32 v42, v43
v_mov_b32 v43, v44
v_mov_b32 v44, v45
v_mov_b32 v45, v46
v_dot2_f32_bf16 v27, v140, v16, 0
v_dot2_f32_bf16 v27, v141, v17, v27
v_dot2_f32_bf16 v27, v142, v18, v27
v_dot2_f32_bf16 v27, v143, v19, v27
v_add_f32_dpp v35, v33, v33 quad_perm:[1,0,3,2] row_mask:0xf bank_mask:0xf
v_cndmask_b32 v46, v34, v35, s[50:51]
v_add_f32_dpp v29, v26, v26 row_ror:8 row_mask:0xf bank_mask:0x3
v_dot2_f32_bf16 v24, v144, v20, 0
v_dot2_f32_bf16 v24, v145, v21, v24
v_dot2_f32_bf16 v24, v146, v22, v24
v_dot2_f32_bf16 v24, v147, v23, v24
v_add_f32_dpp v29, v27, v27 row_ror:8 row_mask:0xf bank_mask:0xc
v_add_f32_dpp v30, v28, v28 row_shl:4 row_mask:0xf bank_mask:0x5
v_dot2_f32_bf16 v25, v148, v20, 0
v_dot2_f32_bf16 v25, v149, v21, v25
v_dot2_f32_bf16 v25, v150, v22, v25
v_dot2_f32_bf16 v25, v151, v23, v25
v_add_f32_dpp v30, v29, v29 row_shr:4 row_mask:0xf bank_mask:0xa
s_waitcnt vmcnt(6)
buffer_load_dwordx4 v[108:111], v8, s[40:43], s36 offen offset:3072 nt
ds_add_u32 v192, v193 offset:256
v_add_f32_dpp v28, v24, v24 row_ror:8 row_mask:0xf bank_mask:0x3
v_dot2_f32_bf16 v26, v152, v20, 0
v_dot2_f32_bf16 v26, v153, v21, v26
v_dot2_f32_bf16 v26, v154, v22, v26
v_dot2_f32_bf16 v26, v155, v23, v26
v_add_f32_dpp v28, v25, v25 row_ror:8 row_mask:0xf bank_mask:0xc
v_dot2_f32_bf16 v27, v156, v20, 0
v_dot2_f32_bf16 v27, v157, v21, v27
v_dot2_f32_bf16 v27, v158, v22, v27
v_dot2_f32_bf16 v27, v159, v23, v27
v_add_f32_dpp v29, v26, v26 row_ror:8 row_mask:0xf bank_mask:0x3
v_dot2_f32_bf16 v24, v160, v16, 0
v_dot2_f32_bf16 v24, v161, v17, v24
v_dot2_f32_bf16 v24, v162, v18, v24
v_dot2_f32_bf16 v24, v163, v19, v24
v_add_f32_dpp v29, v27, v27 row_ror:8 row_mask:0xf bank_mask:0xc
s_waitcnt vmcnt(6)
buffer_load_dwordx4 v[112:115], v9, s[40:43], s36 offen offset:0 nt
v_add_f32_dpp v31, v28, v28 row_shl:4 row_mask:0xf bank_mask:0x5
v_dot2_f32_bf16 v25, v164, v16, 0
v_dot2_f32_bf16 v25, v165, v17, v25
v_dot2_f32_bf16 v25, v166, v18, v25
v_dot2_f32_bf16 v25, v167, v19, v25
v_add_f32_dpp v31, v29, v29 row_shr:4 row_mask:0xf bank_mask:0xa
v_add_f32_dpp v34, v30, v30 quad_perm:[2,3,0,1] row_mask:0xf bank_mask:0xf
v_add_f32_dpp v28, v24, v24 row_ror:8 row_mask:0xf bank_mask:0x3
v_dot2_f32_bf16 v26, v168, v16, 0
v_dot2_f32_bf16 v26, v169, v17, v26
v_dot2_f32_bf16 v26, v170, v18, v26
v_dot2_f32_bf16 v26, v171, v19, v26
v_add_f32_dpp v35, v31, v31 quad_perm:[2,3,0,1] row_mask:0xf bank_mask:0xf
v_cndmask_b32 v32, v34, v35, s[48:49]
v_add_f32_dpp v28, v25, v25 row_ror:8 row_mask:0xf bank_mask:0xc
v_dot2_f32_bf16 v27, v172, v16, 0
v_dot2_f32_bf16 v27, v173, v17, v27
v_dot2_f32_bf16 v27, v174, v18, v27
v_dot2_f32_bf16 v27, v175, v19, v27
s_waitcnt vmcnt(6)
buffer_load_dwordx4 v[116:119], v9, s[40:43], s36 offen offset:1024 nt
ds_add_u32 v192, v193 offset:256
v_add_f32_dpp v29, v26, v26 row_ror:8 row_mask:0xf bank_mask:0x3
v_dot2_f32_bf16 v24, v176, v20, 0
v_dot2_f32_bf16 v24, v177, v21, v24
v_dot2_f32_bf16 v24, v178, v22, v24
v_dot2_f32_bf16 v24, v179, v23, v24
v_add_f32_dpp v29, v27, v27 row_ror:8 row_mask:0xf bank_mask:0xc
v_add_f32_dpp v30, v28, v28 row_shl:4 row_mask:0xf bank_mask:0x5
v_dot2_f32_bf16 v25, v180, v20, 0
v_dot2_f32_bf16 v25, v181, v21, v25
v_dot2_f32_bf16 v25, v182, v22, v25
v_dot2_f32_bf16 v25, v183, v23, v25
v_add_f32_dpp v30, v29, v29 row_shr:4 row_mask:0xf bank_mask:0xa
v_add_f32_dpp v28, v24, v24 row_ror:8 row_mask:0xf bank_mask:0x3
v_dot2_f32_bf16 v26, v184, v20, 0
v_dot2_f32_bf16 v26, v185, v21, v26
v_dot2_f32_bf16 v26, v186, v22, v26
v_dot2_f32_bf16 v26, v187, v23, v26
v_add_f32_dpp v28, v25, v25 row_ror:8 row_mask:0xf bank_mask:0xc
s_waitcnt vmcnt(6)
buffer_load_dwordx4 v[120:123], v9, s[40:43], s36 offen offset:2048 nt
v_dot2_f32_bf16 v27, v188, v20, 0
v_dot2_f32_bf16 v27, v189, v21, v27
v_dot2_f32_bf16 v27, v190, v22, v27
v_dot2_f32_bf16 v27, v191, v23, v27
v_add_f32_dpp v29, v26, v26 row_ror:8 row_mask:0xf bank_mask:0x3
v_dot2_f32_bf16 v24, v64, v16, 0
v_dot2_f32_bf16 v24, v65, v17, v24
v_dot2_f32_bf16 v24, v66, v18, v24
v_dot2_f32_bf16 v24, v67, v19, v24
v_add_f32_dpp v29, v27, v27 row_ror:8 row_mask:0xf bank_mask:0xc
v_add_f32_dpp v31, v28, v28 row_shl:4 row_mask:0xf bank_mask:0x5
v_dot2_f32_bf16 v25, v68, v16, 0
v_dot2_f32_bf16 v25, v69, v17, v25
v_dot2_f32_bf16 v25, v70, v18, v25
v_dot2_f32_bf16 v25, v71, v19, v25
v_add_f32_dpp v31, v29, v29 row_shr:4 row_mask:0xf bank_mask:0xa
s_waitcnt vmcnt(6)
buffer_load_dwordx4 v[124:127], v9, s[40:43], s36 offen offset:3072 nt
ds_add_u32 v192, v193 offset:256
v_add_f32_dpp v34, v30, v30 quad_perm:[2,3,0,1] row_mask:0xf bank_mask:0xf
v_add_f32_dpp v28, v24, v24 row_ror:8 row_mask:0xf bank_mask:0x3
v_dot2_f32_bf16 v26, v72, v16, 0
v_dot2_f32_bf16 v26, v73, v17, v26
v_dot2_f32_bf16 v26, v74, v18, v26
v_dot2_f32_bf16 v26, v75, v19, v26
v_add_f32_dpp v35, v31, v31 quad_perm:[2,3,0,1] row_mask:0xf bank_mask:0xf
v_cndmask_b32 v33, v34, v35, s[48:49]
v_add_f32_dpp v28, v25, v25 row_ror:8 row_mask:0xf bank_mask:0xc
v_add_f32_dpp v34, v32, v32 quad_perm:[1,0,3,2] row_mask:0xf bank_mask:0xf
v_mov_b32 v36, v37
v_mov_b32 v37, v38
v_mov_b32 v38, v39
v_mov_b32 v39, v40
v_mov_b32 v40, v41
v_mov_b32 v41, v42
v_mov_b32 v42, v43
v_mov_b32 v43, v44
v_mov_b32 v44, v45
v_mov_b32 v45, v46
v_dot2_f32_bf16 v27, v76, v16, 0
v_dot2_f32_bf16 v27, v77, v17, v27
v_dot2_f32_bf16 v27, v78, v18, v27
v_dot2_f32_bf16 v27, v79, v19, v27
v_add_f32_dpp v35, v33, v33 quad_perm:[1,0,3,2] row_mask:0xf bank_mask:0xf
v_cndmask_b32 v46, v34, v35, s[50:51]
v_add_f32_dpp v29, v26, v26 row_ror:8 row_mask:0xf bank_mask:0x3
v_dot2_f32_bf16 v24, v80, v20, 0
v_dot2_f32_bf16 v24, v81, v21, v24
v_dot2_f32_bf16 v24, v82, v22, v24
v_dot2_f32_bf16 v24, v83, v23, v24
v_add_f32_dpp v29, v27, v27 row_ror:8 row_mask:0xf bank_mask:0xc
s_waitcnt vmcnt(6)
s_add_u32 s36, s36, 0x18000
buffer_load_dwordx4 v[64:67], v8, s[40:43], s36 offen offset:0 nt
v_add_f32_dpp v30, v28, v28 row_shl:4 row_mask:0xf bank_mask:0x5
v_dot2_f32_bf16 v25, v84, v20, 0
v_dot2_f32_bf16 v25, v85, v21, v25
v_dot2_f32_bf16 v25, v86, v22, v25
v_dot2_f32_bf16 v25, v87, v23, v25
v_add_f32_dpp v30, v29, v29 row_shr:4 row_mask:0xf bank_mask:0xa
v_add_f32_dpp v28, v24, v24 row_ror:8 row_mask:0xf bank_mask:0x3
v_dot2_f32_bf16 v26, v88, v20, 0
v_dot2_f32_bf16 v26, v89, v21, v26
v_dot2_f32_bf16 v26, v90, v22, v26
v_dot2_f32_bf16 v26, v91, v23, v26
v_add_f32_dpp v28, v25, v25 row_ror:8 row_mask:0xf bank_mask:0xc
v_dot2_f32_bf16 v27, v92, v20, 0
v_dot2_f32_bf16 v27, v93, v21, v27
v_dot2_f32_bf16 v27, v94, v22, v27
v_dot2_f32_bf16 v27, v95, v23, v27
s_waitcnt vmcnt(6)
buffer_load_dwordx4 v[68:71], v8, s[40:43], s36 offen offset:1024 nt
ds_add_u32 v192, v193 offset:256
v_add_f32_dpp v29, v26, v26 row_ror:8 row_mask:0xf bank_mask:0x3
v_dot2_f32_bf16 v24, v96, v16, 0
v_dot2_f32_bf16 v24, v97, v17, v24
v_dot2_f32_bf16 v24, v98, v18, v24
v_dot2_f32_bf16 v24, v99, v19, v24
v_add_f32_dpp v29, v27, v27 row_ror:8 row_mask:0xf bank_mask:0xc
v_add_f32_dpp v31, v28, v28 row_shl:4 row_mask:0xf bank_mask:0x5
v_dot2_f32_bf16 v25, v100, v16, 0
v_dot2_f32_bf16 v25, v101, v17, v25
v_dot2_f32_bf16 v25, v102, v18, v25
v_dot2_f32_bf16 v25, v103, v19, v25
v_add_f32_dpp v31, v29, v29 row_shr:4 row_mask:0xf bank_mask:0xa
s_waitcnt vmcnt(6)
buffer_load_dwordx4 v[72:75], v8, s[40:43], s36 offen offset:2048 nt
v_add_f32_dpp v34, v30, v30 quad_perm:[2,3,0,1] row_mask:0xf bank_mask:0xf
v_add_f32_dpp v28, v24, v24 row_ror:8 row_mask:0xf bank_mask:0x3
v_dot2_f32_bf16 v26, v104, v16, 0
v_dot2_f32_bf16 v26, v105, v17, v26
v_dot2_f32_bf16 v26, v106, v18, v26
v_dot2_f32_bf16 v26, v107, v19, v26
v_add_f32_dpp v35, v31, v31 quad_perm:[2,3,0,1] row_mask:0xf bank_mask:0xf
v_cndmask_b32 v32, v34, v35, s[48:49]
v_add_f32_dpp v28, v25, v25 row_ror:8 row_mask:0xf bank_mask:0xc
s_waitcnt vmcnt(6)
buffer_load_dwordx4 v[76:79], v8, s[40:43], s36 offen offset:3072 nt
ds_add_u32 v192, v193 offset:256
v_dot2_f32_bf16 v27, v108, v16, 0
v_dot2_f32_bf16 v27, v109, v17, v27
v_dot2_f32_bf16 v27, v110, v18, v27
v_dot2_f32_bf16 v27, v111, v19, v27
s_waitcnt vmcnt(6)
buffer_load_dwordx4 v[80:83], v9, s[40:43], s36 offen offset:0 nt
v_add_f32_dpp v29, v26, v26 row_ror:8 row_mask:0xf bank_mask:0x3
v_dot2_f32_bf16 v24, v112, v20, 0
v_dot2_f32_bf16 v24, v113, v21, v24
v_dot2_f32_bf16 v24, v114, v22, v24
v_dot2_f32_bf16 v24, v115, v23, v24
v_add_f32_dpp v29, v27, v27 row_ror:8 row_mask:0xf bank_mask:0xc
s_waitcnt vmcnt(6)
buffer_load_dwordx4 v[84:87], v9, s[40:43], s36 offen offset:1024 nt
ds_add_u32 v192, v193 offset:256
v_add_f32_dpp v30, v28, v28 row_shl:4 row_mask:0xf bank_mask:0x5
v_dot2_f32_bf16 v25, v116, v20, 0
v_dot2_f32_bf16 v25, v117, v21, v25
v_dot2_f32_bf16 v25, v118, v22, v25
v_dot2_f32_bf16 v25, v119, v23, v25
v_add_f32_dpp v30, v29, v29 row_shr:4 row_mask:0xf bank_mask:0xa
s_waitcnt vmcnt(6)
buffer_load_dwordx4 v[88:91], v9, s[40:43], s36 offen offset:2048 nt
v_add_f32_dpp v28, v24, v24 row_ror:8 row_mask:0xf bank_mask:0x3
v_dot2_f32_bf16 v26, v120, v20, 0
v_dot2_f32_bf16 v26, v121, v21, v26
v_dot2_f32_bf16 v26, v122, v22, v26
v_dot2_f32_bf16 v26, v123, v23, v26
v_add_f32_dpp v28, v25, v25 row_ror:8 row_mask:0xf bank_mask:0xc
s_waitcnt vmcnt(6)
buffer_load_dwordx4 v[92:95], v9, s[40:43], s36 offen offset:3072 nt
ds_add_u32 v192, v193 offset:256
v_dot2_f32_bf16 v27, v124, v20, 0
v_dot2_f32_bf16 v27, v125, v21, v27
v_dot2_f32_bf16 v27, v126, v22, v27
v_dot2_f32_bf16 v27, v127, v23, v27
s_mov_b32 s38, 7
.p2align 6
L_A_ka:
s_cbranch_vccnz L_A_w1
s_waitcnt vmcnt(6)
L_A_w1:
s_waitcnt vmcnt(7)
s_add_u32 s36, s36, 0x18000
buffer_load_dwordx4 v[96:99], v8, s[40:43], s36 offen offset:0 nt
ds_read_b32 v194, v47 offset:8
v_add_f32_dpp v29, v26, v26 row_ror:8 row_mask:0xf bank_mask:0x3
v_dot2_f32_bf16 v24, v64, v16, 0
v_dot2_f32_bf16 v24, v65, v17, v24
v_dot2_f32_bf16 v24, v66, v18, v24
v_dot2_f32_bf16 v24, v67, v19, v24
v_add_f32_dpp v29, v27, v27 row_ror:8 row_mask:0xf bank_mask:0xc
s_cbranch_vccnz L_A_w2
s_waitcnt vmcnt(6)
L_A_w2:
s_waitcnt vmcnt(7)
buffer_load_dwordx4 v[100:103], v8, s[40:43], s36 offen offset:1024 nt
ds_add_u32 v192, v193 offset:256
s_waitcnt lgkmcnt(1)
v_cmp_ne_u32 vcc, 0, v194
v_add_f32_dpp v31, v28, v28 row_shl:4 row_mask:0xf bank_mask:0x5
v_dot2_f32_bf16 v25, v68, v16, 0
v_dot2_f32_bf16 v25, v69, v17, v25
v_dot2_f32_bf16 v25, v70, v18, v25
v_dot2_f32_bf16 v25, v71, v19, v25
v_add_f32_dpp v31, v29, v29 row_shr:4 row_mask:0xf bank_mask:0xa
s_cbranch_vccnz L_A_w3
s_waitcnt vmcnt(6)
L_A_w3:
s_waitcnt vmcnt(7)
buffer_load_dwordx4 v[104:107], v8, s[40:43], s36 offen offset:2048 nt
v_add_f32_dpp v34, v30, v30 quad_perm:[2,3,0,1] row_mask:0xf bank_mask:0xf
v_add_f32_dpp v28, v24, v24 row_ror:8 row_mask:0xf bank_mask:0x3
v_dot2_f32_bf16 v26, v72, v16, 0
v_dot2_f32_bf16 v26, v73, v17, v26
v_dot2_f32_bf16 v26, v74, v18, v26
v_dot2_f32_bf16 v26, v75, v19, v26
v_add_f32_dpp v35, v31, v31 quad_perm:[2,3,0,1] row_mask:0xf bank_mask:0xf
v_cndmask_b32 v33, v34, v35, s[48:49]
v_add_f32_dpp v28, v25, v25 row_ror:8 row_mask:0xf bank_mask:0xc
s_cbranch_vccnz L_A_w4
s_waitcnt vmcnt(6)
L_A_w4:
s_waitcnt vmcnt(7)
buffer_load_dwordx4 v[108:111], v8, s[40:43], s36 offen offset:3072 nt
ds_add_u32 v192, v193 offset:256
v_add_f32_dpp v34, v32, v32 quad_perm:[1,0,3,2] row_mask:0xf bank_mask:0xf
v_mov_b32 v36, v37
v_mov_b32 v37, v38
v_mov_b32 v38, v39
v_mov_b32 v39, v40
v_mov_b32 v40, v41
v_mov_b32 v41, v42
v_mov_b32 v42, v43
v_mov_b32 v43, v44
v_mov_b32 v44, v45
v_mov_b32 v45, v46
v_dot2_f32_bf16 v27, v76, v16, 0
v_dot2_f32_bf16 v27, v77, v17, v27
v_dot2_f32_bf16 v27, v78, v18, v27
v_dot2_f32_bf16 v27, v79, v19, v27
v_add_f32_dpp v35, v33, v33 quad_perm:[1,0,3,2] row_mask:0xf bank_mask:0xf
v_cndmask_b32 v46, v34, v35, s[50:51]
s_cbranch_vccnz L_A_w5
s_waitcnt vmcnt(6)
L_A_w5:
s_waitcnt vmcnt(7)
buffer_load_dwordx4 v[112:115], v9, s[40:43], s36 offen offset:0 nt
v_add_f32_dpp v29, v26, v26 row_ror:8 row_mask:0xf bank_mask:0x3
v_dot2_f32_bf16 v24, v80, v20, 0
v_dot2_f32_bf16 v24, v81, v21, v24
v_dot2_f32_bf16 v24, v82, v22, v24
v_dot2_f32_bf16 v24, v83, v23, v24
v_add_f32_dpp v29, v27, v27 row_ror:8 row_mask:0xf bank_mask:0xc
s_cbranch_vccnz L_A_w6
s_waitcnt vmcnt(6)
L_A_w6:
s_waitcnt vmcnt(7)
buffer_load_dwordx4 v[116:119], v9, s[40:43], s36 offen offset:1024 nt
ds_add_u32 v192, v193 offset:256
v_add_f32_dpp v30, v28, v28 row_shl:4 row_mask:0xf bank_mask:0x5
v_dot2_f32_bf16 v25, v84, v20, 0
v_dot2_f32_bf16 v25, v85, v21, v25
v_dot2_f32_bf16 v25, v86, v22, v25
v_dot2_f32_bf16 v25, v87, v23, v25
v_add_f32_dpp v30, v29, v29 row_shr:4 row_mask:0xf bank_mask:0xa
s_cbranch_vccnz L_A_w7
s_waitcnt vmcnt(6)
L_A_w7:
s_waitcnt vmcnt(7)
buffer_load_dwordx4 v[120:123], v9, s[40:43], s36 offen offset:2048 nt
v_add_f32_dpp v28, v24, v24 row_ror:8 row_mask:0xf bank_mask:0x3
v_dot2_f32_bf16 v26, v88, v20, 0
v_dot2_f32_bf16 v26, v89, v21, v26
v_dot2_f32_bf16 v26, v90, v22, v26
v_dot2_f32_bf16 v26, v91, v23, v26
v_add_f32_dpp v28, v25, v25 row_ror:8 row_mask:0xf bank_mask:0xc
s_cbranch_vccnz L_A_w8
s_waitcnt vmcnt(6)
L_A_w8:
s_waitcnt vmcnt(7)
buffer_load_dwordx4 v[124:127], v9, s[40:43], s36 offen offset:3072 nt
ds_add_u32 v192, v193 offset:256
v_dot2_f32_bf16 v27, v92, v20, 0
v_dot2_f32_bf16 v27, v93, v21, v27
v_dot2_f32_bf16 v27, v94, v22, v27
v_dot2_f32_bf16 v27, v95, v23, v27
s_cbranch_vccnz L_A_w9
s_waitcnt vmcnt(6)
L_A_w9:
s_waitcnt vmcnt(7)
s_add_u32 s36, s36, 0x18000
buffer_load_dwordx4 v[64:67], v8, s[40:43], s36 offen offset:0 nt
ds_read_b32 v194, v47 offset:8
v_add_f32_dpp v29, v26, v26 row_ror:8 row_mask:0xf bank_mask:0x3
v_dot2_f32_bf16 v24, v96, v16, 0
v_dot2_f32_bf16 v24, v97, v17, v24
v_dot2_f32_bf16 v24, v98, v18, v24
v_dot2_f32_bf16 v24, v99, v19, v24
v_add_f32_dpp v29, v27, v27 row_ror:8 row_mask:0xf bank_mask:0xc
s_cbranch_vccnz L_A_w10
s_waitcnt vmcnt(6)
L_A_w10:
s_waitcnt vmcnt(7)
buffer_load_dwordx4 v[68:71], v8, s[40:43], s36 offen offset:1024 nt
ds_add_u32 v192, v193 offset:256
s_waitcnt lgkmcnt(1)
v_cmp_ne_u32 vcc, 0, v194
v_add_f32_dpp v31, v28, v28 row_shl:4 row_mask:0xf bank_mask:0x5
v_dot2_f32_bf16 v25, v100, v16, 0
v_dot2_f32_bf16 v25, v101, v17, v25
v_dot2_f32_bf16 v25, v102, v18, v25
v_dot2_f32_bf16 v25, v103, v19, v25
v_add_f32_dpp v31, v29, v29 row_shr:4 row_mask:0xf bank_mask:0xa
s_cbranch_vccnz L_A_w11
s_waitcnt vmcnt(6)
L_A_w11:
s_waitcnt vmcnt(7)
buffer_load_dwordx4 v[72:75], v8, s[40:43], s36 offen offset:2048 nt
v_add_f32_dpp v34, v30, v30 quad_perm:[2,3,0,1] row_mask:0xf bank_mask:0xf
v_add_f32_dpp v28, v24, v24 row_ror:8 row_mask:0xf bank_mask:0x3
v_dot2_f32_bf16 v26, v104, v16, 0
v_dot2_f32_bf16 v26, v105, v17, v26
v_dot2_f32_bf16 v26, v106, v18, v26
v_dot2_f32_bf16 v26, v107, v19, v26
v_add_f32_dpp v35, v31, v31 quad_perm:[2,3,0,1] row_mask:0xf bank_mask:0xf
v_cndmask_b32 v32, v34, v35, s[48:49]
v_add_f32_dpp v28, v25, v25 row_ror:8 row_mask:0xf bank_mask:0xc
s_cbranch_vccnz L_A_w12
s_waitcnt vmcnt(6)
L_A_w12:
s_waitcnt vmcnt(7)
buffer_load_dwordx4 v[76:79], v8, s[40:43], s36 offen offset:3072 nt
ds_add_u32 v192, v193 offset:256
v_dot2_f32_bf16 v27, v108, v16, 0
v_dot2_f32_bf16 v27, v109, v17, v27
v_dot2_f32_bf16 v27, v110, v18, v27
v_dot2_f32_bf16 v27, v111, v19, v27
s_cbranch_vccnz L_A_w13
s_waitcnt vmcnt(6)
L_A_w13:
s_waitcnt vmcnt(7)
buffer_load_dwordx4 v[80:83], v9, s[40:43], s36 offen offset:0 nt
v_add_f32_dpp v29, v26, v26 row_ror:8 row_mask:0xf bank_mask:0x3
v_dot2_f32_bf16 v24, v112, v20, 0
v_dot2_f32_bf16 v24, v113, v21, v24
v_dot2_f32_bf16 v24, v114, v22, v24
v_dot2_f32_bf16 v24, v115, v23, v24
v_add_f32_dpp v29, v27, v27 row_ror:8 row_mask:0xf bank_mask:0xc
s_cbranch_vccnz L_A_w14
s_waitcnt vmcnt(6)
L_A_w14:
s_waitcnt vmcnt(7)
buffer_load_dwordx4 v[84:87], v9, s[40:43], s36 offen offset:1024 nt
ds_add_u32 v192, v193 offset:256
v_add_f32_dpp v30, v28, v28 row_shl:4 row_mask:0xf bank_mask:0x5
v_dot2_f32_bf16 v25, v116, v20, 0
v_dot2_f32_bf16 v25, v117, v21, v25
v_dot2_f32_bf16 v25, v118, v22, v25
v_dot2_f32_bf16 v25, v119, v23, v25
v_add_f32_dpp v30, v29, v29 row_shr:4 row_mask:0xf bank_mask:0xa
s_cbranch_vccnz L_A_w15
s_waitcnt vmcnt(6)
L_A_w15:
s_waitcnt vmcnt(7)
buffer_load_dwordx4 v[88:91], v9, s[40:43], s36 offen offset:2048 nt
v_add_f32_dpp v28, v24, v24 row_ror:8 row_mask:0xf bank_mask:0x3
v_dot2_f32_bf16 v26, v120, v20, 0
v_dot2_f32_bf16 v26, v121, v21, v26
v_dot2_f32_bf16 v26, v122, v22, v26
v_dot2_f32_bf16 v26, v123, v23, v26
v_add_f32_dpp v28, v25, v25 row_ror:8 row_mask:0xf bank_mask:0xc
s_cbranch_vccnz L_A_w16
s_waitcnt vmcnt(6)
L_A_w16:
s_waitcnt vmcnt(7)
buffer_load_dwordx4 v[92:95], v9, s[40:43], s36 offen offset:3072 nt
ds_add_u32 v192, v193 offset:256
v_dot2_f32_bf16 v27, v124, v20, 0
v_dot2_f32_bf16 v27, v125, v21, v27
v_dot2_f32_bf16 v27, v126, v22, v27
v_dot2_f32_bf16 v27, v127, v23, v27
s_sub_u32 s38, s38, 1
s_cmp_lg_u32 s38, 0
s_cbranch_scc1 L_A_ka
s_cbranch_vccnz L_A_w17
s_waitcnt vmcnt(5)
L_A_w17:
s_waitcnt vmcnt(7)
buffer_load_dwordx4 v[96:99], v8, s[40:43], s37 offen nt
v_add_f32_dpp v29, v26, v26 row_ror:8 row_mask:0xf bank_mask:0x3
v_dot2_f32_bf16 v24, v64, v16, 0
v_dot2_f32_bf16 v24, v65, v17, v24
v_dot2_f32_bf16 v24, v66, v18, v24
v_dot2_f32_bf16 v24, v67, v19, v24
v_add_f32_dpp v29, v27, v27 row_ror:8 row_mask:0xf bank_mask:0xc
s_cbranch_vccnz L_A_w18
s_waitcnt vmcnt(5)
L_A_w18:
s_waitcnt vmcnt(7)
buffer_load_dwordx4 v[100:103], v10, s[40:43], s37 offen nt
ds_add_u32 v192, v193 offset:256
v_add_f32_dpp v31, v28, v28 row_shl:4 row_mask:0xf bank_mask:0x5
v_dot2_f32_bf16 v25, v68, v16, 0
v_dot2_f32_bf16 v25, v69, v17, v25
v_dot2_f32_bf16 v25, v70, v18, v25
v_dot2_f32_bf16 v25, v71, v19, v25
v_add_f32_dpp v31, v29, v29 row_shr:4 row_mask:0xf bank_mask:0xa
s_cbranch_vccnz L_A_w19
s_waitcnt vmcnt(5)
L_A_w19:
s_waitcnt vmcnt(7)
buffer_load_dwordx4 v[104:107], v9, s[40:43], s37 offen nt
v_add_f32_dpp v34, v30, v30 quad_perm:[2,3,0,1] row_mask:0xf bank_mask:0xf
v_add_f32_dpp v28, v24, v24 row_ror:8 row_mask:0xf bank_mask:0x3
v_dot2_f32_bf16 v26, v72, v16, 0
v_dot2_f32_bf16 v26, v73, v17, v26
v_dot2_f32_bf16 v26, v74, v18, v26
v_dot2_f32_bf16 v26, v75, v19, v26
v_add_f32_dpp v35, v31, v31 quad_perm:[2,3,0,1] row_mask:0xf bank_mask:0xf
v_cndmask_b32 v33, v34, v35, s[48:49]
v_add_f32_dpp v28, v25, v25 row_ror:8 row_mask:0xf bank_mask:0xc
s_cbranch_vccnz L_A_w20
s_waitcnt vmcnt(5)
L_A_w20:
s_waitcnt vmcnt(7)
buffer_load_dwordx4 v[108:111], v11, s[40:43], s37 offen nt
ds_add_u32 v192, v193 offset:256
v_add_f32_dpp v34, v32, v32 quad_perm:[1,0,3,2] row_mask:0xf bank_mask:0xf
v_mov_b32 v36, v37
v_mov_b32 v37, v38
v_mov_b32 v38, v39
v_mov_b32 v39, v40
v_mov_b32 v40, v41
v_mov_b32 v41, v42
v_mov_b32 v42, v43
v_mov_b32 v43, v44
v_mov_b32 v44, v45
v_mov_b32 v45, v46
v_dot2_f32_bf16 v27, v76, v16, 0
v_dot2_f32_bf16 v27, v77, v17, v27
v_dot2_f32_bf16 v27, v78, v18, v27
v_dot2_f32_bf16 v27, v79, v19, v27
v_add_f32_dpp v35, v33, v33 quad_perm:[1,0,3,2] row_mask:0xf bank_mask:0xf
v_cndmask_b32 v46, v34, v35, s[50:51]
s_cbranch_vccnz L_A_w21
s_waitcnt vmcnt(5)
L_A_w21:
s_waitcnt vmcnt(7)
s_mov_b32 s36, s35
buffer_load_dwordx4 v[112:115], v8, s[44:47], s36 offen offset:0 nt
v_add_f32_dpp v29, v26, v26 row_ror:8 row_mask:0xf bank_mask:0x3
v_dot2_f32_bf16 v24, v80, v20, 0
v_dot2_f32_bf16 v24, v81, v21, v24
v_dot2_f32_bf16 v24, v82, v22, v24
v_dot2_f32_bf16 v24, v83, v23, v24
v_add_f32_dpp v29, v27, v27 row_ror:8 row_mask:0xf bank_mask:0xc
s_cbranch_vccnz L_A_w22
s_waitcnt vmcnt(5)
L_A_w22:
s_waitcnt vmcnt(7)
buffer_load_dwordx4 v[116:119], v8, s[44:47], s36 offen offset:1024 nt
ds_add_u32 v192, v193 offset:256
v_add_f32_dpp v30, v28, v28 row_shl:4 row_mask:0xf bank_mask:0x5
v_dot2_f32_bf16 v25, v84, v20, 0
v_dot2_f32_bf16 v25, v85, v21, v25
v_dot2_f32_bf16 v25, v86, v22, v25
v_dot2_f32_bf16 v25, v87, v23, v25
v_add_f32_dpp v30, v29, v29 row_shr:4 row_mask:0xf bank_mask:0xa
s_cbranch_vccnz L_A_w23
s_waitcnt vmcnt(5)
L_A_w23:
s_waitcnt vmcnt(7)
buffer_load_dwordx4 v[120:123], v8, s[44:47], s36 offen offset:2048 nt
v_add_f32_dpp v28, v24, v24 row_ror:8 row_mask:0xf bank_mask:0x3
v_dot2_f32_bf16 v26, v88, v20, 0
v_dot2_f32_bf16 v26, v89, v21, v26
v_dot2_f32_bf16 v26, v90, v22, v26
v_dot2_f32_bf16 v26, v91, v23, v26
v_add_f32_dpp v28, v25, v25 row_ror:8 row_mask:0xf bank_mask:0xc
s_cbranch_vccnz L_A_w24
s_waitcnt vmcnt(5)
L_A_w24:
s_waitcnt vmcnt(7)
buffer_load_dwordx4 v[124:127], v8, s[44:47], s36 offen offset:3072 nt
ds_add_u32 v192, v193 offset:256
v_dot2_f32_bf16 v27, v92, v20, 0
v_dot2_f32_bf16 v27, v93, v21, v27
v_dot2_f32_bf16 v27, v94, v22, v27
v_dot2_f32_bf16 v27, v95, v23, v27
s_cbranch_vccnz L_A_w25
s_waitcnt vmcnt(5)
L_A_w25:
s_waitcnt vmcnt(7)
buffer_load_dwordx4 v[64:67], v9, s[44:47], s36 offen offset:0 nt
v_add_f32_dpp v29, v26, v26 row_ror:8 row_mask:0xf bank_mask:0x3
v_dot2_f32_bf16 v24, v96, v16, 0
v_dot2_f32_bf16 v24, v97, v17, v24
v_dot2_f32_bf16 v24, v98, v18, v24
v_dot2_f32_bf16 v24, v99, v19, v24
v_add_f32_dpp v29, v27, v27 row_ror:8 row_mask:0xf bank_mask:0xc
s_cbranch_vccnz L_A_w26
s_waitcnt vmcnt(5)
L_A_w26:
s_waitcnt vmcnt(7)
buffer_load_dwordx4 v[68:71], v9, s[44:47], s36 offen offset:1024 nt
ds_add_u32 v192, v193 offset:256
v_add_f32_dpp v31, v28, v28 row_shl:4 row_mask:0xf bank_mask:0x5
v_dot2_f32_bf16 v25, v100, v16, 0
v_dot2_f32_bf16 v25, v101, v17, v25
v_dot2_f32_bf16 v25, v102, v18, v25
v_dot2_f32_bf16 v25, v103, v19, v25
v_add_f32_dpp v31, v29, v29 row_shr:4 row_mask:0xf bank_mask:0xa
s_cbranch_vccnz L_A_w27
s_waitcnt vmcnt(5)
L_A_w27:
s_waitcnt vmcnt(7)
buffer_load_dwordx4 v[72:75], v9, s[44:47], s36 offen offset:2048 nt
v_add_f32_dpp v34, v30, v30 quad_perm:[2,3,0,1] row_mask:0xf bank_mask:0xf
v_add_f32_dpp v28, v24, v24 row_ror:8 row_mask:0xf bank_mask:0x3
v_dot2_f32_bf16 v26, v104, v20, 0
v_dot2_f32_bf16 v26, v105, v21, v26
v_dot2_f32_bf16 v26, v106, v22, v26
v_dot2_f32_bf16 v26, v107, v23, v26
v_add_f32_dpp v35, v31, v31 quad_perm:[2,3,0,1] row_mask:0xf bank_mask:0xf
v_cndmask_b32 v32, v34, v35, s[48:49]
v_add_f32_dpp v28, v25, v25 row_ror:8 row_mask:0xf bank_mask:0xc
s_cbranch_vccnz L_A_w28
s_waitcnt vmcnt(5)
L_A_w28:
s_waitcnt vmcnt(7)
buffer_load_dwordx4 v[76:79], v9, s[44:47], s36 offen offset:3072 nt
ds_add_u32 v192, v193 offset:256
v_dot2_f32_bf16 v27, v108, v20, 0
v_dot2_f32_bf16 v27, v109, v21, v27
v_dot2_f32_bf16 v27, v110, v22, v27
v_dot2_f32_bf16 v27, v111, v23, v27
v_add_f32_dpp v30, v28, v28 row_shl:4 row_mask:0xf bank_mask:0x5
s_nop 2
v_add_f32_dpp v28, v26, v26 row_ror:8 row_mask:0xf bank_mask:0x3
s_nop 1
v_add_f32_dpp v28, v27, v27 row_ror:8 row_mask:0xf bank_mask:0xc
s_nop 2
s_nop 1
v_add_f32_dpp v31, v28, v28 row_shl:4 row_mask:0xf bank_mask:0x5
s_nop 2
v_add_f32_dpp v34, v30, v30 quad_perm:[2,3,0,1] row_mask:0xf bank_mask:0xf
s_nop 1
v_add_f32_dpp v35, v31, v31 quad_perm:[2,3,0,1] row_mask:0xf bank_mask:0xf
v_cndmask_b32 v33, v34, v35, s[48:49]
s_nop 2
v_add_f32_dpp v34, v32, v32 quad_perm:[1,0,3,2] row_mask:0xf bank_mask:0xf
v_mov_b32 v36, v37
v_mov_b32 v37, v38
v_mov_b32 v38, v39
v_mov_b32 v39, v40
v_mov_b32 v40, v41
v_mov_b32 v41, v42
v_mov_b32 v42, v43
v_mov_b32 v43, v44
v_mov_b32 v44, v45
v_mov_b32 v45, v46
s_nop 1
v_add_f32_dpp v35, v33, v33 quad_perm:[1,0,3,2] row_mask:0xf bank_mask:0xf
v_cndmask_b32 v46, v34, v35, s[50:51]
v_mov_b32 v60, 0xff800000
v_cndmask_b32 v46, v60, v46, s[52:53]
v_max3_f32 v60, v36, v37, v38
v_max3_f32 v60, v60, v39, v40
v_max3_f32 v60, v60, v41, v42
v_max3_f32 v60, v60, v43, v44
v_max3_f32 v60, v60, v45, v46
s_waitcnt vmcnt(5)
s_add_u32 s36, s36, 0x18000
buffer_load_dwordx4 v[80:83], v8, s[44:47], s36 offen offset:0 nt
s_nop 1
v_max_f32_dpp v60, v60, v60 quad_perm:[1,0,3,2] row_mask:0xf bank_mask:0xf
s_nop 1
v_max_f32_dpp v60, v60, v60 row_ror:4 row_mask:0xf bank_mask:0xf
s_nop 1
v_max_f32_dpp v60, v60, v60 row_ror:8 row_mask:0xf bank_mask:0xf
v_mov_b32 v34, v60
s_nop 1
v_permlane16_swap_b32 v60, v34
s_nop 0
v_max_f32 v60, v60, v34
v_mov_b32 v34, v60
s_nop 1
v_permlane32_swap_b32 v60, v34
s_nop 0
v_max_f32 v60, v60, v34
s_mov_b32 s62, 0x3e0293ee
v_mul_f32 v60, s62, v60
s_waitcnt vmcnt(5)
buffer_load_dwordx4 v[84:87], v8, s[44:47], s36 offen offset:1024 nt
ds_add_u32 v192, v193 offset:256
v_fma_f32 v36, v36, s62, -v60
v_fma_f32 v37, v37, s62, -v60
v_fma_f32 v38, v38, s62, -v60
v_fma_f32 v39, v39, s62, -v60
v_fma_f32 v40, v40, s62, -v60
v_fma_f32 v41, v41, s62, -v60
v_fma_f32 v42, v42, s62, -v60
v_fma_f32 v43, v43, s62, -v60
v_fma_f32 v44, v44, s62, -v60
v_fma_f32 v45, v45, s62, -v60
v_fma_f32 v46, v46, s62, -v60
v_exp_f32 v36, v36
v_exp_f32 v37, v37
v_exp_f32 v38, v38
v_exp_f32 v39, v39
v_exp_f32 v40, v40
v_exp_f32 v41, v41
v_exp_f32 v42, v42
v_exp_f32 v43, v43
v_exp_f32 v44, v44
v_exp_f32 v45, v45
v_exp_f32 v46, v46
s_waitcnt vmcnt(5)
buffer_load_dwordx4 v[88:91], v8, s[44:47], s36 offen offset:2048 nt
v_add_f32 v61, v36, v37
v_add_f32 v61, v61, v38
v_add_f32 v61, v61, v39
v_add_f32 v61, v61, v40
v_add_f32 v61, v61, v41
v_add_f32 v61, v61, v42
v_add_f32 v61, v61, v43
v_add_f32 v61, v61, v44
v_add_f32 v61, v61, v45
v_add_f32 v61, v61, v46
v_cvt_pk_bf16_f32 v36, v36, v36
v_cvt_pk_bf16_f32 v37, v37, v37
v_cvt_pk_bf16_f32 v38, v38, v38
v_cvt_pk_bf16_f32 v39, v39, v39
v_cvt_pk_bf16_f32 v40, v40, v40
v_cvt_pk_bf16_f32 v41, v41, v41
v_cvt_pk_bf16_f32 v42, v42, v42
v_cvt_pk_bf16_f32 v43, v43, v43
v_cvt_pk_bf16_f32 v44, v44, v44
v_cvt_pk_bf16_f32 v45, v45, v45
v_cvt_pk_bf16_f32 v46, v46, v46
s_waitcnt vmcnt(5)
buffer_load_dwordx4 v[92:95], v8, s[44:47], s36 offen offset:3072 nt
ds_add_u32 v192, v193 offset:256
s_nop 1
v_add_f32_dpp v61, v61, v61 quad_perm:[1,0,3,2] row_mask:0xf bank_mask:0xf
s_nop 1
v_add_f32_dpp v61, v61, v61 row_ror:4 row_mask:0xf bank_mask:0xf
s_nop 1
v_add_f32_dpp v61, v61, v61 row_ror:8 row_mask:0xf bank_mask:0xf
v_mov_b32 v34, v61
s_nop 1
v_permlane16_swap_b32 v61, v34
s_nop 0
v_add_f32 v61, v61, v34
v_mov_b32 v34, v61
s_nop 1
v_permlane32_swap_b32 v61, v34
s_nop 0
v_add_f32 v61, v61, v34
s_lshl_b32 s62, s34, 2
v_lshl_add_u32 v62, v1, 3, s62
v_mov_b32 v63, 1
s_mov_b64 exec, 5
ds_write_b32 v62, v60 offset:64
ds_write_b32 v62, v61 offset:96
s_mov_b64 exec, 1
ds_add_u32 v47, v63 offset:4
s_mov_b64 exec, -1
v_and_b32_dpp v52, v36, v4 row_newbcast:0 row_mask:0xf bank_mask:0xf
v_and_b32_dpp v53, v36, v5 row_newbcast:0 row_mask:0xf bank_mask:0xf
v_and_b32_dpp v54, v36, v6 row_newbcast:0 row_mask:0xf bank_mask:0xf
v_and_b32_dpp v55, v36, v7 row_newbcast:0 row_mask:0xf bank_mask:0xf
s_mov_b32 s38, 9
.p2align 6
L_A_va:
s_cbranch_vccnz L_A_w29
s_waitcnt vmcnt(5)
L_A_w29:
s_waitcnt vmcnt(7)
buffer_load_dwordx4 v[96:99], v9, s[44:47], s36 offen offset:0 nt
v_mfma_f32_16x16x32_bf16 v[48:51], v[52:55], v[112:115], v[48:51]
ds_read_b32 v194, v47 offset:8
v_and_b32_dpp v56, v36, v4 row_newbcast:8 row_mask:0xf bank_mask:0xf
v_and_b32_dpp v57, v36, v5 row_newbcast:8 row_mask:0xf bank_mask:0xf
v_and_b32_dpp v58, v36, v6 row_newbcast:8 row_mask:0xf bank_mask:0xf
v_and_b32_dpp v59, v36, v7 row_newbcast:8 row_mask:0xf bank_mask:0xf
s_cbranch_vccnz L_A_w30
s_waitcnt vmcnt(5)
L_A_w30:
s_waitcnt vmcnt(7)
buffer_load_dwordx4 v[100:103], v9, s[44:47], s36 offen offset:1024 nt
ds_add_u32 v192, v193 offset:256
v_mfma_f32_16x16x32_bf16 v[48:51], v[56:59], v[116:119], v[48:51]
s_waitcnt lgkmcnt(1)
v_cmp_ne_u32 vcc, 0, v194
v_and_b32_dpp v52, v36, v4 row_newbcast:4 row_mask:0xf bank_mask:0xf
v_and_b32_dpp v53, v36, v5 row_newbcast:4 row_mask:0xf bank_mask:0xf
v_and_b32_dpp v54, v36, v6 row_newbcast:4 row_mask:0xf bank_mask:0xf
v_and_b32_dpp v55, v36, v7 row_newbcast:4 row_mask:0xf bank_mask:0xf
s_cbranch_vccnz L_A_w31
s_waitcnt vmcnt(5)
L_A_w31:
s_waitcnt vmcnt(7)
buffer_load_dwordx4 v[104:107], v9, s[44:47], s36 offen offset:2048 nt
v_mfma_f32_16x16x32_bf16 v[48:51], v[52:55], v[120:123], v[48:51]
v_and_b32_dpp v56, v36, v4 row_newbcast:12 row_mask:0xf bank_mask:0xf
v_and_b32_dpp v57, v36, v5 row_newbcast:12 row_mask:0xf bank_mask:0xf
v_and_b32_dpp v58, v36, v6 row_newbcast:12 row_mask:0xf bank_mask:0xf
v_and_b32_dpp v59, v36, v7 row_newbcast:12 row_mask:0xf bank_mask:0xf
s_cbranch_vccnz L_A_w32
s_waitcnt vmcnt(5)
L_A_w32:
s_waitcnt vmcnt(7)
buffer_load_dwordx4 v[108:111], v9, s[44:47], s36 offen offset:3072 nt
ds_add_u32 v192, v193 offset:256
v_mfma_f32_16x16x32_bf16 v[48:51], v[56:59], v[124:127], v[48:51]
v_and_b32_dpp v52, v36, v12 row_newbcast:2 row_mask:0xf bank_mask:0xf
v_and_b32_dpp v53, v36, v13 row_newbcast:2 row_mask:0xf bank_mask:0xf
v_and_b32_dpp v54, v36, v14 row_newbcast:2 row_mask:0xf bank_mask:0xf
v_and_b32_dpp v55, v36, v15 row_newbcast:2 row_mask:0xf bank_mask:0xf
s_cbranch_vccnz L_A_w33
s_waitcnt vmcnt(5)
L_A_w33:
s_waitcnt vmcnt(7)
s_add_u32 s36, s36, 0x18000
buffer_load_dwordx4 v[112:115], v8, s[44:47], s36 offen offset:0 nt
v_mfma_f32_16x16x32_bf16 v[48:51], v[52:55], v[64:67], v[48:51]
v_and_b32_dpp v56, v36, v12 row_newbcast:10 row_mask:0xf bank_mask:0xf
v_and_b32_dpp v57, v36, v13 row_newbcast:10 row_mask:0xf bank_mask:0xf
v_and_b32_dpp v58, v36, v14 row_newbcast:10 row_mask:0xf bank_mask:0xf
v_and_b32_dpp v59, v36, v15 row_newbcast:10 row_mask:0xf bank_mask:0xf
s_cbranch_vccnz L_A_w34
s_waitcnt vmcnt(5)
L_A_w34:
s_waitcnt vmcnt(7)
buffer_load_dwordx4 v[116:119], v8, s[44:47], s36 offen offset:1024 nt
ds_add_u32 v192, v193 offset:256
v_mfma_f32_16x16x32_bf16 v[48:51], v[56:59], v[68:71], v[48:51]
v_and_b32_dpp v52, v36, v12 row_newbcast:6 row_mask:0xf bank_mask:0xf
v_and_b32_dpp v53, v36, v13 row_newbcast:6 row_mask:0xf bank_mask:0xf
v_and_b32_dpp v54, v36, v14 row_newbcast:6 row_mask:0xf bank_mask:0xf
v_and_b32_dpp v55, v36, v15 row_newbcast:6 row_mask:0xf bank_mask:0xf
s_cbranch_vccnz L_A_w35
s_waitcnt vmcnt(5)
L_A_w35:
s_waitcnt vmcnt(7)
buffer_load_dwordx4 v[120:123], v8, s[44:47], s36 offen offset:2048 nt
v_mfma_f32_16x16x32_bf16 v[48:51], v[52:55], v[72:75], v[48:51]
v_and_b32_dpp v56, v36, v12 row_newbcast:14 row_mask:0xf bank_mask:0xf
v_and_b32_dpp v57, v36, v13 row_newbcast:14 row_mask:0xf bank_mask:0xf
v_and_b32_dpp v58, v36, v14 row_newbcast:14 row_mask:0xf bank_mask:0xf
v_and_b32_dpp v59, v36, v15 row_newbcast:14 row_mask:0xf bank_mask:0xf
s_cbranch_vccnz L_A_w36
s_waitcnt vmcnt(5)
L_A_w36:
s_waitcnt vmcnt(7)
buffer_load_dwordx4 v[124:127], v8, s[44:47], s36 offen offset:3072 nt
ds_add_u32 v192, v193 offset:256
v_mfma_f32_16x16x32_bf16 v[48:51], v[56:59], v[76:79], v[48:51]
v_and_b32_dpp v52, v36, v4 row_newbcast:1 row_mask:0xf bank_mask:0xf
v_and_b32_dpp v53, v36, v5 row_newbcast:1 row_mask:0xf bank_mask:0xf
v_and_b32_dpp v54, v36, v6 row_newbcast:1 row_mask:0xf bank_mask:0xf
v_and_b32_dpp v55, v36, v7 row_newbcast:1 row_mask:0xf bank_mask:0xf
s_cbranch_vccnz L_A_w37
s_waitcnt vmcnt(5)
L_A_w37:
s_waitcnt vmcnt(7)
buffer_load_dwordx4 v[64:67], v9, s[44:47], s36 offen offset:0 nt
v_mfma_f32_16x16x32_bf16 v[48:51], v[52:55], v[80:83], v[48:51]
ds_read_b32 v194, v47 offset:8
v_and_b32_dpp v56, v36, v4 row_newbcast:9 row_mask:0xf bank_mask:0xf
v_and_b32_dpp v57, v36, v5 row_newbcast:9 row_mask:0xf bank_mask:0xf
v_and_b32_dpp v58, v36, v6 row_newbcast:9 row_mask:0xf bank_mask:0xf
v_and_b32_dpp v59, v36, v7 row_newbcast:9 row_mask:0xf bank_mask:0xf
s_cbranch_vccnz L_A_w38
s_waitcnt vmcnt(5)
L_A_w38:
s_waitcnt vmcnt(7)
buffer_load_dwordx4 v[68:71], v9, s[44:47], s36 offen offset:1024 nt
ds_add_u32 v192, v193 offset:256
v_mfma_f32_16x16x32_bf16 v[48:51], v[56:59], v[84:87], v[48:51]
s_waitcnt lgkmcnt(1)
v_cmp_ne_u32 vcc, 0, v194
v_and_b32_dpp v52, v36, v4 row_newbcast:5 row_mask:0xf bank_mask:0xf
v_and_b32_dpp v53, v36, v5 row_newbcast:5 row_mask:0xf bank_mask:0xf
v_and_b32_dpp v54, v36, v6 row_newbcast:5 row_mask:0xf bank_mask:0xf
v_and_b32_dpp v55, v36, v7 row_newbcast:5 row_mask:0xf bank_mask:0xf
s_cbranch_vccnz L_A_w39
s_waitcnt vmcnt(5)
L_A_w39:
s_waitcnt vmcnt(7)
buffer_load_dwordx4 v[72:75], v9, s[44:47], s36 offen offset:2048 nt
v_mfma_f32_16x16x32_bf16 v[48:51], v[52:55], v[88:91], v[48:51]
v_and_b32_dpp v56, v36, v4 row_newbcast:13 row_mask:0xf bank_mask:0xf
v_and_b32_dpp v57, v36, v5 row_newbcast:13 row_mask:0xf bank_mask:0xf
v_and_b32_dpp v58, v36, v6 row_newbcast:13 row_mask:0xf bank_mask:0xf
v_and_b32_dpp v59, v36, v7 row_newbcast:13 row_mask:0xf bank_mask:0xf
s_cbranch_vccnz L_A_w40
s_waitcnt vmcnt(5)
L_A_w40:
s_waitcnt vmcnt(7)
buffer_load_dwordx4 v[76:79], v9, s[44:47], s36 offen offset:3072 nt
ds_add_u32 v192, v193 offset:256
v_mfma_f32_16x16x32_bf16 v[48:51], v[56:59], v[92:95], v[48:51]
v_and_b32_dpp v52, v36, v12 row_newbcast:3 row_mask:0xf bank_mask:0xf
v_and_b32_dpp v53, v36, v13 row_newbcast:3 row_mask:0xf bank_mask:0xf
v_and_b32_dpp v54, v36, v14 row_newbcast:3 row_mask:0xf bank_mask:0xf
v_and_b32_dpp v55, v36, v15 row_newbcast:3 row_mask:0xf bank_mask:0xf
s_cbranch_vccnz L_A_w41
s_waitcnt vmcnt(5)
L_A_w41:
s_waitcnt vmcnt(7)
s_add_u32 s36, s36, 0x18000
buffer_load_dwordx4 v[80:83], v8, s[44:47], s36 offen offset:0 nt
v_mfma_f32_16x16x32_bf16 v[48:51], v[52:55], v[96:99], v[48:51]
v_and_b32_dpp v56, v36, v12 row_newbcast:11 row_mask:0xf bank_mask:0xf
v_and_b32_dpp v57, v36, v13 row_newbcast:11 row_mask:0xf bank_mask:0xf
v_and_b32_dpp v58, v36, v14 row_newbcast:11 row_mask:0xf bank_mask:0xf
v_and_b32_dpp v59, v36, v15 row_newbcast:11 row_mask:0xf bank_mask:0xf
s_cbranch_vccnz L_A_w42
s_waitcnt vmcnt(5)
L_A_w42:
s_waitcnt vmcnt(7)
buffer_load_dwordx4 v[84:87], v8, s[44:47], s36 offen offset:1024 nt
ds_add_u32 v192, v193 offset:256
v_mfma_f32_16x16x32_bf16 v[48:51], v[56:59], v[100:103], v[48:51]
v_and_b32_dpp v52, v36, v12 row_newbcast:7 row_mask:0xf bank_mask:0xf
v_and_b32_dpp v53, v36, v13 row_newbcast:7 row_mask:0xf bank_mask:0xf
v_and_b32_dpp v54, v36, v14 row_newbcast:7 row_mask:0xf bank_mask:0xf
v_and_b32_dpp v55, v36, v15 row_newbcast:7 row_mask:0xf bank_mask:0xf
s_cbranch_vccnz L_A_w43
s_waitcnt vmcnt(5)
L_A_w43:
s_waitcnt vmcnt(7)
buffer_load_dwordx4 v[88:91], v8, s[44:47], s36 offen offset:2048 nt
v_mfma_f32_16x16x32_bf16 v[48:51], v[52:55], v[104:107], v[48:51]
v_and_b32_dpp v56, v36, v12 row_newbcast:15 row_mask:0xf bank_mask:0xf
v_and_b32_dpp v57, v36, v13 row_newbcast:15 row_mask:0xf bank_mask:0xf
v_and_b32_dpp v58, v36, v14 row_newbcast:15 row_mask:0xf bank_mask:0xf
v_and_b32_dpp v59, v36, v15 row_newbcast:15 row_mask:0xf bank_mask:0xf
s_cbranch_vccnz L_A_w44
s_waitcnt vmcnt(5)
L_A_w44:
s_waitcnt vmcnt(7)
buffer_load_dwordx4 v[92:95], v8, s[44:47], s36 offen offset:3072 nt
ds_add_u32 v192, v193 offset:256
v_mfma_f32_16x16x32_bf16 v[48:51], v[56:59], v[108:111], v[48:51]
v_mov_b32 v36, v37
v_mov_b32 v37, v38
v_mov_b32 v38, v39
v_mov_b32 v39, v40
v_mov_b32 v40, v41
v_mov_b32 v41, v42
v_mov_b32 v42, v43
v_mov_b32 v43, v44
v_mov_b32 v44, v45
v_mov_b32 v45, v46
v_and_b32_dpp v52, v36, v4 row_newbcast:0 row_mask:0xf bank_mask:0xf
v_and_b32_dpp v53, v36, v5 row_newbcast:0 row_mask:0xf bank_mask:0xf
v_and_b32_dpp v54, v36, v6 row_newbcast:0 row_mask:0xf bank_mask:0xf
v_and_b32_dpp v55, v36, v7 row_newbcast:0 row_mask:0xf bank_mask:0xf
s_sub_u32 s38, s38, 1
s_cmp_lg_u32 s38, 0
s_cbranch_scc1 L_A_va
s_waitcnt vmcnt(8)
buffer_load_dwordx4 v[96:99], v9, s[44:47], s36 offen offset:0 nt
v_mfma_f32_16x16x32_bf16 v[48:51], v[52:55], v[112:115], v[48:51]
v_and_b32_dpp v56, v36, v4 row_newbcast:8 row_mask:0xf bank_mask:0xf
v_and_b32_dpp v57, v36, v5 row_newbcast:8 row_mask:0xf bank_mask:0xf
v_and_b32_dpp v58, v36, v6 row_newbcast:8 row_mask:0xf bank_mask:0xf
v_and_b32_dpp v59, v36, v7 row_newbcast:8 row_mask:0xf bank_mask:0xf
s_mov_b32 s64, 0
L_A_sw:
ds_read_b32 v60, v47 offset:4
s_waitcnt lgkmcnt(0)
v_readfirstlane_b32 s65, v60
s_add_u32 s64, s64, 1
s_nop 2
s_cmp_ge_u32 s65, 4
s_cbranch_scc1 L_A_sw_ok
s_sleep 1
s_cmp_lt_u32 s64, 1048576
s_cbranch_scc1 L_A_sw
L_A_sw_ok:
v_lshrrev_b32 v60, 1, v3
v_lshlrev_b32 v60, 4, v60
s_lshl_b32 s62, s34, 2
v_add_u32 v61, s62, v60
ds_read_b128 v[24:27], v60 offset:64
ds_read_b32 v63, v61 offset:64
s_waitcnt vmcnt(8)
buffer_load_dwordx4 v[100:103], v9, s[44:47], s36 offen offset:1024 nt
ds_add_u32 v192, v193 offset:256
v_mfma_f32_16x16x32_bf16 v[48:51], v[56:59], v[116:119], v[48:51]
v_and_b32_dpp v52, v36, v4 row_newbcast:4 row_mask:0xf bank_mask:0xf
v_and_b32_dpp v53, v36, v5 row_newbcast:4 row_mask:0xf bank_mask:0xf
v_and_b32_dpp v54, v36, v6 row_newbcast:4 row_mask:0xf bank_mask:0xf
v_and_b32_dpp v55, v36, v7 row_newbcast:4 row_mask:0xf bank_mask:0xf
s_waitcnt vmcnt(8)
buffer_load_dwordx4 v[104:107], v9, s[44:47], s36 offen offset:2048 nt
v_mfma_f32_16x16x32_bf16 v[48:51], v[52:55], v[120:123], v[48:51]
v_and_b32_dpp v56, v36, v4 row_newbcast:12 row_mask:0xf bank_mask:0xf
v_and_b32_dpp v57, v36, v5 row_newbcast:12 row_mask:0xf bank_mask:0xf
v_and_b32_dpp v58, v36, v6 row_newbcast:12 row_mask:0xf bank_mask:0xf
v_and_b32_dpp v59, v36, v7 row_newbcast:12 row_mask:0xf bank_mask:0xf
s_waitcnt lgkmcnt(0)
v_max3_f32 v60, v24, v25, v26
v_max_f32 v60, v60, v27
v_sub_f32 v63, v63, v60
v_exp_f32 v63, v63
v_lshrrev_b32 v62, 1, v3
v_mul_u32_u24 v62, 1152, v62
v_lshl_add_u32 v62, v2, 3, v62
v_and_b32 v61, 1, v3
v_lshl_add_u32 v62, v61, 2, v62
s_mul_i32 s62, s34, 288
s_add_u32 s62, s62, 8192
v_add_u32 v62, s62, v62
s_waitcnt vmcnt(8)
buffer_load_dwordx4 v[108:111], v9, s[44:47], s36 offen offset:3072 nt
ds_add_u32 v192, v193 offset:256
v_mfma_f32_16x16x32_bf16 v[48:51], v[56:59], v[124:127], v[48:51]
v_and_b32_dpp v52, v36, v12 row_newbcast:2 row_mask:0xf bank_mask:0xf
v_and_b32_dpp v53, v36, v13 row_newbcast:2 row_mask:0xf bank_mask:0xf
v_and_b32_dpp v54, v36, v14 row_newbcast:2 row_mask:0xf bank_mask:0xf
v_and_b32_dpp v55, v36, v15 row_newbcast:2 row_mask:0xf bank_mask:0xf
s_waitcnt vmcnt(8)
s_add_u32 s36, s36, 0x18000
buffer_load_dwordx4 v[112:115], v8, s[44:47], s36 offen offset:0 nt
v_mfma_f32_16x16x32_bf16 v[48:51], v[52:55], v[64:67], v[48:51]
v_and_b32_dpp v56, v36, v12 row_newbcast:10 row_mask:0xf bank_mask:0xf
v_and_b32_dpp v57, v36, v13 row_newbcast:10 row_mask:0xf bank_mask:0xf
v_and_b32_dpp v58, v36, v14 row_newbcast:10 row_mask:0xf bank_mask:0xf
v_and_b32_dpp v59, v36, v15 row_newbcast:10 row_mask:0xf bank_mask:0xf
s_waitcnt vmcnt(8)
buffer_load_dwordx4 v[116:119], v8, s[44:47], s36 offen offset:1024 nt
ds_add_u32 v192, v193 offset:256
v_mfma_f32_16x16x32_bf16 v[48:51], v[56:59], v[68:71], v[48:51]
v_and_b32_dpp v52, v36, v12 row_newbcast:6 row_mask:0xf bank_mask:0xf
v_and_b32_dpp v53, v36, v13 row_newbcast:6 row_mask:0xf bank_mask:0xf
v_and_b32_dpp v54, v36, v14 row_newbcast:6 row_mask:0xf bank_mask:0xf
v_and_b32_dpp v55, v36, v15 row_newbcast:6 row_mask:0xf bank_mask:0xf
s_waitcnt vmcnt(8)
buffer_load_dwordx4 v[120:123], v8, s[44:47], s36 offen offset:2048 nt
v_mfma_f32_16x16x32_bf16 v[48:51], v[52:55], v[72:75], v[48:51]
v_and_b32_dpp v56, v36, v12 row_newbcast:14 row_mask:0xf bank_mask:0xf
v_and_b32_dpp v57, v36, v13 row_newbcast:14 row_mask:0xf bank_mask:0xf
v_and_b32_dpp v58, v36, v14 row_newbcast:14 row_mask:0xf bank_mask:0xf
v_and_b32_dpp v59, v36, v15 row_newbcast:14 row_mask:0xf bank_mask:0xf
s_waitcnt vmcnt(8)
buffer_load_dwordx4 v[124:127], v8, s[44:47], s36 offen offset:3072 nt
ds_add_u32 v192, v193 offset:256
v_mfma_f32_16x16x32_bf16 v[48:51], v[56:59], v[76:79], v[48:51]
v_and_b32_dpp v52, v36, v4 row_newbcast:1 row_mask:0xf bank_mask:0xf
v_and_b32_dpp v53, v36, v5 row_newbcast:1 row_mask:0xf bank_mask:0xf
v_and_b32_dpp v54, v36, v6 row_newbcast:1 row_mask:0xf bank_mask:0xf
v_and_b32_dpp v55, v36, v7 row_newbcast:1 row_mask:0xf bank_mask:0xf
s_waitcnt vmcnt(8)
buffer_load_dwordx4 v[64:67], v9, s[44:47], s36 offen offset:0 nt
v_mfma_f32_16x16x32_bf16 v[48:51], v[52:55], v[80:83], v[48:51]
v_and_b32_dpp v56, v36, v4 row_newbcast:9 row_mask:0xf bank_mask:0xf
v_and_b32_dpp v57, v36, v5 row_newbcast:9 row_mask:0xf bank_mask:0xf
v_and_b32_dpp v58, v36, v6 row_newbcast:9 row_mask:0xf bank_mask:0xf
v_and_b32_dpp v59, v36, v7 row_newbcast:9 row_mask:0xf bank_mask:0xf
s_waitcnt vmcnt(8)
buffer_load_dwordx4 v[68:71], v9, s[44:47], s36 offen offset:1024 nt
ds_add_u32 v192, v193 offset:256
v_mfma_f32_16x16x32_bf16 v[48:51], v[56:59], v[84:87], v[48:51]
v_and_b32_dpp v52, v36, v4 row_newbcast:5 row_mask:0xf bank_mask:0xf
v_and_b32_dpp v53, v36, v5 row_newbcast:5 row_mask:0xf bank_mask:0xf
v_and_b32_dpp v54, v36, v6 row_newbcast:5 row_mask:0xf bank_mask:0xf
v_and_b32_dpp v55, v36, v7 row_newbcast:5 row_mask:0xf bank_mask:0xf
s_waitcnt vmcnt(8)
buffer_load_dwordx4 v[72:75], v9, s[44:47], s36 offen offset:2048 nt
v_mfma_f32_16x16x32_bf16 v[48:51], v[52:55], v[88:91], v[48:51]
v_and_b32_dpp v56, v36, v4 row_newbcast:13 row_mask:0xf bank_mask:0xf
v_and_b32_dpp v57, v36, v5 row_newbcast:13 row_mask:0xf bank_mask:0xf
v_and_b32_dpp v58, v36, v6 row_newbcast:13 row_mask:0xf bank_mask:0xf
v_and_b32_dpp v59, v36, v7 row_newbcast:13 row_mask:0xf bank_mask:0xf
s_waitcnt vmcnt(8)
buffer_load_dwordx4 v[76:79], v9, s[44:47], s36 offen offset:3072 nt
ds_add_u32 v192, v193 offset:256
v_mfma_f32_16x16x32_bf16 v[48:51], v[56:59], v[92:95], v[48:51]
v_and_b32_dpp v52, v36, v12 row_newbcast:3 row_mask:0xf bank_mask:0xf
v_and_b32_dpp v53, v36, v13 row_newbcast:3 row_mask:0xf bank_mask:0xf
v_and_b32_dpp v54, v36, v14 row_newbcast:3 row_mask:0xf bank_mask:0xf
v_and_b32_dpp v55, v36, v15 row_newbcast:3 row_mask:0xf bank_mask:0xf
s_waitcnt vmcnt(8)
buffer_load_dwordx4 v[80:83], v8, s[44:47], s37 offen nt
v_mfma_f32_16x16x32_bf16 v[48:51], v[52:55], v[96:99], v[48:51]
v_and_b32_dpp v56, v36, v12 row_newbcast:11 row_mask:0xf bank_mask:0xf
v_and_b32_dpp v57, v36, v13 row_newbcast:11 row_mask:0xf bank_mask:0xf
v_and_b32_dpp v58, v36, v14 row_newbcast:11 row_mask:0xf bank_mask:0xf
v_and_b32_dpp v59, v36, v15 row_newbcast:11 row_mask:0xf bank_mask:0xf
s_waitcnt vmcnt(8)
buffer_load_dwordx4 v[84:87], v10, s[44:47], s37 offen nt
ds_add_u32 v192, v193 offset:256
v_mfma_f32_16x16x32_bf16 v[48:51], v[56:59], v[100:103], v[48:51]
v_and_b32_dpp v52, v36, v12 row_newbcast:7 row_mask:0xf bank_mask:0xf
v_and_b32_dpp v53, v36, v13 row_newbcast:7 row_mask:0xf bank_mask:0xf
v_and_b32_dpp v54, v36, v14 row_newbcast:7 row_mask:0xf bank_mask:0xf
v_and_b32_dpp v55, v36, v15 row_newbcast:7 row_mask:0xf bank_mask:0xf
s_waitcnt vmcnt(8)
buffer_load_dwordx4 v[88:91], v9, s[44:47], s37 offen nt
v_mfma_f32_16x16x32_bf16 v[48:51], v[52:55], v[104:107], v[48:51]
v_and_b32_dpp v56, v36, v12 row_newbcast:15 row_mask:0xf bank_mask:0xf
v_and_b32_dpp v57, v36, v13 row_newbcast:15 row_mask:0xf bank_mask:0xf
v_and_b32_dpp v58, v36, v14 row_newbcast:15 row_mask:0xf bank_mask:0xf
v_and_b32_dpp v59, v36, v15 row_newbcast:15 row_mask:0xf bank_mask:0xf
s_waitcnt vmcnt(8)
buffer_load_dwordx4 v[92:95], v11, s[44:47], s37 offen nt
ds_add_u32 v192, v193 offset:256
v_mfma_f32_16x16x32_bf16 v[48:51], v[56:59], v[108:111], v[48:51]
v_mov_b32 v36, v37
v_mov_b32 v37, v38
v_mov_b32 v38, v39
v_mov_b32 v39, v40
v_mov_b32 v40, v41
v_mov_b32 v41, v42
v_mov_b32 v42, v43
v_mov_b32 v43, v44
v_mov_b32 v44, v45
v_mov_b32 v45, v46
v_and_b32_dpp v52, v36, v4 row_newbcast:0 row_mask:0xf bank_mask:0xf
v_and_b32_dpp v53, v36, v5 row_newbcast:0 row_mask:0xf bank_mask:0xf
v_and_b32_dpp v54, v36, v6 row_newbcast:0 row_mask:0xf bank_mask:0xf
v_and_b32_dpp v55, v36, v7 row_newbcast:0 row_mask:0xf bank_mask:0xf
s_nop 0
s_nop 0
v_mfma_f32_16x16x32_bf16 v[48:51], v[52:55], v[112:115], v[48:51]
v_and_b32_dpp v56, v36, v4 row_newbcast:8 row_mask:0xf bank_mask:0xf
v_and_b32_dpp v57, v36, v5 row_newbcast:8 row_mask:0xf bank_mask:0xf
v_and_b32_dpp v58, v36, v6 row_newbcast:8 row_mask:0xf bank_mask:0xf
v_and_b32_dpp v59, v36, v7 row_newbcast:8 row_mask:0xf bank_mask:0xf
s_nop 0
s_nop 0
v_mfma_f32_16x16x32_bf16 v[48:51], v[56:59], v[116:119], v[48:51]
v_and_b32_dpp v52, v36, v4 row_newbcast:4 row_mask:0xf bank_mask:0xf
v_and_b32_dpp v53, v36, v5 row_newbcast:4 row_mask:0xf bank_mask:0xf
v_and_b32_dpp v54, v36, v6 row_newbcast:4 row_mask:0xf bank_mask:0xf
v_and_b32_dpp v55, v36, v7 row_newbcast:4 row_mask:0xf bank_mask:0xf
s_nop 0
s_nop 0
v_mfma_f32_16x16x32_bf16 v[48:51], v[52:55], v[120:123], v[48:51]
v_and_b32_dpp v56, v36, v4 row_newbcast:12 row_mask:0xf bank_mask:0xf
v_and_b32_dpp v57, v36, v5 row_newbcast:12 row_mask:0xf bank_mask:0xf
v_and_b32_dpp v58, v36, v6 row_newbcast:12 row_mask:0xf bank_mask:0xf
v_and_b32_dpp v59, v36, v7 row_newbcast:12 row_mask:0xf bank_mask:0xf
s_waitcnt vmcnt(8)
s_nop 0
v_mfma_f32_16x16x32_bf16 v[48:51], v[56:59], v[124:127], v[48:51]
v_and_b32_dpp v52, v36, v12 row_newbcast:2 row_mask:0xf bank_mask:0xf
v_and_b32_dpp v53, v36, v13 row_newbcast:2 row_mask:0xf bank_mask:0xf
v_and_b32_dpp v54, v36, v14 row_newbcast:2 row_mask:0xf bank_mask:0xf
v_and_b32_dpp v55, v36, v15 row_newbcast:2 row_mask:0xf bank_mask:0xf
s_waitcnt vmcnt(7)
s_nop 0
v_mfma_f32_16x16x32_bf16 v[48:51], v[52:55], v[64:67], v[48:51]
v_and_b32_dpp v56, v36, v12 row_newbcast:10 row_mask:0xf bank_mask:0xf
v_and_b32_dpp v57, v36, v13 row_newbcast:10 row_mask:0xf bank_mask:0xf
v_and_b32_dpp v58, v36, v14 row_newbcast:10 row_mask:0xf bank_mask:0xf
v_and_b32_dpp v59, v36, v15 row_newbcast:10 row_mask:0xf bank_mask:0xf
s_waitcnt vmcnt(6)
s_nop 0
v_mfma_f32_16x16x32_bf16 v[48:51], v[56:59], v[68:71], v[48:51]
v_and_b32_dpp v52, v36, v12 row_newbcast:6 row_mask:0xf bank_mask:0xf
v_and_b32_dpp v53, v36, v13 row_newbcast:6 row_mask:0xf bank_mask:0xf
v_and_b32_dpp v54, v36, v14 row_newbcast:6 row_mask:0xf bank_mask:0xf
v_and_b32_dpp v55, v36, v15 row_newbcast:6 row_mask:0xf bank_mask:0xf
s_waitcnt vmcnt(5)
s_nop 0
v_mfma_f32_16x16x32_bf16 v[48:51], v[52:55], v[72:75], v[48:51]
v_and_b32_dpp v56, v36, v12 row_newbcast:14 row_mask:0xf bank_mask:0xf
v_and_b32_dpp v57, v36, v13 row_newbcast:14 row_mask:0xf bank_mask:0xf
v_and_b32_dpp v58, v36, v14 row_newbcast:14 row_mask:0xf bank_mask:0xf
v_and_b32_dpp v59, v36, v15 row_newbcast:14 row_mask:0xf bank_mask:0xf
s_waitcnt vmcnt(4)
s_nop 0
v_mfma_f32_16x16x32_bf16 v[48:51], v[56:59], v[76:79], v[48:51]
v_and_b32_dpp v52, v36, v4 row_newbcast:1 row_mask:0xf bank_mask:0xf
v_and_b32_dpp v53, v36, v5 row_newbcast:1 row_mask:0xf bank_mask:0xf
v_and_b32_dpp v54, v36, v6 row_newbcast:1 row_mask:0xf bank_mask:0xf
v_and_b32_dpp v55, v36, v7 row_newbcast:1 row_mask:0xf bank_mask:0xf
s_waitcnt vmcnt(3)
s_nop 0
v_mfma_f32_16x16x32_bf16 v[48:51], v[52:55], v[80:83], v[48:51]
v_and_b32_dpp v56, v36, v4 row_newbcast:9 row_mask:0xf bank_mask:0xf
v_and_b32_dpp v57, v36, v5 row_newbcast:9 row_mask:0xf bank_mask:0xf
v_and_b32_dpp v58, v36, v6 row_newbcast:9 row_mask:0xf bank_mask:0xf
v_and_b32_dpp v59, v36, v7 row_newbcast:9 row_mask:0xf bank_mask:0xf
s_waitcnt vmcnt(2)
s_nop 0
v_mfma_f32_16x16x32_bf16 v[48:51], v[56:59], v[84:87], v[48:51]
v_and_b32_dpp v52, v36, v12 row_newbcast:3 row_mask:0xf bank_mask:0xf
v_and_b32_dpp v53, v36, v13 row_newbcast:3 row_mask:0xf bank_mask:0xf
v_and_b32_dpp v54, v36, v14 row_newbcast:3 row_mask:0xf bank_mask:0xf
v_and_b32_dpp v55, v36, v15 row_newbcast:3 row_mask:0xf bank_mask:0xf
s_waitcnt vmcnt(1)
s_nop 0
v_mfma_f32_16x16x32_bf16 v[48:51], v[52:55], v[88:91], v[48:51]
v_and_b32_dpp v56, v36, v12 row_newbcast:11 row_mask:0xf bank_mask:0xf
v_and_b32_dpp v57, v36, v13 row_newbcast:11 row_mask:0xf bank_mask:0xf
v_and_b32_dpp v58, v36, v14 row_newbcast:11 row_mask:0xf bank_mask:0xf
v_and_b32_dpp v59, v36, v15 row_newbcast:11 row_mask:0xf bank_mask:0xf
s_waitcnt vmcnt(0)
s_nop 0
v_mfma_f32_16x16x32_bf16 v[48:51], v[56:59], v[92:95], v[48:51]
s_nop 7
v_pk_mul_f32 v[48:49], v[48:49], v[62:63] op_sel:[0,1] op_sel_hi:[1,1]
v_pk_mul_f32 v[50:51], v[50:51], v[62:63] op_sel:[0,1] op_sel_hi:[1,1]
v_cvt_pk_bf16_f32 v48, v48, v49
v_cvt_pk_bf16_f32 v49, v50, v51
ds_write2_b32 v62, v48, v49 offset1:36
s_waitcnt lgkmcnt(0)
s_barrier
s_endpgm
L_A_helper:
s_waitcnt lgkmcnt(0)
s_sub_u32 s35, s34, 4
s_lshl_b32 s37, s32, 3
s_add_u32 s37, s37, s33
s_cmp_lg_u32 s35, 0
s_cbranch_scc1 L_A_noclr
s_lshl_b32 s63, s37, 10
s_add_u32 s63, s63, 0x100000
v_lshl_add_u32 v10, v1, 4, s63
v_add_u32 v11, 0x40000, v10
v_mov_b32 v44, -1
v_mov_b32 v45, -1
v_mov_b32 v46, -1
v_mov_b32 v47, -1
global_store_dwordx4 v10, v[44:47], s[30:31] sc1
global_store_dwordx4 v11, v[44:47], s[30:31] sc1
L_A_noclr:
s_lshl_b32 s62, s89, 17
s_mov_b32 s63, 0x20000
s_add_u32 s40, s12, s62
s_addc_u32 s41, s13, 0
s_and_b32 s41, s41, 0xffff
s_mov_b32 s42, s63
s_mov_b32 s43, 0x20000
v_lshlrev_b32 v9, 13, v3
v_lshl_add_u32 v9, v2, 4, v9
s_lshl_b32 s62, s35, 8
v_add_u32 v9, s62, v9
s_mov_b32 s61, 0
buffer_load_dwordx4 v[184:187], v9, s[40:43], s61 offen offset:0
buffer_load_dwordx4 v[188:191], v9, s[40:43], s61 offen offset:1024
buffer_load_dwordx4 v[192:195], v9, s[40:43], s61 offen offset:2048
buffer_load_dwordx4 v[196:199], v9, s[40:43], s61 offen offset:3072
v_mov_b32 v8, 0
v_mov_b32 v11, 0
ds_write_b32 v8, v8 offset:0
ds_write_b32 v8, v8 offset:4
ds_write_b32 v8, v8 offset:8
ds_write_b32 v8, v8 offset:256
s_waitcnt lgkmcnt(0)
s_barrier
s_load_dword s88, s[30:31], 0x18000
s_mov_b32 s66, 0x05040100
s_mov_b32 s67, 0x07060302
s_mov_b32 s44, s30
s_and_b32 s45, s31, 0xffff
s_mov_b32 s46, 0x1000000
s_mov_b32 s47, 0x20000
s_lshl_b32 s63, s32, 10
s_add_u32 s63, s63, 0x40000
v_lshl_add_u32 v10, v1, 4, s63
v_lshlrev_b32 v11, 3, v1
s_mov_b32 s38, s35
s_waitcnt lgkmcnt(0)
s_add_u32 s88, s88, 0x9e3779b9
s_waitcnt vmcnt(3)
s_mov_b32 s61, 4096
buffer_load_dwordx4 v[200:203], v9, s[40:43], s61 offen offset:0
s_waitcnt vmcnt(3)
buffer_load_dwordx4 v[204:207], v9, s[40:43], s61 offen offset:1024
v_perm_b32 v56, v188, v184, s66
v_perm_b32 v64, v188, v184, s67
v_perm_b32 v72, v189, v185, s66
v_perm_b32 v80, v189, v185, s67
v_perm_b32 v88, v190, v186, s66
v_perm_b32 v96, v190, v186, s67
v_perm_b32 v104, v191, v187, s66
v_perm_b32 v112, v191, v187, s67
s_waitcnt vmcnt(3)
buffer_load_dwordx4 v[208:211], v9, s[40:43], s61 offen offset:2048
s_waitcnt vmcnt(3)
buffer_load_dwordx4 v[212:215], v9, s[40:43], s61 offen offset:3072
v_perm_b32 v57, v196, v192, s66
v_perm_b32 v65, v196, v192, s67
v_perm_b32 v73, v197, v193, s66
v_perm_b32 v81, v197, v193, s67
v_perm_b32 v89, v198, v194, s66
v_perm_b32 v97, v198, v194, s67
v_perm_b32 v105, v199, v195, s66
v_perm_b32 v113, v199, v195, s67
s_waitcnt vmcnt(3)
s_mov_b32 s61, 32768
buffer_load_dwordx4 v[216:219], v9, s[40:43], s61 offen offset:0
s_waitcnt vmcnt(3)
buffer_load_dwordx4 v[220:223], v9, s[40:43], s61 offen offset:1024
v_perm_b32 v58, v204, v200, s66
v_perm_b32 v66, v204, v200, s67
v_perm_b32 v74, v205, v201, s66
v_perm_b32 v82, v205, v201, s67
v_perm_b32 v90, v206, v202, s66
v_perm_b32 v98, v206, v202, s67
v_perm_b32 v106, v207, v203, s66
v_perm_b32 v114, v207, v203, s67
s_waitcnt vmcnt(3)
buffer_load_dwordx4 v[224:227], v9, s[40:43], s61 offen offset:2048
s_waitcnt vmcnt(3)
buffer_load_dwordx4 v[228:231], v9, s[40:43], s61 offen offset:3072
v_perm_b32 v59, v212, v208, s66
v_perm_b32 v67, v212, v208, s67
v_perm_b32 v75, v213, v209, s66
v_perm_b32 v83, v213, v209, s67
v_perm_b32 v91, v214, v210, s66
v_perm_b32 v99, v214, v210, s67
v_perm_b32 v107, v215, v211, s66
v_perm_b32 v115, v215, v211, s67
s_waitcnt vmcnt(3)
s_mov_b32 s61, 36864
buffer_load_dwordx4 v[232:235], v9, s[40:43], s61 offen offset:0
s_waitcnt vmcnt(3)
buffer_load_dwordx4 v[236:239], v9, s[40:43], s61 offen offset:1024
v_perm_b32 v60, v220, v216, s66
v_perm_b32 v68, v220, v216, s67
v_perm_b32 v76, v221, v217, s66
v_perm_b32 v84, v221, v217, s67
v_perm_b32 v92, v222, v218, s66
v_perm_b32 v100, v222, v218, s67
v_perm_b32 v108, v223, v219, s66
v_perm_b32 v116, v223, v219, s67
s_waitcnt vmcnt(3)
buffer_load_dwordx4 v[240:243], v9, s[40:43], s61 offen offset:2048
s_waitcnt vmcnt(3)
buffer_load_dwordx4 v[244:247], v9, s[40:43], s61 offen offset:3072
v_perm_b32 v61, v228, v224, s66
v_perm_b32 v69, v228, v224, s67
v_perm_b32 v77, v229, v225, s66
v_perm_b32 v85, v229, v225, s67
v_perm_b32 v93, v230, v226, s66
v_perm_b32 v101, v230, v226, s67
v_perm_b32 v109, v231, v227, s66
v_perm_b32 v117, v231, v227, s67
s_waitcnt vmcnt(3)
s_mov_b32 s61, 65536
buffer_load_dwordx4 v[184:187], v9, s[40:43], s61 offen offset:0
s_waitcnt vmcnt(3)
buffer_load_dwordx4 v[188:191], v9, s[40:43], s61 offen offset:1024
v_perm_b32 v62, v236, v232, s66
v_perm_b32 v70, v236, v232, s67
v_perm_b32 v78, v237, v233, s66
v_perm_b32 v86, v237, v233, s67
v_perm_b32 v94, v238, v234, s66
v_perm_b32 v102, v238, v234, s67
v_perm_b32 v110, v239, v235, s66
v_perm_b32 v118, v239, v235, s67
s_waitcnt vmcnt(3)
buffer_load_dwordx4 v[192:195], v9, s[40:43], s61 offen offset:2048
s_waitcnt vmcnt(3)
buffer_load_dwordx4 v[196:199], v9, s[40:43], s61 offen offset:3072
v_perm_b32 v63, v244, v240, s66
v_perm_b32 v71, v244, v240, s67
v_perm_b32 v79, v245, v241, s66
v_perm_b32 v87, v245, v241, s67
v_perm_b32 v95, v246, v242, s66
v_perm_b32 v103, v246, v242, s67
v_perm_b32 v111, v247, v243, s66
v_perm_b32 v119, v247, v243, s67
s_waitcnt vmcnt(3)
s_mov_b32 s61, 69632
buffer_load_dwordx4 v[200:203], v9, s[40:43], s61 offen offset:0
s_waitcnt vmcnt(3)
buffer_load_dwordx4 v[204:207], v9, s[40:43], s61 offen offset:1024
v_perm_b32 v120, v188, v184, s66
v_perm_b32 v128, v188, v184, s67
v_perm_b32 v136, v189, v185, s66
v_perm_b32 v144, v189, v185, s67
v_perm_b32 v152, v190, v186, s66
v_perm_b32 v160, v190, v186, s67
v_perm_b32 v168, v191, v187, s66
v_perm_b32 v176, v191, v187, s67
s_waitcnt vmcnt(3)
buffer_load_dwordx4 v[208:211], v9, s[40:43], s61 offen offset:2048
s_waitcnt vmcnt(3)
buffer_load_dwordx4 v[212:215], v9, s[40:43], s61 offen offset:3072
v_perm_b32 v121, v196, v192, s66
v_perm_b32 v129, v196, v192, s67
v_perm_b32 v137, v197, v193, s66
v_perm_b32 v145, v197, v193, s67
v_perm_b32 v153, v198, v194, s66
v_perm_b32 v161, v198, v194, s67
v_perm_b32 v169, v199, v195, s66
v_perm_b32 v177, v199, v195, s67
s_waitcnt vmcnt(3)
s_cmp_lg_u32 s38, 0
s_cbranch_scc1 L_A_qt20
buffer_load_dwordx4 v[44:47], v10, s[44:47], 0 offen sc1
L_A_qt20:
s_mov_b32 s61, 98304
buffer_load_dwordx4 v[216:219], v9, s[40:43], s61 offen offset:0
s_waitcnt vmcnt(3)
buffer_load_dwordx4 v[220:223], v9, s[40:43], s61 offen offset:1024
v_perm_b32 v122, v204, v200, s66
v_perm_b32 v130, v204, v200, s67
v_perm_b32 v138, v205, v201, s66
v_perm_b32 v146, v205, v201, s67
v_perm_b32 v154, v206, v202, s66
v_perm_b32 v162, v206, v202, s67
v_perm_b32 v170, v207, v203, s66
v_perm_b32 v178, v207, v203, s67
s_waitcnt vmcnt(3)
buffer_load_dwordx4 v[224:227], v9, s[40:43], s61 offen offset:2048
s_waitcnt vmcnt(3)
buffer_load_dwordx4 v[228:231], v9, s[40:43], s61 offen offset:3072
v_perm_b32 v123, v212, v208, s66
v_perm_b32 v131, v212, v208, s67
v_perm_b32 v139, v213, v209, s66
v_perm_b32 v147, v213, v209, s67
v_perm_b32 v155, v214, v210, s66
v_perm_b32 v163, v214, v210, s67
v_perm_b32 v171, v215, v211, s66
v_perm_b32 v179, v215, v211, s67
s_waitcnt vmcnt(3)
s_cmp_lg_u32 s38, 0
s_cbranch_scc1 L_A_qc24
v_cmp_ne_u32 s[62:63], s88, v45
v_cmp_ne_u32 vcc, s88, v47
s_nop 1
s_or_b64 vcc, vcc, s[62:63]
s_cbranch_scc1 L_A_qc24
s_mov_b32 s38, 1
v_mov_b32 v45, v46
v_mov_b32 v46, 1
ds_write_b64 v11, v[44:45] offset:1024
ds_write_b32 v8, v46 offset:0
L_A_qc24:
s_cmp_lg_u32 s38, 0
s_cbranch_scc1 L_A_qt24
buffer_load_dwordx4 v[44:47], v10, s[44:47], 0 offen sc1
L_A_qt24:
s_mov_b32 s61, 102400
buffer_load_dwordx4 v[232:235], v9, s[40:43], s61 offen offset:0
s_waitcnt vmcnt(3)
buffer_load_dwordx4 v[236:239], v9, s[40:43], s61 offen offset:1024
v_perm_b32 v124, v220, v216, s66
v_perm_b32 v132, v220, v216, s67
v_perm_b32 v140, v221, v217, s66
v_perm_b32 v148, v221, v217, s67
v_perm_b32 v156, v222, v218, s66
v_perm_b32 v164, v222, v218, s67
v_perm_b32 v172, v223, v219, s66
v_perm_b32 v180, v223, v219, s67
s_waitcnt vmcnt(3)
buffer_load_dwordx4 v[240:243], v9, s[40:43], s61 offen offset:2048
s_waitcnt vmcnt(3)
buffer_load_dwordx4 v[244:247], v9, s[40:43], s61 offen offset:3072
v_perm_b32 v125, v228, v224, s66
v_perm_b32 v133, v228, v224, s67
v_perm_b32 v141, v229, v225, s66
v_perm_b32 v149, v229, v225, s67
v_perm_b32 v157, v230, v226, s66
v_perm_b32 v165, v230, v226, s67
v_perm_b32 v173, v231, v227, s66
v_perm_b32 v181, v231, v227, s67
s_waitcnt vmcnt(3)
s_cmp_lg_u32 s38, 0
s_cbranch_scc1 L_A_qc28
v_cmp_ne_u32 s[62:63], s88, v45
v_cmp_ne_u32 vcc, s88, v47
s_nop 1
s_or_b64 vcc, vcc, s[62:63]
s_cbranch_scc1 L_A_qc28
s_mov_b32 s38, 1
v_mov_b32 v45, v46
v_mov_b32 v46, 1
ds_write_b64 v11, v[44:45] offset:1024
ds_write_b32 v8, v46 offset:0
L_A_qc28:
s_waitcnt vmcnt(2)
v_perm_b32 v126, v236, v232, s66
v_perm_b32 v134, v236, v232, s67
v_perm_b32 v142, v237, v233, s66
v_perm_b32 v150, v237, v233, s67
v_perm_b32 v158, v238, v234, s66
v_perm_b32 v166, v238, v234, s67
v_perm_b32 v174, v239, v235, s66
v_perm_b32 v182, v239, v235, s67
s_waitcnt vmcnt(1)
s_waitcnt vmcnt(0)
v_perm_b32 v127, v244, v240, s66
v_perm_b32 v135, v244, v240, s67
v_perm_b32 v143, v245, v241, s66
v_perm_b32 v151, v245, v241, s67
v_perm_b32 v159, v246, v242, s66
v_perm_b32 v167, v246, v242, s67
v_perm_b32 v175, v247, v243, s66
v_perm_b32 v183, v247, v243, s67
v_mov_b32 v184, 0
v_mov_b32 v185, 0
v_mov_b32 v186, 0
v_mov_b32 v187, 0
v_mov_b32 v188, 0
v_mov_b32 v189, 0
v_mov_b32 v190, 0
v_mov_b32 v191, 0
v_mov_b32 v192, 0
v_mov_b32 v193, 0
v_mov_b32 v194, 0
v_mov_b32 v195, 0
v_mov_b32 v196, 0
v_mov_b32 v197, 0
v_mov_b32 v198, 0
v_mov_b32 v199, 0
v_mov_b32 v200, 0
v_mov_b32 v201, 0
v_mov_b32 v202, 0
v_mov_b32 v203, 0
v_mov_b32 v204, 0
v_mov_b32 v205, 0
v_mov_b32 v206, 0
v_mov_b32 v207, 0
v_mov_b32 v208, 0
v_mov_b32 v209, 0
v_mov_b32 v210, 0
v_mov_b32 v211, 0
v_mov_b32 v212, 0
v_mov_b32 v213, 0
v_mov_b32 v214, 0
v_mov_b32 v215, 0
s_mov_b32 s60, s37
s_cmp_lg_u32 s35, 0
s_cbranch_scc1 L_A_nostat
s_cmp_lg_u32 s38, 0
s_cbranch_scc1 L_A_qdone
s_mov_b32 s64, 0
L_tp_Aq:
buffer_load_dwordx4 v[44:47], v10, s[44:47], 0 offen sc1
s_waitcnt vmcnt(0)
v_cmp_ne_u32 s[62:63], s88, v45
v_cmp_ne_u32 vcc, s88, v47
s_add_u32 s64, s64, 1
s_nop 0
s_or_b64 vcc, vcc, s[62:63]
s_cbranch_scc0 L_tp_Aq_ok
s_cmp_lt_u32 s64, 65536
s_cbranch_scc1 L_tp_Aq
L_tp_Aq_ok:
v_mov_b32 v45, v46
v_mov_b32 v46, 1
ds_write_b64 v11, v[44:45] offset:1024
ds_write_b32 v8, v46 offset:0
L_A_qdone:
s_mov_b32 s64, 0
L_A_hs:
ds_read_b32 v10, v8 offset:4
s_waitcnt lgkmcnt(0)
v_readfirstlane_b32 s65, v10
s_add_u32 s64, s64, 1
s_nop 2
s_cmp_ge_u32 s65, 4
s_cbranch_scc1 L_A_hs_ok
s_sleep 16
s_cmp_lt_u32 s64, 1048576
s_cbranch_scc1 L_A_hs
L_A_hs_ok:
s_waitcnt vmcnt(0)
v_and_b32 v10, 1, v1
v_lshlrev_b32 v11, 4, v10
ds_read_b128 v[44:47], v11 offset:64
ds_read_b128 v[48:51], v11 offset:96
v_lshlrev_b32 v10, 12, v10
s_lshl_b32 s63, s60, 4
s_add_u32 s63, s63, 0x14000
v_add_u32 v10, s63, v10
s_lshl_b32 s63, s60, 7
s_add_u32 s63, s63, 0x50000
v_lshl_add_u32 v10, v1, 4, s63
s_waitcnt lgkmcnt(0)
v_max3_f32 v52, v44, v45, v46
v_max_f32 v52, v52, v47
v_sub_f32 v44, v44, v52
v_sub_f32 v45, v45, v52
v_sub_f32 v46, v46, v52
v_sub_f32 v47, v47, v52
v_exp_f32 v44, v44
v_exp_f32 v45, v45
v_exp_f32 v46, v46
v_exp_f32 v47, v47
s_nop 0
v_mul_f32 v54, v44, v48
v_fma_f32 v54, v45, v49, v54
v_fma_f32 v54, v46, v50, v54
v_fma_f32 v54, v47, v51, v54
v_mov_b32 v53, s88
v_mov_b32 v55, s88
s_mov_b64 exec, 255
global_store_dwordx4 v10, v[52:55], s[30:31] sc1
s_mov_b64 exec, -1
L_A_nostat:
s_sub_u32 s63, s35, 1
s_cmp_gt_u32 s63, 1
s_cbranch_scc1 L_A_monx
s_and_b32 s63, s32, 7
s_mul_i32 s63, s63, 0x100
s_add_u32 s63, s63, 0xc0000
s_add_u32 s56, s30, s63
s_addc_u32 s57, s31, 0
s_mov_b32 s64, 0
s_mov_b32 s59, 0
s_lshr_b32 s62, s32, 3
s_mul_i32 s62, s62, 6
s_add_u32 s62, s62, s33
s_lshl_b32 s62, s62, 2
v_mov_b32 v44, s62
v_lshlrev_b32 v48, 2, v1
s_lshr_b32 s65, s62, 2
s_cmp_eq_u32 s35, 1
s_cbranch_scc1 L_A_mon
s_mov_b64 exec, 1
s_mov_b32 s59, -4
L_A_post:
ds_read_b32 v45, v8 offset:256
s_waitcnt lgkmcnt(0)
v_readfirstlane_b32 s58, v45
v_add_u32 v46, s88, v45
s_sub_u32 s63, s58, s59
s_cmp_lt_u32 s63, 4
s_cbranch_scc1 L_A_postn
global_store_dword v44, v46, s[56:57]
s_mov_b32 s59, s58
s_cmp_ge_u32 s58, 640
s_cbranch_scc1 L_A_monx
L_A_postn:
s_sleep 2
s_add_u32 s64, s64, 1
s_cmp_lt_u32 s64, 65536
s_cbranch_scc1 L_A_post
s_branch L_A_monx
L_A_mon:
s_mov_b64 exec, 1
ds_read_b32 v45, v8 offset:256
s_waitcnt lgkmcnt(0)
v_add_u32 v46, s88, v45
v_readfirstlane_b32 s58, v45
s_mov_b64 exec, 0x1ffffff
global_load_dword v49, v48, s[56:57] nt
s_waitcnt vmcnt(0)
v_subrev_u32 v49, s88, v49
s_mov_b64 exec, 0xffffff
v_cmp_le_u32 vcc, 0x400, v49
v_readlane_b32 s62, v49, 24
v_readlane_b32 s59, v49, s65
v_add_u32_dpp v49, v49, v49 row_shr:1 row_mask:0xf bank_mask:0xf bound_ctrl:0
s_nop 1
v_add_u32_dpp v49, v49, v49 row_shr:2 row_mask:0xf bank_mask:0xf bound_ctrl:0
s_nop 1
v_add_u32_dpp v49, v49, v49 row_shr:4 row_mask:0xf bank_mask:0xf bound_ctrl:0
s_nop 1
v_add_u32_dpp v49, v49, v49 row_shr:8 row_mask:0xf bank_mask:0xf bound_ctrl:0
s_nop 0
v_readlane_b32 s61, v49, 15
v_readlane_b32 s63, v49, 23
s_add_u32 s61, s61, s63
s_mul_i32 s63, s59, 24
s_sub_u32 s61, s61, s63
s_cmp_lt_u32 s62, 0x8000
s_cselect_b32 s62, s62, 0x4000
s_add_u32 s61, s61, s62
s_sub_u32 s61, s61, 0x4000
s_mov_b32 s63, -48
s_cmp_lt_u32 s58, 400
s_cselect_b32 s63, s63, -48
s_cmp_gt_i32 s61, s63
s_cselect_b32 s63, 1, 0
s_cmp_eq_u64 vcc, 0
s_cselect_b32 s63, s63, 0
s_cmp_lt_u32 s58, 620
s_cselect_b32 s63, s63, 1
v_mov_b32 v47, s63
ds_write_b32 v8, v47 offset:8
s_mov_b32 s59, s58
s_cmp_ge_u32 s58, 620
s_cbranch_scc1 L_A_monx
s_add_u32 s64, s64, 1
s_cmp_lt_u32 s64, 4096
s_cbranch_scc1 L_A_mon
L_A_monx:
s_mov_b64 exec, -1
v_mul_u32_u24 v10, 144, v2
v_lshl_add_u32 v10, v3, 4, v10
v_and_b32 v28, 1, v2
v_mul_u32_u24 v28, 0xaaaa, v28
v_add_u32 v28, 0x4444, v28
v_lshrrev_b32 v11, 1, v3
v_lshlrev_b32 v11, 18, v11
v_and_b32 v29, 31, v1
v_lshl_add_u32 v11, v29, 3, v11
s_lshl_b32 s63, s60, 10
s_lshl_b32 s62, s35, 8
s_add_u32 s63, s63, s62
s_add_u32 s63, s63, 0x100000
v_add_u32 v11, s63, v11
s_barrier
ds_read_b128 v[12:15], v10 offset:8192
ds_read_b128 v[16:19], v10 offset:8256
s_waitcnt lgkmcnt(1)
v_smfmac_f32_16x16x64_bf16 v[184:187], v[12:15], v[56:63], v28
v_smfmac_f32_16x16x64_bf16 v[200:203], v[12:15], v[88:95], v28
s_waitcnt lgkmcnt(0)
v_smfmac_f32_16x16x64_bf16 v[184:187], v[16:19], v[120:127], v28
v_smfmac_f32_16x16x64_bf16 v[200:203], v[16:19], v[152:159], v28
v_smfmac_f32_16x16x64_bf16 v[188:191], v[12:15], v[64:71], v28
v_smfmac_f32_16x16x64_bf16 v[204:207], v[12:15], v[96:103], v28
v_smfmac_f32_16x16x64_bf16 v[188:191], v[16:19], v[128:135], v28
v_smfmac_f32_16x16x64_bf16 v[204:207], v[16:19], v[160:167], v28
v_smfmac_f32_16x16x64_bf16 v[192:195], v[12:15], v[72:79], v28
v_smfmac_f32_16x16x64_bf16 v[208:211], v[12:15], v[104:111], v28
v_smfmac_f32_16x16x64_bf16 v[192:195], v[16:19], v[136:143], v28
v_smfmac_f32_16x16x64_bf16 v[208:211], v[16:19], v[168:175], v28
v_smfmac_f32_16x16x64_bf16 v[196:199], v[12:15], v[80:87], v28
v_smfmac_f32_16x16x64_bf16 v[212:215], v[12:15], v[112:119], v28
v_smfmac_f32_16x16x64_bf16 v[196:199], v[16:19], v[144:151], v28
v_smfmac_f32_16x16x64_bf16 v[212:215], v[16:19], v[176:183], v28
v_pk_add_f32 v[184:185], v[184:185], v[186:187]
v_pk_add_f32 v[200:201], v[200:201], v[202:203]
v_add_f32 v184, v184, v185
v_add_f32 v200, v200, v201
v_pk_add_f32 v[188:189], v[188:189], v[190:191]
v_pk_add_f32 v[204:205], v[204:205], v[206:207]
v_permlane16_swap_b32 v184, v200
v_add_f32 v188, v188, v189
v_add_f32 v204, v204, v205
v_pk_add_f32 v[192:193], v[192:193], v[194:195]
v_pk_add_f32 v[208:209], v[208:209], v[210:211]
v_add_f32 v184, v184, v200
v_permlane16_swap_b32 v188, v204
v_add_f32 v192, v192, v193
v_add_f32 v208, v208, v209
v_add_f32 v188, v188, v204
v_pk_add_f32 v[196:197], v[196:197], v[198:199]
v_pk_add_f32 v[212:213], v[212:213], v[214:215]
v_permlane16_swap_b32 v192, v208
v_add_f32 v196, v196, v197
v_add_f32 v212, v212, v213
v_cvt_pk_bf16_f32 v36, v184, v188
v_add_f32 v192, v192, v208
v_permlane16_swap_b32 v196, v212
v_min_u32 v36, 0xfffffffe, v36
v_add_f32 v196, v196, v212
v_cvt_pk_bf16_f32 v37, v192, v196
v_min_u32 v37, 0xfffffffe, v37
global_store_dwordx2 v11, v[36:37], s[30:31] sc1
s_endpgm
L_roleW:
v_and_b32 v8, 1, v0
v_lshlrev_b32 v8, 4, v8
v_mov_b32 v9, 0xffff
v_lshlrev_b32 v8, v8, v9
v_bfe_u32 v9, v0, 1, 2
v_cmp_eq_u32 vcc, 0, v9
s_nop 1
v_cndmask_b32 v4, 0, v8, vcc
v_cmp_eq_u32 vcc, 1, v9
s_nop 1
v_cndmask_b32 v5, 0, v8, vcc
v_cmp_eq_u32 vcc, 2, v9
s_nop 1
v_cndmask_b32 v6, 0, v8, vcc
v_cmp_eq_u32 vcc, 3, v9
s_nop 1
v_cndmask_b32 v7, 0, v8, vcc
s_waitcnt lgkmcnt(0)
s_load_dword s88, s[30:31], 0x18000
v_mov_b32 v8, 0
s_mov_b32 s52, s30
s_and_b32 s53, s31, 0xffff
s_mov_b32 s54, 0x1000000
s_mov_b32 s55, 0x20000
s_lshl_b32 s60, s89, 8
s_sub_u32 s61, 0x400000, s60
s_add_u32 s40, s18, s60
s_addc_u32 s41, s19, 0
s_and_b32 s41, s41, 0xffff
s_mov_b32 s42, s61
s_mov_b32 s43, 0x20000
s_add_u32 s44, s20, s60
s_addc_u32 s45, s21, 0
s_and_b32 s45, s45, 0xffff
s_mov_b32 s46, s61
s_mov_b32 s47, 0x20000
s_mov_b32 s48, s14
s_and_b32 s49, s15, 0xffff
s_mov_b32 s50, 0x800
s_mov_b32 s51, 0x20000
v_lshrrev_b32 v192, 3, v2
v_lshlrev_b32 v192, 10, v192
v_lshl_add_u32 v192, v3, 5, v192
s_lshl_b32 s62, s34, 7
v_add_u32 v192, s62, v192
buffer_load_dwordx4 v[12:15], v192, s[48:51], 0 offen
buffer_load_dwordx4 v[16:19], v192, s[48:51], 0 offen offset:16
v_lshlrev_b32 v9, 17, v3
v_lshl_add_u32 v9, v2, 4, v9
s_lshl_b32 s62, s34, 19
v_add_u32 v9, s62, v9
s_waitcnt vmcnt(2)
s_mov_b32 s62, 0
buffer_load_dwordx4 v[64:67], v9, s[40:43], s62 offen nt
s_waitcnt vmcnt(2)
s_mov_b32 s62, 8192
buffer_load_dwordx4 v[68:71], v9, s[40:43], s62 offen nt
s_waitcnt vmcnt(2)
s_mov_b32 s62, 16384
buffer_load_dwordx4 v[72:75], v9, s[40:43], s62 offen nt
s_waitcnt vmcnt(2)
s_mov_b32 s62, 24576
buffer_load_dwordx4 v[76:79], v9, s[40:43], s62 offen nt
s_waitcnt vmcnt(2)
s_mov_b32 s62, 32768
buffer_load_dwordx4 v[80:83], v9, s[40:43], s62 offen nt
s_waitcnt vmcnt(2)
s_mov_b32 s62, 40960
buffer_load_dwordx4 v[84:87], v9, s[40:43], s62 offen nt
s_waitcnt vmcnt(2)
s_mov_b32 s62, 49152
buffer_load_dwordx4 v[88:91], v9, s[40:43], s62 offen nt
s_waitcnt vmcnt(2)
s_mov_b32 s62, 57344
buffer_load_dwordx4 v[92:95], v9, s[40:43], s62 offen nt
s_waitcnt vmcnt(2)
s_mov_b32 s62, 65536
buffer_load_dwordx4 v[96:99], v9, s[40:43], s62 offen nt
s_waitcnt vmcnt(2)
s_mov_b32 s62, 73728
buffer_load_dwordx4 v[100:103], v9, s[40:43], s62 offen nt
s_waitcnt vmcnt(2)
s_mov_b32 s62, 81920
buffer_load_dwordx4 v[104:107], v9, s[40:43], s62 offen nt
s_waitcnt vmcnt(2)
s_mov_b32 s62, 90112
buffer_load_dwordx4 v[108:111], v9, s[40:43], s62 offen nt
s_waitcnt vmcnt(2)
s_mov_b32 s62, 98304
buffer_load_dwordx4 v[112:115], v9, s[40:43], s62 offen nt
s_waitcnt vmcnt(2)
s_mov_b32 s62, 106496
buffer_load_dwordx4 v[116:119], v9, s[40:43], s62 offen nt
s_waitcnt vmcnt(2)
s_mov_b32 s62, 114688
buffer_load_dwordx4 v[120:123], v9, s[40:43], s62 offen nt
s_waitcnt vmcnt(2)
s_mov_b32 s62, 122880
buffer_load_dwordx4 v[124:127], v9, s[40:43], s62 offen nt
s_barrier
s_waitcnt vmcnt(16)
s_mov_b32 s60, 0x01000100
v_perm_b32 v192, v12, v12, s60
v_and_b32 v28, v192, v4
v_and_b32 v29, v192, v5
v_and_b32 v30, v192, v6
v_and_b32 v31, v192, v7
s_waitcnt vmcnt(15)
s_nop 0
v_mfma_f32_16x16x32_bf16 v[44:47], v[28:31], v[64:67], 0
s_mov_b32 s62, 0
buffer_load_dwordx4 v[128:131], v9, s[44:47], s62 offen nt
s_mov_b32 s60, 0x03020302
v_perm_b32 v193, v12, v12, s60
v_and_b32 v32, v193, v4
v_and_b32 v33, v193, v5
v_and_b32 v34, v193, v6
v_and_b32 v35, v193, v7
s_waitcnt vmcnt(15)
s_nop 0
v_mfma_f32_16x16x32_bf16 v[44:47], v[32:35], v[68:71], v[44:47]
s_mov_b32 s62, 8192
buffer_load_dwordx4 v[132:135], v9, s[44:47], s62 offen nt
s_mov_b32 s60, 0x01000100
v_perm_b32 v192, v13, v13, s60
v_and_b32 v28, v192, v4
v_and_b32 v29, v192, v5
v_and_b32 v30, v192, v6
v_and_b32 v31, v192, v7
s_waitcnt vmcnt(15)
s_nop 0
v_mfma_f32_16x16x32_bf16 v[44:47], v[28:31], v[72:75], v[44:47]
s_mov_b32 s62, 16384
buffer_load_dwordx4 v[136:139], v9, s[44:47], s62 offen nt
s_mov_b32 s60, 0x03020302
v_perm_b32 v193, v13, v13, s60
v_and_b32 v32, v193, v4
v_and_b32 v33, v193, v5
v_and_b32 v34, v193, v6
v_and_b32 v35, v193, v7
s_waitcnt vmcnt(15)
s_nop 0
v_mfma_f32_16x16x32_bf16 v[44:47], v[32:35], v[76:79], v[44:47]
s_mov_b32 s62, 24576
buffer_load_dwordx4 v[140:143], v9, s[44:47], s62 offen nt
s_mov_b32 s60, 0x01000100
v_perm_b32 v192, v14, v14, s60
v_and_b32 v28, v192, v4
v_and_b32 v29, v192, v5
v_and_b32 v30, v192, v6
v_and_b32 v31, v192, v7
s_waitcnt vmcnt(15)
s_nop 0
v_mfma_f32_16x16x32_bf16 v[44:47], v[28:31], v[80:83], v[44:47]
s_mov_b32 s62, 32768
buffer_load_dwordx4 v[144:147], v9, s[44:47], s62 offen nt
s_mov_b32 s60, 0x03020302
v_perm_b32 v193, v14, v14, s60
v_and_b32 v32, v193, v4
v_and_b32 v33, v193, v5
v_and_b32 v34, v193, v6
v_and_b32 v35, v193, v7
s_waitcnt vmcnt(15)
s_nop 0
v_mfma_f32_16x16x32_bf16 v[44:47], v[32:35], v[84:87], v[44:47]
s_mov_b32 s62, 40960
buffer_load_dwordx4 v[148:151], v9, s[44:47], s62 offen nt
s_mov_b32 s60, 0x01000100
v_perm_b32 v192, v15, v15, s60
v_and_b32 v28, v192, v4
v_and_b32 v29, v192, v5
v_and_b32 v30, v192, v6
v_and_b32 v31, v192, v7
s_waitcnt vmcnt(15)
s_nop 0
v_mfma_f32_16x16x32_bf16 v[44:47], v[28:31], v[88:91], v[44:47]
s_mov_b32 s62, 49152
buffer_load_dwordx4 v[152:155], v9, s[44:47], s62 offen nt
s_mov_b32 s60, 0x03020302
v_perm_b32 v193, v15, v15, s60
v_and_b32 v32, v193, v4
v_and_b32 v33, v193, v5
v_and_b32 v34, v193, v6
v_and_b32 v35, v193, v7
s_waitcnt vmcnt(15)
s_nop 0
v_mfma_f32_16x16x32_bf16 v[44:47], v[32:35], v[92:95], v[44:47]
s_mov_b32 s62, 57344
buffer_load_dwordx4 v[156:159], v9, s[44:47], s62 offen nt
s_mov_b32 s60, 0x01000100
v_perm_b32 v192, v16, v16, s60
v_and_b32 v28, v192, v4
v_and_b32 v29, v192, v5
v_and_b32 v30, v192, v6
v_and_b32 v31, v192, v7
s_waitcnt vmcnt(15)
s_nop 0
v_mfma_f32_16x16x32_bf16 v[44:47], v[28:31], v[96:99], v[44:47]
s_mov_b32 s62, 65536
buffer_load_dwordx4 v[160:163], v9, s[44:47], s62 offen nt
s_mov_b32 s60, 0x03020302
v_perm_b32 v193, v16, v16, s60
v_and_b32 v32, v193, v4
v_and_b32 v33, v193, v5
v_and_b32 v34, v193, v6
v_and_b32 v35, v193, v7
s_waitcnt vmcnt(15)
s_nop 0
v_mfma_f32_16x16x32_bf16 v[44:47], v[32:35], v[100:103], v[44:47]
s_mov_b32 s62, 73728
buffer_load_dwordx4 v[164:167], v9, s[44:47], s62 offen nt
s_mov_b32 s60, 0x01000100
v_perm_b32 v192, v17, v17, s60
v_and_b32 v28, v192, v4
v_and_b32 v29, v192, v5
v_and_b32 v30, v192, v6
v_and_b32 v31, v192, v7
s_waitcnt vmcnt(15)
s_nop 0
v_mfma_f32_16x16x32_bf16 v[44:47], v[28:31], v[104:107], v[44:47]
s_mov_b32 s62, 81920
buffer_load_dwordx4 v[168:171], v9, s[44:47], s62 offen nt
s_mov_b32 s60, 0x03020302
v_perm_b32 v193, v17, v17, s60
v_and_b32 v32, v193, v4
v_and_b32 v33, v193, v5
v_and_b32 v34, v193, v6
v_and_b32 v35, v193, v7
s_waitcnt vmcnt(15)
s_nop 0
v_mfma_f32_16x16x32_bf16 v[44:47], v[32:35], v[108:111], v[44:47]
s_mov_b32 s62, 90112
buffer_load_dwordx4 v[172:175], v9, s[44:47], s62 offen nt
s_mov_b32 s60, 0x01000100
v_perm_b32 v192, v18, v18, s60
v_and_b32 v28, v192, v4
v_and_b32 v29, v192, v5
v_and_b32 v30, v192, v6
v_and_b32 v31, v192, v7
s_waitcnt vmcnt(15)
s_nop 0
v_mfma_f32_16x16x32_bf16 v[44:47], v[28:31], v[112:115], v[44:47]
s_mov_b32 s62, 98304
buffer_load_dwordx4 v[176:179], v9, s[44:47], s62 offen nt
s_mov_b32 s60, 0x03020302
v_perm_b32 v193, v18, v18, s60
v_and_b32 v32, v193, v4
v_and_b32 v33, v193, v5
v_and_b32 v34, v193, v6
v_and_b32 v35, v193, v7
s_waitcnt vmcnt(15)
s_nop 0
v_mfma_f32_16x16x32_bf16 v[44:47], v[32:35], v[116:119], v[44:47]
s_mov_b32 s62, 106496
buffer_load_dwordx4 v[180:183], v9, s[44:47], s62 offen nt
s_mov_b32 s60, 0x01000100
v_perm_b32 v192, v19, v19, s60
v_and_b32 v28, v192, v4
v_and_b32 v29, v192, v5
v_and_b32 v30, v192, v6
v_and_b32 v31, v192, v7
s_waitcnt vmcnt(15)
s_nop 0
v_mfma_f32_16x16x32_bf16 v[44:47], v[28:31], v[120:123], v[44:47]
s_mov_b32 s62, 114688
buffer_load_dwordx4 v[184:187], v9, s[44:47], s62 offen nt
s_mov_b32 s60, 0x03020302
v_perm_b32 v193, v19, v19, s60
v_and_b32 v32, v193, v4
v_and_b32 v33, v193, v5
v_and_b32 v34, v193, v6
v_and_b32 v35, v193, v7
s_waitcnt vmcnt(15)
s_nop 0
v_mfma_f32_16x16x32_bf16 v[44:47], v[32:35], v[124:127], v[44:47]
s_mov_b32 s62, 122880
buffer_load_dwordx4 v[188:191], v9, s[44:47], s62 offen nt
s_nop 1
v_lshrrev_b32 v192, 1, v3
v_lshlrev_b32 v192, 9, v192
v_lshl_add_u32 v192, v2, 5, v192
v_and_b32 v193, 1, v3
v_lshl_add_u32 v192, v193, 4, v192
s_lshl_b32 s63, s34, 10
v_add_u32 v192, s63, v192
s_nop 1
s_nop 5
ds_write_b128 v192, v[44:47] offset:0
s_waitcnt lgkmcnt(0)
s_barrier
s_cmp_ge_u32 s34, 4
s_cbranch_scc1 L_W_qskip
v_lshlrev_b32 v194, 2, v0
ds_read_b32 v196, v194 offset:0
ds_read_b32 v197, v194 offset:1024
ds_read_b32 v198, v194 offset:2048
ds_read_b32 v199, v194 offset:3072
ds_read_b32 v200, v194 offset:4096
ds_read_b32 v201, v194 offset:5120
ds_read_b32 v202, v194 offset:6144
ds_read_b32 v203, v194 offset:7168
s_waitcnt lgkmcnt(0)
v_add_f32 v196, v196, v197
v_add_f32 v196, v196, v198
v_add_f32 v196, v196, v199
v_add_f32 v196, v196, v200
v_add_f32 v196, v196, v201
v_add_f32 v196, v196, v202
v_add_f32 v196, v196, v203
v_cvt_pk_bf16_f32 v196, v196, v196
v_lshlrev_b32 v194, 1, v0
ds_write_b16 v194, v196 offset:8192
s_waitcnt lgkmcnt(0)
L_W_qskip:
s_barrier
s_waitcnt lgkmcnt(0)
s_add_u32 s88, s88, 0x9e3779b9
v_lshlrev_b32 v194, 4, v2
ds_read_b128 v[20:23], v194 offset:8192
ds_read_b128 v[24:27], v194 offset:8448
v_mov_b32 v200, 0
v_mov_b32 v201, 0
s_waitcnt lgkmcnt(0)
s_waitcnt vmcnt(14)
v_dot2_f32_bf16 v60, v128, v20, 0
v_dot2_f32_bf16 v61, v128, v24, 0
v_dot2_f32_bf16 v62, v132, v20, 0
v_dot2_f32_bf16 v63, v132, v24, 0
v_dot2_f32_bf16 v60, v129, v21, v60
v_dot2_f32_bf16 v61, v129, v25, v61
v_dot2_f32_bf16 v62, v133, v21, v62
v_dot2_f32_bf16 v63, v133, v25, v63
v_dot2_f32_bf16 v60, v130, v22, v60
v_dot2_f32_bf16 v61, v130, v26, v61
v_dot2_f32_bf16 v62, v134, v22, v62
v_dot2_f32_bf16 v63, v134, v26, v63
v_dot2_f32_bf16 v60, v131, v23, v60
v_dot2_f32_bf16 v61, v131, v27, v61
v_dot2_f32_bf16 v62, v135, v23, v62
v_dot2_f32_bf16 v63, v135, v27, v63
v_add_f32_dpp v60, v60, v60 row_ror:8 row_mask:0xf bank_mask:0xf
v_add_f32_dpp v61, v61, v61 row_ror:8 row_mask:0xf bank_mask:0xf
v_add_f32_dpp v62, v62, v62 row_ror:8 row_mask:0xf bank_mask:0xf
v_add_f32_dpp v63, v63, v63 row_ror:8 row_mask:0xf bank_mask:0xf
v_add_f32_dpp v60, v60, v60 row_ror:4 row_mask:0xf bank_mask:0xf
v_add_f32_dpp v61, v61, v61 row_ror:4 row_mask:0xf bank_mask:0xf
v_add_f32_dpp v62, v62, v62 row_ror:4 row_mask:0xf bank_mask:0xf
v_add_f32_dpp v63, v63, v63 row_ror:4 row_mask:0xf bank_mask:0xf
v_add_f32_dpp v60, v60, v60 row_ror:2 row_mask:0xf bank_mask:0xf
v_add_f32_dpp v61, v61, v61 row_ror:2 row_mask:0xf bank_mask:0xf
v_add_f32_dpp v62, v62, v62 row_ror:2 row_mask:0xf bank_mask:0xf
v_add_f32_dpp v63, v63, v63 row_ror:2 row_mask:0xf bank_mask:0xf
v_add_f32_dpp v60, v60, v60 row_ror:1 row_mask:0xf bank_mask:0xf
v_add_f32_dpp v61, v61, v61 row_ror:1 row_mask:0xf bank_mask:0xf
v_add_f32_dpp v62, v62, v62 row_ror:1 row_mask:0xf bank_mask:0xf
v_add_f32_dpp v63, v63, v63 row_ror:1 row_mask:0xf bank_mask:0xf
v_cmp_eq_u32 vcc, 0, v2
s_nop 1
v_cndmask_b32 v200, v200, v60, vcc
v_cndmask_b32 v201, v201, v61, vcc
v_cmp_eq_u32 vcc, 1, v2
s_nop 1
v_cndmask_b32 v200, v200, v62, vcc
v_cndmask_b32 v201, v201, v63, vcc
s_waitcnt vmcnt(12)
v_dot2_f32_bf16 v60, v136, v20, 0
v_dot2_f32_bf16 v61, v136, v24, 0
v_dot2_f32_bf16 v62, v140, v20, 0
v_dot2_f32_bf16 v63, v140, v24, 0
v_dot2_f32_bf16 v60, v137, v21, v60
v_dot2_f32_bf16 v61, v137, v25, v61
v_dot2_f32_bf16 v62, v141, v21, v62
v_dot2_f32_bf16 v63, v141, v25, v63
v_dot2_f32_bf16 v60, v138, v22, v60
v_dot2_f32_bf16 v61, v138, v26, v61
v_dot2_f32_bf16 v62, v142, v22, v62
v_dot2_f32_bf16 v63, v142, v26, v63
v_dot2_f32_bf16 v60, v139, v23, v60
v_dot2_f32_bf16 v61, v139, v27, v61
v_dot2_f32_bf16 v62, v143, v23, v62
v_dot2_f32_bf16 v63, v143, v27, v63
v_add_f32_dpp v60, v60, v60 row_ror:8 row_mask:0xf bank_mask:0xf
v_add_f32_dpp v61, v61, v61 row_ror:8 row_mask:0xf bank_mask:0xf
v_add_f32_dpp v62, v62, v62 row_ror:8 row_mask:0xf bank_mask:0xf
v_add_f32_dpp v63, v63, v63 row_ror:8 row_mask:0xf bank_mask:0xf
v_add_f32_dpp v60, v60, v60 row_ror:4 row_mask:0xf bank_mask:0xf
v_add_f32_dpp v61, v61, v61 row_ror:4 row_mask:0xf bank_mask:0xf
v_add_f32_dpp v62, v62, v62 row_ror:4 row_mask:0xf bank_mask:0xf
v_add_f32_dpp v63, v63, v63 row_ror:4 row_mask:0xf bank_mask:0xf
v_add_f32_dpp v60, v60, v60 row_ror:2 row_mask:0xf bank_mask:0xf
v_add_f32_dpp v61, v61, v61 row_ror:2 row_mask:0xf bank_mask:0xf
v_add_f32_dpp v62, v62, v62 row_ror:2 row_mask:0xf bank_mask:0xf
v_add_f32_dpp v63, v63, v63 row_ror:2 row_mask:0xf bank_mask:0xf
v_add_f32_dpp v60, v60, v60 row_ror:1 row_mask:0xf bank_mask:0xf
v_add_f32_dpp v61, v61, v61 row_ror:1 row_mask:0xf bank_mask:0xf
v_add_f32_dpp v62, v62, v62 row_ror:1 row_mask:0xf bank_mask:0xf
v_add_f32_dpp v63, v63, v63 row_ror:1 row_mask:0xf bank_mask:0xf
v_cmp_eq_u32 vcc, 2, v2
s_nop 1
v_cndmask_b32 v200, v200, v60, vcc
v_cndmask_b32 v201, v201, v61, vcc
v_cmp_eq_u32 vcc, 3, v2
s_nop 1
v_cndmask_b32 v200, v200, v62, vcc
v_cndmask_b32 v201, v201, v63, vcc
s_waitcnt vmcnt(10)
v_dot2_f32_bf16 v60, v144, v20, 0
v_dot2_f32_bf16 v61, v144, v24, 0
v_dot2_f32_bf16 v62, v148, v20, 0
v_dot2_f32_bf16 v63, v148, v24, 0
v_dot2_f32_bf16 v60, v145, v21, v60
v_dot2_f32_bf16 v61, v145, v25, v61
v_dot2_f32_bf16 v62, v149, v21, v62
v_dot2_f32_bf16 v63, v149, v25, v63
v_dot2_f32_bf16 v60, v146, v22, v60
v_dot2_f32_bf16 v61, v146, v26, v61
v_dot2_f32_bf16 v62, v150, v22, v62
v_dot2_f32_bf16 v63, v150, v26, v63
v_dot2_f32_bf16 v60, v147, v23, v60
v_dot2_f32_bf16 v61, v147, v27, v61
v_dot2_f32_bf16 v62, v151, v23, v62
v_dot2_f32_bf16 v63, v151, v27, v63
v_add_f32_dpp v60, v60, v60 row_ror:8 row_mask:0xf bank_mask:0xf
v_add_f32_dpp v61, v61, v61 row_ror:8 row_mask:0xf bank_mask:0xf
v_add_f32_dpp v62, v62, v62 row_ror:8 row_mask:0xf bank_mask:0xf
v_add_f32_dpp v63, v63, v63 row_ror:8 row_mask:0xf bank_mask:0xf
v_add_f32_dpp v60, v60, v60 row_ror:4 row_mask:0xf bank_mask:0xf
v_add_f32_dpp v61, v61, v61 row_ror:4 row_mask:0xf bank_mask:0xf
v_add_f32_dpp v62, v62, v62 row_ror:4 row_mask:0xf bank_mask:0xf
v_add_f32_dpp v63, v63, v63 row_ror:4 row_mask:0xf bank_mask:0xf
v_add_f32_dpp v60, v60, v60 row_ror:2 row_mask:0xf bank_mask:0xf
v_add_f32_dpp v61, v61, v61 row_ror:2 row_mask:0xf bank_mask:0xf
v_add_f32_dpp v62, v62, v62 row_ror:2 row_mask:0xf bank_mask:0xf
v_add_f32_dpp v63, v63, v63 row_ror:2 row_mask:0xf bank_mask:0xf
v_add_f32_dpp v60, v60, v60 row_ror:1 row_mask:0xf bank_mask:0xf
v_add_f32_dpp v61, v61, v61 row_ror:1 row_mask:0xf bank_mask:0xf
v_add_f32_dpp v62, v62, v62 row_ror:1 row_mask:0xf bank_mask:0xf
v_add_f32_dpp v63, v63, v63 row_ror:1 row_mask:0xf bank_mask:0xf
v_cmp_eq_u32 vcc, 4, v2
s_nop 1
v_cndmask_b32 v200, v200, v60, vcc
v_cndmask_b32 v201, v201, v61, vcc
v_cmp_eq_u32 vcc, 5, v2
s_nop 1
v_cndmask_b32 v200, v200, v62, vcc
v_cndmask_b32 v201, v201, v63, vcc
s_waitcnt vmcnt(8)
v_dot2_f32_bf16 v60, v152, v20, 0
v_dot2_f32_bf16 v61, v152, v24, 0
v_dot2_f32_bf16 v62, v156, v20, 0
v_dot2_f32_bf16 v63, v156, v24, 0
v_dot2_f32_bf16 v60, v153, v21, v60
v_dot2_f32_bf16 v61, v153, v25, v61
v_dot2_f32_bf16 v62, v157, v21, v62
v_dot2_f32_bf16 v63, v157, v25, v63
v_dot2_f32_bf16 v60, v154, v22, v60
v_dot2_f32_bf16 v61, v154, v26, v61
v_dot2_f32_bf16 v62, v158, v22, v62
v_dot2_f32_bf16 v63, v158, v26, v63
v_dot2_f32_bf16 v60, v155, v23, v60
v_dot2_f32_bf16 v61, v155, v27, v61
v_dot2_f32_bf16 v62, v159, v23, v62
v_dot2_f32_bf16 v63, v159, v27, v63
v_add_f32_dpp v60, v60, v60 row_ror:8 row_mask:0xf bank_mask:0xf
v_add_f32_dpp v61, v61, v61 row_ror:8 row_mask:0xf bank_mask:0xf
v_add_f32_dpp v62, v62, v62 row_ror:8 row_mask:0xf bank_mask:0xf
v_add_f32_dpp v63, v63, v63 row_ror:8 row_mask:0xf bank_mask:0xf
v_add_f32_dpp v60, v60, v60 row_ror:4 row_mask:0xf bank_mask:0xf
v_add_f32_dpp v61, v61, v61 row_ror:4 row_mask:0xf bank_mask:0xf
v_add_f32_dpp v62, v62, v62 row_ror:4 row_mask:0xf bank_mask:0xf
v_add_f32_dpp v63, v63, v63 row_ror:4 row_mask:0xf bank_mask:0xf
v_add_f32_dpp v60, v60, v60 row_ror:2 row_mask:0xf bank_mask:0xf
v_add_f32_dpp v61, v61, v61 row_ror:2 row_mask:0xf bank_mask:0xf
v_add_f32_dpp v62, v62, v62 row_ror:2 row_mask:0xf bank_mask:0xf
v_add_f32_dpp v63, v63, v63 row_ror:2 row_mask:0xf bank_mask:0xf
v_add_f32_dpp v60, v60, v60 row_ror:1 row_mask:0xf bank_mask:0xf
v_add_f32_dpp v61, v61, v61 row_ror:1 row_mask:0xf bank_mask:0xf
v_add_f32_dpp v62, v62, v62 row_ror:1 row_mask:0xf bank_mask:0xf
v_add_f32_dpp v63, v63, v63 row_ror:1 row_mask:0xf bank_mask:0xf
v_cmp_eq_u32 vcc, 6, v2
s_nop 1
v_cndmask_b32 v200, v200, v60, vcc
v_cndmask_b32 v201, v201, v61, vcc
v_cmp_eq_u32 vcc, 7, v2
s_nop 1
v_cndmask_b32 v200, v200, v62, vcc
v_cndmask_b32 v201, v201, v63, vcc
s_waitcnt vmcnt(6)
v_dot2_f32_bf16 v60, v160, v20, 0
v_dot2_f32_bf16 v61, v160, v24, 0
v_dot2_f32_bf16 v62, v164, v20, 0
v_dot2_f32_bf16 v63, v164, v24, 0
v_dot2_f32_bf16 v60, v161, v21, v60
v_dot2_f32_bf16 v61, v161, v25, v61
v_dot2_f32_bf16 v62, v165, v21, v62
v_dot2_f32_bf16 v63, v165, v25, v63
v_dot2_f32_bf16 v60, v162, v22, v60
v_dot2_f32_bf16 v61, v162, v26, v61
v_dot2_f32_bf16 v62, v166, v22, v62
v_dot2_f32_bf16 v63, v166, v26, v63
v_dot2_f32_bf16 v60, v163, v23, v60
v_dot2_f32_bf16 v61, v163, v27, v61
v_dot2_f32_bf16 v62, v167, v23, v62
v_dot2_f32_bf16 v63, v167, v27, v63
v_add_f32_dpp v60, v60, v60 row_ror:8 row_mask:0xf bank_mask:0xf
v_add_f32_dpp v61, v61, v61 row_ror:8 row_mask:0xf bank_mask:0xf
v_add_f32_dpp v62, v62, v62 row_ror:8 row_mask:0xf bank_mask:0xf
v_add_f32_dpp v63, v63, v63 row_ror:8 row_mask:0xf bank_mask:0xf
v_add_f32_dpp v60, v60, v60 row_ror:4 row_mask:0xf bank_mask:0xf
v_add_f32_dpp v61, v61, v61 row_ror:4 row_mask:0xf bank_mask:0xf
v_add_f32_dpp v62, v62, v62 row_ror:4 row_mask:0xf bank_mask:0xf
v_add_f32_dpp v63, v63, v63 row_ror:4 row_mask:0xf bank_mask:0xf
v_add_f32_dpp v60, v60, v60 row_ror:2 row_mask:0xf bank_mask:0xf
v_add_f32_dpp v61, v61, v61 row_ror:2 row_mask:0xf bank_mask:0xf
v_add_f32_dpp v62, v62, v62 row_ror:2 row_mask:0xf bank_mask:0xf
v_add_f32_dpp v63, v63, v63 row_ror:2 row_mask:0xf bank_mask:0xf
v_add_f32_dpp v60, v60, v60 row_ror:1 row_mask:0xf bank_mask:0xf
v_add_f32_dpp v61, v61, v61 row_ror:1 row_mask:0xf bank_mask:0xf
v_add_f32_dpp v62, v62, v62 row_ror:1 row_mask:0xf bank_mask:0xf
v_add_f32_dpp v63, v63, v63 row_ror:1 row_mask:0xf bank_mask:0xf
v_cmp_eq_u32 vcc, 8, v2
s_nop 1
v_cndmask_b32 v200, v200, v60, vcc
v_cndmask_b32 v201, v201, v61, vcc
v_cmp_eq_u32 vcc, 9, v2
s_nop 1
v_cndmask_b32 v200, v200, v62, vcc
v_cndmask_b32 v201, v201, v63, vcc
s_waitcnt vmcnt(4)
v_dot2_f32_bf16 v60, v168, v20, 0
v_dot2_f32_bf16 v61, v168, v24, 0
v_dot2_f32_bf16 v62, v172, v20, 0
v_dot2_f32_bf16 v63, v172, v24, 0
v_dot2_f32_bf16 v60, v169, v21, v60
v_dot2_f32_bf16 v61, v169, v25, v61
v_dot2_f32_bf16 v62, v173, v21, v62
v_dot2_f32_bf16 v63, v173, v25, v63
v_dot2_f32_bf16 v60, v170, v22, v60
v_dot2_f32_bf16 v61, v170, v26, v61
v_dot2_f32_bf16 v62, v174, v22, v62
v_dot2_f32_bf16 v63, v174, v26, v63
v_dot2_f32_bf16 v60, v171, v23, v60
v_dot2_f32_bf16 v61, v171, v27, v61
v_dot2_f32_bf16 v62, v175, v23, v62
v_dot2_f32_bf16 v63, v175, v27, v63
v_add_f32_dpp v60, v60, v60 row_ror:8 row_mask:0xf bank_mask:0xf
v_add_f32_dpp v61, v61, v61 row_ror:8 row_mask:0xf bank_mask:0xf
v_add_f32_dpp v62, v62, v62 row_ror:8 row_mask:0xf bank_mask:0xf
v_add_f32_dpp v63, v63, v63 row_ror:8 row_mask:0xf bank_mask:0xf
v_add_f32_dpp v60, v60, v60 row_ror:4 row_mask:0xf bank_mask:0xf
v_add_f32_dpp v61, v61, v61 row_ror:4 row_mask:0xf bank_mask:0xf
v_add_f32_dpp v62, v62, v62 row_ror:4 row_mask:0xf bank_mask:0xf
v_add_f32_dpp v63, v63, v63 row_ror:4 row_mask:0xf bank_mask:0xf
v_add_f32_dpp v60, v60, v60 row_ror:2 row_mask:0xf bank_mask:0xf
v_add_f32_dpp v61, v61, v61 row_ror:2 row_mask:0xf bank_mask:0xf
v_add_f32_dpp v62, v62, v62 row_ror:2 row_mask:0xf bank_mask:0xf
v_add_f32_dpp v63, v63, v63 row_ror:2 row_mask:0xf bank_mask:0xf
v_add_f32_dpp v60, v60, v60 row_ror:1 row_mask:0xf bank_mask:0xf
v_add_f32_dpp v61, v61, v61 row_ror:1 row_mask:0xf bank_mask:0xf
v_add_f32_dpp v62, v62, v62 row_ror:1 row_mask:0xf bank_mask:0xf
v_add_f32_dpp v63, v63, v63 row_ror:1 row_mask:0xf bank_mask:0xf
v_cmp_eq_u32 vcc, 10, v2
s_nop 1
v_cndmask_b32 v200, v200, v60, vcc
v_cndmask_b32 v201, v201, v61, vcc
v_cmp_eq_u32 vcc, 11, v2
s_nop 1
v_cndmask_b32 v200, v200, v62, vcc
v_cndmask_b32 v201, v201, v63, vcc
s_waitcnt vmcnt(2)
v_dot2_f32_bf16 v60, v176, v20, 0
v_dot2_f32_bf16 v61, v176, v24, 0
v_dot2_f32_bf16 v62, v180, v20, 0
v_dot2_f32_bf16 v63, v180, v24, 0
v_dot2_f32_bf16 v60, v177, v21, v60
v_dot2_f32_bf16 v61, v177, v25, v61
v_dot2_f32_bf16 v62, v181, v21, v62
v_dot2_f32_bf16 v63, v181, v25, v63
v_dot2_f32_bf16 v60, v178, v22, v60
v_dot2_f32_bf16 v61, v178, v26, v61
v_dot2_f32_bf16 v62, v182, v22, v62
v_dot2_f32_bf16 v63, v182, v26, v63
v_dot2_f32_bf16 v60, v179, v23, v60
v_dot2_f32_bf16 v61, v179, v27, v61
v_dot2_f32_bf16 v62, v183, v23, v62
v_dot2_f32_bf16 v63, v183, v27, v63
v_add_f32_dpp v60, v60, v60 row_ror:8 row_mask:0xf bank_mask:0xf
v_add_f32_dpp v61, v61, v61 row_ror:8 row_mask:0xf bank_mask:0xf
v_add_f32_dpp v62, v62, v62 row_ror:8 row_mask:0xf bank_mask:0xf
v_add_f32_dpp v63, v63, v63 row_ror:8 row_mask:0xf bank_mask:0xf
v_add_f32_dpp v60, v60, v60 row_ror:4 row_mask:0xf bank_mask:0xf
v_add_f32_dpp v61, v61, v61 row_ror:4 row_mask:0xf bank_mask:0xf
v_add_f32_dpp v62, v62, v62 row_ror:4 row_mask:0xf bank_mask:0xf
v_add_f32_dpp v63, v63, v63 row_ror:4 row_mask:0xf bank_mask:0xf
v_add_f32_dpp v60, v60, v60 row_ror:2 row_mask:0xf bank_mask:0xf
v_add_f32_dpp v61, v61, v61 row_ror:2 row_mask:0xf bank_mask:0xf
v_add_f32_dpp v62, v62, v62 row_ror:2 row_mask:0xf bank_mask:0xf
v_add_f32_dpp v63, v63, v63 row_ror:2 row_mask:0xf bank_mask:0xf
v_add_f32_dpp v60, v60, v60 row_ror:1 row_mask:0xf bank_mask:0xf
v_add_f32_dpp v61, v61, v61 row_ror:1 row_mask:0xf bank_mask:0xf
v_add_f32_dpp v62, v62, v62 row_ror:1 row_mask:0xf bank_mask:0xf
v_add_f32_dpp v63, v63, v63 row_ror:1 row_mask:0xf bank_mask:0xf
v_cmp_eq_u32 vcc, 12, v2
s_nop 1
v_cndmask_b32 v200, v200, v60, vcc
v_cndmask_b32 v201, v201, v61, vcc
v_cmp_eq_u32 vcc, 13, v2
s_nop 1
v_cndmask_b32 v200, v200, v62, vcc
v_cndmask_b32 v201, v201, v63, vcc
s_waitcnt vmcnt(0)
v_dot2_f32_bf16 v60, v184, v20, 0
v_dot2_f32_bf16 v61, v184, v24, 0
v_dot2_f32_bf16 v62, v188, v20, 0
v_dot2_f32_bf16 v63, v188, v24, 0
v_dot2_f32_bf16 v60, v185, v21, v60
v_dot2_f32_bf16 v61, v185, v25, v61
v_dot2_f32_bf16 v62, v189, v21, v62
v_dot2_f32_bf16 v63, v189, v25, v63
v_dot2_f32_bf16 v60, v186, v22, v60
v_dot2_f32_bf16 v61, v186, v26, v61
v_dot2_f32_bf16 v62, v190, v22, v62
v_dot2_f32_bf16 v63, v190, v26, v63
v_dot2_f32_bf16 v60, v187, v23, v60
v_dot2_f32_bf16 v61, v187, v27, v61
v_dot2_f32_bf16 v62, v191, v23, v62
v_dot2_f32_bf16 v63, v191, v27, v63
v_add_f32_dpp v60, v60, v60 row_ror:8 row_mask:0xf bank_mask:0xf
v_add_f32_dpp v61, v61, v61 row_ror:8 row_mask:0xf bank_mask:0xf
v_add_f32_dpp v62, v62, v62 row_ror:8 row_mask:0xf bank_mask:0xf
v_add_f32_dpp v63, v63, v63 row_ror:8 row_mask:0xf bank_mask:0xf
v_add_f32_dpp v60, v60, v60 row_ror:4 row_mask:0xf bank_mask:0xf
v_add_f32_dpp v61, v61, v61 row_ror:4 row_mask:0xf bank_mask:0xf
v_add_f32_dpp v62, v62, v62 row_ror:4 row_mask:0xf bank_mask:0xf
v_add_f32_dpp v63, v63, v63 row_ror:4 row_mask:0xf bank_mask:0xf
v_add_f32_dpp v60, v60, v60 row_ror:2 row_mask:0xf bank_mask:0xf
v_add_f32_dpp v61, v61, v61 row_ror:2 row_mask:0xf bank_mask:0xf
v_add_f32_dpp v62, v62, v62 row_ror:2 row_mask:0xf bank_mask:0xf
v_add_f32_dpp v63, v63, v63 row_ror:2 row_mask:0xf bank_mask:0xf
v_add_f32_dpp v60, v60, v60 row_ror:1 row_mask:0xf bank_mask:0xf
v_add_f32_dpp v61, v61, v61 row_ror:1 row_mask:0xf bank_mask:0xf
v_add_f32_dpp v62, v62, v62 row_ror:1 row_mask:0xf bank_mask:0xf
v_add_f32_dpp v63, v63, v63 row_ror:1 row_mask:0xf bank_mask:0xf
v_cmp_eq_u32 vcc, 14, v2
s_nop 1
v_cndmask_b32 v200, v200, v60, vcc
v_cndmask_b32 v201, v201, v61, vcc
v_cmp_eq_u32 vcc, 15, v2
s_nop 1
v_cndmask_b32 v200, v200, v62, vcc
v_cndmask_b32 v201, v201, v63, vcc
v_cvt_pk_bf16_f32 v200, v200, v200
v_cvt_pk_bf16_f32 v201, v201, v201
s_lshl_b32 s62, s32, 10
s_lshl_b32 s63, s34, 7
s_add_u32 s62, s62, s63
s_add_u32 s62, s62, 0x0
v_lshl_add_u32 v192, v1, 1, s62
buffer_store_short v200, v192, s[52:55], 0 offen sc1
s_mov_b32 s62, 32768
buffer_store_short v201, v192, s[52:55], s62 offen sc1
s_lshl_b32 s62, s32, 8
s_add_u32 s62, s62, 0x1a000
v_lshl_add_u32 v192, v1, 2, s62
v_mov_b32 v193, s88
s_waitcnt vmcnt(0)
s_barrier
s_cmp_lg_u32 s34, 0
s_cbranch_scc1 L_sig_Wq
s_mov_b32 exec_hi, 0
buffer_store_dword v193, v192, s[52:55], 0 offen sc1
s_mov_b64 exec, -1
L_sig_Wq:
s_lshl_b32 s60, s89, 8
s_sub_u32 s61, 0x400000, s60
s_add_u32 s40, s22, s60
s_addc_u32 s41, s23, 0
s_and_b32 s41, s41, 0xffff
s_mov_b32 s42, s61
s_mov_b32 s43, 0x20000
s_lshl_b32 s60, s89, 17
s_mov_b32 s61, 0x20000
s_add_u32 s44, s24, s60
s_addc_u32 s45, s25, 0
s_and_b32 s45, s45, 0xffff
s_mov_b32 s46, s61
s_mov_b32 s47, 0x20000
v_lshlrev_b32 v10, 12, v3
v_lshl_add_u32 v10, v2, 4, v10
s_lshl_b32 s62, s34, 14
v_add_u32 v10, s62, v10
s_waitcnt vmcnt(2)
s_mov_b32 s62, 0
buffer_load_dwordx4 v[64:67], v9, s[40:43], s62 offen nt
s_waitcnt vmcnt(2)
s_mov_b32 s62, 8192
buffer_load_dwordx4 v[68:71], v9, s[40:43], s62 offen nt
s_waitcnt vmcnt(2)
s_mov_b32 s62, 16384
buffer_load_dwordx4 v[72:75], v9, s[40:43], s62 offen nt
s_waitcnt vmcnt(2)
s_mov_b32 s62, 24576
buffer_load_dwordx4 v[76:79], v9, s[40:43], s62 offen nt
s_waitcnt vmcnt(2)
s_mov_b32 s62, 32768
buffer_load_dwordx4 v[80:83], v9, s[40:43], s62 offen nt
s_waitcnt vmcnt(2)
s_mov_b32 s62, 40960
buffer_load_dwordx4 v[84:87], v9, s[40:43], s62 offen nt
s_waitcnt vmcnt(2)
s_mov_b32 s62, 49152
buffer_load_dwordx4 v[88:91], v9, s[40:43], s62 offen nt
s_waitcnt vmcnt(2)
s_mov_b32 s62, 57344
buffer_load_dwordx4 v[92:95], v9, s[40:43], s62 offen nt
s_waitcnt vmcnt(2)
s_mov_b32 s62, 65536
buffer_load_dwordx4 v[96:99], v9, s[40:43], s62 offen nt
s_waitcnt vmcnt(2)
s_mov_b32 s62, 73728
buffer_load_dwordx4 v[100:103], v9, s[40:43], s62 offen nt
s_waitcnt vmcnt(2)
s_mov_b32 s62, 81920
buffer_load_dwordx4 v[104:107], v9, s[40:43], s62 offen nt
s_waitcnt vmcnt(2)
s_mov_b32 s62, 90112
buffer_load_dwordx4 v[108:111], v9, s[40:43], s62 offen nt
s_waitcnt vmcnt(2)
s_mov_b32 s62, 98304
buffer_load_dwordx4 v[112:115], v9, s[40:43], s62 offen nt
s_waitcnt vmcnt(2)
s_mov_b32 s62, 106496
buffer_load_dwordx4 v[116:119], v9, s[40:43], s62 offen nt
s_waitcnt vmcnt(2)
s_mov_b32 s62, 114688
buffer_load_dwordx4 v[120:123], v9, s[40:43], s62 offen nt
s_waitcnt vmcnt(2)
s_mov_b32 s62, 122880
buffer_load_dwordx4 v[124:127], v9, s[40:43], s62 offen nt
s_waitcnt vmcnt(2)
buffer_load_dwordx4 v[128:131], v10, s[44:47], 0 offen offset:0 nt
s_waitcnt vmcnt(2)
buffer_load_dwordx4 v[132:135], v10, s[44:47], 0 offen offset:256 nt
s_waitcnt vmcnt(2)
buffer_load_dwordx4 v[136:139], v10, s[44:47], 0 offen offset:512 nt
s_waitcnt vmcnt(2)
buffer_load_dwordx4 v[140:143], v10, s[44:47], 0 offen offset:768 nt
s_waitcnt vmcnt(2)
buffer_load_dwordx4 v[144:147], v10, s[44:47], 0 offen offset:1024 nt
s_waitcnt vmcnt(2)
buffer_load_dwordx4 v[148:151], v10, s[44:47], 0 offen offset:1280 nt
s_waitcnt vmcnt(2)
buffer_load_dwordx4 v[152:155], v10, s[44:47], 0 offen offset:1536 nt
s_waitcnt vmcnt(2)
buffer_load_dwordx4 v[156:159], v10, s[44:47], 0 offen offset:1792 nt
s_waitcnt vmcnt(2)
buffer_load_dwordx4 v[160:163], v10, s[44:47], 0 offen offset:2048 nt
s_waitcnt vmcnt(2)
buffer_load_dwordx4 v[164:167], v10, s[44:47], 0 offen offset:2304 nt
s_waitcnt vmcnt(2)
buffer_load_dwordx4 v[168:171], v10, s[44:47], 0 offen offset:2560 nt
s_waitcnt vmcnt(2)
buffer_load_dwordx4 v[172:175], v10, s[44:47], 0 offen offset:2816 nt
s_waitcnt vmcnt(2)
buffer_load_dwordx4 v[176:179], v10, s[44:47], 0 offen offset:3072 nt
s_waitcnt vmcnt(2)
buffer_load_dwordx4 v[180:183], v10, s[44:47], 0 offen offset:3328 nt
s_waitcnt vmcnt(2)
buffer_load_dwordx4 v[184:187], v10, s[44:47], 0 offen offset:3584 nt
s_waitcnt vmcnt(2)
buffer_load_dwordx4 v[188:191], v10, s[44:47], 0 offen offset:3840 nt
s_cmp_lg_u32 s34, 7
s_cbranch_scc1 L_W_nogm
s_cmp_ge_u32 s32, 8
s_cbranch_scc1 L_W_nogm
s_and_b32 s63, s32, 7
s_mul_i32 s63, s63, 0x100
s_add_u32 s63, s63, 0xc0000
s_add_u32 s56, s30, s63
s_addc_u32 s57, s31, 0
s_mov_b32 s64, 0
s_mov_b32 s59, 0
s_mov_b32 s58, 0
s_lshl_b32 s62, s32, 12
s_add_u32 s62, s62, 0xd0000
v_lshl_add_u32 v204, v1, 4, s62
v_lshrrev_b32 v205, 2, v1
s_mov_b32 s62, 0xd0000
v_lshl_add_u32 v205, v205, 12, s62
v_and_b32 v206, 3, v1
v_lshlrev_b32 v208, 2, v1
v_mov_b32 v211, 0
L_gm_W:
s_mov_b32 exec_lo, -1
s_mov_b32 exec_hi, 0
v_add_u32 v207, s58, v206
v_and_b32 v207, 15, v207
v_lshl_add_u32 v207, v207, 8, v205
global_load_dword v210, v207, s[30:31] sc1
s_mov_b64 exec, 0x1ffffff
global_load_dword v209, v208, s[56:57] nt
s_waitcnt vmcnt(0)
v_subrev_u32 v209, s88, v209
s_mov_b64 exec, 0xffffff
v_cmp_le_u32 vcc, 0x400, v209
v_readlane_b32 s62, v209, 24
v_add_u32_dpp v209, v209, v209 row_shr:1 row_mask:0xf bank_mask:0xf bound_ctrl:0
s_nop 1
v_add_u32_dpp v209, v209, v209 row_shr:2 row_mask:0xf bank_mask:0xf bound_ctrl:0
s_nop 1
v_add_u32_dpp v209, v209, v209 row_shr:4 row_mask:0xf bank_mask:0xf bound_ctrl:0
s_nop 1
v_add_u32_dpp v209, v209, v209 row_shr:8 row_mask:0xf bank_mask:0xf bound_ctrl:0
s_nop 0
v_readlane_b32 s61, v209, 15
v_readlane_b32 s63, v209, 23
s_add_u32 s61, s61, s63
s_mov_b64 exec, 0xff
s_cbranch_vccnz L_gm_W_next
s_add_u32 s63, s61, s88
v_mov_b32 v200, s63
v_mov_b32 v201, s63
v_mov_b32 v202, s63
v_mov_b32 v203, s63
s_lshr_b32 s58, s61, 9
s_and_b32 s63, s58, 15
s_lshl_b32 s63, s63, 8
v_add_u32 v207, s63, v204
s_sub_u32 s58, s58, 2
global_store_dwordx4 v207, v[200:203], s[30:31] sc1
s_mul_i32 s63, s61, 0
s_mul_i32 s65, s59, 8
s_add_u32 s65, s65, s63
s_cmp_eq_u32 s59, 0
s_mov_b32 s59, s61
s_cbranch_scc1 L_gm_W_next
s_mov_b32 exec_lo, -1
v_subrev_u32 v210, s88, v210
v_cmp_gt_u32 vcc, 0x8000, v210
s_nop 1
v_cndmask_b32 v210, 0, v210, vcc
v_max_u32 v211, v211, v210
s_nop 1
v_max_u32_dpp v211, v211, v211 quad_perm:[1,0,3,2] row_mask:0xf bank_mask:0xf
s_nop 1
v_max_u32_dpp v211, v211, v211 quad_perm:[2,3,0,1] row_mask:0xf bank_mask:0xf
v_cmp_eq_u32 vcc, 0, v211
s_nop 0
v_add_u32_dpp v210, v211, v211 row_shr:4 row_mask:0xf bank_mask:0xf bound_ctrl:0
s_nop 1
v_add_u32_dpp v210, v210, v210 row_shr:8 row_mask:0xf bank_mask:0xf bound_ctrl:0
s_cbranch_vccnz L_gm_W_next
s_nop 0
v_readlane_b32 s63, v210, 15
v_readlane_b32 s62, v210, 31
s_add_u32 s63, s63, s62
s_sub_u32 s63, s63, s65
s_ashr_i32 s63, s63, 3
s_add_u32 s63, s63, 0x4000
s_add_u32 s63, s63, s88
s_mov_b64 exec, 0x1000000
v_mov_b32 v212, s63
global_store_dword v208, v212, s[56:57]
L_gm_W_next:
ds_read_b32 v209, v8 offset:8704
s_waitcnt lgkmcnt(0)
v_readfirstlane_b32 s63, v209
s_cmp_eq_u32 s63, s88
s_cbranch_scc1 L_gm_W_x
s_add_u32 s64, s64, 1
s_cmp_lt_u32 s64, 128
s_cbranch_scc1 L_gm_W
L_gm_W_x:
s_mov_b64 exec, -1
L_W_nogm:
s_cmp_lg_u32 s34, 6
s_cbranch_scc1 L_W_noas
s_and_b32 s63, s32, 7
s_mul_i32 s63, s63, 0x100
s_add_u32 s63, s63, 0xc0000
s_add_u32 s56, s30, s63
s_addc_u32 s57, s31, 0
s_lshl_b32 s62, s89, 21
s_sub_u32 s63, 0x8000000, s62
s_add_u32 s68, s6, s62
s_addc_u32 s69, s7, 0
s_and_b32 s69, s69, 0xffff
s_mov_b32 s70, s63
s_mov_b32 s71, 0x20000
s_add_u32 s72, s8, s62
s_addc_u32 s73, s9, 0
s_and_b32 s73, s73, 0xffff
s_mov_b32 s74, s63
s_mov_b32 s75, 0x20000
s_mov_b64 s[76:77], s[68:69]
s_mov_b64 s[78:79], s[70:71]
s_lshr_b32 s62, s32, 3
s_mul_i32 s62, s62, 6
s_sub_u32 s62, s62, 32
v_add_u32 v208, s62, v1
v_cmp_gt_u32 vcc, 32, v1
v_lshlrev_b32 v205, 7, v1
v_add_u32 v206, 0x4000000, v205
v_cndmask_b32 v200, v208, v1, vcc
v_lshlrev_b32 v200, 2, v200
v_mov_b32 v204, 0
s_mov_b32 s64, 0
L_as_W:
s_mov_b64 exec, 0x1ffffff
s_mov_b32 exec_hi, 0x3f
global_load_dword v201, v200, s[56:57] nt
s_waitcnt vmcnt(0)
v_subrev_u32 v201, s88, v201
s_mov_b64 exec, 0xffffff
v_cmp_le_u32 vcc, 0x400, v201
v_readlane_b32 s62, v201, 24
v_add_u32_dpp v201, v201, v201 row_shr:1 row_mask:0xf bank_mask:0xf bound_ctrl:0
s_nop 1
v_add_u32_dpp v201, v201, v201 row_shr:2 row_mask:0xf bank_mask:0xf bound_ctrl:0
s_nop 1
v_add_u32_dpp v201, v201, v201 row_shr:4 row_mask:0xf bank_mask:0xf bound_ctrl:0
s_nop 1
v_add_u32_dpp v201, v201, v201 row_shr:8 row_mask:0xf bank_mask:0xf bound_ctrl:0
s_nop 0
v_readlane_b32 s61, v201, 15
v_readlane_b32 s63, v201, 23
s_add_u32 s61, s61, s63
s_cbranch_vccnz L_as_W_idle
s_sub_u32 s61, s61, 120
s_mov_b32 exec_lo, 0
s_mov_b32 exec_hi, 0x3f
v_cmp_gt_u32 vcc, 280, v201
v_add_u32 v202, 56, v201
s_nop 0
v_cndmask_b32 v208, 0, 8, vcc
v_add_u32 v202, v202, v208
v_lshrrev_b32 v202, 4, v202
v_sub_u32 v208, v202, v204
v_cmp_gt_i32 vcc, 4, v208
v_cmp_le_i32 s[66:67], 2, v208
s_nop 0
v_cndmask_b32 v203, 0, 7, vcc
v_cmp_ge_u32 vcc, 41, v202
v_add_u32 v203, v203, v201
v_lshl_add_u32 v203, v203, 6, v1
s_and_b64 vcc, vcc, s[66:67]
v_cndmask_b32 v203, -1, v203, vcc
s_nop 1
v_min_u32_dpp v203, v203, v203 row_shr:1 row_mask:0xf bank_mask:0xf
s_nop 1
v_min_u32_dpp v203, v203, v203 row_shr:2 row_mask:0xf bank_mask:0xf
s_nop 1
v_min_u32_dpp v203, v203, v203 row_shr:4 row_mask:0xf bank_mask:0xf
s_nop 0
v_readlane_b32 s63, v203, 37
s_lshr_b32 s65, s63, 6
s_and_b32 s63, s63, 63
s_mul_i32 s65, s65, 24
s_cmp_ge_i32 s65, s61
s_cbranch_scc1 L_as_W_idle
v_readlane_b32 s65, v202, s63
s_mov_b32 m0, s63
s_mov_b64 exec, -1
s_cmp_lt_u32 s65, 21
s_cselect_b64 s[76:77], s[68:69], s[72:73]
v_writelane_b32 v204, s65, m0
s_cselect_b32 s66, 0, 21
s_sub_u32 s65, s65, s66
s_mul_i32 s65, s65, 0x18000
s_and_b32 s63, s63, 7
s_lshl_b32 s63, s63, 14
s_add_u32 s65, s65, s63
s_add_u32 s66, s65, 0x2000
buffer_load_dword v207, v205, s[76:79], s65 offen
buffer_load_dword v207, v205, s[76:79], s66 offen
buffer_load_dword v207, v206, s[76:79], s65 offen
buffer_load_dword v207, v206, s[76:79], s66 offen
s_waitcnt vmcnt(1)
s_branch L_as_W_next
L_as_W_idle:
s_sleep 4
L_as_W_next:
s_mov_b64 exec, 1
ds_read_b32 v208, v8 offset:8704
s_waitcnt lgkmcnt(0)
v_readfirstlane_b32 s63, v208
s_cmp_eq_u32 s63, s88
s_cbranch_scc1 L_as_W_x
s_add_u32 s64, s64, 1
s_cmp_lt_u32 s64, 96
s_cbranch_scc1 L_as_W
L_as_W_x:
s_mov_b64 exec, -1
s_waitcnt vmcnt(0)
L_W_noas:
s_cmp_lg_u32 s34, 0
s_cbranch_scc1 L_wc_Wc
s_lshl_b32 s62, s32, 4
s_add_u32 s62, s62, 0x10000
v_and_b32 v193, 31, v1
v_lshl_add_u32 v192, v193, 9, s62
s_lshl_b64 exec, 1, s32
s_mov_b32 s64, 0
L_tp_Wc0:
buffer_load_dwordx4 v[196:199], v192, s[52:55], 0 offen sc1
s_waitcnt vmcnt(0)
v_cmp_ne_u32 s[62:63], s88, v197
v_cmp_ne_u32 vcc, s88, v199
s_add_u32 s64, s64, 1
s_nop 0
s_or_b64 vcc, vcc, s[62:63]
s_cbranch_scc0 L_tp_Wc0_ok
s_sleep 32
s_cmp_lt_u32 s64, 65536
s_cbranch_scc1 L_tp_Wc0
L_tp_Wc0_ok:
s_mov_b32 exec_lo, -1
s_mov_b32 exec_hi, 0
s_mov_b32 s64, 0
L_tp_Wc:
buffer_load_dwordx4 v[196:199], v192, s[52:55], 0 offen sc1
s_waitcnt vmcnt(0)
v_cmp_ne_u32 s[62:63], s88, v197
v_cmp_ne_u32 vcc, s88, v199
s_add_u32 s64, s64, 1
s_nop 0
s_or_b64 vcc, vcc, s[62:63]
s_cbranch_scc0 L_tp_Wc_ok
s_mov_b64 exec, vcc
s_sleep 8
s_cmp_lt_u32 s64, 65536
s_cbranch_scc1 L_tp_Wc
L_tp_Wc_ok:
s_mov_b32 exec_lo, -1
s_mov_b32 exec_hi, 0
v_lshlrev_b32 v193, 3, v193
v_mov_b32 v197, v198
ds_write_b64 v193, v[196:197] offset:8192
v_mov_b32 v199, s88
ds_write_b32 v8, v199 offset:8704
s_mov_b64 exec, -1
s_waitcnt lgkmcnt(0)
L_wc_Wc:
s_barrier
s_lshr_b32 s35, s34, 2
s_and_b32 s36, s34, 3
s_lshl_b32 s62, s35, 5
s_add_u32 s62, s62, s32
s_lshl_b32 s63, s62, 7
s_add_u32 s63, s63, 0x10000
v_lshl_add_u32 v192, v2, 3, s63
s_lshl_b32 s63, s35, 7
v_lshl_add_u32 v192, v2, 3, s63
ds_read_b64 v[194:195], v192 offset:8192
s_lshl_b32 s63, s62, 14
s_add_u32 s63, s63, 0x200000
s_lshl_b32 s64, s36, 12
s_add_u32 s63, s63, s64
v_lshl_add_u32 v193, v1, 4, s63
buffer_load_dwordx4 v[200:203], v193, s[52:55], 0 offen offset:0 sc1
buffer_load_dwordx4 v[204:207], v193, s[52:55], 0 offen offset:1024 sc1
buffer_load_dwordx4 v[208:211], v193, s[52:55], 0 offen offset:2048 sc1
buffer_load_dwordx4 v[212:215], v193, s[52:55], 0 offen offset:3072 sc1
s_waitcnt vmcnt(4) lgkmcnt(0)
v_mov_b32 v196, v194
s_nop 1
v_max_f32_dpp v196, v196, v196 row_ror:8 row_mask:0xf bank_mask:0xf
s_nop 1
v_max_f32_dpp v196, v196, v196 row_ror:4 row_mask:0xf bank_mask:0xf
s_nop 1
v_max_f32_dpp v196, v196, v196 row_ror:2 row_mask:0xf bank_mask:0xf
s_nop 1
v_max_f32_dpp v196, v196, v196 row_ror:1 row_mask:0xf bank_mask:0xf
v_sub_f32 v197, v194, v196
v_exp_f32 v197, v197
s_nop 0
v_mul_f32 v195, v195, v197
s_nop 1
v_add_f32_dpp v195, v195, v195 row_ror:8 row_mask:0xf bank_mask:0xf
s_nop 1
v_add_f32_dpp v195, v195, v195 row_ror:4 row_mask:0xf bank_mask:0xf
s_nop 1
v_add_f32_dpp v195, v195, v195 row_ror:2 row_mask:0xf bank_mask:0xf
s_nop 1
v_add_f32_dpp v195, v195, v195 row_ror:1 row_mask:0xf bank_mask:0xf
v_rcp_f32 v195, v195
s_nop 0
v_mul_f32 v197, v197, v195
s_lshl_b32 s64, s36, 2
s_add_u32 s65, s64, 0
v_readlane_b32 s66, v197, s65
s_add_u32 s65, s64, 1
v_readlane_b32 s67, v197, s65
s_add_u32 s65, s64, 2
v_readlane_b32 s68, v197, s65
s_add_u32 s65, s64, 3
v_readlane_b32 s69, v197, s65
s_waitcnt vmcnt(3)
v_lshlrev_b32 v216, 16, v200
v_and_b32 v217, 0xffff0000, v200
v_lshlrev_b32 v218, 16, v201
v_and_b32 v219, 0xffff0000, v201
v_lshlrev_b32 v220, 16, v202
v_and_b32 v221, 0xffff0000, v202
v_lshlrev_b32 v222, 16, v203
v_and_b32 v223, 0xffff0000, v203
v_mul_f32 v232, s66, v216
v_mul_f32 v233, s66, v217
v_mul_f32 v234, s66, v218
v_mul_f32 v235, s66, v219
v_mul_f32 v236, s66, v220
v_mul_f32 v237, s66, v221
v_mul_f32 v238, s66, v222
v_mul_f32 v239, s66, v223
s_waitcnt vmcnt(2)
v_lshlrev_b32 v216, 16, v204
v_and_b32 v217, 0xffff0000, v204
v_lshlrev_b32 v218, 16, v205
v_and_b32 v219, 0xffff0000, v205
v_lshlrev_b32 v220, 16, v206
v_and_b32 v221, 0xffff0000, v206
v_lshlrev_b32 v222, 16, v207
v_and_b32 v223, 0xffff0000, v207
v_fma_f32 v232, v216, s67, v232
v_fma_f32 v233, v217, s67, v233
v_fma_f32 v234, v218, s67, v234
v_fma_f32 v235, v219, s67, v235
v_fma_f32 v236, v220, s67, v236
v_fma_f32 v237, v221, s67, v237
v_fma_f32 v238, v222, s67, v238
v_fma_f32 v239, v223, s67, v239
s_waitcnt vmcnt(1)
v_lshlrev_b32 v216, 16, v208
v_and_b32 v217, 0xffff0000, v208
v_lshlrev_b32 v218, 16, v209
v_and_b32 v219, 0xffff0000, v209
v_lshlrev_b32 v220, 16, v210
v_and_b32 v221, 0xffff0000, v210
v_lshlrev_b32 v222, 16, v211
v_and_b32 v223, 0xffff0000, v211
v_fma_f32 v232, v216, s68, v232
v_fma_f32 v233, v217, s68, v233
v_fma_f32 v234, v218, s68, v234
v_fma_f32 v235, v219, s68, v235
v_fma_f32 v236, v220, s68, v236
v_fma_f32 v237, v221, s68, v237
v_fma_f32 v238, v222, s68, v238
v_fma_f32 v239, v223, s68, v239
s_waitcnt vmcnt(0)
v_lshlrev_b32 v216, 16, v212
v_and_b32 v217, 0xffff0000, v212
v_lshlrev_b32 v218, 16, v213
v_and_b32 v219, 0xffff0000, v213
v_lshlrev_b32 v220, 16, v214
v_and_b32 v221, 0xffff0000, v214
v_lshlrev_b32 v222, 16, v215
v_and_b32 v223, 0xffff0000, v215
v_fma_f32 v232, v216, s69, v232
v_fma_f32 v233, v217, s69, v233
v_fma_f32 v234, v218, s69, v234
v_fma_f32 v235, v219, s69, v235
v_fma_f32 v236, v220, s69, v236
v_fma_f32 v237, v221, s69, v237
v_fma_f32 v238, v222, s69, v238
v_fma_f32 v239, v223, s69, v239
s_lshl_b32 s62, s34, 11
v_lshl_add_u32 v192, v1, 5, s62
ds_write_b128 v192, v[232:235] offset:18432
ds_write_b128 v192, v[236:239] offset:18448
s_waitcnt lgkmcnt(0)
s_barrier
v_lshrrev_b32 v192, 3, v2
v_lshlrev_b32 v192, 13, v192
v_lshl_add_u32 v192, v3, 6, v192
s_lshl_b32 s62, s34, 8
v_add_u32 v192, s62, v192
ds_read_b128 v[200:203], v192 offset:18432
ds_read_b128 v[204:207], v192 offset:18448
ds_read_b128 v[208:211], v192 offset:18464
ds_read_b128 v[212:215], v192 offset:18480
ds_read_b128 v[216:219], v192 offset:20480
ds_read_b128 v[220:223], v192 offset:20496
ds_read_b128 v[224:227], v192 offset:20512
ds_read_b128 v[228:231], v192 offset:20528
s_waitcnt lgkmcnt(0)
v_add_f32 v200, v200, v216
v_add_f32 v201, v201, v217
v_add_f32 v202, v202, v218
v_add_f32 v203, v203, v219
v_add_f32 v204, v204, v220
v_add_f32 v205, v205, v221
v_add_f32 v206, v206, v222
v_add_f32 v207, v207, v223
v_add_f32 v208, v208, v224
v_add_f32 v209, v209, v225
v_add_f32 v210, v210, v226
v_add_f32 v211, v211, v227
v_add_f32 v212, v212, v228
v_add_f32 v213, v213, v229
v_add_f32 v214, v214, v230
v_add_f32 v215, v215, v231
ds_read_b128 v[216:219], v192 offset:22528
ds_read_b128 v[220:223], v192 offset:22544
ds_read_b128 v[224:227], v192 offset:22560
ds_read_b128 v[228:231], v192 offset:22576
s_waitcnt lgkmcnt(0)
v_add_f32 v200, v200, v216
v_add_f32 v201, v201, v217
v_add_f32 v202, v202, v218
v_add_f32 v203, v203, v219
v_add_f32 v204, v204, v220
v_add_f32 v205, v205, v221
v_add_f32 v206, v206, v222
v_add_f32 v207, v207, v223
v_add_f32 v208, v208, v224
v_add_f32 v209, v209, v225
v_add_f32 v210, v210, v226
v_add_f32 v211, v211, v227
v_add_f32 v212, v212, v228
v_add_f32 v213, v213, v229
v_add_f32 v214, v214, v230
v_add_f32 v215, v215, v231
ds_read_b128 v[216:219], v192 offset:24576
ds_read_b128 v[220:223], v192 offset:24592
ds_read_b128 v[224:227], v192 offset:24608
ds_read_b128 v[228:231], v192 offset:24624
s_waitcnt lgkmcnt(0)
v_add_f32 v200, v200, v216
v_add_f32 v201, v201, v217
v_add_f32 v202, v202, v218
v_add_f32 v203, v203, v219
v_add_f32 v204, v204, v220
v_add_f32 v205, v205, v221
v_add_f32 v206, v206, v222
v_add_f32 v207, v207, v223
v_add_f32 v208, v208, v224
v_add_f32 v209, v209, v225
v_add_f32 v210, v210, v226
v_add_f32 v211, v211, v227
v_add_f32 v212, v212, v228
v_add_f32 v213, v213, v229
v_add_f32 v214, v214, v230
v_add_f32 v215, v215, v231
v_cvt_pk_bf16_f32 v12, v200, v201
v_cvt_pk_bf16_f32 v13, v202, v203
v_cvt_pk_bf16_f32 v14, v204, v205
v_cvt_pk_bf16_f32 v15, v206, v207
v_cvt_pk_bf16_f32 v16, v208, v209
v_cvt_pk_bf16_f32 v17, v210, v211
v_cvt_pk_bf16_f32 v18, v212, v213
v_cvt_pk_bf16_f32 v19, v214, v215
s_mov_b32 s60, 0x01000100
v_perm_b32 v192, v12, v12, s60
v_and_b32 v28, v192, v4
v_and_b32 v29, v192, v5
v_and_b32 v30, v192, v6
v_and_b32 v31, v192, v7
s_waitcnt vmcnt(63)
s_nop 0
v_mfma_f32_16x16x32_bf16 v[44:47], v[28:31], v[64:67], 0
s_mov_b32 s60, 0x03020302
v_perm_b32 v193, v12, v12, s60
v_and_b32 v32, v193, v4
v_and_b32 v33, v193, v5
v_and_b32 v34, v193, v6
v_and_b32 v35, v193, v7
s_waitcnt vmcnt(63)
s_nop 0
v_mfma_f32_16x16x32_bf16 v[44:47], v[32:35], v[68:71], v[44:47]
s_mov_b32 s60, 0x01000100
v_perm_b32 v192, v13, v13, s60
v_and_b32 v28, v192, v4
v_and_b32 v29, v192, v5
v_and_b32 v30, v192, v6
v_and_b32 v31, v192, v7
s_waitcnt vmcnt(63)
s_nop 0
v_mfma_f32_16x16x32_bf16 v[44:47], v[28:31], v[72:75], v[44:47]
s_mov_b32 s60, 0x03020302
v_perm_b32 v193, v13, v13, s60
v_and_b32 v32, v193, v4
v_and_b32 v33, v193, v5
v_and_b32 v34, v193, v6
v_and_b32 v35, v193, v7
s_waitcnt vmcnt(63)
s_nop 0
v_mfma_f32_16x16x32_bf16 v[44:47], v[32:35], v[76:79], v[44:47]
s_mov_b32 s60, 0x01000100
v_perm_b32 v192, v14, v14, s60
v_and_b32 v28, v192, v4
v_and_b32 v29, v192, v5
v_and_b32 v30, v192, v6
v_and_b32 v31, v192, v7
s_waitcnt vmcnt(63)
s_nop 0
v_mfma_f32_16x16x32_bf16 v[44:47], v[28:31], v[80:83], v[44:47]
s_mov_b32 s60, 0x03020302
v_perm_b32 v193, v14, v14, s60
v_and_b32 v32, v193, v4
v_and_b32 v33, v193, v5
v_and_b32 v34, v193, v6
v_and_b32 v35, v193, v7
s_waitcnt vmcnt(63)
s_nop 0
v_mfma_f32_16x16x32_bf16 v[44:47], v[32:35], v[84:87], v[44:47]
s_mov_b32 s60, 0x01000100
v_perm_b32 v192, v15, v15, s60
v_and_b32 v28, v192, v4
v_and_b32 v29, v192, v5
v_and_b32 v30, v192, v6
v_and_b32 v31, v192, v7
s_waitcnt vmcnt(63)
s_nop 0
v_mfma_f32_16x16x32_bf16 v[44:47], v[28:31], v[88:91], v[44:47]
s_mov_b32 s60, 0x03020302
v_perm_b32 v193, v15, v15, s60
v_and_b32 v32, v193, v4
v_and_b32 v33, v193, v5
v_and_b32 v34, v193, v6
v_and_b32 v35, v193, v7
s_waitcnt vmcnt(63)
s_nop 0
v_mfma_f32_16x16x32_bf16 v[44:47], v[32:35], v[92:95], v[44:47]
s_mov_b32 s60, 0x01000100
v_perm_b32 v192, v16, v16, s60
v_and_b32 v28, v192, v4
v_and_b32 v29, v192, v5
v_and_b32 v30, v192, v6
v_and_b32 v31, v192, v7
s_waitcnt vmcnt(63)
s_nop 0
v_mfma_f32_16x16x32_bf16 v[44:47], v[28:31], v[96:99], v[44:47]
s_mov_b32 s60, 0x03020302
v_perm_b32 v193, v16, v16, s60
v_and_b32 v32, v193, v4
v_and_b32 v33, v193, v5
v_and_b32 v34, v193, v6
v_and_b32 v35, v193, v7
s_waitcnt vmcnt(63)
s_nop 0
v_mfma_f32_16x16x32_bf16 v[44:47], v[32:35], v[100:103], v[44:47]
s_mov_b32 s60, 0x01000100
v_perm_b32 v192, v17, v17, s60
v_and_b32 v28, v192, v4
v_and_b32 v29, v192, v5
v_and_b32 v30, v192, v6
v_and_b32 v31, v192, v7
s_waitcnt vmcnt(63)
s_nop 0
v_mfma_f32_16x16x32_bf16 v[44:47], v[28:31], v[104:107], v[44:47]
s_mov_b32 s60, 0x03020302
v_perm_b32 v193, v17, v17, s60
v_and_b32 v32, v193, v4
v_and_b32 v33, v193, v5
v_and_b32 v34, v193, v6
v_and_b32 v35, v193, v7
s_waitcnt vmcnt(63)
s_nop 0
v_mfma_f32_16x16x32_bf16 v[44:47], v[32:35], v[108:111], v[44:47]
s_mov_b32 s60, 0x01000100
v_perm_b32 v192, v18, v18, s60
v_and_b32 v28, v192, v4
v_and_b32 v29, v192, v5
v_and_b32 v30, v192, v6
v_and_b32 v31, v192, v7
s_waitcnt vmcnt(63)
s_nop 0
v_mfma_f32_16x16x32_bf16 v[44:47], v[28:31], v[112:115], v[44:47]
s_mov_b32 s60, 0x03020302
v_perm_b32 v193, v18, v18, s60
v_and_b32 v32, v193, v4
v_and_b32 v33, v193, v5
v_and_b32 v34, v193, v6
v_and_b32 v35, v193, v7
s_waitcnt vmcnt(63)
s_nop 0
v_mfma_f32_16x16x32_bf16 v[44:47], v[32:35], v[116:119], v[44:47]
s_mov_b32 s60, 0x01000100
v_perm_b32 v192, v19, v19, s60
v_and_b32 v28, v192, v4
v_and_b32 v29, v192, v5
v_and_b32 v30, v192, v6
v_and_b32 v31, v192, v7
s_waitcnt vmcnt(63)
s_nop 0
v_mfma_f32_16x16x32_bf16 v[44:47], v[28:31], v[120:123], v[44:47]
s_mov_b32 s60, 0x03020302
v_perm_b32 v193, v19, v19, s60
v_and_b32 v32, v193, v4
v_and_b32 v33, v193, v5
v_and_b32 v34, v193, v6
v_and_b32 v35, v193, v7
s_waitcnt vmcnt(63)
s_nop 0
v_mfma_f32_16x16x32_bf16 v[44:47], v[32:35], v[124:127], v[44:47]
v_lshrrev_b32 v192, 1, v3
v_lshlrev_b32 v192, 9, v192
v_lshl_add_u32 v192, v2, 5, v192
v_and_b32 v193, 1, v3
v_lshl_add_u32 v192, v193, 4, v192
s_lshl_b32 s63, s34, 10
v_add_u32 v192, s63, v192
s_nop 1
s_nop 5
ds_write_b128 v192, v[44:47] offset:9216
s_waitcnt lgkmcnt(0)
s_barrier
v_lshrrev_b32 v192, 3, v2
v_lshlrev_b32 v192, 9, v192
v_lshl_add_u32 v192, v3, 4, v192
s_lshl_b32 s62, s34, 6
v_add_u32 v192, s62, v192
ds_read_b128 v[200:203], v192 offset:9216
ds_read_b128 v[204:207], v192 offset:10240
ds_read_b128 v[208:211], v192 offset:11264
ds_read_b128 v[212:215], v192 offset:12288
ds_read_b128 v[216:219], v192 offset:13312
ds_read_b128 v[220:223], v192 offset:14336
ds_read_b128 v[224:227], v192 offset:15360
ds_read_b128 v[228:231], v192 offset:16384
s_waitcnt lgkmcnt(6)
v_add_f32 v200, v200, v204
v_add_f32 v201, v201, v205
v_add_f32 v202, v202, v206
v_add_f32 v203, v203, v207
s_waitcnt lgkmcnt(5)
v_add_f32 v200, v200, v208
v_add_f32 v201, v201, v209
v_add_f32 v202, v202, v210
v_add_f32 v203, v203, v211
s_waitcnt lgkmcnt(4)
v_add_f32 v200, v200, v212
v_add_f32 v201, v201, v213
v_add_f32 v202, v202, v214
v_add_f32 v203, v203, v215
s_waitcnt lgkmcnt(3)
v_add_f32 v200, v200, v216
v_add_f32 v201, v201, v217
v_add_f32 v202, v202, v218
v_add_f32 v203, v203, v219
s_waitcnt lgkmcnt(2)
v_add_f32 v200, v200, v220
v_add_f32 v201, v201, v221
v_add_f32 v202, v202, v222
v_add_f32 v203, v203, v223
s_waitcnt lgkmcnt(1)
v_add_f32 v200, v200, v224
v_add_f32 v201, v201, v225
v_add_f32 v202, v202, v226
v_add_f32 v203, v203, v227
s_waitcnt lgkmcnt(0)
v_add_f32 v200, v200, v228
v_add_f32 v201, v201, v229
v_add_f32 v202, v202, v230
v_add_f32 v203, v203, v231
v_cvt_pk_bf16_f32 v60, v200, v200
v_cvt_pk_bf16_f32 v61, v201, v201
v_cvt_pk_bf16_f32 v62, v202, v202
v_cvt_pk_bf16_f32 v63, v203, v203
v_and_b32 v28, v60, v4
v_and_b32 v29, v60, v5
v_and_b32 v30, v60, v6
v_and_b32 v31, v60, v7
v_and_b32 v32, v61, v4
v_and_b32 v33, v61, v5
v_and_b32 v34, v61, v6
v_and_b32 v35, v61, v7
v_and_b32 v36, v62, v4
v_and_b32 v37, v62, v5
v_and_b32 v38, v62, v6
v_and_b32 v39, v62, v7
v_and_b32 v40, v63, v4
v_and_b32 v41, v63, v5
v_and_b32 v42, v63, v6
v_and_b32 v43, v63, v7
s_nop 1
v_mfma_f32_16x16x32_bf16 v[44:47], v[28:31], v[128:131], 0
v_mfma_f32_16x16x32_bf16 v[48:51], v[28:31], v[132:135], 0
v_mfma_f32_16x16x32_bf16 v[52:55], v[28:31], v[136:139], 0
v_mfma_f32_16x16x32_bf16 v[56:59], v[28:31], v[140:143], 0
v_mfma_f32_16x16x32_bf16 v[44:47], v[32:35], v[144:147], v[44:47]
v_mfma_f32_16x16x32_bf16 v[48:51], v[32:35], v[148:151], v[48:51]
v_mfma_f32_16x16x32_bf16 v[52:55], v[32:35], v[152:155], v[52:55]
v_mfma_f32_16x16x32_bf16 v[56:59], v[32:35], v[156:159], v[56:59]
v_mfma_f32_16x16x32_bf16 v[44:47], v[36:39], v[160:163], v[44:47]
v_mfma_f32_16x16x32_bf16 v[48:51], v[36:39], v[164:167], v[48:51]
v_mfma_f32_16x16x32_bf16 v[52:55], v[36:39], v[168:171], v[52:55]
v_mfma_f32_16x16x32_bf16 v[56:59], v[36:39], v[172:175], v[56:59]
v_mfma_f32_16x16x32_bf16 v[44:47], v[40:43], v[176:179], v[44:47]
v_mfma_f32_16x16x32_bf16 v[48:51], v[40:43], v[180:183], v[48:51]
v_mfma_f32_16x16x32_bf16 v[52:55], v[40:43], v[184:187], v[52:55]
v_mfma_f32_16x16x32_bf16 v[56:59], v[40:43], v[188:191], v[56:59]
v_lshrrev_b32 v192, 1, v3
v_lshlrev_b32 v192, 11, v192
v_lshl_add_u32 v192, v2, 5, v192
v_and_b32 v193, 1, v3
v_lshl_add_u32 v192, v193, 4, v192
s_lshl_b32 s63, s34, 12
v_add_u32 v192, s63, v192
s_nop 1
ds_write_b128 v192, v[44:47] offset:18432
ds_write_b128 v192, v[48:51] offset:18944
ds_write_b128 v192, v[52:55] offset:19456
s_nop 5
ds_write_b128 v192, v[56:59] offset:19968
s_waitcnt lgkmcnt(0)
s_barrier
s_cmp_ge_u32 s34, 4
s_cbranch_scc1 L_W_yskip
v_lshlrev_b32 v192, 4, v0
ds_read_b128 v[200:203], v192 offset:18432
ds_read_b128 v[204:207], v192 offset:22528
ds_read_b128 v[208:211], v192 offset:26624
ds_read_b128 v[212:215], v192 offset:30720
ds_read_b128 v[216:219], v192 offset:34816
ds_read_b128 v[220:223], v192 offset:38912
ds_read_b128 v[224:227], v192 offset:43008
ds_read_b128 v[228:231], v192 offset:47104
v_lshrrev_b32 v193, 7, v0
v_lshlrev_b32 v193, 16, v193
v_and_b32 v194, 127, v0
v_lshl_add_u32 v193, v194, 4, v193
s_lshl_b32 s63, s32, 11
s_add_u32 s63, s63, 0x20000
v_add_u32 v193, s63, v193
s_waitcnt lgkmcnt(6)
v_add_f32 v200, v200, v204
v_add_f32 v201, v201, v205
v_add_f32 v202, v202, v206
v_add_f32 v203, v203, v207
s_waitcnt lgkmcnt(5)
v_add_f32 v200, v200, v208
v_add_f32 v201, v201, v209
v_add_f32 v202, v202, v210
v_add_f32 v203, v203, v211
s_waitcnt lgkmcnt(4)
v_add_f32 v200, v200, v212
v_add_f32 v201, v201, v213
v_add_f32 v202, v202, v214
v_add_f32 v203, v203, v215
s_waitcnt lgkmcnt(3)
v_add_f32 v200, v200, v216
v_add_f32 v201, v201, v217
v_add_f32 v202, v202, v218
v_add_f32 v203, v203, v219
s_waitcnt lgkmcnt(2)
v_add_f32 v200, v200, v220
v_add_f32 v201, v201, v221
v_add_f32 v202, v202, v222
v_add_f32 v203, v203, v223
s_waitcnt lgkmcnt(1)
v_add_f32 v200, v200, v224
v_add_f32 v201, v201, v225
v_add_f32 v202, v202, v226
v_add_f32 v203, v203, v227
s_waitcnt lgkmcnt(0)
v_add_f32 v200, v200, v228
v_add_f32 v201, v201, v229
v_add_f32 v202, v202, v230
v_add_f32 v203, v203, v231
v_cvt_pk_bf16_f32 v200, v200, v201
v_cvt_pk_bf16_f32 v202, v202, v203
v_mov_b32 v201, s88
v_mov_b32 v203, s88
buffer_store_dwordx4 v[200:203], v193, s[52:55], 0 offen sc1
L_W_yskip:
s_lshr_b32 s35, s32, 4
s_and_b32 s36, s32, 15
v_mov_b32 v232, 0
v_mov_b32 v233, 0
v_mov_b32 v234, 0
v_mov_b32 v235, 0
s_cmp_ge_u32 s34, 4
s_cbranch_scc1 L_W_bskip
v_lshrrev_b32 v192, 3, v0
v_lshlrev_b32 v192, 11, v192
v_and_b32 v193, 7, v0
v_lshl_add_u32 v192, v193, 4, v192
s_lshl_b32 s62, s35, 16
s_lshl_b32 s63, s36, 7
s_add_u32 s62, s62, s63
s_add_u32 s62, s62, 0x20000
v_add_u32 v192, s62, v192
s_mov_b32 s64, 0
L_tp_Wyb:
buffer_load_dwordx4 v[232:235], v192, s[52:55], 0 offen sc1
s_waitcnt vmcnt(0)
v_cmp_ne_u32 s[62:63], s88, v233
v_cmp_ne_u32 vcc, s88, v235
s_add_u32 s64, s64, 1
s_nop 0
s_or_b64 vcc, vcc, s[62:63]
s_cbranch_scc0 L_tp_Wyb_ok
s_mov_b64 exec, vcc
s_sleep 8
s_cmp_lt_u32 s64, 65536
s_cbranch_scc1 L_tp_Wyb
L_tp_Wyb_ok:
s_mov_b64 exec, -1
v_and_b32 v233, 0xffff0000, v232
v_lshlrev_b32 v232, 16, v232
v_and_b32 v235, 0xffff0000, v234
v_lshlrev_b32 v234, 16, v234
L_W_bskip:
v_and_b32 v192, 7, v1
v_lshl_add_u32 v240, v3, 3, v192
v_mul_u32_u24 v240, 48, v240
ds_write_b32 v240, v8 offset:32
s_lshr_b32 s62, s32, 4
s_lshl_b32 s62, s62, 11
s_bfe_u32 s63, s32, 0x20002
s_lshl_b32 s63, s63, 8
s_add_u32 s62, s62, s63
s_and_b32 s63, s32, 1
s_lshl_b32 s63, s63, 7
s_add_u32 s62, s62, s63
s_and_b32 s63, s32, 2
s_lshl_b32 s63, s63, 2
s_add_u32 s62, s62, s63
v_lshl_add_u32 v243, v192, 3, v3
v_lshl_add_u32 v243, v243, 1, s62
s_lshl_b32 s63, s34, 2
v_add_u32 v241, s63, v240
v_mov_b32 v242, 1
s_nop 1
v_add_f32_dpp v232, v232, v232 row_ror:8 row_mask:0xf bank_mask:0xf
v_add_f32_dpp v233, v233, v233 row_ror:8 row_mask:0xf bank_mask:0xf
v_add_f32_dpp v234, v234, v234 row_ror:8 row_mask:0xf bank_mask:0xf
v_add_f32_dpp v235, v235, v235 row_ror:8 row_mask:0xf bank_mask:0xf
v_mov_b32 v192, v232
v_mov_b32 v193, v233
v_mov_b32 v194, v234
v_mov_b32 v195, v235
s_nop 1
v_permlane16_swap_b32 v232, v192
v_permlane16_swap_b32 v233, v193
v_permlane16_swap_b32 v234, v194
v_permlane16_swap_b32 v235, v195
s_nop 0
v_add_f32 v232, v232, v192
v_add_f32 v233, v233, v193
v_add_f32 v234, v234, v194
v_add_f32 v235, v235, v195
v_mov_b32 v192, v232
v_mov_b32 v193, v233
v_mov_b32 v194, v234
v_mov_b32 v195, v235
s_nop 1
v_permlane32_swap_b32 v232, v192
v_permlane32_swap_b32 v233, v193
v_permlane32_swap_b32 v234, v194
v_permlane32_swap_b32 v235, v195
s_nop 0
v_add_f32 v232, v232, v192
v_add_f32 v233, v233, v193
v_add_f32 v234, v234, v194
v_add_f32 v235, v235, v195
v_lshlrev_b32 v192, 4, v1
s_lshl_b32 s63, s34, 7
v_add_u32 v192, s63, v192
s_mov_b64 exec, 0xff
ds_write_b128 v192, v[232:235] offset:17408
s_mov_b64 exec, -1
s_waitcnt lgkmcnt(0)
s_barrier
s_cmp_lg_u32 s34, 0
s_cbranch_scc1 L_Wb_fin
v_lshlrev_b32 v192, 2, v1
s_mov_b32 exec_hi, 0
ds_read_b32 v193, v192 offset:17408
ds_read_b32 v194, v192 offset:17536
ds_read_b32 v195, v192 offset:17664
ds_read_b32 v196, v192 offset:17792
s_waitcnt lgkmcnt(0)
v_add_f32 v193, v193, v194
v_add_f32 v193, v193, v195
v_add_f32 v193, v193, v196
v_cvt_pk_bf16_f32 v193, v193, v193
s_lshr_b32 s62, s32, 4
s_lshl_b32 s62, s62, 11
s_and_b32 s63, s32, 15
s_lshl_b32 s63, s63, 6
s_add_u32 s62, s62, s63
s_add_u32 s62, s62, 1024
v_lshl_add_u32 v192, v1, 1, s62
global_store_short v192, v193, s[26:27]
s_mov_b64 exec, -1
L_Wb_fin:
v_lshrrev_b32 v192, 3, v1
s_lshl_b32 s62, s35, 8
s_lshl_b32 s63, s34, 3
s_add_u32 s62, s62, s63
v_add_u32 v192, s62, v192
v_lshlrev_b32 v9, 4, v192
v_add_u32 v9, 0x14000, v9
v_and_b32 v9, 255, v192
s_lshl_b32 s63, s35, 4
s_add_u32 s63, s63, 0x50000
v_lshl_add_u32 v9, v9, 7, s63
v_lshlrev_b32 v10, 10, v192
v_and_b32 v193, 7, v1
v_lshl_add_u32 v10, v193, 3, v10
s_lshl_b32 s63, s36, 6
s_add_u32 s63, s63, 0x100000
v_add_u32 v10, s63, v10
v_mov_b32 v80, 0xff800000
v_mov_b32 v81, 0
v_mov_b32 v64, 0
v_mov_b32 v65, 0
v_mov_b32 v82, 0xff800000
v_mov_b32 v83, 0
v_mov_b32 v66, 0
v_mov_b32 v67, 0
v_mov_b32 v84, 0xff800000
v_mov_b32 v85, 0
v_mov_b32 v68, 0
v_mov_b32 v69, 0
v_mov_b32 v86, 0xff800000
v_mov_b32 v87, 0
v_mov_b32 v70, 0
v_mov_b32 v71, 0
s_mov_b32 s66, -1
s_mov_b32 s67, 0xffff
s_mov_b32 s68, -1
s_mov_b32 s69, 0xffff
s_mov_b32 s70, -1
s_mov_b32 s71, 0xffff
s_mov_b32 s72, -1
s_mov_b32 s73, 0xffff
s_mov_b32 s64, 0
s_mov_b64 exec, s[66:67]
L_W_stt:
s_mov_b32 s63, 0
buffer_load_dwordx4 v[96:99], v9, s[52:55], s63 offen sc1
s_mov_b32 s63, 8192
buffer_load_dwordx4 v[100:103], v9, s[52:55], s63 offen sc1
s_mov_b32 s63, 16384
buffer_load_dwordx4 v[104:107], v9, s[52:55], s63 offen sc1
s_mov_b32 s63, 24576
buffer_load_dwordx4 v[108:111], v9, s[52:55], s63 offen sc1
s_waitcnt vmcnt(0)
v_xor_b32 v97, s88, v97
v_xor_b32 v99, s88, v99
v_xor_b32 v101, s88, v101
v_xor_b32 v103, s88, v103
v_xor_b32 v105, s88, v105
v_xor_b32 v107, s88, v107
v_xor_b32 v109, s88, v109
v_xor_b32 v111, s88, v111
v_or3_b32 v192, v97, v99, v101
v_or3_b32 v192, v192, v103, v105
v_or3_b32 v192, v192, v107, v109
v_or_b32 v192, v192, v111
v_cmp_ne_u32 vcc, 0, v192
s_add_u32 s64, s64, 1
s_nop 0
s_cmp_eq_u64 vcc, 0
s_cbranch_scc1 L_W_stt_done
s_sleep 16
s_cmp_lt_u32 s64, 65536
s_cbranch_scc1 L_W_stt
L_W_stt_done:
v_mov_b32 v80, v96
v_mov_b32 v81, v98
v_mov_b32 v82, v100
v_mov_b32 v83, v102
v_mov_b32 v84, v104
v_mov_b32 v85, v106
v_mov_b32 v86, v108
v_mov_b32 v87, v110
s_mov_b64 exec, -1
v_mov_b32 v192, v80
v_mov_b32 v193, v82
v_mov_b32 v194, v84
v_mov_b32 v195, v86
s_nop 1
v_max_f32_dpp v192, v192, v192 row_ror:8 row_mask:0xf bank_mask:0xf
v_max_f32_dpp v193, v193, v193 row_ror:8 row_mask:0xf bank_mask:0xf
v_max_f32_dpp v194, v194, v194 row_ror:8 row_mask:0xf bank_mask:0xf
v_max_f32_dpp v195, v195, v195 row_ror:8 row_mask:0xf bank_mask:0xf
v_mov_b32 v196, v192
v_mov_b32 v197, v193
v_mov_b32 v198, v194
v_mov_b32 v199, v195
s_nop 1
v_permlane16_swap_b32 v192, v196
v_permlane16_swap_b32 v193, v197
v_permlane16_swap_b32 v194, v198
v_permlane16_swap_b32 v195, v199
s_nop 0
v_max_f32 v192, v192, v196
v_max_f32 v193, v193, v197
v_max_f32 v194, v194, v198
v_max_f32 v195, v195, v199
v_mov_b32 v196, v192
v_mov_b32 v197, v193
v_mov_b32 v198, v194
v_mov_b32 v199, v195
s_nop 1
v_permlane32_swap_b32 v192, v196
v_permlane32_swap_b32 v193, v197
v_permlane32_swap_b32 v194, v198
v_permlane32_swap_b32 v195, v199
s_nop 0
v_max_f32 v192, v192, v196
v_max_f32 v193, v193, v197
v_max_f32 v194, v194, v198
v_max_f32 v195, v195, v199
v_sub_f32 v192, v80, v192
v_sub_f32 v193, v82, v193
v_sub_f32 v194, v84, v194
v_sub_f32 v195, v86, v195
v_exp_f32 v192, v192
v_exp_f32 v193, v193
v_exp_f32 v194, v194
v_exp_f32 v195, v195
s_nop 0
v_mul_f32 v200, v81, v192
v_mul_f32 v201, v83, v193
v_mul_f32 v202, v85, v194
v_mul_f32 v203, v87, v195
s_nop 1
v_add_f32_dpp v200, v200, v200 row_ror:8 row_mask:0xf bank_mask:0xf
v_add_f32_dpp v201, v201, v201 row_ror:8 row_mask:0xf bank_mask:0xf
v_add_f32_dpp v202, v202, v202 row_ror:8 row_mask:0xf bank_mask:0xf
v_add_f32_dpp v203, v203, v203 row_ror:8 row_mask:0xf bank_mask:0xf
v_mov_b32 v196, v200
v_mov_b32 v197, v201
v_mov_b32 v198, v202
v_mov_b32 v199, v203
s_nop 1
v_permlane16_swap_b32 v200, v196
v_permlane16_swap_b32 v201, v197
v_permlane16_swap_b32 v202, v198
v_permlane16_swap_b32 v203, v199
s_nop 0
v_add_f32 v200, v200, v196
v_add_f32 v201, v201, v197
v_add_f32 v202, v202, v198
v_add_f32 v203, v203, v199
v_mov_b32 v196, v200
v_mov_b32 v197, v201
v_mov_b32 v198, v202
v_mov_b32 v199, v203
s_nop 1
v_permlane32_swap_b32 v200, v196
v_permlane32_swap_b32 v201, v197
v_permlane32_swap_b32 v202, v198
v_permlane32_swap_b32 v203, v199
s_nop 0
v_add_f32 v200, v200, v196
v_add_f32 v201, v201, v197
v_add_f32 v202, v202, v198
v_add_f32 v203, v203, v199
v_rcp_f32 v200, v200
v_rcp_f32 v201, v201
v_rcp_f32 v202, v202
v_rcp_f32 v203, v203
s_nop 0
v_mul_f32 v80, v192, v200
v_mul_f32 v81, v193, v201
v_mul_f32 v82, v194, v202
v_mul_f32 v83, v195, v203
v_mov_b32 v232, 0
v_mov_b32 v233, 0
v_mov_b32 v234, 0
v_mov_b32 v235, 0
s_mov_b32 s64, 0
s_mov_b32 s74, 0x1010101
s_mov_b32 s75, 0x101
L_W_gate:
s_mov_b64 exec, s[74:75]
buffer_load_dword v192, v10, s[52:55], 0 offen sc1
s_waitcnt vmcnt(0)
v_cmp_ne_u32 vcc, -1, v192
s_mov_b64 exec, -1
s_add_u32 s64, s64, 1
s_cmp_lg_u64 vcc, 0
s_cbranch_scc1 L_W_gate_done
s_sleep 4
s_cmp_lt_u32 s64, 65536
s_cbranch_scc1 L_W_gate
L_W_gate_done:
s_mov_b32 s64, 0
s_mov_b32 s77, 65536
s_mov_b32 s78, 131072
s_mov_b32 s79, 196608
L_W_sweep:
s_mov_b64 exec, s[66:67]
s_cbranch_execz L_W_sw0
buffer_load_dwordx2 v[64:65], v10, s[52:55], 0 offen sc1
L_W_sw0:
s_mov_b64 exec, s[68:69]
s_cbranch_execz L_W_sw1
buffer_load_dwordx2 v[66:67], v10, s[52:55], s77 offen sc1
L_W_sw1:
s_mov_b64 exec, s[70:71]
s_cbranch_execz L_W_sw2
buffer_load_dwordx2 v[68:69], v10, s[52:55], s78 offen sc1
L_W_sw2:
s_mov_b64 exec, s[72:73]
s_cbranch_execz L_W_sw3
buffer_load_dwordx2 v[70:71], v10, s[52:55], s79 offen sc1
L_W_sw3:
s_waitcnt vmcnt(0)
s_mov_b64 exec, s[66:67]
s_cbranch_execz L_W_sx0
v_max_u32 v192, v64, v65
v_cmp_ne_u32 vcc, -1, v192
v_lshlrev_b32 v88, 16, v64
v_and_b32 v89, 0xffff0000, v64
v_lshlrev_b32 v90, 16, v65
v_and_b32 v91, 0xffff0000, v65
s_andn2_b64 s[66:67], exec, vcc
s_mov_b64 exec, vcc
v_fma_f32 v232, v80, v88, v232
v_fma_f32 v233, v80, v89, v233
v_fma_f32 v234, v80, v90, v234
v_fma_f32 v235, v80, v91, v235
L_W_sx0:
s_mov_b64 exec, s[68:69]
s_cbranch_execz L_W_sx1
v_max_u32 v192, v66, v67
v_cmp_ne_u32 vcc, -1, v192
v_lshlrev_b32 v88, 16, v66
v_and_b32 v89, 0xffff0000, v66
v_lshlrev_b32 v90, 16, v67
v_and_b32 v91, 0xffff0000, v67
s_andn2_b64 s[68:69], exec, vcc
s_mov_b64 exec, vcc
v_fma_f32 v232, v81, v88, v232
v_fma_f32 v233, v81, v89, v233
v_fma_f32 v234, v81, v90, v234
v_fma_f32 v235, v81, v91, v235
L_W_sx1:
s_mov_b64 exec, s[70:71]
s_cbranch_execz L_W_sx2
v_max_u32 v192, v68, v69
v_cmp_ne_u32 vcc, -1, v192
v_lshlrev_b32 v88, 16, v68
v_and_b32 v89, 0xffff0000, v68
v_lshlrev_b32 v90, 16, v69
v_and_b32 v91, 0xffff0000, v69
s_andn2_b64 s[70:71], exec, vcc
s_mov_b64 exec, vcc
v_fma_f32 v232, v82, v88, v232
v_fma_f32 v233, v82, v89, v233
v_fma_f32 v234, v82, v90, v234
v_fma_f32 v235, v82, v91, v235
L_W_sx2:
s_mov_b64 exec, s[72:73]
s_cbranch_execz L_W_sx3
v_max_u32 v192, v70, v71
v_cmp_ne_u32 vcc, -1, v192
v_lshlrev_b32 v88, 16, v70
v_and_b32 v89, 0xffff0000, v70
v_lshlrev_b32 v90, 16, v71
v_and_b32 v91, 0xffff0000, v71
s_andn2_b64 s[72:73], exec, vcc
s_mov_b64 exec, vcc
v_fma_f32 v232, v83, v88, v232
v_fma_f32 v233, v83, v89, v233
v_fma_f32 v234, v83, v90, v234
v_fma_f32 v235, v83, v91, v235
L_W_sx3:
s_mov_b64 exec, -1
s_or_b64 s[74:75], s[66:67], s[68:69]
s_or_b64 s[80:81], s[70:71], s[72:73]
s_or_b64 s[74:75], s[74:75], s[80:81]
s_cbranch_scc0 L_W_sweep_done
s_add_u32 s64, s64, 1
s_cmp_lt_u32 s64, 65536
s_cbranch_scc1 L_W_sweep
L_W_sweep_done:
s_nop 1
v_permlane16_swap_b32 v232, v233
v_permlane16_swap_b32 v234, v235
v_add_f32 v232, v232, v233
v_add_f32 v234, v234, v235
s_nop 1
v_permlane32_swap_b32 v232, v234
s_nop 0
v_add_f32 v232, v232, v234
s_nop 1
v_add_f32_dpp v232, v232, v232 row_ror:8 row_mask:0xf bank_mask:0xf
s_mov_b32 exec_lo, 0x00ff00ff
s_mov_b32 exec_hi, 0x00ff00ff
ds_write_b32 v241, v232
ds_add_rtn_u32 v212, v240, v242 offset:32
ds_read_b128 v[204:207], v240
ds_read_b128 v[208:211], v240 offset:16
s_waitcnt lgkmcnt(2)
v_cmp_eq_u32 vcc, 7, v212
s_waitcnt lgkmcnt(0)
v_pk_add_f32 v[204:205], v[204:205], v[206:207]
v_pk_add_f32 v[208:209], v[208:209], v[210:211]
s_and_b64 exec, exec, vcc
s_cbranch_scc1 L_W_last
s_endpgm
L_W_last:
v_pk_add_f32 v[204:205], v[204:205], v[208:209]
v_add_f32 v204, v204, v205
v_cvt_pk_bf16_f32 v204, v204, v204
global_store_short v243, v204, s[26:27]
s_andn2_b32 s34, 1, vcc_lo
s_mov_b64 exec, -1
s_or_b32 s62, s32, s34
s_cbranch_scc1 L_W_nonext
v_mov_b32 v192, 0x18000
v_mov_b32 v193, s88
s_mov_b64 exec, 1
buffer_store_dword v193, v192, s[52:55], 0 offen
s_mov_b64 exec, -1
L_W_nonext:
s_endpgm
L_roleC:
v_and_b32 v8, 1, v0
v_lshlrev_b32 v8, 4, v8
v_mov_b32 v9, 0xffff
v_lshlrev_b32 v8, v8, v9
v_bfe_u32 v9, v0, 1, 2
v_cmp_eq_u32 vcc, 0, v9
s_nop 1
v_cndmask_b32 v4, 0, v8, vcc
v_cmp_eq_u32 vcc, 1, v9
s_nop 1
v_cndmask_b32 v5, 0, v8, vcc
v_cmp_eq_u32 vcc, 2, v9
s_nop 1
v_cndmask_b32 v6, 0, v8, vcc
v_cmp_eq_u32 vcc, 3, v9
s_nop 1
v_cndmask_b32 v7, 0, v8, vcc
s_waitcnt lgkmcnt(0)
s_load_dword s88, s[30:31], 0x18000
v_mov_b32 v8, 0
s_lshr_b32 s35, s32, 4
s_lshr_b32 s36, s34, 1
s_and_b32 s37, s34, 1
s_lshl_b32 s60, s32, 19
s_mov_b32 s61, 0x80000
s_add_u32 s40, s16, s60
s_addc_u32 s41, s17, 0
s_and_b32 s41, s41, 0xffff
s_mov_b32 s42, s61
s_mov_b32 s43, 0x20000
s_mov_b32 s44, s30
s_and_b32 s45, s31, 0xffff
s_mov_b32 s46, 0x1000000
s_mov_b32 s47, 0x20000
v_lshlrev_b32 v9, 4, v1
s_lshl_b32 s62, s34, 13
v_add_u32 v9, s62, v9
s_mul_i32 s38, s34, 8448
s_mov_b32 s51, 4096
s_add_u32 s50, s38, 5120
s_waitcnt vmcnt(3)
s_add_u32 m0, s50, 0
s_nop 0
buffer_load_dwordx4 v9, s[40:43], 0 offen offset:0 nt lds
s_waitcnt vmcnt(3)
s_add_u32 m0, s50, 32
s_nop 0
buffer_load_dwordx4 v9, s[40:43], 0 offen offset:1024 nt lds
s_waitcnt vmcnt(3)
s_add_u32 m0, s50, 64
s_nop 0
buffer_load_dwordx4 v9, s[40:43], 0 offen offset:2048 nt lds
s_waitcnt vmcnt(3)
s_add_u32 m0, s50, 96
s_nop 0
buffer_load_dwordx4 v9, s[40:43], 0 offen offset:3072 nt lds
s_waitcnt vmcnt(3)
s_add_u32 m0, s50, 4224
s_nop 0
buffer_load_dwordx4 v9, s[40:43], s51 offen offset:0 nt lds
s_waitcnt vmcnt(3)
s_add_u32 m0, s50, 4256
s_nop 0
buffer_load_dwordx4 v9, s[40:43], s51 offen offset:1024 nt lds
s_waitcnt vmcnt(3)
s_add_u32 m0, s50, 4288
s_nop 0
buffer_load_dwordx4 v9, s[40:43], s51 offen offset:2048 nt lds
s_waitcnt vmcnt(3)
s_add_u32 m0, s50, 4320
s_nop 0
buffer_load_dwordx4 v9, s[40:43], s51 offen offset:3072 nt lds
v_add_u32 v9, 0x10000, v9
s_lshl_b32 s60, s89, 8
s_sub_u32 s61, 0x400000, s60
s_add_u32 s52, s10, s60
s_addc_u32 s53, s11, 0
s_and_b32 s53, s53, 0xffff
s_mov_b32 s54, s61
s_mov_b32 s55, 0x20000
s_mov_b32 s56, s4
s_and_b32 s57, s5, 0xffff
s_mov_b32 s58, 0x800
s_mov_b32 s59, 0x20000
v_lshrrev_b32 v192, 3, v2
v_lshlrev_b32 v192, 10, v192
v_lshl_add_u32 v192, v3, 5, v192
s_lshl_b32 s62, s34, 7
v_add_u32 v192, s62, v192
buffer_load_dwordx4 v[12:15], v192, s[56:59], 0 offen
buffer_load_dwordx4 v[16:19], v192, s[56:59], 0 offen offset:16
v_lshlrev_b32 v10, 17, v3
v_lshl_add_u32 v10, v2, 4, v10
s_lshl_b32 s62, s34, 19
v_add_u32 v10, s62, v10
s_mov_b32 s62, 0
buffer_load_dwordx4 v[64:67], v10, s[52:55], s62 offen nt
s_mov_b32 s62, 8192
buffer_load_dwordx4 v[68:71], v10, s[52:55], s62 offen nt
s_mov_b32 s62, 16384
buffer_load_dwordx4 v[72:75], v10, s[52:55], s62 offen nt
s_mov_b32 s62, 24576
buffer_load_dwordx4 v[76:79], v10, s[52:55], s62 offen nt
s_mov_b32 s62, 32768
buffer_load_dwordx4 v[80:83], v10, s[52:55], s62 offen nt
s_mov_b32 s62, 40960
buffer_load_dwordx4 v[84:87], v10, s[52:55], s62 offen nt
v_lshrrev_b32 v192, 1, v3
v_lshlrev_b32 v192, 9, v192
v_lshl_add_u32 v192, v2, 5, v192
v_and_b32 v193, 1, v3
v_lshl_add_u32 v192, v193, 4, v192
s_lshl_b32 s63, s34, 10
s_add_u32 s63, s63, 140288
v_add_u32 v192, s63, v192
v_lshlrev_b32 v193, 4, v1
s_lshl_b32 s63, s32, 10
s_add_u32 s63, s63, 0x40000
v_add_u32 v194, s63, v193
v_add_u32 v193, 140288, v193
s_mov_b32 s66, 0x01000100
s_mov_b32 s67, 0x03020302
s_waitcnt vmcnt(5)
s_mov_b32 s62, 49152
buffer_load_dwordx4 v[88:91], v10, s[52:55], s62 offen nt
v_perm_b32 v195, v12, v12, s66
v_and_b32 v28, v195, v4
v_and_b32 v29, v195, v5
v_and_b32 v30, v195, v6
v_and_b32 v31, v195, v7
s_nop 1
v_mfma_f32_16x16x32_bf16 v[44:47], v[28:31], v[64:67], 0
s_waitcnt vmcnt(5)
s_mov_b32 s62, 57344
buffer_load_dwordx4 v[92:95], v10, s[52:55], s62 offen nt
v_perm_b32 v195, v12, v12, s67
v_and_b32 v32, v195, v4
v_and_b32 v33, v195, v5
v_and_b32 v34, v195, v6
v_and_b32 v35, v195, v7
s_nop 1
v_mfma_f32_16x16x32_bf16 v[44:47], v[32:35], v[68:71], v[44:47]
s_waitcnt vmcnt(5)
s_mov_b32 s62, 65536
buffer_load_dwordx4 v[96:99], v10, s[52:55], s62 offen nt
v_perm_b32 v195, v13, v13, s66
v_and_b32 v28, v195, v4
v_and_b32 v29, v195, v5
v_and_b32 v30, v195, v6
v_and_b32 v31, v195, v7
s_nop 1
v_mfma_f32_16x16x32_bf16 v[44:47], v[28:31], v[72:75], v[44:47]
s_waitcnt vmcnt(5)
s_mov_b32 s62, 73728
buffer_load_dwordx4 v[100:103], v10, s[52:55], s62 offen nt
v_perm_b32 v195, v13, v13, s67
v_and_b32 v32, v195, v4
v_and_b32 v33, v195, v5
v_and_b32 v34, v195, v6
v_and_b32 v35, v195, v7
s_nop 1
v_mfma_f32_16x16x32_bf16 v[44:47], v[32:35], v[76:79], v[44:47]
s_waitcnt vmcnt(5)
s_mov_b32 s62, 81920
buffer_load_dwordx4 v[104:107], v10, s[52:55], s62 offen nt
v_perm_b32 v195, v14, v14, s66
v_and_b32 v28, v195, v4
v_and_b32 v29, v195, v5
v_and_b32 v30, v195, v6
v_and_b32 v31, v195, v7
s_nop 1
v_mfma_f32_16x16x32_bf16 v[44:47], v[28:31], v[80:83], v[44:47]
s_waitcnt vmcnt(5)
s_mov_b32 s62, 90112
buffer_load_dwordx4 v[108:111], v10, s[52:55], s62 offen nt
v_perm_b32 v195, v14, v14, s67
v_and_b32 v32, v195, v4
v_and_b32 v33, v195, v5
v_and_b32 v34, v195, v6
v_and_b32 v35, v195, v7
s_nop 1
v_mfma_f32_16x16x32_bf16 v[44:47], v[32:35], v[84:87], v[44:47]
s_waitcnt vmcnt(5)
s_mov_b32 s62, 98304
buffer_load_dwordx4 v[112:115], v10, s[52:55], s62 offen nt
v_perm_b32 v195, v15, v15, s66
v_and_b32 v28, v195, v4
v_and_b32 v29, v195, v5
v_and_b32 v30, v195, v6
v_and_b32 v31, v195, v7
s_nop 1
v_mfma_f32_16x16x32_bf16 v[44:47], v[28:31], v[88:91], v[44:47]
s_waitcnt vmcnt(5)
s_mov_b32 s62, 106496
buffer_load_dwordx4 v[116:119], v10, s[52:55], s62 offen nt
v_perm_b32 v195, v15, v15, s67
v_and_b32 v32, v195, v4
v_and_b32 v33, v195, v5
v_and_b32 v34, v195, v6
v_and_b32 v35, v195, v7
s_nop 1
v_mfma_f32_16x16x32_bf16 v[44:47], v[32:35], v[92:95], v[44:47]
s_waitcnt vmcnt(5)
s_mov_b32 s62, 114688
buffer_load_dwordx4 v[120:123], v10, s[52:55], s62 offen nt
v_perm_b32 v195, v16, v16, s66
v_and_b32 v28, v195, v4
v_and_b32 v29, v195, v5
v_and_b32 v30, v195, v6
v_and_b32 v31, v195, v7
s_nop 1
v_mfma_f32_16x16x32_bf16 v[44:47], v[28:31], v[96:99], v[44:47]
s_waitcnt vmcnt(5)
s_mov_b32 s62, 122880
buffer_load_dwordx4 v[124:127], v10, s[52:55], s62 offen nt
v_perm_b32 v195, v16, v16, s67
v_and_b32 v32, v195, v4
v_and_b32 v33, v195, v5
v_and_b32 v34, v195, v6
v_and_b32 v35, v195, v7
s_nop 1
v_mfma_f32_16x16x32_bf16 v[44:47], v[32:35], v[100:103], v[44:47]
s_waitcnt vmcnt(5)
v_perm_b32 v195, v17, v17, s66
v_and_b32 v28, v195, v4
v_and_b32 v29, v195, v5
v_and_b32 v30, v195, v6
v_and_b32 v31, v195, v7
s_nop 1
v_mfma_f32_16x16x32_bf16 v[44:47], v[28:31], v[104:107], v[44:47]
s_waitcnt vmcnt(4)
v_perm_b32 v195, v17, v17, s67
v_and_b32 v32, v195, v4
v_and_b32 v33, v195, v5
v_and_b32 v34, v195, v6
v_and_b32 v35, v195, v7
s_nop 1
v_mfma_f32_16x16x32_bf16 v[44:47], v[32:35], v[108:111], v[44:47]
s_waitcnt vmcnt(3)
v_perm_b32 v195, v18, v18, s66
v_and_b32 v28, v195, v4
v_and_b32 v29, v195, v5
v_and_b32 v30, v195, v6
v_and_b32 v31, v195, v7
s_nop 1
v_mfma_f32_16x16x32_bf16 v[44:47], v[28:31], v[112:115], v[44:47]
s_waitcnt vmcnt(2)
v_perm_b32 v195, v18, v18, s67
v_and_b32 v32, v195, v4
v_and_b32 v33, v195, v5
v_and_b32 v34, v195, v6
v_and_b32 v35, v195, v7
s_nop 1
v_mfma_f32_16x16x32_bf16 v[44:47], v[32:35], v[116:119], v[44:47]
s_waitcnt vmcnt(1)
v_perm_b32 v195, v19, v19, s66
v_and_b32 v28, v195, v4
v_and_b32 v29, v195, v5
v_and_b32 v30, v195, v6
v_and_b32 v31, v195, v7
s_nop 1
v_mfma_f32_16x16x32_bf16 v[44:47], v[28:31], v[120:123], v[44:47]
s_waitcnt vmcnt(0)
v_perm_b32 v195, v19, v19, s67
v_and_b32 v32, v195, v4
v_and_b32 v33, v195, v5
v_and_b32 v34, v195, v6
v_and_b32 v35, v195, v7
s_nop 1
v_mfma_f32_16x16x32_bf16 v[44:47], v[32:35], v[124:127], v[44:47]
s_nop 7
ds_write_b128 v192, v[44:47]
s_waitcnt lgkmcnt(0)
s_add_u32 s88, s88, 0x9e3779b9
s_barrier
s_cmp_lg_u32 s34, 0
s_cbranch_scc1 L_C_qdone
ds_read_b128 v[64:67], v193 offset:0
ds_read_b128 v[68:71], v193 offset:1024
ds_read_b128 v[72:75], v193 offset:2048
ds_read_b128 v[76:79], v193 offset:3072
ds_read_b128 v[80:83], v193 offset:4096
ds_read_b128 v[84:87], v193 offset:5120
ds_read_b128 v[88:91], v193 offset:6144
ds_read_b128 v[92:95], v193 offset:7168
s_waitcnt lgkmcnt(6)
v_add_f32 v64, v64, v68
v_add_f32 v65, v65, v69
v_add_f32 v66, v66, v70
v_add_f32 v67, v67, v71
s_waitcnt lgkmcnt(5)
v_add_f32 v64, v64, v72
v_add_f32 v65, v65, v73
v_add_f32 v66, v66, v74
v_add_f32 v67, v67, v75
s_waitcnt lgkmcnt(4)
v_add_f32 v64, v64, v76
v_add_f32 v65, v65, v77
v_add_f32 v66, v66, v78
v_add_f32 v67, v67, v79
s_waitcnt lgkmcnt(3)
v_add_f32 v64, v64, v80
v_add_f32 v65, v65, v81
v_add_f32 v66, v66, v82
v_add_f32 v67, v67, v83
s_waitcnt lgkmcnt(2)
v_add_f32 v64, v64, v84
v_add_f32 v65, v65, v85
v_add_f32 v66, v66, v86
v_add_f32 v67, v67, v87
s_waitcnt lgkmcnt(1)
v_add_f32 v64, v64, v88
v_add_f32 v65, v65, v89
v_add_f32 v66, v66, v90
v_add_f32 v67, v67, v91
s_waitcnt lgkmcnt(0)
v_add_f32 v64, v64, v92
v_add_f32 v65, v65, v93
v_add_f32 v66, v66, v94
v_add_f32 v67, v67, v95
v_cvt_pk_bf16_f32 v64, v64, v65
v_cvt_pk_bf16_f32 v66, v66, v67
v_mov_b32 v65, s88
v_mov_b32 v67, s88
buffer_store_dwordx4 v[64:67], v194, s[44:47], 0 offen sc1
L_C_qdone:
s_barrier
s_add_u32 s50, s38, 72704
s_waitcnt vmcnt(3)
s_add_u32 m0, s50, 0
s_nop 0
buffer_load_dwordx4 v9, s[40:43], 0 offen offset:0 nt lds
s_waitcnt vmcnt(3)
s_add_u32 m0, s50, 32
s_nop 0
buffer_load_dwordx4 v9, s[40:43], 0 offen offset:1024 nt lds
s_waitcnt vmcnt(3)
s_add_u32 m0, s50, 64
s_nop 0
buffer_load_dwordx4 v9, s[40:43], 0 offen offset:2048 nt lds
s_waitcnt vmcnt(3)
s_add_u32 m0, s50, 96
s_nop 0
buffer_load_dwordx4 v9, s[40:43], 0 offen offset:3072 nt lds
s_waitcnt vmcnt(3)
s_add_u32 m0, s50, 4224
s_nop 0
buffer_load_dwordx4 v9, s[40:43], s51 offen offset:0 nt lds
s_waitcnt vmcnt(3)
s_add_u32 m0, s50, 4256
s_nop 0
buffer_load_dwordx4 v9, s[40:43], s51 offen offset:1024 nt lds
s_waitcnt vmcnt(3)
s_add_u32 m0, s50, 4288
s_nop 0
buffer_load_dwordx4 v9, s[40:43], s51 offen offset:2048 nt lds
s_waitcnt vmcnt(3)
s_add_u32 m0, s50, 4320
s_nop 0
buffer_load_dwordx4 v9, s[40:43], s51 offen offset:3072 nt lds
v_add_u32 v9, 0x10000, v9
s_waitcnt vmcnt(3)
buffer_load_dwordx4 v[208:211], v9, s[40:43], 0 offen offset:0 nt
s_waitcnt vmcnt(3)
buffer_load_dwordx4 v[212:215], v9, s[40:43], 0 offen offset:1024 nt
s_waitcnt vmcnt(3)
buffer_load_dwordx4 v[216:219], v9, s[40:43], 0 offen offset:2048 nt
s_waitcnt vmcnt(3)
buffer_load_dwordx4 v[220:223], v9, s[40:43], 0 offen offset:3072 nt
s_waitcnt vmcnt(3)
buffer_load_dwordx4 v[224:227], v9, s[40:43], s51 offen offset:0 nt
s_waitcnt vmcnt(3)
buffer_load_dwordx4 v[228:231], v9, s[40:43], s51 offen offset:1024 nt
s_waitcnt vmcnt(3)
buffer_load_dwordx4 v[232:235], v9, s[40:43], s51 offen offset:2048 nt
s_waitcnt vmcnt(3)
buffer_load_dwordx4 v[236:239], v9, s[40:43], s51 offen offset:3072 nt
v_add_u32 v9, 0x10000, v9
s_add_u32 s62, s38, 5120
v_lshl_add_u32 v22, v1, 4, s62
s_lshl_b32 s62, s36, 4
v_add_u32 v240, s62, v2
v_mul_u32_u24 v10, 1056, v240
v_lshl_add_u32 v10, v3, 4, v10
v_add_u32 v10, 5120, v10
v_lshrrev_b32 v240, 1, v3
v_lshlrev_b32 v240, 3, v240
v_lshrrev_b32 v241, 2, v2
v_add_u32 v240, v240, v241
v_mul_u32_u24 v11, 1056, v240
v_and_b32 v240, 1, v3
v_lshl_add_u32 v11, v240, 5, v11
v_and_b32 v240, 3, v2
v_lshl_add_u32 v11, v240, 3, v11
s_lshl_b32 s62, s34, 7
s_add_u32 s62, s62, 5120
v_add_u32 v11, s62, v11
s_lshl_b32 s62, s37, 4
v_add_u32 v240, s62, v2
v_mul_u32_u24 v12, 144, v240
v_lshl_add_u32 v12, v3, 3, v12
s_lshl_b32 s62, s36, 5
v_add_u32 v12, s62, v12
v_lshlrev_b32 v15, 4, v240
s_lshl_b32 s62, s36, 2
v_add_u32 v14, s62, v15
v_and_b32 v240, 31, v1
v_mul_u32_u24 v13, 144, v240
v_lshrrev_b32 v241, 5, v1
v_lshl_add_u32 v13, v241, 4, v13
v_lshlrev_b32 v16, 4, v240
v_mov_b32 v17, 0x3e0293ee
v_mov_b32 v18, 0xff800000
v_mov_b32 v19, 0xff800000
v_mov_b32 v20, 0
v_mov_b32 v96, 0
v_mov_b32 v97, 0
v_mov_b32 v98, 0
v_mov_b32 v99, 0
v_mov_b32 v100, 0
v_mov_b32 v101, 0
v_mov_b32 v102, 0
v_mov_b32 v103, 0
v_mov_b32 v104, 0
v_mov_b32 v105, 0
v_mov_b32 v106, 0
v_mov_b32 v107, 0
v_mov_b32 v108, 0
v_mov_b32 v109, 0
v_mov_b32 v110, 0
v_mov_b32 v111, 0
v_mov_b32 v112, 0
v_mov_b32 v113, 0
v_mov_b32 v114, 0
v_mov_b32 v115, 0
v_mov_b32 v116, 0
v_mov_b32 v117, 0
v_mov_b32 v118, 0
v_mov_b32 v119, 0
v_mov_b32 v120, 0
v_mov_b32 v121, 0
v_mov_b32 v122, 0
v_mov_b32 v123, 0
v_mov_b32 v124, 0
v_mov_b32 v125, 0
v_mov_b32 v126, 0
v_mov_b32 v127, 0
s_cmp_lg_u32 s34, 0
s_cbranch_scc1 L_wc_Cq
s_mov_b32 s62, 0x1a000
v_lshl_add_u32 v240, v1, 8, s62
s_lshl_b64 exec, 1, s32
s_mov_b32 s64, 0
L_tp_Cq0:
buffer_load_dword v241, v240, s[44:47], 0 offen sc1
s_waitcnt vmcnt(0)
v_cmp_ne_u32 vcc, s88, v241
s_add_u32 s64, s64, 1
s_nop 0
s_or_b64 vcc, vcc, vcc
s_cbranch_scc0 L_tp_Cq0_ok
s_sleep 32
s_cmp_lt_u32 s64, 65536
s_cbranch_scc1 L_tp_Cq0
L_tp_Cq0_ok:
s_mov_b32 exec_lo, -1
s_mov_b32 exec_hi, 0
s_mov_b32 s64, 0
L_tp_Cq:
buffer_load_dword v241, v240, s[44:47], 0 offen sc1
s_waitcnt vmcnt(0)
v_cmp_ne_u32 vcc, s88, v241
s_add_u32 s64, s64, 1
s_nop 0
s_or_b64 vcc, vcc, vcc
s_cbranch_scc0 L_tp_Cq_ok
s_mov_b64 exec, vcc
s_sleep 8
s_cmp_lt_u32 s64, 65536
s_cbranch_scc1 L_tp_Cq
L_tp_Cq_ok:
s_mov_b64 exec, -1
L_wc_Cq:
s_barrier
s_lshl_b32 s62, s35, 5
s_lshl_b32 s63, s37, 4
s_add_u32 s62, s62, s63
v_add_u32 v240, s62, v2
v_lshlrev_b32 v240, 10, v240
v_lshl_add_u32 v240, v3, 4, v240
v_add_u32 v240, 0x0, v240
buffer_load_dwordx4 v[32:35], v240, s[44:47], 0 offen offset:0 sc1
buffer_load_dwordx4 v[36:39], v240, s[44:47], 0 offen offset:64 sc1
buffer_load_dwordx4 v[40:43], v240, s[44:47], 0 offen offset:128 sc1
buffer_load_dwordx4 v[44:47], v240, s[44:47], 0 offen offset:192 sc1
buffer_load_dwordx4 v[48:51], v240, s[44:47], 0 offen offset:256 sc1
buffer_load_dwordx4 v[52:55], v240, s[44:47], 0 offen offset:320 sc1
buffer_load_dwordx4 v[56:59], v240, s[44:47], 0 offen offset:384 sc1
buffer_load_dwordx4 v[60:63], v240, s[44:47], 0 offen offset:448 sc1
buffer_load_dwordx4 v[64:67], v240, s[44:47], 0 offen offset:512 sc1
buffer_load_dwordx4 v[68:71], v240, s[44:47], 0 offen offset:576 sc1
buffer_load_dwordx4 v[72:75], v240, s[44:47], 0 offen offset:640 sc1
buffer_load_dwordx4 v[76:79], v240, s[44:47], 0 offen offset:704 sc1
buffer_load_dwordx4 v[80:83], v240, s[44:47], 0 offen offset:768 sc1
buffer_load_dwordx4 v[84:87], v240, s[44:47], 0 offen offset:832 sc1
buffer_load_dwordx4 v[88:91], v240, s[44:47], 0 offen offset:896 sc1
buffer_load_dwordx4 v[92:95], v240, s[44:47], 0 offen offset:960 sc1
s_mov_b32 s39, 0
s_mov_b32 s48, 0
.p2align 6
L_C_loop:
s_cmp_lg_u32 s39, 0
s_cbranch_scc1 L_C_top
s_waitcnt vmcnt(0)
L_C_top:
s_waitcnt lgkmcnt(0)
s_barrier
s_mov_b32 s52, 1
s_cmp_eq_u32 s39, 0
s_cselect_b32 s52, 0, s52
s_cmp_ge_u32 s39, 7
s_cselect_b32 s52, 0, s52
s_sub_u32 s50, 67584, s48
v_add_u32 v23, s50, v22
s_cmp_eq_u32 s52, 0
s_cbranch_scc1 L_C_st0
s_waitcnt vmcnt(7)
ds_write_b128 v23, v[208:211] offset:0
buffer_load_dwordx4 v[208:211], v9, s[40:43], 0 offen offset:0 nt
s_waitcnt vmcnt(7)
ds_write_b128 v23, v[212:215] offset:1056
buffer_load_dwordx4 v[212:215], v9, s[40:43], 0 offen offset:1024 nt
s_waitcnt vmcnt(7)
ds_write_b128 v23, v[216:219] offset:2112
buffer_load_dwordx4 v[216:219], v9, s[40:43], 0 offen offset:2048 nt
s_waitcnt vmcnt(7)
ds_write_b128 v23, v[220:223] offset:3168
buffer_load_dwordx4 v[220:223], v9, s[40:43], 0 offen offset:3072 nt
s_waitcnt vmcnt(7)
ds_write_b128 v23, v[224:227] offset:4224
buffer_load_dwordx4 v[224:227], v9, s[40:43], s51 offen offset:0 nt
s_waitcnt vmcnt(7)
ds_write_b128 v23, v[228:231] offset:5280
buffer_load_dwordx4 v[228:231], v9, s[40:43], s51 offen offset:1024 nt
s_waitcnt vmcnt(7)
ds_write_b128 v23, v[232:235] offset:6336
buffer_load_dwordx4 v[232:235], v9, s[40:43], s51 offen offset:2048 nt
s_waitcnt vmcnt(7)
ds_write_b128 v23, v[236:239] offset:7392
buffer_load_dwordx4 v[236:239], v9, s[40:43], s51 offen offset:3072 nt
v_add_u32 v9, 0x10000, v9
L_C_st0:
v_add_u32 v240, s48, v10
v_add_u32 v241, s48, v11
ds_read_b128 v[128:131], v240 offset:0
ds_read_b128 v[132:135], v240 offset:64
ds_read_b128 v[136:139], v240 offset:128
ds_read_b128 v[140:143], v240 offset:192
ds_read_b128 v[144:147], v240 offset:256
ds_read_b128 v[148:151], v240 offset:320
ds_read_b128 v[152:155], v240 offset:384
ds_read_b128 v[156:159], v240 offset:448
ds_read_b128 v[160:163], v240 offset:512
ds_read_b128 v[164:167], v240 offset:576
ds_read_b128 v[168:171], v240 offset:640
ds_read_b128 v[172:175], v240 offset:704
ds_read_b128 v[176:179], v240 offset:768
ds_read_b128 v[180:183], v240 offset:832
ds_read_b128 v[184:187], v240 offset:896
ds_read_b128 v[188:191], v240 offset:960
s_waitcnt lgkmcnt(15)
v_mfma_f32_16x16x32_bf16 v[28:31], v[128:131], v[32:35], 0
s_waitcnt lgkmcnt(14)
v_mfma_f32_16x16x32_bf16 v[28:31], v[132:135], v[36:39], v[28:31]
s_waitcnt lgkmcnt(13)
v_mfma_f32_16x16x32_bf16 v[28:31], v[136:139], v[40:43], v[28:31]
s_waitcnt lgkmcnt(12)
v_mfma_f32_16x16x32_bf16 v[28:31], v[140:143], v[44:47], v[28:31]
s_waitcnt lgkmcnt(11)
v_mfma_f32_16x16x32_bf16 v[28:31], v[144:147], v[48:51], v[28:31]
s_waitcnt lgkmcnt(10)
v_mfma_f32_16x16x32_bf16 v[28:31], v[148:151], v[52:55], v[28:31]
s_waitcnt lgkmcnt(9)
v_mfma_f32_16x16x32_bf16 v[28:31], v[152:155], v[56:59], v[28:31]
s_waitcnt lgkmcnt(8)
v_mfma_f32_16x16x32_bf16 v[28:31], v[156:159], v[60:63], v[28:31]
s_waitcnt lgkmcnt(7)
v_mfma_f32_16x16x32_bf16 v[28:31], v[160:163], v[64:67], v[28:31]
s_waitcnt lgkmcnt(6)
v_mfma_f32_16x16x32_bf16 v[28:31], v[164:167], v[68:71], v[28:31]
s_waitcnt lgkmcnt(5)
v_mfma_f32_16x16x32_bf16 v[28:31], v[168:171], v[72:75], v[28:31]
s_waitcnt lgkmcnt(4)
v_mfma_f32_16x16x32_bf16 v[28:31], v[172:175], v[76:79], v[28:31]
s_waitcnt lgkmcnt(3)
v_mfma_f32_16x16x32_bf16 v[28:31], v[176:179], v[80:83], v[28:31]
s_waitcnt lgkmcnt(2)
v_mfma_f32_16x16x32_bf16 v[28:31], v[180:183], v[84:87], v[28:31]
s_waitcnt lgkmcnt(1)
v_mfma_f32_16x16x32_bf16 v[28:31], v[184:187], v[88:91], v[28:31]
s_waitcnt lgkmcnt(0)
v_mfma_f32_16x16x32_bf16 v[28:31], v[188:191], v[92:95], v[28:31]
s_nop 7
v_mul_f32 v24, v28, v17
v_mul_f32 v25, v29, v17
v_mul_f32 v26, v30, v17
v_mul_f32 v27, v31, v17
v_max3_f32 v242, v24, v25, v26
v_max_f32 v242, v242, v27
v_mov_b32 v243, v242
s_nop 1
v_permlane16_swap_b32 v242, v243
s_nop 0
v_max_f32 v242, v242, v243
v_mov_b32 v243, v242
s_nop 1
v_permlane32_swap_b32 v242, v243
s_nop 0
v_max_f32 v242, v242, v243
s_mov_b64 exec, 0xffff
ds_write_b32 v14, v242 offset:0
s_mov_b64 exec, -1
s_waitcnt lgkmcnt(0)
s_barrier
ds_read_b128 v[192:195], v15 offset:0
ds_read_b128 v[196:199], v16 offset:0
s_waitcnt lgkmcnt(1)
v_max3_f32 v242, v192, v193, v194
v_max3_f32 v242, v242, v195, v18
v_sub_f32 v21, v18, v242
v_sub_f32 v24, v24, v242
v_sub_f32 v25, v25, v242
v_sub_f32 v26, v26, v242
v_sub_f32 v27, v27, v242
v_exp_f32 v21, v21
v_exp_f32 v24, v24
v_exp_f32 v25, v25
v_exp_f32 v26, v26
v_exp_f32 v27, v27
v_mov_b32 v18, v242
v_cvt_pk_bf16_f32 v244, v24, v25
v_cvt_pk_bf16_f32 v245, v26, v27
ds_write_b64 v12, v[244:245] offset:512
v_add_f32 v24, v24, v25
v_add_f32 v26, v26, v27
v_fma_f32 v20, v20, v21, v24
v_add_f32 v20, v20, v26
s_waitcnt lgkmcnt(1)
v_max3_f32 v242, v196, v197, v198
v_max3_f32 v242, v242, v199, v19
v_sub_f32 v21, v19, v242
v_exp_f32 v21, v21
v_mov_b32 v19, v242
v_mul_f32 v96, v96, v21
v_mul_f32 v97, v97, v21
v_mul_f32 v98, v98, v21
v_mul_f32 v99, v99, v21
v_mul_f32 v100, v100, v21
v_mul_f32 v101, v101, v21
v_mul_f32 v102, v102, v21
v_mul_f32 v103, v103, v21
v_mul_f32 v104, v104, v21
v_mul_f32 v105, v105, v21
v_mul_f32 v106, v106, v21
v_mul_f32 v107, v107, v21
v_mul_f32 v108, v108, v21
v_mul_f32 v109, v109, v21
v_mul_f32 v110, v110, v21
v_mul_f32 v111, v111, v21
v_mul_f32 v112, v112, v21
v_mul_f32 v113, v113, v21
v_mul_f32 v114, v114, v21
v_mul_f32 v115, v115, v21
v_mul_f32 v116, v116, v21
v_mul_f32 v117, v117, v21
v_mul_f32 v118, v118, v21
v_mul_f32 v119, v119, v21
v_mul_f32 v120, v120, v21
v_mul_f32 v121, v121, v21
v_mul_f32 v122, v122, v21
v_mul_f32 v123, v123, v21
v_mul_f32 v124, v124, v21
v_mul_f32 v125, v125, v21
v_mul_f32 v126, v126, v21
v_mul_f32 v127, v127, v21
s_waitcnt lgkmcnt(0)
s_barrier
ds_read_b128 v[192:195], v13 offset:512
ds_read_b128 v[196:199], v13 offset:544
ds_read_b128 v[200:203], v13 offset:576
ds_read_b128 v[204:207], v13 offset:608
ds_read_b64_tr_b16 v[128:129], v241 offset:0
ds_read_b64_tr_b16 v[130:131], v241 offset:4224
ds_read_b64_tr_b16 v[132:133], v241 offset:64
ds_read_b64_tr_b16 v[134:135], v241 offset:4288
ds_read_b64_tr_b16 v[136:137], v241 offset:16896
ds_read_b64_tr_b16 v[138:139], v241 offset:21120
ds_read_b64_tr_b16 v[140:141], v241 offset:16960
ds_read_b64_tr_b16 v[142:143], v241 offset:21184
ds_read_b64_tr_b16 v[144:145], v241 offset:33792
ds_read_b64_tr_b16 v[146:147], v241 offset:38016
ds_read_b64_tr_b16 v[148:149], v241 offset:33856
ds_read_b64_tr_b16 v[150:151], v241 offset:38080
ds_read_b64_tr_b16 v[152:153], v241 offset:50688
ds_read_b64_tr_b16 v[154:155], v241 offset:54912
ds_read_b64_tr_b16 v[156:157], v241 offset:50752
ds_read_b64_tr_b16 v[158:159], v241 offset:54976
s_waitcnt lgkmcnt(12)
v_mfma_f32_32x32x16_bf16 v[96:111], v[128:131], v[192:195], v[96:111]
v_mfma_f32_32x32x16_bf16 v[112:127], v[132:135], v[192:195], v[112:127]
s_waitcnt lgkmcnt(8)
v_mfma_f32_32x32x16_bf16 v[96:111], v[136:139], v[196:199], v[96:111]
v_mfma_f32_32x32x16_bf16 v[112:127], v[140:143], v[196:199], v[112:127]
s_waitcnt lgkmcnt(4)
v_mfma_f32_32x32x16_bf16 v[96:111], v[144:147], v[200:203], v[96:111]
v_mfma_f32_32x32x16_bf16 v[112:127], v[148:151], v[200:203], v[112:127]
s_waitcnt lgkmcnt(0)
v_mfma_f32_32x32x16_bf16 v[96:111], v[152:155], v[204:207], v[96:111]
v_mfma_f32_32x32x16_bf16 v[112:127], v[156:159], v[204:207], v[112:127]
s_sub_u32 s48, 67584, s48
s_add_u32 s39, s39, 1
s_cmp_lt_u32 s39, 8
s_cbranch_scc1 L_C_loop
v_mov_b32 v243, v20
s_nop 1
v_permlane16_swap_b32 v20, v243
s_nop 0
v_add_f32 v20, v20, v243
v_mov_b32 v243, v20
s_nop 1
v_permlane32_swap_b32 v20, v243
s_nop 0
v_add_f32 v20, v20, v243
s_barrier
s_mov_b64 exec, 0xffff
ds_write_b32 v14, v20 offset:0
s_mov_b64 exec, -1
v_and_b32 v240, 31, v1
v_mul_u32_u24 v240, 2064, v240
v_lshrrev_b32 v241, 5, v1
v_lshl_add_u32 v240, v241, 4, v240
s_lshl_b32 s62, s34, 8
s_add_u32 s62, s62, 5120
v_add_u32 v240, s62, v240
s_nop 5
ds_write_b128 v240, v[96:99] offset:0
ds_write_b128 v240, v[100:103] offset:32
ds_write_b128 v240, v[104:107] offset:64
ds_write_b128 v240, v[108:111] offset:96
ds_write_b128 v240, v[112:115] offset:128
ds_write_b128 v240, v[116:119] offset:160
ds_write_b128 v240, v[120:123] offset:192
ds_write_b128 v240, v[124:127] offset:224
s_waitcnt lgkmcnt(0)
s_barrier
s_mul_i32 s62, s34, 8256
s_add_u32 s62, s62, 5120
v_lshl_add_u32 v240, v1, 5, s62
ds_read_b128 v[128:131], v240 offset:0
ds_read_b128 v[132:135], v240 offset:16
ds_read_b128 v[136:139], v240 offset:2064
ds_read_b128 v[140:143], v240 offset:2080
ds_read_b128 v[144:147], v240 offset:4128
ds_read_b128 v[148:151], v240 offset:4144
ds_read_b128 v[152:155], v240 offset:6192
ds_read_b128 v[156:159], v240 offset:6208
s_lshl_b32 s62, s35, 5
s_lshl_b32 s63, s34, 2
s_add_u32 s62, s62, s63
s_lshl_b32 s62, s62, 4
s_and_b32 s63, s32, 15
s_add_u32 s62, s62, s63
s_lshl_b32 s62, s62, 10
s_add_u32 s62, s62, 0x200000
v_lshl_add_u32 v241, v1, 4, s62
s_waitcnt lgkmcnt(6)
v_cvt_pk_bf16_f32 v160, v128, v129
v_cvt_pk_bf16_f32 v161, v130, v131
v_cvt_pk_bf16_f32 v162, v132, v133
v_cvt_pk_bf16_f32 v163, v134, v135
s_mov_b32 s63, 0
buffer_store_dwordx4 v[160:163], v241, s[44:47], s63 offen sc1
s_waitcnt lgkmcnt(4)
v_cvt_pk_bf16_f32 v164, v136, v137
v_cvt_pk_bf16_f32 v165, v138, v139
v_cvt_pk_bf16_f32 v166, v140, v141
v_cvt_pk_bf16_f32 v167, v142, v143
s_mov_b32 s63, 16384
buffer_store_dwordx4 v[164:167], v241, s[44:47], s63 offen sc1
s_waitcnt lgkmcnt(2)
v_cvt_pk_bf16_f32 v168, v144, v145
v_cvt_pk_bf16_f32 v169, v146, v147
v_cvt_pk_bf16_f32 v170, v148, v149
v_cvt_pk_bf16_f32 v171, v150, v151
s_mov_b32 s63, 32768
buffer_store_dwordx4 v[168:171], v241, s[44:47], s63 offen sc1
s_waitcnt lgkmcnt(0)
v_cvt_pk_bf16_f32 v172, v152, v153
v_cvt_pk_bf16_f32 v173, v154, v155
v_cvt_pk_bf16_f32 v174, v156, v157
v_cvt_pk_bf16_f32 v175, v158, v159
s_mov_b32 s63, 49152
buffer_store_dwordx4 v[172:175], v241, s[44:47], s63 offen sc1
ds_read_b128 v[192:195], v16 offset:0
v_and_b32 v240, 31, v1
s_lshl_b32 s63, s32, 9
s_add_u32 s63, s63, 0x10000
v_lshl_add_u32 v240, v240, 4, s63
s_waitcnt lgkmcnt(0)
v_add_f32 v192, v192, v193
v_add_f32 v194, v194, v195
v_add_f32 v194, v192, v194
v_mov_b32 v192, v19
v_mov_b32 v193, s88
v_mov_b32 v195, s88
s_waitcnt vmcnt(0)
s_barrier
s_cmp_lg_u32 s34, 1
s_cbranch_scc1 L_C_noas
s_and_b32 s63, s32, 7
s_mul_i32 s63, s63, 0x100
s_add_u32 s63, s63, 0xc0000
s_add_u32 s56, s30, s63
s_addc_u32 s57, s31, 0
s_lshl_b32 s62, s89, 21
s_sub_u32 s63, 0x8000000, s62
s_add_u32 s68, s6, s62
s_addc_u32 s69, s7, 0
s_and_b32 s69, s69, 0xffff
s_mov_b32 s70, s63
s_mov_b32 s71, 0x20000
s_add_u32 s72, s8, s62
s_addc_u32 s73, s9, 0
s_and_b32 s73, s73, 0xffff
s_mov_b32 s74, s63
s_mov_b32 s75, 0x20000
s_mov_b64 s[76:77], s[68:69]
s_mov_b64 s[78:79], s[70:71]
s_lshr_b32 s62, s32, 3
s_mul_i32 s62, s62, 6
s_sub_u32 s62, s62, 32
v_add_u32 v136, s62, v1
v_cmp_gt_u32 vcc, 32, v1
v_lshlrev_b32 v133, 7, v1
v_add_u32 v134, 0x4000000, v133
v_cndmask_b32 v128, v136, v1, vcc
v_lshlrev_b32 v128, 2, v128
v_mov_b32 v132, 0
s_mov_b32 s64, 0
L_as_C:
s_mov_b64 exec, 0x1ffffff
s_mov_b32 exec_hi, 0x3f
global_load_dword v129, v128, s[56:57] nt
s_waitcnt vmcnt(0)
v_subrev_u32 v129, s88, v129
s_mov_b64 exec, 0xffffff
v_cmp_le_u32 vcc, 0x400, v129
v_readlane_b32 s62, v129, 24
v_add_u32_dpp v129, v129, v129 row_shr:1 row_mask:0xf bank_mask:0xf bound_ctrl:0
s_nop 1
v_add_u32_dpp v129, v129, v129 row_shr:2 row_mask:0xf bank_mask:0xf bound_ctrl:0
s_nop 1
v_add_u32_dpp v129, v129, v129 row_shr:4 row_mask:0xf bank_mask:0xf bound_ctrl:0
s_nop 1
v_add_u32_dpp v129, v129, v129 row_shr:8 row_mask:0xf bank_mask:0xf bound_ctrl:0
s_nop 0
v_readlane_b32 s61, v129, 15
v_readlane_b32 s63, v129, 23
s_add_u32 s61, s61, s63
s_cbranch_vccnz L_as_C_x
s_cmp_ge_u32 s61, 15168
s_cbranch_scc1 L_as_C_x
s_sub_u32 s61, s61, 120
s_mov_b32 exec_lo, 0
s_mov_b32 exec_hi, 0x3f
v_cmp_gt_u32 vcc, 280, v129
v_add_u32 v130, 56, v129
s_nop 0
v_cndmask_b32 v136, 0, 8, vcc
v_add_u32 v130, v130, v136
v_lshrrev_b32 v130, 4, v130
v_sub_u32 v136, v130, v132
v_cmp_gt_i32 vcc, 4, v136
v_cmp_le_i32 s[66:67], 2, v136
s_nop 0
v_cndmask_b32 v131, 0, 7, vcc
v_cmp_ge_u32 vcc, 41, v130
v_add_u32 v131, v131, v129
v_lshl_add_u32 v131, v131, 6, v1
s_and_b64 vcc, vcc, s[66:67]
v_cndmask_b32 v131, -1, v131, vcc
s_nop 1
v_min_u32_dpp v131, v131, v131 row_shr:1 row_mask:0xf bank_mask:0xf
s_nop 1
v_min_u32_dpp v131, v131, v131 row_shr:2 row_mask:0xf bank_mask:0xf
s_nop 1
v_min_u32_dpp v131, v131, v131 row_shr:4 row_mask:0xf bank_mask:0xf
s_nop 0
v_readlane_b32 s63, v131, 37
s_lshr_b32 s65, s63, 6
s_and_b32 s63, s63, 63
s_mul_i32 s65, s65, 24
s_cmp_ge_i32 s65, s61
s_cbranch_scc1 L_as_C_idle
v_readlane_b32 s65, v130, s63
s_mov_b32 m0, s63
s_mov_b64 exec, -1
s_cmp_lt_u32 s65, 21
s_cselect_b64 s[76:77], s[68:69], s[72:73]
v_writelane_b32 v132, s65, m0
s_cselect_b32 s66, 0, 21
s_sub_u32 s65, s65, s66
s_mul_i32 s65, s65, 0x18000
s_and_b32 s63, s63, 7
s_lshl_b32 s63, s63, 14
s_add_u32 s65, s65, s63
s_add_u32 s66, s65, 0x2000
buffer_load_dword v135, v133, s[76:79], s65 offen
buffer_load_dword v135, v133, s[76:79], s66 offen
buffer_load_dword v135, v134, s[76:79], s65 offen
buffer_load_dword v135, v134, s[76:79], s66 offen
s_waitcnt vmcnt(1)
s_branch L_as_C_next
L_as_C_idle:
s_sleep 4
L_as_C_next:
s_add_u32 s64, s64, 1
s_cmp_lt_u32 s64, 96
s_cbranch_scc1 L_as_C
L_as_C_x:
s_mov_b64 exec, -1
s_waitcnt vmcnt(0)
L_C_noas:
s_cmp_lg_u32 s34, 0
s_cbranch_scc1 L_C_done
s_mov_b32 exec_hi, 0
buffer_store_dwordx4 v[192:195], v240, s[44:47], 0 offen sc1
s_mov_b64 exec, -1
s_cmp_ge_u32 s32, 8
s_cbranch_scc1 L_C_done
s_and_b32 s63, s32, 7
s_mul_i32 s63, s63, 0x100
s_add_u32 s63, s63, 0xc0000
s_add_u32 s56, s30, s63
s_addc_u32 s57, s31, 0
s_mov_b32 s64, 0
s_mov_b32 s59, 0
s_mov_b32 s58, 0
s_lshl_b32 s62, s32, 12
s_add_u32 s62, s62, 0xd0000
v_lshl_add_u32 v132, v1, 4, s62
v_lshrrev_b32 v133, 2, v1
s_mov_b32 s62, 0xd0000
v_lshl_add_u32 v133, v133, 12, s62
v_and_b32 v134, 3, v1
v_lshlrev_b32 v136, 2, v1
v_mov_b32 v139, 0
L_gm_C:
s_mov_b32 exec_lo, -1
s_mov_b32 exec_hi, 0
v_add_u32 v135, s58, v134
v_and_b32 v135, 15, v135
v_lshl_add_u32 v135, v135, 8, v133
global_load_dword v138, v135, s[30:31] sc1
s_mov_b64 exec, 0x1ffffff
global_load_dword v137, v136, s[56:57] nt
s_waitcnt vmcnt(0)
v_subrev_u32 v137, s88, v137
s_mov_b64 exec, 0xffffff
v_cmp_le_u32 vcc, 0x400, v137
v_readlane_b32 s62, v137, 24
v_add_u32_dpp v137, v137, v137 row_shr:1 row_mask:0xf bank_mask:0xf bound_ctrl:0
s_nop 1
v_add_u32_dpp v137, v137, v137 row_shr:2 row_mask:0xf bank_mask:0xf bound_ctrl:0
s_nop 1
v_add_u32_dpp v137, v137, v137 row_shr:4 row_mask:0xf bank_mask:0xf bound_ctrl:0
s_nop 1
v_add_u32_dpp v137, v137, v137 row_shr:8 row_mask:0xf bank_mask:0xf bound_ctrl:0
s_nop 0
v_readlane_b32 s61, v137, 15
v_readlane_b32 s63, v137, 23
s_add_u32 s61, s61, s63
s_mov_b64 exec, 0xff
s_cbranch_vccnz L_gm_C_x
s_add_u32 s63, s61, s88
v_mov_b32 v128, s63
v_mov_b32 v129, s63
v_mov_b32 v130, s63
v_mov_b32 v131, s63
s_lshr_b32 s58, s61, 9
s_and_b32 s63, s58, 15
s_lshl_b32 s63, s63, 8
v_add_u32 v135, s63, v132
s_sub_u32 s58, s58, 2
global_store_dwordx4 v135, v[128:131], s[30:31] sc1
s_mul_i32 s63, s61, 0
s_mul_i32 s65, s59, 8
s_add_u32 s65, s65, s63
s_cmp_eq_u32 s59, 0
s_mov_b32 s59, s61
s_cbranch_scc1 L_gm_C_next
s_mov_b32 exec_lo, -1
v_subrev_u32 v138, s88, v138
v_cmp_gt_u32 vcc, 0x8000, v138
s_nop 1
v_cndmask_b32 v138, 0, v138, vcc
v_max_u32 v139, v139, v138
s_nop 1
v_max_u32_dpp v139, v139, v139 quad_perm:[1,0,3,2] row_mask:0xf bank_mask:0xf
s_nop 1
v_max_u32_dpp v139, v139, v139 quad_perm:[2,3,0,1] row_mask:0xf bank_mask:0xf
v_cmp_eq_u32 vcc, 0, v139
s_nop 0
v_add_u32_dpp v138, v139, v139 row_shr:4 row_mask:0xf bank_mask:0xf bound_ctrl:0
s_nop 1
v_add_u32_dpp v138, v138, v138 row_shr:8 row_mask:0xf bank_mask:0xf bound_ctrl:0
s_cbranch_vccnz L_gm_C_next
s_nop 0
v_readlane_b32 s63, v138, 15
v_readlane_b32 s62, v138, 31
s_add_u32 s63, s63, s62
s_sub_u32 s63, s63, s65
s_ashr_i32 s63, s63, 3
s_add_u32 s63, s63, 0x4000
s_add_u32 s63, s63, s88
s_mov_b64 exec, 0x1000000
v_mov_b32 v140, s63
global_store_dword v136, v140, s[56:57]
L_gm_C_next:
s_cmp_ge_u32 s61, 14400
s_cbranch_scc1 L_gm_C_x
s_add_u32 s64, s64, 1
s_cmp_lt_u32 s64, 128
s_cbranch_scc1 L_gm_C
L_gm_C_x:
s_mov_b64 exec, -1
L_C_done:
s_endpgm
L_exit:
s_endpgm
.section .rodata,"a"
.p2align 6
.amdhsa_kernel concat_heads__gqa_block_cached__compressed_kv_cla__decode_kernel
  .amdhsa_next_free_vgpr 256
  .amdhsa_next_free_sgpr 102
  .amdhsa_accum_offset 256
  .amdhsa_group_segment_fixed_size 0
  .amdhsa_kernarg_size 112
  .amdhsa_user_sgpr_count 2
  .amdhsa_user_sgpr_kernarg_segment_ptr 1
  .amdhsa_system_sgpr_workgroup_id_x 1
.end_amdhsa_kernel
```

```asm
; @launch grid=(256,1,1) block=(512,1,1) lds=153600
.amdgcn_target "amdgcn-amd-amdhsa--gfx950"
.text
.globl concat_heads__gqa_block_cached__compressed_kv_cla__decode_kernel
.p2align 8
.type concat_heads__gqa_block_cached__compressed_kv_cla__decode_kernel,@function
concat_heads__gqa_block_cached__compressed_kv_cla__decode_kernel:
s_lshr_b32 s60, s2, 8
s_cbranch_scc1 L_exit
s_load_dwordx16 s[4:19], s[0:1], 0
s_load_dwordx8 s[20:27], s[0:1], 64
s_load_dwordx4 s[28:31], s[0:1], 96
v_readfirstlane_b32 s34, v0
s_and_b32 s60, s2, 7
s_lshr_b32 s61, s2, 6
s_lshl3_add_u32 s32, s61, s60
s_lshr_b32 s33, s2, 3
s_and_b32 s33, s33, 7
s_lshr_b32 s34, s34, 6
s_cmp_eq_u32 s33, 6
s_cbranch_scc1 L_roleW
s_cmp_eq_u32 s33, 7
s_cbranch_scc1 L_roleC
L_roleA:
s_cmp_ge_u32 s34, 4
s_cbranch_scc1 L_A_helper
v_and_b32 v2, 15, v0
v_lshrrev_b32 v24, 4, v0
v_lshlrev_b32 v61, 4, v2
v_lshl_add_u32 v61, v24, 13, v61
s_lshl_b32 s60, s32, 8
s_sub_u32 s70, 0x400000, s60
s_mov_b32 s71, 0x20000
s_mov_b64 s[74:75], s[70:71]
s_lshl_b32 s39, s33, 19
s_waitcnt lgkmcnt(0)
s_add_u32 s68, s18, s60
s_addc_u32 s69, s19, 0
s_pack_ll_b32_b16 s69, s69, 0
buffer_load_dwordx4 v[128:131], v61, s[68:71], s39 offen
s_add_u32 s39, s39, s71
buffer_load_dwordx4 v[132:135], v61, s[68:71], s39 offen
s_add_u32 s39, s39, s71
buffer_load_dwordx4 v[136:139], v61, s[68:71], s39 offen
s_add_u32 s39, s39, s71
buffer_load_dwordx4 v[140:143], v61, s[68:71], s39 offen
s_add_u32 s72, s20, s60
s_addc_u32 s73, s21, 0
s_pack_ll_b32_b16 s73, s73, 0
s_xor_b32 s39, s39, 0x100000
buffer_load_dwordx4 v[144:147], v61, s[72:75], s39 offen
s_sub_u32 s39, s39, s71
buffer_load_dwordx4 v[148:151], v61, s[72:75], s39 offen
s_sub_u32 s39, s39, s71
buffer_load_dwordx4 v[152:155], v61, s[72:75], s39 offen
s_sub_u32 s39, s39, s71
buffer_load_dwordx4 v[156:159], v61, s[72:75], s39 offen
s_mov_b32 s89, s32
v_and_b32 v1, 63, v0
v_and_b32 v2, 15, v0
v_bfe_u32 v3, v0, 4, 2
v_bfe_u32 v24, v0, 3, 2
v_mad_i32_i24 v24, v24, -2, s33
v_add_u32 v25, 6, v24
v_min_u32 v24, v24, v25
v_min_u32 v25, 2, v24
v_mad_u32_u24 v24, v24, 5, v25
v_and_b32 v63, 7, v0
v_add_u32 v24, v24, v63
v_lshrrev_b32 v62, 1, v24
v_add_u32 v25, v25, v63
v_xor_b32 v62, v62, v24
v_cmp_gt_u32 vcc, 7, v25
v_and_b32 v62, 4, v62
v_mul_u32_u24 v62, 3, v62
v_xor_b32 v62, v62, v24
v_cndmask_b32 v62, 32, v62, vcc
v_lshlrev_b32 v62, 17, v62
s_add_u32 s39, s33, 24
s_lshl_b32 s39, s39, 17
s_waitcnt vmcnt(7)
buffer_load_dwordx4 v[128:131], v61, s[68:71], s39 offen
s_add_u32 s39, s33, 30
s_lshl_b32 s39, s39, 17
s_waitcnt vmcnt(7)
buffer_load_dwordx4 v[132:135], v61, s[68:71], s39 offen
s_add_u32 s39, s33, 16
s_lshl_b32 s39, s39, 17
s_waitcnt vmcnt(7)
buffer_load_dwordx4 v[136:139], v61, s[72:75], s39 offen
s_add_u32 s39, s33, 20
s_sub_u32 s60, s33, 2
s_cmp_lt_u32 s60, 2
s_cselect_b32 s39, s39, 32
s_lshl_b32 s39, s39, 17
s_waitcnt vmcnt(7)
buffer_load_dwordx4 v[140:143], v61, s[72:75], s39 offen
s_barrier
s_lshl_b32 s60, s89, 8
s_sub_u32 s61, 0x400000, s60
s_add_u32 s76, s10, s60
s_addc_u32 s77, s11, 0
s_and_b32 s77, s77, 0xffff
s_mov_b32 s78, s61
s_mov_b32 s79, 0x20000
v_readlane_b32 s39, v62, 16
s_nop 3
s_waitcnt vmcnt(7)
buffer_load_dwordx4 v[144:147], v61, s[76:79], s39 offen
v_readlane_b32 s39, v62, 17
s_nop 3
s_waitcnt vmcnt(7)
buffer_load_dwordx4 v[148:151], v61, s[76:79], s39 offen
v_readlane_b32 s39, v62, 18
s_nop 3
s_waitcnt vmcnt(7)
buffer_load_dwordx4 v[152:155], v61, s[76:79], s39 offen
v_readlane_b32 s39, v62, 19
s_nop 3
s_waitcnt vmcnt(7)
buffer_load_dwordx4 v[156:159], v61, s[76:79], s39 offen
v_readlane_b32 s39, v62, 20
s_nop 3
s_waitcnt vmcnt(7)
buffer_load_dwordx4 v[128:131], v61, s[76:79], s39 offen
v_readlane_b32 s39, v62, 21
s_nop 3
s_waitcnt vmcnt(7)
buffer_load_dwordx4 v[132:135], v61, s[76:79], s39 offen
s_lshl_b32 s35, s33, 2
s_add_u32 s35, s35, s34
s_lshl_b32 s35, s35, 12
s_mov_b32 s36, s35
v_lshlrev_b32 v8, 4, v1
v_add_u32 v9, 0x4000000, v8
s_lshr_b32 s54, s35, 12
s_mov_b32 s57, 0xff
s_sub_u32 s55, s54, 8
s_cselect_b32 s60, 24, 0
s_add_u32 s55, s55, s60
s_sub_u32 s56, s55, 8
s_cselect_b32 s60, 24, 0
s_add_u32 s56, s56, s60
s_lshl_b32 s60, s89, 8
s_sub_u32 s61, 0x400000, s60
s_add_u32 s80, s22, s60
s_addc_u32 s81, s23, 0
s_and_b32 s81, s81, 0xffff
s_mov_b32 s82, s61
s_mov_b32 s83, 0x20000
v_readlane_b32 s39, v62, 0
s_nop 3
s_waitcnt vmcnt(7)
buffer_load_dwordx4 v[136:139], v61, s[80:83], s39 offen
v_readlane_b32 s39, v62, 1
s_nop 3
s_waitcnt vmcnt(7)
buffer_load_dwordx4 v[140:143], v61, s[80:83], s39 offen
v_readlane_b32 s39, v62, 2
s_nop 3
s_waitcnt vmcnt(7)
buffer_load_dwordx4 v[144:147], v61, s[80:83], s39 offen
v_readlane_b32 s39, v62, 3
s_nop 3
s_waitcnt vmcnt(7)
buffer_load_dwordx4 v[148:151], v61, s[80:83], s39 offen
v_and_b32 v24, 1, v0
v_lshlrev_b32 v24, 4, v24
v_mov_b32 v25, 0xffff
v_lshlrev_b32 v24, v24, v25
v_bfe_u32 v25, v0, 1, 2
v_cmp_eq_u32 vcc, 0, v25
s_nop 1
v_cndmask_b32 v4, 0, v24, vcc
v_cmp_eq_u32 vcc, 1, v25
s_nop 1
v_cndmask_b32 v5, 0, v24, vcc
v_cmp_eq_u32 vcc, 2, v25
s_nop 1
v_cndmask_b32 v6, 0, v24, vcc
v_cmp_eq_u32 vcc, 3, v25
s_nop 1
v_cndmask_b32 v7, 0, v24, vcc
v_readlane_b32 s39, v62, 4
s_nop 3
s_waitcnt vmcnt(7)
buffer_load_dwordx4 v[152:155], v61, s[80:83], s39 offen
v_readlane_b32 s39, v62, 5
s_nop 3
s_waitcnt vmcnt(7)
buffer_load_dwordx4 v[156:159], v61, s[80:83], s39 offen
s_lshl_b32 s60, s89, 17
s_mov_b32 s61, 0x20000
s_add_u32 s68, s24, s60
s_addc_u32 s69, s25, 0
s_and_b32 s69, s69, 0xffff
s_mov_b32 s70, s61
s_mov_b32 s71, 0x20000
s_lshr_b32 s58, s55, 2
s_min_u32 s60, s58, 2
s_mul_i32 s59, s58, 5
s_add_u32 s59, s59, s60
s_lshl_b32 s59, s59, 2
s_add_u32 s59, s59, s34
s_lshl_b32 s39, s59, 10
s_waitcnt vmcnt(7)
buffer_load_dwordx4 v[128:131], v8, s[68:71], s39 offen
s_add_u32 s59, s59, 4
s_lshl_b32 s39, s59, 10
s_waitcnt vmcnt(7)
buffer_load_dwordx4 v[132:135], v8, s[68:71], s39 offen
s_lshl_b32 s62, s89, 21
s_sub_u32 s63, 0x8000000, s62
s_add_u32 s40, s6, s62
s_addc_u32 s41, s7, 0
s_and_b32 s41, s41, 0xffff
s_mov_b32 s42, s63
s_mov_b32 s43, 0x20000
s_add_u32 s44, s8, s62
s_addc_u32 s45, s9, 0
s_and_b32 s45, s45, 0xffff
s_mov_b32 s46, s63
s_mov_b32 s47, 0x20000
s_add_u32 s59, s59, 4
s_lshl_b32 s39, s59, 10
s_waitcnt vmcnt(7)
buffer_load_dwordx4 v[136:139], v8, s[68:71], s39 offen
s_add_u32 s59, s59, 4
s_lshl_b32 s39, s59, 10
s_waitcnt vmcnt(7)
buffer_load_dwordx4 v[140:143], v8, s[68:71], s39 offen
s_add_u32 s59, s59, 4
s_lshl_b32 s39, s59, 10
s_waitcnt vmcnt(7)
buffer_load_dwordx4 v[144:147], v8, s[68:71], s39 offen
s_add_u32 s59, s59, 4
s_cmp_lt_u32 s58, 2
s_cselect_b32 s59, s59, 128
s_lshl_b32 s39, s59, 10
s_waitcnt vmcnt(7)
buffer_load_dwordx4 v[148:151], v8, s[68:71], s39 offen
s_mul_i32 s60, s34, 6
s_add_u32 s60, s60, s33
s_lshl_b32 s37, s60, 10
s_add_u32 s37, s37, 0x1f8000
s_mov_b32 s52, 0x555f
s_cmp_lt_u32 s60, 8
s_cselect_b32 s61, 0, 1
s_cselect_b32 s62, 0x200, 0
s_or_b32 s52, s52, s62
s_lshl_b32 s61, s61, 31
s_add_u32 s61, s61, 24576
v_add_u32 v10, s61, v8
s_sub_u32 s60, s60, 8
s_cmp_lt_u32 s60, 8
s_cselect_b32 s61, 0, 1
s_cselect_b32 s62, 0x800, 0
s_or_b32 s52, s52, s62
s_lshl_b32 s61, s61, 31
s_add_u32 s61, s61, 16384
v_add_u32 v11, s61, v9
s_mul_i32 s52, s52, 0x10001
s_mov_b32 s53, s52
s_lshl_b32 s60, s32, 19
s_add_u32 s60, s60, 0x30000
s_mov_b32 s61, 0x50000
s_add_u32 s72, s16, s60
s_addc_u32 s73, s17, 0
s_and_b32 s73, s73, 0xffff
s_mov_b32 s74, s61
s_mov_b32 s75, 0x20000
s_lshr_b32 s58, s56, 2
s_min_u32 s60, s58, 2
s_mul_i32 s59, s58, 13
s_add_u32 s59, s59, s60
s_lshl_b32 s59, s59, 2
s_add_u32 s59, s59, s34
s_lshl_b32 s39, s59, 10
s_waitcnt vmcnt(7)
buffer_load_dwordx4 v[152:155], v8, s[72:75], s39 offen
s_add_u32 s59, s59, 4
s_lshl_b32 s39, s59, 10
s_waitcnt vmcnt(7)
buffer_load_dwordx4 v[156:159], v8, s[72:75], s39 offen
s_add_u32 s59, s59, 4
s_lshl_b32 s39, s59, 10
s_waitcnt vmcnt(7)
buffer_load_dwordx4 v[128:131], v8, s[72:75], s39 offen
s_add_u32 s59, s59, 4
s_lshl_b32 s39, s59, 10
s_waitcnt vmcnt(7)
buffer_load_dwordx4 v[132:135], v8, s[72:75], s39 offen
s_mov_b32 s48, 0xcccccccc
s_mov_b32 s49, 0xcccccccc
s_mov_b32 s50, 0xaaaaaaaa
s_mov_b32 s51, 0xaaaaaaaa
v_cmp_gt_u32 vcc, 8, v2
v_mov_b32 v47, 0
v_mov_b32 v48, 0
v_mov_b32 v49, 0
v_mov_b32 v50, 0
v_mov_b32 v51, 0
v_cndmask_b32 v12, v4, v47, vcc
v_cndmask_b32 v13, v5, v47, vcc
v_cndmask_b32 v14, v6, v47, vcc
v_cndmask_b32 v15, v7, v47, vcc
v_cndmask_b32 v4, v47, v4, vcc
v_cndmask_b32 v5, v47, v5, vcc
v_cndmask_b32 v6, v47, v6, vcc
v_cndmask_b32 v7, v47, v7, vcc
v_lshlrev_b32 v192, 2, v1
v_mov_b32 v193, 1
s_mov_b64 vcc, 0
s_add_u32 s59, s59, 4
s_lshl_b32 s39, s59, 10
s_waitcnt vmcnt(7)
buffer_load_dwordx4 v[136:139], v8, s[72:75], s39 offen
s_add_u32 s59, s59, 4
s_lshl_b32 s39, s59, 10
s_waitcnt vmcnt(7)
buffer_load_dwordx4 v[140:143], v8, s[72:75], s39 offen
s_add_u32 s59, s59, 4
s_lshl_b32 s39, s59, 10
s_waitcnt vmcnt(7)
buffer_load_dwordx4 v[144:147], v8, s[72:75], s39 offen
s_add_u32 s59, s59, 4
s_lshl_b32 s39, s59, 10
s_waitcnt vmcnt(7)
buffer_load_dwordx4 v[148:151], v8, s[72:75], s39 offen
s_add_u32 s59, s59, 4
s_lshl_b32 s39, s59, 10
s_waitcnt vmcnt(7)
buffer_load_dwordx4 v[152:155], v8, s[72:75], s39 offen
s_add_u32 s59, s59, 4
s_lshl_b32 s39, s59, 10
s_waitcnt vmcnt(7)
buffer_load_dwordx4 v[156:159], v8, s[72:75], s39 offen
s_add_u32 s59, s59, 4
s_lshl_b32 s39, s59, 10
s_waitcnt vmcnt(7)
buffer_load_dwordx4 v[128:131], v8, s[72:75], s39 offen
s_add_u32 s59, s59, 4
s_lshl_b32 s39, s59, 10
s_waitcnt vmcnt(7)
buffer_load_dwordx4 v[132:135], v8, s[72:75], s39 offen
s_add_u32 s59, s59, 4
s_lshl_b32 s39, s59, 10
s_waitcnt vmcnt(7)
buffer_load_dwordx4 v[136:139], v8, s[72:75], s39 offen
s_add_u32 s59, s59, 4
s_cmp_lt_u32 s58, 2
s_cselect_b32 s59, s59, 320
s_lshl_b32 s39, s59, 10
s_waitcnt vmcnt(7)
buffer_load_dwordx4 v[140:143], v8, s[72:75], s39 offen
s_waitcnt vmcnt(7)
buffer_load_dwordx4 v[64:67], v8, s[40:43], s36 offen offset:0 nt
s_waitcnt vmcnt(7)
buffer_load_dwordx4 v[68:71], v8, s[40:43], s36 offen offset:1024 nt
s_waitcnt vmcnt(7)
buffer_load_dwordx4 v[72:75], v8, s[40:43], s36 offen offset:2048 nt
s_waitcnt vmcnt(7)
buffer_load_dwordx4 v[76:79], v8, s[40:43], s36 offen offset:3072 nt
s_waitcnt vmcnt(7)
buffer_load_dwordx4 v[80:83], v9, s[40:43], s36 offen offset:0 nt
s_waitcnt vmcnt(7)
buffer_load_dwordx4 v[84:87], v9, s[40:43], s36 offen offset:1024 nt
s_waitcnt vmcnt(7)
buffer_load_dwordx4 v[88:91], v9, s[40:43], s36 offen offset:2048 nt
s_waitcnt vmcnt(7)
buffer_load_dwordx4 v[92:95], v9, s[40:43], s36 offen offset:3072 nt
s_add_u32 s36, s36, 0x18000
s_waitcnt vmcnt(7)
buffer_load_dwordx4 v[96:99], v8, s[40:43], s36 offen offset:0 nt
s_waitcnt vmcnt(7)
buffer_load_dwordx4 v[100:103], v8, s[40:43], s36 offen offset:1024 nt
ds_add_u32 v192, v193 offset:256
s_waitcnt vmcnt(7)
buffer_load_dwordx4 v[104:107], v8, s[40:43], s36 offen offset:2048 nt
s_waitcnt vmcnt(7)
buffer_load_dwordx4 v[108:111], v8, s[40:43], s36 offen offset:3072 nt
ds_add_u32 v192, v193 offset:256
s_waitcnt vmcnt(7)
buffer_load_dwordx4 v[112:115], v9, s[40:43], s36 offen offset:0 nt
s_waitcnt vmcnt(7)
buffer_load_dwordx4 v[116:119], v9, s[40:43], s36 offen offset:1024 nt
ds_add_u32 v192, v193 offset:256
s_waitcnt vmcnt(7)
buffer_load_dwordx4 v[120:123], v9, s[40:43], s36 offen offset:2048 nt
s_waitcnt vmcnt(7)
buffer_load_dwordx4 v[124:127], v9, s[40:43], s36 offen offset:3072 nt
ds_add_u32 v192, v193 offset:256
s_add_u32 s36, s36, 0x18000
s_waitcnt vmcnt(7)
buffer_load_dwordx4 v[128:131], v8, s[40:43], s36 offen offset:0 nt
s_waitcnt vmcnt(7)
buffer_load_dwordx4 v[132:135], v8, s[40:43], s36 offen offset:1024 nt
ds_add_u32 v192, v193 offset:256
s_waitcnt vmcnt(7)
buffer_load_dwordx4 v[136:139], v8, s[40:43], s36 offen offset:2048 nt
s_waitcnt vmcnt(7)
buffer_load_dwordx4 v[140:143], v8, s[40:43], s36 offen offset:3072 nt
ds_add_u32 v192, v193 offset:256
s_waitcnt vmcnt(7)
buffer_load_dwordx4 v[144:147], v9, s[40:43], s36 offen offset:0 nt
s_waitcnt vmcnt(7)
buffer_load_dwordx4 v[148:151], v9, s[40:43], s36 offen offset:1024 nt
ds_add_u32 v192, v193 offset:256
s_waitcnt vmcnt(7)
buffer_load_dwordx4 v[152:155], v9, s[40:43], s36 offen offset:2048 nt
s_waitcnt vmcnt(7)
buffer_load_dwordx4 v[156:159], v9, s[40:43], s36 offen offset:3072 nt
ds_add_u32 v192, v193 offset:256
s_add_u32 s36, s36, 0x18000
s_waitcnt vmcnt(7)
buffer_load_dwordx4 v[160:163], v8, s[40:43], s36 offen offset:0 nt
s_waitcnt vmcnt(7)
buffer_load_dwordx4 v[164:167], v8, s[40:43], s36 offen offset:1024 nt
ds_add_u32 v192, v193 offset:256
s_waitcnt vmcnt(7)
buffer_load_dwordx4 v[168:171], v8, s[40:43], s36 offen offset:2048 nt
s_waitcnt vmcnt(7)
buffer_load_dwordx4 v[172:175], v8, s[40:43], s36 offen offset:3072 nt
ds_add_u32 v192, v193 offset:256
s_waitcnt vmcnt(7)
buffer_load_dwordx4 v[176:179], v9, s[40:43], s36 offen offset:0 nt
s_waitcnt vmcnt(7)
buffer_load_dwordx4 v[180:183], v9, s[40:43], s36 offen offset:1024 nt
ds_add_u32 v192, v193 offset:256
s_waitcnt vmcnt(7)
buffer_load_dwordx4 v[184:187], v9, s[40:43], s36 offen offset:2048 nt
s_waitcnt vmcnt(7)
buffer_load_dwordx4 v[188:191], v9, s[40:43], s36 offen offset:3072 nt
ds_add_u32 v192, v193 offset:256
v_lshlrev_b32 v61, 4, v2
s_mov_b32 s64, 0
L_A_qw:
ds_read_b32 v60, v47 offset:0
s_waitcnt lgkmcnt(0)
v_readfirstlane_b32 s65, v60
s_add_u32 s64, s64, 1
s_nop 2
s_cmp_ge_u32 s65, 1
s_cbranch_scc1 L_A_qw_ok
s_sleep 1
s_cmp_lt_u32 s64, 1048576
s_cbranch_scc1 L_A_qw
L_A_qw_ok:
v_lshlrev_b32 v60, 5, v2
ds_read_b128 v[16:19], v61 offset:1024
ds_read_b128 v[20:23], v61 offset:1280
s_waitcnt lgkmcnt(0)
v_dot2_f32_bf16 v24, v64, v16, 0
v_dot2_f32_bf16 v24, v65, v17, v24
v_dot2_f32_bf16 v24, v66, v18, v24
v_dot2_f32_bf16 v24, v67, v19, v24
s_waitcnt vmcnt(6)
s_add_u32 s36, s36, 0x18000
buffer_load_dwordx4 v[64:67], v8, s[40:43], s36 offen offset:0 nt
v_dot2_f32_bf16 v25, v68, v16, 0
v_dot2_f32_bf16 v25, v69, v17, v25
v_dot2_f32_bf16 v25, v70, v18, v25
v_dot2_f32_bf16 v25, v71, v19, v25
s_waitcnt vmcnt(6)
buffer_load_dwordx4 v[68:71], v8, s[40:43], s36 offen offset:1024 nt
ds_add_u32 v192, v193 offset:256
v_add_f32_dpp v28, v24, v24 row_ror:8 row_mask:0xf bank_mask:0x3
v_dot2_f32_bf16 v26, v72, v16, 0
v_dot2_f32_bf16 v26, v73, v17, v26
v_dot2_f32_bf16 v26, v74, v18, v26
v_dot2_f32_bf16 v26, v75, v19, v26
v_add_f32_dpp v28, v25, v25 row_ror:8 row_mask:0xf bank_mask:0xc
s_waitcnt vmcnt(6)
buffer_load_dwordx4 v[72:75], v8, s[40:43], s36 offen offset:2048 nt
v_dot2_f32_bf16 v27, v76, v16, 0
v_dot2_f32_bf16 v27, v77, v17, v27
v_dot2_f32_bf16 v27, v78, v18, v27
v_dot2_f32_bf16 v27, v79, v19, v27
s_waitcnt vmcnt(6)
buffer_load_dwordx4 v[76:79], v8, s[40:43], s36 offen offset:3072 nt
ds_add_u32 v192, v193 offset:256
v_add_f32_dpp v29, v26, v26 row_ror:8 row_mask:0xf bank_mask:0x3
v_dot2_f32_bf16 v24, v80, v20, 0
v_dot2_f32_bf16 v24, v81, v21, v24
v_dot2_f32_bf16 v24, v82, v22, v24
v_dot2_f32_bf16 v24, v83, v23, v24
v_add_f32_dpp v29, v27, v27 row_ror:8 row_mask:0xf bank_mask:0xc
s_waitcnt vmcnt(6)
buffer_load_dwordx4 v[80:83], v9, s[40:43], s36 offen offset:0 nt
v_add_f32_dpp v30, v28, v28 row_shl:4 row_mask:0xf bank_mask:0x5
v_dot2_f32_bf16 v25, v84, v20, 0
v_dot2_f32_bf16 v25, v85, v21, v25
v_dot2_f32_bf16 v25, v86, v22, v25
v_dot2_f32_bf16 v25, v87, v23, v25
v_add_f32_dpp v30, v29, v29 row_shr:4 row_mask:0xf bank_mask:0xa
s_waitcnt vmcnt(6)
buffer_load_dwordx4 v[84:87], v9, s[40:43], s36 offen offset:1024 nt
ds_add_u32 v192, v193 offset:256
v_add_f32_dpp v28, v24, v24 row_ror:8 row_mask:0xf bank_mask:0x3
v_dot2_f32_bf16 v26, v88, v20, 0
v_dot2_f32_bf16 v26, v89, v21, v26
v_dot2_f32_bf16 v26, v90, v22, v26
v_dot2_f32_bf16 v26, v91, v23, v26
v_add_f32_dpp v28, v25, v25 row_ror:8 row_mask:0xf bank_mask:0xc
s_waitcnt vmcnt(6)
buffer_load_dwordx4 v[88:91], v9, s[40:43], s36 offen offset:2048 nt
v_dot2_f32_bf16 v27, v92, v20, 0
v_dot2_f32_bf16 v27, v93, v21, v27
v_dot2_f32_bf16 v27, v94, v22, v27
v_dot2_f32_bf16 v27, v95, v23, v27
v_add_f32_dpp v29, v26, v26 row_ror:8 row_mask:0xf bank_mask:0x3
v_dot2_f32_bf16 v24, v96, v16, 0
v_dot2_f32_bf16 v24, v97, v17, v24
v_dot2_f32_bf16 v24, v98, v18, v24
v_dot2_f32_bf16 v24, v99, v19, v24
v_add_f32_dpp v29, v27, v27 row_ror:8 row_mask:0xf bank_mask:0xc
v_add_f32_dpp v31, v28, v28 row_shl:4 row_mask:0xf bank_mask:0x5
v_dot2_f32_bf16 v25, v100, v16, 0
v_dot2_f32_bf16 v25, v101, v17, v25
v_dot2_f32_bf16 v25, v102, v18, v25
v_dot2_f32_bf16 v25, v103, v19, v25
v_add_f32_dpp v31, v29, v29 row_shr:4 row_mask:0xf bank_mask:0xa
s_waitcnt vmcnt(6)
buffer_load_dwordx4 v[92:95], v9, s[40:43], s36 offen offset:3072 nt
ds_add_u32 v192, v193 offset:256
v_add_f32_dpp v34, v30, v30 quad_perm:[2,3,0,1] row_mask:0xf bank_mask:0xf
v_add_f32_dpp v28, v24, v24 row_ror:8 row_mask:0xf bank_mask:0x3
v_dot2_f32_bf16 v26, v104, v16, 0
v_dot2_f32_bf16 v26, v105, v17, v26
v_dot2_f32_bf16 v26, v106, v18, v26
v_dot2_f32_bf16 v26, v107, v19, v26
v_add_f32_dpp v35, v31, v31 quad_perm:[2,3,0,1] row_mask:0xf bank_mask:0xf
v_cndmask_b32 v32, v34, v35, s[48:49]
v_add_f32_dpp v28, v25, v25 row_ror:8 row_mask:0xf bank_mask:0xc
v_dot2_f32_bf16 v27, v108, v16, 0
v_dot2_f32_bf16 v27, v109, v17, v27
v_dot2_f32_bf16 v27, v110, v18, v27
v_dot2_f32_bf16 v27, v111, v19, v27
v_add_f32_dpp v29, v26, v26 row_ror:8 row_mask:0xf bank_mask:0x3
v_dot2_f32_bf16 v24, v112, v20, 0
v_dot2_f32_bf16 v24, v113, v21, v24
v_dot2_f32_bf16 v24, v114, v22, v24
v_dot2_f32_bf16 v24, v115, v23, v24
v_add_f32_dpp v29, v27, v27 row_ror:8 row_mask:0xf bank_mask:0xc
s_waitcnt vmcnt(6)
s_add_u32 s36, s36, 0x18000
buffer_load_dwordx4 v[96:99], v8, s[40:43], s36 offen offset:0 nt
v_add_f32_dpp v30, v28, v28 row_shl:4 row_mask:0xf bank_mask:0x5
v_dot2_f32_bf16 v25, v116, v20, 0
v_dot2_f32_bf16 v25, v117, v21, v25
v_dot2_f32_bf16 v25, v118, v22, v25
v_dot2_f32_bf16 v25, v119, v23, v25
v_add_f32_dpp v30, v29, v29 row_shr:4 row_mask:0xf bank_mask:0xa
v_add_f32_dpp v28, v24, v24 row_ror:8 row_mask:0xf bank_mask:0x3
v_dot2_f32_bf16 v26, v120, v20, 0
v_dot2_f32_bf16 v26, v121, v21, v26
v_dot2_f32_bf16 v26, v122, v22, v26
v_dot2_f32_bf16 v26, v123, v23, v26
v_add_f32_dpp v28, v25, v25 row_ror:8 row_mask:0xf bank_mask:0xc
v_dot2_f32_bf16 v27, v124, v20, 0
v_dot2_f32_bf16 v27, v125, v21, v27
v_dot2_f32_bf16 v27, v126, v22, v27
v_dot2_f32_bf16 v27, v127, v23, v27
s_waitcnt vmcnt(6)
buffer_load_dwordx4 v[100:103], v8, s[40:43], s36 offen offset:1024 nt
ds_add_u32 v192, v193 offset:256
v_add_f32_dpp v29, v26, v26 row_ror:8 row_mask:0xf bank_mask:0x3
v_dot2_f32_bf16 v24, v128, v16, 0
v_dot2_f32_bf16 v24, v129, v17, v24
v_dot2_f32_bf16 v24, v130, v18, v24
v_dot2_f32_bf16 v24, v131, v19, v24
v_add_f32_dpp v29, v27, v27 row_ror:8 row_mask:0xf bank_mask:0xc
v_add_f32_dpp v31, v28, v28 row_shl:4 row_mask:0xf bank_mask:0x5
v_dot2_f32_bf16 v25, v132, v16, 0
v_dot2_f32_bf16 v25, v133, v17, v25
v_dot2_f32_bf16 v25, v134, v18, v25
v_dot2_f32_bf16 v25, v135, v19, v25
v_add_f32_dpp v31, v29, v29 row_shr:4 row_mask:0xf bank_mask:0xa
v_add_f32_dpp v34, v30, v30 quad_perm:[2,3,0,1] row_mask:0xf bank_mask:0xf
v_add_f32_dpp v28, v24, v24 row_ror:8 row_mask:0xf bank_mask:0x3
v_dot2_f32_bf16 v26, v136, v16, 0
v_dot2_f32_bf16 v26, v137, v17, v26
v_dot2_f32_bf16 v26, v138, v18, v26
v_dot2_f32_bf16 v26, v139, v19, v26
v_add_f32_dpp v35, v31, v31 quad_perm:[2,3,0,1] row_mask:0xf bank_mask:0xf
v_cndmask_b32 v33, v34, v35, s[48:49]
v_add_f32_dpp v28, v25, v25 row_ror:8 row_mask:0xf bank_mask:0xc
s_waitcnt vmcnt(6)
buffer_load_dwordx4 v[104:107], v8, s[40:43], s36 offen offset:2048 nt
v_add_f32_dpp v34, v32, v32 quad_perm:[1,0,3,2] row_mask:0xf bank_mask:0xf
v_mov_b32 v36, v37
v_mov_b32 v37, v38
v_mov_b32 v38, v39
v_mov_b32 v39, v40
v_mov_b32 v40, v41
v_mov_b32 v41, v42
v_mov_b32 v42, v43
v_mov_b32 v43, v44
v_mov_b32 v44, v45
v_mov_b32 v45, v46
v_dot2_f32_bf16 v27, v140, v16, 0
v_dot2_f32_bf16 v27, v141, v17, v27
v_dot2_f32_bf16 v27, v142, v18, v27
v_dot2_f32_bf16 v27, v143, v19, v27
v_add_f32_dpp v35, v33, v33 quad_perm:[1,0,3,2] row_mask:0xf bank_mask:0xf
v_cndmask_b32 v46, v34, v35, s[50:51]
v_add_f32_dpp v29, v26, v26 row_ror:8 row_mask:0xf bank_mask:0x3
v_dot2_f32_bf16 v24, v144, v20, 0
v_dot2_f32_bf16 v24, v145, v21, v24
v_dot2_f32_bf16 v24, v146, v22, v24
v_dot2_f32_bf16 v24, v147, v23, v24
v_add_f32_dpp v29, v27, v27 row_ror:8 row_mask:0xf bank_mask:0xc
v_add_f32_dpp v30, v28, v28 row_shl:4 row_mask:0xf bank_mask:0x5
v_dot2_f32_bf16 v25, v148, v20, 0
v_dot2_f32_bf16 v25, v149, v21, v25
v_dot2_f32_bf16 v25, v150, v22, v25
v_dot2_f32_bf16 v25, v151, v23, v25
v_add_f32_dpp v30, v29, v29 row_shr:4 row_mask:0xf bank_mask:0xa
s_waitcnt vmcnt(6)
buffer_load_dwordx4 v[108:111], v8, s[40:43], s36 offen offset:3072 nt
ds_add_u32 v192, v193 offset:256
v_add_f32_dpp v28, v24, v24 row_ror:8 row_mask:0xf bank_mask:0x3
v_dot2_f32_bf16 v26, v152, v20, 0
v_dot2_f32_bf16 v26, v153, v21, v26
v_dot2_f32_bf16 v26, v154, v22, v26
v_dot2_f32_bf16 v26, v155, v23, v26
v_add_f32_dpp v28, v25, v25 row_ror:8 row_mask:0xf bank_mask:0xc
v_dot2_f32_bf16 v27, v156, v20, 0
v_dot2_f32_bf16 v27, v157, v21, v27
v_dot2_f32_bf16 v27, v158, v22, v27
v_dot2_f32_bf16 v27, v159, v23, v27
v_add_f32_dpp v29, v26, v26 row_ror:8 row_mask:0xf bank_mask:0x3
v_dot2_f32_bf16 v24, v160, v16, 0
v_dot2_f32_bf16 v24, v161, v17, v24
v_dot2_f32_bf16 v24, v162, v18, v24
v_dot2_f32_bf16 v24, v163, v19, v24
v_add_f32_dpp v29, v27, v27 row_ror:8 row_mask:0xf bank_mask:0xc
s_waitcnt vmcnt(6)
buffer_load_dwordx4 v[112:115], v9, s[40:43], s36 offen offset:0 nt
v_add_f32_dpp v31, v28, v28 row_shl:4 row_mask:0xf bank_mask:0x5
v_dot2_f32_bf16 v25, v164, v16, 0
v_dot2_f32_bf16 v25, v165, v17, v25
v_dot2_f32_bf16 v25, v166, v18, v25
v_dot2_f32_bf16 v25, v167, v19, v25
v_add_f32_dpp v31, v29, v29 row_shr:4 row_mask:0xf bank_mask:0xa
v_add_f32_dpp v34, v30, v30 quad_perm:[2,3,0,1] row_mask:0xf bank_mask:0xf
v_add_f32_dpp v28, v24, v24 row_ror:8 row_mask:0xf bank_mask:0x3
v_dot2_f32_bf16 v26, v168, v16, 0
v_dot2_f32_bf16 v26, v169, v17, v26
v_dot2_f32_bf16 v26, v170, v18, v26
v_dot2_f32_bf16 v26, v171, v19, v26
v_add_f32_dpp v35, v31, v31 quad_perm:[2,3,0,1] row_mask:0xf bank_mask:0xf
v_cndmask_b32 v32, v34, v35, s[48:49]
v_add_f32_dpp v28, v25, v25 row_ror:8 row_mask:0xf bank_mask:0xc
v_dot2_f32_bf16 v27, v172, v16, 0
v_dot2_f32_bf16 v27, v173, v17, v27
v_dot2_f32_bf16 v27, v174, v18, v27
v_dot2_f32_bf16 v27, v175, v19, v27
s_waitcnt vmcnt(6)
buffer_load_dwordx4 v[116:119], v9, s[40:43], s36 offen offset:1024 nt
ds_add_u32 v192, v193 offset:256
v_add_f32_dpp v29, v26, v26 row_ror:8 row_mask:0xf bank_mask:0x3
v_dot2_f32_bf16 v24, v176, v20, 0
v_dot2_f32_bf16 v24, v177, v21, v24
v_dot2_f32_bf16 v24, v178, v22, v24
v_dot2_f32_bf16 v24, v179, v23, v24
v_add_f32_dpp v29, v27, v27 row_ror:8 row_mask:0xf bank_mask:0xc
v_add_f32_dpp v30, v28, v28 row_shl:4 row_mask:0xf bank_mask:0x5
v_dot2_f32_bf16 v25, v180, v20, 0
v_dot2_f32_bf16 v25, v181, v21, v25
v_dot2_f32_bf16 v25, v182, v22, v25
v_dot2_f32_bf16 v25, v183, v23, v25
v_add_f32_dpp v30, v29, v29 row_shr:4 row_mask:0xf bank_mask:0xa
v_add_f32_dpp v28, v24, v24 row_ror:8 row_mask:0xf bank_mask:0x3
v_dot2_f32_bf16 v26, v184, v20, 0
v_dot2_f32_bf16 v26, v185, v21, v26
v_dot2_f32_bf16 v26, v186, v22, v26
v_dot2_f32_bf16 v26, v187, v23, v26
v_add_f32_dpp v28, v25, v25 row_ror:8 row_mask:0xf bank_mask:0xc
s_waitcnt vmcnt(6)
buffer_load_dwordx4 v[120:123], v9, s[40:43], s36 offen offset:2048 nt
v_dot2_f32_bf16 v27, v188, v20, 0
v_dot2_f32_bf16 v27, v189, v21, v27
v_dot2_f32_bf16 v27, v190, v22, v27
v_dot2_f32_bf16 v27, v191, v23, v27
v_add_f32_dpp v29, v26, v26 row_ror:8 row_mask:0xf bank_mask:0x3
v_dot2_f32_bf16 v24, v64, v16, 0
v_dot2_f32_bf16 v24, v65, v17, v24
v_dot2_f32_bf16 v24, v66, v18, v24
v_dot2_f32_bf16 v24, v67, v19, v24
v_add_f32_dpp v29, v27, v27 row_ror:8 row_mask:0xf bank_mask:0xc
v_add_f32_dpp v31, v28, v28 row_shl:4 row_mask:0xf bank_mask:0x5
v_dot2_f32_bf16 v25, v68, v16, 0
v_dot2_f32_bf16 v25, v69, v17, v25
v_dot2_f32_bf16 v25, v70, v18, v25
v_dot2_f32_bf16 v25, v71, v19, v25
v_add_f32_dpp v31, v29, v29 row_shr:4 row_mask:0xf bank_mask:0xa
s_waitcnt vmcnt(6)
buffer_load_dwordx4 v[124:127], v9, s[40:43], s36 offen offset:3072 nt
ds_add_u32 v192, v193 offset:256
v_add_f32_dpp v34, v30, v30 quad_perm:[2,3,0,1] row_mask:0xf bank_mask:0xf
v_add_f32_dpp v28, v24, v24 row_ror:8 row_mask:0xf bank_mask:0x3
v_dot2_f32_bf16 v26, v72, v16, 0
v_dot2_f32_bf16 v26, v73, v17, v26
v_dot2_f32_bf16 v26, v74, v18, v26
v_dot2_f32_bf16 v26, v75, v19, v26
v_add_f32_dpp v35, v31, v31 quad_perm:[2,3,0,1] row_mask:0xf bank_mask:0xf
v_cndmask_b32 v33, v34, v35, s[48:49]
v_add_f32_dpp v28, v25, v25 row_ror:8 row_mask:0xf bank_mask:0xc
v_add_f32_dpp v34, v32, v32 quad_perm:[1,0,3,2] row_mask:0xf bank_mask:0xf
v_mov_b32 v36, v37
v_mov_b32 v37, v38
v_mov_b32 v38, v39
v_mov_b32 v39, v40
v_mov_b32 v40, v41
v_mov_b32 v41, v42
v_mov_b32 v42, v43
v_mov_b32 v43, v44
v_mov_b32 v44, v45
v_mov_b32 v45, v46
v_dot2_f32_bf16 v27, v76, v16, 0
v_dot2_f32_bf16 v27, v77, v17, v27
v_dot2_f32_bf16 v27, v78, v18, v27
v_dot2_f32_bf16 v27, v79, v19, v27
v_add_f32_dpp v35, v33, v33 quad_perm:[1,0,3,2] row_mask:0xf bank_mask:0xf
v_cndmask_b32 v46, v34, v35, s[50:51]
v_add_f32_dpp v29, v26, v26 row_ror:8 row_mask:0xf bank_mask:0x3
v_dot2_f32_bf16 v24, v80, v20, 0
v_dot2_f32_bf16 v24, v81, v21, v24
v_dot2_f32_bf16 v24, v82, v22, v24
v_dot2_f32_bf16 v24, v83, v23, v24
v_add_f32_dpp v29, v27, v27 row_ror:8 row_mask:0xf bank_mask:0xc
s_waitcnt vmcnt(6)
s_add_u32 s36, s36, 0x18000
buffer_load_dwordx4 v[64:67], v8, s[40:43], s36 offen offset:0 nt
v_add_f32_dpp v30, v28, v28 row_shl:4 row_mask:0xf bank_mask:0x5
v_dot2_f32_bf16 v25, v84, v20, 0
v_dot2_f32_bf16 v25, v85, v21, v25
v_dot2_f32_bf16 v25, v86, v22, v25
v_dot2_f32_bf16 v25, v87, v23, v25
v_add_f32_dpp v30, v29, v29 row_shr:4 row_mask:0xf bank_mask:0xa
v_add_f32_dpp v28, v24, v24 row_ror:8 row_mask:0xf bank_mask:0x3
v_dot2_f32_bf16 v26, v88, v20, 0
v_dot2_f32_bf16 v26, v89, v21, v26
v_dot2_f32_bf16 v26, v90, v22, v26
v_dot2_f32_bf16 v26, v91, v23, v26
v_add_f32_dpp v28, v25, v25 row_ror:8 row_mask:0xf bank_mask:0xc
v_dot2_f32_bf16 v27, v92, v20, 0
v_dot2_f32_bf16 v27, v93, v21, v27
v_dot2_f32_bf16 v27, v94, v22, v27
v_dot2_f32_bf16 v27, v95, v23, v27
s_waitcnt vmcnt(6)
buffer_load_dwordx4 v[68:71], v8, s[40:43], s36 offen offset:1024 nt
ds_add_u32 v192, v193 offset:256
v_add_f32_dpp v29, v26, v26 row_ror:8 row_mask:0xf bank_mask:0x3
v_dot2_f32_bf16 v24, v96, v16, 0
v_dot2_f32_bf16 v24, v97, v17, v24
v_dot2_f32_bf16 v24, v98, v18, v24
v_dot2_f32_bf16 v24, v99, v19, v24
v_add_f32_dpp v29, v27, v27 row_ror:8 row_mask:0xf bank_mask:0xc
v_add_f32_dpp v31, v28, v28 row_shl:4 row_mask:0xf bank_mask:0x5
v_dot2_f32_bf16 v25, v100, v16, 0
v_dot2_f32_bf16 v25, v101, v17, v25
v_dot2_f32_bf16 v25, v102, v18, v25
v_dot2_f32_bf16 v25, v103, v19, v25
v_add_f32_dpp v31, v29, v29 row_shr:4 row_mask:0xf bank_mask:0xa
s_waitcnt vmcnt(6)
buffer_load_dwordx4 v[72:75], v8, s[40:43], s36 offen offset:2048 nt
v_add_f32_dpp v34, v30, v30 quad_perm:[2,3,0,1] row_mask:0xf bank_mask:0xf
v_add_f32_dpp v28, v24, v24 row_ror:8 row_mask:0xf bank_mask:0x3
v_dot2_f32_bf16 v26, v104, v16, 0
v_dot2_f32_bf16 v26, v105, v17, v26
v_dot2_f32_bf16 v26, v106, v18, v26
v_dot2_f32_bf16 v26, v107, v19, v26
v_add_f32_dpp v35, v31, v31 quad_perm:[2,3,0,1] row_mask:0xf bank_mask:0xf
v_cndmask_b32 v32, v34, v35, s[48:49]
v_add_f32_dpp v28, v25, v25 row_ror:8 row_mask:0xf bank_mask:0xc
s_waitcnt vmcnt(6)
buffer_load_dwordx4 v[76:79], v8, s[40:43], s36 offen offset:3072 nt
ds_add_u32 v192, v193 offset:256
v_dot2_f32_bf16 v27, v108, v16, 0
v_dot2_f32_bf16 v27, v109, v17, v27
v_dot2_f32_bf16 v27, v110, v18, v27
v_dot2_f32_bf16 v27, v111, v19, v27
s_waitcnt vmcnt(6)
buffer_load_dwordx4 v[80:83], v9, s[40:43], s36 offen offset:0 nt
v_add_f32_dpp v29, v26, v26 row_ror:8 row_mask:0xf bank_mask:0x3
v_dot2_f32_bf16 v24, v112, v20, 0
v_dot2_f32_bf16 v24, v113, v21, v24
v_dot2_f32_bf16 v24, v114, v22, v24
v_dot2_f32_bf16 v24, v115, v23, v24
v_add_f32_dpp v29, v27, v27 row_ror:8 row_mask:0xf bank_mask:0xc
s_waitcnt vmcnt(6)
buffer_load_dwordx4 v[84:87], v9, s[40:43], s36 offen offset:1024 nt
ds_add_u32 v192, v193 offset:256
v_add_f32_dpp v30, v28, v28 row_shl:4 row_mask:0xf bank_mask:0x5
v_dot2_f32_bf16 v25, v116, v20, 0
v_dot2_f32_bf16 v25, v117, v21, v25
v_dot2_f32_bf16 v25, v118, v22, v25
v_dot2_f32_bf16 v25, v119, v23, v25
v_add_f32_dpp v30, v29, v29 row_shr:4 row_mask:0xf bank_mask:0xa
s_waitcnt vmcnt(6)
buffer_load_dwordx4 v[88:91], v9, s[40:43], s36 offen offset:2048 nt
v_add_f32_dpp v28, v24, v24 row_ror:8 row_mask:0xf bank_mask:0x3
v_dot2_f32_bf16 v26, v120, v20, 0
v_dot2_f32_bf16 v26, v121, v21, v26
v_dot2_f32_bf16 v26, v122, v22, v26
v_dot2_f32_bf16 v26, v123, v23, v26
v_add_f32_dpp v28, v25, v25 row_ror:8 row_mask:0xf bank_mask:0xc
s_waitcnt vmcnt(6)
buffer_load_dwordx4 v[92:95], v9, s[40:43], s36 offen offset:3072 nt
ds_add_u32 v192, v193 offset:256
v_dot2_f32_bf16 v27, v124, v20, 0
v_dot2_f32_bf16 v27, v125, v21, v27
v_dot2_f32_bf16 v27, v126, v22, v27
v_dot2_f32_bf16 v27, v127, v23, v27
s_mov_b32 s38, 7
.p2align 6
L_A_ka:
s_cbranch_vccnz L_A_w1
s_waitcnt vmcnt(6)
L_A_w1:
s_waitcnt vmcnt(7)
s_add_u32 s36, s36, 0x18000
buffer_load_dwordx4 v[96:99], v8, s[40:43], s36 offen offset:0 nt
ds_read_b32 v194, v47 offset:8
v_add_f32_dpp v29, v26, v26 row_ror:8 row_mask:0xf bank_mask:0x3
v_dot2_f32_bf16 v24, v64, v16, 0
v_dot2_f32_bf16 v24, v65, v17, v24
v_dot2_f32_bf16 v24, v66, v18, v24
v_dot2_f32_bf16 v24, v67, v19, v24
v_add_f32_dpp v29, v27, v27 row_ror:8 row_mask:0xf bank_mask:0xc
s_cbranch_vccnz L_A_w2
s_waitcnt vmcnt(6)
L_A_w2:
s_waitcnt vmcnt(7)
buffer_load_dwordx4 v[100:103], v8, s[40:43], s36 offen offset:1024 nt
ds_add_u32 v192, v193 offset:256
s_waitcnt lgkmcnt(1)
v_cmp_ne_u32 vcc, 0, v194
v_add_f32_dpp v31, v28, v28 row_shl:4 row_mask:0xf bank_mask:0x5
v_dot2_f32_bf16 v25, v68, v16, 0
v_dot2_f32_bf16 v25, v69, v17, v25
v_dot2_f32_bf16 v25, v70, v18, v25
v_dot2_f32_bf16 v25, v71, v19, v25
v_add_f32_dpp v31, v29, v29 row_shr:4 row_mask:0xf bank_mask:0xa
s_cbranch_vccnz L_A_w3
s_waitcnt vmcnt(6)
L_A_w3:
s_waitcnt vmcnt(7)
buffer_load_dwordx4 v[104:107], v8, s[40:43], s36 offen offset:2048 nt
v_add_f32_dpp v34, v30, v30 quad_perm:[2,3,0,1] row_mask:0xf bank_mask:0xf
v_add_f32_dpp v28, v24, v24 row_ror:8 row_mask:0xf bank_mask:0x3
v_dot2_f32_bf16 v26, v72, v16, 0
v_dot2_f32_bf16 v26, v73, v17, v26
v_dot2_f32_bf16 v26, v74, v18, v26
v_dot2_f32_bf16 v26, v75, v19, v26
v_add_f32_dpp v35, v31, v31 quad_perm:[2,3,0,1] row_mask:0xf bank_mask:0xf
v_cndmask_b32 v33, v34, v35, s[48:49]
v_add_f32_dpp v28, v25, v25 row_ror:8 row_mask:0xf bank_mask:0xc
s_cbranch_vccnz L_A_w4
s_waitcnt vmcnt(6)
L_A_w4:
s_waitcnt vmcnt(7)
buffer_load_dwordx4 v[108:111], v8, s[40:43], s36 offen offset:3072 nt
ds_add_u32 v192, v193 offset:256
v_add_f32_dpp v34, v32, v32 quad_perm:[1,0,3,2] row_mask:0xf bank_mask:0xf
v_mov_b32 v36, v37
v_mov_b32 v37, v38
v_mov_b32 v38, v39
v_mov_b32 v39, v40
v_mov_b32 v40, v41
v_mov_b32 v41, v42
v_mov_b32 v42, v43
v_mov_b32 v43, v44
v_mov_b32 v44, v45
v_mov_b32 v45, v46
v_dot2_f32_bf16 v27, v76, v16, 0
v_dot2_f32_bf16 v27, v77, v17, v27
v_dot2_f32_bf16 v27, v78, v18, v27
v_dot2_f32_bf16 v27, v79, v19, v27
v_add_f32_dpp v35, v33, v33 quad_perm:[1,0,3,2] row_mask:0xf bank_mask:0xf
v_cndmask_b32 v46, v34, v35, s[50:51]
s_cbranch_vccnz L_A_w5
s_waitcnt vmcnt(6)
L_A_w5:
s_waitcnt vmcnt(7)
buffer_load_dwordx4 v[112:115], v9, s[40:43], s36 offen offset:0 nt
v_add_f32_dpp v29, v26, v26 row_ror:8 row_mask:0xf bank_mask:0x3
v_dot2_f32_bf16 v24, v80, v20, 0
v_dot2_f32_bf16 v24, v81, v21, v24
v_dot2_f32_bf16 v24, v82, v22, v24
v_dot2_f32_bf16 v24, v83, v23, v24
v_add_f32_dpp v29, v27, v27 row_ror:8 row_mask:0xf bank_mask:0xc
s_cbranch_vccnz L_A_w6
s_waitcnt vmcnt(6)
L_A_w6:
s_waitcnt vmcnt(7)
buffer_load_dwordx4 v[116:119], v9, s[40:43], s36 offen offset:1024 nt
ds_add_u32 v192, v193 offset:256
v_add_f32_dpp v30, v28, v28 row_shl:4 row_mask:0xf bank_mask:0x5
v_dot2_f32_bf16 v25, v84, v20, 0
v_dot2_f32_bf16 v25, v85, v21, v25
v_dot2_f32_bf16 v25, v86, v22, v25
v_dot2_f32_bf16 v25, v87, v23, v25
v_add_f32_dpp v30, v29, v29 row_shr:4 row_mask:0xf bank_mask:0xa
s_cbranch_vccnz L_A_w7
s_waitcnt vmcnt(6)
L_A_w7:
s_waitcnt vmcnt(7)
buffer_load_dwordx4 v[120:123], v9, s[40:43], s36 offen offset:2048 nt
v_add_f32_dpp v28, v24, v24 row_ror:8 row_mask:0xf bank_mask:0x3
v_dot2_f32_bf16 v26, v88, v20, 0
v_dot2_f32_bf16 v26, v89, v21, v26
v_dot2_f32_bf16 v26, v90, v22, v26
v_dot2_f32_bf16 v26, v91, v23, v26
v_add_f32_dpp v28, v25, v25 row_ror:8 row_mask:0xf bank_mask:0xc
s_cbranch_vccnz L_A_w8
s_waitcnt vmcnt(6)
L_A_w8:
s_waitcnt vmcnt(7)
buffer_load_dwordx4 v[124:127], v9, s[40:43], s36 offen offset:3072 nt
ds_add_u32 v192, v193 offset:256
v_dot2_f32_bf16 v27, v92, v20, 0
v_dot2_f32_bf16 v27, v93, v21, v27
v_dot2_f32_bf16 v27, v94, v22, v27
v_dot2_f32_bf16 v27, v95, v23, v27
s_cbranch_vccnz L_A_w9
s_waitcnt vmcnt(6)
L_A_w9:
s_waitcnt vmcnt(7)
s_add_u32 s36, s36, 0x18000
buffer_load_dwordx4 v[64:67], v8, s[40:43], s36 offen offset:0 nt
ds_read_b32 v194, v47 offset:8
v_add_f32_dpp v29, v26, v26 row_ror:8 row_mask:0xf bank_mask:0x3
v_dot2_f32_bf16 v24, v96, v16, 0
v_dot2_f32_bf16 v24, v97, v17, v24
v_dot2_f32_bf16 v24, v98, v18, v24
v_dot2_f32_bf16 v24, v99, v19, v24
v_add_f32_dpp v29, v27, v27 row_ror:8 row_mask:0xf bank_mask:0xc
s_cbranch_vccnz L_A_w10
s_waitcnt vmcnt(6)
L_A_w10:
s_waitcnt vmcnt(7)
buffer_load_dwordx4 v[68:71], v8, s[40:43], s36 offen offset:1024 nt
ds_add_u32 v192, v193 offset:256
s_waitcnt lgkmcnt(1)
v_cmp_ne_u32 vcc, 0, v194
v_add_f32_dpp v31, v28, v28 row_shl:4 row_mask:0xf bank_mask:0x5
v_dot2_f32_bf16 v25, v100, v16, 0
v_dot2_f32_bf16 v25, v101, v17, v25
v_dot2_f32_bf16 v25, v102, v18, v25
v_dot2_f32_bf16 v25, v103, v19, v25
v_add_f32_dpp v31, v29, v29 row_shr:4 row_mask:0xf bank_mask:0xa
s_cbranch_vccnz L_A_w11
s_waitcnt vmcnt(6)
L_A_w11:
s_waitcnt vmcnt(7)
buffer_load_dwordx4 v[72:75], v8, s[40:43], s36 offen offset:2048 nt
v_add_f32_dpp v34, v30, v30 quad_perm:[2,3,0,1] row_mask:0xf bank_mask:0xf
v_add_f32_dpp v28, v24, v24 row_ror:8 row_mask:0xf bank_mask:0x3
v_dot2_f32_bf16 v26, v104, v16, 0
v_dot2_f32_bf16 v26, v105, v17, v26
v_dot2_f32_bf16 v26, v106, v18, v26
v_dot2_f32_bf16 v26, v107, v19, v26
v_add_f32_dpp v35, v31, v31 quad_perm:[2,3,0,1] row_mask:0xf bank_mask:0xf
v_cndmask_b32 v32, v34, v35, s[48:49]
v_add_f32_dpp v28, v25, v25 row_ror:8 row_mask:0xf bank_mask:0xc
s_cbranch_vccnz L_A_w12
s_waitcnt vmcnt(6)
L_A_w12:
s_waitcnt vmcnt(7)
buffer_load_dwordx4 v[76:79], v8, s[40:43], s36 offen offset:3072 nt
ds_add_u32 v192, v193 offset:256
v_dot2_f32_bf16 v27, v108, v16, 0
v_dot2_f32_bf16 v27, v109, v17, v27
v_dot2_f32_bf16 v27, v110, v18, v27
v_dot2_f32_bf16 v27, v111, v19, v27
s_cbranch_vccnz L_A_w13
s_waitcnt vmcnt(6)
L_A_w13:
s_waitcnt vmcnt(7)
buffer_load_dwordx4 v[80:83], v9, s[40:43], s36 offen offset:0 nt
v_add_f32_dpp v29, v26, v26 row_ror:8 row_mask:0xf bank_mask:0x3
v_dot2_f32_bf16 v24, v112, v20, 0
v_dot2_f32_bf16 v24, v113, v21, v24
v_dot2_f32_bf16 v24, v114, v22, v24
v_dot2_f32_bf16 v24, v115, v23, v24
v_add_f32_dpp v29, v27, v27 row_ror:8 row_mask:0xf bank_mask:0xc
s_cbranch_vccnz L_A_w14
s_waitcnt vmcnt(6)
L_A_w14:
s_waitcnt vmcnt(7)
buffer_load_dwordx4 v[84:87], v9, s[40:43], s36 offen offset:1024 nt
ds_add_u32 v192, v193 offset:256
v_add_f32_dpp v30, v28, v28 row_shl:4 row_mask:0xf bank_mask:0x5
v_dot2_f32_bf16 v25, v116, v20, 0
v_dot2_f32_bf16 v25, v117, v21, v25
v_dot2_f32_bf16 v25, v118, v22, v25
v_dot2_f32_bf16 v25, v119, v23, v25
v_add_f32_dpp v30, v29, v29 row_shr:4 row_mask:0xf bank_mask:0xa
s_cbranch_vccnz L_A_w15
s_waitcnt vmcnt(6)
L_A_w15:
s_waitcnt vmcnt(7)
buffer_load_dwordx4 v[88:91], v9, s[40:43], s36 offen offset:2048 nt
v_add_f32_dpp v28, v24, v24 row_ror:8 row_mask:0xf bank_mask:0x3
v_dot2_f32_bf16 v26, v120, v20, 0
v_dot2_f32_bf16 v26, v121, v21, v26
v_dot2_f32_bf16 v26, v122, v22, v26
v_dot2_f32_bf16 v26, v123, v23, v26
v_add_f32_dpp v28, v25, v25 row_ror:8 row_mask:0xf bank_mask:0xc
s_cbranch_vccnz L_A_w16
s_waitcnt vmcnt(6)
L_A_w16:
s_waitcnt vmcnt(7)
buffer_load_dwordx4 v[92:95], v9, s[40:43], s36 offen offset:3072 nt
ds_add_u32 v192, v193 offset:256
v_dot2_f32_bf16 v27, v124, v20, 0
v_dot2_f32_bf16 v27, v125, v21, v27
v_dot2_f32_bf16 v27, v126, v22, v27
v_dot2_f32_bf16 v27, v127, v23, v27
s_sub_u32 s38, s38, 1
s_cmp_lg_u32 s38, 0
s_cbranch_scc1 L_A_ka
s_cbranch_vccnz L_A_w17
s_waitcnt vmcnt(5)
L_A_w17:
s_waitcnt vmcnt(7)
buffer_load_dwordx4 v[96:99], v8, s[40:43], s37 offen nt
v_add_f32_dpp v29, v26, v26 row_ror:8 row_mask:0xf bank_mask:0x3
v_dot2_f32_bf16 v24, v64, v16, 0
v_dot2_f32_bf16 v24, v65, v17, v24
v_dot2_f32_bf16 v24, v66, v18, v24
v_dot2_f32_bf16 v24, v67, v19, v24
v_add_f32_dpp v29, v27, v27 row_ror:8 row_mask:0xf bank_mask:0xc
s_cbranch_vccnz L_A_w18
s_waitcnt vmcnt(5)
L_A_w18:
s_waitcnt vmcnt(7)
buffer_load_dwordx4 v[100:103], v10, s[40:43], s37 offen nt
ds_add_u32 v192, v193 offset:256
v_add_f32_dpp v31, v28, v28 row_shl:4 row_mask:0xf bank_mask:0x5
v_dot2_f32_bf16 v25, v68, v16, 0
v_dot2_f32_bf16 v25, v69, v17, v25
v_dot2_f32_bf16 v25, v70, v18, v25
v_dot2_f32_bf16 v25, v71, v19, v25
v_add_f32_dpp v31, v29, v29 row_shr:4 row_mask:0xf bank_mask:0xa
s_cbranch_vccnz L_A_w19
s_waitcnt vmcnt(5)
L_A_w19:
s_waitcnt vmcnt(7)
buffer_load_dwordx4 v[104:107], v9, s[40:43], s37 offen nt
v_add_f32_dpp v34, v30, v30 quad_perm:[2,3,0,1] row_mask:0xf bank_mask:0xf
v_add_f32_dpp v28, v24, v24 row_ror:8 row_mask:0xf bank_mask:0x3
v_dot2_f32_bf16 v26, v72, v16, 0
v_dot2_f32_bf16 v26, v73, v17, v26
v_dot2_f32_bf16 v26, v74, v18, v26
v_dot2_f32_bf16 v26, v75, v19, v26
v_add_f32_dpp v35, v31, v31 quad_perm:[2,3,0,1] row_mask:0xf bank_mask:0xf
v_cndmask_b32 v33, v34, v35, s[48:49]
v_add_f32_dpp v28, v25, v25 row_ror:8 row_mask:0xf bank_mask:0xc
s_cbranch_vccnz L_A_w20
s_waitcnt vmcnt(5)
L_A_w20:
s_waitcnt vmcnt(7)
buffer_load_dwordx4 v[108:111], v11, s[40:43], s37 offen nt
ds_add_u32 v192, v193 offset:256
v_add_f32_dpp v34, v32, v32 quad_perm:[1,0,3,2] row_mask:0xf bank_mask:0xf
v_mov_b32 v36, v37
v_mov_b32 v37, v38
v_mov_b32 v38, v39
v_mov_b32 v39, v40
v_mov_b32 v40, v41
v_mov_b32 v41, v42
v_mov_b32 v42, v43
v_mov_b32 v43, v44
v_mov_b32 v44, v45
v_mov_b32 v45, v46
v_dot2_f32_bf16 v27, v76, v16, 0
v_dot2_f32_bf16 v27, v77, v17, v27
v_dot2_f32_bf16 v27, v78, v18, v27
v_dot2_f32_bf16 v27, v79, v19, v27
v_add_f32_dpp v35, v33, v33 quad_perm:[1,0,3,2] row_mask:0xf bank_mask:0xf
v_cndmask_b32 v46, v34, v35, s[50:51]
s_cbranch_vccnz L_A_w21
s_waitcnt vmcnt(5)
L_A_w21:
s_waitcnt vmcnt(7)
s_mov_b32 s36, s35
buffer_load_dwordx4 v[112:115], v8, s[44:47], s36 offen offset:0 nt
v_add_f32_dpp v29, v26, v26 row_ror:8 row_mask:0xf bank_mask:0x3
v_dot2_f32_bf16 v24, v80, v20, 0
v_dot2_f32_bf16 v24, v81, v21, v24
v_dot2_f32_bf16 v24, v82, v22, v24
v_dot2_f32_bf16 v24, v83, v23, v24
v_add_f32_dpp v29, v27, v27 row_ror:8 row_mask:0xf bank_mask:0xc
s_cbranch_vccnz L_A_w22
s_waitcnt vmcnt(5)
L_A_w22:
s_waitcnt vmcnt(7)
buffer_load_dwordx4 v[116:119], v8, s[44:47], s36 offen offset:1024 nt
ds_add_u32 v192, v193 offset:256
v_add_f32_dpp v30, v28, v28 row_shl:4 row_mask:0xf bank_mask:0x5
v_dot2_f32_bf16 v25, v84, v20, 0
v_dot2_f32_bf16 v25, v85, v21, v25
v_dot2_f32_bf16 v25, v86, v22, v25
v_dot2_f32_bf16 v25, v87, v23, v25
v_add_f32_dpp v30, v29, v29 row_shr:4 row_mask:0xf bank_mask:0xa
s_cbranch_vccnz L_A_w23
s_waitcnt vmcnt(5)
L_A_w23:
s_waitcnt vmcnt(7)
buffer_load_dwordx4 v[120:123], v8, s[44:47], s36 offen offset:2048 nt
v_add_f32_dpp v28, v24, v24 row_ror:8 row_mask:0xf bank_mask:0x3
v_dot2_f32_bf16 v26, v88, v20, 0
v_dot2_f32_bf16 v26, v89, v21, v26
v_dot2_f32_bf16 v26, v90, v22, v26
v_dot2_f32_bf16 v26, v91, v23, v26
v_add_f32_dpp v28, v25, v25 row_ror:8 row_mask:0xf bank_mask:0xc
s_cbranch_vccnz L_A_w24
s_waitcnt vmcnt(5)
L_A_w24:
s_waitcnt vmcnt(7)
buffer_load_dwordx4 v[124:127], v8, s[44:47], s36 offen offset:3072 nt
ds_add_u32 v192, v193 offset:256
v_dot2_f32_bf16 v27, v92, v20, 0
v_dot2_f32_bf16 v27, v93, v21, v27
v_dot2_f32_bf16 v27, v94, v22, v27
v_dot2_f32_bf16 v27, v95, v23, v27
s_cbranch_vccnz L_A_w25
s_waitcnt vmcnt(5)
L_A_w25:
s_waitcnt vmcnt(7)
buffer_load_dwordx4 v[64:67], v9, s[44:47], s36 offen offset:0 nt
v_add_f32_dpp v29, v26, v26 row_ror:8 row_mask:0xf bank_mask:0x3
v_dot2_f32_bf16 v24, v96, v16, 0
v_dot2_f32_bf16 v24, v97, v17, v24
v_dot2_f32_bf16 v24, v98, v18, v24
v_dot2_f32_bf16 v24, v99, v19, v24
v_add_f32_dpp v29, v27, v27 row_ror:8 row_mask:0xf bank_mask:0xc
s_cbranch_vccnz L_A_w26
s_waitcnt vmcnt(5)
L_A_w26:
s_waitcnt vmcnt(7)
buffer_load_dwordx4 v[68:71], v9, s[44:47], s36 offen offset:1024 nt
ds_add_u32 v192, v193 offset:256
v_add_f32_dpp v31, v28, v28 row_shl:4 row_mask:0xf bank_mask:0x5
v_dot2_f32_bf16 v25, v100, v16, 0
v_dot2_f32_bf16 v25, v101, v17, v25
v_dot2_f32_bf16 v25, v102, v18, v25
v_dot2_f32_bf16 v25, v103, v19, v25
v_add_f32_dpp v31, v29, v29 row_shr:4 row_mask:0xf bank_mask:0xa
s_cbranch_vccnz L_A_w27
s_waitcnt vmcnt(5)
L_A_w27:
s_waitcnt vmcnt(7)
buffer_load_dwordx4 v[72:75], v9, s[44:47], s36 offen offset:2048 nt
v_add_f32_dpp v34, v30, v30 quad_perm:[2,3,0,1] row_mask:0xf bank_mask:0xf
v_add_f32_dpp v28, v24, v24 row_ror:8 row_mask:0xf bank_mask:0x3
v_dot2_f32_bf16 v26, v104, v20, 0
v_dot2_f32_bf16 v26, v105, v21, v26
v_dot2_f32_bf16 v26, v106, v22, v26
v_dot2_f32_bf16 v26, v107, v23, v26
v_add_f32_dpp v35, v31, v31 quad_perm:[2,3,0,1] row_mask:0xf bank_mask:0xf
v_cndmask_b32 v32, v34, v35, s[48:49]
v_add_f32_dpp v28, v25, v25 row_ror:8 row_mask:0xf bank_mask:0xc
s_cbranch_vccnz L_A_w28
s_waitcnt vmcnt(5)
L_A_w28:
s_waitcnt vmcnt(7)
buffer_load_dwordx4 v[76:79], v9, s[44:47], s36 offen offset:3072 nt
ds_add_u32 v192, v193 offset:256
v_dot2_f32_bf16 v27, v108, v20, 0
v_dot2_f32_bf16 v27, v109, v21, v27
v_dot2_f32_bf16 v27, v110, v22, v27
v_dot2_f32_bf16 v27, v111, v23, v27
v_add_f32_dpp v30, v28, v28 row_shl:4 row_mask:0xf bank_mask:0x5
s_nop 2
v_add_f32_dpp v28, v26, v26 row_ror:8 row_mask:0xf bank_mask:0x3
s_nop 1
v_add_f32_dpp v28, v27, v27 row_ror:8 row_mask:0xf bank_mask:0xc
s_nop 2
s_nop 1
v_add_f32_dpp v31, v28, v28 row_shl:4 row_mask:0xf bank_mask:0x5
s_nop 2
v_add_f32_dpp v34, v30, v30 quad_perm:[2,3,0,1] row_mask:0xf bank_mask:0xf
s_nop 1
v_add_f32_dpp v35, v31, v31 quad_perm:[2,3,0,1] row_mask:0xf bank_mask:0xf
v_cndmask_b32 v33, v34, v35, s[48:49]
s_nop 2
v_add_f32_dpp v34, v32, v32 quad_perm:[1,0,3,2] row_mask:0xf bank_mask:0xf
v_mov_b32 v36, v37
v_mov_b32 v37, v38
v_mov_b32 v38, v39
v_mov_b32 v39, v40
v_mov_b32 v40, v41
v_mov_b32 v41, v42
v_mov_b32 v42, v43
v_mov_b32 v43, v44
v_mov_b32 v44, v45
v_mov_b32 v45, v46
s_nop 1
v_add_f32_dpp v35, v33, v33 quad_perm:[1,0,3,2] row_mask:0xf bank_mask:0xf
v_cndmask_b32 v46, v34, v35, s[50:51]
v_mov_b32 v60, 0xff800000
v_cndmask_b32 v46, v60, v46, s[52:53]
v_max3_f32 v60, v36, v37, v38
v_max3_f32 v60, v60, v39, v40
v_max3_f32 v60, v60, v41, v42
v_max3_f32 v60, v60, v43, v44
v_max3_f32 v60, v60, v45, v46
s_waitcnt vmcnt(5)
s_add_u32 s36, s36, 0x18000
buffer_load_dwordx4 v[80:83], v8, s[44:47], s36 offen offset:0 nt
s_nop 1
v_max_f32_dpp v60, v60, v60 quad_perm:[1,0,3,2] row_mask:0xf bank_mask:0xf
s_nop 1
v_max_f32_dpp v60, v60, v60 row_ror:4 row_mask:0xf bank_mask:0xf
s_nop 1
v_max_f32_dpp v60, v60, v60 row_ror:8 row_mask:0xf bank_mask:0xf
v_mov_b32 v34, v60
s_nop 1
v_permlane16_swap_b32 v60, v34
s_nop 0
v_max_f32 v60, v60, v34
v_mov_b32 v34, v60
s_nop 1
v_permlane32_swap_b32 v60, v34
s_nop 0
v_max_f32 v60, v60, v34
s_mov_b32 s62, 0x3e0293ee
v_mul_f32 v60, s62, v60
s_waitcnt vmcnt(5)
buffer_load_dwordx4 v[84:87], v8, s[44:47], s36 offen offset:1024 nt
ds_add_u32 v192, v193 offset:256
v_fma_f32 v36, v36, s62, -v60
v_fma_f32 v37, v37, s62, -v60
v_fma_f32 v38, v38, s62, -v60
v_fma_f32 v39, v39, s62, -v60
v_fma_f32 v40, v40, s62, -v60
v_fma_f32 v41, v41, s62, -v60
v_fma_f32 v42, v42, s62, -v60
v_fma_f32 v43, v43, s62, -v60
v_fma_f32 v44, v44, s62, -v60
v_fma_f32 v45, v45, s62, -v60
v_fma_f32 v46, v46, s62, -v60
v_exp_f32 v36, v36
v_exp_f32 v37, v37
v_exp_f32 v38, v38
v_exp_f32 v39, v39
v_exp_f32 v40, v40
v_exp_f32 v41, v41
v_exp_f32 v42, v42
v_exp_f32 v43, v43
v_exp_f32 v44, v44
v_exp_f32 v45, v45
v_exp_f32 v46, v46
s_waitcnt vmcnt(5)
buffer_load_dwordx4 v[88:91], v8, s[44:47], s36 offen offset:2048 nt
v_add_f32 v61, v36, v37
v_add_f32 v61, v61, v38
v_add_f32 v61, v61, v39
v_add_f32 v61, v61, v40
v_add_f32 v61, v61, v41
v_add_f32 v61, v61, v42
v_add_f32 v61, v61, v43
v_add_f32 v61, v61, v44
v_add_f32 v61, v61, v45
v_add_f32 v61, v61, v46
v_cvt_pk_bf16_f32 v36, v36, v36
v_cvt_pk_bf16_f32 v37, v37, v37
v_cvt_pk_bf16_f32 v38, v38, v38
v_cvt_pk_bf16_f32 v39, v39, v39
v_cvt_pk_bf16_f32 v40, v40, v40
v_cvt_pk_bf16_f32 v41, v41, v41
v_cvt_pk_bf16_f32 v42, v42, v42
v_cvt_pk_bf16_f32 v43, v43, v43
v_cvt_pk_bf16_f32 v44, v44, v44
v_cvt_pk_bf16_f32 v45, v45, v45
v_cvt_pk_bf16_f32 v46, v46, v46
s_waitcnt vmcnt(5)
buffer_load_dwordx4 v[92:95], v8, s[44:47], s36 offen offset:3072 nt
ds_add_u32 v192, v193 offset:256
s_nop 1
v_add_f32_dpp v61, v61, v61 quad_perm:[1,0,3,2] row_mask:0xf bank_mask:0xf
s_nop 1
v_add_f32_dpp v61, v61, v61 row_ror:4 row_mask:0xf bank_mask:0xf
s_nop 1
v_add_f32_dpp v61, v61, v61 row_ror:8 row_mask:0xf bank_mask:0xf
v_mov_b32 v34, v61
s_nop 1
v_permlane16_swap_b32 v61, v34
s_nop 0
v_add_f32 v61, v61, v34
v_mov_b32 v34, v61
s_nop 1
v_permlane32_swap_b32 v61, v34
s_nop 0
v_add_f32 v61, v61, v34
s_lshl_b32 s62, s34, 2
v_lshl_add_u32 v62, v1, 3, s62
v_mov_b32 v63, 1
s_mov_b64 exec, 5
ds_write_b32 v62, v60 offset:64
ds_write_b32 v62, v61 offset:96
s_mov_b64 exec, 1
ds_add_u32 v47, v63 offset:4
s_mov_b64 exec, -1
v_and_b32_dpp v52, v36, v4 row_newbcast:0 row_mask:0xf bank_mask:0xf
v_and_b32_dpp v53, v36, v5 row_newbcast:0 row_mask:0xf bank_mask:0xf
v_and_b32_dpp v54, v36, v6 row_newbcast:0 row_mask:0xf bank_mask:0xf
v_and_b32_dpp v55, v36, v7 row_newbcast:0 row_mask:0xf bank_mask:0xf
s_mov_b32 s38, 9
.p2align 6
L_A_va:
s_cbranch_vccnz L_A_w29
s_waitcnt vmcnt(5)
L_A_w29:
s_waitcnt vmcnt(7)
buffer_load_dwordx4 v[96:99], v9, s[44:47], s36 offen offset:0 nt
v_mfma_f32_16x16x32_bf16 v[48:51], v[52:55], v[112:115], v[48:51]
ds_read_b32 v194, v47 offset:8
v_and_b32_dpp v56, v36, v4 row_newbcast:8 row_mask:0xf bank_mask:0xf
v_and_b32_dpp v57, v36, v5 row_newbcast:8 row_mask:0xf bank_mask:0xf
v_and_b32_dpp v58, v36, v6 row_newbcast:8 row_mask:0xf bank_mask:0xf
v_and_b32_dpp v59, v36, v7 row_newbcast:8 row_mask:0xf bank_mask:0xf
s_cbranch_vccnz L_A_w30
s_waitcnt vmcnt(5)
L_A_w30:
s_waitcnt vmcnt(7)
buffer_load_dwordx4 v[100:103], v9, s[44:47], s36 offen offset:1024 nt
ds_add_u32 v192, v193 offset:256
v_mfma_f32_16x16x32_bf16 v[48:51], v[56:59], v[116:119], v[48:51]
s_waitcnt lgkmcnt(1)
v_cmp_ne_u32 vcc, 0, v194
v_and_b32_dpp v52, v36, v4 row_newbcast:4 row_mask:0xf bank_mask:0xf
v_and_b32_dpp v53, v36, v5 row_newbcast:4 row_mask:0xf bank_mask:0xf
v_and_b32_dpp v54, v36, v6 row_newbcast:4 row_mask:0xf bank_mask:0xf
v_and_b32_dpp v55, v36, v7 row_newbcast:4 row_mask:0xf bank_mask:0xf
s_cbranch_vccnz L_A_w31
s_waitcnt vmcnt(5)
L_A_w31:
s_waitcnt vmcnt(7)
buffer_load_dwordx4 v[104:107], v9, s[44:47], s36 offen offset:2048 nt
v_mfma_f32_16x16x32_bf16 v[48:51], v[52:55], v[120:123], v[48:51]
v_and_b32_dpp v56, v36, v4 row_newbcast:12 row_mask:0xf bank_mask:0xf
v_and_b32_dpp v57, v36, v5 row_newbcast:12 row_mask:0xf bank_mask:0xf
v_and_b32_dpp v58, v36, v6 row_newbcast:12 row_mask:0xf bank_mask:0xf
v_and_b32_dpp v59, v36, v7 row_newbcast:12 row_mask:0xf bank_mask:0xf
s_cbranch_vccnz L_A_w32
s_waitcnt vmcnt(5)
L_A_w32:
s_waitcnt vmcnt(7)
buffer_load_dwordx4 v[108:111], v9, s[44:47], s36 offen offset:3072 nt
ds_add_u32 v192, v193 offset:256
v_mfma_f32_16x16x32_bf16 v[48:51], v[56:59], v[124:127], v[48:51]
v_and_b32_dpp v52, v36, v12 row_newbcast:2 row_mask:0xf bank_mask:0xf
v_and_b32_dpp v53, v36, v13 row_newbcast:2 row_mask:0xf bank_mask:0xf
v_and_b32_dpp v54, v36, v14 row_newbcast:2 row_mask:0xf bank_mask:0xf
v_and_b32_dpp v55, v36, v15 row_newbcast:2 row_mask:0xf bank_mask:0xf
s_cbranch_vccnz L_A_w33
s_waitcnt vmcnt(5)
L_A_w33:
s_waitcnt vmcnt(7)
s_add_u32 s36, s36, 0x18000
buffer_load_dwordx4 v[112:115], v8, s[44:47], s36 offen offset:0 nt
v_mfma_f32_16x16x32_bf16 v[48:51], v[52:55], v[64:67], v[48:51]
v_and_b32_dpp v56, v36, v12 row_newbcast:10 row_mask:0xf bank_mask:0xf
v_and_b32_dpp v57, v36, v13 row_newbcast:10 row_mask:0xf bank_mask:0xf
v_and_b32_dpp v58, v36, v14 row_newbcast:10 row_mask:0xf bank_mask:0xf
v_and_b32_dpp v59, v36, v15 row_newbcast:10 row_mask:0xf bank_mask:0xf
s_cbranch_vccnz L_A_w34
s_waitcnt vmcnt(5)
L_A_w34:
s_waitcnt vmcnt(7)
buffer_load_dwordx4 v[116:119], v8, s[44:47], s36 offen offset:1024 nt
ds_add_u32 v192, v193 offset:256
v_mfma_f32_16x16x32_bf16 v[48:51], v[56:59], v[68:71], v[48:51]
v_and_b32_dpp v52, v36, v12 row_newbcast:6 row_mask:0xf bank_mask:0xf
v_and_b32_dpp v53, v36, v13 row_newbcast:6 row_mask:0xf bank_mask:0xf
v_and_b32_dpp v54, v36, v14 row_newbcast:6 row_mask:0xf bank_mask:0xf
v_and_b32_dpp v55, v36, v15 row_newbcast:6 row_mask:0xf bank_mask:0xf
s_cbranch_vccnz L_A_w35
s_waitcnt vmcnt(5)
L_A_w35:
s_waitcnt vmcnt(7)
buffer_load_dwordx4 v[120:123], v8, s[44:47], s36 offen offset:2048 nt
v_mfma_f32_16x16x32_bf16 v[48:51], v[52:55], v[72:75], v[48:51]
v_and_b32_dpp v56, v36, v12 row_newbcast:14 row_mask:0xf bank_mask:0xf
v_and_b32_dpp v57, v36, v13 row_newbcast:14 row_mask:0xf bank_mask:0xf
v_and_b32_dpp v58, v36, v14 row_newbcast:14 row_mask:0xf bank_mask:0xf
v_and_b32_dpp v59, v36, v15 row_newbcast:14 row_mask:0xf bank_mask:0xf
s_cbranch_vccnz L_A_w36
s_waitcnt vmcnt(5)
L_A_w36:
s_waitcnt vmcnt(7)
buffer_load_dwordx4 v[124:127], v8, s[44:47], s36 offen offset:3072 nt
ds_add_u32 v192, v193 offset:256
v_mfma_f32_16x16x32_bf16 v[48:51], v[56:59], v[76:79], v[48:51]
v_and_b32_dpp v52, v36, v4 row_newbcast:1 row_mask:0xf bank_mask:0xf
v_and_b32_dpp v53, v36, v5 row_newbcast:1 row_mask:0xf bank_mask:0xf
v_and_b32_dpp v54, v36, v6 row_newbcast:1 row_mask:0xf bank_mask:0xf
v_and_b32_dpp v55, v36, v7 row_newbcast:1 row_mask:0xf bank_mask:0xf
s_cbranch_vccnz L_A_w37
s_waitcnt vmcnt(5)
L_A_w37:
s_waitcnt vmcnt(7)
buffer_load_dwordx4 v[64:67], v9, s[44:47], s36 offen offset:0 nt
v_mfma_f32_16x16x32_bf16 v[48:51], v[52:55], v[80:83], v[48:51]
ds_read_b32 v194, v47 offset:8
v_and_b32_dpp v56, v36, v4 row_newbcast:9 row_mask:0xf bank_mask:0xf
v_and_b32_dpp v57, v36, v5 row_newbcast:9 row_mask:0xf bank_mask:0xf
v_and_b32_dpp v58, v36, v6 row_newbcast:9 row_mask:0xf bank_mask:0xf
v_and_b32_dpp v59, v36, v7 row_newbcast:9 row_mask:0xf bank_mask:0xf
s_cbranch_vccnz L_A_w38
s_waitcnt vmcnt(5)
L_A_w38:
s_waitcnt vmcnt(7)
buffer_load_dwordx4 v[68:71], v9, s[44:47], s36 offen offset:1024 nt
ds_add_u32 v192, v193 offset:256
v_mfma_f32_16x16x32_bf16 v[48:51], v[56:59], v[84:87], v[48:51]
s_waitcnt lgkmcnt(1)
v_cmp_ne_u32 vcc, 0, v194
v_and_b32_dpp v52, v36, v4 row_newbcast:5 row_mask:0xf bank_mask:0xf
v_and_b32_dpp v53, v36, v5 row_newbcast:5 row_mask:0xf bank_mask:0xf
v_and_b32_dpp v54, v36, v6 row_newbcast:5 row_mask:0xf bank_mask:0xf
v_and_b32_dpp v55, v36, v7 row_newbcast:5 row_mask:0xf bank_mask:0xf
s_cbranch_vccnz L_A_w39
s_waitcnt vmcnt(5)
L_A_w39:
s_waitcnt vmcnt(7)
buffer_load_dwordx4 v[72:75], v9, s[44:47], s36 offen offset:2048 nt
v_mfma_f32_16x16x32_bf16 v[48:51], v[52:55], v[88:91], v[48:51]
v_and_b32_dpp v56, v36, v4 row_newbcast:13 row_mask:0xf bank_mask:0xf
v_and_b32_dpp v57, v36, v5 row_newbcast:13 row_mask:0xf bank_mask:0xf
v_and_b32_dpp v58, v36, v6 row_newbcast:13 row_mask:0xf bank_mask:0xf
v_and_b32_dpp v59, v36, v7 row_newbcast:13 row_mask:0xf bank_mask:0xf
s_cbranch_vccnz L_A_w40
s_waitcnt vmcnt(5)
L_A_w40:
s_waitcnt vmcnt(7)
buffer_load_dwordx4 v[76:79], v9, s[44:47], s36 offen offset:3072 nt
ds_add_u32 v192, v193 offset:256
v_mfma_f32_16x16x32_bf16 v[48:51], v[56:59], v[92:95], v[48:51]
v_and_b32_dpp v52, v36, v12 row_newbcast:3 row_mask:0xf bank_mask:0xf
v_and_b32_dpp v53, v36, v13 row_newbcast:3 row_mask:0xf bank_mask:0xf
v_and_b32_dpp v54, v36, v14 row_newbcast:3 row_mask:0xf bank_mask:0xf
v_and_b32_dpp v55, v36, v15 row_newbcast:3 row_mask:0xf bank_mask:0xf
s_cbranch_vccnz L_A_w41
s_waitcnt vmcnt(5)
L_A_w41:
s_waitcnt vmcnt(7)
s_add_u32 s36, s36, 0x18000
buffer_load_dwordx4 v[80:83], v8, s[44:47], s36 offen offset:0 nt
v_mfma_f32_16x16x32_bf16 v[48:51], v[52:55], v[96:99], v[48:51]
v_and_b32_dpp v56, v36, v12 row_newbcast:11 row_mask:0xf bank_mask:0xf
v_and_b32_dpp v57, v36, v13 row_newbcast:11 row_mask:0xf bank_mask:0xf
v_and_b32_dpp v58, v36, v14 row_newbcast:11 row_mask:0xf bank_mask:0xf
v_and_b32_dpp v59, v36, v15 row_newbcast:11 row_mask:0xf bank_mask:0xf
s_cbranch_vccnz L_A_w42
s_waitcnt vmcnt(5)
L_A_w42:
s_waitcnt vmcnt(7)
buffer_load_dwordx4 v[84:87], v8, s[44:47], s36 offen offset:1024 nt
ds_add_u32 v192, v193 offset:256
v_mfma_f32_16x16x32_bf16 v[48:51], v[56:59], v[100:103], v[48:51]
v_and_b32_dpp v52, v36, v12 row_newbcast:7 row_mask:0xf bank_mask:0xf
v_and_b32_dpp v53, v36, v13 row_newbcast:7 row_mask:0xf bank_mask:0xf
v_and_b32_dpp v54, v36, v14 row_newbcast:7 row_mask:0xf bank_mask:0xf
v_and_b32_dpp v55, v36, v15 row_newbcast:7 row_mask:0xf bank_mask:0xf
s_cbranch_vccnz L_A_w43
s_waitcnt vmcnt(5)
L_A_w43:
s_waitcnt vmcnt(7)
buffer_load_dwordx4 v[88:91], v8, s[44:47], s36 offen offset:2048 nt
v_mfma_f32_16x16x32_bf16 v[48:51], v[52:55], v[104:107], v[48:51]
v_and_b32_dpp v56, v36, v12 row_newbcast:15 row_mask:0xf bank_mask:0xf
v_and_b32_dpp v57, v36, v13 row_newbcast:15 row_mask:0xf bank_mask:0xf
v_and_b32_dpp v58, v36, v14 row_newbcast:15 row_mask:0xf bank_mask:0xf
v_and_b32_dpp v59, v36, v15 row_newbcast:15 row_mask:0xf bank_mask:0xf
s_cbranch_vccnz L_A_w44
s_waitcnt vmcnt(5)
L_A_w44:
s_waitcnt vmcnt(7)
buffer_load_dwordx4 v[92:95], v8, s[44:47], s36 offen offset:3072 nt
ds_add_u32 v192, v193 offset:256
v_mfma_f32_16x16x32_bf16 v[48:51], v[56:59], v[108:111], v[48:51]
v_mov_b32 v36, v37
v_mov_b32 v37, v38
v_mov_b32 v38, v39
v_mov_b32 v39, v40
v_mov_b32 v40, v41
v_mov_b32 v41, v42
v_mov_b32 v42, v43
v_mov_b32 v43, v44
v_mov_b32 v44, v45
v_mov_b32 v45, v46
v_and_b32_dpp v52, v36, v4 row_newbcast:0 row_mask:0xf bank_mask:0xf
v_and_b32_dpp v53, v36, v5 row_newbcast:0 row_mask:0xf bank_mask:0xf
v_and_b32_dpp v54, v36, v6 row_newbcast:0 row_mask:0xf bank_mask:0xf
v_and_b32_dpp v55, v36, v7 row_newbcast:0 row_mask:0xf bank_mask:0xf
s_sub_u32 s38, s38, 1
s_cmp_lg_u32 s38, 0
s_cbranch_scc1 L_A_va
s_waitcnt vmcnt(8)
buffer_load_dwordx4 v[96:99], v9, s[44:47], s36 offen offset:0 nt
v_mfma_f32_16x16x32_bf16 v[48:51], v[52:55], v[112:115], v[48:51]
v_and_b32_dpp v56, v36, v4 row_newbcast:8 row_mask:0xf bank_mask:0xf
v_and_b32_dpp v57, v36, v5 row_newbcast:8 row_mask:0xf bank_mask:0xf
v_and_b32_dpp v58, v36, v6 row_newbcast:8 row_mask:0xf bank_mask:0xf
v_and_b32_dpp v59, v36, v7 row_newbcast:8 row_mask:0xf bank_mask:0xf
s_mov_b32 s64, 0
L_A_sw:
ds_read_b32 v60, v47 offset:4
s_waitcnt lgkmcnt(0)
v_readfirstlane_b32 s65, v60
s_add_u32 s64, s64, 1
s_nop 2
s_cmp_ge_u32 s65, 4
s_cbranch_scc1 L_A_sw_ok
s_sleep 1
s_cmp_lt_u32 s64, 1048576
s_cbranch_scc1 L_A_sw
L_A_sw_ok:
v_lshrrev_b32 v60, 1, v3
v_lshlrev_b32 v60, 4, v60
s_lshl_b32 s62, s34, 2
v_add_u32 v61, s62, v60
ds_read_b128 v[24:27], v60 offset:64
ds_read_b32 v63, v61 offset:64
s_waitcnt vmcnt(8)
buffer_load_dwordx4 v[100:103], v9, s[44:47], s36 offen offset:1024 nt
ds_add_u32 v192, v193 offset:256
v_mfma_f32_16x16x32_bf16 v[48:51], v[56:59], v[116:119], v[48:51]
v_and_b32_dpp v52, v36, v4 row_newbcast:4 row_mask:0xf bank_mask:0xf
v_and_b32_dpp v53, v36, v5 row_newbcast:4 row_mask:0xf bank_mask:0xf
v_and_b32_dpp v54, v36, v6 row_newbcast:4 row_mask:0xf bank_mask:0xf
v_and_b32_dpp v55, v36, v7 row_newbcast:4 row_mask:0xf bank_mask:0xf
s_waitcnt vmcnt(8)
buffer_load_dwordx4 v[104:107], v9, s[44:47], s36 offen offset:2048 nt
v_mfma_f32_16x16x32_bf16 v[48:51], v[52:55], v[120:123], v[48:51]
v_and_b32_dpp v56, v36, v4 row_newbcast:12 row_mask:0xf bank_mask:0xf
v_and_b32_dpp v57, v36, v5 row_newbcast:12 row_mask:0xf bank_mask:0xf
v_and_b32_dpp v58, v36, v6 row_newbcast:12 row_mask:0xf bank_mask:0xf
v_and_b32_dpp v59, v36, v7 row_newbcast:12 row_mask:0xf bank_mask:0xf
s_waitcnt lgkmcnt(0)
v_max3_f32 v60, v24, v25, v26
v_max_f32 v60, v60, v27
v_sub_f32 v63, v63, v60
v_exp_f32 v63, v63
v_lshrrev_b32 v62, 1, v3
v_mul_u32_u24 v62, 1152, v62
v_lshl_add_u32 v62, v2, 3, v62
v_and_b32 v61, 1, v3
v_lshl_add_u32 v62, v61, 2, v62
s_mul_i32 s62, s34, 288
s_add_u32 s62, s62, 8192
v_add_u32 v62, s62, v62
s_waitcnt vmcnt(8)
buffer_load_dwordx4 v[108:111], v9, s[44:47], s36 offen offset:3072 nt
ds_add_u32 v192, v193 offset:256
v_mfma_f32_16x16x32_bf16 v[48:51], v[56:59], v[124:127], v[48:51]
v_and_b32_dpp v52, v36, v12 row_newbcast:2 row_mask:0xf bank_mask:0xf
v_and_b32_dpp v53, v36, v13 row_newbcast:2 row_mask:0xf bank_mask:0xf
v_and_b32_dpp v54, v36, v14 row_newbcast:2 row_mask:0xf bank_mask:0xf
v_and_b32_dpp v55, v36, v15 row_newbcast:2 row_mask:0xf bank_mask:0xf
s_waitcnt vmcnt(8)
s_add_u32 s36, s36, 0x18000
buffer_load_dwordx4 v[112:115], v8, s[44:47], s36 offen offset:0 nt
v_mfma_f32_16x16x32_bf16 v[48:51], v[52:55], v[64:67], v[48:51]
v_and_b32_dpp v56, v36, v12 row_newbcast:10 row_mask:0xf bank_mask:0xf
v_and_b32_dpp v57, v36, v13 row_newbcast:10 row_mask:0xf bank_mask:0xf
v_and_b32_dpp v58, v36, v14 row_newbcast:10 row_mask:0xf bank_mask:0xf
v_and_b32_dpp v59, v36, v15 row_newbcast:10 row_mask:0xf bank_mask:0xf
s_waitcnt vmcnt(8)
buffer_load_dwordx4 v[116:119], v8, s[44:47], s36 offen offset:1024 nt
ds_add_u32 v192, v193 offset:256
v_mfma_f32_16x16x32_bf16 v[48:51], v[56:59], v[68:71], v[48:51]
v_and_b32_dpp v52, v36, v12 row_newbcast:6 row_mask:0xf bank_mask:0xf
v_and_b32_dpp v53, v36, v13 row_newbcast:6 row_mask:0xf bank_mask:0xf
v_and_b32_dpp v54, v36, v14 row_newbcast:6 row_mask:0xf bank_mask:0xf
v_and_b32_dpp v55, v36, v15 row_newbcast:6 row_mask:0xf bank_mask:0xf
s_waitcnt vmcnt(8)
buffer_load_dwordx4 v[120:123], v8, s[44:47], s36 offen offset:2048 nt
v_mfma_f32_16x16x32_bf16 v[48:51], v[52:55], v[72:75], v[48:51]
v_and_b32_dpp v56, v36, v12 row_newbcast:14 row_mask:0xf bank_mask:0xf
v_and_b32_dpp v57, v36, v13 row_newbcast:14 row_mask:0xf bank_mask:0xf
v_and_b32_dpp v58, v36, v14 row_newbcast:14 row_mask:0xf bank_mask:0xf
v_and_b32_dpp v59, v36, v15 row_newbcast:14 row_mask:0xf bank_mask:0xf
s_waitcnt vmcnt(8)
buffer_load_dwordx4 v[124:127], v8, s[44:47], s36 offen offset:3072 nt
ds_add_u32 v192, v193 offset:256
v_mfma_f32_16x16x32_bf16 v[48:51], v[56:59], v[76:79], v[48:51]
v_and_b32_dpp v52, v36, v4 row_newbcast:1 row_mask:0xf bank_mask:0xf
v_and_b32_dpp v53, v36, v5 row_newbcast:1 row_mask:0xf bank_mask:0xf
v_and_b32_dpp v54, v36, v6 row_newbcast:1 row_mask:0xf bank_mask:0xf
v_and_b32_dpp v55, v36, v7 row_newbcast:1 row_mask:0xf bank_mask:0xf
s_waitcnt vmcnt(8)
buffer_load_dwordx4 v[64:67], v9, s[44:47], s36 offen offset:0 nt
v_mfma_f32_16x16x32_bf16 v[48:51], v[52:55], v[80:83], v[48:51]
v_and_b32_dpp v56, v36, v4 row_newbcast:9 row_mask:0xf bank_mask:0xf
v_and_b32_dpp v57, v36, v5 row_newbcast:9 row_mask:0xf bank_mask:0xf
v_and_b32_dpp v58, v36, v6 row_newbcast:9 row_mask:0xf bank_mask:0xf
v_and_b32_dpp v59, v36, v7 row_newbcast:9 row_mask:0xf bank_mask:0xf
s_waitcnt vmcnt(8)
buffer_load_dwordx4 v[68:71], v9, s[44:47], s36 offen offset:1024 nt
ds_add_u32 v192, v193 offset:256
v_mfma_f32_16x16x32_bf16 v[48:51], v[56:59], v[84:87], v[48:51]
v_and_b32_dpp v52, v36, v4 row_newbcast:5 row_mask:0xf bank_mask:0xf
v_and_b32_dpp v53, v36, v5 row_newbcast:5 row_mask:0xf bank_mask:0xf
v_and_b32_dpp v54, v36, v6 row_newbcast:5 row_mask:0xf bank_mask:0xf
v_and_b32_dpp v55, v36, v7 row_newbcast:5 row_mask:0xf bank_mask:0xf
s_waitcnt vmcnt(8)
buffer_load_dwordx4 v[72:75], v9, s[44:47], s36 offen offset:2048 nt
v_mfma_f32_16x16x32_bf16 v[48:51], v[52:55], v[88:91], v[48:51]
v_and_b32_dpp v56, v36, v4 row_newbcast:13 row_mask:0xf bank_mask:0xf
v_and_b32_dpp v57, v36, v5 row_newbcast:13 row_mask:0xf bank_mask:0xf
v_and_b32_dpp v58, v36, v6 row_newbcast:13 row_mask:0xf bank_mask:0xf
v_and_b32_dpp v59, v36, v7 row_newbcast:13 row_mask:0xf bank_mask:0xf
s_waitcnt vmcnt(8)
buffer_load_dwordx4 v[76:79], v9, s[44:47], s36 offen offset:3072 nt
ds_add_u32 v192, v193 offset:256
v_mfma_f32_16x16x32_bf16 v[48:51], v[56:59], v[92:95], v[48:51]
v_and_b32_dpp v52, v36, v12 row_newbcast:3 row_mask:0xf bank_mask:0xf
v_and_b32_dpp v53, v36, v13 row_newbcast:3 row_mask:0xf bank_mask:0xf
v_and_b32_dpp v54, v36, v14 row_newbcast:3 row_mask:0xf bank_mask:0xf
v_and_b32_dpp v55, v36, v15 row_newbcast:3 row_mask:0xf bank_mask:0xf
s_waitcnt vmcnt(8)
buffer_load_dwordx4 v[80:83], v8, s[44:47], s37 offen nt
v_mfma_f32_16x16x32_bf16 v[48:51], v[52:55], v[96:99], v[48:51]
v_and_b32_dpp v56, v36, v12 row_newbcast:11 row_mask:0xf bank_mask:0xf
v_and_b32_dpp v57, v36, v13 row_newbcast:11 row_mask:0xf bank_mask:0xf
v_and_b32_dpp v58, v36, v14 row_newbcast:11 row_mask:0xf bank_mask:0xf
v_and_b32_dpp v59, v36, v15 row_newbcast:11 row_mask:0xf bank_mask:0xf
s_waitcnt vmcnt(8)
buffer_load_dwordx4 v[84:87], v10, s[44:47], s37 offen nt
ds_add_u32 v192, v193 offset:256
v_mfma_f32_16x16x32_bf16 v[48:51], v[56:59], v[100:103], v[48:51]
v_and_b32_dpp v52, v36, v12 row_newbcast:7 row_mask:0xf bank_mask:0xf
v_and_b32_dpp v53, v36, v13 row_newbcast:7 row_mask:0xf bank_mask:0xf
v_and_b32_dpp v54, v36, v14 row_newbcast:7 row_mask:0xf bank_mask:0xf
v_and_b32_dpp v55, v36, v15 row_newbcast:7 row_mask:0xf bank_mask:0xf
s_waitcnt vmcnt(8)
buffer_load_dwordx4 v[88:91], v9, s[44:47], s37 offen nt
v_mfma_f32_16x16x32_bf16 v[48:51], v[52:55], v[104:107], v[48:51]
v_and_b32_dpp v56, v36, v12 row_newbcast:15 row_mask:0xf bank_mask:0xf
v_and_b32_dpp v57, v36, v13 row_newbcast:15 row_mask:0xf bank_mask:0xf
v_and_b32_dpp v58, v36, v14 row_newbcast:15 row_mask:0xf bank_mask:0xf
v_and_b32_dpp v59, v36, v15 row_newbcast:15 row_mask:0xf bank_mask:0xf
s_waitcnt vmcnt(8)
buffer_load_dwordx4 v[92:95], v11, s[44:47], s37 offen nt
ds_add_u32 v192, v193 offset:256
v_mfma_f32_16x16x32_bf16 v[48:51], v[56:59], v[108:111], v[48:51]
v_mov_b32 v36, v37
v_mov_b32 v37, v38
v_mov_b32 v38, v39
v_mov_b32 v39, v40
v_mov_b32 v40, v41
v_mov_b32 v41, v42
v_mov_b32 v42, v43
v_mov_b32 v43, v44
v_mov_b32 v44, v45
v_mov_b32 v45, v46
v_and_b32_dpp v52, v36, v4 row_newbcast:0 row_mask:0xf bank_mask:0xf
v_and_b32_dpp v53, v36, v5 row_newbcast:0 row_mask:0xf bank_mask:0xf
v_and_b32_dpp v54, v36, v6 row_newbcast:0 row_mask:0xf bank_mask:0xf
v_and_b32_dpp v55, v36, v7 row_newbcast:0 row_mask:0xf bank_mask:0xf
s_nop 0
s_nop 0
v_mfma_f32_16x16x32_bf16 v[48:51], v[52:55], v[112:115], v[48:51]
v_and_b32_dpp v56, v36, v4 row_newbcast:8 row_mask:0xf bank_mask:0xf
v_and_b32_dpp v57, v36, v5 row_newbcast:8 row_mask:0xf bank_mask:0xf
v_and_b32_dpp v58, v36, v6 row_newbcast:8 row_mask:0xf bank_mask:0xf
v_and_b32_dpp v59, v36, v7 row_newbcast:8 row_mask:0xf bank_mask:0xf
s_nop 0
s_nop 0
v_mfma_f32_16x16x32_bf16 v[48:51], v[56:59], v[116:119], v[48:51]
v_and_b32_dpp v52, v36, v4 row_newbcast:4 row_mask:0xf bank_mask:0xf
v_and_b32_dpp v53, v36, v5 row_newbcast:4 row_mask:0xf bank_mask:0xf
v_and_b32_dpp v54, v36, v6 row_newbcast:4 row_mask:0xf bank_mask:0xf
v_and_b32_dpp v55, v36, v7 row_newbcast:4 row_mask:0xf bank_mask:0xf
s_nop 0
s_nop 0
v_mfma_f32_16x16x32_bf16 v[48:51], v[52:55], v[120:123], v[48:51]
v_and_b32_dpp v56, v36, v4 row_newbcast:12 row_mask:0xf bank_mask:0xf
v_and_b32_dpp v57, v36, v5 row_newbcast:12 row_mask:0xf bank_mask:0xf
v_and_b32_dpp v58, v36, v6 row_newbcast:12 row_mask:0xf bank_mask:0xf
v_and_b32_dpp v59, v36, v7 row_newbcast:12 row_mask:0xf bank_mask:0xf
s_waitcnt vmcnt(8)
s_nop 0
v_mfma_f32_16x16x32_bf16 v[48:51], v[56:59], v[124:127], v[48:51]
v_and_b32_dpp v52, v36, v12 row_newbcast:2 row_mask:0xf bank_mask:0xf
v_and_b32_dpp v53, v36, v13 row_newbcast:2 row_mask:0xf bank_mask:0xf
v_and_b32_dpp v54, v36, v14 row_newbcast:2 row_mask:0xf bank_mask:0xf
v_and_b32_dpp v55, v36, v15 row_newbcast:2 row_mask:0xf bank_mask:0xf
s_waitcnt vmcnt(7)
s_nop 0
v_mfma_f32_16x16x32_bf16 v[48:51], v[52:55], v[64:67], v[48:51]
v_and_b32_dpp v56, v36, v12 row_newbcast:10 row_mask:0xf bank_mask:0xf
v_and_b32_dpp v57, v36, v13 row_newbcast:10 row_mask:0xf bank_mask:0xf
v_and_b32_dpp v58, v36, v14 row_newbcast:10 row_mask:0xf bank_mask:0xf
v_and_b32_dpp v59, v36, v15 row_newbcast:10 row_mask:0xf bank_mask:0xf
s_waitcnt vmcnt(6)
s_nop 0
v_mfma_f32_16x16x32_bf16 v[48:51], v[56:59], v[68:71], v[48:51]
v_and_b32_dpp v52, v36, v12 row_newbcast:6 row_mask:0xf bank_mask:0xf
v_and_b32_dpp v53, v36, v13 row_newbcast:6 row_mask:0xf bank_mask:0xf
v_and_b32_dpp v54, v36, v14 row_newbcast:6 row_mask:0xf bank_mask:0xf
v_and_b32_dpp v55, v36, v15 row_newbcast:6 row_mask:0xf bank_mask:0xf
s_waitcnt vmcnt(5)
s_nop 0
v_mfma_f32_16x16x32_bf16 v[48:51], v[52:55], v[72:75], v[48:51]
v_and_b32_dpp v56, v36, v12 row_newbcast:14 row_mask:0xf bank_mask:0xf
v_and_b32_dpp v57, v36, v13 row_newbcast:14 row_mask:0xf bank_mask:0xf
v_and_b32_dpp v58, v36, v14 row_newbcast:14 row_mask:0xf bank_mask:0xf
v_and_b32_dpp v59, v36, v15 row_newbcast:14 row_mask:0xf bank_mask:0xf
s_waitcnt vmcnt(4)
s_nop 0
v_mfma_f32_16x16x32_bf16 v[48:51], v[56:59], v[76:79], v[48:51]
v_and_b32_dpp v52, v36, v4 row_newbcast:1 row_mask:0xf bank_mask:0xf
v_and_b32_dpp v53, v36, v5 row_newbcast:1 row_mask:0xf bank_mask:0xf
v_and_b32_dpp v54, v36, v6 row_newbcast:1 row_mask:0xf bank_mask:0xf
v_and_b32_dpp v55, v36, v7 row_newbcast:1 row_mask:0xf bank_mask:0xf
s_waitcnt vmcnt(3)
s_nop 0
v_mfma_f32_16x16x32_bf16 v[48:51], v[52:55], v[80:83], v[48:51]
v_and_b32_dpp v56, v36, v4 row_newbcast:9 row_mask:0xf bank_mask:0xf
v_and_b32_dpp v57, v36, v5 row_newbcast:9 row_mask:0xf bank_mask:0xf
v_and_b32_dpp v58, v36, v6 row_newbcast:9 row_mask:0xf bank_mask:0xf
v_and_b32_dpp v59, v36, v7 row_newbcast:9 row_mask:0xf bank_mask:0xf
s_waitcnt vmcnt(2)
s_nop 0
v_mfma_f32_16x16x32_bf16 v[48:51], v[56:59], v[84:87], v[48:51]
v_and_b32_dpp v52, v36, v12 row_newbcast:3 row_mask:0xf bank_mask:0xf
v_and_b32_dpp v53, v36, v13 row_newbcast:3 row_mask:0xf bank_mask:0xf
v_and_b32_dpp v54, v36, v14 row_newbcast:3 row_mask:0xf bank_mask:0xf
v_and_b32_dpp v55, v36, v15 row_newbcast:3 row_mask:0xf bank_mask:0xf
s_waitcnt vmcnt(1)
s_nop 0
v_mfma_f32_16x16x32_bf16 v[48:51], v[52:55], v[88:91], v[48:51]
v_and_b32_dpp v56, v36, v12 row_newbcast:11 row_mask:0xf bank_mask:0xf
v_and_b32_dpp v57, v36, v13 row_newbcast:11 row_mask:0xf bank_mask:0xf
v_and_b32_dpp v58, v36, v14 row_newbcast:11 row_mask:0xf bank_mask:0xf
v_and_b32_dpp v59, v36, v15 row_newbcast:11 row_mask:0xf bank_mask:0xf
s_waitcnt vmcnt(0)
s_nop 0
v_mfma_f32_16x16x32_bf16 v[48:51], v[56:59], v[92:95], v[48:51]
s_nop 7
v_pk_mul_f32 v[48:49], v[48:49], v[62:63] op_sel:[0,1] op_sel_hi:[1,1]
v_pk_mul_f32 v[50:51], v[50:51], v[62:63] op_sel:[0,1] op_sel_hi:[1,1]
v_cvt_pk_bf16_f32 v48, v48, v49
v_cvt_pk_bf16_f32 v49, v50, v51
ds_write2_b32 v62, v48, v49 offset1:36
s_waitcnt lgkmcnt(0)
s_barrier
s_endpgm
L_A_helper:
s_mov_b32 s89, s32
v_and_b32 v1, 63, v0
v_and_b32 v2, 15, v0
v_bfe_u32 v3, v0, 4, 2
s_waitcnt lgkmcnt(0)
s_sub_u32 s35, s34, 4
s_lshl_b32 s37, s32, 3
s_add_u32 s37, s37, s33
s_cmp_lg_u32 s35, 0
s_cbranch_scc1 L_A_noclr
s_lshl_b32 s63, s37, 10
s_add_u32 s63, s63, 0x100000
v_lshl_add_u32 v10, v1, 4, s63
v_add_u32 v11, 0x40000, v10
v_mov_b32 v44, -1
v_mov_b32 v45, -1
v_mov_b32 v46, -1
v_mov_b32 v47, -1
global_store_dwordx4 v10, v[44:47], s[30:31] sc1
global_store_dwordx4 v11, v[44:47], s[30:31] sc1
L_A_noclr:
s_lshl_b32 s62, s89, 17
s_mov_b32 s63, 0x20000
s_add_u32 s40, s12, s62
s_addc_u32 s41, s13, 0
s_and_b32 s41, s41, 0xffff
s_mov_b32 s42, s63
s_mov_b32 s43, 0x20000
v_lshlrev_b32 v9, 13, v3
v_lshl_add_u32 v9, v2, 4, v9
s_lshl_b32 s62, s35, 8
v_add_u32 v9, s62, v9
s_mov_b32 s61, 0
buffer_load_dwordx4 v[184:187], v9, s[40:43], s61 offen offset:0
buffer_load_dwordx4 v[188:191], v9, s[40:43], s61 offen offset:1024
buffer_load_dwordx4 v[192:195], v9, s[40:43], s61 offen offset:2048
buffer_load_dwordx4 v[196:199], v9, s[40:43], s61 offen offset:3072
v_mov_b32 v8, 0
v_mov_b32 v11, 0
ds_write_b32 v8, v8 offset:0
ds_write_b32 v8, v8 offset:4
ds_write_b32 v8, v8 offset:8
ds_write_b32 v8, v8 offset:256
s_waitcnt lgkmcnt(0)
s_barrier
s_load_dword s88, s[30:31], 0x18000
s_mov_b32 s66, 0x05040100
s_mov_b32 s67, 0x07060302
s_mov_b32 s44, s30
s_and_b32 s45, s31, 0xffff
s_mov_b32 s46, 0x1000000
s_mov_b32 s47, 0x20000
s_lshl_b32 s63, s32, 10
s_add_u32 s63, s63, 0x40000
v_lshl_add_u32 v10, v1, 4, s63
v_lshlrev_b32 v11, 3, v1
s_mov_b32 s38, s35
s_waitcnt lgkmcnt(0)
s_add_u32 s88, s88, 0x9e3779b9
s_waitcnt vmcnt(3)
s_mov_b32 s61, 4096
buffer_load_dwordx4 v[200:203], v9, s[40:43], s61 offen offset:0
s_waitcnt vmcnt(3)
buffer_load_dwordx4 v[204:207], v9, s[40:43], s61 offen offset:1024
v_perm_b32 v56, v188, v184, s66
v_perm_b32 v64, v188, v184, s67
v_perm_b32 v72, v189, v185, s66
v_perm_b32 v80, v189, v185, s67
v_perm_b32 v88, v190, v186, s66
v_perm_b32 v96, v190, v186, s67
v_perm_b32 v104, v191, v187, s66
v_perm_b32 v112, v191, v187, s67
s_waitcnt vmcnt(3)
buffer_load_dwordx4 v[208:211], v9, s[40:43], s61 offen offset:2048
s_waitcnt vmcnt(3)
buffer_load_dwordx4 v[212:215], v9, s[40:43], s61 offen offset:3072
v_perm_b32 v57, v196, v192, s66
v_perm_b32 v65, v196, v192, s67
v_perm_b32 v73, v197, v193, s66
v_perm_b32 v81, v197, v193, s67
v_perm_b32 v89, v198, v194, s66
v_perm_b32 v97, v198, v194, s67
v_perm_b32 v105, v199, v195, s66
v_perm_b32 v113, v199, v195, s67
s_waitcnt vmcnt(3)
s_mov_b32 s61, 32768
buffer_load_dwordx4 v[216:219], v9, s[40:43], s61 offen offset:0
s_waitcnt vmcnt(3)
buffer_load_dwordx4 v[220:223], v9, s[40:43], s61 offen offset:1024
v_perm_b32 v58, v204, v200, s66
v_perm_b32 v66, v204, v200, s67
v_perm_b32 v74, v205, v201, s66
v_perm_b32 v82, v205, v201, s67
v_perm_b32 v90, v206, v202, s66
v_perm_b32 v98, v206, v202, s67
v_perm_b32 v106, v207, v203, s66
v_perm_b32 v114, v207, v203, s67
s_waitcnt vmcnt(3)
buffer_load_dwordx4 v[224:227], v9, s[40:43], s61 offen offset:2048
s_waitcnt vmcnt(3)
buffer_load_dwordx4 v[228:231], v9, s[40:43], s61 offen offset:3072
v_perm_b32 v59, v212, v208, s66
v_perm_b32 v67, v212, v208, s67
v_perm_b32 v75, v213, v209, s66
v_perm_b32 v83, v213, v209, s67
v_perm_b32 v91, v214, v210, s66
v_perm_b32 v99, v214, v210, s67
v_perm_b32 v107, v215, v211, s66
v_perm_b32 v115, v215, v211, s67
s_waitcnt vmcnt(3)
s_mov_b32 s61, 36864
buffer_load_dwordx4 v[232:235], v9, s[40:43], s61 offen offset:0
s_waitcnt vmcnt(3)
buffer_load_dwordx4 v[236:239], v9, s[40:43], s61 offen offset:1024
v_perm_b32 v60, v220, v216, s66
v_perm_b32 v68, v220, v216, s67
v_perm_b32 v76, v221, v217, s66
v_perm_b32 v84, v221, v217, s67
v_perm_b32 v92, v222, v218, s66
v_perm_b32 v100, v222, v218, s67
v_perm_b32 v108, v223, v219, s66
v_perm_b32 v116, v223, v219, s67
s_waitcnt vmcnt(3)
buffer_load_dwordx4 v[240:243], v9, s[40:43], s61 offen offset:2048
s_waitcnt vmcnt(3)
buffer_load_dwordx4 v[244:247], v9, s[40:43], s61 offen offset:3072
v_perm_b32 v61, v228, v224, s66
v_perm_b32 v69, v228, v224, s67
v_perm_b32 v77, v229, v225, s66
v_perm_b32 v85, v229, v225, s67
v_perm_b32 v93, v230, v226, s66
v_perm_b32 v101, v230, v226, s67
v_perm_b32 v109, v231, v227, s66
v_perm_b32 v117, v231, v227, s67
s_waitcnt vmcnt(3)
s_mov_b32 s61, 65536
buffer_load_dwordx4 v[184:187], v9, s[40:43], s61 offen offset:0
s_waitcnt vmcnt(3)
buffer_load_dwordx4 v[188:191], v9, s[40:43], s61 offen offset:1024
v_perm_b32 v62, v236, v232, s66
v_perm_b32 v70, v236, v232, s67
v_perm_b32 v78, v237, v233, s66
v_perm_b32 v86, v237, v233, s67
v_perm_b32 v94, v238, v234, s66
v_perm_b32 v102, v238, v234, s67
v_perm_b32 v110, v239, v235, s66
v_perm_b32 v118, v239, v235, s67
s_waitcnt vmcnt(3)
buffer_load_dwordx4 v[192:195], v9, s[40:43], s61 offen offset:2048
s_waitcnt vmcnt(3)
buffer_load_dwordx4 v[196:199], v9, s[40:43], s61 offen offset:3072
v_perm_b32 v63, v244, v240, s66
v_perm_b32 v71, v244, v240, s67
v_perm_b32 v79, v245, v241, s66
v_perm_b32 v87, v245, v241, s67
v_perm_b32 v95, v246, v242, s66
v_perm_b32 v103, v246, v242, s67
v_perm_b32 v111, v247, v243, s66
v_perm_b32 v119, v247, v243, s67
s_waitcnt vmcnt(3)
s_mov_b32 s61, 69632
buffer_load_dwordx4 v[200:203], v9, s[40:43], s61 offen offset:0
s_waitcnt vmcnt(3)
buffer_load_dwordx4 v[204:207], v9, s[40:43], s61 offen offset:1024
v_perm_b32 v120, v188, v184, s66
v_perm_b32 v128, v188, v184, s67
v_perm_b32 v136, v189, v185, s66
v_perm_b32 v144, v189, v185, s67
v_perm_b32 v152, v190, v186, s66
v_perm_b32 v160, v190, v186, s67
v_perm_b32 v168, v191, v187, s66
v_perm_b32 v176, v191, v187, s67
s_waitcnt vmcnt(3)
buffer_load_dwordx4 v[208:211], v9, s[40:43], s61 offen offset:2048
s_waitcnt vmcnt(3)
buffer_load_dwordx4 v[212:215], v9, s[40:43], s61 offen offset:3072
v_perm_b32 v121, v196, v192, s66
v_perm_b32 v129, v196, v192, s67
v_perm_b32 v137, v197, v193, s66
v_perm_b32 v145, v197, v193, s67
v_perm_b32 v153, v198, v194, s66
v_perm_b32 v161, v198, v194, s67
v_perm_b32 v169, v199, v195, s66
v_perm_b32 v177, v199, v195, s67
s_waitcnt vmcnt(3)
s_cmp_lg_u32 s38, 0
s_cbranch_scc1 L_A_qt20
buffer_load_dwordx4 v[44:47], v10, s[44:47], 0 offen sc1
L_A_qt20:
s_mov_b32 s61, 98304
buffer_load_dwordx4 v[216:219], v9, s[40:43], s61 offen offset:0
s_waitcnt vmcnt(3)
buffer_load_dwordx4 v[220:223], v9, s[40:43], s61 offen offset:1024
v_perm_b32 v122, v204, v200, s66
v_perm_b32 v130, v204, v200, s67
v_perm_b32 v138, v205, v201, s66
v_perm_b32 v146, v205, v201, s67
v_perm_b32 v154, v206, v202, s66
v_perm_b32 v162, v206, v202, s67
v_perm_b32 v170, v207, v203, s66
v_perm_b32 v178, v207, v203, s67
s_waitcnt vmcnt(3)
buffer_load_dwordx4 v[224:227], v9, s[40:43], s61 offen offset:2048
s_waitcnt vmcnt(3)
buffer_load_dwordx4 v[228:231], v9, s[40:43], s61 offen offset:3072
v_perm_b32 v123, v212, v208, s66
v_perm_b32 v131, v212, v208, s67
v_perm_b32 v139, v213, v209, s66
v_perm_b32 v147, v213, v209, s67
v_perm_b32 v155, v214, v210, s66
v_perm_b32 v163, v214, v210, s67
v_perm_b32 v171, v215, v211, s66
v_perm_b32 v179, v215, v211, s67
s_waitcnt vmcnt(3)
s_cmp_lg_u32 s38, 0
s_cbranch_scc1 L_A_qc24
v_cmp_ne_u32 s[62:63], s88, v45
v_cmp_ne_u32 vcc, s88, v47
s_nop 1
s_or_b64 vcc, vcc, s[62:63]
s_cbranch_scc1 L_A_qc24
s_mov_b32 s38, 1
v_mov_b32 v45, v46
v_mov_b32 v46, 1
ds_write_b64 v11, v[44:45] offset:1024
ds_write_b32 v8, v46 offset:0
L_A_qc24:
s_cmp_lg_u32 s38, 0
s_cbranch_scc1 L_A_qt24
buffer_load_dwordx4 v[44:47], v10, s[44:47], 0 offen sc1
L_A_qt24:
s_mov_b32 s61, 102400
buffer_load_dwordx4 v[232:235], v9, s[40:43], s61 offen offset:0
s_waitcnt vmcnt(3)
buffer_load_dwordx4 v[236:239], v9, s[40:43], s61 offen offset:1024
v_perm_b32 v124, v220, v216, s66
v_perm_b32 v132, v220, v216, s67
v_perm_b32 v140, v221, v217, s66
v_perm_b32 v148, v221, v217, s67
v_perm_b32 v156, v222, v218, s66
v_perm_b32 v164, v222, v218, s67
v_perm_b32 v172, v223, v219, s66
v_perm_b32 v180, v223, v219, s67
s_waitcnt vmcnt(3)
buffer_load_dwordx4 v[240:243], v9, s[40:43], s61 offen offset:2048
s_waitcnt vmcnt(3)
buffer_load_dwordx4 v[244:247], v9, s[40:43], s61 offen offset:3072
v_perm_b32 v125, v228, v224, s66
v_perm_b32 v133, v228, v224, s67
v_perm_b32 v141, v229, v225, s66
v_perm_b32 v149, v229, v225, s67
v_perm_b32 v157, v230, v226, s66
v_perm_b32 v165, v230, v226, s67
v_perm_b32 v173, v231, v227, s66
v_perm_b32 v181, v231, v227, s67
s_waitcnt vmcnt(3)
s_cmp_lg_u32 s38, 0
s_cbranch_scc1 L_A_qc28
v_cmp_ne_u32 s[62:63], s88, v45
v_cmp_ne_u32 vcc, s88, v47
s_nop 1
s_or_b64 vcc, vcc, s[62:63]
s_cbranch_scc1 L_A_qc28
s_mov_b32 s38, 1
v_mov_b32 v45, v46
v_mov_b32 v46, 1
ds_write_b64 v11, v[44:45] offset:1024
ds_write_b32 v8, v46 offset:0
L_A_qc28:
s_waitcnt vmcnt(2)
v_perm_b32 v126, v236, v232, s66
v_perm_b32 v134, v236, v232, s67
v_perm_b32 v142, v237, v233, s66
v_perm_b32 v150, v237, v233, s67
v_perm_b32 v158, v238, v234, s66
v_perm_b32 v166, v238, v234, s67
v_perm_b32 v174, v239, v235, s66
v_perm_b32 v182, v239, v235, s67
s_waitcnt vmcnt(1)
s_waitcnt vmcnt(0)
v_perm_b32 v127, v244, v240, s66
v_perm_b32 v135, v244, v240, s67
v_perm_b32 v143, v245, v241, s66
v_perm_b32 v151, v245, v241, s67
v_perm_b32 v159, v246, v242, s66
v_perm_b32 v167, v246, v242, s67
v_perm_b32 v175, v247, v243, s66
v_perm_b32 v183, v247, v243, s67
v_mov_b32 v184, 0
v_mov_b32 v185, 0
v_mov_b32 v186, 0
v_mov_b32 v187, 0
v_mov_b32 v188, 0
v_mov_b32 v189, 0
v_mov_b32 v190, 0
v_mov_b32 v191, 0
v_mov_b32 v192, 0
v_mov_b32 v193, 0
v_mov_b32 v194, 0
v_mov_b32 v195, 0
v_mov_b32 v196, 0
v_mov_b32 v197, 0
v_mov_b32 v198, 0
v_mov_b32 v199, 0
v_mov_b32 v200, 0
v_mov_b32 v201, 0
v_mov_b32 v202, 0
v_mov_b32 v203, 0
v_mov_b32 v204, 0
v_mov_b32 v205, 0
v_mov_b32 v206, 0
v_mov_b32 v207, 0
v_mov_b32 v208, 0
v_mov_b32 v209, 0
v_mov_b32 v210, 0
v_mov_b32 v211, 0
v_mov_b32 v212, 0
v_mov_b32 v213, 0
v_mov_b32 v214, 0
v_mov_b32 v215, 0
s_mov_b32 s60, s37
s_cmp_lg_u32 s35, 0
s_cbranch_scc1 L_A_nostat
s_cmp_lg_u32 s38, 0
s_cbranch_scc1 L_A_qdone
s_mov_b32 s64, 0
L_tp_Aq:
buffer_load_dwordx4 v[44:47], v10, s[44:47], 0 offen sc1
s_waitcnt vmcnt(0)
v_cmp_ne_u32 s[62:63], s88, v45
v_cmp_ne_u32 vcc, s88, v47
s_add_u32 s64, s64, 1
s_nop 0
s_or_b64 vcc, vcc, s[62:63]
s_cbranch_scc0 L_tp_Aq_ok
s_cmp_lt_u32 s64, 65536
s_cbranch_scc1 L_tp_Aq
L_tp_Aq_ok:
v_mov_b32 v45, v46
v_mov_b32 v46, 1
ds_write_b64 v11, v[44:45] offset:1024
ds_write_b32 v8, v46 offset:0
L_A_qdone:
s_mov_b32 s64, 0
L_A_hs:
ds_read_b32 v10, v8 offset:4
s_waitcnt lgkmcnt(0)
v_readfirstlane_b32 s65, v10
s_add_u32 s64, s64, 1
s_nop 2
s_cmp_ge_u32 s65, 4
s_cbranch_scc1 L_A_hs_ok
s_sleep 16
s_cmp_lt_u32 s64, 1048576
s_cbranch_scc1 L_A_hs
L_A_hs_ok:
s_waitcnt vmcnt(0)
v_and_b32 v10, 1, v1
v_lshlrev_b32 v11, 4, v10
ds_read_b128 v[44:47], v11 offset:64
ds_read_b128 v[48:51], v11 offset:96
v_lshlrev_b32 v10, 12, v10
s_lshl_b32 s63, s60, 4
s_add_u32 s63, s63, 0x14000
v_add_u32 v10, s63, v10
s_lshl_b32 s63, s60, 7
s_add_u32 s63, s63, 0x50000
v_lshl_add_u32 v10, v1, 4, s63
s_waitcnt lgkmcnt(0)
v_max3_f32 v52, v44, v45, v46
v_max_f32 v52, v52, v47
v_sub_f32 v44, v44, v52
v_sub_f32 v45, v45, v52
v_sub_f32 v46, v46, v52
v_sub_f32 v47, v47, v52
v_exp_f32 v44, v44
v_exp_f32 v45, v45
v_exp_f32 v46, v46
v_exp_f32 v47, v47
s_nop 0
v_mul_f32 v54, v44, v48
v_fma_f32 v54, v45, v49, v54
v_fma_f32 v54, v46, v50, v54
v_fma_f32 v54, v47, v51, v54
v_mov_b32 v53, s88
v_mov_b32 v55, s88
s_mov_b64 exec, 255
global_store_dwordx4 v10, v[52:55], s[30:31] sc1
s_mov_b64 exec, -1
L_A_nostat:
s_sub_u32 s63, s35, 1
s_cmp_gt_u32 s63, 1
s_cbranch_scc1 L_A_monx
s_and_b32 s63, s32, 7
s_mul_i32 s63, s63, 0x100
s_add_u32 s63, s63, 0xc0000
s_add_u32 s56, s30, s63
s_addc_u32 s57, s31, 0
s_mov_b32 s64, 0
s_mov_b32 s59, 0
s_lshr_b32 s62, s32, 3
s_mul_i32 s62, s62, 6
s_add_u32 s62, s62, s33
s_lshl_b32 s62, s62, 2
v_mov_b32 v44, s62
v_lshlrev_b32 v48, 2, v1
s_lshr_b32 s65, s62, 2
s_cmp_eq_u32 s35, 1
s_cbranch_scc1 L_A_mon
s_mov_b64 exec, 1
s_mov_b32 s59, -4
L_A_post:
ds_read_b32 v45, v8 offset:256
s_waitcnt lgkmcnt(0)
v_readfirstlane_b32 s58, v45
v_add_u32 v46, s88, v45
s_sub_u32 s63, s58, s59
s_cmp_lt_u32 s63, 4
s_cbranch_scc1 L_A_postn
global_store_dword v44, v46, s[56:57]
s_mov_b32 s59, s58
s_cmp_ge_u32 s58, 640
s_cbranch_scc1 L_A_monx
L_A_postn:
s_sleep 2
s_add_u32 s64, s64, 1
s_cmp_lt_u32 s64, 65536
s_cbranch_scc1 L_A_post
s_branch L_A_monx
L_A_mon:
s_mov_b64 exec, 1
ds_read_b32 v45, v8 offset:256
s_waitcnt lgkmcnt(0)
v_add_u32 v46, s88, v45
v_readfirstlane_b32 s58, v45
s_mov_b64 exec, 0x1ffffff
global_load_dword v49, v48, s[56:57] nt
s_waitcnt vmcnt(0)
v_subrev_u32 v49, s88, v49
s_mov_b64 exec, 0xffffff
v_cmp_le_u32 vcc, 0x400, v49
v_readlane_b32 s62, v49, 24
v_readlane_b32 s59, v49, s65
v_add_u32_dpp v49, v49, v49 row_shr:1 row_mask:0xf bank_mask:0xf bound_ctrl:0
s_nop 1
v_add_u32_dpp v49, v49, v49 row_shr:2 row_mask:0xf bank_mask:0xf bound_ctrl:0
s_nop 1
v_add_u32_dpp v49, v49, v49 row_shr:4 row_mask:0xf bank_mask:0xf bound_ctrl:0
s_nop 1
v_add_u32_dpp v49, v49, v49 row_shr:8 row_mask:0xf bank_mask:0xf bound_ctrl:0
s_nop 0
v_readlane_b32 s61, v49, 15
v_readlane_b32 s63, v49, 23
s_add_u32 s61, s61, s63
s_mul_i32 s63, s59, 24
s_sub_u32 s61, s61, s63
s_cmp_lt_u32 s62, 0x8000
s_cselect_b32 s62, s62, 0x4000
s_add_u32 s61, s61, s62
s_sub_u32 s61, s61, 0x4000
s_mov_b32 s63, -48
s_cmp_lt_u32 s58, 400
s_cselect_b32 s63, s63, -48
s_cmp_gt_i32 s61, s63
s_cselect_b32 s63, 1, 0
s_cmp_eq_u64 vcc, 0
s_cselect_b32 s63, s63, 0
s_cmp_lt_u32 s58, 620
s_cselect_b32 s63, s63, 1
v_mov_b32 v47, s63
ds_write_b32 v8, v47 offset:8
s_mov_b32 s59, s58
s_cmp_ge_u32 s58, 620
s_cbranch_scc1 L_A_monx
s_add_u32 s64, s64, 1
s_cmp_lt_u32 s64, 4096
s_cbranch_scc1 L_A_mon
L_A_monx:
s_mov_b64 exec, -1
v_mul_u32_u24 v10, 144, v2
v_lshl_add_u32 v10, v3, 4, v10
v_and_b32 v28, 1, v2
v_mul_u32_u24 v28, 0xaaaa, v28
v_add_u32 v28, 0x4444, v28
v_lshrrev_b32 v11, 1, v3
v_lshlrev_b32 v11, 18, v11
v_and_b32 v29, 31, v1
v_lshl_add_u32 v11, v29, 3, v11
s_lshl_b32 s63, s60, 10
s_lshl_b32 s62, s35, 8
s_add_u32 s63, s63, s62
s_add_u32 s63, s63, 0x100000
v_add_u32 v11, s63, v11
s_barrier
ds_read_b128 v[12:15], v10 offset:8192
ds_read_b128 v[16:19], v10 offset:8256
s_waitcnt lgkmcnt(1)
v_smfmac_f32_16x16x64_bf16 v[184:187], v[12:15], v[56:63], v28
v_smfmac_f32_16x16x64_bf16 v[200:203], v[12:15], v[88:95], v28
s_waitcnt lgkmcnt(0)
v_smfmac_f32_16x16x64_bf16 v[184:187], v[16:19], v[120:127], v28
v_smfmac_f32_16x16x64_bf16 v[200:203], v[16:19], v[152:159], v28
v_smfmac_f32_16x16x64_bf16 v[188:191], v[12:15], v[64:71], v28
v_smfmac_f32_16x16x64_bf16 v[204:207], v[12:15], v[96:103], v28
v_smfmac_f32_16x16x64_bf16 v[188:191], v[16:19], v[128:135], v28
v_smfmac_f32_16x16x64_bf16 v[204:207], v[16:19], v[160:167], v28
v_smfmac_f32_16x16x64_bf16 v[192:195], v[12:15], v[72:79], v28
v_smfmac_f32_16x16x64_bf16 v[208:211], v[12:15], v[104:111], v28
v_smfmac_f32_16x16x64_bf16 v[192:195], v[16:19], v[136:143], v28
v_smfmac_f32_16x16x64_bf16 v[208:211], v[16:19], v[168:175], v28
v_smfmac_f32_16x16x64_bf16 v[196:199], v[12:15], v[80:87], v28
v_smfmac_f32_16x16x64_bf16 v[212:215], v[12:15], v[112:119], v28
v_smfmac_f32_16x16x64_bf16 v[196:199], v[16:19], v[144:151], v28
v_smfmac_f32_16x16x64_bf16 v[212:215], v[16:19], v[176:183], v28
v_pk_add_f32 v[184:185], v[184:185], v[186:187]
v_pk_add_f32 v[200:201], v[200:201], v[202:203]
v_add_f32 v184, v184, v185
v_add_f32 v200, v200, v201
v_pk_add_f32 v[188:189], v[188:189], v[190:191]
v_pk_add_f32 v[204:205], v[204:205], v[206:207]
v_permlane16_swap_b32 v184, v200
v_add_f32 v188, v188, v189
v_add_f32 v204, v204, v205
v_pk_add_f32 v[192:193], v[192:193], v[194:195]
v_pk_add_f32 v[208:209], v[208:209], v[210:211]
v_add_f32 v184, v184, v200
v_permlane16_swap_b32 v188, v204
v_add_f32 v192, v192, v193
v_add_f32 v208, v208, v209
v_add_f32 v188, v188, v204
v_pk_add_f32 v[196:197], v[196:197], v[198:199]
v_pk_add_f32 v[212:213], v[212:213], v[214:215]
v_permlane16_swap_b32 v192, v208
v_add_f32 v196, v196, v197
v_add_f32 v212, v212, v213
v_cvt_pk_bf16_f32 v36, v184, v188
v_add_f32 v192, v192, v208
v_permlane16_swap_b32 v196, v212
v_min_u32 v36, 0xfffffffe, v36
v_add_f32 v196, v196, v212
v_cvt_pk_bf16_f32 v37, v192, v196
v_min_u32 v37, 0xfffffffe, v37
global_store_dwordx2 v11, v[36:37], s[30:31] sc1
s_endpgm
L_roleW:
s_mov_b32 s89, s32
v_and_b32 v1, 63, v0
v_and_b32 v2, 15, v0
v_bfe_u32 v3, v0, 4, 2
v_and_b32 v8, 1, v0
v_lshlrev_b32 v8, 4, v8
v_mov_b32 v9, 0xffff
v_lshlrev_b32 v8, v8, v9
v_bfe_u32 v9, v0, 1, 2
v_cmp_eq_u32 vcc, 0, v9
s_nop 1
v_cndmask_b32 v4, 0, v8, vcc
v_cmp_eq_u32 vcc, 1, v9
s_nop 1
v_cndmask_b32 v5, 0, v8, vcc
v_cmp_eq_u32 vcc, 2, v9
s_nop 1
v_cndmask_b32 v6, 0, v8, vcc
v_cmp_eq_u32 vcc, 3, v9
s_nop 1
v_cndmask_b32 v7, 0, v8, vcc
s_waitcnt lgkmcnt(0)
s_load_dword s88, s[30:31], 0x18000
v_mov_b32 v8, 0
s_mov_b32 s52, s30
s_and_b32 s53, s31, 0xffff
s_mov_b32 s54, 0x1000000
s_mov_b32 s55, 0x20000
s_lshl_b32 s60, s89, 8
s_sub_u32 s61, 0x400000, s60
s_add_u32 s40, s18, s60
s_addc_u32 s41, s19, 0
s_and_b32 s41, s41, 0xffff
s_mov_b32 s42, s61
s_mov_b32 s43, 0x20000
s_add_u32 s44, s20, s60
s_addc_u32 s45, s21, 0
s_and_b32 s45, s45, 0xffff
s_mov_b32 s46, s61
s_mov_b32 s47, 0x20000
s_mov_b32 s48, s14
s_and_b32 s49, s15, 0xffff
s_mov_b32 s50, 0x800
s_mov_b32 s51, 0x20000
v_lshrrev_b32 v192, 3, v2
v_lshlrev_b32 v192, 10, v192
v_lshl_add_u32 v192, v3, 5, v192
s_lshl_b32 s62, s34, 7
v_add_u32 v192, s62, v192
buffer_load_dwordx4 v[12:15], v192, s[48:51], 0 offen
buffer_load_dwordx4 v[16:19], v192, s[48:51], 0 offen offset:16
v_lshlrev_b32 v9, 17, v3
v_lshl_add_u32 v9, v2, 4, v9
s_lshl_b32 s62, s34, 19
v_add_u32 v9, s62, v9
s_waitcnt vmcnt(2)
s_mov_b32 s62, 0
buffer_load_dwordx4 v[64:67], v9, s[40:43], s62 offen nt
s_waitcnt vmcnt(2)
s_mov_b32 s62, 8192
buffer_load_dwordx4 v[68:71], v9, s[40:43], s62 offen nt
s_waitcnt vmcnt(2)
s_mov_b32 s62, 16384
buffer_load_dwordx4 v[72:75], v9, s[40:43], s62 offen nt
s_waitcnt vmcnt(2)
s_mov_b32 s62, 24576
buffer_load_dwordx4 v[76:79], v9, s[40:43], s62 offen nt
s_waitcnt vmcnt(2)
s_mov_b32 s62, 32768
buffer_load_dwordx4 v[80:83], v9, s[40:43], s62 offen nt
s_waitcnt vmcnt(2)
s_mov_b32 s62, 40960
buffer_load_dwordx4 v[84:87], v9, s[40:43], s62 offen nt
s_waitcnt vmcnt(2)
s_mov_b32 s62, 49152
buffer_load_dwordx4 v[88:91], v9, s[40:43], s62 offen nt
s_waitcnt vmcnt(2)
s_mov_b32 s62, 57344
buffer_load_dwordx4 v[92:95], v9, s[40:43], s62 offen nt
s_waitcnt vmcnt(2)
s_mov_b32 s62, 65536
buffer_load_dwordx4 v[96:99], v9, s[40:43], s62 offen nt
s_waitcnt vmcnt(2)
s_mov_b32 s62, 73728
buffer_load_dwordx4 v[100:103], v9, s[40:43], s62 offen nt
s_waitcnt vmcnt(2)
s_mov_b32 s62, 81920
buffer_load_dwordx4 v[104:107], v9, s[40:43], s62 offen nt
s_waitcnt vmcnt(2)
s_mov_b32 s62, 90112
buffer_load_dwordx4 v[108:111], v9, s[40:43], s62 offen nt
s_waitcnt vmcnt(2)
s_mov_b32 s62, 98304
buffer_load_dwordx4 v[112:115], v9, s[40:43], s62 offen nt
s_waitcnt vmcnt(2)
s_mov_b32 s62, 106496
buffer_load_dwordx4 v[116:119], v9, s[40:43], s62 offen nt
s_waitcnt vmcnt(2)
s_mov_b32 s62, 114688
buffer_load_dwordx4 v[120:123], v9, s[40:43], s62 offen nt
s_waitcnt vmcnt(2)
s_mov_b32 s62, 122880
buffer_load_dwordx4 v[124:127], v9, s[40:43], s62 offen nt
s_barrier
s_waitcnt vmcnt(16)
s_mov_b32 s60, 0x01000100
v_perm_b32 v192, v12, v12, s60
v_and_b32 v28, v192, v4
v_and_b32 v29, v192, v5
v_and_b32 v30, v192, v6
v_and_b32 v31, v192, v7
s_waitcnt vmcnt(15)
s_nop 0
v_mfma_f32_16x16x32_bf16 v[44:47], v[28:31], v[64:67], 0
s_mov_b32 s62, 0
buffer_load_dwordx4 v[128:131], v9, s[44:47], s62 offen nt
s_mov_b32 s60, 0x03020302
v_perm_b32 v193, v12, v12, s60
v_and_b32 v32, v193, v4
v_and_b32 v33, v193, v5
v_and_b32 v34, v193, v6
v_and_b32 v35, v193, v7
s_waitcnt vmcnt(15)
s_nop 0
v_mfma_f32_16x16x32_bf16 v[44:47], v[32:35], v[68:71], v[44:47]
s_mov_b32 s62, 8192
buffer_load_dwordx4 v[132:135], v9, s[44:47], s62 offen nt
s_mov_b32 s60, 0x01000100
v_perm_b32 v192, v13, v13, s60
v_and_b32 v28, v192, v4
v_and_b32 v29, v192, v5
v_and_b32 v30, v192, v6
v_and_b32 v31, v192, v7
s_waitcnt vmcnt(15)
s_nop 0
v_mfma_f32_16x16x32_bf16 v[44:47], v[28:31], v[72:75], v[44:47]
s_mov_b32 s62, 16384
buffer_load_dwordx4 v[136:139], v9, s[44:47], s62 offen nt
s_mov_b32 s60, 0x03020302
v_perm_b32 v193, v13, v13, s60
v_and_b32 v32, v193, v4
v_and_b32 v33, v193, v5
v_and_b32 v34, v193, v6
v_and_b32 v35, v193, v7
s_waitcnt vmcnt(15)
s_nop 0
v_mfma_f32_16x16x32_bf16 v[44:47], v[32:35], v[76:79], v[44:47]
s_mov_b32 s62, 24576
buffer_load_dwordx4 v[140:143], v9, s[44:47], s62 offen nt
s_mov_b32 s60, 0x01000100
v_perm_b32 v192, v14, v14, s60
v_and_b32 v28, v192, v4
v_and_b32 v29, v192, v5
v_and_b32 v30, v192, v6
v_and_b32 v31, v192, v7
s_waitcnt vmcnt(15)
s_nop 0
v_mfma_f32_16x16x32_bf16 v[44:47], v[28:31], v[80:83], v[44:47]
s_mov_b32 s62, 32768
buffer_load_dwordx4 v[144:147], v9, s[44:47], s62 offen nt
s_mov_b32 s60, 0x03020302
v_perm_b32 v193, v14, v14, s60
v_and_b32 v32, v193, v4
v_and_b32 v33, v193, v5
v_and_b32 v34, v193, v6
v_and_b32 v35, v193, v7
s_waitcnt vmcnt(15)
s_nop 0
v_mfma_f32_16x16x32_bf16 v[44:47], v[32:35], v[84:87], v[44:47]
s_mov_b32 s62, 40960
buffer_load_dwordx4 v[148:151], v9, s[44:47], s62 offen nt
s_mov_b32 s60, 0x01000100
v_perm_b32 v192, v15, v15, s60
v_and_b32 v28, v192, v4
v_and_b32 v29, v192, v5
v_and_b32 v30, v192, v6
v_and_b32 v31, v192, v7
s_waitcnt vmcnt(15)
s_nop 0
v_mfma_f32_16x16x32_bf16 v[44:47], v[28:31], v[88:91], v[44:47]
s_mov_b32 s62, 49152
buffer_load_dwordx4 v[152:155], v9, s[44:47], s62 offen nt
s_mov_b32 s60, 0x03020302
v_perm_b32 v193, v15, v15, s60
v_and_b32 v32, v193, v4
v_and_b32 v33, v193, v5
v_and_b32 v34, v193, v6
v_and_b32 v35, v193, v7
s_waitcnt vmcnt(15)
s_nop 0
v_mfma_f32_16x16x32_bf16 v[44:47], v[32:35], v[92:95], v[44:47]
s_mov_b32 s62, 57344
buffer_load_dwordx4 v[156:159], v9, s[44:47], s62 offen nt
s_mov_b32 s60, 0x01000100
v_perm_b32 v192, v16, v16, s60
v_and_b32 v28, v192, v4
v_and_b32 v29, v192, v5
v_and_b32 v30, v192, v6
v_and_b32 v31, v192, v7
s_waitcnt vmcnt(15)
s_nop 0
v_mfma_f32_16x16x32_bf16 v[44:47], v[28:31], v[96:99], v[44:47]
s_mov_b32 s62, 65536
buffer_load_dwordx4 v[160:163], v9, s[44:47], s62 offen nt
s_mov_b32 s60, 0x03020302
v_perm_b32 v193, v16, v16, s60
v_and_b32 v32, v193, v4
v_and_b32 v33, v193, v5
v_and_b32 v34, v193, v6
v_and_b32 v35, v193, v7
s_waitcnt vmcnt(15)
s_nop 0
v_mfma_f32_16x16x32_bf16 v[44:47], v[32:35], v[100:103], v[44:47]
s_mov_b32 s62, 73728
buffer_load_dwordx4 v[164:167], v9, s[44:47], s62 offen nt
s_mov_b32 s60, 0x01000100
v_perm_b32 v192, v17, v17, s60
v_and_b32 v28, v192, v4
v_and_b32 v29, v192, v5
v_and_b32 v30, v192, v6
v_and_b32 v31, v192, v7
s_waitcnt vmcnt(15)
s_nop 0
v_mfma_f32_16x16x32_bf16 v[44:47], v[28:31], v[104:107], v[44:47]
s_mov_b32 s62, 81920
buffer_load_dwordx4 v[168:171], v9, s[44:47], s62 offen nt
s_mov_b32 s60, 0x03020302
v_perm_b32 v193, v17, v17, s60
v_and_b32 v32, v193, v4
v_and_b32 v33, v193, v5
v_and_b32 v34, v193, v6
v_and_b32 v35, v193, v7
s_waitcnt vmcnt(15)
s_nop 0
v_mfma_f32_16x16x32_bf16 v[44:47], v[32:35], v[108:111], v[44:47]
s_mov_b32 s62, 90112
buffer_load_dwordx4 v[172:175], v9, s[44:47], s62 offen nt
s_mov_b32 s60, 0x01000100
v_perm_b32 v192, v18, v18, s60
v_and_b32 v28, v192, v4
v_and_b32 v29, v192, v5
v_and_b32 v30, v192, v6
v_and_b32 v31, v192, v7
s_waitcnt vmcnt(15)
s_nop 0
v_mfma_f32_16x16x32_bf16 v[44:47], v[28:31], v[112:115], v[44:47]
s_mov_b32 s62, 98304
buffer_load_dwordx4 v[176:179], v9, s[44:47], s62 offen nt
s_mov_b32 s60, 0x03020302
v_perm_b32 v193, v18, v18, s60
v_and_b32 v32, v193, v4
v_and_b32 v33, v193, v5
v_and_b32 v34, v193, v6
v_and_b32 v35, v193, v7
s_waitcnt vmcnt(15)
s_nop 0
v_mfma_f32_16x16x32_bf16 v[44:47], v[32:35], v[116:119], v[44:47]
s_mov_b32 s62, 106496
buffer_load_dwordx4 v[180:183], v9, s[44:47], s62 offen nt
s_mov_b32 s60, 0x01000100
v_perm_b32 v192, v19, v19, s60
v_and_b32 v28, v192, v4
v_and_b32 v29, v192, v5
v_and_b32 v30, v192, v6
v_and_b32 v31, v192, v7
s_waitcnt vmcnt(15)
s_nop 0
v_mfma_f32_16x16x32_bf16 v[44:47], v[28:31], v[120:123], v[44:47]
s_mov_b32 s62, 114688
buffer_load_dwordx4 v[184:187], v9, s[44:47], s62 offen nt
s_mov_b32 s60, 0x03020302
v_perm_b32 v193, v19, v19, s60
v_and_b32 v32, v193, v4
v_and_b32 v33, v193, v5
v_and_b32 v34, v193, v6
v_and_b32 v35, v193, v7
s_waitcnt vmcnt(15)
s_nop 0
v_mfma_f32_16x16x32_bf16 v[44:47], v[32:35], v[124:127], v[44:47]
s_mov_b32 s62, 122880
buffer_load_dwordx4 v[188:191], v9, s[44:47], s62 offen nt
s_nop 1
v_lshrrev_b32 v192, 1, v3
v_lshlrev_b32 v192, 9, v192
v_lshl_add_u32 v192, v2, 5, v192
v_and_b32 v193, 1, v3
v_lshl_add_u32 v192, v193, 4, v192
s_lshl_b32 s63, s34, 10
v_add_u32 v192, s63, v192
s_nop 1
s_nop 5
ds_write_b128 v192, v[44:47] offset:0
s_waitcnt lgkmcnt(0)
s_barrier
s_cmp_ge_u32 s34, 4
s_cbranch_scc1 L_W_qskip
v_lshlrev_b32 v194, 2, v0
ds_read_b32 v196, v194 offset:0
ds_read_b32 v197, v194 offset:1024
ds_read_b32 v198, v194 offset:2048
ds_read_b32 v199, v194 offset:3072
ds_read_b32 v200, v194 offset:4096
ds_read_b32 v201, v194 offset:5120
ds_read_b32 v202, v194 offset:6144
ds_read_b32 v203, v194 offset:7168
s_waitcnt lgkmcnt(0)
v_add_f32 v196, v196, v197
v_add_f32 v196, v196, v198
v_add_f32 v196, v196, v199
v_add_f32 v196, v196, v200
v_add_f32 v196, v196, v201
v_add_f32 v196, v196, v202
v_add_f32 v196, v196, v203
v_cvt_pk_bf16_f32 v196, v196, v196
v_lshlrev_b32 v194, 1, v0
ds_write_b16 v194, v196 offset:8192
s_waitcnt lgkmcnt(0)
L_W_qskip:
s_barrier
s_waitcnt lgkmcnt(0)
s_add_u32 s88, s88, 0x9e3779b9
v_lshlrev_b32 v194, 4, v2
ds_read_b128 v[20:23], v194 offset:8192
ds_read_b128 v[24:27], v194 offset:8448
v_mov_b32 v200, 0
v_mov_b32 v201, 0
s_waitcnt lgkmcnt(0)
s_waitcnt vmcnt(14)
v_dot2_f32_bf16 v60, v128, v20, 0
v_dot2_f32_bf16 v61, v128, v24, 0
v_dot2_f32_bf16 v62, v132, v20, 0
v_dot2_f32_bf16 v63, v132, v24, 0
v_dot2_f32_bf16 v60, v129, v21, v60
v_dot2_f32_bf16 v61, v129, v25, v61
v_dot2_f32_bf16 v62, v133, v21, v62
v_dot2_f32_bf16 v63, v133, v25, v63
v_dot2_f32_bf16 v60, v130, v22, v60
v_dot2_f32_bf16 v61, v130, v26, v61
v_dot2_f32_bf16 v62, v134, v22, v62
v_dot2_f32_bf16 v63, v134, v26, v63
v_dot2_f32_bf16 v60, v131, v23, v60
v_dot2_f32_bf16 v61, v131, v27, v61
v_dot2_f32_bf16 v62, v135, v23, v62
v_dot2_f32_bf16 v63, v135, v27, v63
v_add_f32_dpp v60, v60, v60 row_ror:8 row_mask:0xf bank_mask:0xf
v_add_f32_dpp v61, v61, v61 row_ror:8 row_mask:0xf bank_mask:0xf
v_add_f32_dpp v62, v62, v62 row_ror:8 row_mask:0xf bank_mask:0xf
v_add_f32_dpp v63, v63, v63 row_ror:8 row_mask:0xf bank_mask:0xf
v_add_f32_dpp v60, v60, v60 row_ror:4 row_mask:0xf bank_mask:0xf
v_add_f32_dpp v61, v61, v61 row_ror:4 row_mask:0xf bank_mask:0xf
v_add_f32_dpp v62, v62, v62 row_ror:4 row_mask:0xf bank_mask:0xf
v_add_f32_dpp v63, v63, v63 row_ror:4 row_mask:0xf bank_mask:0xf
v_add_f32_dpp v60, v60, v60 row_ror:2 row_mask:0xf bank_mask:0xf
v_add_f32_dpp v61, v61, v61 row_ror:2 row_mask:0xf bank_mask:0xf
v_add_f32_dpp v62, v62, v62 row_ror:2 row_mask:0xf bank_mask:0xf
v_add_f32_dpp v63, v63, v63 row_ror:2 row_mask:0xf bank_mask:0xf
v_add_f32_dpp v60, v60, v60 row_ror:1 row_mask:0xf bank_mask:0xf
v_add_f32_dpp v61, v61, v61 row_ror:1 row_mask:0xf bank_mask:0xf
v_add_f32_dpp v62, v62, v62 row_ror:1 row_mask:0xf bank_mask:0xf
v_add_f32_dpp v63, v63, v63 row_ror:1 row_mask:0xf bank_mask:0xf
v_cmp_eq_u32 vcc, 0, v2
s_nop 1
v_cndmask_b32 v200, v200, v60, vcc
v_cndmask_b32 v201, v201, v61, vcc
v_cmp_eq_u32 vcc, 1, v2
s_nop 1
v_cndmask_b32 v200, v200, v62, vcc
v_cndmask_b32 v201, v201, v63, vcc
s_waitcnt vmcnt(12)
v_dot2_f32_bf16 v60, v136, v20, 0
v_dot2_f32_bf16 v61, v136, v24, 0
v_dot2_f32_bf16 v62, v140, v20, 0
v_dot2_f32_bf16 v63, v140, v24, 0
v_dot2_f32_bf16 v60, v137, v21, v60
v_dot2_f32_bf16 v61, v137, v25, v61
v_dot2_f32_bf16 v62, v141, v21, v62
v_dot2_f32_bf16 v63, v141, v25, v63
v_dot2_f32_bf16 v60, v138, v22, v60
v_dot2_f32_bf16 v61, v138, v26, v61
v_dot2_f32_bf16 v62, v142, v22, v62
v_dot2_f32_bf16 v63, v142, v26, v63
v_dot2_f32_bf16 v60, v139, v23, v60
v_dot2_f32_bf16 v61, v139, v27, v61
v_dot2_f32_bf16 v62, v143, v23, v62
v_dot2_f32_bf16 v63, v143, v27, v63
v_add_f32_dpp v60, v60, v60 row_ror:8 row_mask:0xf bank_mask:0xf
v_add_f32_dpp v61, v61, v61 row_ror:8 row_mask:0xf bank_mask:0xf
v_add_f32_dpp v62, v62, v62 row_ror:8 row_mask:0xf bank_mask:0xf
v_add_f32_dpp v63, v63, v63 row_ror:8 row_mask:0xf bank_mask:0xf
v_add_f32_dpp v60, v60, v60 row_ror:4 row_mask:0xf bank_mask:0xf
v_add_f32_dpp v61, v61, v61 row_ror:4 row_mask:0xf bank_mask:0xf
v_add_f32_dpp v62, v62, v62 row_ror:4 row_mask:0xf bank_mask:0xf
v_add_f32_dpp v63, v63, v63 row_ror:4 row_mask:0xf bank_mask:0xf
v_add_f32_dpp v60, v60, v60 row_ror:2 row_mask:0xf bank_mask:0xf
v_add_f32_dpp v61, v61, v61 row_ror:2 row_mask:0xf bank_mask:0xf
v_add_f32_dpp v62, v62, v62 row_ror:2 row_mask:0xf bank_mask:0xf
v_add_f32_dpp v63, v63, v63 row_ror:2 row_mask:0xf bank_mask:0xf
v_add_f32_dpp v60, v60, v60 row_ror:1 row_mask:0xf bank_mask:0xf
v_add_f32_dpp v61, v61, v61 row_ror:1 row_mask:0xf bank_mask:0xf
v_add_f32_dpp v62, v62, v62 row_ror:1 row_mask:0xf bank_mask:0xf
v_add_f32_dpp v63, v63, v63 row_ror:1 row_mask:0xf bank_mask:0xf
v_cmp_eq_u32 vcc, 2, v2
s_nop 1
v_cndmask_b32 v200, v200, v60, vcc
v_cndmask_b32 v201, v201, v61, vcc
v_cmp_eq_u32 vcc, 3, v2
s_nop 1
v_cndmask_b32 v200, v200, v62, vcc
v_cndmask_b32 v201, v201, v63, vcc
s_waitcnt vmcnt(10)
v_dot2_f32_bf16 v60, v144, v20, 0
v_dot2_f32_bf16 v61, v144, v24, 0
v_dot2_f32_bf16 v62, v148, v20, 0
v_dot2_f32_bf16 v63, v148, v24, 0
v_dot2_f32_bf16 v60, v145, v21, v60
v_dot2_f32_bf16 v61, v145, v25, v61
v_dot2_f32_bf16 v62, v149, v21, v62
v_dot2_f32_bf16 v63, v149, v25, v63
v_dot2_f32_bf16 v60, v146, v22, v60
v_dot2_f32_bf16 v61, v146, v26, v61
v_dot2_f32_bf16 v62, v150, v22, v62
v_dot2_f32_bf16 v63, v150, v26, v63
v_dot2_f32_bf16 v60, v147, v23, v60
v_dot2_f32_bf16 v61, v147, v27, v61
v_dot2_f32_bf16 v62, v151, v23, v62
v_dot2_f32_bf16 v63, v151, v27, v63
v_add_f32_dpp v60, v60, v60 row_ror:8 row_mask:0xf bank_mask:0xf
v_add_f32_dpp v61, v61, v61 row_ror:8 row_mask:0xf bank_mask:0xf
v_add_f32_dpp v62, v62, v62 row_ror:8 row_mask:0xf bank_mask:0xf
v_add_f32_dpp v63, v63, v63 row_ror:8 row_mask:0xf bank_mask:0xf
v_add_f32_dpp v60, v60, v60 row_ror:4 row_mask:0xf bank_mask:0xf
v_add_f32_dpp v61, v61, v61 row_ror:4 row_mask:0xf bank_mask:0xf
v_add_f32_dpp v62, v62, v62 row_ror:4 row_mask:0xf bank_mask:0xf
v_add_f32_dpp v63, v63, v63 row_ror:4 row_mask:0xf bank_mask:0xf
v_add_f32_dpp v60, v60, v60 row_ror:2 row_mask:0xf bank_mask:0xf
v_add_f32_dpp v61, v61, v61 row_ror:2 row_mask:0xf bank_mask:0xf
v_add_f32_dpp v62, v62, v62 row_ror:2 row_mask:0xf bank_mask:0xf
v_add_f32_dpp v63, v63, v63 row_ror:2 row_mask:0xf bank_mask:0xf
v_add_f32_dpp v60, v60, v60 row_ror:1 row_mask:0xf bank_mask:0xf
v_add_f32_dpp v61, v61, v61 row_ror:1 row_mask:0xf bank_mask:0xf
v_add_f32_dpp v62, v62, v62 row_ror:1 row_mask:0xf bank_mask:0xf
v_add_f32_dpp v63, v63, v63 row_ror:1 row_mask:0xf bank_mask:0xf
v_cmp_eq_u32 vcc, 4, v2
s_nop 1
v_cndmask_b32 v200, v200, v60, vcc
v_cndmask_b32 v201, v201, v61, vcc
v_cmp_eq_u32 vcc, 5, v2
s_nop 1
v_cndmask_b32 v200, v200, v62, vcc
v_cndmask_b32 v201, v201, v63, vcc
s_waitcnt vmcnt(8)
v_dot2_f32_bf16 v60, v152, v20, 0
v_dot2_f32_bf16 v61, v152, v24, 0
v_dot2_f32_bf16 v62, v156, v20, 0
v_dot2_f32_bf16 v63, v156, v24, 0
v_dot2_f32_bf16 v60, v153, v21, v60
v_dot2_f32_bf16 v61, v153, v25, v61
v_dot2_f32_bf16 v62, v157, v21, v62
v_dot2_f32_bf16 v63, v157, v25, v63
v_dot2_f32_bf16 v60, v154, v22, v60
v_dot2_f32_bf16 v61, v154, v26, v61
v_dot2_f32_bf16 v62, v158, v22, v62
v_dot2_f32_bf16 v63, v158, v26, v63
v_dot2_f32_bf16 v60, v155, v23, v60
v_dot2_f32_bf16 v61, v155, v27, v61
v_dot2_f32_bf16 v62, v159, v23, v62
v_dot2_f32_bf16 v63, v159, v27, v63
v_add_f32_dpp v60, v60, v60 row_ror:8 row_mask:0xf bank_mask:0xf
v_add_f32_dpp v61, v61, v61 row_ror:8 row_mask:0xf bank_mask:0xf
v_add_f32_dpp v62, v62, v62 row_ror:8 row_mask:0xf bank_mask:0xf
v_add_f32_dpp v63, v63, v63 row_ror:8 row_mask:0xf bank_mask:0xf
v_add_f32_dpp v60, v60, v60 row_ror:4 row_mask:0xf bank_mask:0xf
v_add_f32_dpp v61, v61, v61 row_ror:4 row_mask:0xf bank_mask:0xf
v_add_f32_dpp v62, v62, v62 row_ror:4 row_mask:0xf bank_mask:0xf
v_add_f32_dpp v63, v63, v63 row_ror:4 row_mask:0xf bank_mask:0xf
v_add_f32_dpp v60, v60, v60 row_ror:2 row_mask:0xf bank_mask:0xf
v_add_f32_dpp v61, v61, v61 row_ror:2 row_mask:0xf bank_mask:0xf
v_add_f32_dpp v62, v62, v62 row_ror:2 row_mask:0xf bank_mask:0xf
v_add_f32_dpp v63, v63, v63 row_ror:2 row_mask:0xf bank_mask:0xf
v_add_f32_dpp v60, v60, v60 row_ror:1 row_mask:0xf bank_mask:0xf
v_add_f32_dpp v61, v61, v61 row_ror:1 row_mask:0xf bank_mask:0xf
v_add_f32_dpp v62, v62, v62 row_ror:1 row_mask:0xf bank_mask:0xf
v_add_f32_dpp v63, v63, v63 row_ror:1 row_mask:0xf bank_mask:0xf
v_cmp_eq_u32 vcc, 6, v2
s_nop 1
v_cndmask_b32 v200, v200, v60, vcc
v_cndmask_b32 v201, v201, v61, vcc
v_cmp_eq_u32 vcc, 7, v2
s_nop 1
v_cndmask_b32 v200, v200, v62, vcc
v_cndmask_b32 v201, v201, v63, vcc
s_waitcnt vmcnt(6)
v_dot2_f32_bf16 v60, v160, v20, 0
v_dot2_f32_bf16 v61, v160, v24, 0
v_dot2_f32_bf16 v62, v164, v20, 0
v_dot2_f32_bf16 v63, v164, v24, 0
v_dot2_f32_bf16 v60, v161, v21, v60
v_dot2_f32_bf16 v61, v161, v25, v61
v_dot2_f32_bf16 v62, v165, v21, v62
v_dot2_f32_bf16 v63, v165, v25, v63
v_dot2_f32_bf16 v60, v162, v22, v60
v_dot2_f32_bf16 v61, v162, v26, v61
v_dot2_f32_bf16 v62, v166, v22, v62
v_dot2_f32_bf16 v63, v166, v26, v63
v_dot2_f32_bf16 v60, v163, v23, v60
v_dot2_f32_bf16 v61, v163, v27, v61
v_dot2_f32_bf16 v62, v167, v23, v62
v_dot2_f32_bf16 v63, v167, v27, v63
v_add_f32_dpp v60, v60, v60 row_ror:8 row_mask:0xf bank_mask:0xf
v_add_f32_dpp v61, v61, v61 row_ror:8 row_mask:0xf bank_mask:0xf
v_add_f32_dpp v62, v62, v62 row_ror:8 row_mask:0xf bank_mask:0xf
v_add_f32_dpp v63, v63, v63 row_ror:8 row_mask:0xf bank_mask:0xf
v_add_f32_dpp v60, v60, v60 row_ror:4 row_mask:0xf bank_mask:0xf
v_add_f32_dpp v61, v61, v61 row_ror:4 row_mask:0xf bank_mask:0xf
v_add_f32_dpp v62, v62, v62 row_ror:4 row_mask:0xf bank_mask:0xf
v_add_f32_dpp v63, v63, v63 row_ror:4 row_mask:0xf bank_mask:0xf
v_add_f32_dpp v60, v60, v60 row_ror:2 row_mask:0xf bank_mask:0xf
v_add_f32_dpp v61, v61, v61 row_ror:2 row_mask:0xf bank_mask:0xf
v_add_f32_dpp v62, v62, v62 row_ror:2 row_mask:0xf bank_mask:0xf
v_add_f32_dpp v63, v63, v63 row_ror:2 row_mask:0xf bank_mask:0xf
v_add_f32_dpp v60, v60, v60 row_ror:1 row_mask:0xf bank_mask:0xf
v_add_f32_dpp v61, v61, v61 row_ror:1 row_mask:0xf bank_mask:0xf
v_add_f32_dpp v62, v62, v62 row_ror:1 row_mask:0xf bank_mask:0xf
v_add_f32_dpp v63, v63, v63 row_ror:1 row_mask:0xf bank_mask:0xf
v_cmp_eq_u32 vcc, 8, v2
s_nop 1
v_cndmask_b32 v200, v200, v60, vcc
v_cndmask_b32 v201, v201, v61, vcc
v_cmp_eq_u32 vcc, 9, v2
s_nop 1
v_cndmask_b32 v200, v200, v62, vcc
v_cndmask_b32 v201, v201, v63, vcc
s_waitcnt vmcnt(4)
v_dot2_f32_bf16 v60, v168, v20, 0
v_dot2_f32_bf16 v61, v168, v24, 0
v_dot2_f32_bf16 v62, v172, v20, 0
v_dot2_f32_bf16 v63, v172, v24, 0
v_dot2_f32_bf16 v60, v169, v21, v60
v_dot2_f32_bf16 v61, v169, v25, v61
v_dot2_f32_bf16 v62, v173, v21, v62
v_dot2_f32_bf16 v63, v173, v25, v63
v_dot2_f32_bf16 v60, v170, v22, v60
v_dot2_f32_bf16 v61, v170, v26, v61
v_dot2_f32_bf16 v62, v174, v22, v62
v_dot2_f32_bf16 v63, v174, v26, v63
v_dot2_f32_bf16 v60, v171, v23, v60
v_dot2_f32_bf16 v61, v171, v27, v61
v_dot2_f32_bf16 v62, v175, v23, v62
v_dot2_f32_bf16 v63, v175, v27, v63
v_add_f32_dpp v60, v60, v60 row_ror:8 row_mask:0xf bank_mask:0xf
v_add_f32_dpp v61, v61, v61 row_ror:8 row_mask:0xf bank_mask:0xf
v_add_f32_dpp v62, v62, v62 row_ror:8 row_mask:0xf bank_mask:0xf
v_add_f32_dpp v63, v63, v63 row_ror:8 row_mask:0xf bank_mask:0xf
v_add_f32_dpp v60, v60, v60 row_ror:4 row_mask:0xf bank_mask:0xf
v_add_f32_dpp v61, v61, v61 row_ror:4 row_mask:0xf bank_mask:0xf
v_add_f32_dpp v62, v62, v62 row_ror:4 row_mask:0xf bank_mask:0xf
v_add_f32_dpp v63, v63, v63 row_ror:4 row_mask:0xf bank_mask:0xf
v_add_f32_dpp v60, v60, v60 row_ror:2 row_mask:0xf bank_mask:0xf
v_add_f32_dpp v61, v61, v61 row_ror:2 row_mask:0xf bank_mask:0xf
v_add_f32_dpp v62, v62, v62 row_ror:2 row_mask:0xf bank_mask:0xf
v_add_f32_dpp v63, v63, v63 row_ror:2 row_mask:0xf bank_mask:0xf
v_add_f32_dpp v60, v60, v60 row_ror:1 row_mask:0xf bank_mask:0xf
v_add_f32_dpp v61, v61, v61 row_ror:1 row_mask:0xf bank_mask:0xf
v_add_f32_dpp v62, v62, v62 row_ror:1 row_mask:0xf bank_mask:0xf
v_add_f32_dpp v63, v63, v63 row_ror:1 row_mask:0xf bank_mask:0xf
v_cmp_eq_u32 vcc, 10, v2
s_nop 1
v_cndmask_b32 v200, v200, v60, vcc
v_cndmask_b32 v201, v201, v61, vcc
v_cmp_eq_u32 vcc, 11, v2
s_nop 1
v_cndmask_b32 v200, v200, v62, vcc
v_cndmask_b32 v201, v201, v63, vcc
s_waitcnt vmcnt(2)
v_dot2_f32_bf16 v60, v176, v20, 0
v_dot2_f32_bf16 v61, v176, v24, 0
v_dot2_f32_bf16 v62, v180, v20, 0
v_dot2_f32_bf16 v63, v180, v24, 0
v_dot2_f32_bf16 v60, v177, v21, v60
v_dot2_f32_bf16 v61, v177, v25, v61
v_dot2_f32_bf16 v62, v181, v21, v62
v_dot2_f32_bf16 v63, v181, v25, v63
v_dot2_f32_bf16 v60, v178, v22, v60
v_dot2_f32_bf16 v61, v178, v26, v61
v_dot2_f32_bf16 v62, v182, v22, v62
v_dot2_f32_bf16 v63, v182, v26, v63
v_dot2_f32_bf16 v60, v179, v23, v60
v_dot2_f32_bf16 v61, v179, v27, v61
v_dot2_f32_bf16 v62, v183, v23, v62
v_dot2_f32_bf16 v63, v183, v27, v63
v_add_f32_dpp v60, v60, v60 row_ror:8 row_mask:0xf bank_mask:0xf
v_add_f32_dpp v61, v61, v61 row_ror:8 row_mask:0xf bank_mask:0xf
v_add_f32_dpp v62, v62, v62 row_ror:8 row_mask:0xf bank_mask:0xf
v_add_f32_dpp v63, v63, v63 row_ror:8 row_mask:0xf bank_mask:0xf
v_add_f32_dpp v60, v60, v60 row_ror:4 row_mask:0xf bank_mask:0xf
v_add_f32_dpp v61, v61, v61 row_ror:4 row_mask:0xf bank_mask:0xf
v_add_f32_dpp v62, v62, v62 row_ror:4 row_mask:0xf bank_mask:0xf
v_add_f32_dpp v63, v63, v63 row_ror:4 row_mask:0xf bank_mask:0xf
v_add_f32_dpp v60, v60, v60 row_ror:2 row_mask:0xf bank_mask:0xf
v_add_f32_dpp v61, v61, v61 row_ror:2 row_mask:0xf bank_mask:0xf
v_add_f32_dpp v62, v62, v62 row_ror:2 row_mask:0xf bank_mask:0xf
v_add_f32_dpp v63, v63, v63 row_ror:2 row_mask:0xf bank_mask:0xf
v_add_f32_dpp v60, v60, v60 row_ror:1 row_mask:0xf bank_mask:0xf
v_add_f32_dpp v61, v61, v61 row_ror:1 row_mask:0xf bank_mask:0xf
v_add_f32_dpp v62, v62, v62 row_ror:1 row_mask:0xf bank_mask:0xf
v_add_f32_dpp v63, v63, v63 row_ror:1 row_mask:0xf bank_mask:0xf
v_cmp_eq_u32 vcc, 12, v2
s_nop 1
v_cndmask_b32 v200, v200, v60, vcc
v_cndmask_b32 v201, v201, v61, vcc
v_cmp_eq_u32 vcc, 13, v2
s_nop 1
v_cndmask_b32 v200, v200, v62, vcc
v_cndmask_b32 v201, v201, v63, vcc
s_waitcnt vmcnt(0)
v_dot2_f32_bf16 v60, v184, v20, 0
v_dot2_f32_bf16 v61, v184, v24, 0
v_dot2_f32_bf16 v62, v188, v20, 0
v_dot2_f32_bf16 v63, v188, v24, 0
v_dot2_f32_bf16 v60, v185, v21, v60
v_dot2_f32_bf16 v61, v185, v25, v61
v_dot2_f32_bf16 v62, v189, v21, v62
v_dot2_f32_bf16 v63, v189, v25, v63
v_dot2_f32_bf16 v60, v186, v22, v60
v_dot2_f32_bf16 v61, v186, v26, v61
v_dot2_f32_bf16 v62, v190, v22, v62
v_dot2_f32_bf16 v63, v190, v26, v63
v_dot2_f32_bf16 v60, v187, v23, v60
v_dot2_f32_bf16 v61, v187, v27, v61
v_dot2_f32_bf16 v62, v191, v23, v62
v_dot2_f32_bf16 v63, v191, v27, v63
v_add_f32_dpp v60, v60, v60 row_ror:8 row_mask:0xf bank_mask:0xf
v_add_f32_dpp v61, v61, v61 row_ror:8 row_mask:0xf bank_mask:0xf
v_add_f32_dpp v62, v62, v62 row_ror:8 row_mask:0xf bank_mask:0xf
v_add_f32_dpp v63, v63, v63 row_ror:8 row_mask:0xf bank_mask:0xf
v_add_f32_dpp v60, v60, v60 row_ror:4 row_mask:0xf bank_mask:0xf
v_add_f32_dpp v61, v61, v61 row_ror:4 row_mask:0xf bank_mask:0xf
v_add_f32_dpp v62, v62, v62 row_ror:4 row_mask:0xf bank_mask:0xf
v_add_f32_dpp v63, v63, v63 row_ror:4 row_mask:0xf bank_mask:0xf
v_add_f32_dpp v60, v60, v60 row_ror:2 row_mask:0xf bank_mask:0xf
v_add_f32_dpp v61, v61, v61 row_ror:2 row_mask:0xf bank_mask:0xf
v_add_f32_dpp v62, v62, v62 row_ror:2 row_mask:0xf bank_mask:0xf
v_add_f32_dpp v63, v63, v63 row_ror:2 row_mask:0xf bank_mask:0xf
v_add_f32_dpp v60, v60, v60 row_ror:1 row_mask:0xf bank_mask:0xf
v_add_f32_dpp v61, v61, v61 row_ror:1 row_mask:0xf bank_mask:0xf
v_add_f32_dpp v62, v62, v62 row_ror:1 row_mask:0xf bank_mask:0xf
v_add_f32_dpp v63, v63, v63 row_ror:1 row_mask:0xf bank_mask:0xf
v_cmp_eq_u32 vcc, 14, v2
s_nop 1
v_cndmask_b32 v200, v200, v60, vcc
v_cndmask_b32 v201, v201, v61, vcc
v_cmp_eq_u32 vcc, 15, v2
s_nop 1
v_cndmask_b32 v200, v200, v62, vcc
v_cndmask_b32 v201, v201, v63, vcc
v_cvt_pk_bf16_f32 v200, v200, v200
v_cvt_pk_bf16_f32 v201, v201, v201
s_lshl_b32 s62, s32, 10
s_lshl_b32 s63, s34, 7
s_add_u32 s62, s62, s63
s_add_u32 s62, s62, 0x0
v_lshl_add_u32 v192, v1, 1, s62
buffer_store_short v200, v192, s[52:55], 0 offen sc1
s_mov_b32 s62, 32768
buffer_store_short v201, v192, s[52:55], s62 offen sc1
s_lshl_b32 s62, s32, 8
s_add_u32 s62, s62, 0x1a000
v_lshl_add_u32 v192, v1, 2, s62
v_mov_b32 v193, s88
s_waitcnt vmcnt(0)
s_barrier
s_cmp_lg_u32 s34, 0
s_cbranch_scc1 L_sig_Wq
s_mov_b32 exec_hi, 0
buffer_store_dword v193, v192, s[52:55], 0 offen sc1
s_mov_b64 exec, -1
L_sig_Wq:
s_lshl_b32 s60, s89, 8
s_sub_u32 s61, 0x400000, s60
s_add_u32 s40, s22, s60
s_addc_u32 s41, s23, 0
s_and_b32 s41, s41, 0xffff
s_mov_b32 s42, s61
s_mov_b32 s43, 0x20000
s_lshl_b32 s60, s89, 17
s_mov_b32 s61, 0x20000
s_add_u32 s44, s24, s60
s_addc_u32 s45, s25, 0
s_and_b32 s45, s45, 0xffff
s_mov_b32 s46, s61
s_mov_b32 s47, 0x20000
v_lshlrev_b32 v10, 12, v3
v_lshl_add_u32 v10, v2, 4, v10
s_lshl_b32 s62, s34, 14
v_add_u32 v10, s62, v10
s_waitcnt vmcnt(2)
s_mov_b32 s62, 0
buffer_load_dwordx4 v[64:67], v9, s[40:43], s62 offen nt
s_waitcnt vmcnt(2)
s_mov_b32 s62, 8192
buffer_load_dwordx4 v[68:71], v9, s[40:43], s62 offen nt
s_waitcnt vmcnt(2)
s_mov_b32 s62, 16384
buffer_load_dwordx4 v[72:75], v9, s[40:43], s62 offen nt
s_waitcnt vmcnt(2)
s_mov_b32 s62, 24576
buffer_load_dwordx4 v[76:79], v9, s[40:43], s62 offen nt
s_waitcnt vmcnt(2)
s_mov_b32 s62, 32768
buffer_load_dwordx4 v[80:83], v9, s[40:43], s62 offen nt
s_waitcnt vmcnt(2)
s_mov_b32 s62, 40960
buffer_load_dwordx4 v[84:87], v9, s[40:43], s62 offen nt
s_waitcnt vmcnt(2)
s_mov_b32 s62, 49152
buffer_load_dwordx4 v[88:91], v9, s[40:43], s62 offen nt
s_waitcnt vmcnt(2)
s_mov_b32 s62, 57344
buffer_load_dwordx4 v[92:95], v9, s[40:43], s62 offen nt
s_waitcnt vmcnt(2)
s_mov_b32 s62, 65536
buffer_load_dwordx4 v[96:99], v9, s[40:43], s62 offen nt
s_waitcnt vmcnt(2)
s_mov_b32 s62, 73728
buffer_load_dwordx4 v[100:103], v9, s[40:43], s62 offen nt
s_waitcnt vmcnt(2)
s_mov_b32 s62, 81920
buffer_load_dwordx4 v[104:107], v9, s[40:43], s62 offen nt
s_waitcnt vmcnt(2)
s_mov_b32 s62, 90112
buffer_load_dwordx4 v[108:111], v9, s[40:43], s62 offen nt
s_waitcnt vmcnt(2)
s_mov_b32 s62, 98304
buffer_load_dwordx4 v[112:115], v9, s[40:43], s62 offen nt
s_waitcnt vmcnt(2)
s_mov_b32 s62, 106496
buffer_load_dwordx4 v[116:119], v9, s[40:43], s62 offen nt
s_waitcnt vmcnt(2)
s_mov_b32 s62, 114688
buffer_load_dwordx4 v[120:123], v9, s[40:43], s62 offen nt
s_waitcnt vmcnt(2)
s_mov_b32 s62, 122880
buffer_load_dwordx4 v[124:127], v9, s[40:43], s62 offen nt
s_waitcnt vmcnt(2)
buffer_load_dwordx4 v[128:131], v10, s[44:47], 0 offen offset:0 nt
s_waitcnt vmcnt(2)
buffer_load_dwordx4 v[132:135], v10, s[44:47], 0 offen offset:256 nt
s_waitcnt vmcnt(2)
buffer_load_dwordx4 v[136:139], v10, s[44:47], 0 offen offset:512 nt
s_waitcnt vmcnt(2)
buffer_load_dwordx4 v[140:143], v10, s[44:47], 0 offen offset:768 nt
s_waitcnt vmcnt(2)
buffer_load_dwordx4 v[144:147], v10, s[44:47], 0 offen offset:1024 nt
s_waitcnt vmcnt(2)
buffer_load_dwordx4 v[148:151], v10, s[44:47], 0 offen offset:1280 nt
s_waitcnt vmcnt(2)
buffer_load_dwordx4 v[152:155], v10, s[44:47], 0 offen offset:1536 nt
s_waitcnt vmcnt(2)
buffer_load_dwordx4 v[156:159], v10, s[44:47], 0 offen offset:1792 nt
s_waitcnt vmcnt(2)
buffer_load_dwordx4 v[160:163], v10, s[44:47], 0 offen offset:2048 nt
s_waitcnt vmcnt(2)
buffer_load_dwordx4 v[164:167], v10, s[44:47], 0 offen offset:2304 nt
s_waitcnt vmcnt(2)
buffer_load_dwordx4 v[168:171], v10, s[44:47], 0 offen offset:2560 nt
s_waitcnt vmcnt(2)
buffer_load_dwordx4 v[172:175], v10, s[44:47], 0 offen offset:2816 nt
s_waitcnt vmcnt(2)
buffer_load_dwordx4 v[176:179], v10, s[44:47], 0 offen offset:3072 nt
s_waitcnt vmcnt(2)
buffer_load_dwordx4 v[180:183], v10, s[44:47], 0 offen offset:3328 nt
s_waitcnt vmcnt(2)
buffer_load_dwordx4 v[184:187], v10, s[44:47], 0 offen offset:3584 nt
s_waitcnt vmcnt(2)
buffer_load_dwordx4 v[188:191], v10, s[44:47], 0 offen offset:3840 nt
s_cmp_lg_u32 s34, 7
s_cbranch_scc1 L_W_nogm
s_cmp_ge_u32 s32, 8
s_cbranch_scc1 L_W_nogm
s_and_b32 s63, s32, 7
s_mul_i32 s63, s63, 0x100
s_add_u32 s63, s63, 0xc0000
s_add_u32 s56, s30, s63
s_addc_u32 s57, s31, 0
s_mov_b32 s64, 0
s_mov_b32 s59, 0
s_mov_b32 s58, 0
s_lshl_b32 s62, s32, 12
s_add_u32 s62, s62, 0xd0000
v_lshl_add_u32 v204, v1, 4, s62
v_lshrrev_b32 v205, 2, v1
s_mov_b32 s62, 0xd0000
v_lshl_add_u32 v205, v205, 12, s62
v_and_b32 v206, 3, v1
v_lshlrev_b32 v208, 2, v1
v_mov_b32 v211, 0
L_gm_W:
s_mov_b32 exec_lo, -1
s_mov_b32 exec_hi, 0
v_add_u32 v207, s58, v206
v_and_b32 v207, 15, v207
v_lshl_add_u32 v207, v207, 8, v205
global_load_dword v210, v207, s[30:31] sc1
s_mov_b64 exec, 0x1ffffff
global_load_dword v209, v208, s[56:57] nt
s_waitcnt vmcnt(0)
v_subrev_u32 v209, s88, v209
s_mov_b64 exec, 0xffffff
v_cmp_le_u32 vcc, 0x400, v209
v_readlane_b32 s62, v209, 24
v_add_u32_dpp v209, v209, v209 row_shr:1 row_mask:0xf bank_mask:0xf bound_ctrl:0
s_nop 1
v_add_u32_dpp v209, v209, v209 row_shr:2 row_mask:0xf bank_mask:0xf bound_ctrl:0
s_nop 1
v_add_u32_dpp v209, v209, v209 row_shr:4 row_mask:0xf bank_mask:0xf bound_ctrl:0
s_nop 1
v_add_u32_dpp v209, v209, v209 row_shr:8 row_mask:0xf bank_mask:0xf bound_ctrl:0
s_nop 0
v_readlane_b32 s61, v209, 15
v_readlane_b32 s63, v209, 23
s_add_u32 s61, s61, s63
s_mov_b64 exec, 0xff
s_cbranch_vccnz L_gm_W_next
s_add_u32 s63, s61, s88
v_mov_b32 v200, s63
v_mov_b32 v201, s63
v_mov_b32 v202, s63
v_mov_b32 v203, s63
s_lshr_b32 s58, s61, 9
s_and_b32 s63, s58, 15
s_lshl_b32 s63, s63, 8
v_add_u32 v207, s63, v204
s_sub_u32 s58, s58, 2
global_store_dwordx4 v207, v[200:203], s[30:31] sc1
s_mul_i32 s63, s61, 0
s_mul_i32 s65, s59, 8
s_add_u32 s65, s65, s63
s_cmp_eq_u32 s59, 0
s_mov_b32 s59, s61
s_cbranch_scc1 L_gm_W_next
s_mov_b32 exec_lo, -1
v_subrev_u32 v210, s88, v210
v_cmp_gt_u32 vcc, 0x8000, v210
s_nop 1
v_cndmask_b32 v210, 0, v210, vcc
v_max_u32 v211, v211, v210
s_nop 1
v_max_u32_dpp v211, v211, v211 quad_perm:[1,0,3,2] row_mask:0xf bank_mask:0xf
s_nop 1
v_max_u32_dpp v211, v211, v211 quad_perm:[2,3,0,1] row_mask:0xf bank_mask:0xf
v_cmp_eq_u32 vcc, 0, v211
s_nop 0
v_add_u32_dpp v210, v211, v211 row_shr:4 row_mask:0xf bank_mask:0xf bound_ctrl:0
s_nop 1
v_add_u32_dpp v210, v210, v210 row_shr:8 row_mask:0xf bank_mask:0xf bound_ctrl:0
s_cbranch_vccnz L_gm_W_next
s_nop 0
v_readlane_b32 s63, v210, 15
v_readlane_b32 s62, v210, 31
s_add_u32 s63, s63, s62
s_sub_u32 s63, s63, s65
s_ashr_i32 s63, s63, 3
s_add_u32 s63, s63, 0x4000
s_add_u32 s63, s63, s88
s_mov_b64 exec, 0x1000000
v_mov_b32 v212, s63
global_store_dword v208, v212, s[56:57]
L_gm_W_next:
ds_read_b32 v209, v8 offset:8704
s_waitcnt lgkmcnt(0)
v_readfirstlane_b32 s63, v209
s_cmp_eq_u32 s63, s88
s_cbranch_scc1 L_gm_W_x
s_add_u32 s64, s64, 1
s_cmp_lt_u32 s64, 128
s_cbranch_scc1 L_gm_W
L_gm_W_x:
s_mov_b64 exec, -1
L_W_nogm:
s_cmp_lg_u32 s34, 6
s_cbranch_scc1 L_W_noas
s_and_b32 s63, s32, 7
s_mul_i32 s63, s63, 0x100
s_add_u32 s63, s63, 0xc0000
s_add_u32 s56, s30, s63
s_addc_u32 s57, s31, 0
s_lshl_b32 s62, s89, 21
s_sub_u32 s63, 0x8000000, s62
s_add_u32 s68, s6, s62
s_addc_u32 s69, s7, 0
s_and_b32 s69, s69, 0xffff
s_mov_b32 s70, s63
s_mov_b32 s71, 0x20000
s_add_u32 s72, s8, s62
s_addc_u32 s73, s9, 0
s_and_b32 s73, s73, 0xffff
s_mov_b32 s74, s63
s_mov_b32 s75, 0x20000
s_mov_b64 s[76:77], s[68:69]
s_mov_b64 s[78:79], s[70:71]
s_lshr_b32 s62, s32, 3
s_mul_i32 s62, s62, 6
s_sub_u32 s62, s62, 32
v_add_u32 v208, s62, v1
v_cmp_gt_u32 vcc, 32, v1
v_lshlrev_b32 v205, 7, v1
v_add_u32 v206, 0x4000000, v205
v_cndmask_b32 v200, v208, v1, vcc
v_lshlrev_b32 v200, 2, v200
v_mov_b32 v204, 0
s_mov_b32 s64, 0
L_as_W:
s_mov_b64 exec, 0x1ffffff
s_mov_b32 exec_hi, 0x3f
global_load_dword v201, v200, s[56:57] nt
s_waitcnt vmcnt(0)
v_subrev_u32 v201, s88, v201
s_mov_b64 exec, 0xffffff
v_cmp_le_u32 vcc, 0x400, v201
v_readlane_b32 s62, v201, 24
v_add_u32_dpp v201, v201, v201 row_shr:1 row_mask:0xf bank_mask:0xf bound_ctrl:0
s_nop 1
v_add_u32_dpp v201, v201, v201 row_shr:2 row_mask:0xf bank_mask:0xf bound_ctrl:0
s_nop 1
v_add_u32_dpp v201, v201, v201 row_shr:4 row_mask:0xf bank_mask:0xf bound_ctrl:0
s_nop 1
v_add_u32_dpp v201, v201, v201 row_shr:8 row_mask:0xf bank_mask:0xf bound_ctrl:0
s_nop 0
v_readlane_b32 s61, v201, 15
v_readlane_b32 s63, v201, 23
s_add_u32 s61, s61, s63
s_cbranch_vccnz L_as_W_idle
s_sub_u32 s61, s61, 120
s_mov_b32 exec_lo, 0
s_mov_b32 exec_hi, 0x3f
v_cmp_gt_u32 vcc, 280, v201
v_add_u32 v202, 56, v201
s_nop 0
v_cndmask_b32 v208, 0, 8, vcc
v_add_u32 v202, v202, v208
v_lshrrev_b32 v202, 4, v202
v_sub_u32 v208, v202, v204
v_cmp_gt_i32 vcc, 4, v208
v_cmp_le_i32 s[66:67], 2, v208
s_nop 0
v_cndmask_b32 v203, 0, 7, vcc
v_cmp_ge_u32 vcc, 41, v202
v_add_u32 v203, v203, v201
v_lshl_add_u32 v203, v203, 6, v1
s_and_b64 vcc, vcc, s[66:67]
v_cndmask_b32 v203, -1, v203, vcc
s_nop 1
v_min_u32_dpp v203, v203, v203 row_shr:1 row_mask:0xf bank_mask:0xf
s_nop 1
v_min_u32_dpp v203, v203, v203 row_shr:2 row_mask:0xf bank_mask:0xf
s_nop 1
v_min_u32_dpp v203, v203, v203 row_shr:4 row_mask:0xf bank_mask:0xf
s_nop 0
v_readlane_b32 s63, v203, 37
s_lshr_b32 s65, s63, 6
s_and_b32 s63, s63, 63
s_mul_i32 s65, s65, 24
s_cmp_ge_i32 s65, s61
s_cbranch_scc1 L_as_W_idle
v_readlane_b32 s65, v202, s63
s_mov_b32 m0, s63
s_mov_b64 exec, -1
s_cmp_lt_u32 s65, 21
s_cselect_b64 s[76:77], s[68:69], s[72:73]
v_writelane_b32 v204, s65, m0
s_cselect_b32 s66, 0, 21
s_sub_u32 s65, s65, s66
s_mul_i32 s65, s65, 0x18000
s_and_b32 s63, s63, 7
s_lshl_b32 s63, s63, 14
s_add_u32 s65, s65, s63
s_add_u32 s66, s65, 0x2000
buffer_load_dword v207, v205, s[76:79], s65 offen
buffer_load_dword v207, v205, s[76:79], s66 offen
buffer_load_dword v207, v206, s[76:79], s65 offen
buffer_load_dword v207, v206, s[76:79], s66 offen
s_waitcnt vmcnt(1)
s_branch L_as_W_next
L_as_W_idle:
s_sleep 4
L_as_W_next:
s_mov_b64 exec, 1
ds_read_b32 v208, v8 offset:8704
s_waitcnt lgkmcnt(0)
v_readfirstlane_b32 s63, v208
s_cmp_eq_u32 s63, s88
s_cbranch_scc1 L_as_W_x
s_add_u32 s64, s64, 1
s_cmp_lt_u32 s64, 96
s_cbranch_scc1 L_as_W
L_as_W_x:
s_mov_b64 exec, -1
s_waitcnt vmcnt(0)
L_W_noas:
s_cmp_lg_u32 s34, 0
s_cbranch_scc1 L_wc_Wc
s_lshl_b32 s62, s32, 4
s_add_u32 s62, s62, 0x10000
v_and_b32 v193, 31, v1
v_lshl_add_u32 v192, v193, 9, s62
s_lshl_b64 exec, 1, s32
s_mov_b32 s64, 0
L_tp_Wc0:
buffer_load_dwordx4 v[196:199], v192, s[52:55], 0 offen sc1
s_waitcnt vmcnt(0)
v_cmp_ne_u32 s[62:63], s88, v197
v_cmp_ne_u32 vcc, s88, v199
s_add_u32 s64, s64, 1
s_nop 0
s_or_b64 vcc, vcc, s[62:63]
s_cbranch_scc0 L_tp_Wc0_ok
s_sleep 32
s_cmp_lt_u32 s64, 65536
s_cbranch_scc1 L_tp_Wc0
L_tp_Wc0_ok:
s_mov_b32 exec_lo, -1
s_mov_b32 exec_hi, 0
s_mov_b32 s64, 0
L_tp_Wc:
buffer_load_dwordx4 v[196:199], v192, s[52:55], 0 offen sc1
s_waitcnt vmcnt(0)
v_cmp_ne_u32 s[62:63], s88, v197
v_cmp_ne_u32 vcc, s88, v199
s_add_u32 s64, s64, 1
s_nop 0
s_or_b64 vcc, vcc, s[62:63]
s_cbranch_scc0 L_tp_Wc_ok
s_mov_b64 exec, vcc
s_sleep 8
s_cmp_lt_u32 s64, 65536
s_cbranch_scc1 L_tp_Wc
L_tp_Wc_ok:
s_mov_b32 exec_lo, -1
s_mov_b32 exec_hi, 0
v_lshlrev_b32 v193, 3, v193
v_mov_b32 v197, v198
ds_write_b64 v193, v[196:197] offset:8192
v_mov_b32 v199, s88
ds_write_b32 v8, v199 offset:8704
s_mov_b64 exec, -1
s_waitcnt lgkmcnt(0)
L_wc_Wc:
s_barrier
s_lshr_b32 s35, s34, 2
s_and_b32 s36, s34, 3
s_lshl_b32 s62, s35, 5
s_add_u32 s62, s62, s32
s_lshl_b32 s63, s62, 7
s_add_u32 s63, s63, 0x10000
v_lshl_add_u32 v192, v2, 3, s63
s_lshl_b32 s63, s35, 7
v_lshl_add_u32 v192, v2, 3, s63
ds_read_b64 v[194:195], v192 offset:8192
s_lshl_b32 s63, s62, 14
s_add_u32 s63, s63, 0x200000
s_lshl_b32 s64, s36, 12
s_add_u32 s63, s63, s64
v_lshl_add_u32 v193, v1, 4, s63
buffer_load_dwordx4 v[200:203], v193, s[52:55], 0 offen offset:0 sc1
buffer_load_dwordx4 v[204:207], v193, s[52:55], 0 offen offset:1024 sc1
buffer_load_dwordx4 v[208:211], v193, s[52:55], 0 offen offset:2048 sc1
buffer_load_dwordx4 v[212:215], v193, s[52:55], 0 offen offset:3072 sc1
s_waitcnt vmcnt(4) lgkmcnt(0)
v_mov_b32 v196, v194
s_nop 1
v_max_f32_dpp v196, v196, v196 row_ror:8 row_mask:0xf bank_mask:0xf
s_nop 1
v_max_f32_dpp v196, v196, v196 row_ror:4 row_mask:0xf bank_mask:0xf
s_nop 1
v_max_f32_dpp v196, v196, v196 row_ror:2 row_mask:0xf bank_mask:0xf
s_nop 1
v_max_f32_dpp v196, v196, v196 row_ror:1 row_mask:0xf bank_mask:0xf
v_sub_f32 v197, v194, v196
v_exp_f32 v197, v197
s_nop 0
v_mul_f32 v195, v195, v197
s_nop 1
v_add_f32_dpp v195, v195, v195 row_ror:8 row_mask:0xf bank_mask:0xf
s_nop 1
v_add_f32_dpp v195, v195, v195 row_ror:4 row_mask:0xf bank_mask:0xf
s_nop 1
v_add_f32_dpp v195, v195, v195 row_ror:2 row_mask:0xf bank_mask:0xf
s_nop 1
v_add_f32_dpp v195, v195, v195 row_ror:1 row_mask:0xf bank_mask:0xf
v_rcp_f32 v195, v195
s_nop 0
v_mul_f32 v197, v197, v195
s_lshl_b32 s64, s36, 2
s_add_u32 s65, s64, 0
v_readlane_b32 s66, v197, s65
s_add_u32 s65, s64, 1
v_readlane_b32 s67, v197, s65
s_add_u32 s65, s64, 2
v_readlane_b32 s68, v197, s65
s_add_u32 s65, s64, 3
v_readlane_b32 s69, v197, s65
s_waitcnt vmcnt(3)
v_lshlrev_b32 v216, 16, v200
v_and_b32 v217, 0xffff0000, v200
v_lshlrev_b32 v218, 16, v201
v_and_b32 v219, 0xffff0000, v201
v_lshlrev_b32 v220, 16, v202
v_and_b32 v221, 0xffff0000, v202
v_lshlrev_b32 v222, 16, v203
v_and_b32 v223, 0xffff0000, v203
v_mul_f32 v232, s66, v216
v_mul_f32 v233, s66, v217
v_mul_f32 v234, s66, v218
v_mul_f32 v235, s66, v219
v_mul_f32 v236, s66, v220
v_mul_f32 v237, s66, v221
v_mul_f32 v238, s66, v222
v_mul_f32 v239, s66, v223
s_waitcnt vmcnt(2)
v_lshlrev_b32 v216, 16, v204
v_and_b32 v217, 0xffff0000, v204
v_lshlrev_b32 v218, 16, v205
v_and_b32 v219, 0xffff0000, v205
v_lshlrev_b32 v220, 16, v206
v_and_b32 v221, 0xffff0000, v206
v_lshlrev_b32 v222, 16, v207
v_and_b32 v223, 0xffff0000, v207
v_fma_f32 v232, v216, s67, v232
v_fma_f32 v233, v217, s67, v233
v_fma_f32 v234, v218, s67, v234
v_fma_f32 v235, v219, s67, v235
v_fma_f32 v236, v220, s67, v236
v_fma_f32 v237, v221, s67, v237
v_fma_f32 v238, v222, s67, v238
v_fma_f32 v239, v223, s67, v239
s_waitcnt vmcnt(1)
v_lshlrev_b32 v216, 16, v208
v_and_b32 v217, 0xffff0000, v208
v_lshlrev_b32 v218, 16, v209
v_and_b32 v219, 0xffff0000, v209
v_lshlrev_b32 v220, 16, v210
v_and_b32 v221, 0xffff0000, v210
v_lshlrev_b32 v222, 16, v211
v_and_b32 v223, 0xffff0000, v211
v_fma_f32 v232, v216, s68, v232
v_fma_f32 v233, v217, s68, v233
v_fma_f32 v234, v218, s68, v234
v_fma_f32 v235, v219, s68, v235
v_fma_f32 v236, v220, s68, v236
v_fma_f32 v237, v221, s68, v237
v_fma_f32 v238, v222, s68, v238
v_fma_f32 v239, v223, s68, v239
s_waitcnt vmcnt(0)
v_lshlrev_b32 v216, 16, v212
v_and_b32 v217, 0xffff0000, v212
v_lshlrev_b32 v218, 16, v213
v_and_b32 v219, 0xffff0000, v213
v_lshlrev_b32 v220, 16, v214
v_and_b32 v221, 0xffff0000, v214
v_lshlrev_b32 v222, 16, v215
v_and_b32 v223, 0xffff0000, v215
v_fma_f32 v232, v216, s69, v232
v_fma_f32 v233, v217, s69, v233
v_fma_f32 v234, v218, s69, v234
v_fma_f32 v235, v219, s69, v235
v_fma_f32 v236, v220, s69, v236
v_fma_f32 v237, v221, s69, v237
v_fma_f32 v238, v222, s69, v238
v_fma_f32 v239, v223, s69, v239
s_lshl_b32 s62, s34, 11
v_lshl_add_u32 v192, v1, 5, s62
ds_write_b128 v192, v[232:235] offset:18432
ds_write_b128 v192, v[236:239] offset:18448
s_waitcnt lgkmcnt(0)
s_barrier
v_lshrrev_b32 v192, 3, v2
v_lshlrev_b32 v192, 13, v192
v_lshl_add_u32 v192, v3, 6, v192
s_lshl_b32 s62, s34, 8
v_add_u32 v192, s62, v192
ds_read_b128 v[200:203], v192 offset:18432
ds_read_b128 v[204:207], v192 offset:18448
ds_read_b128 v[208:211], v192 offset:18464
ds_read_b128 v[212:215], v192 offset:18480
ds_read_b128 v[216:219], v192 offset:20480
ds_read_b128 v[220:223], v192 offset:20496
ds_read_b128 v[224:227], v192 offset:20512
ds_read_b128 v[228:231], v192 offset:20528
s_waitcnt lgkmcnt(0)
v_add_f32 v200, v200, v216
v_add_f32 v201, v201, v217
v_add_f32 v202, v202, v218
v_add_f32 v203, v203, v219
v_add_f32 v204, v204, v220
v_add_f32 v205, v205, v221
v_add_f32 v206, v206, v222
v_add_f32 v207, v207, v223
v_add_f32 v208, v208, v224
v_add_f32 v209, v209, v225
v_add_f32 v210, v210, v226
v_add_f32 v211, v211, v227
v_add_f32 v212, v212, v228
v_add_f32 v213, v213, v229
v_add_f32 v214, v214, v230
v_add_f32 v215, v215, v231
ds_read_b128 v[216:219], v192 offset:22528
ds_read_b128 v[220:223], v192 offset:22544
ds_read_b128 v[224:227], v192 offset:22560
ds_read_b128 v[228:231], v192 offset:22576
s_waitcnt lgkmcnt(0)
v_add_f32 v200, v200, v216
v_add_f32 v201, v201, v217
v_add_f32 v202, v202, v218
v_add_f32 v203, v203, v219
v_add_f32 v204, v204, v220
v_add_f32 v205, v205, v221
v_add_f32 v206, v206, v222
v_add_f32 v207, v207, v223
v_add_f32 v208, v208, v224
v_add_f32 v209, v209, v225
v_add_f32 v210, v210, v226
v_add_f32 v211, v211, v227
v_add_f32 v212, v212, v228
v_add_f32 v213, v213, v229
v_add_f32 v214, v214, v230
v_add_f32 v215, v215, v231
ds_read_b128 v[216:219], v192 offset:24576
ds_read_b128 v[220:223], v192 offset:24592
ds_read_b128 v[224:227], v192 offset:24608
ds_read_b128 v[228:231], v192 offset:24624
s_waitcnt lgkmcnt(0)
v_add_f32 v200, v200, v216
v_add_f32 v201, v201, v217
v_add_f32 v202, v202, v218
v_add_f32 v203, v203, v219
v_add_f32 v204, v204, v220
v_add_f32 v205, v205, v221
v_add_f32 v206, v206, v222
v_add_f32 v207, v207, v223
v_add_f32 v208, v208, v224
v_add_f32 v209, v209, v225
v_add_f32 v210, v210, v226
v_add_f32 v211, v211, v227
v_add_f32 v212, v212, v228
v_add_f32 v213, v213, v229
v_add_f32 v214, v214, v230
v_add_f32 v215, v215, v231
v_cvt_pk_bf16_f32 v12, v200, v201
v_cvt_pk_bf16_f32 v13, v202, v203
v_cvt_pk_bf16_f32 v14, v204, v205
v_cvt_pk_bf16_f32 v15, v206, v207
v_cvt_pk_bf16_f32 v16, v208, v209
v_cvt_pk_bf16_f32 v17, v210, v211
v_cvt_pk_bf16_f32 v18, v212, v213
v_cvt_pk_bf16_f32 v19, v214, v215
s_mov_b32 s60, 0x01000100
v_perm_b32 v192, v12, v12, s60
v_and_b32 v28, v192, v4
v_and_b32 v29, v192, v5
v_and_b32 v30, v192, v6
v_and_b32 v31, v192, v7
s_waitcnt vmcnt(63)
s_nop 0
v_mfma_f32_16x16x32_bf16 v[44:47], v[28:31], v[64:67], 0
s_mov_b32 s60, 0x03020302
v_perm_b32 v193, v12, v12, s60
v_and_b32 v32, v193, v4
v_and_b32 v33, v193, v5
v_and_b32 v34, v193, v6
v_and_b32 v35, v193, v7
s_waitcnt vmcnt(63)
s_nop 0
v_mfma_f32_16x16x32_bf16 v[44:47], v[32:35], v[68:71], v[44:47]
s_mov_b32 s60, 0x01000100
v_perm_b32 v192, v13, v13, s60
v_and_b32 v28, v192, v4
v_and_b32 v29, v192, v5
v_and_b32 v30, v192, v6
v_and_b32 v31, v192, v7
s_waitcnt vmcnt(63)
s_nop 0
v_mfma_f32_16x16x32_bf16 v[44:47], v[28:31], v[72:75], v[44:47]
s_mov_b32 s60, 0x03020302
v_perm_b32 v193, v13, v13, s60
v_and_b32 v32, v193, v4
v_and_b32 v33, v193, v5
v_and_b32 v34, v193, v6
v_and_b32 v35, v193, v7
s_waitcnt vmcnt(63)
s_nop 0
v_mfma_f32_16x16x32_bf16 v[44:47], v[32:35], v[76:79], v[44:47]
s_mov_b32 s60, 0x01000100
v_perm_b32 v192, v14, v14, s60
v_and_b32 v28, v192, v4
v_and_b32 v29, v192, v5
v_and_b32 v30, v192, v6
v_and_b32 v31, v192, v7
s_waitcnt vmcnt(63)
s_nop 0
v_mfma_f32_16x16x32_bf16 v[44:47], v[28:31], v[80:83], v[44:47]
s_mov_b32 s60, 0x03020302
v_perm_b32 v193, v14, v14, s60
v_and_b32 v32, v193, v4
v_and_b32 v33, v193, v5
v_and_b32 v34, v193, v6
v_and_b32 v35, v193, v7
s_waitcnt vmcnt(63)
s_nop 0
v_mfma_f32_16x16x32_bf16 v[44:47], v[32:35], v[84:87], v[44:47]
s_mov_b32 s60, 0x01000100
v_perm_b32 v192, v15, v15, s60
v_and_b32 v28, v192, v4
v_and_b32 v29, v192, v5
v_and_b32 v30, v192, v6
v_and_b32 v31, v192, v7
s_waitcnt vmcnt(63)
s_nop 0
v_mfma_f32_16x16x32_bf16 v[44:47], v[28:31], v[88:91], v[44:47]
s_mov_b32 s60, 0x03020302
v_perm_b32 v193, v15, v15, s60
v_and_b32 v32, v193, v4
v_and_b32 v33, v193, v5
v_and_b32 v34, v193, v6
v_and_b32 v35, v193, v7
s_waitcnt vmcnt(63)
s_nop 0
v_mfma_f32_16x16x32_bf16 v[44:47], v[32:35], v[92:95], v[44:47]
s_mov_b32 s60, 0x01000100
v_perm_b32 v192, v16, v16, s60
v_and_b32 v28, v192, v4
v_and_b32 v29, v192, v5
v_and_b32 v30, v192, v6
v_and_b32 v31, v192, v7
s_waitcnt vmcnt(63)
s_nop 0
v_mfma_f32_16x16x32_bf16 v[44:47], v[28:31], v[96:99], v[44:47]
s_mov_b32 s60, 0x03020302
v_perm_b32 v193, v16, v16, s60
v_and_b32 v32, v193, v4
v_and_b32 v33, v193, v5
v_and_b32 v34, v193, v6
v_and_b32 v35, v193, v7
s_waitcnt vmcnt(63)
s_nop 0
v_mfma_f32_16x16x32_bf16 v[44:47], v[32:35], v[100:103], v[44:47]
s_mov_b32 s60, 0x01000100
v_perm_b32 v192, v17, v17, s60
v_and_b32 v28, v192, v4
v_and_b32 v29, v192, v5
v_and_b32 v30, v192, v6
v_and_b32 v31, v192, v7
s_waitcnt vmcnt(63)
s_nop 0
v_mfma_f32_16x16x32_bf16 v[44:47], v[28:31], v[104:107], v[44:47]
s_mov_b32 s60, 0x03020302
v_perm_b32 v193, v17, v17, s60
v_and_b32 v32, v193, v4
v_and_b32 v33, v193, v5
v_and_b32 v34, v193, v6
v_and_b32 v35, v193, v7
s_waitcnt vmcnt(63)
s_nop 0
v_mfma_f32_16x16x32_bf16 v[44:47], v[32:35], v[108:111], v[44:47]
s_mov_b32 s60, 0x01000100
v_perm_b32 v192, v18, v18, s60
v_and_b32 v28, v192, v4
v_and_b32 v29, v192, v5
v_and_b32 v30, v192, v6
v_and_b32 v31, v192, v7
s_waitcnt vmcnt(63)
s_nop 0
v_mfma_f32_16x16x32_bf16 v[44:47], v[28:31], v[112:115], v[44:47]
s_mov_b32 s60, 0x03020302
v_perm_b32 v193, v18, v18, s60
v_and_b32 v32, v193, v4
v_and_b32 v33, v193, v5
v_and_b32 v34, v193, v6
v_and_b32 v35, v193, v7
s_waitcnt vmcnt(63)
s_nop 0
v_mfma_f32_16x16x32_bf16 v[44:47], v[32:35], v[116:119], v[44:47]
s_mov_b32 s60, 0x01000100
v_perm_b32 v192, v19, v19, s60
v_and_b32 v28, v192, v4
v_and_b32 v29, v192, v5
v_and_b32 v30, v192, v6
v_and_b32 v31, v192, v7
s_waitcnt vmcnt(63)
s_nop 0
v_mfma_f32_16x16x32_bf16 v[44:47], v[28:31], v[120:123], v[44:47]
s_mov_b32 s60, 0x03020302
v_perm_b32 v193, v19, v19, s60
v_and_b32 v32, v193, v4
v_and_b32 v33, v193, v5
v_and_b32 v34, v193, v6
v_and_b32 v35, v193, v7
s_waitcnt vmcnt(63)
s_nop 0
v_mfma_f32_16x16x32_bf16 v[44:47], v[32:35], v[124:127], v[44:47]
v_lshrrev_b32 v192, 1, v3
v_lshlrev_b32 v192, 9, v192
v_lshl_add_u32 v192, v2, 5, v192
v_and_b32 v193, 1, v3
v_lshl_add_u32 v192, v193, 4, v192
s_lshl_b32 s63, s34, 10
v_add_u32 v192, s63, v192
s_nop 1
s_nop 5
ds_write_b128 v192, v[44:47] offset:9216
s_waitcnt lgkmcnt(0)
s_barrier
v_lshrrev_b32 v192, 3, v2
v_lshlrev_b32 v192, 9, v192
v_lshl_add_u32 v192, v3, 4, v192
s_lshl_b32 s62, s34, 6
v_add_u32 v192, s62, v192
ds_read_b128 v[200:203], v192 offset:9216
ds_read_b128 v[204:207], v192 offset:10240
ds_read_b128 v[208:211], v192 offset:11264
ds_read_b128 v[212:215], v192 offset:12288
ds_read_b128 v[216:219], v192 offset:13312
ds_read_b128 v[220:223], v192 offset:14336
ds_read_b128 v[224:227], v192 offset:15360
ds_read_b128 v[228:231], v192 offset:16384
s_waitcnt lgkmcnt(6)
v_add_f32 v200, v200, v204
v_add_f32 v201, v201, v205
v_add_f32 v202, v202, v206
v_add_f32 v203, v203, v207
s_waitcnt lgkmcnt(5)
v_add_f32 v200, v200, v208
v_add_f32 v201, v201, v209
v_add_f32 v202, v202, v210
v_add_f32 v203, v203, v211
s_waitcnt lgkmcnt(4)
v_add_f32 v200, v200, v212
v_add_f32 v201, v201, v213
v_add_f32 v202, v202, v214
v_add_f32 v203, v203, v215
s_waitcnt lgkmcnt(3)
v_add_f32 v200, v200, v216
v_add_f32 v201, v201, v217
v_add_f32 v202, v202, v218
v_add_f32 v203, v203, v219
s_waitcnt lgkmcnt(2)
v_add_f32 v200, v200, v220
v_add_f32 v201, v201, v221
v_add_f32 v202, v202, v222
v_add_f32 v203, v203, v223
s_waitcnt lgkmcnt(1)
v_add_f32 v200, v200, v224
v_add_f32 v201, v201, v225
v_add_f32 v202, v202, v226
v_add_f32 v203, v203, v227
s_waitcnt lgkmcnt(0)
v_add_f32 v200, v200, v228
v_add_f32 v201, v201, v229
v_add_f32 v202, v202, v230
v_add_f32 v203, v203, v231
v_cvt_pk_bf16_f32 v60, v200, v200
v_cvt_pk_bf16_f32 v61, v201, v201
v_cvt_pk_bf16_f32 v62, v202, v202
v_cvt_pk_bf16_f32 v63, v203, v203
v_and_b32 v28, v60, v4
v_and_b32 v29, v60, v5
v_and_b32 v30, v60, v6
v_and_b32 v31, v60, v7
v_and_b32 v32, v61, v4
v_and_b32 v33, v61, v5
v_and_b32 v34, v61, v6
v_and_b32 v35, v61, v7
v_and_b32 v36, v62, v4
v_and_b32 v37, v62, v5
v_and_b32 v38, v62, v6
v_and_b32 v39, v62, v7
v_and_b32 v40, v63, v4
v_and_b32 v41, v63, v5
v_and_b32 v42, v63, v6
v_and_b32 v43, v63, v7
s_nop 1
v_mfma_f32_16x16x32_bf16 v[44:47], v[28:31], v[128:131], 0
v_mfma_f32_16x16x32_bf16 v[48:51], v[28:31], v[132:135], 0
v_mfma_f32_16x16x32_bf16 v[52:55], v[28:31], v[136:139], 0
v_mfma_f32_16x16x32_bf16 v[56:59], v[28:31], v[140:143], 0
v_mfma_f32_16x16x32_bf16 v[44:47], v[32:35], v[144:147], v[44:47]
v_mfma_f32_16x16x32_bf16 v[48:51], v[32:35], v[148:151], v[48:51]
v_mfma_f32_16x16x32_bf16 v[52:55], v[32:35], v[152:155], v[52:55]
v_mfma_f32_16x16x32_bf16 v[56:59], v[32:35], v[156:159], v[56:59]
v_mfma_f32_16x16x32_bf16 v[44:47], v[36:39], v[160:163], v[44:47]
v_mfma_f32_16x16x32_bf16 v[48:51], v[36:39], v[164:167], v[48:51]
v_mfma_f32_16x16x32_bf16 v[52:55], v[36:39], v[168:171], v[52:55]
v_mfma_f32_16x16x32_bf16 v[56:59], v[36:39], v[172:175], v[56:59]
v_mfma_f32_16x16x32_bf16 v[44:47], v[40:43], v[176:179], v[44:47]
v_mfma_f32_16x16x32_bf16 v[48:51], v[40:43], v[180:183], v[48:51]
v_mfma_f32_16x16x32_bf16 v[52:55], v[40:43], v[184:187], v[52:55]
v_mfma_f32_16x16x32_bf16 v[56:59], v[40:43], v[188:191], v[56:59]
v_lshrrev_b32 v192, 1, v3
v_lshlrev_b32 v192, 11, v192
v_lshl_add_u32 v192, v2, 5, v192
v_and_b32 v193, 1, v3
v_lshl_add_u32 v192, v193, 4, v192
s_lshl_b32 s63, s34, 12
v_add_u32 v192, s63, v192
s_nop 1
ds_write_b128 v192, v[44:47] offset:18432
ds_write_b128 v192, v[48:51] offset:18944
ds_write_b128 v192, v[52:55] offset:19456
s_nop 5
ds_write_b128 v192, v[56:59] offset:19968
s_waitcnt lgkmcnt(0)
s_barrier
s_cmp_ge_u32 s34, 4
s_cbranch_scc1 L_W_yskip
v_lshlrev_b32 v192, 4, v0
ds_read_b128 v[200:203], v192 offset:18432
ds_read_b128 v[204:207], v192 offset:22528
ds_read_b128 v[208:211], v192 offset:26624
ds_read_b128 v[212:215], v192 offset:30720
ds_read_b128 v[216:219], v192 offset:34816
ds_read_b128 v[220:223], v192 offset:38912
ds_read_b128 v[224:227], v192 offset:43008
ds_read_b128 v[228:231], v192 offset:47104
v_lshrrev_b32 v193, 7, v0
v_lshlrev_b32 v193, 16, v193
v_and_b32 v194, 127, v0
v_lshl_add_u32 v193, v194, 4, v193
s_lshl_b32 s63, s32, 11
s_add_u32 s63, s63, 0x20000
v_add_u32 v193, s63, v193
s_waitcnt lgkmcnt(6)
v_add_f32 v200, v200, v204
v_add_f32 v201, v201, v205
v_add_f32 v202, v202, v206
v_add_f32 v203, v203, v207
s_waitcnt lgkmcnt(5)
v_add_f32 v200, v200, v208
v_add_f32 v201, v201, v209
v_add_f32 v202, v202, v210
v_add_f32 v203, v203, v211
s_waitcnt lgkmcnt(4)
v_add_f32 v200, v200, v212
v_add_f32 v201, v201, v213
v_add_f32 v202, v202, v214
v_add_f32 v203, v203, v215
s_waitcnt lgkmcnt(3)
v_add_f32 v200, v200, v216
v_add_f32 v201, v201, v217
v_add_f32 v202, v202, v218
v_add_f32 v203, v203, v219
s_waitcnt lgkmcnt(2)
v_add_f32 v200, v200, v220
v_add_f32 v201, v201, v221
v_add_f32 v202, v202, v222
v_add_f32 v203, v203, v223
s_waitcnt lgkmcnt(1)
v_add_f32 v200, v200, v224
v_add_f32 v201, v201, v225
v_add_f32 v202, v202, v226
v_add_f32 v203, v203, v227
s_waitcnt lgkmcnt(0)
v_add_f32 v200, v200, v228
v_add_f32 v201, v201, v229
v_add_f32 v202, v202, v230
v_add_f32 v203, v203, v231
v_cvt_pk_bf16_f32 v200, v200, v201
v_cvt_pk_bf16_f32 v202, v202, v203
v_mov_b32 v201, s88
v_mov_b32 v203, s88
buffer_store_dwordx4 v[200:203], v193, s[52:55], 0 offen sc1
L_W_yskip:
s_lshr_b32 s35, s32, 4
s_and_b32 s36, s32, 15
v_mov_b32 v232, 0
v_mov_b32 v233, 0
v_mov_b32 v234, 0
v_mov_b32 v235, 0
s_cmp_ge_u32 s34, 4
s_cbranch_scc1 L_W_bskip
v_lshrrev_b32 v192, 3, v0
v_lshlrev_b32 v192, 11, v192
v_and_b32 v193, 7, v0
v_lshl_add_u32 v192, v193, 4, v192
s_lshl_b32 s62, s35, 16
s_lshl_b32 s63, s36, 7
s_add_u32 s62, s62, s63
s_add_u32 s62, s62, 0x20000
v_add_u32 v192, s62, v192
s_mov_b32 s64, 0
L_tp_Wyb:
buffer_load_dwordx4 v[232:235], v192, s[52:55], 0 offen sc1
s_waitcnt vmcnt(0)
v_cmp_ne_u32 s[62:63], s88, v233
v_cmp_ne_u32 vcc, s88, v235
s_add_u32 s64, s64, 1
s_nop 0
s_or_b64 vcc, vcc, s[62:63]
s_cbranch_scc0 L_tp_Wyb_ok
s_mov_b64 exec, vcc
s_sleep 8
s_cmp_lt_u32 s64, 65536
s_cbranch_scc1 L_tp_Wyb
L_tp_Wyb_ok:
s_mov_b64 exec, -1
v_and_b32 v233, 0xffff0000, v232
v_lshlrev_b32 v232, 16, v232
v_and_b32 v235, 0xffff0000, v234
v_lshlrev_b32 v234, 16, v234
L_W_bskip:
v_and_b32 v192, 7, v1
v_lshl_add_u32 v240, v3, 3, v192
v_mul_u32_u24 v240, 48, v240
ds_write_b32 v240, v8 offset:32
s_lshr_b32 s62, s32, 4
s_lshl_b32 s62, s62, 11
s_bfe_u32 s63, s32, 0x20002
s_lshl_b32 s63, s63, 8
s_add_u32 s62, s62, s63
s_and_b32 s63, s32, 1
s_lshl_b32 s63, s63, 7
s_add_u32 s62, s62, s63
s_and_b32 s63, s32, 2
s_lshl_b32 s63, s63, 2
s_add_u32 s62, s62, s63
v_lshl_add_u32 v243, v192, 3, v3
v_lshl_add_u32 v243, v243, 1, s62
s_lshl_b32 s63, s34, 2
v_add_u32 v241, s63, v240
v_mov_b32 v242, 1
s_nop 1
v_add_f32_dpp v232, v232, v232 row_ror:8 row_mask:0xf bank_mask:0xf
v_add_f32_dpp v233, v233, v233 row_ror:8 row_mask:0xf bank_mask:0xf
v_add_f32_dpp v234, v234, v234 row_ror:8 row_mask:0xf bank_mask:0xf
v_add_f32_dpp v235, v235, v235 row_ror:8 row_mask:0xf bank_mask:0xf
v_mov_b32 v192, v232
v_mov_b32 v193, v233
v_mov_b32 v194, v234
v_mov_b32 v195, v235
s_nop 1
v_permlane16_swap_b32 v232, v192
v_permlane16_swap_b32 v233, v193
v_permlane16_swap_b32 v234, v194
v_permlane16_swap_b32 v235, v195
s_nop 0
v_add_f32 v232, v232, v192
v_add_f32 v233, v233, v193
v_add_f32 v234, v234, v194
v_add_f32 v235, v235, v195
v_mov_b32 v192, v232
v_mov_b32 v193, v233
v_mov_b32 v194, v234
v_mov_b32 v195, v235
s_nop 1
v_permlane32_swap_b32 v232, v192
v_permlane32_swap_b32 v233, v193
v_permlane32_swap_b32 v234, v194
v_permlane32_swap_b32 v235, v195
s_nop 0
v_add_f32 v232, v232, v192
v_add_f32 v233, v233, v193
v_add_f32 v234, v234, v194
v_add_f32 v235, v235, v195
v_lshlrev_b32 v192, 4, v1
s_lshl_b32 s63, s34, 7
v_add_u32 v192, s63, v192
s_mov_b64 exec, 0xff
ds_write_b128 v192, v[232:235] offset:17408
s_mov_b64 exec, -1
s_waitcnt lgkmcnt(0)
s_barrier
s_cmp_lg_u32 s34, 0
s_cbranch_scc1 L_Wb_fin
v_lshlrev_b32 v192, 2, v1
s_mov_b32 exec_hi, 0
ds_read_b32 v193, v192 offset:17408
ds_read_b32 v194, v192 offset:17536
ds_read_b32 v195, v192 offset:17664
ds_read_b32 v196, v192 offset:17792
s_waitcnt lgkmcnt(0)
v_add_f32 v193, v193, v194
v_add_f32 v193, v193, v195
v_add_f32 v193, v193, v196
v_cvt_pk_bf16_f32 v193, v193, v193
s_lshr_b32 s62, s32, 4
s_lshl_b32 s62, s62, 11
s_and_b32 s63, s32, 15
s_lshl_b32 s63, s63, 6
s_add_u32 s62, s62, s63
s_add_u32 s62, s62, 1024
v_lshl_add_u32 v192, v1, 1, s62
global_store_short v192, v193, s[26:27]
s_mov_b64 exec, -1
L_Wb_fin:
v_lshrrev_b32 v192, 3, v1
s_lshl_b32 s62, s35, 8
s_lshl_b32 s63, s34, 3
s_add_u32 s62, s62, s63
v_add_u32 v192, s62, v192
v_lshlrev_b32 v9, 4, v192
v_add_u32 v9, 0x14000, v9
v_and_b32 v9, 255, v192
s_lshl_b32 s63, s35, 4
s_add_u32 s63, s63, 0x50000
v_lshl_add_u32 v9, v9, 7, s63
v_lshlrev_b32 v10, 10, v192
v_and_b32 v193, 7, v1
v_lshl_add_u32 v10, v193, 3, v10
s_lshl_b32 s63, s36, 6
s_add_u32 s63, s63, 0x100000
v_add_u32 v10, s63, v10
v_mov_b32 v80, 0xff800000
v_mov_b32 v81, 0
v_mov_b32 v64, 0
v_mov_b32 v65, 0
v_mov_b32 v82, 0xff800000
v_mov_b32 v83, 0
v_mov_b32 v66, 0
v_mov_b32 v67, 0
v_mov_b32 v84, 0xff800000
v_mov_b32 v85, 0
v_mov_b32 v68, 0
v_mov_b32 v69, 0
v_mov_b32 v86, 0xff800000
v_mov_b32 v87, 0
v_mov_b32 v70, 0
v_mov_b32 v71, 0
s_mov_b32 s66, -1
s_mov_b32 s67, 0xffff
s_mov_b32 s68, -1
s_mov_b32 s69, 0xffff
s_mov_b32 s70, -1
s_mov_b32 s71, 0xffff
s_mov_b32 s72, -1
s_mov_b32 s73, 0xffff
s_mov_b32 s64, 0
s_mov_b64 exec, s[66:67]
L_W_stt:
s_mov_b32 s63, 0
buffer_load_dwordx4 v[96:99], v9, s[52:55], s63 offen sc1
s_mov_b32 s63, 8192
buffer_load_dwordx4 v[100:103], v9, s[52:55], s63 offen sc1
s_mov_b32 s63, 16384
buffer_load_dwordx4 v[104:107], v9, s[52:55], s63 offen sc1
s_mov_b32 s63, 24576
buffer_load_dwordx4 v[108:111], v9, s[52:55], s63 offen sc1
s_waitcnt vmcnt(0)
v_xor_b32 v97, s88, v97
v_xor_b32 v99, s88, v99
v_xor_b32 v101, s88, v101
v_xor_b32 v103, s88, v103
v_xor_b32 v105, s88, v105
v_xor_b32 v107, s88, v107
v_xor_b32 v109, s88, v109
v_xor_b32 v111, s88, v111
v_or3_b32 v192, v97, v99, v101
v_or3_b32 v192, v192, v103, v105
v_or3_b32 v192, v192, v107, v109
v_or_b32 v192, v192, v111
v_cmp_ne_u32 vcc, 0, v192
s_add_u32 s64, s64, 1
s_nop 0
s_cmp_eq_u64 vcc, 0
s_cbranch_scc1 L_W_stt_done
s_sleep 16
s_cmp_lt_u32 s64, 65536
s_cbranch_scc1 L_W_stt
L_W_stt_done:
v_mov_b32 v80, v96
v_mov_b32 v81, v98
v_mov_b32 v82, v100
v_mov_b32 v83, v102
v_mov_b32 v84, v104
v_mov_b32 v85, v106
v_mov_b32 v86, v108
v_mov_b32 v87, v110
s_mov_b64 exec, -1
v_mov_b32 v192, v80
v_mov_b32 v193, v82
v_mov_b32 v194, v84
v_mov_b32 v195, v86
s_nop 1
v_max_f32_dpp v192, v192, v192 row_ror:8 row_mask:0xf bank_mask:0xf
v_max_f32_dpp v193, v193, v193 row_ror:8 row_mask:0xf bank_mask:0xf
v_max_f32_dpp v194, v194, v194 row_ror:8 row_mask:0xf bank_mask:0xf
v_max_f32_dpp v195, v195, v195 row_ror:8 row_mask:0xf bank_mask:0xf
v_mov_b32 v196, v192
v_mov_b32 v197, v193
v_mov_b32 v198, v194
v_mov_b32 v199, v195
s_nop 1
v_permlane16_swap_b32 v192, v196
v_permlane16_swap_b32 v193, v197
v_permlane16_swap_b32 v194, v198
v_permlane16_swap_b32 v195, v199
s_nop 0
v_max_f32 v192, v192, v196
v_max_f32 v193, v193, v197
v_max_f32 v194, v194, v198
v_max_f32 v195, v195, v199
v_mov_b32 v196, v192
v_mov_b32 v197, v193
v_mov_b32 v198, v194
v_mov_b32 v199, v195
s_nop 1
v_permlane32_swap_b32 v192, v196
v_permlane32_swap_b32 v193, v197
v_permlane32_swap_b32 v194, v198
v_permlane32_swap_b32 v195, v199
s_nop 0
v_max_f32 v192, v192, v196
v_max_f32 v193, v193, v197
v_max_f32 v194, v194, v198
v_max_f32 v195, v195, v199
v_sub_f32 v192, v80, v192
v_sub_f32 v193, v82, v193
v_sub_f32 v194, v84, v194
v_sub_f32 v195, v86, v195
v_exp_f32 v192, v192
v_exp_f32 v193, v193
v_exp_f32 v194, v194
v_exp_f32 v195, v195
s_nop 0
v_mul_f32 v200, v81, v192
v_mul_f32 v201, v83, v193
v_mul_f32 v202, v85, v194
v_mul_f32 v203, v87, v195
s_nop 1
v_add_f32_dpp v200, v200, v200 row_ror:8 row_mask:0xf bank_mask:0xf
v_add_f32_dpp v201, v201, v201 row_ror:8 row_mask:0xf bank_mask:0xf
v_add_f32_dpp v202, v202, v202 row_ror:8 row_mask:0xf bank_mask:0xf
v_add_f32_dpp v203, v203, v203 row_ror:8 row_mask:0xf bank_mask:0xf
v_mov_b32 v196, v200
v_mov_b32 v197, v201
v_mov_b32 v198, v202
v_mov_b32 v199, v203
s_nop 1
v_permlane16_swap_b32 v200, v196
v_permlane16_swap_b32 v201, v197
v_permlane16_swap_b32 v202, v198
v_permlane16_swap_b32 v203, v199
s_nop 0
v_add_f32 v200, v200, v196
v_add_f32 v201, v201, v197
v_add_f32 v202, v202, v198
v_add_f32 v203, v203, v199
v_mov_b32 v196, v200
v_mov_b32 v197, v201
v_mov_b32 v198, v202
v_mov_b32 v199, v203
s_nop 1
v_permlane32_swap_b32 v200, v196
v_permlane32_swap_b32 v201, v197
v_permlane32_swap_b32 v202, v198
v_permlane32_swap_b32 v203, v199
s_nop 0
v_add_f32 v200, v200, v196
v_add_f32 v201, v201, v197
v_add_f32 v202, v202, v198
v_add_f32 v203, v203, v199
v_rcp_f32 v200, v200
v_rcp_f32 v201, v201
v_rcp_f32 v202, v202
v_rcp_f32 v203, v203
s_nop 0
v_mul_f32 v80, v192, v200
v_mul_f32 v81, v193, v201
v_mul_f32 v82, v194, v202
v_mul_f32 v83, v195, v203
v_mov_b32 v232, 0
v_mov_b32 v233, 0
v_mov_b32 v234, 0
v_mov_b32 v235, 0
s_mov_b32 s64, 0
s_mov_b32 s74, 0x1010101
s_mov_b32 s75, 0x101
L_W_gate:
s_mov_b64 exec, s[74:75]
buffer_load_dword v192, v10, s[52:55], 0 offen sc1
s_waitcnt vmcnt(0)
v_cmp_ne_u32 vcc, -1, v192
s_mov_b64 exec, -1
s_add_u32 s64, s64, 1
s_cmp_lg_u64 vcc, 0
s_cbranch_scc1 L_W_gate_done
s_sleep 4
s_cmp_lt_u32 s64, 65536
s_cbranch_scc1 L_W_gate
L_W_gate_done:
s_mov_b32 s64, 0
s_mov_b32 s77, 65536
s_mov_b32 s78, 131072
s_mov_b32 s79, 196608
L_W_sweep:
s_mov_b64 exec, s[66:67]
s_cbranch_execz L_W_sw0
buffer_load_dwordx2 v[64:65], v10, s[52:55], 0 offen sc1
L_W_sw0:
s_mov_b64 exec, s[68:69]
s_cbranch_execz L_W_sw1
buffer_load_dwordx2 v[66:67], v10, s[52:55], s77 offen sc1
L_W_sw1:
s_mov_b64 exec, s[70:71]
s_cbranch_execz L_W_sw2
buffer_load_dwordx2 v[68:69], v10, s[52:55], s78 offen sc1
L_W_sw2:
s_mov_b64 exec, s[72:73]
s_cbranch_execz L_W_sw3
buffer_load_dwordx2 v[70:71], v10, s[52:55], s79 offen sc1
L_W_sw3:
s_waitcnt vmcnt(0)
s_mov_b64 exec, s[66:67]
s_cbranch_execz L_W_sx0
v_max_u32 v192, v64, v65
v_cmp_ne_u32 vcc, -1, v192
v_lshlrev_b32 v88, 16, v64
v_and_b32 v89, 0xffff0000, v64
v_lshlrev_b32 v90, 16, v65
v_and_b32 v91, 0xffff0000, v65
s_andn2_b64 s[66:67], exec, vcc
s_mov_b64 exec, vcc
v_fma_f32 v232, v80, v88, v232
v_fma_f32 v233, v80, v89, v233
v_fma_f32 v234, v80, v90, v234
v_fma_f32 v235, v80, v91, v235
L_W_sx0:
s_mov_b64 exec, s[68:69]
s_cbranch_execz L_W_sx1
v_max_u32 v192, v66, v67
v_cmp_ne_u32 vcc, -1, v192
v_lshlrev_b32 v88, 16, v66
v_and_b32 v89, 0xffff0000, v66
v_lshlrev_b32 v90, 16, v67
v_and_b32 v91, 0xffff0000, v67
s_andn2_b64 s[68:69], exec, vcc
s_mov_b64 exec, vcc
v_fma_f32 v232, v81, v88, v232
v_fma_f32 v233, v81, v89, v233
v_fma_f32 v234, v81, v90, v234
v_fma_f32 v235, v81, v91, v235
L_W_sx1:
s_mov_b64 exec, s[70:71]
s_cbranch_execz L_W_sx2
v_max_u32 v192, v68, v69
v_cmp_ne_u32 vcc, -1, v192
v_lshlrev_b32 v88, 16, v68
v_and_b32 v89, 0xffff0000, v68
v_lshlrev_b32 v90, 16, v69
v_and_b32 v91, 0xffff0000, v69
s_andn2_b64 s[70:71], exec, vcc
s_mov_b64 exec, vcc
v_fma_f32 v232, v82, v88, v232
v_fma_f32 v233, v82, v89, v233
v_fma_f32 v234, v82, v90, v234
v_fma_f32 v235, v82, v91, v235
L_W_sx2:
s_mov_b64 exec, s[72:73]
s_cbranch_execz L_W_sx3
v_max_u32 v192, v70, v71
v_cmp_ne_u32 vcc, -1, v192
v_lshlrev_b32 v88, 16, v70
v_and_b32 v89, 0xffff0000, v70
v_lshlrev_b32 v90, 16, v71
v_and_b32 v91, 0xffff0000, v71
s_andn2_b64 s[72:73], exec, vcc
s_mov_b64 exec, vcc
v_fma_f32 v232, v83, v88, v232
v_fma_f32 v233, v83, v89, v233
v_fma_f32 v234, v83, v90, v234
v_fma_f32 v235, v83, v91, v235
L_W_sx3:
s_mov_b64 exec, -1
s_or_b64 s[74:75], s[66:67], s[68:69]
s_or_b64 s[80:81], s[70:71], s[72:73]
s_or_b64 s[74:75], s[74:75], s[80:81]
s_cbranch_scc0 L_W_sweep_done
s_add_u32 s64, s64, 1
s_cmp_lt_u32 s64, 65536
s_cbranch_scc1 L_W_sweep
L_W_sweep_done:
s_nop 1
v_permlane16_swap_b32 v232, v233
v_permlane16_swap_b32 v234, v235
v_add_f32 v232, v232, v233
v_add_f32 v234, v234, v235
s_nop 1
v_permlane32_swap_b32 v232, v234
s_nop 0
v_add_f32 v232, v232, v234
s_nop 1
v_add_f32_dpp v232, v232, v232 row_ror:8 row_mask:0xf bank_mask:0xf
s_mov_b32 exec_lo, 0x00ff00ff
s_mov_b32 exec_hi, 0x00ff00ff
ds_write_b32 v241, v232
ds_add_rtn_u32 v212, v240, v242 offset:32
ds_read_b128 v[204:207], v240
ds_read_b128 v[208:211], v240 offset:16
s_waitcnt lgkmcnt(2)
v_cmp_eq_u32 vcc, 7, v212
s_waitcnt lgkmcnt(0)
v_pk_add_f32 v[204:205], v[204:205], v[206:207]
v_pk_add_f32 v[208:209], v[208:209], v[210:211]
s_and_b64 exec, exec, vcc
s_cbranch_scc1 L_W_last
s_endpgm
L_W_last:
v_pk_add_f32 v[204:205], v[204:205], v[208:209]
v_add_f32 v204, v204, v205
v_cvt_pk_bf16_f32 v204, v204, v204
global_store_short v243, v204, s[26:27]
s_andn2_b32 s34, 1, vcc_lo
s_mov_b64 exec, -1
s_or_b32 s62, s32, s34
s_cbranch_scc1 L_W_nonext
v_mov_b32 v192, 0x18000
v_mov_b32 v193, s88
s_mov_b64 exec, 1
buffer_store_dword v193, v192, s[52:55], 0 offen
s_mov_b64 exec, -1
L_W_nonext:
s_endpgm
L_roleC:
s_mov_b32 s89, s32
v_and_b32 v1, 63, v0
v_and_b32 v2, 15, v0
v_bfe_u32 v3, v0, 4, 2
v_and_b32 v8, 1, v0
v_lshlrev_b32 v8, 4, v8
v_mov_b32 v9, 0xffff
v_lshlrev_b32 v8, v8, v9
v_bfe_u32 v9, v0, 1, 2
v_cmp_eq_u32 vcc, 0, v9
s_nop 1
v_cndmask_b32 v4, 0, v8, vcc
v_cmp_eq_u32 vcc, 1, v9
s_nop 1
v_cndmask_b32 v5, 0, v8, vcc
v_cmp_eq_u32 vcc, 2, v9
s_nop 1
v_cndmask_b32 v6, 0, v8, vcc
v_cmp_eq_u32 vcc, 3, v9
s_nop 1
v_cndmask_b32 v7, 0, v8, vcc
s_waitcnt lgkmcnt(0)
s_load_dword s88, s[30:31], 0x18000
v_mov_b32 v8, 0
s_lshr_b32 s35, s32, 4
s_lshr_b32 s36, s34, 1
s_and_b32 s37, s34, 1
s_lshl_b32 s60, s32, 19
s_mov_b32 s61, 0x80000
s_add_u32 s40, s16, s60
s_addc_u32 s41, s17, 0
s_and_b32 s41, s41, 0xffff
s_mov_b32 s42, s61
s_mov_b32 s43, 0x20000
s_mov_b32 s44, s30
s_and_b32 s45, s31, 0xffff
s_mov_b32 s46, 0x1000000
s_mov_b32 s47, 0x20000
v_lshlrev_b32 v9, 4, v1
s_lshl_b32 s62, s34, 13
v_add_u32 v9, s62, v9
s_mul_i32 s38, s34, 8448
s_mov_b32 s51, 4096
s_add_u32 s50, s38, 5120
s_waitcnt vmcnt(3)
s_add_u32 m0, s50, 0
s_nop 0
buffer_load_dwordx4 v9, s[40:43], 0 offen offset:0 nt lds
s_waitcnt vmcnt(3)
s_add_u32 m0, s50, 32
s_nop 0
buffer_load_dwordx4 v9, s[40:43], 0 offen offset:1024 nt lds
s_waitcnt vmcnt(3)
s_add_u32 m0, s50, 64
s_nop 0
buffer_load_dwordx4 v9, s[40:43], 0 offen offset:2048 nt lds
s_waitcnt vmcnt(3)
s_add_u32 m0, s50, 96
s_nop 0
buffer_load_dwordx4 v9, s[40:43], 0 offen offset:3072 nt lds
s_waitcnt vmcnt(3)
s_add_u32 m0, s50, 4224
s_nop 0
buffer_load_dwordx4 v9, s[40:43], s51 offen offset:0 nt lds
s_waitcnt vmcnt(3)
s_add_u32 m0, s50, 4256
s_nop 0
buffer_load_dwordx4 v9, s[40:43], s51 offen offset:1024 nt lds
s_waitcnt vmcnt(3)
s_add_u32 m0, s50, 4288
s_nop 0
buffer_load_dwordx4 v9, s[40:43], s51 offen offset:2048 nt lds
s_waitcnt vmcnt(3)
s_add_u32 m0, s50, 4320
s_nop 0
buffer_load_dwordx4 v9, s[40:43], s51 offen offset:3072 nt lds
v_add_u32 v9, 0x10000, v9
s_lshl_b32 s60, s89, 8
s_sub_u32 s61, 0x400000, s60
s_add_u32 s52, s10, s60
s_addc_u32 s53, s11, 0
s_and_b32 s53, s53, 0xffff
s_mov_b32 s54, s61
s_mov_b32 s55, 0x20000
s_mov_b32 s56, s4
s_and_b32 s57, s5, 0xffff
s_mov_b32 s58, 0x800
s_mov_b32 s59, 0x20000
v_lshrrev_b32 v192, 3, v2
v_lshlrev_b32 v192, 10, v192
v_lshl_add_u32 v192, v3, 5, v192
s_lshl_b32 s62, s34, 7
v_add_u32 v192, s62, v192
buffer_load_dwordx4 v[12:15], v192, s[56:59], 0 offen
buffer_load_dwordx4 v[16:19], v192, s[56:59], 0 offen offset:16
v_lshlrev_b32 v10, 17, v3
v_lshl_add_u32 v10, v2, 4, v10
s_lshl_b32 s62, s34, 19
v_add_u32 v10, s62, v10
s_mov_b32 s62, 0
buffer_load_dwordx4 v[64:67], v10, s[52:55], s62 offen nt
s_mov_b32 s62, 8192
buffer_load_dwordx4 v[68:71], v10, s[52:55], s62 offen nt
s_mov_b32 s62, 16384
buffer_load_dwordx4 v[72:75], v10, s[52:55], s62 offen nt
s_mov_b32 s62, 24576
buffer_load_dwordx4 v[76:79], v10, s[52:55], s62 offen nt
s_mov_b32 s62, 32768
buffer_load_dwordx4 v[80:83], v10, s[52:55], s62 offen nt
s_mov_b32 s62, 40960
buffer_load_dwordx4 v[84:87], v10, s[52:55], s62 offen nt
v_lshrrev_b32 v192, 1, v3
v_lshlrev_b32 v192, 9, v192
v_lshl_add_u32 v192, v2, 5, v192
v_and_b32 v193, 1, v3
v_lshl_add_u32 v192, v193, 4, v192
s_lshl_b32 s63, s34, 10
s_add_u32 s63, s63, 140288
v_add_u32 v192, s63, v192
v_lshlrev_b32 v193, 4, v1
s_lshl_b32 s63, s32, 10
s_add_u32 s63, s63, 0x40000
v_add_u32 v194, s63, v193
v_add_u32 v193, 140288, v193
s_mov_b32 s66, 0x01000100
s_mov_b32 s67, 0x03020302
s_waitcnt vmcnt(5)
s_mov_b32 s62, 49152
buffer_load_dwordx4 v[88:91], v10, s[52:55], s62 offen nt
v_perm_b32 v195, v12, v12, s66
v_and_b32 v28, v195, v4
v_and_b32 v29, v195, v5
v_and_b32 v30, v195, v6
v_and_b32 v31, v195, v7
s_nop 1
v_mfma_f32_16x16x32_bf16 v[44:47], v[28:31], v[64:67], 0
s_waitcnt vmcnt(5)
s_mov_b32 s62, 57344
buffer_load_dwordx4 v[92:95], v10, s[52:55], s62 offen nt
v_perm_b32 v195, v12, v12, s67
v_and_b32 v32, v195, v4
v_and_b32 v33, v195, v5
v_and_b32 v34, v195, v6
v_and_b32 v35, v195, v7
s_nop 1
v_mfma_f32_16x16x32_bf16 v[44:47], v[32:35], v[68:71], v[44:47]
s_waitcnt vmcnt(5)
s_mov_b32 s62, 65536
buffer_load_dwordx4 v[96:99], v10, s[52:55], s62 offen nt
v_perm_b32 v195, v13, v13, s66
v_and_b32 v28, v195, v4
v_and_b32 v29, v195, v5
v_and_b32 v30, v195, v6
v_and_b32 v31, v195, v7
s_nop 1
v_mfma_f32_16x16x32_bf16 v[44:47], v[28:31], v[72:75], v[44:47]
s_waitcnt vmcnt(5)
s_mov_b32 s62, 73728
buffer_load_dwordx4 v[100:103], v10, s[52:55], s62 offen nt
v_perm_b32 v195, v13, v13, s67
v_and_b32 v32, v195, v4
v_and_b32 v33, v195, v5
v_and_b32 v34, v195, v6
v_and_b32 v35, v195, v7
s_nop 1
v_mfma_f32_16x16x32_bf16 v[44:47], v[32:35], v[76:79], v[44:47]
s_waitcnt vmcnt(5)
s_mov_b32 s62, 81920
buffer_load_dwordx4 v[104:107], v10, s[52:55], s62 offen nt
v_perm_b32 v195, v14, v14, s66
v_and_b32 v28, v195, v4
v_and_b32 v29, v195, v5
v_and_b32 v30, v195, v6
v_and_b32 v31, v195, v7
s_nop 1
v_mfma_f32_16x16x32_bf16 v[44:47], v[28:31], v[80:83], v[44:47]
s_waitcnt vmcnt(5)
s_mov_b32 s62, 90112
buffer_load_dwordx4 v[108:111], v10, s[52:55], s62 offen nt
v_perm_b32 v195, v14, v14, s67
v_and_b32 v32, v195, v4
v_and_b32 v33, v195, v5
v_and_b32 v34, v195, v6
v_and_b32 v35, v195, v7
s_nop 1
v_mfma_f32_16x16x32_bf16 v[44:47], v[32:35], v[84:87], v[44:47]
s_waitcnt vmcnt(5)
s_mov_b32 s62, 98304
buffer_load_dwordx4 v[112:115], v10, s[52:55], s62 offen nt
v_perm_b32 v195, v15, v15, s66
v_and_b32 v28, v195, v4
v_and_b32 v29, v195, v5
v_and_b32 v30, v195, v6
v_and_b32 v31, v195, v7
s_nop 1
v_mfma_f32_16x16x32_bf16 v[44:47], v[28:31], v[88:91], v[44:47]
s_waitcnt vmcnt(5)
s_mov_b32 s62, 106496
buffer_load_dwordx4 v[116:119], v10, s[52:55], s62 offen nt
v_perm_b32 v195, v15, v15, s67
v_and_b32 v32, v195, v4
v_and_b32 v33, v195, v5
v_and_b32 v34, v195, v6
v_and_b32 v35, v195, v7
s_nop 1
v_mfma_f32_16x16x32_bf16 v[44:47], v[32:35], v[92:95], v[44:47]
s_waitcnt vmcnt(5)
s_mov_b32 s62, 114688
buffer_load_dwordx4 v[120:123], v10, s[52:55], s62 offen nt
v_perm_b32 v195, v16, v16, s66
v_and_b32 v28, v195, v4
v_and_b32 v29, v195, v5
v_and_b32 v30, v195, v6
v_and_b32 v31, v195, v7
s_nop 1
v_mfma_f32_16x16x32_bf16 v[44:47], v[28:31], v[96:99], v[44:47]
s_waitcnt vmcnt(5)
s_mov_b32 s62, 122880
buffer_load_dwordx4 v[124:127], v10, s[52:55], s62 offen nt
v_perm_b32 v195, v16, v16, s67
v_and_b32 v32, v195, v4
v_and_b32 v33, v195, v5
v_and_b32 v34, v195, v6
v_and_b32 v35, v195, v7
s_nop 1
v_mfma_f32_16x16x32_bf16 v[44:47], v[32:35], v[100:103], v[44:47]
s_waitcnt vmcnt(5)
v_perm_b32 v195, v17, v17, s66
v_and_b32 v28, v195, v4
v_and_b32 v29, v195, v5
v_and_b32 v30, v195, v6
v_and_b32 v31, v195, v7
s_nop 1
v_mfma_f32_16x16x32_bf16 v[44:47], v[28:31], v[104:107], v[44:47]
s_waitcnt vmcnt(4)
v_perm_b32 v195, v17, v17, s67
v_and_b32 v32, v195, v4
v_and_b32 v33, v195, v5
v_and_b32 v34, v195, v6
v_and_b32 v35, v195, v7
s_nop 1
v_mfma_f32_16x16x32_bf16 v[44:47], v[32:35], v[108:111], v[44:47]
s_waitcnt vmcnt(3)
v_perm_b32 v195, v18, v18, s66
v_and_b32 v28, v195, v4
v_and_b32 v29, v195, v5
v_and_b32 v30, v195, v6
v_and_b32 v31, v195, v7
s_nop 1
v_mfma_f32_16x16x32_bf16 v[44:47], v[28:31], v[112:115], v[44:47]
s_waitcnt vmcnt(2)
v_perm_b32 v195, v18, v18, s67
v_and_b32 v32, v195, v4
v_and_b32 v33, v195, v5
v_and_b32 v34, v195, v6
v_and_b32 v35, v195, v7
s_nop 1
v_mfma_f32_16x16x32_bf16 v[44:47], v[32:35], v[116:119], v[44:47]
s_waitcnt vmcnt(1)
v_perm_b32 v195, v19, v19, s66
v_and_b32 v28, v195, v4
v_and_b32 v29, v195, v5
v_and_b32 v30, v195, v6
v_and_b32 v31, v195, v7
s_nop 1
v_mfma_f32_16x16x32_bf16 v[44:47], v[28:31], v[120:123], v[44:47]
s_waitcnt vmcnt(0)
v_perm_b32 v195, v19, v19, s67
v_and_b32 v32, v195, v4
v_and_b32 v33, v195, v5
v_and_b32 v34, v195, v6
v_and_b32 v35, v195, v7
s_nop 1
v_mfma_f32_16x16x32_bf16 v[44:47], v[32:35], v[124:127], v[44:47]
s_nop 7
ds_write_b128 v192, v[44:47]
s_waitcnt lgkmcnt(0)
s_add_u32 s88, s88, 0x9e3779b9
s_barrier
s_cmp_lg_u32 s34, 0
s_cbranch_scc1 L_C_qdone
ds_read_b128 v[64:67], v193 offset:0
ds_read_b128 v[68:71], v193 offset:1024
ds_read_b128 v[72:75], v193 offset:2048
ds_read_b128 v[76:79], v193 offset:3072
ds_read_b128 v[80:83], v193 offset:4096
ds_read_b128 v[84:87], v193 offset:5120
ds_read_b128 v[88:91], v193 offset:6144
ds_read_b128 v[92:95], v193 offset:7168
s_waitcnt lgkmcnt(6)
v_add_f32 v64, v64, v68
v_add_f32 v65, v65, v69
v_add_f32 v66, v66, v70
v_add_f32 v67, v67, v71
s_waitcnt lgkmcnt(5)
v_add_f32 v64, v64, v72
v_add_f32 v65, v65, v73
v_add_f32 v66, v66, v74
v_add_f32 v67, v67, v75
s_waitcnt lgkmcnt(4)
v_add_f32 v64, v64, v76
v_add_f32 v65, v65, v77
v_add_f32 v66, v66, v78
v_add_f32 v67, v67, v79
s_waitcnt lgkmcnt(3)
v_add_f32 v64, v64, v80
v_add_f32 v65, v65, v81
v_add_f32 v66, v66, v82
v_add_f32 v67, v67, v83
s_waitcnt lgkmcnt(2)
v_add_f32 v64, v64, v84
v_add_f32 v65, v65, v85
v_add_f32 v66, v66, v86
v_add_f32 v67, v67, v87
s_waitcnt lgkmcnt(1)
v_add_f32 v64, v64, v88
v_add_f32 v65, v65, v89
v_add_f32 v66, v66, v90
v_add_f32 v67, v67, v91
s_waitcnt lgkmcnt(0)
v_add_f32 v64, v64, v92
v_add_f32 v65, v65, v93
v_add_f32 v66, v66, v94
v_add_f32 v67, v67, v95
v_cvt_pk_bf16_f32 v64, v64, v65
v_cvt_pk_bf16_f32 v66, v66, v67
v_mov_b32 v65, s88
v_mov_b32 v67, s88
buffer_store_dwordx4 v[64:67], v194, s[44:47], 0 offen sc1
L_C_qdone:
s_barrier
s_add_u32 s50, s38, 72704
s_waitcnt vmcnt(3)
s_add_u32 m0, s50, 0
s_nop 0
buffer_load_dwordx4 v9, s[40:43], 0 offen offset:0 nt lds
s_waitcnt vmcnt(3)
s_add_u32 m0, s50, 32
s_nop 0
buffer_load_dwordx4 v9, s[40:43], 0 offen offset:1024 nt lds
s_waitcnt vmcnt(3)
s_add_u32 m0, s50, 64
s_nop 0
buffer_load_dwordx4 v9, s[40:43], 0 offen offset:2048 nt lds
s_waitcnt vmcnt(3)
s_add_u32 m0, s50, 96
s_nop 0
buffer_load_dwordx4 v9, s[40:43], 0 offen offset:3072 nt lds
s_waitcnt vmcnt(3)
s_add_u32 m0, s50, 4224
s_nop 0
buffer_load_dwordx4 v9, s[40:43], s51 offen offset:0 nt lds
s_waitcnt vmcnt(3)
s_add_u32 m0, s50, 4256
s_nop 0
buffer_load_dwordx4 v9, s[40:43], s51 offen offset:1024 nt lds
s_waitcnt vmcnt(3)
s_add_u32 m0, s50, 4288
s_nop 0
buffer_load_dwordx4 v9, s[40:43], s51 offen offset:2048 nt lds
s_waitcnt vmcnt(3)
s_add_u32 m0, s50, 4320
s_nop 0
buffer_load_dwordx4 v9, s[40:43], s51 offen offset:3072 nt lds
v_add_u32 v9, 0x10000, v9
s_waitcnt vmcnt(3)
buffer_load_dwordx4 v[208:211], v9, s[40:43], 0 offen offset:0 nt
s_waitcnt vmcnt(3)
buffer_load_dwordx4 v[212:215], v9, s[40:43], 0 offen offset:1024 nt
s_waitcnt vmcnt(3)
buffer_load_dwordx4 v[216:219], v9, s[40:43], 0 offen offset:2048 nt
s_waitcnt vmcnt(3)
buffer_load_dwordx4 v[220:223], v9, s[40:43], 0 offen offset:3072 nt
s_waitcnt vmcnt(3)
buffer_load_dwordx4 v[224:227], v9, s[40:43], s51 offen offset:0 nt
s_waitcnt vmcnt(3)
buffer_load_dwordx4 v[228:231], v9, s[40:43], s51 offen offset:1024 nt
s_waitcnt vmcnt(3)
buffer_load_dwordx4 v[232:235], v9, s[40:43], s51 offen offset:2048 nt
s_waitcnt vmcnt(3)
buffer_load_dwordx4 v[236:239], v9, s[40:43], s51 offen offset:3072 nt
v_add_u32 v9, 0x10000, v9
s_add_u32 s62, s38, 5120
v_lshl_add_u32 v22, v1, 4, s62
s_lshl_b32 s62, s36, 4
v_add_u32 v240, s62, v2
v_mul_u32_u24 v10, 1056, v240
v_lshl_add_u32 v10, v3, 4, v10
v_add_u32 v10, 5120, v10
v_lshrrev_b32 v240, 1, v3
v_lshlrev_b32 v240, 3, v240
v_lshrrev_b32 v241, 2, v2
v_add_u32 v240, v240, v241
v_mul_u32_u24 v11, 1056, v240
v_and_b32 v240, 1, v3
v_lshl_add_u32 v11, v240, 5, v11
v_and_b32 v240, 3, v2
v_lshl_add_u32 v11, v240, 3, v11
s_lshl_b32 s62, s34, 7
s_add_u32 s62, s62, 5120
v_add_u32 v11, s62, v11
s_lshl_b32 s62, s37, 4
v_add_u32 v240, s62, v2
v_mul_u32_u24 v12, 144, v240
v_lshl_add_u32 v12, v3, 3, v12
s_lshl_b32 s62, s36, 5
v_add_u32 v12, s62, v12
v_lshlrev_b32 v15, 4, v240
s_lshl_b32 s62, s36, 2
v_add_u32 v14, s62, v15
v_and_b32 v240, 31, v1
v_mul_u32_u24 v13, 144, v240
v_lshrrev_b32 v241, 5, v1
v_lshl_add_u32 v13, v241, 4, v13
v_lshlrev_b32 v16, 4, v240
v_mov_b32 v17, 0x3e0293ee
v_mov_b32 v18, 0xff800000
v_mov_b32 v19, 0xff800000
v_mov_b32 v20, 0
v_mov_b32 v96, 0
v_mov_b32 v97, 0
v_mov_b32 v98, 0
v_mov_b32 v99, 0
v_mov_b32 v100, 0
v_mov_b32 v101, 0
v_mov_b32 v102, 0
v_mov_b32 v103, 0
v_mov_b32 v104, 0
v_mov_b32 v105, 0
v_mov_b32 v106, 0
v_mov_b32 v107, 0
v_mov_b32 v108, 0
v_mov_b32 v109, 0
v_mov_b32 v110, 0
v_mov_b32 v111, 0
v_mov_b32 v112, 0
v_mov_b32 v113, 0
v_mov_b32 v114, 0
v_mov_b32 v115, 0
v_mov_b32 v116, 0
v_mov_b32 v117, 0
v_mov_b32 v118, 0
v_mov_b32 v119, 0
v_mov_b32 v120, 0
v_mov_b32 v121, 0
v_mov_b32 v122, 0
v_mov_b32 v123, 0
v_mov_b32 v124, 0
v_mov_b32 v125, 0
v_mov_b32 v126, 0
v_mov_b32 v127, 0
s_cmp_lg_u32 s34, 0
s_cbranch_scc1 L_wc_Cq
s_mov_b32 s62, 0x1a000
v_lshl_add_u32 v240, v1, 8, s62
s_lshl_b64 exec, 1, s32
s_mov_b32 s64, 0
L_tp_Cq0:
buffer_load_dword v241, v240, s[44:47], 0 offen sc1
s_waitcnt vmcnt(0)
v_cmp_ne_u32 vcc, s88, v241
s_add_u32 s64, s64, 1
s_nop 0
s_or_b64 vcc, vcc, vcc
s_cbranch_scc0 L_tp_Cq0_ok
s_sleep 32
s_cmp_lt_u32 s64, 65536
s_cbranch_scc1 L_tp_Cq0
L_tp_Cq0_ok:
s_mov_b32 exec_lo, -1
s_mov_b32 exec_hi, 0
s_mov_b32 s64, 0
L_tp_Cq:
buffer_load_dword v241, v240, s[44:47], 0 offen sc1
s_waitcnt vmcnt(0)
v_cmp_ne_u32 vcc, s88, v241
s_add_u32 s64, s64, 1
s_nop 0
s_or_b64 vcc, vcc, vcc
s_cbranch_scc0 L_tp_Cq_ok
s_mov_b64 exec, vcc
s_sleep 8
s_cmp_lt_u32 s64, 65536
s_cbranch_scc1 L_tp_Cq
L_tp_Cq_ok:
s_mov_b64 exec, -1
L_wc_Cq:
s_barrier
s_lshl_b32 s62, s35, 5
s_lshl_b32 s63, s37, 4
s_add_u32 s62, s62, s63
v_add_u32 v240, s62, v2
v_lshlrev_b32 v240, 10, v240
v_lshl_add_u32 v240, v3, 4, v240
v_add_u32 v240, 0x0, v240
buffer_load_dwordx4 v[32:35], v240, s[44:47], 0 offen offset:0 sc1
buffer_load_dwordx4 v[36:39], v240, s[44:47], 0 offen offset:64 sc1
buffer_load_dwordx4 v[40:43], v240, s[44:47], 0 offen offset:128 sc1
buffer_load_dwordx4 v[44:47], v240, s[44:47], 0 offen offset:192 sc1
buffer_load_dwordx4 v[48:51], v240, s[44:47], 0 offen offset:256 sc1
buffer_load_dwordx4 v[52:55], v240, s[44:47], 0 offen offset:320 sc1
buffer_load_dwordx4 v[56:59], v240, s[44:47], 0 offen offset:384 sc1
buffer_load_dwordx4 v[60:63], v240, s[44:47], 0 offen offset:448 sc1
buffer_load_dwordx4 v[64:67], v240, s[44:47], 0 offen offset:512 sc1
buffer_load_dwordx4 v[68:71], v240, s[44:47], 0 offen offset:576 sc1
buffer_load_dwordx4 v[72:75], v240, s[44:47], 0 offen offset:640 sc1
buffer_load_dwordx4 v[76:79], v240, s[44:47], 0 offen offset:704 sc1
buffer_load_dwordx4 v[80:83], v240, s[44:47], 0 offen offset:768 sc1
buffer_load_dwordx4 v[84:87], v240, s[44:47], 0 offen offset:832 sc1
buffer_load_dwordx4 v[88:91], v240, s[44:47], 0 offen offset:896 sc1
buffer_load_dwordx4 v[92:95], v240, s[44:47], 0 offen offset:960 sc1
s_mov_b32 s39, 0
s_mov_b32 s48, 0
.p2align 6
L_C_loop:
s_cmp_lg_u32 s39, 0
s_cbranch_scc1 L_C_top
s_waitcnt vmcnt(0)
L_C_top:
s_waitcnt lgkmcnt(0)
s_barrier
s_mov_b32 s52, 1
s_cmp_eq_u32 s39, 0
s_cselect_b32 s52, 0, s52
s_cmp_ge_u32 s39, 7
s_cselect_b32 s52, 0, s52
s_sub_u32 s50, 67584, s48
v_add_u32 v23, s50, v22
s_cmp_eq_u32 s52, 0
s_cbranch_scc1 L_C_st0
s_waitcnt vmcnt(7)
ds_write_b128 v23, v[208:211] offset:0
buffer_load_dwordx4 v[208:211], v9, s[40:43], 0 offen offset:0 nt
s_waitcnt vmcnt(7)
ds_write_b128 v23, v[212:215] offset:1056
buffer_load_dwordx4 v[212:215], v9, s[40:43], 0 offen offset:1024 nt
s_waitcnt vmcnt(7)
ds_write_b128 v23, v[216:219] offset:2112
buffer_load_dwordx4 v[216:219], v9, s[40:43], 0 offen offset:2048 nt
s_waitcnt vmcnt(7)
ds_write_b128 v23, v[220:223] offset:3168
buffer_load_dwordx4 v[220:223], v9, s[40:43], 0 offen offset:3072 nt
s_waitcnt vmcnt(7)
ds_write_b128 v23, v[224:227] offset:4224
buffer_load_dwordx4 v[224:227], v9, s[40:43], s51 offen offset:0 nt
s_waitcnt vmcnt(7)
ds_write_b128 v23, v[228:231] offset:5280
buffer_load_dwordx4 v[228:231], v9, s[40:43], s51 offen offset:1024 nt
s_waitcnt vmcnt(7)
ds_write_b128 v23, v[232:235] offset:6336
buffer_load_dwordx4 v[232:235], v9, s[40:43], s51 offen offset:2048 nt
s_waitcnt vmcnt(7)
ds_write_b128 v23, v[236:239] offset:7392
buffer_load_dwordx4 v[236:239], v9, s[40:43], s51 offen offset:3072 nt
v_add_u32 v9, 0x10000, v9
L_C_st0:
v_add_u32 v240, s48, v10
v_add_u32 v241, s48, v11
ds_read_b128 v[128:131], v240 offset:0
ds_read_b128 v[132:135], v240 offset:64
ds_read_b128 v[136:139], v240 offset:128
ds_read_b128 v[140:143], v240 offset:192
ds_read_b128 v[144:147], v240 offset:256
ds_read_b128 v[148:151], v240 offset:320
ds_read_b128 v[152:155], v240 offset:384
ds_read_b128 v[156:159], v240 offset:448
ds_read_b128 v[160:163], v240 offset:512
ds_read_b128 v[164:167], v240 offset:576
ds_read_b128 v[168:171], v240 offset:640
ds_read_b128 v[172:175], v240 offset:704
ds_read_b128 v[176:179], v240 offset:768
ds_read_b128 v[180:183], v240 offset:832
ds_read_b128 v[184:187], v240 offset:896
ds_read_b128 v[188:191], v240 offset:960
s_waitcnt lgkmcnt(15)
v_mfma_f32_16x16x32_bf16 v[28:31], v[128:131], v[32:35], 0
s_waitcnt lgkmcnt(14)
v_mfma_f32_16x16x32_bf16 v[28:31], v[132:135], v[36:39], v[28:31]
s_waitcnt lgkmcnt(13)
v_mfma_f32_16x16x32_bf16 v[28:31], v[136:139], v[40:43], v[28:31]
s_waitcnt lgkmcnt(12)
v_mfma_f32_16x16x32_bf16 v[28:31], v[140:143], v[44:47], v[28:31]
s_waitcnt lgkmcnt(11)
v_mfma_f32_16x16x32_bf16 v[28:31], v[144:147], v[48:51], v[28:31]
s_waitcnt lgkmcnt(10)
v_mfma_f32_16x16x32_bf16 v[28:31], v[148:151], v[52:55], v[28:31]
s_waitcnt lgkmcnt(9)
v_mfma_f32_16x16x32_bf16 v[28:31], v[152:155], v[56:59], v[28:31]
s_waitcnt lgkmcnt(8)
v_mfma_f32_16x16x32_bf16 v[28:31], v[156:159], v[60:63], v[28:31]
s_waitcnt lgkmcnt(7)
v_mfma_f32_16x16x32_bf16 v[28:31], v[160:163], v[64:67], v[28:31]
s_waitcnt lgkmcnt(6)
v_mfma_f32_16x16x32_bf16 v[28:31], v[164:167], v[68:71], v[28:31]
s_waitcnt lgkmcnt(5)
v_mfma_f32_16x16x32_bf16 v[28:31], v[168:171], v[72:75], v[28:31]
s_waitcnt lgkmcnt(4)
v_mfma_f32_16x16x32_bf16 v[28:31], v[172:175], v[76:79], v[28:31]
s_waitcnt lgkmcnt(3)
v_mfma_f32_16x16x32_bf16 v[28:31], v[176:179], v[80:83], v[28:31]
s_waitcnt lgkmcnt(2)
v_mfma_f32_16x16x32_bf16 v[28:31], v[180:183], v[84:87], v[28:31]
s_waitcnt lgkmcnt(1)
v_mfma_f32_16x16x32_bf16 v[28:31], v[184:187], v[88:91], v[28:31]
s_waitcnt lgkmcnt(0)
v_mfma_f32_16x16x32_bf16 v[28:31], v[188:191], v[92:95], v[28:31]
s_nop 7
v_mul_f32 v24, v28, v17
v_mul_f32 v25, v29, v17
v_mul_f32 v26, v30, v17
v_mul_f32 v27, v31, v17
v_max3_f32 v242, v24, v25, v26
v_max_f32 v242, v242, v27
v_mov_b32 v243, v242
s_nop 1
v_permlane16_swap_b32 v242, v243
s_nop 0
v_max_f32 v242, v242, v243
v_mov_b32 v243, v242
s_nop 1
v_permlane32_swap_b32 v242, v243
s_nop 0
v_max_f32 v242, v242, v243
s_mov_b64 exec, 0xffff
ds_write_b32 v14, v242 offset:0
s_mov_b64 exec, -1
s_waitcnt lgkmcnt(0)
s_barrier
ds_read_b128 v[192:195], v15 offset:0
ds_read_b128 v[196:199], v16 offset:0
s_waitcnt lgkmcnt(1)
v_max3_f32 v242, v192, v193, v194
v_max3_f32 v242, v242, v195, v18
v_sub_f32 v21, v18, v242
v_sub_f32 v24, v24, v242
v_sub_f32 v25, v25, v242
v_sub_f32 v26, v26, v242
v_sub_f32 v27, v27, v242
v_exp_f32 v21, v21
v_exp_f32 v24, v24
v_exp_f32 v25, v25
v_exp_f32 v26, v26
v_exp_f32 v27, v27
v_mov_b32 v18, v242
v_cvt_pk_bf16_f32 v244, v24, v25
v_cvt_pk_bf16_f32 v245, v26, v27
ds_write_b64 v12, v[244:245] offset:512
v_add_f32 v24, v24, v25
v_add_f32 v26, v26, v27
v_fma_f32 v20, v20, v21, v24
v_add_f32 v20, v20, v26
s_waitcnt lgkmcnt(1)
v_max3_f32 v242, v196, v197, v198
v_max3_f32 v242, v242, v199, v19
v_sub_f32 v21, v19, v242
v_exp_f32 v21, v21
v_mov_b32 v19, v242
v_mul_f32 v96, v96, v21
v_mul_f32 v97, v97, v21
v_mul_f32 v98, v98, v21
v_mul_f32 v99, v99, v21
v_mul_f32 v100, v100, v21
v_mul_f32 v101, v101, v21
v_mul_f32 v102, v102, v21
v_mul_f32 v103, v103, v21
v_mul_f32 v104, v104, v21
v_mul_f32 v105, v105, v21
v_mul_f32 v106, v106, v21
v_mul_f32 v107, v107, v21
v_mul_f32 v108, v108, v21
v_mul_f32 v109, v109, v21
v_mul_f32 v110, v110, v21
v_mul_f32 v111, v111, v21
v_mul_f32 v112, v112, v21
v_mul_f32 v113, v113, v21
v_mul_f32 v114, v114, v21
v_mul_f32 v115, v115, v21
v_mul_f32 v116, v116, v21
v_mul_f32 v117, v117, v21
v_mul_f32 v118, v118, v21
v_mul_f32 v119, v119, v21
v_mul_f32 v120, v120, v21
v_mul_f32 v121, v121, v21
v_mul_f32 v122, v122, v21
v_mul_f32 v123, v123, v21
v_mul_f32 v124, v124, v21
v_mul_f32 v125, v125, v21
v_mul_f32 v126, v126, v21
v_mul_f32 v127, v127, v21
s_waitcnt lgkmcnt(0)
s_barrier
ds_read_b128 v[192:195], v13 offset:512
ds_read_b128 v[196:199], v13 offset:544
ds_read_b128 v[200:203], v13 offset:576
ds_read_b128 v[204:207], v13 offset:608
ds_read_b64_tr_b16 v[128:129], v241 offset:0
ds_read_b64_tr_b16 v[130:131], v241 offset:4224
ds_read_b64_tr_b16 v[132:133], v241 offset:64
ds_read_b64_tr_b16 v[134:135], v241 offset:4288
ds_read_b64_tr_b16 v[136:137], v241 offset:16896
ds_read_b64_tr_b16 v[138:139], v241 offset:21120
ds_read_b64_tr_b16 v[140:141], v241 offset:16960
ds_read_b64_tr_b16 v[142:143], v241 offset:21184
ds_read_b64_tr_b16 v[144:145], v241 offset:33792
ds_read_b64_tr_b16 v[146:147], v241 offset:38016
ds_read_b64_tr_b16 v[148:149], v241 offset:33856
ds_read_b64_tr_b16 v[150:151], v241 offset:38080
ds_read_b64_tr_b16 v[152:153], v241 offset:50688
ds_read_b64_tr_b16 v[154:155], v241 offset:54912
ds_read_b64_tr_b16 v[156:157], v241 offset:50752
ds_read_b64_tr_b16 v[158:159], v241 offset:54976
s_waitcnt lgkmcnt(12)
v_mfma_f32_32x32x16_bf16 v[96:111], v[128:131], v[192:195], v[96:111]
v_mfma_f32_32x32x16_bf16 v[112:127], v[132:135], v[192:195], v[112:127]
s_waitcnt lgkmcnt(8)
v_mfma_f32_32x32x16_bf16 v[96:111], v[136:139], v[196:199], v[96:111]
v_mfma_f32_32x32x16_bf16 v[112:127], v[140:143], v[196:199], v[112:127]
s_waitcnt lgkmcnt(4)
v_mfma_f32_32x32x16_bf16 v[96:111], v[144:147], v[200:203], v[96:111]
v_mfma_f32_32x32x16_bf16 v[112:127], v[148:151], v[200:203], v[112:127]
s_waitcnt lgkmcnt(0)
v_mfma_f32_32x32x16_bf16 v[96:111], v[152:155], v[204:207], v[96:111]
v_mfma_f32_32x32x16_bf16 v[112:127], v[156:159], v[204:207], v[112:127]
s_sub_u32 s48, 67584, s48
s_add_u32 s39, s39, 1
s_cmp_lt_u32 s39, 8
s_cbranch_scc1 L_C_loop
v_mov_b32 v243, v20
s_nop 1
v_permlane16_swap_b32 v20, v243
s_nop 0
v_add_f32 v20, v20, v243
v_mov_b32 v243, v20
s_nop 1
v_permlane32_swap_b32 v20, v243
s_nop 0
v_add_f32 v20, v20, v243
s_barrier
s_mov_b64 exec, 0xffff
ds_write_b32 v14, v20 offset:0
s_mov_b64 exec, -1
v_and_b32 v240, 31, v1
v_mul_u32_u24 v240, 2064, v240
v_lshrrev_b32 v241, 5, v1
v_lshl_add_u32 v240, v241, 4, v240
s_lshl_b32 s62, s34, 8
s_add_u32 s62, s62, 5120
v_add_u32 v240, s62, v240
s_nop 5
ds_write_b128 v240, v[96:99] offset:0
ds_write_b128 v240, v[100:103] offset:32
ds_write_b128 v240, v[104:107] offset:64
ds_write_b128 v240, v[108:111] offset:96
ds_write_b128 v240, v[112:115] offset:128
ds_write_b128 v240, v[116:119] offset:160
ds_write_b128 v240, v[120:123] offset:192
ds_write_b128 v240, v[124:127] offset:224
s_waitcnt lgkmcnt(0)
s_barrier
s_mul_i32 s62, s34, 8256
s_add_u32 s62, s62, 5120
v_lshl_add_u32 v240, v1, 5, s62
ds_read_b128 v[128:131], v240 offset:0
ds_read_b128 v[132:135], v240 offset:16
ds_read_b128 v[136:139], v240 offset:2064
ds_read_b128 v[140:143], v240 offset:2080
ds_read_b128 v[144:147], v240 offset:4128
ds_read_b128 v[148:151], v240 offset:4144
ds_read_b128 v[152:155], v240 offset:6192
ds_read_b128 v[156:159], v240 offset:6208
s_lshl_b32 s62, s35, 5
s_lshl_b32 s63, s34, 2
s_add_u32 s62, s62, s63
s_lshl_b32 s62, s62, 4
s_and_b32 s63, s32, 15
s_add_u32 s62, s62, s63
s_lshl_b32 s62, s62, 10
s_add_u32 s62, s62, 0x200000
v_lshl_add_u32 v241, v1, 4, s62
s_waitcnt lgkmcnt(6)
v_cvt_pk_bf16_f32 v160, v128, v129
v_cvt_pk_bf16_f32 v161, v130, v131
v_cvt_pk_bf16_f32 v162, v132, v133
v_cvt_pk_bf16_f32 v163, v134, v135
s_mov_b32 s63, 0
buffer_store_dwordx4 v[160:163], v241, s[44:47], s63 offen sc1
s_waitcnt lgkmcnt(4)
v_cvt_pk_bf16_f32 v164, v136, v137
v_cvt_pk_bf16_f32 v165, v138, v139
v_cvt_pk_bf16_f32 v166, v140, v141
v_cvt_pk_bf16_f32 v167, v142, v143
s_mov_b32 s63, 16384
buffer_store_dwordx4 v[164:167], v241, s[44:47], s63 offen sc1
s_waitcnt lgkmcnt(2)
v_cvt_pk_bf16_f32 v168, v144, v145
v_cvt_pk_bf16_f32 v169, v146, v147
v_cvt_pk_bf16_f32 v170, v148, v149
v_cvt_pk_bf16_f32 v171, v150, v151
s_mov_b32 s63, 32768
buffer_store_dwordx4 v[168:171], v241, s[44:47], s63 offen sc1
s_waitcnt lgkmcnt(0)
v_cvt_pk_bf16_f32 v172, v152, v153
v_cvt_pk_bf16_f32 v173, v154, v155
v_cvt_pk_bf16_f32 v174, v156, v157
v_cvt_pk_bf16_f32 v175, v158, v159
s_mov_b32 s63, 49152
buffer_store_dwordx4 v[172:175], v241, s[44:47], s63 offen sc1
ds_read_b128 v[192:195], v16 offset:0
v_and_b32 v240, 31, v1
s_lshl_b32 s63, s32, 9
s_add_u32 s63, s63, 0x10000
v_lshl_add_u32 v240, v240, 4, s63
s_waitcnt lgkmcnt(0)
v_add_f32 v192, v192, v193
v_add_f32 v194, v194, v195
v_add_f32 v194, v192, v194
v_mov_b32 v192, v19
v_mov_b32 v193, s88
v_mov_b32 v195, s88
s_waitcnt vmcnt(0)
s_barrier
s_cmp_lg_u32 s34, 1
s_cbranch_scc1 L_C_noas
s_and_b32 s63, s32, 7
s_mul_i32 s63, s63, 0x100
s_add_u32 s63, s63, 0xc0000
s_add_u32 s56, s30, s63
s_addc_u32 s57, s31, 0
s_lshl_b32 s62, s89, 21
s_sub_u32 s63, 0x8000000, s62
s_add_u32 s68, s6, s62
s_addc_u32 s69, s7, 0
s_and_b32 s69, s69, 0xffff
s_mov_b32 s70, s63
s_mov_b32 s71, 0x20000
s_add_u32 s72, s8, s62
s_addc_u32 s73, s9, 0
s_and_b32 s73, s73, 0xffff
s_mov_b32 s74, s63
s_mov_b32 s75, 0x20000
s_mov_b64 s[76:77], s[68:69]
s_mov_b64 s[78:79], s[70:71]
s_lshr_b32 s62, s32, 3
s_mul_i32 s62, s62, 6
s_sub_u32 s62, s62, 32
v_add_u32 v136, s62, v1
v_cmp_gt_u32 vcc, 32, v1
v_lshlrev_b32 v133, 7, v1
v_add_u32 v134, 0x4000000, v133
v_cndmask_b32 v128, v136, v1, vcc
v_lshlrev_b32 v128, 2, v128
v_mov_b32 v132, 0
s_mov_b32 s64, 0
L_as_C:
s_mov_b64 exec, 0x1ffffff
s_mov_b32 exec_hi, 0x3f
global_load_dword v129, v128, s[56:57] nt
s_waitcnt vmcnt(0)
v_subrev_u32 v129, s88, v129
s_mov_b64 exec, 0xffffff
v_cmp_le_u32 vcc, 0x400, v129
v_readlane_b32 s62, v129, 24
v_add_u32_dpp v129, v129, v129 row_shr:1 row_mask:0xf bank_mask:0xf bound_ctrl:0
s_nop 1
v_add_u32_dpp v129, v129, v129 row_shr:2 row_mask:0xf bank_mask:0xf bound_ctrl:0
s_nop 1
v_add_u32_dpp v129, v129, v129 row_shr:4 row_mask:0xf bank_mask:0xf bound_ctrl:0
s_nop 1
v_add_u32_dpp v129, v129, v129 row_shr:8 row_mask:0xf bank_mask:0xf bound_ctrl:0
s_nop 0
v_readlane_b32 s61, v129, 15
v_readlane_b32 s63, v129, 23
s_add_u32 s61, s61, s63
s_cbranch_vccnz L_as_C_x
s_cmp_ge_u32 s61, 15168
s_cbranch_scc1 L_as_C_x
s_sub_u32 s61, s61, 120
s_mov_b32 exec_lo, 0
s_mov_b32 exec_hi, 0x3f
v_cmp_gt_u32 vcc, 280, v129
v_add_u32 v130, 56, v129
s_nop 0
v_cndmask_b32 v136, 0, 8, vcc
v_add_u32 v130, v130, v136
v_lshrrev_b32 v130, 4, v130
v_sub_u32 v136, v130, v132
v_cmp_gt_i32 vcc, 4, v136
v_cmp_le_i32 s[66:67], 2, v136
s_nop 0
v_cndmask_b32 v131, 0, 7, vcc
v_cmp_ge_u32 vcc, 41, v130
v_add_u32 v131, v131, v129
v_lshl_add_u32 v131, v131, 6, v1
s_and_b64 vcc, vcc, s[66:67]
v_cndmask_b32 v131, -1, v131, vcc
s_nop 1
v_min_u32_dpp v131, v131, v131 row_shr:1 row_mask:0xf bank_mask:0xf
s_nop 1
v_min_u32_dpp v131, v131, v131 row_shr:2 row_mask:0xf bank_mask:0xf
s_nop 1
v_min_u32_dpp v131, v131, v131 row_shr:4 row_mask:0xf bank_mask:0xf
s_nop 0
v_readlane_b32 s63, v131, 37
s_lshr_b32 s65, s63, 6
s_and_b32 s63, s63, 63
s_mul_i32 s65, s65, 24
s_cmp_ge_i32 s65, s61
s_cbranch_scc1 L_as_C_idle
v_readlane_b32 s65, v130, s63
s_mov_b32 m0, s63
s_mov_b64 exec, -1
s_cmp_lt_u32 s65, 21
s_cselect_b64 s[76:77], s[68:69], s[72:73]
v_writelane_b32 v132, s65, m0
s_cselect_b32 s66, 0, 21
s_sub_u32 s65, s65, s66
s_mul_i32 s65, s65, 0x18000
s_and_b32 s63, s63, 7
s_lshl_b32 s63, s63, 14
s_add_u32 s65, s65, s63
s_add_u32 s66, s65, 0x2000
buffer_load_dword v135, v133, s[76:79], s65 offen
buffer_load_dword v135, v133, s[76:79], s66 offen
buffer_load_dword v135, v134, s[76:79], s65 offen
buffer_load_dword v135, v134, s[76:79], s66 offen
s_waitcnt vmcnt(1)
s_branch L_as_C_next
L_as_C_idle:
s_sleep 4
L_as_C_next:
s_add_u32 s64, s64, 1
s_cmp_lt_u32 s64, 96
s_cbranch_scc1 L_as_C
L_as_C_x:
s_mov_b64 exec, -1
s_waitcnt vmcnt(0)
L_C_noas:
s_cmp_lg_u32 s34, 0
s_cbranch_scc1 L_C_done
s_mov_b32 exec_hi, 0
buffer_store_dwordx4 v[192:195], v240, s[44:47], 0 offen sc1
s_mov_b64 exec, -1
s_cmp_ge_u32 s32, 8
s_cbranch_scc1 L_C_done
s_and_b32 s63, s32, 7
s_mul_i32 s63, s63, 0x100
s_add_u32 s63, s63, 0xc0000
s_add_u32 s56, s30, s63
s_addc_u32 s57, s31, 0
s_mov_b32 s64, 0
s_mov_b32 s59, 0
s_mov_b32 s58, 0
s_lshl_b32 s62, s32, 12
s_add_u32 s62, s62, 0xd0000
v_lshl_add_u32 v132, v1, 4, s62
v_lshrrev_b32 v133, 2, v1
s_mov_b32 s62, 0xd0000
v_lshl_add_u32 v133, v133, 12, s62
v_and_b32 v134, 3, v1
v_lshlrev_b32 v136, 2, v1
v_mov_b32 v139, 0
L_gm_C:
s_mov_b32 exec_lo, -1
s_mov_b32 exec_hi, 0
v_add_u32 v135, s58, v134
v_and_b32 v135, 15, v135
v_lshl_add_u32 v135, v135, 8, v133
global_load_dword v138, v135, s[30:31] sc1
s_mov_b64 exec, 0x1ffffff
global_load_dword v137, v136, s[56:57] nt
s_waitcnt vmcnt(0)
v_subrev_u32 v137, s88, v137
s_mov_b64 exec, 0xffffff
v_cmp_le_u32 vcc, 0x400, v137
v_readlane_b32 s62, v137, 24
v_add_u32_dpp v137, v137, v137 row_shr:1 row_mask:0xf bank_mask:0xf bound_ctrl:0
s_nop 1
v_add_u32_dpp v137, v137, v137 row_shr:2 row_mask:0xf bank_mask:0xf bound_ctrl:0
s_nop 1
v_add_u32_dpp v137, v137, v137 row_shr:4 row_mask:0xf bank_mask:0xf bound_ctrl:0
s_nop 1
v_add_u32_dpp v137, v137, v137 row_shr:8 row_mask:0xf bank_mask:0xf bound_ctrl:0
s_nop 0
v_readlane_b32 s61, v137, 15
v_readlane_b32 s63, v137, 23
s_add_u32 s61, s61, s63
s_mov_b64 exec, 0xff
s_cbranch_vccnz L_gm_C_x
s_add_u32 s63, s61, s88
v_mov_b32 v128, s63
v_mov_b32 v129, s63
v_mov_b32 v130, s63
v_mov_b32 v131, s63
s_lshr_b32 s58, s61, 9
s_and_b32 s63, s58, 15
s_lshl_b32 s63, s63, 8
v_add_u32 v135, s63, v132
s_sub_u32 s58, s58, 2
global_store_dwordx4 v135, v[128:131], s[30:31] sc1
s_mul_i32 s63, s61, 0
s_mul_i32 s65, s59, 8
s_add_u32 s65, s65, s63
s_cmp_eq_u32 s59, 0
s_mov_b32 s59, s61
s_cbranch_scc1 L_gm_C_next
s_mov_b32 exec_lo, -1
v_subrev_u32 v138, s88, v138
v_cmp_gt_u32 vcc, 0x8000, v138
s_nop 1
v_cndmask_b32 v138, 0, v138, vcc
v_max_u32 v139, v139, v138
s_nop 1
v_max_u32_dpp v139, v139, v139 quad_perm:[1,0,3,2] row_mask:0xf bank_mask:0xf
s_nop 1
v_max_u32_dpp v139, v139, v139 quad_perm:[2,3,0,1] row_mask:0xf bank_mask:0xf
v_cmp_eq_u32 vcc, 0, v139
s_nop 0
v_add_u32_dpp v138, v139, v139 row_shr:4 row_mask:0xf bank_mask:0xf bound_ctrl:0
s_nop 1
v_add_u32_dpp v138, v138, v138 row_shr:8 row_mask:0xf bank_mask:0xf bound_ctrl:0
s_cbranch_vccnz L_gm_C_next
s_nop 0
v_readlane_b32 s63, v138, 15
v_readlane_b32 s62, v138, 31
s_add_u32 s63, s63, s62
s_sub_u32 s63, s63, s65
s_ashr_i32 s63, s63, 3
s_add_u32 s63, s63, 0x4000
s_add_u32 s63, s63, s88
s_mov_b64 exec, 0x1000000
v_mov_b32 v140, s63
global_store_dword v136, v140, s[56:57]
L_gm_C_next:
s_cmp_ge_u32 s61, 14400
s_cbranch_scc1 L_gm_C_x
s_add_u32 s64, s64, 1
s_cmp_lt_u32 s64, 128
s_cbranch_scc1 L_gm_C
L_gm_C_x:
s_mov_b64 exec, -1
L_C_done:
s_endpgm
L_exit:
s_endpgm
.section .rodata,"a"
.p2align 6
.amdhsa_kernel concat_heads__gqa_block_cached__compressed_kv_cla__decode_kernel
  .amdhsa_next_free_vgpr 256
  .amdhsa_next_free_sgpr 102
  .amdhsa_accum_offset 256
  .amdhsa_group_segment_fixed_size 0
  .amdhsa_kernarg_size 112
  .amdhsa_user_sgpr_count 2
  .amdhsa_user_sgpr_kernarg_segment_ptr 1
  .amdhsa_system_sgpr_workgroup_id_x 1
.end_amdhsa_kernel
```

```asm
; @launch grid=(256,1,1) block=(512,1,1) lds=153600
.amdgcn_target "amdgcn-amd-amdhsa--gfx950"
.text
.globl concat_heads__gqa_block_cached__compressed_kv_cla__decode_kernel
.p2align 8
.type concat_heads__gqa_block_cached__compressed_kv_cla__decode_kernel,@function
concat_heads__gqa_block_cached__compressed_kv_cla__decode_kernel:
s_lshr_b32 s60, s2, 8
s_cbranch_scc1 L_exit
s_load_dwordx16 s[4:19], s[0:1], 0
s_load_dwordx8 s[20:27], s[0:1], 64
s_load_dwordx4 s[28:31], s[0:1], 96
v_readfirstlane_b32 s34, v0
s_and_b32 s60, s2, 7
s_lshr_b32 s61, s2, 6
s_lshl3_add_u32 s32, s61, s60
s_lshr_b32 s33, s2, 3
s_and_b32 s33, s33, 7
s_lshr_b32 s34, s34, 6
s_cmp_eq_u32 s33, 6
s_cbranch_scc1 L_roleW
s_cmp_eq_u32 s33, 7
s_cbranch_scc1 L_roleC
L_roleA:
s_cmp_ge_u32 s34, 4
s_cbranch_scc1 L_A_helper
v_and_b32 v2, 15, v0
v_lshrrev_b32 v24, 4, v0
v_lshlrev_b32 v61, 4, v2
v_lshl_add_u32 v61, v24, 13, v61
s_lshl_b32 s60, s32, 8
s_sub_u32 s70, 0x400000, s60
s_mov_b32 s71, 0x20000
s_mov_b64 s[74:75], s[70:71]
s_lshl_b32 s39, s33, 19
s_waitcnt lgkmcnt(0)
s_add_u32 s68, s18, s60
s_addc_u32 s69, s19, 0
s_pack_ll_b32_b16 s69, s69, 0
buffer_load_dwordx4 v[128:131], v61, s[68:71], s39 offen
s_add_u32 s39, s39, s71
buffer_load_dwordx4 v[132:135], v61, s[68:71], s39 offen
s_add_u32 s39, s39, s71
buffer_load_dwordx4 v[136:139], v61, s[68:71], s39 offen
s_add_u32 s39, s39, s71
buffer_load_dwordx4 v[140:143], v61, s[68:71], s39 offen
s_add_u32 s72, s20, s60
s_addc_u32 s73, s21, 0
s_pack_ll_b32_b16 s73, s73, 0
s_xor_b32 s39, s39, 0x100000
buffer_load_dwordx4 v[144:147], v61, s[72:75], s39 offen
s_sub_u32 s39, s39, s71
buffer_load_dwordx4 v[148:151], v61, s[72:75], s39 offen
s_sub_u32 s39, s39, s71
buffer_load_dwordx4 v[152:155], v61, s[72:75], s39 offen
s_sub_u32 s39, s39, s71
buffer_load_dwordx4 v[156:159], v61, s[72:75], s39 offen
s_mov_b32 s89, s32
v_and_b32 v1, 63, v0
v_and_b32 v2, 15, v0
v_bfe_u32 v3, v0, 4, 2
v_bfe_u32 v24, v0, 3, 2
v_mad_i32_i24 v24, v24, -2, s33
v_add_u32 v25, 6, v24
v_min_u32 v24, v24, v25
v_min_u32 v25, 2, v24
v_mad_u32_u24 v24, v24, 5, v25
v_and_b32 v63, 7, v0
v_add_u32 v24, v24, v63
v_lshrrev_b32 v62, 1, v24
v_add_u32 v25, v25, v63
v_xor_b32 v62, v62, v24
v_cmp_gt_u32 vcc, 7, v25
v_and_b32 v62, 4, v62
v_mul_u32_u24 v62, 3, v62
v_xor_b32 v62, v62, v24
v_cndmask_b32 v62, 32, v62, vcc
v_lshlrev_b32 v62, 17, v62
s_add_u32 s39, s33, 24
s_lshl_b32 s39, s39, 17
s_waitcnt vmcnt(7)
buffer_load_dwordx4 v[128:131], v61, s[68:71], s39 offen
s_add_u32 s39, s33, 30
s_lshl_b32 s39, s39, 17
s_waitcnt vmcnt(7)
buffer_load_dwordx4 v[132:135], v61, s[68:71], s39 offen
s_add_u32 s39, s33, 16
s_lshl_b32 s39, s39, 17
s_waitcnt vmcnt(7)
buffer_load_dwordx4 v[136:139], v61, s[72:75], s39 offen
s_add_u32 s39, s33, 20
s_sub_u32 s60, s33, 2
s_cmp_lt_u32 s60, 2
s_cselect_b32 s39, s39, 32
s_lshl_b32 s39, s39, 17
s_waitcnt vmcnt(7)
buffer_load_dwordx4 v[140:143], v61, s[72:75], s39 offen
s_barrier
s_lshl_b32 s60, s89, 8
s_sub_u32 s61, 0x400000, s60
s_add_u32 s76, s10, s60
s_addc_u32 s77, s11, 0
s_and_b32 s77, s77, 0xffff
s_mov_b32 s78, s61
s_mov_b32 s79, 0x20000
v_readlane_b32 s39, v62, 16
s_nop 3
s_waitcnt vmcnt(7)
buffer_load_dwordx4 v[144:147], v61, s[76:79], s39 offen
v_readlane_b32 s39, v62, 17
s_nop 3
s_waitcnt vmcnt(7)
buffer_load_dwordx4 v[148:151], v61, s[76:79], s39 offen
v_readlane_b32 s39, v62, 18
s_nop 3
s_waitcnt vmcnt(7)
buffer_load_dwordx4 v[152:155], v61, s[76:79], s39 offen
v_readlane_b32 s39, v62, 19
s_nop 3
s_waitcnt vmcnt(7)
buffer_load_dwordx4 v[156:159], v61, s[76:79], s39 offen
v_readlane_b32 s39, v62, 20
s_nop 3
s_waitcnt vmcnt(7)
buffer_load_dwordx4 v[128:131], v61, s[76:79], s39 offen
v_readlane_b32 s39, v62, 21
s_nop 3
s_waitcnt vmcnt(7)
buffer_load_dwordx4 v[132:135], v61, s[76:79], s39 offen
s_lshl_b32 s35, s33, 2
s_add_u32 s35, s35, s34
s_lshl_b32 s35, s35, 12
s_mov_b32 s36, s35
v_lshlrev_b32 v8, 4, v1
v_add_u32 v9, 0x4000000, v8
s_lshr_b32 s54, s35, 12
s_mov_b32 s57, 0xff
s_sub_u32 s55, s54, 8
s_cselect_b32 s60, 24, 0
s_add_u32 s55, s55, s60
s_sub_u32 s56, s55, 8
s_cselect_b32 s60, 24, 0
s_add_u32 s56, s56, s60
s_lshl_b32 s60, s89, 8
s_sub_u32 s61, 0x400000, s60
s_add_u32 s80, s22, s60
s_addc_u32 s81, s23, 0
s_and_b32 s81, s81, 0xffff
s_mov_b32 s82, s61
s_mov_b32 s83, 0x20000
v_readlane_b32 s39, v62, 0
s_nop 3
s_waitcnt vmcnt(7)
buffer_load_dwordx4 v[136:139], v61, s[80:83], s39 offen
v_readlane_b32 s39, v62, 1
s_nop 3
s_waitcnt vmcnt(7)
buffer_load_dwordx4 v[140:143], v61, s[80:83], s39 offen
v_readlane_b32 s39, v62, 2
s_nop 3
s_waitcnt vmcnt(7)
buffer_load_dwordx4 v[144:147], v61, s[80:83], s39 offen
v_readlane_b32 s39, v62, 3
s_nop 3
s_waitcnt vmcnt(7)
buffer_load_dwordx4 v[148:151], v61, s[80:83], s39 offen
v_and_b32 v24, 1, v0
v_lshlrev_b32 v24, 4, v24
v_mov_b32 v25, 0xffff
v_lshlrev_b32 v24, v24, v25
v_bfe_u32 v25, v0, 1, 2
v_cmp_eq_u32 vcc, 0, v25
s_nop 1
v_cndmask_b32 v4, 0, v24, vcc
v_cmp_eq_u32 vcc, 1, v25
s_nop 1
v_cndmask_b32 v5, 0, v24, vcc
v_cmp_eq_u32 vcc, 2, v25
s_nop 1
v_cndmask_b32 v6, 0, v24, vcc
v_cmp_eq_u32 vcc, 3, v25
s_nop 1
v_cndmask_b32 v7, 0, v24, vcc
v_readlane_b32 s39, v62, 4
s_nop 3
s_waitcnt vmcnt(7)
buffer_load_dwordx4 v[152:155], v61, s[80:83], s39 offen
v_readlane_b32 s39, v62, 5
s_nop 3
s_waitcnt vmcnt(7)
buffer_load_dwordx4 v[156:159], v61, s[80:83], s39 offen
s_lshl_b32 s60, s89, 17
s_mov_b32 s61, 0x20000
s_add_u32 s68, s24, s60
s_addc_u32 s69, s25, 0
s_and_b32 s69, s69, 0xffff
s_mov_b32 s70, s61
s_mov_b32 s71, 0x20000
s_lshr_b32 s58, s55, 2
s_min_u32 s60, s58, 2
s_mul_i32 s59, s58, 5
s_add_u32 s59, s59, s60
s_lshl_b32 s59, s59, 2
s_add_u32 s59, s59, s34
s_lshl_b32 s39, s59, 10
s_waitcnt vmcnt(7)
buffer_load_dwordx4 v[128:131], v8, s[68:71], s39 offen
s_add_u32 s59, s59, 4
s_lshl_b32 s39, s59, 10
s_waitcnt vmcnt(7)
buffer_load_dwordx4 v[132:135], v8, s[68:71], s39 offen
s_lshl_b32 s62, s89, 21
s_sub_u32 s63, 0x8000000, s62
s_add_u32 s40, s6, s62
s_addc_u32 s41, s7, 0
s_and_b32 s41, s41, 0xffff
s_mov_b32 s42, s63
s_mov_b32 s43, 0x20000
s_add_u32 s44, s8, s62
s_addc_u32 s45, s9, 0
s_and_b32 s45, s45, 0xffff
s_mov_b32 s46, s63
s_mov_b32 s47, 0x20000
s_add_u32 s59, s59, 4
s_lshl_b32 s39, s59, 10
s_waitcnt vmcnt(7)
buffer_load_dwordx4 v[136:139], v8, s[68:71], s39 offen
s_add_u32 s59, s59, 4
s_lshl_b32 s39, s59, 10
s_waitcnt vmcnt(7)
buffer_load_dwordx4 v[140:143], v8, s[68:71], s39 offen
s_add_u32 s59, s59, 4
s_lshl_b32 s39, s59, 10
s_waitcnt vmcnt(7)
buffer_load_dwordx4 v[144:147], v8, s[68:71], s39 offen
s_add_u32 s59, s59, 4
s_cmp_lt_u32 s58, 2
s_cselect_b32 s59, s59, 128
s_lshl_b32 s39, s59, 10
s_waitcnt vmcnt(7)
buffer_load_dwordx4 v[148:151], v8, s[68:71], s39 offen
s_mul_i32 s60, s34, 6
s_add_u32 s60, s60, s33
s_lshl_b32 s37, s60, 10
s_add_u32 s37, s37, 0x1f8000
s_mov_b32 s52, 0x555f
s_cmp_lt_u32 s60, 8
s_cselect_b32 s61, 0, 1
s_cselect_b32 s62, 0x200, 0
s_or_b32 s52, s52, s62
s_lshl_b32 s61, s61, 31
s_add_u32 s61, s61, 24576
v_add_u32 v10, s61, v8
s_sub_u32 s60, s60, 8
s_cmp_lt_u32 s60, 8
s_cselect_b32 s61, 0, 1
s_cselect_b32 s62, 0x800, 0
s_or_b32 s52, s52, s62
s_lshl_b32 s61, s61, 31
s_add_u32 s61, s61, 16384
v_add_u32 v11, s61, v9
s_mul_i32 s52, s52, 0x10001
s_mov_b32 s53, s52
s_lshl_b32 s60, s32, 19
s_add_u32 s60, s60, 0x30000
s_mov_b32 s61, 0x50000
s_add_u32 s72, s16, s60
s_addc_u32 s73, s17, 0
s_and_b32 s73, s73, 0xffff
s_mov_b32 s74, s61
s_mov_b32 s75, 0x20000
s_lshr_b32 s58, s56, 2
s_min_u32 s60, s58, 2
s_mul_i32 s59, s58, 13
s_add_u32 s59, s59, s60
s_lshl_b32 s59, s59, 2
s_add_u32 s59, s59, s34
s_lshl_b32 s39, s59, 10
s_waitcnt vmcnt(7)
buffer_load_dwordx4 v[152:155], v8, s[72:75], s39 offen
s_add_u32 s59, s59, 4
s_lshl_b32 s39, s59, 10
s_waitcnt vmcnt(7)
buffer_load_dwordx4 v[156:159], v8, s[72:75], s39 offen
s_add_u32 s59, s59, 4
s_lshl_b32 s39, s59, 10
s_waitcnt vmcnt(7)
buffer_load_dwordx4 v[128:131], v8, s[72:75], s39 offen
s_add_u32 s59, s59, 4
s_lshl_b32 s39, s59, 10
s_waitcnt vmcnt(7)
buffer_load_dwordx4 v[132:135], v8, s[72:75], s39 offen
s_mov_b32 s48, 0xcccccccc
s_mov_b32 s49, 0xcccccccc
s_mov_b32 s50, 0xaaaaaaaa
s_mov_b32 s51, 0xaaaaaaaa
v_cmp_gt_u32 vcc, 8, v2
v_mov_b32 v47, 0
v_mov_b32 v48, 0
v_mov_b32 v49, 0
v_mov_b32 v50, 0
v_mov_b32 v51, 0
v_cndmask_b32 v12, v4, v47, vcc
v_cndmask_b32 v13, v5, v47, vcc
v_cndmask_b32 v14, v6, v47, vcc
v_cndmask_b32 v15, v7, v47, vcc
v_cndmask_b32 v4, v47, v4, vcc
v_cndmask_b32 v5, v47, v5, vcc
v_cndmask_b32 v6, v47, v6, vcc
v_cndmask_b32 v7, v47, v7, vcc
v_lshlrev_b32 v192, 2, v1
v_mov_b32 v193, 1
s_mov_b64 vcc, 0
s_add_u32 s59, s59, 4
s_lshl_b32 s39, s59, 10
s_waitcnt vmcnt(7)
buffer_load_dwordx4 v[136:139], v8, s[72:75], s39 offen
s_add_u32 s59, s59, 4
s_lshl_b32 s39, s59, 10
s_waitcnt vmcnt(7)
buffer_load_dwordx4 v[140:143], v8, s[72:75], s39 offen
s_add_u32 s59, s59, 4
s_lshl_b32 s39, s59, 10
s_waitcnt vmcnt(7)
buffer_load_dwordx4 v[144:147], v8, s[72:75], s39 offen
s_add_u32 s59, s59, 4
s_lshl_b32 s39, s59, 10
s_waitcnt vmcnt(7)
buffer_load_dwordx4 v[148:151], v8, s[72:75], s39 offen
s_add_u32 s59, s59, 4
s_lshl_b32 s39, s59, 10
s_waitcnt vmcnt(7)
buffer_load_dwordx4 v[152:155], v8, s[72:75], s39 offen
s_add_u32 s59, s59, 4
s_lshl_b32 s39, s59, 10
s_waitcnt vmcnt(7)
buffer_load_dwordx4 v[156:159], v8, s[72:75], s39 offen
s_add_u32 s59, s59, 4
s_lshl_b32 s39, s59, 10
s_waitcnt vmcnt(7)
buffer_load_dwordx4 v[128:131], v8, s[72:75], s39 offen
s_add_u32 s59, s59, 4
s_lshl_b32 s39, s59, 10
s_waitcnt vmcnt(7)
buffer_load_dwordx4 v[132:135], v8, s[72:75], s39 offen
s_add_u32 s59, s59, 4
s_lshl_b32 s39, s59, 10
s_waitcnt vmcnt(7)
buffer_load_dwordx4 v[136:139], v8, s[72:75], s39 offen
s_add_u32 s59, s59, 4
s_cmp_lt_u32 s58, 2
s_cselect_b32 s59, s59, 320
s_lshl_b32 s39, s59, 10
s_waitcnt vmcnt(7)
buffer_load_dwordx4 v[140:143], v8, s[72:75], s39 offen
s_waitcnt vmcnt(7)
buffer_load_dwordx4 v[64:67], v8, s[40:43], s36 offen offset:0 nt
s_waitcnt vmcnt(7)
buffer_load_dwordx4 v[68:71], v8, s[40:43], s36 offen offset:1024 nt
s_waitcnt vmcnt(7)
buffer_load_dwordx4 v[72:75], v8, s[40:43], s36 offen offset:2048 nt
s_waitcnt vmcnt(7)
buffer_load_dwordx4 v[76:79], v8, s[40:43], s36 offen offset:3072 nt
s_waitcnt vmcnt(7)
buffer_load_dwordx4 v[80:83], v9, s[40:43], s36 offen offset:0 nt
s_waitcnt vmcnt(7)
buffer_load_dwordx4 v[84:87], v9, s[40:43], s36 offen offset:1024 nt
s_waitcnt vmcnt(7)
buffer_load_dwordx4 v[88:91], v9, s[40:43], s36 offen offset:2048 nt
s_waitcnt vmcnt(7)
buffer_load_dwordx4 v[92:95], v9, s[40:43], s36 offen offset:3072 nt
s_add_u32 s36, s36, 0x18000
s_waitcnt vmcnt(7)
buffer_load_dwordx4 v[96:99], v8, s[40:43], s36 offen offset:0 nt
s_waitcnt vmcnt(7)
buffer_load_dwordx4 v[100:103], v8, s[40:43], s36 offen offset:1024 nt
ds_add_u32 v192, v193 offset:256
s_waitcnt vmcnt(7)
buffer_load_dwordx4 v[104:107], v8, s[40:43], s36 offen offset:2048 nt
s_waitcnt vmcnt(7)
buffer_load_dwordx4 v[108:111], v8, s[40:43], s36 offen offset:3072 nt
ds_add_u32 v192, v193 offset:256
s_waitcnt vmcnt(7)
buffer_load_dwordx4 v[112:115], v9, s[40:43], s36 offen offset:0 nt
s_waitcnt vmcnt(7)
buffer_load_dwordx4 v[116:119], v9, s[40:43], s36 offen offset:1024 nt
ds_add_u32 v192, v193 offset:256
s_waitcnt vmcnt(7)
buffer_load_dwordx4 v[120:123], v9, s[40:43], s36 offen offset:2048 nt
s_waitcnt vmcnt(7)
buffer_load_dwordx4 v[124:127], v9, s[40:43], s36 offen offset:3072 nt
ds_add_u32 v192, v193 offset:256
s_add_u32 s36, s36, 0x18000
s_waitcnt vmcnt(7)
buffer_load_dwordx4 v[128:131], v8, s[40:43], s36 offen offset:0 nt
s_waitcnt vmcnt(7)
buffer_load_dwordx4 v[132:135], v8, s[40:43], s36 offen offset:1024 nt
ds_add_u32 v192, v193 offset:256
s_waitcnt vmcnt(7)
buffer_load_dwordx4 v[136:139], v8, s[40:43], s36 offen offset:2048 nt
s_waitcnt vmcnt(7)
buffer_load_dwordx4 v[140:143], v8, s[40:43], s36 offen offset:3072 nt
ds_add_u32 v192, v193 offset:256
s_waitcnt vmcnt(7)
buffer_load_dwordx4 v[144:147], v9, s[40:43], s36 offen offset:0 nt
s_waitcnt vmcnt(7)
buffer_load_dwordx4 v[148:151], v9, s[40:43], s36 offen offset:1024 nt
ds_add_u32 v192, v193 offset:256
s_waitcnt vmcnt(7)
buffer_load_dwordx4 v[152:155], v9, s[40:43], s36 offen offset:2048 nt
s_waitcnt vmcnt(7)
buffer_load_dwordx4 v[156:159], v9, s[40:43], s36 offen offset:3072 nt
ds_add_u32 v192, v193 offset:256
s_add_u32 s36, s36, 0x18000
s_waitcnt vmcnt(7)
buffer_load_dwordx4 v[160:163], v8, s[40:43], s36 offen offset:0 nt
s_waitcnt vmcnt(7)
buffer_load_dwordx4 v[164:167], v8, s[40:43], s36 offen offset:1024 nt
ds_add_u32 v192, v193 offset:256
s_waitcnt vmcnt(7)
buffer_load_dwordx4 v[168:171], v8, s[40:43], s36 offen offset:2048 nt
s_waitcnt vmcnt(7)
buffer_load_dwordx4 v[172:175], v8, s[40:43], s36 offen offset:3072 nt
ds_add_u32 v192, v193 offset:256
s_waitcnt vmcnt(7)
buffer_load_dwordx4 v[176:179], v9, s[40:43], s36 offen offset:0 nt
s_waitcnt vmcnt(7)
buffer_load_dwordx4 v[180:183], v9, s[40:43], s36 offen offset:1024 nt
ds_add_u32 v192, v193 offset:256
s_waitcnt vmcnt(7)
buffer_load_dwordx4 v[184:187], v9, s[40:43], s36 offen offset:2048 nt
s_waitcnt vmcnt(7)
buffer_load_dwordx4 v[188:191], v9, s[40:43], s36 offen offset:3072 nt
ds_add_u32 v192, v193 offset:256
v_lshlrev_b32 v61, 4, v2
s_mov_b32 s64, 0
L_A_qw:
ds_read_b32 v60, v47 offset:0
s_waitcnt lgkmcnt(0)
v_readfirstlane_b32 s65, v60
s_add_u32 s64, s64, 1
s_nop 2
s_cmp_ge_u32 s65, 1
s_cbranch_scc1 L_A_qw_ok
s_sleep 1
s_cmp_lt_u32 s64, 1048576
s_cbranch_scc1 L_A_qw
L_A_qw_ok:
v_lshlrev_b32 v60, 5, v2
ds_read_b128 v[16:19], v61 offset:1024
ds_read_b128 v[20:23], v61 offset:1280
s_waitcnt lgkmcnt(0)
v_dot2_f32_bf16 v24, v64, v16, 0
v_dot2_f32_bf16 v24, v65, v17, v24
v_dot2_f32_bf16 v24, v66, v18, v24
v_dot2_f32_bf16 v24, v67, v19, v24
s_waitcnt vmcnt(6)
s_add_u32 s36, s36, 0x18000
buffer_load_dwordx4 v[64:67], v8, s[40:43], s36 offen offset:0 nt
v_dot2_f32_bf16 v25, v68, v16, 0
v_dot2_f32_bf16 v25, v69, v17, v25
v_dot2_f32_bf16 v25, v70, v18, v25
v_dot2_f32_bf16 v25, v71, v19, v25
s_waitcnt vmcnt(6)
buffer_load_dwordx4 v[68:71], v8, s[40:43], s36 offen offset:1024 nt
ds_add_u32 v192, v193 offset:256
v_add_f32_dpp v28, v24, v24 row_ror:8 row_mask:0xf bank_mask:0x3
v_dot2_f32_bf16 v26, v72, v16, 0
v_dot2_f32_bf16 v26, v73, v17, v26
v_dot2_f32_bf16 v26, v74, v18, v26
v_dot2_f32_bf16 v26, v75, v19, v26
v_add_f32_dpp v28, v25, v25 row_ror:8 row_mask:0xf bank_mask:0xc
s_waitcnt vmcnt(6)
buffer_load_dwordx4 v[72:75], v8, s[40:43], s36 offen offset:2048 nt
v_dot2_f32_bf16 v27, v76, v16, 0
v_dot2_f32_bf16 v27, v77, v17, v27
v_dot2_f32_bf16 v27, v78, v18, v27
v_dot2_f32_bf16 v27, v79, v19, v27
s_waitcnt vmcnt(6)
buffer_load_dwordx4 v[76:79], v8, s[40:43], s36 offen offset:3072 nt
ds_add_u32 v192, v193 offset:256
v_add_f32_dpp v29, v26, v26 row_ror:8 row_mask:0xf bank_mask:0x3
v_dot2_f32_bf16 v24, v80, v20, 0
v_dot2_f32_bf16 v24, v81, v21, v24
v_dot2_f32_bf16 v24, v82, v22, v24
v_dot2_f32_bf16 v24, v83, v23, v24
v_add_f32_dpp v29, v27, v27 row_ror:8 row_mask:0xf bank_mask:0xc
s_waitcnt vmcnt(6)
buffer_load_dwordx4 v[80:83], v9, s[40:43], s36 offen offset:0 nt
v_add_f32_dpp v30, v28, v28 row_shl:4 row_mask:0xf bank_mask:0x5
v_dot2_f32_bf16 v25, v84, v20, 0
v_dot2_f32_bf16 v25, v85, v21, v25
v_dot2_f32_bf16 v25, v86, v22, v25
v_dot2_f32_bf16 v25, v87, v23, v25
v_add_f32_dpp v30, v29, v29 row_shr:4 row_mask:0xf bank_mask:0xa
s_waitcnt vmcnt(6)
buffer_load_dwordx4 v[84:87], v9, s[40:43], s36 offen offset:1024 nt
ds_add_u32 v192, v193 offset:256
v_add_f32_dpp v28, v24, v24 row_ror:8 row_mask:0xf bank_mask:0x3
v_dot2_f32_bf16 v26, v88, v20, 0
v_dot2_f32_bf16 v26, v89, v21, v26
v_dot2_f32_bf16 v26, v90, v22, v26
v_dot2_f32_bf16 v26, v91, v23, v26
v_add_f32_dpp v28, v25, v25 row_ror:8 row_mask:0xf bank_mask:0xc
s_waitcnt vmcnt(6)
buffer_load_dwordx4 v[88:91], v9, s[40:43], s36 offen offset:2048 nt
v_dot2_f32_bf16 v27, v92, v20, 0
v_dot2_f32_bf16 v27, v93, v21, v27
v_dot2_f32_bf16 v27, v94, v22, v27
v_dot2_f32_bf16 v27, v95, v23, v27
v_add_f32_dpp v29, v26, v26 row_ror:8 row_mask:0xf bank_mask:0x3
v_dot2_f32_bf16 v24, v96, v16, 0
v_dot2_f32_bf16 v24, v97, v17, v24
v_dot2_f32_bf16 v24, v98, v18, v24
v_dot2_f32_bf16 v24, v99, v19, v24
v_add_f32_dpp v29, v27, v27 row_ror:8 row_mask:0xf bank_mask:0xc
v_add_f32_dpp v31, v28, v28 row_shl:4 row_mask:0xf bank_mask:0x5
v_dot2_f32_bf16 v25, v100, v16, 0
v_dot2_f32_bf16 v25, v101, v17, v25
v_dot2_f32_bf16 v25, v102, v18, v25
v_dot2_f32_bf16 v25, v103, v19, v25
v_add_f32_dpp v31, v29, v29 row_shr:4 row_mask:0xf bank_mask:0xa
s_waitcnt vmcnt(6)
buffer_load_dwordx4 v[92:95], v9, s[40:43], s36 offen offset:3072 nt
ds_add_u32 v192, v193 offset:256
v_add_f32_dpp v34, v30, v30 quad_perm:[2,3,0,1] row_mask:0xf bank_mask:0xf
v_add_f32_dpp v28, v24, v24 row_ror:8 row_mask:0xf bank_mask:0x3
v_dot2_f32_bf16 v26, v104, v16, 0
v_dot2_f32_bf16 v26, v105, v17, v26
v_dot2_f32_bf16 v26, v106, v18, v26
v_dot2_f32_bf16 v26, v107, v19, v26
v_add_f32_dpp v35, v31, v31 quad_perm:[2,3,0,1] row_mask:0xf bank_mask:0xf
v_cndmask_b32 v32, v34, v35, s[48:49]
v_add_f32_dpp v28, v25, v25 row_ror:8 row_mask:0xf bank_mask:0xc
v_dot2_f32_bf16 v27, v108, v16, 0
v_dot2_f32_bf16 v27, v109, v17, v27
v_dot2_f32_bf16 v27, v110, v18, v27
v_dot2_f32_bf16 v27, v111, v19, v27
v_add_f32_dpp v29, v26, v26 row_ror:8 row_mask:0xf bank_mask:0x3
v_dot2_f32_bf16 v24, v112, v20, 0
v_dot2_f32_bf16 v24, v113, v21, v24
v_dot2_f32_bf16 v24, v114, v22, v24
v_dot2_f32_bf16 v24, v115, v23, v24
v_add_f32_dpp v29, v27, v27 row_ror:8 row_mask:0xf bank_mask:0xc
s_waitcnt vmcnt(6)
s_add_u32 s36, s36, 0x18000
buffer_load_dwordx4 v[96:99], v8, s[40:43], s36 offen offset:0 nt
v_add_f32_dpp v30, v28, v28 row_shl:4 row_mask:0xf bank_mask:0x5
v_dot2_f32_bf16 v25, v116, v20, 0
v_dot2_f32_bf16 v25, v117, v21, v25
v_dot2_f32_bf16 v25, v118, v22, v25
v_dot2_f32_bf16 v25, v119, v23, v25
v_add_f32_dpp v30, v29, v29 row_shr:4 row_mask:0xf bank_mask:0xa
v_add_f32_dpp v28, v24, v24 row_ror:8 row_mask:0xf bank_mask:0x3
v_dot2_f32_bf16 v26, v120, v20, 0
v_dot2_f32_bf16 v26, v121, v21, v26
v_dot2_f32_bf16 v26, v122, v22, v26
v_dot2_f32_bf16 v26, v123, v23, v26
v_add_f32_dpp v28, v25, v25 row_ror:8 row_mask:0xf bank_mask:0xc
v_dot2_f32_bf16 v27, v124, v20, 0
v_dot2_f32_bf16 v27, v125, v21, v27
v_dot2_f32_bf16 v27, v126, v22, v27
v_dot2_f32_bf16 v27, v127, v23, v27
s_waitcnt vmcnt(6)
buffer_load_dwordx4 v[100:103], v8, s[40:43], s36 offen offset:1024 nt
ds_add_u32 v192, v193 offset:256
v_add_f32_dpp v29, v26, v26 row_ror:8 row_mask:0xf bank_mask:0x3
v_dot2_f32_bf16 v24, v128, v16, 0
v_dot2_f32_bf16 v24, v129, v17, v24
v_dot2_f32_bf16 v24, v130, v18, v24
v_dot2_f32_bf16 v24, v131, v19, v24
v_add_f32_dpp v29, v27, v27 row_ror:8 row_mask:0xf bank_mask:0xc
v_add_f32_dpp v31, v28, v28 row_shl:4 row_mask:0xf bank_mask:0x5
v_dot2_f32_bf16 v25, v132, v16, 0
v_dot2_f32_bf16 v25, v133, v17, v25
v_dot2_f32_bf16 v25, v134, v18, v25
v_dot2_f32_bf16 v25, v135, v19, v25
v_add_f32_dpp v31, v29, v29 row_shr:4 row_mask:0xf bank_mask:0xa
v_add_f32_dpp v34, v30, v30 quad_perm:[2,3,0,1] row_mask:0xf bank_mask:0xf
v_add_f32_dpp v28, v24, v24 row_ror:8 row_mask:0xf bank_mask:0x3
v_dot2_f32_bf16 v26, v136, v16, 0
v_dot2_f32_bf16 v26, v137, v17, v26
v_dot2_f32_bf16 v26, v138, v18, v26
v_dot2_f32_bf16 v26, v139, v19, v26
v_add_f32_dpp v35, v31, v31 quad_perm:[2,3,0,1] row_mask:0xf bank_mask:0xf
v_cndmask_b32 v33, v34, v35, s[48:49]
v_add_f32_dpp v28, v25, v25 row_ror:8 row_mask:0xf bank_mask:0xc
s_waitcnt vmcnt(6)
buffer_load_dwordx4 v[104:107], v8, s[40:43], s36 offen offset:2048 nt
v_add_f32_dpp v34, v32, v32 quad_perm:[1,0,3,2] row_mask:0xf bank_mask:0xf
v_mov_b32 v36, v37
v_mov_b32 v37, v38
v_mov_b32 v38, v39
v_mov_b32 v39, v40
v_mov_b32 v40, v41
v_mov_b32 v41, v42
v_mov_b32 v42, v43
v_mov_b32 v43, v44
v_mov_b32 v44, v45
v_mov_b32 v45, v46
v_dot2_f32_bf16 v27, v140, v16, 0
v_dot2_f32_bf16 v27, v141, v17, v27
v_dot2_f32_bf16 v27, v142, v18, v27
v_dot2_f32_bf16 v27, v143, v19, v27
v_add_f32_dpp v35, v33, v33 quad_perm:[1,0,3,2] row_mask:0xf bank_mask:0xf
v_cndmask_b32 v46, v34, v35, s[50:51]
v_add_f32_dpp v29, v26, v26 row_ror:8 row_mask:0xf bank_mask:0x3
v_dot2_f32_bf16 v24, v144, v20, 0
v_dot2_f32_bf16 v24, v145, v21, v24
v_dot2_f32_bf16 v24, v146, v22, v24
v_dot2_f32_bf16 v24, v147, v23, v24
v_add_f32_dpp v29, v27, v27 row_ror:8 row_mask:0xf bank_mask:0xc
v_add_f32_dpp v30, v28, v28 row_shl:4 row_mask:0xf bank_mask:0x5
v_dot2_f32_bf16 v25, v148, v20, 0
v_dot2_f32_bf16 v25, v149, v21, v25
v_dot2_f32_bf16 v25, v150, v22, v25
v_dot2_f32_bf16 v25, v151, v23, v25
v_add_f32_dpp v30, v29, v29 row_shr:4 row_mask:0xf bank_mask:0xa
s_waitcnt vmcnt(6)
buffer_load_dwordx4 v[108:111], v8, s[40:43], s36 offen offset:3072 nt
ds_add_u32 v192, v193 offset:256
v_add_f32_dpp v28, v24, v24 row_ror:8 row_mask:0xf bank_mask:0x3
v_dot2_f32_bf16 v26, v152, v20, 0
v_dot2_f32_bf16 v26, v153, v21, v26
v_dot2_f32_bf16 v26, v154, v22, v26
v_dot2_f32_bf16 v26, v155, v23, v26
v_add_f32_dpp v28, v25, v25 row_ror:8 row_mask:0xf bank_mask:0xc
v_dot2_f32_bf16 v27, v156, v20, 0
v_dot2_f32_bf16 v27, v157, v21, v27
v_dot2_f32_bf16 v27, v158, v22, v27
v_dot2_f32_bf16 v27, v159, v23, v27
v_add_f32_dpp v29, v26, v26 row_ror:8 row_mask:0xf bank_mask:0x3
v_dot2_f32_bf16 v24, v160, v16, 0
v_dot2_f32_bf16 v24, v161, v17, v24
v_dot2_f32_bf16 v24, v162, v18, v24
v_dot2_f32_bf16 v24, v163, v19, v24
v_add_f32_dpp v29, v27, v27 row_ror:8 row_mask:0xf bank_mask:0xc
s_waitcnt vmcnt(6)
buffer_load_dwordx4 v[112:115], v9, s[40:43], s36 offen offset:0 nt
v_add_f32_dpp v31, v28, v28 row_shl:4 row_mask:0xf bank_mask:0x5
v_dot2_f32_bf16 v25, v164, v16, 0
v_dot2_f32_bf16 v25, v165, v17, v25
v_dot2_f32_bf16 v25, v166, v18, v25
v_dot2_f32_bf16 v25, v167, v19, v25
v_add_f32_dpp v31, v29, v29 row_shr:4 row_mask:0xf bank_mask:0xa
v_add_f32_dpp v34, v30, v30 quad_perm:[2,3,0,1] row_mask:0xf bank_mask:0xf
v_add_f32_dpp v28, v24, v24 row_ror:8 row_mask:0xf bank_mask:0x3
v_dot2_f32_bf16 v26, v168, v16, 0
v_dot2_f32_bf16 v26, v169, v17, v26
v_dot2_f32_bf16 v26, v170, v18, v26
v_dot2_f32_bf16 v26, v171, v19, v26
v_add_f32_dpp v35, v31, v31 quad_perm:[2,3,0,1] row_mask:0xf bank_mask:0xf
v_cndmask_b32 v32, v34, v35, s[48:49]
v_add_f32_dpp v28, v25, v25 row_ror:8 row_mask:0xf bank_mask:0xc
v_dot2_f32_bf16 v27, v172, v16, 0
v_dot2_f32_bf16 v27, v173, v17, v27
v_dot2_f32_bf16 v27, v174, v18, v27
v_dot2_f32_bf16 v27, v175, v19, v27
s_waitcnt vmcnt(6)
buffer_load_dwordx4 v[116:119], v9, s[40:43], s36 offen offset:1024 nt
ds_add_u32 v192, v193 offset:256
v_add_f32_dpp v29, v26, v26 row_ror:8 row_mask:0xf bank_mask:0x3
v_dot2_f32_bf16 v24, v176, v20, 0
v_dot2_f32_bf16 v24, v177, v21, v24
v_dot2_f32_bf16 v24, v178, v22, v24
v_dot2_f32_bf16 v24, v179, v23, v24
v_add_f32_dpp v29, v27, v27 row_ror:8 row_mask:0xf bank_mask:0xc
v_add_f32_dpp v30, v28, v28 row_shl:4 row_mask:0xf bank_mask:0x5
v_dot2_f32_bf16 v25, v180, v20, 0
v_dot2_f32_bf16 v25, v181, v21, v25
v_dot2_f32_bf16 v25, v182, v22, v25
v_dot2_f32_bf16 v25, v183, v23, v25
v_add_f32_dpp v30, v29, v29 row_shr:4 row_mask:0xf bank_mask:0xa
v_add_f32_dpp v28, v24, v24 row_ror:8 row_mask:0xf bank_mask:0x3
v_dot2_f32_bf16 v26, v184, v20, 0
v_dot2_f32_bf16 v26, v185, v21, v26
v_dot2_f32_bf16 v26, v186, v22, v26
v_dot2_f32_bf16 v26, v187, v23, v26
v_add_f32_dpp v28, v25, v25 row_ror:8 row_mask:0xf bank_mask:0xc
s_waitcnt vmcnt(6)
buffer_load_dwordx4 v[120:123], v9, s[40:43], s36 offen offset:2048 nt
v_dot2_f32_bf16 v27, v188, v20, 0
v_dot2_f32_bf16 v27, v189, v21, v27
v_dot2_f32_bf16 v27, v190, v22, v27
v_dot2_f32_bf16 v27, v191, v23, v27
v_add_f32_dpp v29, v26, v26 row_ror:8 row_mask:0xf bank_mask:0x3
v_dot2_f32_bf16 v24, v64, v16, 0
v_dot2_f32_bf16 v24, v65, v17, v24
v_dot2_f32_bf16 v24, v66, v18, v24
v_dot2_f32_bf16 v24, v67, v19, v24
v_add_f32_dpp v29, v27, v27 row_ror:8 row_mask:0xf bank_mask:0xc
v_add_f32_dpp v31, v28, v28 row_shl:4 row_mask:0xf bank_mask:0x5
v_dot2_f32_bf16 v25, v68, v16, 0
v_dot2_f32_bf16 v25, v69, v17, v25
v_dot2_f32_bf16 v25, v70, v18, v25
v_dot2_f32_bf16 v25, v71, v19, v25
v_add_f32_dpp v31, v29, v29 row_shr:4 row_mask:0xf bank_mask:0xa
s_waitcnt vmcnt(6)
buffer_load_dwordx4 v[124:127], v9, s[40:43], s36 offen offset:3072 nt
ds_add_u32 v192, v193 offset:256
v_add_f32_dpp v34, v30, v30 quad_perm:[2,3,0,1] row_mask:0xf bank_mask:0xf
v_add_f32_dpp v28, v24, v24 row_ror:8 row_mask:0xf bank_mask:0x3
v_dot2_f32_bf16 v26, v72, v16, 0
v_dot2_f32_bf16 v26, v73, v17, v26
v_dot2_f32_bf16 v26, v74, v18, v26
v_dot2_f32_bf16 v26, v75, v19, v26
v_add_f32_dpp v35, v31, v31 quad_perm:[2,3,0,1] row_mask:0xf bank_mask:0xf
v_cndmask_b32 v33, v34, v35, s[48:49]
v_add_f32_dpp v28, v25, v25 row_ror:8 row_mask:0xf bank_mask:0xc
v_add_f32_dpp v34, v32, v32 quad_perm:[1,0,3,2] row_mask:0xf bank_mask:0xf
v_mov_b32 v36, v37
v_mov_b32 v37, v38
v_mov_b32 v38, v39
v_mov_b32 v39, v40
v_mov_b32 v40, v41
v_mov_b32 v41, v42
v_mov_b32 v42, v43
v_mov_b32 v43, v44
v_mov_b32 v44, v45
v_mov_b32 v45, v46
v_dot2_f32_bf16 v27, v76, v16, 0
v_dot2_f32_bf16 v27, v77, v17, v27
v_dot2_f32_bf16 v27, v78, v18, v27
v_dot2_f32_bf16 v27, v79, v19, v27
v_add_f32_dpp v35, v33, v33 quad_perm:[1,0,3,2] row_mask:0xf bank_mask:0xf
v_cndmask_b32 v46, v34, v35, s[50:51]
v_add_f32_dpp v29, v26, v26 row_ror:8 row_mask:0xf bank_mask:0x3
v_dot2_f32_bf16 v24, v80, v20, 0
v_dot2_f32_bf16 v24, v81, v21, v24
v_dot2_f32_bf16 v24, v82, v22, v24
v_dot2_f32_bf16 v24, v83, v23, v24
v_add_f32_dpp v29, v27, v27 row_ror:8 row_mask:0xf bank_mask:0xc
s_waitcnt vmcnt(6)
s_add_u32 s36, s36, 0x18000
buffer_load_dwordx4 v[64:67], v8, s[40:43], s36 offen offset:0 nt
v_add_f32_dpp v30, v28, v28 row_shl:4 row_mask:0xf bank_mask:0x5
v_dot2_f32_bf16 v25, v84, v20, 0
v_dot2_f32_bf16 v25, v85, v21, v25
v_dot2_f32_bf16 v25, v86, v22, v25
v_dot2_f32_bf16 v25, v87, v23, v25
v_add_f32_dpp v30, v29, v29 row_shr:4 row_mask:0xf bank_mask:0xa
v_add_f32_dpp v28, v24, v24 row_ror:8 row_mask:0xf bank_mask:0x3
v_dot2_f32_bf16 v26, v88, v20, 0
v_dot2_f32_bf16 v26, v89, v21, v26
v_dot2_f32_bf16 v26, v90, v22, v26
v_dot2_f32_bf16 v26, v91, v23, v26
v_add_f32_dpp v28, v25, v25 row_ror:8 row_mask:0xf bank_mask:0xc
v_dot2_f32_bf16 v27, v92, v20, 0
v_dot2_f32_bf16 v27, v93, v21, v27
v_dot2_f32_bf16 v27, v94, v22, v27
v_dot2_f32_bf16 v27, v95, v23, v27
s_waitcnt vmcnt(6)
buffer_load_dwordx4 v[68:71], v8, s[40:43], s36 offen offset:1024 nt
ds_add_u32 v192, v193 offset:256
v_add_f32_dpp v29, v26, v26 row_ror:8 row_mask:0xf bank_mask:0x3
v_dot2_f32_bf16 v24, v96, v16, 0
v_dot2_f32_bf16 v24, v97, v17, v24
v_dot2_f32_bf16 v24, v98, v18, v24
v_dot2_f32_bf16 v24, v99, v19, v24
v_add_f32_dpp v29, v27, v27 row_ror:8 row_mask:0xf bank_mask:0xc
v_add_f32_dpp v31, v28, v28 row_shl:4 row_mask:0xf bank_mask:0x5
v_dot2_f32_bf16 v25, v100, v16, 0
v_dot2_f32_bf16 v25, v101, v17, v25
v_dot2_f32_bf16 v25, v102, v18, v25
v_dot2_f32_bf16 v25, v103, v19, v25
v_add_f32_dpp v31, v29, v29 row_shr:4 row_mask:0xf bank_mask:0xa
s_waitcnt vmcnt(6)
buffer_load_dwordx4 v[72:75], v8, s[40:43], s36 offen offset:2048 nt
v_add_f32_dpp v34, v30, v30 quad_perm:[2,3,0,1] row_mask:0xf bank_mask:0xf
v_add_f32_dpp v28, v24, v24 row_ror:8 row_mask:0xf bank_mask:0x3
v_dot2_f32_bf16 v26, v104, v16, 0
v_dot2_f32_bf16 v26, v105, v17, v26
v_dot2_f32_bf16 v26, v106, v18, v26
v_dot2_f32_bf16 v26, v107, v19, v26
v_add_f32_dpp v35, v31, v31 quad_perm:[2,3,0,1] row_mask:0xf bank_mask:0xf
v_cndmask_b32 v32, v34, v35, s[48:49]
v_add_f32_dpp v28, v25, v25 row_ror:8 row_mask:0xf bank_mask:0xc
s_waitcnt vmcnt(6)
buffer_load_dwordx4 v[76:79], v8, s[40:43], s36 offen offset:3072 nt
ds_add_u32 v192, v193 offset:256
v_dot2_f32_bf16 v27, v108, v16, 0
v_dot2_f32_bf16 v27, v109, v17, v27
v_dot2_f32_bf16 v27, v110, v18, v27
v_dot2_f32_bf16 v27, v111, v19, v27
s_waitcnt vmcnt(6)
buffer_load_dwordx4 v[80:83], v9, s[40:43], s36 offen offset:0 nt
v_add_f32_dpp v29, v26, v26 row_ror:8 row_mask:0xf bank_mask:0x3
v_dot2_f32_bf16 v24, v112, v20, 0
v_dot2_f32_bf16 v24, v113, v21, v24
v_dot2_f32_bf16 v24, v114, v22, v24
v_dot2_f32_bf16 v24, v115, v23, v24
v_add_f32_dpp v29, v27, v27 row_ror:8 row_mask:0xf bank_mask:0xc
s_waitcnt vmcnt(6)
buffer_load_dwordx4 v[84:87], v9, s[40:43], s36 offen offset:1024 nt
ds_add_u32 v192, v193 offset:256
v_add_f32_dpp v30, v28, v28 row_shl:4 row_mask:0xf bank_mask:0x5
v_dot2_f32_bf16 v25, v116, v20, 0
v_dot2_f32_bf16 v25, v117, v21, v25
v_dot2_f32_bf16 v25, v118, v22, v25
v_dot2_f32_bf16 v25, v119, v23, v25
v_add_f32_dpp v30, v29, v29 row_shr:4 row_mask:0xf bank_mask:0xa
s_waitcnt vmcnt(6)
buffer_load_dwordx4 v[88:91], v9, s[40:43], s36 offen offset:2048 nt
v_add_f32_dpp v28, v24, v24 row_ror:8 row_mask:0xf bank_mask:0x3
v_dot2_f32_bf16 v26, v120, v20, 0
v_dot2_f32_bf16 v26, v121, v21, v26
v_dot2_f32_bf16 v26, v122, v22, v26
v_dot2_f32_bf16 v26, v123, v23, v26
v_add_f32_dpp v28, v25, v25 row_ror:8 row_mask:0xf bank_mask:0xc
s_waitcnt vmcnt(6)
buffer_load_dwordx4 v[92:95], v9, s[40:43], s36 offen offset:3072 nt
ds_add_u32 v192, v193 offset:256
v_dot2_f32_bf16 v27, v124, v20, 0
v_dot2_f32_bf16 v27, v125, v21, v27
v_dot2_f32_bf16 v27, v126, v22, v27
v_dot2_f32_bf16 v27, v127, v23, v27
s_mov_b32 s38, 7
.p2align 6
L_A_ka:
s_cbranch_vccnz L_A_w1
s_waitcnt vmcnt(6)
L_A_w1:
s_waitcnt vmcnt(7)
s_add_u32 s36, s36, 0x18000
buffer_load_dwordx4 v[96:99], v8, s[40:43], s36 offen offset:0 nt
ds_read_b32 v194, v47 offset:8
v_add_f32_dpp v29, v26, v26 row_ror:8 row_mask:0xf bank_mask:0x3
v_dot2_f32_bf16 v24, v64, v16, 0
v_dot2_f32_bf16 v24, v65, v17, v24
v_dot2_f32_bf16 v24, v66, v18, v24
v_dot2_f32_bf16 v24, v67, v19, v24
v_add_f32_dpp v29, v27, v27 row_ror:8 row_mask:0xf bank_mask:0xc
s_cbranch_vccnz L_A_w2
s_waitcnt vmcnt(6)
L_A_w2:
s_waitcnt vmcnt(7)
buffer_load_dwordx4 v[100:103], v8, s[40:43], s36 offen offset:1024 nt
ds_add_u32 v192, v193 offset:256
s_waitcnt lgkmcnt(1)
v_cmp_ne_u32 vcc, 0, v194
v_add_f32_dpp v31, v28, v28 row_shl:4 row_mask:0xf bank_mask:0x5
v_dot2_f32_bf16 v25, v68, v16, 0
v_dot2_f32_bf16 v25, v69, v17, v25
v_dot2_f32_bf16 v25, v70, v18, v25
v_dot2_f32_bf16 v25, v71, v19, v25
v_add_f32_dpp v31, v29, v29 row_shr:4 row_mask:0xf bank_mask:0xa
s_cbranch_vccnz L_A_w3
s_waitcnt vmcnt(6)
L_A_w3:
s_waitcnt vmcnt(7)
buffer_load_dwordx4 v[104:107], v8, s[40:43], s36 offen offset:2048 nt
v_add_f32_dpp v34, v30, v30 quad_perm:[2,3,0,1] row_mask:0xf bank_mask:0xf
v_add_f32_dpp v28, v24, v24 row_ror:8 row_mask:0xf bank_mask:0x3
v_dot2_f32_bf16 v26, v72, v16, 0
v_dot2_f32_bf16 v26, v73, v17, v26
v_dot2_f32_bf16 v26, v74, v18, v26
v_dot2_f32_bf16 v26, v75, v19, v26
v_add_f32_dpp v35, v31, v31 quad_perm:[2,3,0,1] row_mask:0xf bank_mask:0xf
v_cndmask_b32 v33, v34, v35, s[48:49]
v_add_f32_dpp v28, v25, v25 row_ror:8 row_mask:0xf bank_mask:0xc
s_cbranch_vccnz L_A_w4
s_waitcnt vmcnt(6)
L_A_w4:
s_waitcnt vmcnt(7)
buffer_load_dwordx4 v[108:111], v8, s[40:43], s36 offen offset:3072 nt
ds_add_u32 v192, v193 offset:256
v_add_f32_dpp v34, v32, v32 quad_perm:[1,0,3,2] row_mask:0xf bank_mask:0xf
v_mov_b32 v36, v37
v_mov_b32 v37, v38
v_mov_b32 v38, v39
v_mov_b32 v39, v40
v_mov_b32 v40, v41
v_mov_b32 v41, v42
v_mov_b32 v42, v43
v_mov_b32 v43, v44
v_mov_b32 v44, v45
v_mov_b32 v45, v46
v_dot2_f32_bf16 v27, v76, v16, 0
v_dot2_f32_bf16 v27, v77, v17, v27
v_dot2_f32_bf16 v27, v78, v18, v27
v_dot2_f32_bf16 v27, v79, v19, v27
v_add_f32_dpp v35, v33, v33 quad_perm:[1,0,3,2] row_mask:0xf bank_mask:0xf
v_cndmask_b32 v46, v34, v35, s[50:51]
s_cbranch_vccnz L_A_w5
s_waitcnt vmcnt(6)
L_A_w5:
s_waitcnt vmcnt(7)
buffer_load_dwordx4 v[112:115], v9, s[40:43], s36 offen offset:0 nt
v_add_f32_dpp v29, v26, v26 row_ror:8 row_mask:0xf bank_mask:0x3
v_dot2_f32_bf16 v24, v80, v20, 0
v_dot2_f32_bf16 v24, v81, v21, v24
v_dot2_f32_bf16 v24, v82, v22, v24
v_dot2_f32_bf16 v24, v83, v23, v24
v_add_f32_dpp v29, v27, v27 row_ror:8 row_mask:0xf bank_mask:0xc
s_cbranch_vccnz L_A_w6
s_waitcnt vmcnt(6)
L_A_w6:
s_waitcnt vmcnt(7)
buffer_load_dwordx4 v[116:119], v9, s[40:43], s36 offen offset:1024 nt
ds_add_u32 v192, v193 offset:256
v_add_f32_dpp v30, v28, v28 row_shl:4 row_mask:0xf bank_mask:0x5
v_dot2_f32_bf16 v25, v84, v20, 0
v_dot2_f32_bf16 v25, v85, v21, v25
v_dot2_f32_bf16 v25, v86, v22, v25
v_dot2_f32_bf16 v25, v87, v23, v25
v_add_f32_dpp v30, v29, v29 row_shr:4 row_mask:0xf bank_mask:0xa
s_cbranch_vccnz L_A_w7
s_waitcnt vmcnt(6)
L_A_w7:
s_waitcnt vmcnt(7)
buffer_load_dwordx4 v[120:123], v9, s[40:43], s36 offen offset:2048 nt
v_add_f32_dpp v28, v24, v24 row_ror:8 row_mask:0xf bank_mask:0x3
v_dot2_f32_bf16 v26, v88, v20, 0
v_dot2_f32_bf16 v26, v89, v21, v26
v_dot2_f32_bf16 v26, v90, v22, v26
v_dot2_f32_bf16 v26, v91, v23, v26
v_add_f32_dpp v28, v25, v25 row_ror:8 row_mask:0xf bank_mask:0xc
s_cbranch_vccnz L_A_w8
s_waitcnt vmcnt(6)
L_A_w8:
s_waitcnt vmcnt(7)
buffer_load_dwordx4 v[124:127], v9, s[40:43], s36 offen offset:3072 nt
ds_add_u32 v192, v193 offset:256
v_dot2_f32_bf16 v27, v92, v20, 0
v_dot2_f32_bf16 v27, v93, v21, v27
v_dot2_f32_bf16 v27, v94, v22, v27
v_dot2_f32_bf16 v27, v95, v23, v27
s_cbranch_vccnz L_A_w9
s_waitcnt vmcnt(6)
L_A_w9:
s_waitcnt vmcnt(7)
s_add_u32 s36, s36, 0x18000
buffer_load_dwordx4 v[64:67], v8, s[40:43], s36 offen offset:0 nt
ds_read_b32 v194, v47 offset:8
v_add_f32_dpp v29, v26, v26 row_ror:8 row_mask:0xf bank_mask:0x3
v_dot2_f32_bf16 v24, v96, v16, 0
v_dot2_f32_bf16 v24, v97, v17, v24
v_dot2_f32_bf16 v24, v98, v18, v24
v_dot2_f32_bf16 v24, v99, v19, v24
v_add_f32_dpp v29, v27, v27 row_ror:8 row_mask:0xf bank_mask:0xc
s_cbranch_vccnz L_A_w10
s_waitcnt vmcnt(6)
L_A_w10:
s_waitcnt vmcnt(7)
buffer_load_dwordx4 v[68:71], v8, s[40:43], s36 offen offset:1024 nt
ds_add_u32 v192, v193 offset:256
s_waitcnt lgkmcnt(1)
v_cmp_ne_u32 vcc, 0, v194
v_add_f32_dpp v31, v28, v28 row_shl:4 row_mask:0xf bank_mask:0x5
v_dot2_f32_bf16 v25, v100, v16, 0
v_dot2_f32_bf16 v25, v101, v17, v25
v_dot2_f32_bf16 v25, v102, v18, v25
v_dot2_f32_bf16 v25, v103, v19, v25
v_add_f32_dpp v31, v29, v29 row_shr:4 row_mask:0xf bank_mask:0xa
s_cbranch_vccnz L_A_w11
s_waitcnt vmcnt(6)
L_A_w11:
s_waitcnt vmcnt(7)
buffer_load_dwordx4 v[72:75], v8, s[40:43], s36 offen offset:2048 nt
v_add_f32_dpp v34, v30, v30 quad_perm:[2,3,0,1] row_mask:0xf bank_mask:0xf
v_add_f32_dpp v28, v24, v24 row_ror:8 row_mask:0xf bank_mask:0x3
v_dot2_f32_bf16 v26, v104, v16, 0
v_dot2_f32_bf16 v26, v105, v17, v26
v_dot2_f32_bf16 v26, v106, v18, v26
v_dot2_f32_bf16 v26, v107, v19, v26
v_add_f32_dpp v35, v31, v31 quad_perm:[2,3,0,1] row_mask:0xf bank_mask:0xf
v_cndmask_b32 v32, v34, v35, s[48:49]
v_add_f32_dpp v28, v25, v25 row_ror:8 row_mask:0xf bank_mask:0xc
s_cbranch_vccnz L_A_w12
s_waitcnt vmcnt(6)
L_A_w12:
s_waitcnt vmcnt(7)
buffer_load_dwordx4 v[76:79], v8, s[40:43], s36 offen offset:3072 nt
ds_add_u32 v192, v193 offset:256
v_dot2_f32_bf16 v27, v108, v16, 0
v_dot2_f32_bf16 v27, v109, v17, v27
v_dot2_f32_bf16 v27, v110, v18, v27
v_dot2_f32_bf16 v27, v111, v19, v27
s_cbranch_vccnz L_A_w13
s_waitcnt vmcnt(6)
L_A_w13:
s_waitcnt vmcnt(7)
buffer_load_dwordx4 v[80:83], v9, s[40:43], s36 offen offset:0 nt
v_add_f32_dpp v29, v26, v26 row_ror:8 row_mask:0xf bank_mask:0x3
v_dot2_f32_bf16 v24, v112, v20, 0
v_dot2_f32_bf16 v24, v113, v21, v24
v_dot2_f32_bf16 v24, v114, v22, v24
v_dot2_f32_bf16 v24, v115, v23, v24
v_add_f32_dpp v29, v27, v27 row_ror:8 row_mask:0xf bank_mask:0xc
s_cbranch_vccnz L_A_w14
s_waitcnt vmcnt(6)
L_A_w14:
s_waitcnt vmcnt(7)
buffer_load_dwordx4 v[84:87], v9, s[40:43], s36 offen offset:1024 nt
ds_add_u32 v192, v193 offset:256
v_add_f32_dpp v30, v28, v28 row_shl:4 row_mask:0xf bank_mask:0x5
v_dot2_f32_bf16 v25, v116, v20, 0
v_dot2_f32_bf16 v25, v117, v21, v25
v_dot2_f32_bf16 v25, v118, v22, v25
v_dot2_f32_bf16 v25, v119, v23, v25
v_add_f32_dpp v30, v29, v29 row_shr:4 row_mask:0xf bank_mask:0xa
s_cbranch_vccnz L_A_w15
s_waitcnt vmcnt(6)
L_A_w15:
s_waitcnt vmcnt(7)
buffer_load_dwordx4 v[88:91], v9, s[40:43], s36 offen offset:2048 nt
v_add_f32_dpp v28, v24, v24 row_ror:8 row_mask:0xf bank_mask:0x3
v_dot2_f32_bf16 v26, v120, v20, 0
v_dot2_f32_bf16 v26, v121, v21, v26
v_dot2_f32_bf16 v26, v122, v22, v26
v_dot2_f32_bf16 v26, v123, v23, v26
v_add_f32_dpp v28, v25, v25 row_ror:8 row_mask:0xf bank_mask:0xc
s_cbranch_vccnz L_A_w16
s_waitcnt vmcnt(6)
L_A_w16:
s_waitcnt vmcnt(7)
buffer_load_dwordx4 v[92:95], v9, s[40:43], s36 offen offset:3072 nt
ds_add_u32 v192, v193 offset:256
v_dot2_f32_bf16 v27, v124, v20, 0
v_dot2_f32_bf16 v27, v125, v21, v27
v_dot2_f32_bf16 v27, v126, v22, v27
v_dot2_f32_bf16 v27, v127, v23, v27
s_sub_u32 s38, s38, 1
s_cmp_lg_u32 s38, 0
s_cbranch_scc1 L_A_ka
s_cbranch_vccnz L_A_w17
s_waitcnt vmcnt(5)
L_A_w17:
s_waitcnt vmcnt(7)
buffer_load_dwordx4 v[96:99], v8, s[40:43], s37 offen nt
v_add_f32_dpp v29, v26, v26 row_ror:8 row_mask:0xf bank_mask:0x3
v_dot2_f32_bf16 v24, v64, v16, 0
v_dot2_f32_bf16 v24, v65, v17, v24
v_dot2_f32_bf16 v24, v66, v18, v24
v_dot2_f32_bf16 v24, v67, v19, v24
v_add_f32_dpp v29, v27, v27 row_ror:8 row_mask:0xf bank_mask:0xc
s_cbranch_vccnz L_A_w18
s_waitcnt vmcnt(5)
L_A_w18:
s_waitcnt vmcnt(7)
buffer_load_dwordx4 v[100:103], v10, s[40:43], s37 offen nt
ds_add_u32 v192, v193 offset:256
v_add_f32_dpp v31, v28, v28 row_shl:4 row_mask:0xf bank_mask:0x5
v_dot2_f32_bf16 v25, v68, v16, 0
v_dot2_f32_bf16 v25, v69, v17, v25
v_dot2_f32_bf16 v25, v70, v18, v25
v_dot2_f32_bf16 v25, v71, v19, v25
v_add_f32_dpp v31, v29, v29 row_shr:4 row_mask:0xf bank_mask:0xa
s_cbranch_vccnz L_A_w19
s_waitcnt vmcnt(5)
L_A_w19:
s_waitcnt vmcnt(7)
buffer_load_dwordx4 v[104:107], v9, s[40:43], s37 offen nt
v_add_f32_dpp v34, v30, v30 quad_perm:[2,3,0,1] row_mask:0xf bank_mask:0xf
v_add_f32_dpp v28, v24, v24 row_ror:8 row_mask:0xf bank_mask:0x3
v_dot2_f32_bf16 v26, v72, v16, 0
v_dot2_f32_bf16 v26, v73, v17, v26
v_dot2_f32_bf16 v26, v74, v18, v26
v_dot2_f32_bf16 v26, v75, v19, v26
v_add_f32_dpp v35, v31, v31 quad_perm:[2,3,0,1] row_mask:0xf bank_mask:0xf
v_cndmask_b32 v33, v34, v35, s[48:49]
v_add_f32_dpp v28, v25, v25 row_ror:8 row_mask:0xf bank_mask:0xc
s_cbranch_vccnz L_A_w20
s_waitcnt vmcnt(5)
L_A_w20:
s_waitcnt vmcnt(7)
buffer_load_dwordx4 v[108:111], v11, s[40:43], s37 offen nt
ds_add_u32 v192, v193 offset:256
v_add_f32_dpp v34, v32, v32 quad_perm:[1,0,3,2] row_mask:0xf bank_mask:0xf
v_mov_b32 v36, v37
v_mov_b32 v37, v38
v_mov_b32 v38, v39
v_mov_b32 v39, v40
v_mov_b32 v40, v41
v_mov_b32 v41, v42
v_mov_b32 v42, v43
v_mov_b32 v43, v44
v_mov_b32 v44, v45
v_mov_b32 v45, v46
v_dot2_f32_bf16 v27, v76, v16, 0
v_dot2_f32_bf16 v27, v77, v17, v27
v_dot2_f32_bf16 v27, v78, v18, v27
v_dot2_f32_bf16 v27, v79, v19, v27
v_add_f32_dpp v35, v33, v33 quad_perm:[1,0,3,2] row_mask:0xf bank_mask:0xf
v_cndmask_b32 v46, v34, v35, s[50:51]
s_cbranch_vccnz L_A_w21
s_waitcnt vmcnt(5)
L_A_w21:
s_waitcnt vmcnt(7)
s_mov_b32 s36, s35
buffer_load_dwordx4 v[112:115], v8, s[44:47], s36 offen offset:0 nt
v_add_f32_dpp v29, v26, v26 row_ror:8 row_mask:0xf bank_mask:0x3
v_dot2_f32_bf16 v24, v80, v20, 0
v_dot2_f32_bf16 v24, v81, v21, v24
v_dot2_f32_bf16 v24, v82, v22, v24
v_dot2_f32_bf16 v24, v83, v23, v24
v_add_f32_dpp v29, v27, v27 row_ror:8 row_mask:0xf bank_mask:0xc
s_cbranch_vccnz L_A_w22
s_waitcnt vmcnt(5)
L_A_w22:
s_waitcnt vmcnt(7)
buffer_load_dwordx4 v[116:119], v8, s[44:47], s36 offen offset:1024 nt
ds_add_u32 v192, v193 offset:256
v_add_f32_dpp v30, v28, v28 row_shl:4 row_mask:0xf bank_mask:0x5
v_dot2_f32_bf16 v25, v84, v20, 0
v_dot2_f32_bf16 v25, v85, v21, v25
v_dot2_f32_bf16 v25, v86, v22, v25
v_dot2_f32_bf16 v25, v87, v23, v25
v_add_f32_dpp v30, v29, v29 row_shr:4 row_mask:0xf bank_mask:0xa
s_cbranch_vccnz L_A_w23
s_waitcnt vmcnt(5)
L_A_w23:
s_waitcnt vmcnt(7)
buffer_load_dwordx4 v[120:123], v8, s[44:47], s36 offen offset:2048 nt
v_add_f32_dpp v28, v24, v24 row_ror:8 row_mask:0xf bank_mask:0x3
v_dot2_f32_bf16 v26, v88, v20, 0
v_dot2_f32_bf16 v26, v89, v21, v26
v_dot2_f32_bf16 v26, v90, v22, v26
v_dot2_f32_bf16 v26, v91, v23, v26
v_add_f32_dpp v28, v25, v25 row_ror:8 row_mask:0xf bank_mask:0xc
s_cbranch_vccnz L_A_w24
s_waitcnt vmcnt(5)
L_A_w24:
s_waitcnt vmcnt(7)
buffer_load_dwordx4 v[124:127], v8, s[44:47], s36 offen offset:3072 nt
ds_add_u32 v192, v193 offset:256
v_dot2_f32_bf16 v27, v92, v20, 0
v_dot2_f32_bf16 v27, v93, v21, v27
v_dot2_f32_bf16 v27, v94, v22, v27
v_dot2_f32_bf16 v27, v95, v23, v27
s_cbranch_vccnz L_A_w25
s_waitcnt vmcnt(5)
L_A_w25:
s_waitcnt vmcnt(7)
buffer_load_dwordx4 v[64:67], v9, s[44:47], s36 offen offset:0 nt
v_add_f32_dpp v29, v26, v26 row_ror:8 row_mask:0xf bank_mask:0x3
v_dot2_f32_bf16 v24, v96, v16, 0
v_dot2_f32_bf16 v24, v97, v17, v24
v_dot2_f32_bf16 v24, v98, v18, v24
v_dot2_f32_bf16 v24, v99, v19, v24
v_add_f32_dpp v29, v27, v27 row_ror:8 row_mask:0xf bank_mask:0xc
s_cbranch_vccnz L_A_w26
s_waitcnt vmcnt(5)
L_A_w26:
s_waitcnt vmcnt(7)
buffer_load_dwordx4 v[68:71], v9, s[44:47], s36 offen offset:1024 nt
ds_add_u32 v192, v193 offset:256
v_add_f32_dpp v31, v28, v28 row_shl:4 row_mask:0xf bank_mask:0x5
v_dot2_f32_bf16 v25, v100, v16, 0
v_dot2_f32_bf16 v25, v101, v17, v25
v_dot2_f32_bf16 v25, v102, v18, v25
v_dot2_f32_bf16 v25, v103, v19, v25
v_add_f32_dpp v31, v29, v29 row_shr:4 row_mask:0xf bank_mask:0xa
s_cbranch_vccnz L_A_w27
s_waitcnt vmcnt(5)
L_A_w27:
s_waitcnt vmcnt(7)
buffer_load_dwordx4 v[72:75], v9, s[44:47], s36 offen offset:2048 nt
v_add_f32_dpp v34, v30, v30 quad_perm:[2,3,0,1] row_mask:0xf bank_mask:0xf
v_add_f32_dpp v28, v24, v24 row_ror:8 row_mask:0xf bank_mask:0x3
v_dot2_f32_bf16 v26, v104, v20, 0
v_dot2_f32_bf16 v26, v105, v21, v26
v_dot2_f32_bf16 v26, v106, v22, v26
v_dot2_f32_bf16 v26, v107, v23, v26
v_add_f32_dpp v35, v31, v31 quad_perm:[2,3,0,1] row_mask:0xf bank_mask:0xf
v_cndmask_b32 v32, v34, v35, s[48:49]
v_add_f32_dpp v28, v25, v25 row_ror:8 row_mask:0xf bank_mask:0xc
s_cbranch_vccnz L_A_w28
s_waitcnt vmcnt(5)
L_A_w28:
s_waitcnt vmcnt(7)
buffer_load_dwordx4 v[76:79], v9, s[44:47], s36 offen offset:3072 nt
ds_add_u32 v192, v193 offset:256
v_dot2_f32_bf16 v27, v108, v20, 0
v_dot2_f32_bf16 v27, v109, v21, v27
v_dot2_f32_bf16 v27, v110, v22, v27
v_dot2_f32_bf16 v27, v111, v23, v27
v_add_f32_dpp v30, v28, v28 row_shl:4 row_mask:0xf bank_mask:0x5
s_nop 2
v_add_f32_dpp v28, v26, v26 row_ror:8 row_mask:0xf bank_mask:0x3
s_nop 1
v_add_f32_dpp v28, v27, v27 row_ror:8 row_mask:0xf bank_mask:0xc
s_nop 2
s_nop 1
v_add_f32_dpp v31, v28, v28 row_shl:4 row_mask:0xf bank_mask:0x5
s_nop 2
v_add_f32_dpp v34, v30, v30 quad_perm:[2,3,0,1] row_mask:0xf bank_mask:0xf
s_nop 1
v_add_f32_dpp v35, v31, v31 quad_perm:[2,3,0,1] row_mask:0xf bank_mask:0xf
v_cndmask_b32 v33, v34, v35, s[48:49]
s_nop 2
v_add_f32_dpp v34, v32, v32 quad_perm:[1,0,3,2] row_mask:0xf bank_mask:0xf
v_mov_b32 v36, v37
v_mov_b32 v37, v38
v_mov_b32 v38, v39
v_mov_b32 v39, v40
v_mov_b32 v40, v41
v_mov_b32 v41, v42
v_mov_b32 v42, v43
v_mov_b32 v43, v44
v_mov_b32 v44, v45
v_mov_b32 v45, v46
s_nop 1
v_add_f32_dpp v35, v33, v33 quad_perm:[1,0,3,2] row_mask:0xf bank_mask:0xf
v_cndmask_b32 v46, v34, v35, s[50:51]
v_mov_b32 v60, 0xff800000
v_cndmask_b32 v46, v60, v46, s[52:53]
v_max3_f32 v60, v36, v37, v38
v_max3_f32 v60, v60, v39, v40
v_max3_f32 v60, v60, v41, v42
v_max3_f32 v60, v60, v43, v44
v_max3_f32 v60, v60, v45, v46
s_waitcnt vmcnt(5)
s_add_u32 s36, s36, 0x18000
buffer_load_dwordx4 v[80:83], v8, s[44:47], s36 offen offset:0 nt
s_nop 1
v_max_f32_dpp v60, v60, v60 quad_perm:[1,0,3,2] row_mask:0xf bank_mask:0xf
s_nop 1
v_max_f32_dpp v60, v60, v60 row_ror:4 row_mask:0xf bank_mask:0xf
s_nop 1
v_max_f32_dpp v60, v60, v60 row_ror:8 row_mask:0xf bank_mask:0xf
v_mov_b32 v34, v60
s_nop 1
v_permlane16_swap_b32 v60, v34
s_nop 0
v_max_f32 v60, v60, v34
v_mov_b32 v34, v60
s_nop 1
v_permlane32_swap_b32 v60, v34
s_nop 0
v_max_f32 v60, v60, v34
s_mov_b32 s62, 0x3e0293ee
v_mul_f32 v60, s62, v60
s_waitcnt vmcnt(5)
buffer_load_dwordx4 v[84:87], v8, s[44:47], s36 offen offset:1024 nt
ds_add_u32 v192, v193 offset:256
v_fma_f32 v36, v36, s62, -v60
v_fma_f32 v37, v37, s62, -v60
v_fma_f32 v38, v38, s62, -v60
v_fma_f32 v39, v39, s62, -v60
v_fma_f32 v40, v40, s62, -v60
v_fma_f32 v41, v41, s62, -v60
v_fma_f32 v42, v42, s62, -v60
v_fma_f32 v43, v43, s62, -v60
v_fma_f32 v44, v44, s62, -v60
v_fma_f32 v45, v45, s62, -v60
v_fma_f32 v46, v46, s62, -v60
v_exp_f32 v36, v36
v_exp_f32 v37, v37
v_exp_f32 v38, v38
v_exp_f32 v39, v39
v_exp_f32 v40, v40
v_exp_f32 v41, v41
v_exp_f32 v42, v42
v_exp_f32 v43, v43
v_exp_f32 v44, v44
v_exp_f32 v45, v45
v_exp_f32 v46, v46
s_waitcnt vmcnt(5)
buffer_load_dwordx4 v[88:91], v8, s[44:47], s36 offen offset:2048 nt
v_add_f32 v61, v36, v37
v_add_f32 v61, v61, v38
v_add_f32 v61, v61, v39
v_add_f32 v61, v61, v40
v_add_f32 v61, v61, v41
v_add_f32 v61, v61, v42
v_add_f32 v61, v61, v43
v_add_f32 v61, v61, v44
v_add_f32 v61, v61, v45
v_add_f32 v61, v61, v46
v_cvt_pk_bf16_f32 v36, v36, v36
v_cvt_pk_bf16_f32 v37, v37, v37
v_cvt_pk_bf16_f32 v38, v38, v38
v_cvt_pk_bf16_f32 v39, v39, v39
v_cvt_pk_bf16_f32 v40, v40, v40
v_cvt_pk_bf16_f32 v41, v41, v41
v_cvt_pk_bf16_f32 v42, v42, v42
v_cvt_pk_bf16_f32 v43, v43, v43
v_cvt_pk_bf16_f32 v44, v44, v44
v_cvt_pk_bf16_f32 v45, v45, v45
v_cvt_pk_bf16_f32 v46, v46, v46
s_waitcnt vmcnt(5)
buffer_load_dwordx4 v[92:95], v8, s[44:47], s36 offen offset:3072 nt
ds_add_u32 v192, v193 offset:256
s_nop 1
v_add_f32_dpp v61, v61, v61 quad_perm:[1,0,3,2] row_mask:0xf bank_mask:0xf
s_nop 1
v_add_f32_dpp v61, v61, v61 row_ror:4 row_mask:0xf bank_mask:0xf
s_nop 1
v_add_f32_dpp v61, v61, v61 row_ror:8 row_mask:0xf bank_mask:0xf
v_mov_b32 v34, v61
s_nop 1
v_permlane16_swap_b32 v61, v34
s_nop 0
v_add_f32 v61, v61, v34
v_mov_b32 v34, v61
s_nop 1
v_permlane32_swap_b32 v61, v34
s_nop 0
v_add_f32 v61, v61, v34
s_lshl_b32 s62, s34, 2
v_lshl_add_u32 v62, v1, 3, s62
v_mov_b32 v63, 1
s_mov_b64 exec, 5
ds_write_b32 v62, v60 offset:64
ds_write_b32 v62, v61 offset:96
s_mov_b64 exec, 1
ds_add_u32 v47, v63 offset:4
s_mov_b64 exec, -1
v_and_b32_dpp v52, v36, v4 row_newbcast:0 row_mask:0xf bank_mask:0xf
v_and_b32_dpp v53, v36, v5 row_newbcast:0 row_mask:0xf bank_mask:0xf
v_and_b32_dpp v54, v36, v6 row_newbcast:0 row_mask:0xf bank_mask:0xf
v_and_b32_dpp v55, v36, v7 row_newbcast:0 row_mask:0xf bank_mask:0xf
s_mov_b32 s38, 9
.p2align 6
L_A_va:
s_cbranch_vccnz L_A_w29
s_waitcnt vmcnt(5)
L_A_w29:
s_waitcnt vmcnt(7)
buffer_load_dwordx4 v[96:99], v9, s[44:47], s36 offen offset:0 nt
v_mfma_f32_16x16x32_bf16 v[48:51], v[52:55], v[112:115], v[48:51]
ds_read_b32 v194, v47 offset:8
v_and_b32_dpp v56, v36, v4 row_newbcast:8 row_mask:0xf bank_mask:0xf
v_and_b32_dpp v57, v36, v5 row_newbcast:8 row_mask:0xf bank_mask:0xf
v_and_b32_dpp v58, v36, v6 row_newbcast:8 row_mask:0xf bank_mask:0xf
v_and_b32_dpp v59, v36, v7 row_newbcast:8 row_mask:0xf bank_mask:0xf
s_cbranch_vccnz L_A_w30
s_waitcnt vmcnt(5)
L_A_w30:
s_waitcnt vmcnt(7)
buffer_load_dwordx4 v[100:103], v9, s[44:47], s36 offen offset:1024 nt
ds_add_u32 v192, v193 offset:256
v_mfma_f32_16x16x32_bf16 v[48:51], v[56:59], v[116:119], v[48:51]
s_waitcnt lgkmcnt(1)
v_cmp_ne_u32 vcc, 0, v194
v_and_b32_dpp v52, v36, v4 row_newbcast:4 row_mask:0xf bank_mask:0xf
v_and_b32_dpp v53, v36, v5 row_newbcast:4 row_mask:0xf bank_mask:0xf
v_and_b32_dpp v54, v36, v6 row_newbcast:4 row_mask:0xf bank_mask:0xf
v_and_b32_dpp v55, v36, v7 row_newbcast:4 row_mask:0xf bank_mask:0xf
s_cbranch_vccnz L_A_w31
s_waitcnt vmcnt(5)
L_A_w31:
s_waitcnt vmcnt(7)
buffer_load_dwordx4 v[104:107], v9, s[44:47], s36 offen offset:2048 nt
v_mfma_f32_16x16x32_bf16 v[48:51], v[52:55], v[120:123], v[48:51]
v_and_b32_dpp v56, v36, v4 row_newbcast:12 row_mask:0xf bank_mask:0xf
v_and_b32_dpp v57, v36, v5 row_newbcast:12 row_mask:0xf bank_mask:0xf
v_and_b32_dpp v58, v36, v6 row_newbcast:12 row_mask:0xf bank_mask:0xf
v_and_b32_dpp v59, v36, v7 row_newbcast:12 row_mask:0xf bank_mask:0xf
s_cbranch_vccnz L_A_w32
s_waitcnt vmcnt(5)
L_A_w32:
s_waitcnt vmcnt(7)
buffer_load_dwordx4 v[108:111], v9, s[44:47], s36 offen offset:3072 nt
ds_add_u32 v192, v193 offset:256
v_mfma_f32_16x16x32_bf16 v[48:51], v[56:59], v[124:127], v[48:51]
v_and_b32_dpp v52, v36, v12 row_newbcast:2 row_mask:0xf bank_mask:0xf
v_and_b32_dpp v53, v36, v13 row_newbcast:2 row_mask:0xf bank_mask:0xf
v_and_b32_dpp v54, v36, v14 row_newbcast:2 row_mask:0xf bank_mask:0xf
v_and_b32_dpp v55, v36, v15 row_newbcast:2 row_mask:0xf bank_mask:0xf
s_cbranch_vccnz L_A_w33
s_waitcnt vmcnt(5)
L_A_w33:
s_waitcnt vmcnt(7)
s_add_u32 s36, s36, 0x18000
buffer_load_dwordx4 v[112:115], v8, s[44:47], s36 offen offset:0 nt
v_mfma_f32_16x16x32_bf16 v[48:51], v[52:55], v[64:67], v[48:51]
v_and_b32_dpp v56, v36, v12 row_newbcast:10 row_mask:0xf bank_mask:0xf
v_and_b32_dpp v57, v36, v13 row_newbcast:10 row_mask:0xf bank_mask:0xf
v_and_b32_dpp v58, v36, v14 row_newbcast:10 row_mask:0xf bank_mask:0xf
v_and_b32_dpp v59, v36, v15 row_newbcast:10 row_mask:0xf bank_mask:0xf
s_cbranch_vccnz L_A_w34
s_waitcnt vmcnt(5)
L_A_w34:
s_waitcnt vmcnt(7)
buffer_load_dwordx4 v[116:119], v8, s[44:47], s36 offen offset:1024 nt
ds_add_u32 v192, v193 offset:256
v_mfma_f32_16x16x32_bf16 v[48:51], v[56:59], v[68:71], v[48:51]
v_and_b32_dpp v52, v36, v12 row_newbcast:6 row_mask:0xf bank_mask:0xf
v_and_b32_dpp v53, v36, v13 row_newbcast:6 row_mask:0xf bank_mask:0xf
v_and_b32_dpp v54, v36, v14 row_newbcast:6 row_mask:0xf bank_mask:0xf
v_and_b32_dpp v55, v36, v15 row_newbcast:6 row_mask:0xf bank_mask:0xf
s_cbranch_vccnz L_A_w35
s_waitcnt vmcnt(5)
L_A_w35:
s_waitcnt vmcnt(7)
buffer_load_dwordx4 v[120:123], v8, s[44:47], s36 offen offset:2048 nt
v_mfma_f32_16x16x32_bf16 v[48:51], v[52:55], v[72:75], v[48:51]
v_and_b32_dpp v56, v36, v12 row_newbcast:14 row_mask:0xf bank_mask:0xf
v_and_b32_dpp v57, v36, v13 row_newbcast:14 row_mask:0xf bank_mask:0xf
v_and_b32_dpp v58, v36, v14 row_newbcast:14 row_mask:0xf bank_mask:0xf
v_and_b32_dpp v59, v36, v15 row_newbcast:14 row_mask:0xf bank_mask:0xf
s_cbranch_vccnz L_A_w36
s_waitcnt vmcnt(5)
L_A_w36:
s_waitcnt vmcnt(7)
buffer_load_dwordx4 v[124:127], v8, s[44:47], s36 offen offset:3072 nt
ds_add_u32 v192, v193 offset:256
v_mfma_f32_16x16x32_bf16 v[48:51], v[56:59], v[76:79], v[48:51]
v_and_b32_dpp v52, v36, v4 row_newbcast:1 row_mask:0xf bank_mask:0xf
v_and_b32_dpp v53, v36, v5 row_newbcast:1 row_mask:0xf bank_mask:0xf
v_and_b32_dpp v54, v36, v6 row_newbcast:1 row_mask:0xf bank_mask:0xf
v_and_b32_dpp v55, v36, v7 row_newbcast:1 row_mask:0xf bank_mask:0xf
s_cbranch_vccnz L_A_w37
s_waitcnt vmcnt(5)
L_A_w37:
s_waitcnt vmcnt(7)
buffer_load_dwordx4 v[64:67], v9, s[44:47], s36 offen offset:0 nt
v_mfma_f32_16x16x32_bf16 v[48:51], v[52:55], v[80:83], v[48:51]
ds_read_b32 v194, v47 offset:8
v_and_b32_dpp v56, v36, v4 row_newbcast:9 row_mask:0xf bank_mask:0xf
v_and_b32_dpp v57, v36, v5 row_newbcast:9 row_mask:0xf bank_mask:0xf
v_and_b32_dpp v58, v36, v6 row_newbcast:9 row_mask:0xf bank_mask:0xf
v_and_b32_dpp v59, v36, v7 row_newbcast:9 row_mask:0xf bank_mask:0xf
s_cbranch_vccnz L_A_w38
s_waitcnt vmcnt(5)
L_A_w38:
s_waitcnt vmcnt(7)
buffer_load_dwordx4 v[68:71], v9, s[44:47], s36 offen offset:1024 nt
ds_add_u32 v192, v193 offset:256
v_mfma_f32_16x16x32_bf16 v[48:51], v[56:59], v[84:87], v[48:51]
s_waitcnt lgkmcnt(1)
v_cmp_ne_u32 vcc, 0, v194
v_and_b32_dpp v52, v36, v4 row_newbcast:5 row_mask:0xf bank_mask:0xf
v_and_b32_dpp v53, v36, v5 row_newbcast:5 row_mask:0xf bank_mask:0xf
v_and_b32_dpp v54, v36, v6 row_newbcast:5 row_mask:0xf bank_mask:0xf
v_and_b32_dpp v55, v36, v7 row_newbcast:5 row_mask:0xf bank_mask:0xf
s_cbranch_vccnz L_A_w39
s_waitcnt vmcnt(5)
L_A_w39:
s_waitcnt vmcnt(7)
buffer_load_dwordx4 v[72:75], v9, s[44:47], s36 offen offset:2048 nt
v_mfma_f32_16x16x32_bf16 v[48:51], v[52:55], v[88:91], v[48:51]
v_and_b32_dpp v56, v36, v4 row_newbcast:13 row_mask:0xf bank_mask:0xf
v_and_b32_dpp v57, v36, v5 row_newbcast:13 row_mask:0xf bank_mask:0xf
v_and_b32_dpp v58, v36, v6 row_newbcast:13 row_mask:0xf bank_mask:0xf
v_and_b32_dpp v59, v36, v7 row_newbcast:13 row_mask:0xf bank_mask:0xf
s_cbranch_vccnz L_A_w40
s_waitcnt vmcnt(5)
L_A_w40:
s_waitcnt vmcnt(7)
buffer_load_dwordx4 v[76:79], v9, s[44:47], s36 offen offset:3072 nt
ds_add_u32 v192, v193 offset:256
v_mfma_f32_16x16x32_bf16 v[48:51], v[56:59], v[92:95], v[48:51]
v_and_b32_dpp v52, v36, v12 row_newbcast:3 row_mask:0xf bank_mask:0xf
v_and_b32_dpp v53, v36, v13 row_newbcast:3 row_mask:0xf bank_mask:0xf
v_and_b32_dpp v54, v36, v14 row_newbcast:3 row_mask:0xf bank_mask:0xf
v_and_b32_dpp v55, v36, v15 row_newbcast:3 row_mask:0xf bank_mask:0xf
s_cbranch_vccnz L_A_w41
s_waitcnt vmcnt(5)
L_A_w41:
s_waitcnt vmcnt(7)
s_add_u32 s36, s36, 0x18000
buffer_load_dwordx4 v[80:83], v8, s[44:47], s36 offen offset:0 nt
v_mfma_f32_16x16x32_bf16 v[48:51], v[52:55], v[96:99], v[48:51]
v_and_b32_dpp v56, v36, v12 row_newbcast:11 row_mask:0xf bank_mask:0xf
v_and_b32_dpp v57, v36, v13 row_newbcast:11 row_mask:0xf bank_mask:0xf
v_and_b32_dpp v58, v36, v14 row_newbcast:11 row_mask:0xf bank_mask:0xf
v_and_b32_dpp v59, v36, v15 row_newbcast:11 row_mask:0xf bank_mask:0xf
s_cbranch_vccnz L_A_w42
s_waitcnt vmcnt(5)
L_A_w42:
s_waitcnt vmcnt(7)
buffer_load_dwordx4 v[84:87], v8, s[44:47], s36 offen offset:1024 nt
ds_add_u32 v192, v193 offset:256
v_mfma_f32_16x16x32_bf16 v[48:51], v[56:59], v[100:103], v[48:51]
v_and_b32_dpp v52, v36, v12 row_newbcast:7 row_mask:0xf bank_mask:0xf
v_and_b32_dpp v53, v36, v13 row_newbcast:7 row_mask:0xf bank_mask:0xf
v_and_b32_dpp v54, v36, v14 row_newbcast:7 row_mask:0xf bank_mask:0xf
v_and_b32_dpp v55, v36, v15 row_newbcast:7 row_mask:0xf bank_mask:0xf
s_cbranch_vccnz L_A_w43
s_waitcnt vmcnt(5)
L_A_w43:
s_waitcnt vmcnt(7)
buffer_load_dwordx4 v[88:91], v8, s[44:47], s36 offen offset:2048 nt
v_mfma_f32_16x16x32_bf16 v[48:51], v[52:55], v[104:107], v[48:51]
v_and_b32_dpp v56, v36, v12 row_newbcast:15 row_mask:0xf bank_mask:0xf
v_and_b32_dpp v57, v36, v13 row_newbcast:15 row_mask:0xf bank_mask:0xf
v_and_b32_dpp v58, v36, v14 row_newbcast:15 row_mask:0xf bank_mask:0xf
v_and_b32_dpp v59, v36, v15 row_newbcast:15 row_mask:0xf bank_mask:0xf
s_cbranch_vccnz L_A_w44
s_waitcnt vmcnt(5)
L_A_w44:
s_waitcnt vmcnt(7)
buffer_load_dwordx4 v[92:95], v8, s[44:47], s36 offen offset:3072 nt
ds_add_u32 v192, v193 offset:256
v_mfma_f32_16x16x32_bf16 v[48:51], v[56:59], v[108:111], v[48:51]
v_mov_b32 v36, v37
v_mov_b32 v37, v38
v_mov_b32 v38, v39
v_mov_b32 v39, v40
v_mov_b32 v40, v41
v_mov_b32 v41, v42
v_mov_b32 v42, v43
v_mov_b32 v43, v44
v_mov_b32 v44, v45
v_mov_b32 v45, v46
v_and_b32_dpp v52, v36, v4 row_newbcast:0 row_mask:0xf bank_mask:0xf
v_and_b32_dpp v53, v36, v5 row_newbcast:0 row_mask:0xf bank_mask:0xf
v_and_b32_dpp v54, v36, v6 row_newbcast:0 row_mask:0xf bank_mask:0xf
v_and_b32_dpp v55, v36, v7 row_newbcast:0 row_mask:0xf bank_mask:0xf
s_sub_u32 s38, s38, 1
s_cmp_lg_u32 s38, 0
s_cbranch_scc1 L_A_va
s_waitcnt vmcnt(8)
buffer_load_dwordx4 v[96:99], v9, s[44:47], s36 offen offset:0 nt
v_mfma_f32_16x16x32_bf16 v[48:51], v[52:55], v[112:115], v[48:51]
v_and_b32_dpp v56, v36, v4 row_newbcast:8 row_mask:0xf bank_mask:0xf
v_and_b32_dpp v57, v36, v5 row_newbcast:8 row_mask:0xf bank_mask:0xf
v_and_b32_dpp v58, v36, v6 row_newbcast:8 row_mask:0xf bank_mask:0xf
v_and_b32_dpp v59, v36, v7 row_newbcast:8 row_mask:0xf bank_mask:0xf
s_mov_b32 s64, 0
L_A_sw:
ds_read_b32 v60, v47 offset:4
s_waitcnt lgkmcnt(0)
v_readfirstlane_b32 s65, v60
s_add_u32 s64, s64, 1
s_nop 2
s_cmp_ge_u32 s65, 4
s_cbranch_scc1 L_A_sw_ok
s_sleep 1
s_cmp_lt_u32 s64, 1048576
s_cbranch_scc1 L_A_sw
L_A_sw_ok:
v_lshrrev_b32 v60, 1, v3
v_lshlrev_b32 v60, 4, v60
s_lshl_b32 s62, s34, 2
v_add_u32 v61, s62, v60
ds_read_b128 v[24:27], v60 offset:64
ds_read_b32 v63, v61 offset:64
s_waitcnt vmcnt(8)
buffer_load_dwordx4 v[100:103], v9, s[44:47], s36 offen offset:1024 nt
ds_add_u32 v192, v193 offset:256
v_mfma_f32_16x16x32_bf16 v[48:51], v[56:59], v[116:119], v[48:51]
v_and_b32_dpp v52, v36, v4 row_newbcast:4 row_mask:0xf bank_mask:0xf
v_and_b32_dpp v53, v36, v5 row_newbcast:4 row_mask:0xf bank_mask:0xf
v_and_b32_dpp v54, v36, v6 row_newbcast:4 row_mask:0xf bank_mask:0xf
v_and_b32_dpp v55, v36, v7 row_newbcast:4 row_mask:0xf bank_mask:0xf
s_waitcnt vmcnt(8)
buffer_load_dwordx4 v[104:107], v9, s[44:47], s36 offen offset:2048 nt
v_mfma_f32_16x16x32_bf16 v[48:51], v[52:55], v[120:123], v[48:51]
v_and_b32_dpp v56, v36, v4 row_newbcast:12 row_mask:0xf bank_mask:0xf
v_and_b32_dpp v57, v36, v5 row_newbcast:12 row_mask:0xf bank_mask:0xf
v_and_b32_dpp v58, v36, v6 row_newbcast:12 row_mask:0xf bank_mask:0xf
v_and_b32_dpp v59, v36, v7 row_newbcast:12 row_mask:0xf bank_mask:0xf
s_waitcnt lgkmcnt(0)
v_max3_f32 v60, v24, v25, v26
v_max_f32 v60, v60, v27
v_sub_f32 v63, v63, v60
v_exp_f32 v63, v63
v_lshrrev_b32 v62, 1, v3
v_mul_u32_u24 v62, 1152, v62
v_lshl_add_u32 v62, v2, 3, v62
v_and_b32 v61, 1, v3
v_lshl_add_u32 v62, v61, 2, v62
s_mul_i32 s62, s34, 288
s_add_u32 s62, s62, 8192
v_add_u32 v62, s62, v62
s_waitcnt vmcnt(8)
buffer_load_dwordx4 v[108:111], v9, s[44:47], s36 offen offset:3072 nt
ds_add_u32 v192, v193 offset:256
v_mfma_f32_16x16x32_bf16 v[48:51], v[56:59], v[124:127], v[48:51]
v_and_b32_dpp v52, v36, v12 row_newbcast:2 row_mask:0xf bank_mask:0xf
v_and_b32_dpp v53, v36, v13 row_newbcast:2 row_mask:0xf bank_mask:0xf
v_and_b32_dpp v54, v36, v14 row_newbcast:2 row_mask:0xf bank_mask:0xf
v_and_b32_dpp v55, v36, v15 row_newbcast:2 row_mask:0xf bank_mask:0xf
s_waitcnt vmcnt(8)
s_add_u32 s36, s36, 0x18000
buffer_load_dwordx4 v[112:115], v8, s[44:47], s36 offen offset:0 nt
v_mfma_f32_16x16x32_bf16 v[48:51], v[52:55], v[64:67], v[48:51]
v_and_b32_dpp v56, v36, v12 row_newbcast:10 row_mask:0xf bank_mask:0xf
v_and_b32_dpp v57, v36, v13 row_newbcast:10 row_mask:0xf bank_mask:0xf
v_and_b32_dpp v58, v36, v14 row_newbcast:10 row_mask:0xf bank_mask:0xf
v_and_b32_dpp v59, v36, v15 row_newbcast:10 row_mask:0xf bank_mask:0xf
s_waitcnt vmcnt(8)
buffer_load_dwordx4 v[116:119], v8, s[44:47], s36 offen offset:1024 nt
ds_add_u32 v192, v193 offset:256
v_mfma_f32_16x16x32_bf16 v[48:51], v[56:59], v[68:71], v[48:51]
v_and_b32_dpp v52, v36, v12 row_newbcast:6 row_mask:0xf bank_mask:0xf
v_and_b32_dpp v53, v36, v13 row_newbcast:6 row_mask:0xf bank_mask:0xf
v_and_b32_dpp v54, v36, v14 row_newbcast:6 row_mask:0xf bank_mask:0xf
v_and_b32_dpp v55, v36, v15 row_newbcast:6 row_mask:0xf bank_mask:0xf
s_waitcnt vmcnt(8)
buffer_load_dwordx4 v[120:123], v8, s[44:47], s36 offen offset:2048 nt
v_mfma_f32_16x16x32_bf16 v[48:51], v[52:55], v[72:75], v[48:51]
v_and_b32_dpp v56, v36, v12 row_newbcast:14 row_mask:0xf bank_mask:0xf
v_and_b32_dpp v57, v36, v13 row_newbcast:14 row_mask:0xf bank_mask:0xf
v_and_b32_dpp v58, v36, v14 row_newbcast:14 row_mask:0xf bank_mask:0xf
v_and_b32_dpp v59, v36, v15 row_newbcast:14 row_mask:0xf bank_mask:0xf
s_waitcnt vmcnt(8)
buffer_load_dwordx4 v[124:127], v8, s[44:47], s36 offen offset:3072 nt
ds_add_u32 v192, v193 offset:256
v_mfma_f32_16x16x32_bf16 v[48:51], v[56:59], v[76:79], v[48:51]
v_and_b32_dpp v52, v36, v4 row_newbcast:1 row_mask:0xf bank_mask:0xf
v_and_b32_dpp v53, v36, v5 row_newbcast:1 row_mask:0xf bank_mask:0xf
v_and_b32_dpp v54, v36, v6 row_newbcast:1 row_mask:0xf bank_mask:0xf
v_and_b32_dpp v55, v36, v7 row_newbcast:1 row_mask:0xf bank_mask:0xf
s_waitcnt vmcnt(8)
buffer_load_dwordx4 v[64:67], v9, s[44:47], s36 offen offset:0 nt
v_mfma_f32_16x16x32_bf16 v[48:51], v[52:55], v[80:83], v[48:51]
v_and_b32_dpp v56, v36, v4 row_newbcast:9 row_mask:0xf bank_mask:0xf
v_and_b32_dpp v57, v36, v5 row_newbcast:9 row_mask:0xf bank_mask:0xf
v_and_b32_dpp v58, v36, v6 row_newbcast:9 row_mask:0xf bank_mask:0xf
v_and_b32_dpp v59, v36, v7 row_newbcast:9 row_mask:0xf bank_mask:0xf
s_waitcnt vmcnt(8)
buffer_load_dwordx4 v[68:71], v9, s[44:47], s36 offen offset:1024 nt
ds_add_u32 v192, v193 offset:256
v_mfma_f32_16x16x32_bf16 v[48:51], v[56:59], v[84:87], v[48:51]
v_and_b32_dpp v52, v36, v4 row_newbcast:5 row_mask:0xf bank_mask:0xf
v_and_b32_dpp v53, v36, v5 row_newbcast:5 row_mask:0xf bank_mask:0xf
v_and_b32_dpp v54, v36, v6 row_newbcast:5 row_mask:0xf bank_mask:0xf
v_and_b32_dpp v55, v36, v7 row_newbcast:5 row_mask:0xf bank_mask:0xf
s_waitcnt vmcnt(8)
buffer_load_dwordx4 v[72:75], v9, s[44:47], s36 offen offset:2048 nt
v_mfma_f32_16x16x32_bf16 v[48:51], v[52:55], v[88:91], v[48:51]
v_and_b32_dpp v56, v36, v4 row_newbcast:13 row_mask:0xf bank_mask:0xf
v_and_b32_dpp v57, v36, v5 row_newbcast:13 row_mask:0xf bank_mask:0xf
v_and_b32_dpp v58, v36, v6 row_newbcast:13 row_mask:0xf bank_mask:0xf
v_and_b32_dpp v59, v36, v7 row_newbcast:13 row_mask:0xf bank_mask:0xf
s_waitcnt vmcnt(8)
buffer_load_dwordx4 v[76:79], v9, s[44:47], s36 offen offset:3072 nt
ds_add_u32 v192, v193 offset:256
v_mfma_f32_16x16x32_bf16 v[48:51], v[56:59], v[92:95], v[48:51]
v_and_b32_dpp v52, v36, v12 row_newbcast:3 row_mask:0xf bank_mask:0xf
v_and_b32_dpp v53, v36, v13 row_newbcast:3 row_mask:0xf bank_mask:0xf
v_and_b32_dpp v54, v36, v14 row_newbcast:3 row_mask:0xf bank_mask:0xf
v_and_b32_dpp v55, v36, v15 row_newbcast:3 row_mask:0xf bank_mask:0xf
s_waitcnt vmcnt(8)
buffer_load_dwordx4 v[80:83], v8, s[44:47], s37 offen nt
v_mfma_f32_16x16x32_bf16 v[48:51], v[52:55], v[96:99], v[48:51]
v_and_b32_dpp v56, v36, v12 row_newbcast:11 row_mask:0xf bank_mask:0xf
v_and_b32_dpp v57, v36, v13 row_newbcast:11 row_mask:0xf bank_mask:0xf
v_and_b32_dpp v58, v36, v14 row_newbcast:11 row_mask:0xf bank_mask:0xf
v_and_b32_dpp v59, v36, v15 row_newbcast:11 row_mask:0xf bank_mask:0xf
s_waitcnt vmcnt(8)
buffer_load_dwordx4 v[84:87], v10, s[44:47], s37 offen nt
ds_add_u32 v192, v193 offset:256
v_mfma_f32_16x16x32_bf16 v[48:51], v[56:59], v[100:103], v[48:51]
v_and_b32_dpp v52, v36, v12 row_newbcast:7 row_mask:0xf bank_mask:0xf
v_and_b32_dpp v53, v36, v13 row_newbcast:7 row_mask:0xf bank_mask:0xf
v_and_b32_dpp v54, v36, v14 row_newbcast:7 row_mask:0xf bank_mask:0xf
v_and_b32_dpp v55, v36, v15 row_newbcast:7 row_mask:0xf bank_mask:0xf
s_waitcnt vmcnt(8)
buffer_load_dwordx4 v[88:91], v9, s[44:47], s37 offen nt
v_mfma_f32_16x16x32_bf16 v[48:51], v[52:55], v[104:107], v[48:51]
v_and_b32_dpp v56, v36, v12 row_newbcast:15 row_mask:0xf bank_mask:0xf
v_and_b32_dpp v57, v36, v13 row_newbcast:15 row_mask:0xf bank_mask:0xf
v_and_b32_dpp v58, v36, v14 row_newbcast:15 row_mask:0xf bank_mask:0xf
v_and_b32_dpp v59, v36, v15 row_newbcast:15 row_mask:0xf bank_mask:0xf
s_waitcnt vmcnt(8)
buffer_load_dwordx4 v[92:95], v11, s[44:47], s37 offen nt
ds_add_u32 v192, v193 offset:256
v_mfma_f32_16x16x32_bf16 v[48:51], v[56:59], v[108:111], v[48:51]
v_mov_b32 v36, v37
v_mov_b32 v37, v38
v_mov_b32 v38, v39
v_mov_b32 v39, v40
v_mov_b32 v40, v41
v_mov_b32 v41, v42
v_mov_b32 v42, v43
v_mov_b32 v43, v44
v_mov_b32 v44, v45
v_mov_b32 v45, v46
v_and_b32_dpp v52, v36, v4 row_newbcast:0 row_mask:0xf bank_mask:0xf
v_and_b32_dpp v53, v36, v5 row_newbcast:0 row_mask:0xf bank_mask:0xf
v_and_b32_dpp v54, v36, v6 row_newbcast:0 row_mask:0xf bank_mask:0xf
v_and_b32_dpp v55, v36, v7 row_newbcast:0 row_mask:0xf bank_mask:0xf
s_nop 0
s_nop 0
v_mfma_f32_16x16x32_bf16 v[48:51], v[52:55], v[112:115], v[48:51]
v_and_b32_dpp v56, v36, v4 row_newbcast:8 row_mask:0xf bank_mask:0xf
v_and_b32_dpp v57, v36, v5 row_newbcast:8 row_mask:0xf bank_mask:0xf
v_and_b32_dpp v58, v36, v6 row_newbcast:8 row_mask:0xf bank_mask:0xf
v_and_b32_dpp v59, v36, v7 row_newbcast:8 row_mask:0xf bank_mask:0xf
s_nop 0
s_nop 0
v_mfma_f32_16x16x32_bf16 v[48:51], v[56:59], v[116:119], v[48:51]
v_and_b32_dpp v52, v36, v4 row_newbcast:4 row_mask:0xf bank_mask:0xf
v_and_b32_dpp v53, v36, v5 row_newbcast:4 row_mask:0xf bank_mask:0xf
v_and_b32_dpp v54, v36, v6 row_newbcast:4 row_mask:0xf bank_mask:0xf
v_and_b32_dpp v55, v36, v7 row_newbcast:4 row_mask:0xf bank_mask:0xf
s_nop 0
s_nop 0
v_mfma_f32_16x16x32_bf16 v[48:51], v[52:55], v[120:123], v[48:51]
v_and_b32_dpp v56, v36, v4 row_newbcast:12 row_mask:0xf bank_mask:0xf
v_and_b32_dpp v57, v36, v5 row_newbcast:12 row_mask:0xf bank_mask:0xf
v_and_b32_dpp v58, v36, v6 row_newbcast:12 row_mask:0xf bank_mask:0xf
v_and_b32_dpp v59, v36, v7 row_newbcast:12 row_mask:0xf bank_mask:0xf
s_waitcnt vmcnt(8)
s_nop 0
v_mfma_f32_16x16x32_bf16 v[48:51], v[56:59], v[124:127], v[48:51]
v_and_b32_dpp v52, v36, v12 row_newbcast:2 row_mask:0xf bank_mask:0xf
v_and_b32_dpp v53, v36, v13 row_newbcast:2 row_mask:0xf bank_mask:0xf
v_and_b32_dpp v54, v36, v14 row_newbcast:2 row_mask:0xf bank_mask:0xf
v_and_b32_dpp v55, v36, v15 row_newbcast:2 row_mask:0xf bank_mask:0xf
s_waitcnt vmcnt(7)
s_nop 0
v_mfma_f32_16x16x32_bf16 v[48:51], v[52:55], v[64:67], v[48:51]
v_and_b32_dpp v56, v36, v12 row_newbcast:10 row_mask:0xf bank_mask:0xf
v_and_b32_dpp v57, v36, v13 row_newbcast:10 row_mask:0xf bank_mask:0xf
v_and_b32_dpp v58, v36, v14 row_newbcast:10 row_mask:0xf bank_mask:0xf
v_and_b32_dpp v59, v36, v15 row_newbcast:10 row_mask:0xf bank_mask:0xf
s_waitcnt vmcnt(6)
s_nop 0
v_mfma_f32_16x16x32_bf16 v[48:51], v[56:59], v[68:71], v[48:51]
v_and_b32_dpp v52, v36, v12 row_newbcast:6 row_mask:0xf bank_mask:0xf
v_and_b32_dpp v53, v36, v13 row_newbcast:6 row_mask:0xf bank_mask:0xf
v_and_b32_dpp v54, v36, v14 row_newbcast:6 row_mask:0xf bank_mask:0xf
v_and_b32_dpp v55, v36, v15 row_newbcast:6 row_mask:0xf bank_mask:0xf
s_waitcnt vmcnt(5)
s_nop 0
v_mfma_f32_16x16x32_bf16 v[48:51], v[52:55], v[72:75], v[48:51]
v_and_b32_dpp v56, v36, v12 row_newbcast:14 row_mask:0xf bank_mask:0xf
v_and_b32_dpp v57, v36, v13 row_newbcast:14 row_mask:0xf bank_mask:0xf
v_and_b32_dpp v58, v36, v14 row_newbcast:14 row_mask:0xf bank_mask:0xf
v_and_b32_dpp v59, v36, v15 row_newbcast:14 row_mask:0xf bank_mask:0xf
s_waitcnt vmcnt(4)
s_nop 0
v_mfma_f32_16x16x32_bf16 v[48:51], v[56:59], v[76:79], v[48:51]
v_and_b32_dpp v52, v36, v4 row_newbcast:1 row_mask:0xf bank_mask:0xf
v_and_b32_dpp v53, v36, v5 row_newbcast:1 row_mask:0xf bank_mask:0xf
v_and_b32_dpp v54, v36, v6 row_newbcast:1 row_mask:0xf bank_mask:0xf
v_and_b32_dpp v55, v36, v7 row_newbcast:1 row_mask:0xf bank_mask:0xf
s_waitcnt vmcnt(3)
s_nop 0
v_mfma_f32_16x16x32_bf16 v[48:51], v[52:55], v[80:83], v[48:51]
v_and_b32_dpp v56, v36, v4 row_newbcast:9 row_mask:0xf bank_mask:0xf
v_and_b32_dpp v57, v36, v5 row_newbcast:9 row_mask:0xf bank_mask:0xf
v_and_b32_dpp v58, v36, v6 row_newbcast:9 row_mask:0xf bank_mask:0xf
v_and_b32_dpp v59, v36, v7 row_newbcast:9 row_mask:0xf bank_mask:0xf
s_waitcnt vmcnt(2)
s_nop 0
v_mfma_f32_16x16x32_bf16 v[48:51], v[56:59], v[84:87], v[48:51]
v_and_b32_dpp v52, v36, v12 row_newbcast:3 row_mask:0xf bank_mask:0xf
v_and_b32_dpp v53, v36, v13 row_newbcast:3 row_mask:0xf bank_mask:0xf
v_and_b32_dpp v54, v36, v14 row_newbcast:3 row_mask:0xf bank_mask:0xf
v_and_b32_dpp v55, v36, v15 row_newbcast:3 row_mask:0xf bank_mask:0xf
s_waitcnt vmcnt(1)
s_nop 0
v_mfma_f32_16x16x32_bf16 v[48:51], v[52:55], v[88:91], v[48:51]
v_and_b32_dpp v56, v36, v12 row_newbcast:11 row_mask:0xf bank_mask:0xf
v_and_b32_dpp v57, v36, v13 row_newbcast:11 row_mask:0xf bank_mask:0xf
v_and_b32_dpp v58, v36, v14 row_newbcast:11 row_mask:0xf bank_mask:0xf
v_and_b32_dpp v59, v36, v15 row_newbcast:11 row_mask:0xf bank_mask:0xf
s_waitcnt vmcnt(0)
s_nop 0
v_mfma_f32_16x16x32_bf16 v[48:51], v[56:59], v[92:95], v[48:51]
s_nop 7
v_pk_mul_f32 v[48:49], v[48:49], v[62:63] op_sel:[0,1] op_sel_hi:[1,1]
v_pk_mul_f32 v[50:51], v[50:51], v[62:63] op_sel:[0,1] op_sel_hi:[1,1]
v_cvt_pk_bf16_f32 v48, v48, v49
v_cvt_pk_bf16_f32 v49, v50, v51
ds_write2_b32 v62, v48, v49 offset1:36
s_waitcnt lgkmcnt(0)
s_barrier
s_endpgm
L_A_helper:
s_mov_b32 s89, s32
v_and_b32 v1, 63, v0
v_and_b32 v2, 15, v0
v_bfe_u32 v3, v0, 4, 2
s_waitcnt lgkmcnt(0)
s_sub_u32 s35, s34, 4
s_lshl_b32 s37, s32, 3
s_add_u32 s37, s37, s33
s_cmp_lg_u32 s35, 0
s_cbranch_scc1 L_A_noclr
s_lshl_b32 s63, s37, 10
s_add_u32 s63, s63, 0x100000
v_lshl_add_u32 v10, v1, 4, s63
v_add_u32 v11, 0x40000, v10
v_mov_b32 v44, -1
v_mov_b32 v45, -1
v_mov_b32 v46, -1
v_mov_b32 v47, -1
global_store_dwordx4 v10, v[44:47], s[30:31] sc1
global_store_dwordx4 v11, v[44:47], s[30:31] sc1
L_A_noclr:
s_lshl_b32 s62, s89, 17
s_mov_b32 s63, 0x20000
s_add_u32 s40, s12, s62
s_addc_u32 s41, s13, 0
s_and_b32 s41, s41, 0xffff
s_mov_b32 s42, s63
s_mov_b32 s43, 0x20000
v_lshlrev_b32 v9, 13, v3
v_lshl_add_u32 v9, v2, 4, v9
s_lshl_b32 s62, s35, 8
v_add_u32 v9, s62, v9
s_mov_b32 s61, 0
buffer_load_dwordx4 v[184:187], v9, s[40:43], s61 offen offset:0
buffer_load_dwordx4 v[188:191], v9, s[40:43], s61 offen offset:1024
buffer_load_dwordx4 v[192:195], v9, s[40:43], s61 offen offset:2048
buffer_load_dwordx4 v[196:199], v9, s[40:43], s61 offen offset:3072
v_mov_b32 v8, 0
v_mov_b32 v11, 0
ds_write_b32 v8, v8 offset:0
ds_write_b32 v8, v8 offset:4
ds_write_b32 v8, v8 offset:8
ds_write_b32 v8, v8 offset:256
s_waitcnt lgkmcnt(0)
s_barrier
s_load_dword s88, s[30:31], 0x18000
s_mov_b32 s66, 0x05040100
s_mov_b32 s67, 0x07060302
s_mov_b32 s44, s30
s_and_b32 s45, s31, 0xffff
s_mov_b32 s46, 0x1000000
s_mov_b32 s47, 0x20000
s_lshl_b32 s63, s32, 10
s_add_u32 s63, s63, 0x40000
v_lshl_add_u32 v10, v1, 4, s63
v_lshlrev_b32 v11, 3, v1
s_mov_b32 s38, s35
s_waitcnt lgkmcnt(0)
s_add_u32 s88, s88, 0x9e3779b9
s_waitcnt vmcnt(3)
s_mov_b32 s61, 4096
buffer_load_dwordx4 v[200:203], v9, s[40:43], s61 offen offset:0
s_waitcnt vmcnt(3)
buffer_load_dwordx4 v[204:207], v9, s[40:43], s61 offen offset:1024
v_perm_b32 v56, v188, v184, s66
v_perm_b32 v64, v188, v184, s67
v_perm_b32 v72, v189, v185, s66
v_perm_b32 v80, v189, v185, s67
v_perm_b32 v88, v190, v186, s66
v_perm_b32 v96, v190, v186, s67
v_perm_b32 v104, v191, v187, s66
v_perm_b32 v112, v191, v187, s67
s_waitcnt vmcnt(3)
buffer_load_dwordx4 v[208:211], v9, s[40:43], s61 offen offset:2048
s_waitcnt vmcnt(3)
buffer_load_dwordx4 v[212:215], v9, s[40:43], s61 offen offset:3072
v_perm_b32 v57, v196, v192, s66
v_perm_b32 v65, v196, v192, s67
v_perm_b32 v73, v197, v193, s66
v_perm_b32 v81, v197, v193, s67
v_perm_b32 v89, v198, v194, s66
v_perm_b32 v97, v198, v194, s67
v_perm_b32 v105, v199, v195, s66
v_perm_b32 v113, v199, v195, s67
s_waitcnt vmcnt(3)
s_mov_b32 s61, 32768
buffer_load_dwordx4 v[216:219], v9, s[40:43], s61 offen offset:0
s_waitcnt vmcnt(3)
buffer_load_dwordx4 v[220:223], v9, s[40:43], s61 offen offset:1024
v_perm_b32 v58, v204, v200, s66
v_perm_b32 v66, v204, v200, s67
v_perm_b32 v74, v205, v201, s66
v_perm_b32 v82, v205, v201, s67
v_perm_b32 v90, v206, v202, s66
v_perm_b32 v98, v206, v202, s67
v_perm_b32 v106, v207, v203, s66
v_perm_b32 v114, v207, v203, s67
s_waitcnt vmcnt(3)
buffer_load_dwordx4 v[224:227], v9, s[40:43], s61 offen offset:2048
s_waitcnt vmcnt(3)
buffer_load_dwordx4 v[228:231], v9, s[40:43], s61 offen offset:3072
v_perm_b32 v59, v212, v208, s66
v_perm_b32 v67, v212, v208, s67
v_perm_b32 v75, v213, v209, s66
v_perm_b32 v83, v213, v209, s67
v_perm_b32 v91, v214, v210, s66
v_perm_b32 v99, v214, v210, s67
v_perm_b32 v107, v215, v211, s66
v_perm_b32 v115, v215, v211, s67
s_waitcnt vmcnt(3)
s_mov_b32 s61, 36864
buffer_load_dwordx4 v[232:235], v9, s[40:43], s61 offen offset:0
s_waitcnt vmcnt(3)
buffer_load_dwordx4 v[236:239], v9, s[40:43], s61 offen offset:1024
v_perm_b32 v60, v220, v216, s66
v_perm_b32 v68, v220, v216, s67
v_perm_b32 v76, v221, v217, s66
v_perm_b32 v84, v221, v217, s67
v_perm_b32 v92, v222, v218, s66
v_perm_b32 v100, v222, v218, s67
v_perm_b32 v108, v223, v219, s66
v_perm_b32 v116, v223, v219, s67
s_waitcnt vmcnt(3)
buffer_load_dwordx4 v[240:243], v9, s[40:43], s61 offen offset:2048
s_waitcnt vmcnt(3)
buffer_load_dwordx4 v[244:247], v9, s[40:43], s61 offen offset:3072
v_perm_b32 v61, v228, v224, s66
v_perm_b32 v69, v228, v224, s67
v_perm_b32 v77, v229, v225, s66
v_perm_b32 v85, v229, v225, s67
v_perm_b32 v93, v230, v226, s66
v_perm_b32 v101, v230, v226, s67
v_perm_b32 v109, v231, v227, s66
v_perm_b32 v117, v231, v227, s67
s_waitcnt vmcnt(3)
s_mov_b32 s61, 65536
buffer_load_dwordx4 v[184:187], v9, s[40:43], s61 offen offset:0
s_waitcnt vmcnt(3)
buffer_load_dwordx4 v[188:191], v9, s[40:43], s61 offen offset:1024
v_perm_b32 v62, v236, v232, s66
v_perm_b32 v70, v236, v232, s67
v_perm_b32 v78, v237, v233, s66
v_perm_b32 v86, v237, v233, s67
v_perm_b32 v94, v238, v234, s66
v_perm_b32 v102, v238, v234, s67
v_perm_b32 v110, v239, v235, s66
v_perm_b32 v118, v239, v235, s67
s_waitcnt vmcnt(3)
buffer_load_dwordx4 v[192:195], v9, s[40:43], s61 offen offset:2048
s_waitcnt vmcnt(3)
buffer_load_dwordx4 v[196:199], v9, s[40:43], s61 offen offset:3072
v_perm_b32 v63, v244, v240, s66
v_perm_b32 v71, v244, v240, s67
v_perm_b32 v79, v245, v241, s66
v_perm_b32 v87, v245, v241, s67
v_perm_b32 v95, v246, v242, s66
v_perm_b32 v103, v246, v242, s67
v_perm_b32 v111, v247, v243, s66
v_perm_b32 v119, v247, v243, s67
s_waitcnt vmcnt(3)
s_mov_b32 s61, 69632
buffer_load_dwordx4 v[200:203], v9, s[40:43], s61 offen offset:0
s_waitcnt vmcnt(3)
buffer_load_dwordx4 v[204:207], v9, s[40:43], s61 offen offset:1024
v_perm_b32 v120, v188, v184, s66
v_perm_b32 v128, v188, v184, s67
v_perm_b32 v136, v189, v185, s66
v_perm_b32 v144, v189, v185, s67
v_perm_b32 v152, v190, v186, s66
v_perm_b32 v160, v190, v186, s67
v_perm_b32 v168, v191, v187, s66
v_perm_b32 v176, v191, v187, s67
s_waitcnt vmcnt(3)
buffer_load_dwordx4 v[208:211], v9, s[40:43], s61 offen offset:2048
s_waitcnt vmcnt(3)
buffer_load_dwordx4 v[212:215], v9, s[40:43], s61 offen offset:3072
v_perm_b32 v121, v196, v192, s66
v_perm_b32 v129, v196, v192, s67
v_perm_b32 v137, v197, v193, s66
v_perm_b32 v145, v197, v193, s67
v_perm_b32 v153, v198, v194, s66
v_perm_b32 v161, v198, v194, s67
v_perm_b32 v169, v199, v195, s66
v_perm_b32 v177, v199, v195, s67
s_waitcnt vmcnt(3)
s_cmp_lg_u32 s38, 0
s_cbranch_scc1 L_A_qt20
buffer_load_dwordx4 v[44:47], v10, s[44:47], 0 offen sc1
L_A_qt20:
s_mov_b32 s61, 98304
buffer_load_dwordx4 v[216:219], v9, s[40:43], s61 offen offset:0
s_waitcnt vmcnt(3)
buffer_load_dwordx4 v[220:223], v9, s[40:43], s61 offen offset:1024
v_perm_b32 v122, v204, v200, s66
v_perm_b32 v130, v204, v200, s67
v_perm_b32 v138, v205, v201, s66
v_perm_b32 v146, v205, v201, s67
v_perm_b32 v154, v206, v202, s66
v_perm_b32 v162, v206, v202, s67
v_perm_b32 v170, v207, v203, s66
v_perm_b32 v178, v207, v203, s67
s_waitcnt vmcnt(3)
buffer_load_dwordx4 v[224:227], v9, s[40:43], s61 offen offset:2048
s_waitcnt vmcnt(3)
buffer_load_dwordx4 v[228:231], v9, s[40:43], s61 offen offset:3072
v_perm_b32 v123, v212, v208, s66
v_perm_b32 v131, v212, v208, s67
v_perm_b32 v139, v213, v209, s66
v_perm_b32 v147, v213, v209, s67
v_perm_b32 v155, v214, v210, s66
v_perm_b32 v163, v214, v210, s67
v_perm_b32 v171, v215, v211, s66
v_perm_b32 v179, v215, v211, s67
s_waitcnt vmcnt(3)
s_cmp_lg_u32 s38, 0
s_cbranch_scc1 L_A_qc24
v_cmp_ne_u32 s[62:63], s88, v45
v_cmp_ne_u32 vcc, s88, v47
s_nop 1
s_or_b64 vcc, vcc, s[62:63]
s_cbranch_scc1 L_A_qc24
s_mov_b32 s38, 1
v_mov_b32 v45, v46
v_mov_b32 v46, 1
ds_write_b64 v11, v[44:45] offset:1024
ds_write_b32 v8, v46 offset:0
L_A_qc24:
s_cmp_lg_u32 s38, 0
s_cbranch_scc1 L_A_qt24
buffer_load_dwordx4 v[44:47], v10, s[44:47], 0 offen sc1
L_A_qt24:
s_mov_b32 s61, 102400
buffer_load_dwordx4 v[232:235], v9, s[40:43], s61 offen offset:0
s_waitcnt vmcnt(3)
buffer_load_dwordx4 v[236:239], v9, s[40:43], s61 offen offset:1024
v_perm_b32 v124, v220, v216, s66
v_perm_b32 v132, v220, v216, s67
v_perm_b32 v140, v221, v217, s66
v_perm_b32 v148, v221, v217, s67
v_perm_b32 v156, v222, v218, s66
v_perm_b32 v164, v222, v218, s67
v_perm_b32 v172, v223, v219, s66
v_perm_b32 v180, v223, v219, s67
s_waitcnt vmcnt(3)
buffer_load_dwordx4 v[240:243], v9, s[40:43], s61 offen offset:2048
s_waitcnt vmcnt(3)
buffer_load_dwordx4 v[244:247], v9, s[40:43], s61 offen offset:3072
v_perm_b32 v125, v228, v224, s66
v_perm_b32 v133, v228, v224, s67
v_perm_b32 v141, v229, v225, s66
v_perm_b32 v149, v229, v225, s67
v_perm_b32 v157, v230, v226, s66
v_perm_b32 v165, v230, v226, s67
v_perm_b32 v173, v231, v227, s66
v_perm_b32 v181, v231, v227, s67
s_waitcnt vmcnt(3)
s_cmp_lg_u32 s38, 0
s_cbranch_scc1 L_A_qc28
v_cmp_ne_u32 s[62:63], s88, v45
v_cmp_ne_u32 vcc, s88, v47
s_nop 1
s_or_b64 vcc, vcc, s[62:63]
s_cbranch_scc1 L_A_qc28
s_mov_b32 s38, 1
v_mov_b32 v45, v46
v_mov_b32 v46, 1
ds_write_b64 v11, v[44:45] offset:1024
ds_write_b32 v8, v46 offset:0
L_A_qc28:
s_waitcnt vmcnt(2)
v_perm_b32 v126, v236, v232, s66
v_perm_b32 v134, v236, v232, s67
v_perm_b32 v142, v237, v233, s66
v_perm_b32 v150, v237, v233, s67
v_perm_b32 v158, v238, v234, s66
v_perm_b32 v166, v238, v234, s67
v_perm_b32 v174, v239, v235, s66
v_perm_b32 v182, v239, v235, s67
s_waitcnt vmcnt(1)
s_waitcnt vmcnt(0)
v_perm_b32 v127, v244, v240, s66
v_perm_b32 v135, v244, v240, s67
v_perm_b32 v143, v245, v241, s66
v_perm_b32 v151, v245, v241, s67
v_perm_b32 v159, v246, v242, s66
v_perm_b32 v167, v246, v242, s67
v_perm_b32 v175, v247, v243, s66
v_perm_b32 v183, v247, v243, s67
v_mov_b32 v184, 0
v_mov_b32 v185, 0
v_mov_b32 v186, 0
v_mov_b32 v187, 0
v_mov_b32 v188, 0
v_mov_b32 v189, 0
v_mov_b32 v190, 0
v_mov_b32 v191, 0
v_mov_b32 v192, 0
v_mov_b32 v193, 0
v_mov_b32 v194, 0
v_mov_b32 v195, 0
v_mov_b32 v196, 0
v_mov_b32 v197, 0
v_mov_b32 v198, 0
v_mov_b32 v199, 0
v_mov_b32 v200, 0
v_mov_b32 v201, 0
v_mov_b32 v202, 0
v_mov_b32 v203, 0
v_mov_b32 v204, 0
v_mov_b32 v205, 0
v_mov_b32 v206, 0
v_mov_b32 v207, 0
v_mov_b32 v208, 0
v_mov_b32 v209, 0
v_mov_b32 v210, 0
v_mov_b32 v211, 0
v_mov_b32 v212, 0
v_mov_b32 v213, 0
v_mov_b32 v214, 0
v_mov_b32 v215, 0
s_mov_b32 s60, s37
s_cmp_lg_u32 s35, 0
s_cbranch_scc1 L_A_nostat
s_cmp_lg_u32 s38, 0
s_cbranch_scc1 L_A_qdone
s_mov_b32 s64, 0
L_tp_Aq:
buffer_load_dwordx4 v[44:47], v10, s[44:47], 0 offen sc1
s_waitcnt vmcnt(0)
v_cmp_ne_u32 s[62:63], s88, v45
v_cmp_ne_u32 vcc, s88, v47
s_add_u32 s64, s64, 1
s_nop 0
s_or_b64 vcc, vcc, s[62:63]
s_cbranch_scc0 L_tp_Aq_ok
s_cmp_lt_u32 s64, 65536
s_cbranch_scc1 L_tp_Aq
L_tp_Aq_ok:
v_mov_b32 v45, v46
v_mov_b32 v46, 1
ds_write_b64 v11, v[44:45] offset:1024
ds_write_b32 v8, v46 offset:0
L_A_qdone:
s_mov_b32 s64, 0
L_A_hs:
ds_read_b32 v10, v8 offset:4
s_waitcnt lgkmcnt(0)
v_readfirstlane_b32 s65, v10
s_add_u32 s64, s64, 1
s_nop 2
s_cmp_ge_u32 s65, 4
s_cbranch_scc1 L_A_hs_ok
s_sleep 16
s_cmp_lt_u32 s64, 1048576
s_cbranch_scc1 L_A_hs
L_A_hs_ok:
s_waitcnt vmcnt(0)
v_and_b32 v10, 1, v1
v_lshlrev_b32 v11, 4, v10
ds_read_b128 v[44:47], v11 offset:64
ds_read_b128 v[48:51], v11 offset:96
v_lshlrev_b32 v10, 12, v10
s_lshl_b32 s63, s60, 4
s_add_u32 s63, s63, 0x14000
v_add_u32 v10, s63, v10
s_lshl_b32 s63, s60, 7
s_add_u32 s63, s63, 0x50000
v_lshl_add_u32 v10, v1, 4, s63
s_waitcnt lgkmcnt(0)
v_max3_f32 v52, v44, v45, v46
v_max_f32 v52, v52, v47
v_sub_f32 v44, v44, v52
v_sub_f32 v45, v45, v52
v_sub_f32 v46, v46, v52
v_sub_f32 v47, v47, v52
v_exp_f32 v44, v44
v_exp_f32 v45, v45
v_exp_f32 v46, v46
v_exp_f32 v47, v47
s_nop 0
v_mul_f32 v54, v44, v48
v_fma_f32 v54, v45, v49, v54
v_fma_f32 v54, v46, v50, v54
v_fma_f32 v54, v47, v51, v54
v_mov_b32 v53, s88
v_mov_b32 v55, s88
s_mov_b64 exec, 255
global_store_dwordx4 v10, v[52:55], s[30:31] sc1
s_mov_b64 exec, -1
L_A_nostat:
s_sub_u32 s63, s35, 1
s_cmp_gt_u32 s63, 1
s_cbranch_scc1 L_A_monx
s_and_b32 s63, s32, 7
s_mul_i32 s63, s63, 0x100
s_add_u32 s63, s63, 0xc0000
s_add_u32 s56, s30, s63
s_addc_u32 s57, s31, 0
s_mov_b32 s64, 0
s_mov_b32 s59, 0
s_lshr_b32 s62, s32, 3
s_mul_i32 s62, s62, 6
s_add_u32 s62, s62, s33
s_lshl_b32 s62, s62, 2
v_mov_b32 v44, s62
v_lshlrev_b32 v48, 2, v1
s_lshr_b32 s65, s62, 2
s_cmp_eq_u32 s35, 1
s_cbranch_scc1 L_A_mon
s_mov_b64 exec, 1
s_mov_b32 s59, -4
L_A_post:
ds_read_b32 v45, v8 offset:256
s_waitcnt lgkmcnt(0)
v_readfirstlane_b32 s58, v45
v_add_u32 v46, s88, v45
s_sub_u32 s63, s58, s59
s_cmp_lt_u32 s63, 4
s_cbranch_scc1 L_A_postn
global_store_dword v44, v46, s[56:57]
s_mov_b32 s59, s58
s_cmp_ge_u32 s58, 640
s_cbranch_scc1 L_A_monx
L_A_postn:
s_sleep 2
s_add_u32 s64, s64, 1
s_cmp_lt_u32 s64, 65536
s_cbranch_scc1 L_A_post
s_branch L_A_monx
L_A_mon:
s_mov_b64 exec, 1
ds_read_b32 v45, v8 offset:256
s_waitcnt lgkmcnt(0)
v_add_u32 v46, s88, v45
v_readfirstlane_b32 s58, v45
s_mov_b64 exec, 0x1ffffff
global_load_dword v49, v48, s[56:57] nt
s_waitcnt vmcnt(0)
v_subrev_u32 v49, s88, v49
s_mov_b64 exec, 0xffffff
v_cmp_le_u32 vcc, 0x400, v49
v_readlane_b32 s62, v49, 24
v_readlane_b32 s59, v49, s65
v_add_u32_dpp v49, v49, v49 row_shr:1 row_mask:0xf bank_mask:0xf bound_ctrl:0
s_nop 1
v_add_u32_dpp v49, v49, v49 row_shr:2 row_mask:0xf bank_mask:0xf bound_ctrl:0
s_nop 1
v_add_u32_dpp v49, v49, v49 row_shr:4 row_mask:0xf bank_mask:0xf bound_ctrl:0
s_nop 1
v_add_u32_dpp v49, v49, v49 row_shr:8 row_mask:0xf bank_mask:0xf bound_ctrl:0
s_nop 0
v_readlane_b32 s61, v49, 15
v_readlane_b32 s63, v49, 23
s_add_u32 s61, s61, s63
s_mul_i32 s63, s59, 24
s_sub_u32 s61, s61, s63
s_cmp_lt_u32 s62, 0x8000
s_cselect_b32 s62, s62, 0x4000
s_add_u32 s61, s61, s62
s_sub_u32 s61, s61, 0x4000
s_mov_b32 s63, -48
s_cmp_lt_u32 s58, 400
s_cselect_b32 s63, s63, -48
s_cmp_gt_i32 s61, s63
s_cselect_b32 s63, 1, 0
s_cmp_eq_u64 vcc, 0
s_cselect_b32 s63, s63, 0
s_cmp_lt_u32 s58, 620
s_cselect_b32 s63, s63, 1
v_mov_b32 v47, s63
ds_write_b32 v8, v47 offset:8
s_mov_b32 s59, s58
s_cmp_ge_u32 s58, 620
s_cbranch_scc1 L_A_monx
s_add_u32 s64, s64, 1
s_cmp_lt_u32 s64, 4096
s_cbranch_scc1 L_A_mon
L_A_monx:
s_mov_b64 exec, -1
v_mul_u32_u24 v10, 144, v2
v_lshl_add_u32 v10, v3, 4, v10
v_and_b32 v28, 1, v2
v_mul_u32_u24 v28, 0xaaaa, v28
v_add_u32 v28, 0x4444, v28
v_lshrrev_b32 v11, 1, v3
v_lshlrev_b32 v11, 18, v11
v_and_b32 v29, 31, v1
v_lshl_add_u32 v11, v29, 3, v11
s_lshl_b32 s63, s60, 10
s_lshl_b32 s62, s35, 8
s_add_u32 s63, s63, s62
s_add_u32 s63, s63, 0x100000
v_add_u32 v11, s63, v11
s_barrier
ds_read_b128 v[12:15], v10 offset:8192
ds_read_b128 v[16:19], v10 offset:8256
s_waitcnt lgkmcnt(1)
v_smfmac_f32_16x16x64_bf16 v[184:187], v[12:15], v[56:63], v28
v_smfmac_f32_16x16x64_bf16 v[200:203], v[12:15], v[88:95], v28
s_waitcnt lgkmcnt(0)
v_smfmac_f32_16x16x64_bf16 v[184:187], v[16:19], v[120:127], v28
v_smfmac_f32_16x16x64_bf16 v[200:203], v[16:19], v[152:159], v28
v_smfmac_f32_16x16x64_bf16 v[188:191], v[12:15], v[64:71], v28
v_smfmac_f32_16x16x64_bf16 v[204:207], v[12:15], v[96:103], v28
v_smfmac_f32_16x16x64_bf16 v[188:191], v[16:19], v[128:135], v28
v_smfmac_f32_16x16x64_bf16 v[204:207], v[16:19], v[160:167], v28
v_smfmac_f32_16x16x64_bf16 v[192:195], v[12:15], v[72:79], v28
v_smfmac_f32_16x16x64_bf16 v[208:211], v[12:15], v[104:111], v28
v_smfmac_f32_16x16x64_bf16 v[192:195], v[16:19], v[136:143], v28
v_smfmac_f32_16x16x64_bf16 v[208:211], v[16:19], v[168:175], v28
v_smfmac_f32_16x16x64_bf16 v[196:199], v[12:15], v[80:87], v28
v_smfmac_f32_16x16x64_bf16 v[212:215], v[12:15], v[112:119], v28
v_smfmac_f32_16x16x64_bf16 v[196:199], v[16:19], v[144:151], v28
v_smfmac_f32_16x16x64_bf16 v[212:215], v[16:19], v[176:183], v28
v_pk_add_f32 v[184:185], v[184:185], v[186:187]
v_pk_add_f32 v[200:201], v[200:201], v[202:203]
v_add_f32 v184, v184, v185
v_add_f32 v200, v200, v201
v_pk_add_f32 v[188:189], v[188:189], v[190:191]
v_pk_add_f32 v[204:205], v[204:205], v[206:207]
v_permlane16_swap_b32 v184, v200
v_add_f32 v188, v188, v189
v_add_f32 v204, v204, v205
v_pk_add_f32 v[192:193], v[192:193], v[194:195]
v_pk_add_f32 v[208:209], v[208:209], v[210:211]
v_add_f32 v184, v184, v200
v_permlane16_swap_b32 v188, v204
v_add_f32 v192, v192, v193
v_add_f32 v208, v208, v209
v_add_f32 v188, v188, v204
v_pk_add_f32 v[196:197], v[196:197], v[198:199]
v_pk_add_f32 v[212:213], v[212:213], v[214:215]
v_permlane16_swap_b32 v192, v208
v_add_f32 v196, v196, v197
v_add_f32 v212, v212, v213
v_cvt_pk_bf16_f32 v36, v184, v188
v_add_f32 v192, v192, v208
v_permlane16_swap_b32 v196, v212
v_min_u32 v36, 0xfffffffe, v36
v_add_f32 v196, v196, v212
v_cvt_pk_bf16_f32 v37, v192, v196
v_min_u32 v37, 0xfffffffe, v37
global_store_dwordx2 v11, v[36:37], s[30:31] sc1
s_endpgm
L_roleW:
s_mov_b32 s89, s32
v_and_b32 v1, 63, v0
v_and_b32 v2, 15, v0
v_bfe_u32 v3, v0, 4, 2
v_and_b32 v8, 1, v0
v_lshlrev_b32 v8, 4, v8
v_mov_b32 v9, 0xffff
v_lshlrev_b32 v8, v8, v9
v_bfe_u32 v9, v0, 1, 2
v_cmp_eq_u32 vcc, 0, v9
s_nop 1
v_cndmask_b32 v4, 0, v8, vcc
v_cmp_eq_u32 vcc, 1, v9
s_nop 1
v_cndmask_b32 v5, 0, v8, vcc
v_cmp_eq_u32 vcc, 2, v9
s_nop 1
v_cndmask_b32 v6, 0, v8, vcc
v_cmp_eq_u32 vcc, 3, v9
s_nop 1
v_cndmask_b32 v7, 0, v8, vcc
s_waitcnt lgkmcnt(0)
s_load_dword s88, s[30:31], 0x18000
v_mov_b32 v8, 0
s_mov_b32 s52, s30
s_and_b32 s53, s31, 0xffff
s_mov_b32 s54, 0x4000000
s_mov_b32 s55, 0x20000
s_lshl_b32 s60, s89, 8
s_sub_u32 s61, 0x400000, s60
s_add_u32 s40, s18, s60
s_addc_u32 s41, s19, 0
s_and_b32 s41, s41, 0xffff
s_mov_b32 s42, s61
s_mov_b32 s43, 0x20000
s_add_u32 s44, s20, s60
s_addc_u32 s45, s21, 0
s_and_b32 s45, s45, 0xffff
s_mov_b32 s46, s61
s_mov_b32 s47, 0x20000
s_mov_b32 s48, s14
s_and_b32 s49, s15, 0xffff
s_mov_b32 s50, 0x800
s_mov_b32 s51, 0x20000
v_lshrrev_b32 v192, 3, v2
v_lshlrev_b32 v192, 10, v192
v_lshl_add_u32 v192, v3, 5, v192
s_lshl_b32 s62, s34, 7
v_add_u32 v192, s62, v192
buffer_load_dwordx4 v[12:15], v192, s[48:51], 0 offen
buffer_load_dwordx4 v[16:19], v192, s[48:51], 0 offen offset:16
v_lshlrev_b32 v9, 17, v3
v_lshl_add_u32 v9, v2, 4, v9
s_lshl_b32 s62, s34, 19
v_add_u32 v9, s62, v9
s_waitcnt vmcnt(2)
s_mov_b32 s62, 0
buffer_load_dwordx4 v[64:67], v9, s[40:43], s62 offen nt
s_waitcnt vmcnt(2)
s_mov_b32 s62, 8192
buffer_load_dwordx4 v[68:71], v9, s[40:43], s62 offen nt
s_waitcnt vmcnt(2)
s_mov_b32 s62, 16384
buffer_load_dwordx4 v[72:75], v9, s[40:43], s62 offen nt
s_waitcnt vmcnt(2)
s_mov_b32 s62, 24576
buffer_load_dwordx4 v[76:79], v9, s[40:43], s62 offen nt
s_waitcnt vmcnt(2)
s_mov_b32 s62, 32768
buffer_load_dwordx4 v[80:83], v9, s[40:43], s62 offen nt
s_waitcnt vmcnt(2)
s_mov_b32 s62, 40960
buffer_load_dwordx4 v[84:87], v9, s[40:43], s62 offen nt
s_waitcnt vmcnt(2)
s_mov_b32 s62, 49152
buffer_load_dwordx4 v[88:91], v9, s[40:43], s62 offen nt
s_waitcnt vmcnt(2)
s_mov_b32 s62, 57344
buffer_load_dwordx4 v[92:95], v9, s[40:43], s62 offen nt
s_waitcnt vmcnt(2)
s_mov_b32 s62, 65536
buffer_load_dwordx4 v[96:99], v9, s[40:43], s62 offen nt
s_waitcnt vmcnt(2)
s_mov_b32 s62, 73728
buffer_load_dwordx4 v[100:103], v9, s[40:43], s62 offen nt
s_waitcnt vmcnt(2)
s_mov_b32 s62, 81920
buffer_load_dwordx4 v[104:107], v9, s[40:43], s62 offen nt
s_waitcnt vmcnt(2)
s_mov_b32 s62, 90112
buffer_load_dwordx4 v[108:111], v9, s[40:43], s62 offen nt
s_waitcnt vmcnt(2)
s_mov_b32 s62, 98304
buffer_load_dwordx4 v[112:115], v9, s[40:43], s62 offen nt
s_waitcnt vmcnt(2)
s_mov_b32 s62, 106496
buffer_load_dwordx4 v[116:119], v9, s[40:43], s62 offen nt
s_waitcnt vmcnt(2)
s_mov_b32 s62, 114688
buffer_load_dwordx4 v[120:123], v9, s[40:43], s62 offen nt
s_waitcnt vmcnt(2)
s_mov_b32 s62, 122880
buffer_load_dwordx4 v[124:127], v9, s[40:43], s62 offen nt
s_barrier
s_waitcnt vmcnt(16)
s_mov_b32 s60, 0x01000100
v_perm_b32 v192, v12, v12, s60
v_and_b32 v28, v192, v4
v_and_b32 v29, v192, v5
v_and_b32 v30, v192, v6
v_and_b32 v31, v192, v7
s_waitcnt vmcnt(15)
s_nop 0
v_mfma_f32_16x16x32_bf16 v[44:47], v[28:31], v[64:67], 0
s_mov_b32 s62, 0
buffer_load_dwordx4 v[128:131], v9, s[44:47], s62 offen nt
s_mov_b32 s60, 0x03020302
v_perm_b32 v193, v12, v12, s60
v_and_b32 v32, v193, v4
v_and_b32 v33, v193, v5
v_and_b32 v34, v193, v6
v_and_b32 v35, v193, v7
s_waitcnt vmcnt(15)
s_nop 0
v_mfma_f32_16x16x32_bf16 v[44:47], v[32:35], v[68:71], v[44:47]
s_mov_b32 s62, 8192
buffer_load_dwordx4 v[132:135], v9, s[44:47], s62 offen nt
s_mov_b32 s60, 0x01000100
v_perm_b32 v192, v13, v13, s60
v_and_b32 v28, v192, v4
v_and_b32 v29, v192, v5
v_and_b32 v30, v192, v6
v_and_b32 v31, v192, v7
s_waitcnt vmcnt(15)
s_nop 0
v_mfma_f32_16x16x32_bf16 v[44:47], v[28:31], v[72:75], v[44:47]
s_mov_b32 s62, 16384
buffer_load_dwordx4 v[136:139], v9, s[44:47], s62 offen nt
s_mov_b32 s60, 0x03020302
v_perm_b32 v193, v13, v13, s60
v_and_b32 v32, v193, v4
v_and_b32 v33, v193, v5
v_and_b32 v34, v193, v6
v_and_b32 v35, v193, v7
s_waitcnt vmcnt(15)
s_nop 0
v_mfma_f32_16x16x32_bf16 v[44:47], v[32:35], v[76:79], v[44:47]
s_mov_b32 s62, 24576
buffer_load_dwordx4 v[140:143], v9, s[44:47], s62 offen nt
s_mov_b32 s60, 0x01000100
v_perm_b32 v192, v14, v14, s60
v_and_b32 v28, v192, v4
v_and_b32 v29, v192, v5
v_and_b32 v30, v192, v6
v_and_b32 v31, v192, v7
s_waitcnt vmcnt(15)
s_nop 0
v_mfma_f32_16x16x32_bf16 v[44:47], v[28:31], v[80:83], v[44:47]
s_mov_b32 s62, 32768
buffer_load_dwordx4 v[144:147], v9, s[44:47], s62 offen nt
s_mov_b32 s60, 0x03020302
v_perm_b32 v193, v14, v14, s60
v_and_b32 v32, v193, v4
v_and_b32 v33, v193, v5
v_and_b32 v34, v193, v6
v_and_b32 v35, v193, v7
s_waitcnt vmcnt(15)
s_nop 0
v_mfma_f32_16x16x32_bf16 v[44:47], v[32:35], v[84:87], v[44:47]
s_mov_b32 s62, 40960
buffer_load_dwordx4 v[148:151], v9, s[44:47], s62 offen nt
s_mov_b32 s60, 0x01000100
v_perm_b32 v192, v15, v15, s60
v_and_b32 v28, v192, v4
v_and_b32 v29, v192, v5
v_and_b32 v30, v192, v6
v_and_b32 v31, v192, v7
s_waitcnt vmcnt(15)
s_nop 0
v_mfma_f32_16x16x32_bf16 v[44:47], v[28:31], v[88:91], v[44:47]
s_mov_b32 s62, 49152
buffer_load_dwordx4 v[152:155], v9, s[44:47], s62 offen nt
s_mov_b32 s60, 0x03020302
v_perm_b32 v193, v15, v15, s60
v_and_b32 v32, v193, v4
v_and_b32 v33, v193, v5
v_and_b32 v34, v193, v6
v_and_b32 v35, v193, v7
s_waitcnt vmcnt(15)
s_nop 0
v_mfma_f32_16x16x32_bf16 v[44:47], v[32:35], v[92:95], v[44:47]
s_mov_b32 s62, 57344
buffer_load_dwordx4 v[156:159], v9, s[44:47], s62 offen nt
s_mov_b32 s60, 0x01000100
v_perm_b32 v192, v16, v16, s60
v_and_b32 v28, v192, v4
v_and_b32 v29, v192, v5
v_and_b32 v30, v192, v6
v_and_b32 v31, v192, v7
s_waitcnt vmcnt(15)
s_nop 0
v_mfma_f32_16x16x32_bf16 v[44:47], v[28:31], v[96:99], v[44:47]
s_mov_b32 s62, 65536
buffer_load_dwordx4 v[160:163], v9, s[44:47], s62 offen nt
s_mov_b32 s60, 0x03020302
v_perm_b32 v193, v16, v16, s60
v_and_b32 v32, v193, v4
v_and_b32 v33, v193, v5
v_and_b32 v34, v193, v6
v_and_b32 v35, v193, v7
s_waitcnt vmcnt(15)
s_nop 0
v_mfma_f32_16x16x32_bf16 v[44:47], v[32:35], v[100:103], v[44:47]
s_mov_b32 s62, 73728
buffer_load_dwordx4 v[164:167], v9, s[44:47], s62 offen nt
s_mov_b32 s60, 0x01000100
v_perm_b32 v192, v17, v17, s60
v_and_b32 v28, v192, v4
v_and_b32 v29, v192, v5
v_and_b32 v30, v192, v6
v_and_b32 v31, v192, v7
s_waitcnt vmcnt(15)
s_nop 0
v_mfma_f32_16x16x32_bf16 v[44:47], v[28:31], v[104:107], v[44:47]
s_mov_b32 s62, 81920
buffer_load_dwordx4 v[168:171], v9, s[44:47], s62 offen nt
s_mov_b32 s60, 0x03020302
v_perm_b32 v193, v17, v17, s60
v_and_b32 v32, v193, v4
v_and_b32 v33, v193, v5
v_and_b32 v34, v193, v6
v_and_b32 v35, v193, v7
s_waitcnt vmcnt(15)
s_nop 0
v_mfma_f32_16x16x32_bf16 v[44:47], v[32:35], v[108:111], v[44:47]
s_mov_b32 s62, 90112
buffer_load_dwordx4 v[172:175], v9, s[44:47], s62 offen nt
s_mov_b32 s60, 0x01000100
v_perm_b32 v192, v18, v18, s60
v_and_b32 v28, v192, v4
v_and_b32 v29, v192, v5
v_and_b32 v30, v192, v6
v_and_b32 v31, v192, v7
s_waitcnt vmcnt(15)
s_nop 0
v_mfma_f32_16x16x32_bf16 v[44:47], v[28:31], v[112:115], v[44:47]
s_mov_b32 s62, 98304
buffer_load_dwordx4 v[176:179], v9, s[44:47], s62 offen nt
s_mov_b32 s60, 0x03020302
v_perm_b32 v193, v18, v18, s60
v_and_b32 v32, v193, v4
v_and_b32 v33, v193, v5
v_and_b32 v34, v193, v6
v_and_b32 v35, v193, v7
s_waitcnt vmcnt(15)
s_nop 0
v_mfma_f32_16x16x32_bf16 v[44:47], v[32:35], v[116:119], v[44:47]
s_mov_b32 s62, 106496
buffer_load_dwordx4 v[180:183], v9, s[44:47], s62 offen nt
s_mov_b32 s60, 0x01000100
v_perm_b32 v192, v19, v19, s60
v_and_b32 v28, v192, v4
v_and_b32 v29, v192, v5
v_and_b32 v30, v192, v6
v_and_b32 v31, v192, v7
s_waitcnt vmcnt(15)
s_nop 0
v_mfma_f32_16x16x32_bf16 v[44:47], v[28:31], v[120:123], v[44:47]
s_mov_b32 s62, 114688
buffer_load_dwordx4 v[184:187], v9, s[44:47], s62 offen nt
s_mov_b32 s60, 0x03020302
v_perm_b32 v193, v19, v19, s60
v_and_b32 v32, v193, v4
v_and_b32 v33, v193, v5
v_and_b32 v34, v193, v6
v_and_b32 v35, v193, v7
s_waitcnt vmcnt(15)
s_nop 0
v_mfma_f32_16x16x32_bf16 v[44:47], v[32:35], v[124:127], v[44:47]
s_mov_b32 s62, 122880
buffer_load_dwordx4 v[188:191], v9, s[44:47], s62 offen nt
s_nop 1
v_lshrrev_b32 v192, 1, v3
v_lshlrev_b32 v192, 9, v192
v_lshl_add_u32 v192, v2, 5, v192
v_and_b32 v193, 1, v3
v_lshl_add_u32 v192, v193, 4, v192
s_lshl_b32 s63, s34, 10
v_add_u32 v192, s63, v192
s_nop 1
s_nop 5
ds_write_b128 v192, v[44:47] offset:0
s_waitcnt lgkmcnt(0)
s_barrier
s_cmp_ge_u32 s34, 4
s_cbranch_scc1 L_W_qskip
v_lshlrev_b32 v194, 2, v0
ds_read_b32 v196, v194 offset:0
ds_read_b32 v197, v194 offset:1024
ds_read_b32 v198, v194 offset:2048
ds_read_b32 v199, v194 offset:3072
ds_read_b32 v200, v194 offset:4096
ds_read_b32 v201, v194 offset:5120
ds_read_b32 v202, v194 offset:6144
ds_read_b32 v203, v194 offset:7168
s_waitcnt lgkmcnt(0)
v_add_f32 v196, v196, v197
v_add_f32 v196, v196, v198
v_add_f32 v196, v196, v199
v_add_f32 v196, v196, v200
v_add_f32 v196, v196, v201
v_add_f32 v196, v196, v202
v_add_f32 v196, v196, v203
v_cvt_pk_bf16_f32 v196, v196, v196
v_lshlrev_b32 v194, 1, v0
ds_write_b16 v194, v196 offset:8192
s_waitcnt lgkmcnt(0)
L_W_qskip:
s_barrier
s_waitcnt lgkmcnt(0)
s_add_u32 s88, s88, 0x9e3779b9
v_lshlrev_b32 v194, 4, v2
ds_read_b128 v[20:23], v194 offset:8192
ds_read_b128 v[24:27], v194 offset:8448
v_mov_b32 v200, 0
v_mov_b32 v201, 0
s_waitcnt lgkmcnt(0)
s_waitcnt vmcnt(14)
v_dot2_f32_bf16 v60, v128, v20, 0
v_dot2_f32_bf16 v61, v128, v24, 0
v_dot2_f32_bf16 v62, v132, v20, 0
v_dot2_f32_bf16 v63, v132, v24, 0
v_dot2_f32_bf16 v60, v129, v21, v60
v_dot2_f32_bf16 v61, v129, v25, v61
v_dot2_f32_bf16 v62, v133, v21, v62
v_dot2_f32_bf16 v63, v133, v25, v63
v_dot2_f32_bf16 v60, v130, v22, v60
v_dot2_f32_bf16 v61, v130, v26, v61
v_dot2_f32_bf16 v62, v134, v22, v62
v_dot2_f32_bf16 v63, v134, v26, v63
v_dot2_f32_bf16 v60, v131, v23, v60
v_dot2_f32_bf16 v61, v131, v27, v61
v_dot2_f32_bf16 v62, v135, v23, v62
v_dot2_f32_bf16 v63, v135, v27, v63
v_add_f32_dpp v60, v60, v60 row_ror:8 row_mask:0xf bank_mask:0xf
v_add_f32_dpp v61, v61, v61 row_ror:8 row_mask:0xf bank_mask:0xf
v_add_f32_dpp v62, v62, v62 row_ror:8 row_mask:0xf bank_mask:0xf
v_add_f32_dpp v63, v63, v63 row_ror:8 row_mask:0xf bank_mask:0xf
v_add_f32_dpp v60, v60, v60 row_ror:4 row_mask:0xf bank_mask:0xf
v_add_f32_dpp v61, v61, v61 row_ror:4 row_mask:0xf bank_mask:0xf
v_add_f32_dpp v62, v62, v62 row_ror:4 row_mask:0xf bank_mask:0xf
v_add_f32_dpp v63, v63, v63 row_ror:4 row_mask:0xf bank_mask:0xf
v_add_f32_dpp v60, v60, v60 row_ror:2 row_mask:0xf bank_mask:0xf
v_add_f32_dpp v61, v61, v61 row_ror:2 row_mask:0xf bank_mask:0xf
v_add_f32_dpp v62, v62, v62 row_ror:2 row_mask:0xf bank_mask:0xf
v_add_f32_dpp v63, v63, v63 row_ror:2 row_mask:0xf bank_mask:0xf
v_add_f32_dpp v60, v60, v60 row_ror:1 row_mask:0xf bank_mask:0xf
v_add_f32_dpp v61, v61, v61 row_ror:1 row_mask:0xf bank_mask:0xf
v_add_f32_dpp v62, v62, v62 row_ror:1 row_mask:0xf bank_mask:0xf
v_add_f32_dpp v63, v63, v63 row_ror:1 row_mask:0xf bank_mask:0xf
v_cmp_eq_u32 vcc, 0, v2
s_nop 1
v_cndmask_b32 v200, v200, v60, vcc
v_cndmask_b32 v201, v201, v61, vcc
v_cmp_eq_u32 vcc, 1, v2
s_nop 1
v_cndmask_b32 v200, v200, v62, vcc
v_cndmask_b32 v201, v201, v63, vcc
s_waitcnt vmcnt(12)
v_dot2_f32_bf16 v60, v136, v20, 0
v_dot2_f32_bf16 v61, v136, v24, 0
v_dot2_f32_bf16 v62, v140, v20, 0
v_dot2_f32_bf16 v63, v140, v24, 0
v_dot2_f32_bf16 v60, v137, v21, v60
v_dot2_f32_bf16 v61, v137, v25, v61
v_dot2_f32_bf16 v62, v141, v21, v62
v_dot2_f32_bf16 v63, v141, v25, v63
v_dot2_f32_bf16 v60, v138, v22, v60
v_dot2_f32_bf16 v61, v138, v26, v61
v_dot2_f32_bf16 v62, v142, v22, v62
v_dot2_f32_bf16 v63, v142, v26, v63
v_dot2_f32_bf16 v60, v139, v23, v60
v_dot2_f32_bf16 v61, v139, v27, v61
v_dot2_f32_bf16 v62, v143, v23, v62
v_dot2_f32_bf16 v63, v143, v27, v63
v_add_f32_dpp v60, v60, v60 row_ror:8 row_mask:0xf bank_mask:0xf
v_add_f32_dpp v61, v61, v61 row_ror:8 row_mask:0xf bank_mask:0xf
v_add_f32_dpp v62, v62, v62 row_ror:8 row_mask:0xf bank_mask:0xf
v_add_f32_dpp v63, v63, v63 row_ror:8 row_mask:0xf bank_mask:0xf
v_add_f32_dpp v60, v60, v60 row_ror:4 row_mask:0xf bank_mask:0xf
v_add_f32_dpp v61, v61, v61 row_ror:4 row_mask:0xf bank_mask:0xf
v_add_f32_dpp v62, v62, v62 row_ror:4 row_mask:0xf bank_mask:0xf
v_add_f32_dpp v63, v63, v63 row_ror:4 row_mask:0xf bank_mask:0xf
v_add_f32_dpp v60, v60, v60 row_ror:2 row_mask:0xf bank_mask:0xf
v_add_f32_dpp v61, v61, v61 row_ror:2 row_mask:0xf bank_mask:0xf
v_add_f32_dpp v62, v62, v62 row_ror:2 row_mask:0xf bank_mask:0xf
v_add_f32_dpp v63, v63, v63 row_ror:2 row_mask:0xf bank_mask:0xf
v_add_f32_dpp v60, v60, v60 row_ror:1 row_mask:0xf bank_mask:0xf
v_add_f32_dpp v61, v61, v61 row_ror:1 row_mask:0xf bank_mask:0xf
v_add_f32_dpp v62, v62, v62 row_ror:1 row_mask:0xf bank_mask:0xf
v_add_f32_dpp v63, v63, v63 row_ror:1 row_mask:0xf bank_mask:0xf
v_cmp_eq_u32 vcc, 2, v2
s_nop 1
v_cndmask_b32 v200, v200, v60, vcc
v_cndmask_b32 v201, v201, v61, vcc
v_cmp_eq_u32 vcc, 3, v2
s_nop 1
v_cndmask_b32 v200, v200, v62, vcc
v_cndmask_b32 v201, v201, v63, vcc
s_waitcnt vmcnt(10)
v_dot2_f32_bf16 v60, v144, v20, 0
v_dot2_f32_bf16 v61, v144, v24, 0
v_dot2_f32_bf16 v62, v148, v20, 0
v_dot2_f32_bf16 v63, v148, v24, 0
v_dot2_f32_bf16 v60, v145, v21, v60
v_dot2_f32_bf16 v61, v145, v25, v61
v_dot2_f32_bf16 v62, v149, v21, v62
v_dot2_f32_bf16 v63, v149, v25, v63
v_dot2_f32_bf16 v60, v146, v22, v60
v_dot2_f32_bf16 v61, v146, v26, v61
v_dot2_f32_bf16 v62, v150, v22, v62
v_dot2_f32_bf16 v63, v150, v26, v63
v_dot2_f32_bf16 v60, v147, v23, v60
v_dot2_f32_bf16 v61, v147, v27, v61
v_dot2_f32_bf16 v62, v151, v23, v62
v_dot2_f32_bf16 v63, v151, v27, v63
v_add_f32_dpp v60, v60, v60 row_ror:8 row_mask:0xf bank_mask:0xf
v_add_f32_dpp v61, v61, v61 row_ror:8 row_mask:0xf bank_mask:0xf
v_add_f32_dpp v62, v62, v62 row_ror:8 row_mask:0xf bank_mask:0xf
v_add_f32_dpp v63, v63, v63 row_ror:8 row_mask:0xf bank_mask:0xf
v_add_f32_dpp v60, v60, v60 row_ror:4 row_mask:0xf bank_mask:0xf
v_add_f32_dpp v61, v61, v61 row_ror:4 row_mask:0xf bank_mask:0xf
v_add_f32_dpp v62, v62, v62 row_ror:4 row_mask:0xf bank_mask:0xf
v_add_f32_dpp v63, v63, v63 row_ror:4 row_mask:0xf bank_mask:0xf
v_add_f32_dpp v60, v60, v60 row_ror:2 row_mask:0xf bank_mask:0xf
v_add_f32_dpp v61, v61, v61 row_ror:2 row_mask:0xf bank_mask:0xf
v_add_f32_dpp v62, v62, v62 row_ror:2 row_mask:0xf bank_mask:0xf
v_add_f32_dpp v63, v63, v63 row_ror:2 row_mask:0xf bank_mask:0xf
v_add_f32_dpp v60, v60, v60 row_ror:1 row_mask:0xf bank_mask:0xf
v_add_f32_dpp v61, v61, v61 row_ror:1 row_mask:0xf bank_mask:0xf
v_add_f32_dpp v62, v62, v62 row_ror:1 row_mask:0xf bank_mask:0xf
v_add_f32_dpp v63, v63, v63 row_ror:1 row_mask:0xf bank_mask:0xf
v_cmp_eq_u32 vcc, 4, v2
s_nop 1
v_cndmask_b32 v200, v200, v60, vcc
v_cndmask_b32 v201, v201, v61, vcc
v_cmp_eq_u32 vcc, 5, v2
s_nop 1
v_cndmask_b32 v200, v200, v62, vcc
v_cndmask_b32 v201, v201, v63, vcc
s_waitcnt vmcnt(8)
v_dot2_f32_bf16 v60, v152, v20, 0
v_dot2_f32_bf16 v61, v152, v24, 0
v_dot2_f32_bf16 v62, v156, v20, 0
v_dot2_f32_bf16 v63, v156, v24, 0
v_dot2_f32_bf16 v60, v153, v21, v60
v_dot2_f32_bf16 v61, v153, v25, v61
v_dot2_f32_bf16 v62, v157, v21, v62
v_dot2_f32_bf16 v63, v157, v25, v63
v_dot2_f32_bf16 v60, v154, v22, v60
v_dot2_f32_bf16 v61, v154, v26, v61
v_dot2_f32_bf16 v62, v158, v22, v62
v_dot2_f32_bf16 v63, v158, v26, v63
v_dot2_f32_bf16 v60, v155, v23, v60
v_dot2_f32_bf16 v61, v155, v27, v61
v_dot2_f32_bf16 v62, v159, v23, v62
v_dot2_f32_bf16 v63, v159, v27, v63
v_add_f32_dpp v60, v60, v60 row_ror:8 row_mask:0xf bank_mask:0xf
v_add_f32_dpp v61, v61, v61 row_ror:8 row_mask:0xf bank_mask:0xf
v_add_f32_dpp v62, v62, v62 row_ror:8 row_mask:0xf bank_mask:0xf
v_add_f32_dpp v63, v63, v63 row_ror:8 row_mask:0xf bank_mask:0xf
v_add_f32_dpp v60, v60, v60 row_ror:4 row_mask:0xf bank_mask:0xf
v_add_f32_dpp v61, v61, v61 row_ror:4 row_mask:0xf bank_mask:0xf
v_add_f32_dpp v62, v62, v62 row_ror:4 row_mask:0xf bank_mask:0xf
v_add_f32_dpp v63, v63, v63 row_ror:4 row_mask:0xf bank_mask:0xf
v_add_f32_dpp v60, v60, v60 row_ror:2 row_mask:0xf bank_mask:0xf
v_add_f32_dpp v61, v61, v61 row_ror:2 row_mask:0xf bank_mask:0xf
v_add_f32_dpp v62, v62, v62 row_ror:2 row_mask:0xf bank_mask:0xf
v_add_f32_dpp v63, v63, v63 row_ror:2 row_mask:0xf bank_mask:0xf
v_add_f32_dpp v60, v60, v60 row_ror:1 row_mask:0xf bank_mask:0xf
v_add_f32_dpp v61, v61, v61 row_ror:1 row_mask:0xf bank_mask:0xf
v_add_f32_dpp v62, v62, v62 row_ror:1 row_mask:0xf bank_mask:0xf
v_add_f32_dpp v63, v63, v63 row_ror:1 row_mask:0xf bank_mask:0xf
v_cmp_eq_u32 vcc, 6, v2
s_nop 1
v_cndmask_b32 v200, v200, v60, vcc
v_cndmask_b32 v201, v201, v61, vcc
v_cmp_eq_u32 vcc, 7, v2
s_nop 1
v_cndmask_b32 v200, v200, v62, vcc
v_cndmask_b32 v201, v201, v63, vcc
s_waitcnt vmcnt(6)
v_dot2_f32_bf16 v60, v160, v20, 0
v_dot2_f32_bf16 v61, v160, v24, 0
v_dot2_f32_bf16 v62, v164, v20, 0
v_dot2_f32_bf16 v63, v164, v24, 0
v_dot2_f32_bf16 v60, v161, v21, v60
v_dot2_f32_bf16 v61, v161, v25, v61
v_dot2_f32_bf16 v62, v165, v21, v62
v_dot2_f32_bf16 v63, v165, v25, v63
v_dot2_f32_bf16 v60, v162, v22, v60
v_dot2_f32_bf16 v61, v162, v26, v61
v_dot2_f32_bf16 v62, v166, v22, v62
v_dot2_f32_bf16 v63, v166, v26, v63
v_dot2_f32_bf16 v60, v163, v23, v60
v_dot2_f32_bf16 v61, v163, v27, v61
v_dot2_f32_bf16 v62, v167, v23, v62
v_dot2_f32_bf16 v63, v167, v27, v63
v_add_f32_dpp v60, v60, v60 row_ror:8 row_mask:0xf bank_mask:0xf
v_add_f32_dpp v61, v61, v61 row_ror:8 row_mask:0xf bank_mask:0xf
v_add_f32_dpp v62, v62, v62 row_ror:8 row_mask:0xf bank_mask:0xf
v_add_f32_dpp v63, v63, v63 row_ror:8 row_mask:0xf bank_mask:0xf
v_add_f32_dpp v60, v60, v60 row_ror:4 row_mask:0xf bank_mask:0xf
v_add_f32_dpp v61, v61, v61 row_ror:4 row_mask:0xf bank_mask:0xf
v_add_f32_dpp v62, v62, v62 row_ror:4 row_mask:0xf bank_mask:0xf
v_add_f32_dpp v63, v63, v63 row_ror:4 row_mask:0xf bank_mask:0xf
v_add_f32_dpp v60, v60, v60 row_ror:2 row_mask:0xf bank_mask:0xf
v_add_f32_dpp v61, v61, v61 row_ror:2 row_mask:0xf bank_mask:0xf
v_add_f32_dpp v62, v62, v62 row_ror:2 row_mask:0xf bank_mask:0xf
v_add_f32_dpp v63, v63, v63 row_ror:2 row_mask:0xf bank_mask:0xf
v_add_f32_dpp v60, v60, v60 row_ror:1 row_mask:0xf bank_mask:0xf
v_add_f32_dpp v61, v61, v61 row_ror:1 row_mask:0xf bank_mask:0xf
v_add_f32_dpp v62, v62, v62 row_ror:1 row_mask:0xf bank_mask:0xf
v_add_f32_dpp v63, v63, v63 row_ror:1 row_mask:0xf bank_mask:0xf
v_cmp_eq_u32 vcc, 8, v2
s_nop 1
v_cndmask_b32 v200, v200, v60, vcc
v_cndmask_b32 v201, v201, v61, vcc
v_cmp_eq_u32 vcc, 9, v2
s_nop 1
v_cndmask_b32 v200, v200, v62, vcc
v_cndmask_b32 v201, v201, v63, vcc
s_waitcnt vmcnt(4)
v_dot2_f32_bf16 v60, v168, v20, 0
v_dot2_f32_bf16 v61, v168, v24, 0
v_dot2_f32_bf16 v62, v172, v20, 0
v_dot2_f32_bf16 v63, v172, v24, 0
v_dot2_f32_bf16 v60, v169, v21, v60
v_dot2_f32_bf16 v61, v169, v25, v61
v_dot2_f32_bf16 v62, v173, v21, v62
v_dot2_f32_bf16 v63, v173, v25, v63
v_dot2_f32_bf16 v60, v170, v22, v60
v_dot2_f32_bf16 v61, v170, v26, v61
v_dot2_f32_bf16 v62, v174, v22, v62
v_dot2_f32_bf16 v63, v174, v26, v63
v_dot2_f32_bf16 v60, v171, v23, v60
v_dot2_f32_bf16 v61, v171, v27, v61
v_dot2_f32_bf16 v62, v175, v23, v62
v_dot2_f32_bf16 v63, v175, v27, v63
v_add_f32_dpp v60, v60, v60 row_ror:8 row_mask:0xf bank_mask:0xf
v_add_f32_dpp v61, v61, v61 row_ror:8 row_mask:0xf bank_mask:0xf
v_add_f32_dpp v62, v62, v62 row_ror:8 row_mask:0xf bank_mask:0xf
v_add_f32_dpp v63, v63, v63 row_ror:8 row_mask:0xf bank_mask:0xf
v_add_f32_dpp v60, v60, v60 row_ror:4 row_mask:0xf bank_mask:0xf
v_add_f32_dpp v61, v61, v61 row_ror:4 row_mask:0xf bank_mask:0xf
v_add_f32_dpp v62, v62, v62 row_ror:4 row_mask:0xf bank_mask:0xf
v_add_f32_dpp v63, v63, v63 row_ror:4 row_mask:0xf bank_mask:0xf
v_add_f32_dpp v60, v60, v60 row_ror:2 row_mask:0xf bank_mask:0xf
v_add_f32_dpp v61, v61, v61 row_ror:2 row_mask:0xf bank_mask:0xf
v_add_f32_dpp v62, v62, v62 row_ror:2 row_mask:0xf bank_mask:0xf
v_add_f32_dpp v63, v63, v63 row_ror:2 row_mask:0xf bank_mask:0xf
v_add_f32_dpp v60, v60, v60 row_ror:1 row_mask:0xf bank_mask:0xf
v_add_f32_dpp v61, v61, v61 row_ror:1 row_mask:0xf bank_mask:0xf
v_add_f32_dpp v62, v62, v62 row_ror:1 row_mask:0xf bank_mask:0xf
v_add_f32_dpp v63, v63, v63 row_ror:1 row_mask:0xf bank_mask:0xf
v_cmp_eq_u32 vcc, 10, v2
s_nop 1
v_cndmask_b32 v200, v200, v60, vcc
v_cndmask_b32 v201, v201, v61, vcc
v_cmp_eq_u32 vcc, 11, v2
s_nop 1
v_cndmask_b32 v200, v200, v62, vcc
v_cndmask_b32 v201, v201, v63, vcc
s_waitcnt vmcnt(2)
v_dot2_f32_bf16 v60, v176, v20, 0
v_dot2_f32_bf16 v61, v176, v24, 0
v_dot2_f32_bf16 v62, v180, v20, 0
v_dot2_f32_bf16 v63, v180, v24, 0
v_dot2_f32_bf16 v60, v177, v21, v60
v_dot2_f32_bf16 v61, v177, v25, v61
v_dot2_f32_bf16 v62, v181, v21, v62
v_dot2_f32_bf16 v63, v181, v25, v63
v_dot2_f32_bf16 v60, v178, v22, v60
v_dot2_f32_bf16 v61, v178, v26, v61
v_dot2_f32_bf16 v62, v182, v22, v62
v_dot2_f32_bf16 v63, v182, v26, v63
v_dot2_f32_bf16 v60, v179, v23, v60
v_dot2_f32_bf16 v61, v179, v27, v61
v_dot2_f32_bf16 v62, v183, v23, v62
v_dot2_f32_bf16 v63, v183, v27, v63
v_add_f32_dpp v60, v60, v60 row_ror:8 row_mask:0xf bank_mask:0xf
v_add_f32_dpp v61, v61, v61 row_ror:8 row_mask:0xf bank_mask:0xf
v_add_f32_dpp v62, v62, v62 row_ror:8 row_mask:0xf bank_mask:0xf
v_add_f32_dpp v63, v63, v63 row_ror:8 row_mask:0xf bank_mask:0xf
v_add_f32_dpp v60, v60, v60 row_ror:4 row_mask:0xf bank_mask:0xf
v_add_f32_dpp v61, v61, v61 row_ror:4 row_mask:0xf bank_mask:0xf
v_add_f32_dpp v62, v62, v62 row_ror:4 row_mask:0xf bank_mask:0xf
v_add_f32_dpp v63, v63, v63 row_ror:4 row_mask:0xf bank_mask:0xf
v_add_f32_dpp v60, v60, v60 row_ror:2 row_mask:0xf bank_mask:0xf
v_add_f32_dpp v61, v61, v61 row_ror:2 row_mask:0xf bank_mask:0xf
v_add_f32_dpp v62, v62, v62 row_ror:2 row_mask:0xf bank_mask:0xf
v_add_f32_dpp v63, v63, v63 row_ror:2 row_mask:0xf bank_mask:0xf
v_add_f32_dpp v60, v60, v60 row_ror:1 row_mask:0xf bank_mask:0xf
v_add_f32_dpp v61, v61, v61 row_ror:1 row_mask:0xf bank_mask:0xf
v_add_f32_dpp v62, v62, v62 row_ror:1 row_mask:0xf bank_mask:0xf
v_add_f32_dpp v63, v63, v63 row_ror:1 row_mask:0xf bank_mask:0xf
v_cmp_eq_u32 vcc, 12, v2
s_nop 1
v_cndmask_b32 v200, v200, v60, vcc
v_cndmask_b32 v201, v201, v61, vcc
v_cmp_eq_u32 vcc, 13, v2
s_nop 1
v_cndmask_b32 v200, v200, v62, vcc
v_cndmask_b32 v201, v201, v63, vcc
s_waitcnt vmcnt(0)
v_dot2_f32_bf16 v60, v184, v20, 0
v_dot2_f32_bf16 v61, v184, v24, 0
v_dot2_f32_bf16 v62, v188, v20, 0
v_dot2_f32_bf16 v63, v188, v24, 0
v_dot2_f32_bf16 v60, v185, v21, v60
v_dot2_f32_bf16 v61, v185, v25, v61
v_dot2_f32_bf16 v62, v189, v21, v62
v_dot2_f32_bf16 v63, v189, v25, v63
v_dot2_f32_bf16 v60, v186, v22, v60
v_dot2_f32_bf16 v61, v186, v26, v61
v_dot2_f32_bf16 v62, v190, v22, v62
v_dot2_f32_bf16 v63, v190, v26, v63
v_dot2_f32_bf16 v60, v187, v23, v60
v_dot2_f32_bf16 v61, v187, v27, v61
v_dot2_f32_bf16 v62, v191, v23, v62
v_dot2_f32_bf16 v63, v191, v27, v63
v_add_f32_dpp v60, v60, v60 row_ror:8 row_mask:0xf bank_mask:0xf
v_add_f32_dpp v61, v61, v61 row_ror:8 row_mask:0xf bank_mask:0xf
v_add_f32_dpp v62, v62, v62 row_ror:8 row_mask:0xf bank_mask:0xf
v_add_f32_dpp v63, v63, v63 row_ror:8 row_mask:0xf bank_mask:0xf
v_add_f32_dpp v60, v60, v60 row_ror:4 row_mask:0xf bank_mask:0xf
v_add_f32_dpp v61, v61, v61 row_ror:4 row_mask:0xf bank_mask:0xf
v_add_f32_dpp v62, v62, v62 row_ror:4 row_mask:0xf bank_mask:0xf
v_add_f32_dpp v63, v63, v63 row_ror:4 row_mask:0xf bank_mask:0xf
v_add_f32_dpp v60, v60, v60 row_ror:2 row_mask:0xf bank_mask:0xf
v_add_f32_dpp v61, v61, v61 row_ror:2 row_mask:0xf bank_mask:0xf
v_add_f32_dpp v62, v62, v62 row_ror:2 row_mask:0xf bank_mask:0xf
v_add_f32_dpp v63, v63, v63 row_ror:2 row_mask:0xf bank_mask:0xf
v_add_f32_dpp v60, v60, v60 row_ror:1 row_mask:0xf bank_mask:0xf
v_add_f32_dpp v61, v61, v61 row_ror:1 row_mask:0xf bank_mask:0xf
v_add_f32_dpp v62, v62, v62 row_ror:1 row_mask:0xf bank_mask:0xf
v_add_f32_dpp v63, v63, v63 row_ror:1 row_mask:0xf bank_mask:0xf
v_cmp_eq_u32 vcc, 14, v2
s_nop 1
v_cndmask_b32 v200, v200, v60, vcc
v_cndmask_b32 v201, v201, v61, vcc
v_cmp_eq_u32 vcc, 15, v2
s_nop 1
v_cndmask_b32 v200, v200, v62, vcc
v_cndmask_b32 v201, v201, v63, vcc
v_cvt_pk_bf16_f32 v200, v200, v200
v_cvt_pk_bf16_f32 v201, v201, v201
s_lshl_b32 s62, s32, 10
s_lshl_b32 s63, s34, 7
s_add_u32 s62, s62, s63
s_add_u32 s62, s62, 0x0
v_lshl_add_u32 v192, v1, 1, s62
buffer_store_short v200, v192, s[52:55], 0 offen sc1
s_mov_b32 s62, 32768
buffer_store_short v201, v192, s[52:55], s62 offen sc1
s_lshl_b32 s62, s32, 8
s_add_u32 s62, s62, 0x1a000
v_lshl_add_u32 v192, v1, 2, s62
v_mov_b32 v193, s88
s_waitcnt vmcnt(0)
s_barrier
s_cmp_lg_u32 s34, 0
s_cbranch_scc1 L_sig_Wq
s_mov_b32 exec_hi, 0
buffer_store_dword v193, v192, s[52:55], 0 offen sc1
s_mov_b64 exec, -1
L_sig_Wq:
s_lshl_b32 s60, s89, 8
s_sub_u32 s61, 0x400000, s60
s_add_u32 s40, s22, s60
s_addc_u32 s41, s23, 0
s_and_b32 s41, s41, 0xffff
s_mov_b32 s42, s61
s_mov_b32 s43, 0x20000
s_lshl_b32 s60, s89, 17
s_mov_b32 s61, 0x20000
s_add_u32 s44, s24, s60
s_addc_u32 s45, s25, 0
s_and_b32 s45, s45, 0xffff
s_mov_b32 s46, s61
s_mov_b32 s47, 0x20000
v_lshlrev_b32 v10, 12, v3
v_lshl_add_u32 v10, v2, 4, v10
s_lshl_b32 s62, s34, 14
v_add_u32 v10, s62, v10
s_waitcnt vmcnt(2)
s_mov_b32 s62, 0
buffer_load_dwordx4 v[64:67], v9, s[40:43], s62 offen nt
s_waitcnt vmcnt(2)
s_mov_b32 s62, 8192
buffer_load_dwordx4 v[68:71], v9, s[40:43], s62 offen nt
s_waitcnt vmcnt(2)
s_mov_b32 s62, 16384
buffer_load_dwordx4 v[72:75], v9, s[40:43], s62 offen nt
s_waitcnt vmcnt(2)
s_mov_b32 s62, 24576
buffer_load_dwordx4 v[76:79], v9, s[40:43], s62 offen nt
s_waitcnt vmcnt(2)
s_mov_b32 s62, 32768
buffer_load_dwordx4 v[80:83], v9, s[40:43], s62 offen nt
s_waitcnt vmcnt(2)
s_mov_b32 s62, 40960
buffer_load_dwordx4 v[84:87], v9, s[40:43], s62 offen nt
s_waitcnt vmcnt(2)
s_mov_b32 s62, 49152
buffer_load_dwordx4 v[88:91], v9, s[40:43], s62 offen nt
s_waitcnt vmcnt(2)
s_mov_b32 s62, 57344
buffer_load_dwordx4 v[92:95], v9, s[40:43], s62 offen nt
s_waitcnt vmcnt(2)
s_mov_b32 s62, 65536
buffer_load_dwordx4 v[96:99], v9, s[40:43], s62 offen nt
s_waitcnt vmcnt(2)
s_mov_b32 s62, 73728
buffer_load_dwordx4 v[100:103], v9, s[40:43], s62 offen nt
s_waitcnt vmcnt(2)
s_mov_b32 s62, 81920
buffer_load_dwordx4 v[104:107], v9, s[40:43], s62 offen nt
s_waitcnt vmcnt(2)
s_mov_b32 s62, 90112
buffer_load_dwordx4 v[108:111], v9, s[40:43], s62 offen nt
s_waitcnt vmcnt(2)
s_mov_b32 s62, 98304
buffer_load_dwordx4 v[112:115], v9, s[40:43], s62 offen nt
s_waitcnt vmcnt(2)
s_mov_b32 s62, 106496
buffer_load_dwordx4 v[116:119], v9, s[40:43], s62 offen nt
s_waitcnt vmcnt(2)
s_mov_b32 s62, 114688
buffer_load_dwordx4 v[120:123], v9, s[40:43], s62 offen nt
s_waitcnt vmcnt(2)
s_mov_b32 s62, 122880
buffer_load_dwordx4 v[124:127], v9, s[40:43], s62 offen nt
s_waitcnt vmcnt(2)
buffer_load_dwordx4 v[128:131], v10, s[44:47], 0 offen offset:0 nt
s_waitcnt vmcnt(2)
buffer_load_dwordx4 v[132:135], v10, s[44:47], 0 offen offset:256 nt
s_waitcnt vmcnt(2)
buffer_load_dwordx4 v[136:139], v10, s[44:47], 0 offen offset:512 nt
s_waitcnt vmcnt(2)
buffer_load_dwordx4 v[140:143], v10, s[44:47], 0 offen offset:768 nt
s_waitcnt vmcnt(2)
buffer_load_dwordx4 v[144:147], v10, s[44:47], 0 offen offset:1024 nt
s_waitcnt vmcnt(2)
buffer_load_dwordx4 v[148:151], v10, s[44:47], 0 offen offset:1280 nt
s_waitcnt vmcnt(2)
buffer_load_dwordx4 v[152:155], v10, s[44:47], 0 offen offset:1536 nt
s_waitcnt vmcnt(2)
buffer_load_dwordx4 v[156:159], v10, s[44:47], 0 offen offset:1792 nt
s_waitcnt vmcnt(2)
buffer_load_dwordx4 v[160:163], v10, s[44:47], 0 offen offset:2048 nt
s_waitcnt vmcnt(2)
buffer_load_dwordx4 v[164:167], v10, s[44:47], 0 offen offset:2304 nt
s_waitcnt vmcnt(2)
buffer_load_dwordx4 v[168:171], v10, s[44:47], 0 offen offset:2560 nt
s_waitcnt vmcnt(2)
buffer_load_dwordx4 v[172:175], v10, s[44:47], 0 offen offset:2816 nt
s_waitcnt vmcnt(2)
buffer_load_dwordx4 v[176:179], v10, s[44:47], 0 offen offset:3072 nt
s_waitcnt vmcnt(2)
buffer_load_dwordx4 v[180:183], v10, s[44:47], 0 offen offset:3328 nt
s_waitcnt vmcnt(2)
buffer_load_dwordx4 v[184:187], v10, s[44:47], 0 offen offset:3584 nt
s_waitcnt vmcnt(2)
buffer_load_dwordx4 v[188:191], v10, s[44:47], 0 offen offset:3840 nt
s_cmp_lg_u32 s34, 7
s_cbranch_scc1 L_W_nogm
s_cmp_ge_u32 s32, 8
s_cbranch_scc1 L_W_nogm
s_and_b32 s63, s32, 7
s_mul_i32 s63, s63, 0x100
s_add_u32 s63, s63, 0xc0000
s_add_u32 s56, s30, s63
s_addc_u32 s57, s31, 0
s_mov_b32 s64, 0
s_mov_b32 s59, 0
s_mov_b32 s58, 0
s_lshl_b32 s62, s32, 12
s_add_u32 s62, s62, 0xd0000
v_lshl_add_u32 v204, v1, 4, s62
v_lshrrev_b32 v205, 2, v1
s_mov_b32 s62, 0xd0000
v_lshl_add_u32 v205, v205, 12, s62
v_and_b32 v206, 3, v1
v_lshlrev_b32 v208, 2, v1
v_mov_b32 v211, 0
L_gm_W:
s_mov_b32 exec_lo, -1
s_mov_b32 exec_hi, 0
v_add_u32 v207, s58, v206
v_and_b32 v207, 15, v207
v_lshl_add_u32 v207, v207, 8, v205
global_load_dword v210, v207, s[30:31] sc1
s_mov_b64 exec, 0x1ffffff
global_load_dword v209, v208, s[56:57] nt
s_waitcnt vmcnt(0)
v_subrev_u32 v209, s88, v209
s_mov_b64 exec, 0xffffff
v_cmp_le_u32 vcc, 0x400, v209
v_readlane_b32 s62, v209, 24
v_add_u32_dpp v209, v209, v209 row_shr:1 row_mask:0xf bank_mask:0xf bound_ctrl:0
s_nop 1
v_add_u32_dpp v209, v209, v209 row_shr:2 row_mask:0xf bank_mask:0xf bound_ctrl:0
s_nop 1
v_add_u32_dpp v209, v209, v209 row_shr:4 row_mask:0xf bank_mask:0xf bound_ctrl:0
s_nop 1
v_add_u32_dpp v209, v209, v209 row_shr:8 row_mask:0xf bank_mask:0xf bound_ctrl:0
s_nop 0
v_readlane_b32 s61, v209, 15
v_readlane_b32 s63, v209, 23
s_add_u32 s61, s61, s63
s_mov_b64 exec, 0xff
s_cbranch_vccnz L_gm_W_next
s_add_u32 s63, s61, s88
v_mov_b32 v200, s63
v_mov_b32 v201, s63
v_mov_b32 v202, s63
v_mov_b32 v203, s63
s_lshr_b32 s58, s61, 9
s_and_b32 s63, s58, 15
s_lshl_b32 s63, s63, 8
v_add_u32 v207, s63, v204
s_sub_u32 s58, s58, 2
global_store_dwordx4 v207, v[200:203], s[30:31] sc1
s_mul_i32 s63, s61, 0
s_mul_i32 s65, s59, 8
s_add_u32 s65, s65, s63
s_cmp_eq_u32 s59, 0
s_mov_b32 s59, s61
s_cbranch_scc1 L_gm_W_next
s_mov_b32 exec_lo, -1
v_subrev_u32 v210, s88, v210
v_cmp_gt_u32 vcc, 0x8000, v210
s_nop 1
v_cndmask_b32 v210, 0, v210, vcc
v_max_u32 v211, v211, v210
s_nop 1
v_max_u32_dpp v211, v211, v211 quad_perm:[1,0,3,2] row_mask:0xf bank_mask:0xf
s_nop 1
v_max_u32_dpp v211, v211, v211 quad_perm:[2,3,0,1] row_mask:0xf bank_mask:0xf
v_cmp_eq_u32 vcc, 0, v211
s_nop 0
v_add_u32_dpp v210, v211, v211 row_shr:4 row_mask:0xf bank_mask:0xf bound_ctrl:0
s_nop 1
v_add_u32_dpp v210, v210, v210 row_shr:8 row_mask:0xf bank_mask:0xf bound_ctrl:0
s_cbranch_vccnz L_gm_W_next
s_nop 0
v_readlane_b32 s63, v210, 15
v_readlane_b32 s62, v210, 31
s_add_u32 s63, s63, s62
s_sub_u32 s63, s63, s65
s_ashr_i32 s63, s63, 3
s_add_u32 s63, s63, 0x4000
s_add_u32 s63, s63, s88
s_mov_b64 exec, 0x1000000
v_mov_b32 v212, s63
global_store_dword v208, v212, s[56:57]
L_gm_W_next:
ds_read_b32 v209, v8 offset:8704
s_waitcnt lgkmcnt(0)
v_readfirstlane_b32 s63, v209
s_cmp_eq_u32 s63, s88
s_cbranch_scc1 L_gm_W_x
s_add_u32 s64, s64, 1
s_cmp_lt_u32 s64, 128
s_cbranch_scc1 L_gm_W
L_gm_W_x:
s_mov_b64 exec, -1
L_W_nogm:
s_cmp_lg_u32 s34, 6
s_cbranch_scc1 L_W_noas
s_and_b32 s63, s32, 7
s_mul_i32 s63, s63, 0x100
s_add_u32 s63, s63, 0xc0000
s_add_u32 s56, s30, s63
s_addc_u32 s57, s31, 0
s_lshl_b32 s62, s89, 21
s_sub_u32 s63, 0x8000000, s62
s_add_u32 s68, s6, s62
s_addc_u32 s69, s7, 0
s_and_b32 s69, s69, 0xffff
s_mov_b32 s70, s63
s_mov_b32 s71, 0x20000
s_add_u32 s72, s8, s62
s_addc_u32 s73, s9, 0
s_and_b32 s73, s73, 0xffff
s_mov_b32 s74, s63
s_mov_b32 s75, 0x20000
s_mov_b64 s[76:77], s[68:69]
s_mov_b64 s[78:79], s[70:71]
s_lshr_b32 s62, s32, 3
s_mul_i32 s62, s62, 6
s_sub_u32 s62, s62, 32
v_add_u32 v208, s62, v1
v_cmp_gt_u32 vcc, 32, v1
v_lshlrev_b32 v205, 7, v1
v_add_u32 v206, 0x4000000, v205
v_cndmask_b32 v200, v208, v1, vcc
v_lshlrev_b32 v200, 2, v200
v_mov_b32 v204, 0
s_mov_b32 s64, 0
L_as_W:
s_mov_b64 exec, 0x1ffffff
s_mov_b32 exec_hi, 0x3f
global_load_dword v201, v200, s[56:57] nt
s_waitcnt vmcnt(0)
v_subrev_u32 v201, s88, v201
s_mov_b64 exec, 0xffffff
v_cmp_le_u32 vcc, 0x400, v201
v_readlane_b32 s62, v201, 24
v_add_u32_dpp v201, v201, v201 row_shr:1 row_mask:0xf bank_mask:0xf bound_ctrl:0
s_nop 1
v_add_u32_dpp v201, v201, v201 row_shr:2 row_mask:0xf bank_mask:0xf bound_ctrl:0
s_nop 1
v_add_u32_dpp v201, v201, v201 row_shr:4 row_mask:0xf bank_mask:0xf bound_ctrl:0
s_nop 1
v_add_u32_dpp v201, v201, v201 row_shr:8 row_mask:0xf bank_mask:0xf bound_ctrl:0
s_nop 0
v_readlane_b32 s61, v201, 15
v_readlane_b32 s63, v201, 23
s_add_u32 s61, s61, s63
s_cbranch_vccnz L_as_W_idle
s_sub_u32 s61, s61, 120
s_mov_b32 exec_lo, 0
s_mov_b32 exec_hi, 0x3f
v_cmp_gt_u32 vcc, 280, v201
v_add_u32 v202, 56, v201
s_nop 0
v_cndmask_b32 v208, 0, 8, vcc
v_add_u32 v202, v202, v208
v_lshrrev_b32 v202, 4, v202
v_sub_u32 v208, v202, v204
v_cmp_gt_i32 vcc, 4, v208
v_cmp_le_i32 s[66:67], 2, v208
s_nop 0
v_cndmask_b32 v203, 0, 7, vcc
v_cmp_ge_u32 vcc, 41, v202
v_add_u32 v203, v203, v201
v_lshl_add_u32 v203, v203, 6, v1
s_and_b64 vcc, vcc, s[66:67]
v_cndmask_b32 v203, -1, v203, vcc
s_nop 1
v_min_u32_dpp v203, v203, v203 row_shr:1 row_mask:0xf bank_mask:0xf
s_nop 1
v_min_u32_dpp v203, v203, v203 row_shr:2 row_mask:0xf bank_mask:0xf
s_nop 1
v_min_u32_dpp v203, v203, v203 row_shr:4 row_mask:0xf bank_mask:0xf
s_nop 0
v_readlane_b32 s63, v203, 37
s_lshr_b32 s65, s63, 6
s_and_b32 s63, s63, 63
s_mul_i32 s65, s65, 24
s_cmp_ge_i32 s65, s61
s_cbranch_scc1 L_as_W_idle
v_readlane_b32 s65, v202, s63
s_mov_b32 m0, s63
s_mov_b64 exec, -1
s_cmp_lt_u32 s65, 21
s_cselect_b64 s[76:77], s[68:69], s[72:73]
v_writelane_b32 v204, s65, m0
s_cselect_b32 s66, 0, 21
s_sub_u32 s65, s65, s66
s_mul_i32 s65, s65, 0x18000
s_and_b32 s63, s63, 7
s_lshl_b32 s63, s63, 14
s_add_u32 s65, s65, s63
s_add_u32 s66, s65, 0x2000
buffer_load_dword v207, v205, s[76:79], s65 offen
buffer_load_dword v207, v205, s[76:79], s66 offen
buffer_load_dword v207, v206, s[76:79], s65 offen
buffer_load_dword v207, v206, s[76:79], s66 offen
s_waitcnt vmcnt(1)
s_branch L_as_W_next
L_as_W_idle:
s_sleep 4
L_as_W_next:
s_mov_b64 exec, 1
ds_read_b32 v208, v8 offset:8704
s_waitcnt lgkmcnt(0)
v_readfirstlane_b32 s63, v208
s_cmp_eq_u32 s63, s88
s_cbranch_scc1 L_as_W_x
s_add_u32 s64, s64, 1
s_cmp_lt_u32 s64, 96
s_cbranch_scc1 L_as_W
L_as_W_x:
s_mov_b64 exec, -1
s_waitcnt vmcnt(0)
L_W_noas:
s_cmp_lg_u32 s34, 0
s_cbranch_scc1 L_wc_Wc
s_lshl_b32 s62, s32, 4
s_add_u32 s62, s62, 0x10000
v_and_b32 v193, 31, v1
v_lshl_add_u32 v192, v193, 9, s62
s_lshl_b64 exec, 1, s32
s_mov_b32 s64, 0
L_tp_Wc0:
buffer_load_dwordx4 v[196:199], v192, s[52:55], 0 offen sc1
s_waitcnt vmcnt(0)
v_cmp_ne_u32 s[62:63], s88, v197
v_cmp_ne_u32 vcc, s88, v199
s_add_u32 s64, s64, 1
s_nop 0
s_or_b64 vcc, vcc, s[62:63]
s_cbranch_scc0 L_tp_Wc0_ok
s_sleep 32
s_cmp_lt_u32 s64, 65536
s_cbranch_scc1 L_tp_Wc0
L_tp_Wc0_ok:
s_mov_b32 exec_lo, -1
s_mov_b32 exec_hi, 0
s_mov_b32 s64, 0
L_tp_Wc:
buffer_load_dwordx4 v[196:199], v192, s[52:55], 0 offen sc1
s_waitcnt vmcnt(0)
v_cmp_ne_u32 s[62:63], s88, v197
v_cmp_ne_u32 vcc, s88, v199
s_add_u32 s64, s64, 1
s_nop 0
s_or_b64 vcc, vcc, s[62:63]
s_cbranch_scc0 L_tp_Wc_ok
s_mov_b64 exec, vcc
s_sleep 8
s_cmp_lt_u32 s64, 65536
s_cbranch_scc1 L_tp_Wc
L_tp_Wc_ok:
s_mov_b32 exec_lo, -1
s_mov_b32 exec_hi, 0
v_lshlrev_b32 v193, 3, v193
v_mov_b32 v197, v198
ds_write_b64 v193, v[196:197] offset:8192
v_mov_b32 v199, s88
ds_write_b32 v8, v199 offset:8704
s_mov_b64 exec, -1
s_waitcnt lgkmcnt(0)
L_wc_Wc:
s_barrier
s_lshr_b32 s35, s34, 2
s_and_b32 s36, s34, 3
s_lshl_b32 s62, s35, 5
s_add_u32 s62, s62, s32
s_lshl_b32 s63, s62, 7
s_add_u32 s63, s63, 0x10000
v_lshl_add_u32 v192, v2, 3, s63
s_lshl_b32 s63, s35, 7
v_lshl_add_u32 v192, v2, 3, s63
ds_read_b64 v[194:195], v192 offset:8192
s_lshl_b32 s63, s62, 14
s_add_u32 s63, s63, 0x200000
s_lshl_b32 s64, s36, 12
s_add_u32 s63, s63, s64
v_lshl_add_u32 v193, v1, 4, s63
s_mov_b32 s64, 0x0
buffer_load_dwordx4 v[200:203], v193, s[52:55], s64 offen offset:0 sc1
s_mov_b32 s64, 0x0
buffer_load_dwordx4 v[204:207], v193, s[52:55], s64 offen offset:1024 sc1
s_mov_b32 s64, 0x0
buffer_load_dwordx4 v[208:211], v193, s[52:55], s64 offen offset:2048 sc1
s_mov_b32 s64, 0x0
buffer_load_dwordx4 v[212:215], v193, s[52:55], s64 offen offset:3072 sc1
s_waitcnt vmcnt(4) lgkmcnt(0)
v_mov_b32 v196, v194
s_nop 1
v_max_f32_dpp v196, v196, v196 row_ror:8 row_mask:0xf bank_mask:0xf
s_nop 1
v_max_f32_dpp v196, v196, v196 row_ror:4 row_mask:0xf bank_mask:0xf
s_nop 1
v_max_f32_dpp v196, v196, v196 row_ror:2 row_mask:0xf bank_mask:0xf
s_nop 1
v_max_f32_dpp v196, v196, v196 row_ror:1 row_mask:0xf bank_mask:0xf
v_sub_f32 v197, v194, v196
v_exp_f32 v197, v197
s_nop 0
v_mul_f32 v195, v195, v197
s_nop 1
v_add_f32_dpp v195, v195, v195 row_ror:8 row_mask:0xf bank_mask:0xf
s_nop 1
v_add_f32_dpp v195, v195, v195 row_ror:4 row_mask:0xf bank_mask:0xf
s_nop 1
v_add_f32_dpp v195, v195, v195 row_ror:2 row_mask:0xf bank_mask:0xf
s_nop 1
v_add_f32_dpp v195, v195, v195 row_ror:1 row_mask:0xf bank_mask:0xf
v_rcp_f32 v195, v195
s_nop 0
v_mul_f32 v197, v197, v195
s_lshl_b32 s64, s36, 2
s_add_u32 s65, s64, 0
v_readlane_b32 s66, v197, s65
s_add_u32 s65, s64, 1
v_readlane_b32 s67, v197, s65
s_add_u32 s65, s64, 2
v_readlane_b32 s68, v197, s65
s_add_u32 s65, s64, 3
v_readlane_b32 s69, v197, s65
s_waitcnt vmcnt(3)
v_lshlrev_b32 v216, 16, v200
v_and_b32 v217, 0xffff0000, v200
v_lshlrev_b32 v218, 16, v201
v_and_b32 v219, 0xffff0000, v201
v_lshlrev_b32 v220, 16, v202
v_and_b32 v221, 0xffff0000, v202
v_lshlrev_b32 v222, 16, v203
v_and_b32 v223, 0xffff0000, v203
v_mul_f32 v232, s66, v216
v_mul_f32 v233, s66, v217
v_mul_f32 v234, s66, v218
v_mul_f32 v235, s66, v219
v_mul_f32 v236, s66, v220
v_mul_f32 v237, s66, v221
v_mul_f32 v238, s66, v222
v_mul_f32 v239, s66, v223
s_waitcnt vmcnt(2)
v_lshlrev_b32 v216, 16, v204
v_and_b32 v217, 0xffff0000, v204
v_lshlrev_b32 v218, 16, v205
v_and_b32 v219, 0xffff0000, v205
v_lshlrev_b32 v220, 16, v206
v_and_b32 v221, 0xffff0000, v206
v_lshlrev_b32 v222, 16, v207
v_and_b32 v223, 0xffff0000, v207
v_fma_f32 v232, v216, s67, v232
v_fma_f32 v233, v217, s67, v233
v_fma_f32 v234, v218, s67, v234
v_fma_f32 v235, v219, s67, v235
v_fma_f32 v236, v220, s67, v236
v_fma_f32 v237, v221, s67, v237
v_fma_f32 v238, v222, s67, v238
v_fma_f32 v239, v223, s67, v239
s_waitcnt vmcnt(1)
v_lshlrev_b32 v216, 16, v208
v_and_b32 v217, 0xffff0000, v208
v_lshlrev_b32 v218, 16, v209
v_and_b32 v219, 0xffff0000, v209
v_lshlrev_b32 v220, 16, v210
v_and_b32 v221, 0xffff0000, v210
v_lshlrev_b32 v222, 16, v211
v_and_b32 v223, 0xffff0000, v211
v_fma_f32 v232, v216, s68, v232
v_fma_f32 v233, v217, s68, v233
v_fma_f32 v234, v218, s68, v234
v_fma_f32 v235, v219, s68, v235
v_fma_f32 v236, v220, s68, v236
v_fma_f32 v237, v221, s68, v237
v_fma_f32 v238, v222, s68, v238
v_fma_f32 v239, v223, s68, v239
s_waitcnt vmcnt(0)
v_lshlrev_b32 v216, 16, v212
v_and_b32 v217, 0xffff0000, v212
v_lshlrev_b32 v218, 16, v213
v_and_b32 v219, 0xffff0000, v213
v_lshlrev_b32 v220, 16, v214
v_and_b32 v221, 0xffff0000, v214
v_lshlrev_b32 v222, 16, v215
v_and_b32 v223, 0xffff0000, v215
v_fma_f32 v232, v216, s69, v232
v_fma_f32 v233, v217, s69, v233
v_fma_f32 v234, v218, s69, v234
v_fma_f32 v235, v219, s69, v235
v_fma_f32 v236, v220, s69, v236
v_fma_f32 v237, v221, s69, v237
v_fma_f32 v238, v222, s69, v238
v_fma_f32 v239, v223, s69, v239
s_lshl_b32 s62, s34, 11
v_lshl_add_u32 v192, v1, 5, s62
ds_write_b128 v192, v[232:235] offset:18432
ds_write_b128 v192, v[236:239] offset:18448
s_waitcnt lgkmcnt(0)
s_barrier
v_lshrrev_b32 v192, 3, v2
v_lshlrev_b32 v192, 13, v192
v_lshl_add_u32 v192, v3, 6, v192
s_lshl_b32 s62, s34, 8
v_add_u32 v192, s62, v192
ds_read_b128 v[200:203], v192 offset:18432
ds_read_b128 v[204:207], v192 offset:18448
ds_read_b128 v[208:211], v192 offset:18464
ds_read_b128 v[212:215], v192 offset:18480
ds_read_b128 v[216:219], v192 offset:20480
ds_read_b128 v[220:223], v192 offset:20496
ds_read_b128 v[224:227], v192 offset:20512
ds_read_b128 v[228:231], v192 offset:20528
s_waitcnt lgkmcnt(0)
v_add_f32 v200, v200, v216
v_add_f32 v201, v201, v217
v_add_f32 v202, v202, v218
v_add_f32 v203, v203, v219
v_add_f32 v204, v204, v220
v_add_f32 v205, v205, v221
v_add_f32 v206, v206, v222
v_add_f32 v207, v207, v223
v_add_f32 v208, v208, v224
v_add_f32 v209, v209, v225
v_add_f32 v210, v210, v226
v_add_f32 v211, v211, v227
v_add_f32 v212, v212, v228
v_add_f32 v213, v213, v229
v_add_f32 v214, v214, v230
v_add_f32 v215, v215, v231
ds_read_b128 v[216:219], v192 offset:22528
ds_read_b128 v[220:223], v192 offset:22544
ds_read_b128 v[224:227], v192 offset:22560
ds_read_b128 v[228:231], v192 offset:22576
s_waitcnt lgkmcnt(0)
v_add_f32 v200, v200, v216
v_add_f32 v201, v201, v217
v_add_f32 v202, v202, v218
v_add_f32 v203, v203, v219
v_add_f32 v204, v204, v220
v_add_f32 v205, v205, v221
v_add_f32 v206, v206, v222
v_add_f32 v207, v207, v223
v_add_f32 v208, v208, v224
v_add_f32 v209, v209, v225
v_add_f32 v210, v210, v226
v_add_f32 v211, v211, v227
v_add_f32 v212, v212, v228
v_add_f32 v213, v213, v229
v_add_f32 v214, v214, v230
v_add_f32 v215, v215, v231
ds_read_b128 v[216:219], v192 offset:24576
ds_read_b128 v[220:223], v192 offset:24592
ds_read_b128 v[224:227], v192 offset:24608
ds_read_b128 v[228:231], v192 offset:24624
s_waitcnt lgkmcnt(0)
v_add_f32 v200, v200, v216
v_add_f32 v201, v201, v217
v_add_f32 v202, v202, v218
v_add_f32 v203, v203, v219
v_add_f32 v204, v204, v220
v_add_f32 v205, v205, v221
v_add_f32 v206, v206, v222
v_add_f32 v207, v207, v223
v_add_f32 v208, v208, v224
v_add_f32 v209, v209, v225
v_add_f32 v210, v210, v226
v_add_f32 v211, v211, v227
v_add_f32 v212, v212, v228
v_add_f32 v213, v213, v229
v_add_f32 v214, v214, v230
v_add_f32 v215, v215, v231
v_cvt_pk_bf16_f32 v12, v200, v201
v_cvt_pk_bf16_f32 v13, v202, v203
v_cvt_pk_bf16_f32 v14, v204, v205
v_cvt_pk_bf16_f32 v15, v206, v207
v_cvt_pk_bf16_f32 v16, v208, v209
v_cvt_pk_bf16_f32 v17, v210, v211
v_cvt_pk_bf16_f32 v18, v212, v213
v_cvt_pk_bf16_f32 v19, v214, v215
s_mov_b32 s60, 0x01000100
v_perm_b32 v192, v12, v12, s60
v_and_b32 v28, v192, v4
v_and_b32 v29, v192, v5
v_and_b32 v30, v192, v6
v_and_b32 v31, v192, v7
s_waitcnt vmcnt(63)
s_nop 0
v_mfma_f32_16x16x32_bf16 v[44:47], v[28:31], v[64:67], 0
s_mov_b32 s60, 0x03020302
v_perm_b32 v193, v12, v12, s60
v_and_b32 v32, v193, v4
v_and_b32 v33, v193, v5
v_and_b32 v34, v193, v6
v_and_b32 v35, v193, v7
s_waitcnt vmcnt(63)
s_nop 0
v_mfma_f32_16x16x32_bf16 v[44:47], v[32:35], v[68:71], v[44:47]
s_mov_b32 s60, 0x01000100
v_perm_b32 v192, v13, v13, s60
v_and_b32 v28, v192, v4
v_and_b32 v29, v192, v5
v_and_b32 v30, v192, v6
v_and_b32 v31, v192, v7
s_waitcnt vmcnt(63)
s_nop 0
v_mfma_f32_16x16x32_bf16 v[44:47], v[28:31], v[72:75], v[44:47]
s_mov_b32 s60, 0x03020302
v_perm_b32 v193, v13, v13, s60
v_and_b32 v32, v193, v4
v_and_b32 v33, v193, v5
v_and_b32 v34, v193, v6
v_and_b32 v35, v193, v7
s_waitcnt vmcnt(63)
s_nop 0
v_mfma_f32_16x16x32_bf16 v[44:47], v[32:35], v[76:79], v[44:47]
s_mov_b32 s60, 0x01000100
v_perm_b32 v192, v14, v14, s60
v_and_b32 v28, v192, v4
v_and_b32 v29, v192, v5
v_and_b32 v30, v192, v6
v_and_b32 v31, v192, v7
s_waitcnt vmcnt(63)
s_nop 0
v_mfma_f32_16x16x32_bf16 v[44:47], v[28:31], v[80:83], v[44:47]
s_mov_b32 s60, 0x03020302
v_perm_b32 v193, v14, v14, s60
v_and_b32 v32, v193, v4
v_and_b32 v33, v193, v5
v_and_b32 v34, v193, v6
v_and_b32 v35, v193, v7
s_waitcnt vmcnt(63)
s_nop 0
v_mfma_f32_16x16x32_bf16 v[44:47], v[32:35], v[84:87], v[44:47]
s_mov_b32 s60, 0x01000100
v_perm_b32 v192, v15, v15, s60
v_and_b32 v28, v192, v4
v_and_b32 v29, v192, v5
v_and_b32 v30, v192, v6
v_and_b32 v31, v192, v7
s_waitcnt vmcnt(63)
s_nop 0
v_mfma_f32_16x16x32_bf16 v[44:47], v[28:31], v[88:91], v[44:47]
s_mov_b32 s60, 0x03020302
v_perm_b32 v193, v15, v15, s60
v_and_b32 v32, v193, v4
v_and_b32 v33, v193, v5
v_and_b32 v34, v193, v6
v_and_b32 v35, v193, v7
s_waitcnt vmcnt(63)
s_nop 0
v_mfma_f32_16x16x32_bf16 v[44:47], v[32:35], v[92:95], v[44:47]
s_mov_b32 s60, 0x01000100
v_perm_b32 v192, v16, v16, s60
v_and_b32 v28, v192, v4
v_and_b32 v29, v192, v5
v_and_b32 v30, v192, v6
v_and_b32 v31, v192, v7
s_waitcnt vmcnt(63)
s_nop 0
v_mfma_f32_16x16x32_bf16 v[44:47], v[28:31], v[96:99], v[44:47]
s_mov_b32 s60, 0x03020302
v_perm_b32 v193, v16, v16, s60
v_and_b32 v32, v193, v4
v_and_b32 v33, v193, v5
v_and_b32 v34, v193, v6
v_and_b32 v35, v193, v7
s_waitcnt vmcnt(63)
s_nop 0
v_mfma_f32_16x16x32_bf16 v[44:47], v[32:35], v[100:103], v[44:47]
s_mov_b32 s60, 0x01000100
v_perm_b32 v192, v17, v17, s60
v_and_b32 v28, v192, v4
v_and_b32 v29, v192, v5
v_and_b32 v30, v192, v6
v_and_b32 v31, v192, v7
s_waitcnt vmcnt(63)
s_nop 0
v_mfma_f32_16x16x32_bf16 v[44:47], v[28:31], v[104:107], v[44:47]
s_mov_b32 s60, 0x03020302
v_perm_b32 v193, v17, v17, s60
v_and_b32 v32, v193, v4
v_and_b32 v33, v193, v5
v_and_b32 v34, v193, v6
v_and_b32 v35, v193, v7
s_waitcnt vmcnt(63)
s_nop 0
v_mfma_f32_16x16x32_bf16 v[44:47], v[32:35], v[108:111], v[44:47]
s_mov_b32 s60, 0x01000100
v_perm_b32 v192, v18, v18, s60
v_and_b32 v28, v192, v4
v_and_b32 v29, v192, v5
v_and_b32 v30, v192, v6
v_and_b32 v31, v192, v7
s_waitcnt vmcnt(63)
s_nop 0
v_mfma_f32_16x16x32_bf16 v[44:47], v[28:31], v[112:115], v[44:47]
s_mov_b32 s60, 0x03020302
v_perm_b32 v193, v18, v18, s60
v_and_b32 v32, v193, v4
v_and_b32 v33, v193, v5
v_and_b32 v34, v193, v6
v_and_b32 v35, v193, v7
s_waitcnt vmcnt(63)
s_nop 0
v_mfma_f32_16x16x32_bf16 v[44:47], v[32:35], v[116:119], v[44:47]
s_mov_b32 s60, 0x01000100
v_perm_b32 v192, v19, v19, s60
v_and_b32 v28, v192, v4
v_and_b32 v29, v192, v5
v_and_b32 v30, v192, v6
v_and_b32 v31, v192, v7
s_waitcnt vmcnt(63)
s_nop 0
v_mfma_f32_16x16x32_bf16 v[44:47], v[28:31], v[120:123], v[44:47]
s_mov_b32 s60, 0x03020302
v_perm_b32 v193, v19, v19, s60
v_and_b32 v32, v193, v4
v_and_b32 v33, v193, v5
v_and_b32 v34, v193, v6
v_and_b32 v35, v193, v7
s_waitcnt vmcnt(63)
s_nop 0
v_mfma_f32_16x16x32_bf16 v[44:47], v[32:35], v[124:127], v[44:47]
v_lshrrev_b32 v192, 1, v3
v_lshlrev_b32 v192, 9, v192
v_lshl_add_u32 v192, v2, 5, v192
v_and_b32 v193, 1, v3
v_lshl_add_u32 v192, v193, 4, v192
s_lshl_b32 s63, s34, 10
v_add_u32 v192, s63, v192
s_nop 1
s_nop 5
ds_write_b128 v192, v[44:47] offset:9216
s_waitcnt lgkmcnt(0)
s_barrier
v_lshrrev_b32 v192, 3, v2
v_lshlrev_b32 v192, 9, v192
v_lshl_add_u32 v192, v3, 4, v192
s_lshl_b32 s62, s34, 6
v_add_u32 v192, s62, v192
ds_read_b128 v[200:203], v192 offset:9216
ds_read_b128 v[204:207], v192 offset:10240
ds_read_b128 v[208:211], v192 offset:11264
ds_read_b128 v[212:215], v192 offset:12288
ds_read_b128 v[216:219], v192 offset:13312
ds_read_b128 v[220:223], v192 offset:14336
ds_read_b128 v[224:227], v192 offset:15360
ds_read_b128 v[228:231], v192 offset:16384
s_waitcnt lgkmcnt(6)
v_add_f32 v200, v200, v204
v_add_f32 v201, v201, v205
v_add_f32 v202, v202, v206
v_add_f32 v203, v203, v207
s_waitcnt lgkmcnt(5)
v_add_f32 v200, v200, v208
v_add_f32 v201, v201, v209
v_add_f32 v202, v202, v210
v_add_f32 v203, v203, v211
s_waitcnt lgkmcnt(4)
v_add_f32 v200, v200, v212
v_add_f32 v201, v201, v213
v_add_f32 v202, v202, v214
v_add_f32 v203, v203, v215
s_waitcnt lgkmcnt(3)
v_add_f32 v200, v200, v216
v_add_f32 v201, v201, v217
v_add_f32 v202, v202, v218
v_add_f32 v203, v203, v219
s_waitcnt lgkmcnt(2)
v_add_f32 v200, v200, v220
v_add_f32 v201, v201, v221
v_add_f32 v202, v202, v222
v_add_f32 v203, v203, v223
s_waitcnt lgkmcnt(1)
v_add_f32 v200, v200, v224
v_add_f32 v201, v201, v225
v_add_f32 v202, v202, v226
v_add_f32 v203, v203, v227
s_waitcnt lgkmcnt(0)
v_add_f32 v200, v200, v228
v_add_f32 v201, v201, v229
v_add_f32 v202, v202, v230
v_add_f32 v203, v203, v231
v_cvt_pk_bf16_f32 v60, v200, v200
v_cvt_pk_bf16_f32 v61, v201, v201
v_cvt_pk_bf16_f32 v62, v202, v202
v_cvt_pk_bf16_f32 v63, v203, v203
v_and_b32 v28, v60, v4
v_and_b32 v29, v60, v5
v_and_b32 v30, v60, v6
v_and_b32 v31, v60, v7
v_and_b32 v32, v61, v4
v_and_b32 v33, v61, v5
v_and_b32 v34, v61, v6
v_and_b32 v35, v61, v7
v_and_b32 v36, v62, v4
v_and_b32 v37, v62, v5
v_and_b32 v38, v62, v6
v_and_b32 v39, v62, v7
v_and_b32 v40, v63, v4
v_and_b32 v41, v63, v5
v_and_b32 v42, v63, v6
v_and_b32 v43, v63, v7
s_nop 1
v_mfma_f32_16x16x32_bf16 v[44:47], v[28:31], v[128:131], 0
v_mfma_f32_16x16x32_bf16 v[48:51], v[28:31], v[132:135], 0
v_mfma_f32_16x16x32_bf16 v[52:55], v[28:31], v[136:139], 0
v_mfma_f32_16x16x32_bf16 v[56:59], v[28:31], v[140:143], 0
v_mfma_f32_16x16x32_bf16 v[44:47], v[32:35], v[144:147], v[44:47]
v_mfma_f32_16x16x32_bf16 v[48:51], v[32:35], v[148:151], v[48:51]
v_mfma_f32_16x16x32_bf16 v[52:55], v[32:35], v[152:155], v[52:55]
v_mfma_f32_16x16x32_bf16 v[56:59], v[32:35], v[156:159], v[56:59]
v_mfma_f32_16x16x32_bf16 v[44:47], v[36:39], v[160:163], v[44:47]
v_mfma_f32_16x16x32_bf16 v[48:51], v[36:39], v[164:167], v[48:51]
v_mfma_f32_16x16x32_bf16 v[52:55], v[36:39], v[168:171], v[52:55]
v_mfma_f32_16x16x32_bf16 v[56:59], v[36:39], v[172:175], v[56:59]
v_mfma_f32_16x16x32_bf16 v[44:47], v[40:43], v[176:179], v[44:47]
v_mfma_f32_16x16x32_bf16 v[48:51], v[40:43], v[180:183], v[48:51]
v_mfma_f32_16x16x32_bf16 v[52:55], v[40:43], v[184:187], v[52:55]
v_mfma_f32_16x16x32_bf16 v[56:59], v[40:43], v[188:191], v[56:59]
v_lshrrev_b32 v192, 1, v3
v_lshlrev_b32 v192, 11, v192
v_lshl_add_u32 v192, v2, 5, v192
v_and_b32 v193, 1, v3
v_lshl_add_u32 v192, v193, 4, v192
s_lshl_b32 s63, s34, 12
v_add_u32 v192, s63, v192
s_nop 1
ds_write_b128 v192, v[44:47] offset:18432
ds_write_b128 v192, v[48:51] offset:18944
ds_write_b128 v192, v[52:55] offset:19456
s_nop 5
ds_write_b128 v192, v[56:59] offset:19968
s_waitcnt lgkmcnt(0)
s_barrier
s_cmp_ge_u32 s34, 4
s_cbranch_scc1 L_W_yskip
v_lshlrev_b32 v192, 4, v0
ds_read_b128 v[200:203], v192 offset:18432
ds_read_b128 v[204:207], v192 offset:22528
ds_read_b128 v[208:211], v192 offset:26624
ds_read_b128 v[212:215], v192 offset:30720
ds_read_b128 v[216:219], v192 offset:34816
ds_read_b128 v[220:223], v192 offset:38912
ds_read_b128 v[224:227], v192 offset:43008
ds_read_b128 v[228:231], v192 offset:47104
v_lshrrev_b32 v193, 7, v0
v_lshlrev_b32 v193, 16, v193
v_and_b32 v194, 127, v0
v_lshl_add_u32 v193, v194, 4, v193
s_lshl_b32 s63, s32, 11
s_add_u32 s63, s63, 0x20000
v_add_u32 v193, s63, v193
s_waitcnt lgkmcnt(6)
v_add_f32 v200, v200, v204
v_add_f32 v201, v201, v205
v_add_f32 v202, v202, v206
v_add_f32 v203, v203, v207
s_waitcnt lgkmcnt(5)
v_add_f32 v200, v200, v208
v_add_f32 v201, v201, v209
v_add_f32 v202, v202, v210
v_add_f32 v203, v203, v211
s_waitcnt lgkmcnt(4)
v_add_f32 v200, v200, v212
v_add_f32 v201, v201, v213
v_add_f32 v202, v202, v214
v_add_f32 v203, v203, v215
s_waitcnt lgkmcnt(3)
v_add_f32 v200, v200, v216
v_add_f32 v201, v201, v217
v_add_f32 v202, v202, v218
v_add_f32 v203, v203, v219
s_waitcnt lgkmcnt(2)
v_add_f32 v200, v200, v220
v_add_f32 v201, v201, v221
v_add_f32 v202, v202, v222
v_add_f32 v203, v203, v223
s_waitcnt lgkmcnt(1)
v_add_f32 v200, v200, v224
v_add_f32 v201, v201, v225
v_add_f32 v202, v202, v226
v_add_f32 v203, v203, v227
s_waitcnt lgkmcnt(0)
v_add_f32 v200, v200, v228
v_add_f32 v201, v201, v229
v_add_f32 v202, v202, v230
v_add_f32 v203, v203, v231
v_cvt_pk_bf16_f32 v200, v200, v201
v_cvt_pk_bf16_f32 v202, v202, v203
v_mov_b32 v201, s88
v_mov_b32 v203, s88
buffer_store_dwordx4 v[200:203], v193, s[52:55], 0 offen sc1
L_W_yskip:
s_lshr_b32 s35, s32, 4
s_and_b32 s36, s32, 15
v_mov_b32 v232, 0
v_mov_b32 v233, 0
v_mov_b32 v234, 0
v_mov_b32 v235, 0
s_cmp_ge_u32 s34, 4
s_cbranch_scc1 L_W_bskip
v_lshrrev_b32 v192, 3, v0
v_lshlrev_b32 v192, 11, v192
v_and_b32 v193, 7, v0
v_lshl_add_u32 v192, v193, 4, v192
s_lshl_b32 s62, s35, 16
s_lshl_b32 s63, s36, 7
s_add_u32 s62, s62, s63
s_add_u32 s62, s62, 0x20000
v_add_u32 v192, s62, v192
s_mov_b32 s64, 0
L_tp_Wyb:
buffer_load_dwordx4 v[232:235], v192, s[52:55], 0 offen sc1
s_waitcnt vmcnt(0)
v_cmp_ne_u32 s[62:63], s88, v233
v_cmp_ne_u32 vcc, s88, v235
s_add_u32 s64, s64, 1
s_nop 0
s_or_b64 vcc, vcc, s[62:63]
s_cbranch_scc0 L_tp_Wyb_ok
s_mov_b64 exec, vcc
s_sleep 8
s_cmp_lt_u32 s64, 65536
s_cbranch_scc1 L_tp_Wyb
L_tp_Wyb_ok:
s_mov_b64 exec, -1
v_and_b32 v233, 0xffff0000, v232
v_lshlrev_b32 v232, 16, v232
v_and_b32 v235, 0xffff0000, v234
v_lshlrev_b32 v234, 16, v234
L_W_bskip:
v_and_b32 v192, 7, v1
v_lshl_add_u32 v240, v3, 3, v192
v_mul_u32_u24 v240, 48, v240
ds_write_b32 v240, v8 offset:32
s_lshr_b32 s62, s32, 4
s_lshl_b32 s62, s62, 11
s_bfe_u32 s63, s32, 0x20002
s_lshl_b32 s63, s63, 8
s_add_u32 s62, s62, s63
s_and_b32 s63, s32, 1
s_lshl_b32 s63, s63, 7
s_add_u32 s62, s62, s63
s_and_b32 s63, s32, 2
s_lshl_b32 s63, s63, 2
s_add_u32 s62, s62, s63
v_lshl_add_u32 v243, v192, 3, v3
v_lshl_add_u32 v243, v243, 1, s62
s_lshl_b32 s63, s34, 2
v_add_u32 v241, s63, v240
v_mov_b32 v242, 1
s_nop 1
v_add_f32_dpp v232, v232, v232 row_ror:8 row_mask:0xf bank_mask:0xf
v_add_f32_dpp v233, v233, v233 row_ror:8 row_mask:0xf bank_mask:0xf
v_add_f32_dpp v234, v234, v234 row_ror:8 row_mask:0xf bank_mask:0xf
v_add_f32_dpp v235, v235, v235 row_ror:8 row_mask:0xf bank_mask:0xf
v_mov_b32 v192, v232
v_mov_b32 v193, v233
v_mov_b32 v194, v234
v_mov_b32 v195, v235
s_nop 1
v_permlane16_swap_b32 v232, v192
v_permlane16_swap_b32 v233, v193
v_permlane16_swap_b32 v234, v194
v_permlane16_swap_b32 v235, v195
s_nop 0
v_add_f32 v232, v232, v192
v_add_f32 v233, v233, v193
v_add_f32 v234, v234, v194
v_add_f32 v235, v235, v195
v_mov_b32 v192, v232
v_mov_b32 v193, v233
v_mov_b32 v194, v234
v_mov_b32 v195, v235
s_nop 1
v_permlane32_swap_b32 v232, v192
v_permlane32_swap_b32 v233, v193
v_permlane32_swap_b32 v234, v194
v_permlane32_swap_b32 v235, v195
s_nop 0
v_add_f32 v232, v232, v192
v_add_f32 v233, v233, v193
v_add_f32 v234, v234, v194
v_add_f32 v235, v235, v195
v_lshlrev_b32 v192, 4, v1
s_lshl_b32 s63, s34, 7
v_add_u32 v192, s63, v192
s_mov_b64 exec, 0xff
ds_write_b128 v192, v[232:235] offset:17408
s_mov_b64 exec, -1
s_waitcnt lgkmcnt(0)
s_barrier
s_cmp_lg_u32 s34, 0
s_cbranch_scc1 L_Wb_fin
v_lshlrev_b32 v192, 2, v1
s_mov_b32 exec_hi, 0
ds_read_b32 v193, v192 offset:17408
ds_read_b32 v194, v192 offset:17536
ds_read_b32 v195, v192 offset:17664
ds_read_b32 v196, v192 offset:17792
s_waitcnt lgkmcnt(0)
v_add_f32 v193, v193, v194
v_add_f32 v193, v193, v195
v_add_f32 v193, v193, v196
v_cvt_pk_bf16_f32 v193, v193, v193
s_lshr_b32 s62, s32, 4
s_lshl_b32 s62, s62, 11
s_and_b32 s63, s32, 15
s_lshl_b32 s63, s63, 6
s_add_u32 s62, s62, s63
s_add_u32 s62, s62, 1024
v_lshl_add_u32 v192, v1, 1, s62
global_store_short v192, v193, s[26:27]
s_mov_b64 exec, -1
L_Wb_fin:
v_lshrrev_b32 v192, 3, v1
s_lshl_b32 s62, s35, 8
s_lshl_b32 s63, s34, 3
s_add_u32 s62, s62, s63
v_add_u32 v192, s62, v192
v_lshlrev_b32 v9, 4, v192
v_add_u32 v9, 0x14000, v9
v_and_b32 v9, 255, v192
s_lshl_b32 s63, s35, 4
s_add_u32 s63, s63, 0x50000
v_lshl_add_u32 v9, v9, 7, s63
v_lshlrev_b32 v10, 10, v192
v_and_b32 v193, 7, v1
v_lshl_add_u32 v10, v193, 3, v10
s_lshl_b32 s63, s36, 6
s_add_u32 s63, s63, 0x100000
v_add_u32 v10, s63, v10
v_mov_b32 v80, 0xff800000
v_mov_b32 v81, 0
v_mov_b32 v64, 0
v_mov_b32 v65, 0
v_mov_b32 v82, 0xff800000
v_mov_b32 v83, 0
v_mov_b32 v66, 0
v_mov_b32 v67, 0
v_mov_b32 v84, 0xff800000
v_mov_b32 v85, 0
v_mov_b32 v68, 0
v_mov_b32 v69, 0
v_mov_b32 v86, 0xff800000
v_mov_b32 v87, 0
v_mov_b32 v70, 0
v_mov_b32 v71, 0
s_mov_b32 s66, -1
s_mov_b32 s67, 0xffff
s_mov_b32 s68, -1
s_mov_b32 s69, 0xffff
s_mov_b32 s70, -1
s_mov_b32 s71, 0xffff
s_mov_b32 s72, -1
s_mov_b32 s73, 0xffff
s_mov_b32 s64, 0
s_mov_b64 exec, s[66:67]
L_W_stt:
s_mov_b32 s63, 0
buffer_load_dwordx4 v[96:99], v9, s[52:55], s63 offen sc1
s_mov_b32 s63, 8192
buffer_load_dwordx4 v[100:103], v9, s[52:55], s63 offen sc1
s_mov_b32 s63, 16384
buffer_load_dwordx4 v[104:107], v9, s[52:55], s63 offen sc1
s_mov_b32 s63, 24576
buffer_load_dwordx4 v[108:111], v9, s[52:55], s63 offen sc1
s_waitcnt vmcnt(0)
v_xor_b32 v97, s88, v97
v_xor_b32 v99, s88, v99
v_xor_b32 v101, s88, v101
v_xor_b32 v103, s88, v103
v_xor_b32 v105, s88, v105
v_xor_b32 v107, s88, v107
v_xor_b32 v109, s88, v109
v_xor_b32 v111, s88, v111
v_or3_b32 v192, v97, v99, v101
v_or3_b32 v192, v192, v103, v105
v_or3_b32 v192, v192, v107, v109
v_or_b32 v192, v192, v111
v_cmp_ne_u32 vcc, 0, v192
s_add_u32 s64, s64, 1
s_nop 0
s_cmp_eq_u64 vcc, 0
s_cbranch_scc1 L_W_stt_done
s_sleep 16
s_cmp_lt_u32 s64, 65536
s_cbranch_scc1 L_W_stt
L_W_stt_done:
v_mov_b32 v80, v96
v_mov_b32 v81, v98
v_mov_b32 v82, v100
v_mov_b32 v83, v102
v_mov_b32 v84, v104
v_mov_b32 v85, v106
v_mov_b32 v86, v108
v_mov_b32 v87, v110
s_mov_b64 exec, -1
v_mov_b32 v192, v80
v_mov_b32 v193, v82
v_mov_b32 v194, v84
v_mov_b32 v195, v86
s_nop 1
v_max_f32_dpp v192, v192, v192 row_ror:8 row_mask:0xf bank_mask:0xf
v_max_f32_dpp v193, v193, v193 row_ror:8 row_mask:0xf bank_mask:0xf
v_max_f32_dpp v194, v194, v194 row_ror:8 row_mask:0xf bank_mask:0xf
v_max_f32_dpp v195, v195, v195 row_ror:8 row_mask:0xf bank_mask:0xf
v_mov_b32 v196, v192
v_mov_b32 v197, v193
v_mov_b32 v198, v194
v_mov_b32 v199, v195
s_nop 1
v_permlane16_swap_b32 v192, v196
v_permlane16_swap_b32 v193, v197
v_permlane16_swap_b32 v194, v198
v_permlane16_swap_b32 v195, v199
s_nop 0
v_max_f32 v192, v192, v196
v_max_f32 v193, v193, v197
v_max_f32 v194, v194, v198
v_max_f32 v195, v195, v199
v_mov_b32 v196, v192
v_mov_b32 v197, v193
v_mov_b32 v198, v194
v_mov_b32 v199, v195
s_nop 1
v_permlane32_swap_b32 v192, v196
v_permlane32_swap_b32 v193, v197
v_permlane32_swap_b32 v194, v198
v_permlane32_swap_b32 v195, v199
s_nop 0
v_max_f32 v192, v192, v196
v_max_f32 v193, v193, v197
v_max_f32 v194, v194, v198
v_max_f32 v195, v195, v199
v_sub_f32 v192, v80, v192
v_sub_f32 v193, v82, v193
v_sub_f32 v194, v84, v194
v_sub_f32 v195, v86, v195
v_exp_f32 v192, v192
v_exp_f32 v193, v193
v_exp_f32 v194, v194
v_exp_f32 v195, v195
s_nop 0
v_mul_f32 v200, v81, v192
v_mul_f32 v201, v83, v193
v_mul_f32 v202, v85, v194
v_mul_f32 v203, v87, v195
s_nop 1
v_add_f32_dpp v200, v200, v200 row_ror:8 row_mask:0xf bank_mask:0xf
v_add_f32_dpp v201, v201, v201 row_ror:8 row_mask:0xf bank_mask:0xf
v_add_f32_dpp v202, v202, v202 row_ror:8 row_mask:0xf bank_mask:0xf
v_add_f32_dpp v203, v203, v203 row_ror:8 row_mask:0xf bank_mask:0xf
v_mov_b32 v196, v200
v_mov_b32 v197, v201
v_mov_b32 v198, v202
v_mov_b32 v199, v203
s_nop 1
v_permlane16_swap_b32 v200, v196
v_permlane16_swap_b32 v201, v197
v_permlane16_swap_b32 v202, v198
v_permlane16_swap_b32 v203, v199
s_nop 0
v_add_f32 v200, v200, v196
v_add_f32 v201, v201, v197
v_add_f32 v202, v202, v198
v_add_f32 v203, v203, v199
v_mov_b32 v196, v200
v_mov_b32 v197, v201
v_mov_b32 v198, v202
v_mov_b32 v199, v203
s_nop 1
v_permlane32_swap_b32 v200, v196
v_permlane32_swap_b32 v201, v197
v_permlane32_swap_b32 v202, v198
v_permlane32_swap_b32 v203, v199
s_nop 0
v_add_f32 v200, v200, v196
v_add_f32 v201, v201, v197
v_add_f32 v202, v202, v198
v_add_f32 v203, v203, v199
v_rcp_f32 v200, v200
v_rcp_f32 v201, v201
v_rcp_f32 v202, v202
v_rcp_f32 v203, v203
s_nop 0
v_mul_f32 v80, v192, v200
v_mul_f32 v81, v193, v201
v_mul_f32 v82, v194, v202
v_mul_f32 v83, v195, v203
v_mov_b32 v232, 0
v_mov_b32 v233, 0
v_mov_b32 v234, 0
v_mov_b32 v235, 0
s_mov_b32 s64, 0
s_mov_b32 s74, 0x1010101
s_mov_b32 s75, 0x101
L_W_gate:
s_mov_b64 exec, s[74:75]
buffer_load_dword v192, v10, s[52:55], 0 offen sc1
s_waitcnt vmcnt(0)
v_cmp_ne_u32 vcc, -1, v192
s_mov_b64 exec, -1
s_add_u32 s64, s64, 1
s_cmp_lg_u64 vcc, 0
s_cbranch_scc1 L_W_gate_done
s_sleep 4
s_cmp_lt_u32 s64, 65536
s_cbranch_scc1 L_W_gate
L_W_gate_done:
s_mov_b32 s64, 0
s_mov_b32 s77, 65536
s_mov_b32 s78, 131072
s_mov_b32 s79, 196608
L_W_sweep:
s_mov_b64 exec, s[66:67]
s_cbranch_execz L_W_sw0
buffer_load_dwordx2 v[64:65], v10, s[52:55], 0 offen sc1
L_W_sw0:
s_mov_b64 exec, s[68:69]
s_cbranch_execz L_W_sw1
buffer_load_dwordx2 v[66:67], v10, s[52:55], s77 offen sc1
L_W_sw1:
s_mov_b64 exec, s[70:71]
s_cbranch_execz L_W_sw2
buffer_load_dwordx2 v[68:69], v10, s[52:55], s78 offen sc1
L_W_sw2:
s_mov_b64 exec, s[72:73]
s_cbranch_execz L_W_sw3
buffer_load_dwordx2 v[70:71], v10, s[52:55], s79 offen sc1
L_W_sw3:
s_waitcnt vmcnt(0)
s_mov_b64 exec, s[66:67]
s_cbranch_execz L_W_sx0
v_max_u32 v192, v64, v65
v_cmp_ne_u32 vcc, -1, v192
v_lshlrev_b32 v88, 16, v64
v_and_b32 v89, 0xffff0000, v64
v_lshlrev_b32 v90, 16, v65
v_and_b32 v91, 0xffff0000, v65
s_andn2_b64 s[66:67], exec, vcc
s_mov_b64 exec, vcc
v_fma_f32 v232, v80, v88, v232
v_fma_f32 v233, v80, v89, v233
v_fma_f32 v234, v80, v90, v234
v_fma_f32 v235, v80, v91, v235
L_W_sx0:
s_mov_b64 exec, s[68:69]
s_cbranch_execz L_W_sx1
v_max_u32 v192, v66, v67
v_cmp_ne_u32 vcc, -1, v192
v_lshlrev_b32 v88, 16, v66
v_and_b32 v89, 0xffff0000, v66
v_lshlrev_b32 v90, 16, v67
v_and_b32 v91, 0xffff0000, v67
s_andn2_b64 s[68:69], exec, vcc
s_mov_b64 exec, vcc
v_fma_f32 v232, v81, v88, v232
v_fma_f32 v233, v81, v89, v233
v_fma_f32 v234, v81, v90, v234
v_fma_f32 v235, v81, v91, v235
L_W_sx1:
s_mov_b64 exec, s[70:71]
s_cbranch_execz L_W_sx2
v_max_u32 v192, v68, v69
v_cmp_ne_u32 vcc, -1, v192
v_lshlrev_b32 v88, 16, v68
v_and_b32 v89, 0xffff0000, v68
v_lshlrev_b32 v90, 16, v69
v_and_b32 v91, 0xffff0000, v69
s_andn2_b64 s[70:71], exec, vcc
s_mov_b64 exec, vcc
v_fma_f32 v232, v82, v88, v232
v_fma_f32 v233, v82, v89, v233
v_fma_f32 v234, v82, v90, v234
v_fma_f32 v235, v82, v91, v235
L_W_sx2:
s_mov_b64 exec, s[72:73]
s_cbranch_execz L_W_sx3
v_max_u32 v192, v70, v71
v_cmp_ne_u32 vcc, -1, v192
v_lshlrev_b32 v88, 16, v70
v_and_b32 v89, 0xffff0000, v70
v_lshlrev_b32 v90, 16, v71
v_and_b32 v91, 0xffff0000, v71
s_andn2_b64 s[72:73], exec, vcc
s_mov_b64 exec, vcc
v_fma_f32 v232, v83, v88, v232
v_fma_f32 v233, v83, v89, v233
v_fma_f32 v234, v83, v90, v234
v_fma_f32 v235, v83, v91, v235
L_W_sx3:
s_mov_b64 exec, -1
s_or_b64 s[74:75], s[66:67], s[68:69]
s_or_b64 s[80:81], s[70:71], s[72:73]
s_or_b64 s[74:75], s[74:75], s[80:81]
s_cbranch_scc0 L_W_sweep_done
s_add_u32 s64, s64, 1
s_cmp_lt_u32 s64, 65536
s_cbranch_scc1 L_W_sweep
L_W_sweep_done:
s_nop 1
v_permlane16_swap_b32 v232, v233
v_permlane16_swap_b32 v234, v235
v_add_f32 v232, v232, v233
v_add_f32 v234, v234, v235
s_nop 1
v_permlane32_swap_b32 v232, v234
s_nop 0
v_add_f32 v232, v232, v234
s_nop 1
v_add_f32_dpp v232, v232, v232 row_ror:8 row_mask:0xf bank_mask:0xf
s_mov_b32 exec_lo, 0x00ff00ff
s_mov_b32 exec_hi, 0x00ff00ff
ds_write_b32 v241, v232
ds_add_rtn_u32 v212, v240, v242 offset:32
ds_read_b128 v[204:207], v240
ds_read_b128 v[208:211], v240 offset:16
s_waitcnt lgkmcnt(2)
v_cmp_eq_u32 vcc, 7, v212
s_waitcnt lgkmcnt(0)
v_pk_add_f32 v[204:205], v[204:205], v[206:207]
v_pk_add_f32 v[208:209], v[208:209], v[210:211]
s_and_b64 exec, exec, vcc
s_cbranch_scc1 L_W_last
s_endpgm
L_W_last:
v_pk_add_f32 v[204:205], v[204:205], v[208:209]
v_add_f32 v204, v204, v205
v_cvt_pk_bf16_f32 v204, v204, v204
global_store_short v243, v204, s[26:27]
s_andn2_b32 s34, 1, vcc_lo
s_mov_b64 exec, -1
s_or_b32 s62, s32, s34
s_cbranch_scc1 L_W_nonext
v_mov_b32 v192, 0x18000
v_mov_b32 v193, s88
s_mov_b64 exec, 1
buffer_store_dword v193, v192, s[52:55], 0 offen
s_mov_b64 exec, -1
L_W_nonext:
s_endpgm
L_roleC:
s_mov_b32 s89, s32
v_and_b32 v1, 63, v0
v_and_b32 v2, 15, v0
v_bfe_u32 v3, v0, 4, 2
v_and_b32 v8, 1, v0
v_lshlrev_b32 v8, 4, v8
v_mov_b32 v9, 0xffff
v_lshlrev_b32 v8, v8, v9
v_bfe_u32 v9, v0, 1, 2
v_cmp_eq_u32 vcc, 0, v9
s_nop 1
v_cndmask_b32 v4, 0, v8, vcc
v_cmp_eq_u32 vcc, 1, v9
s_nop 1
v_cndmask_b32 v5, 0, v8, vcc
v_cmp_eq_u32 vcc, 2, v9
s_nop 1
v_cndmask_b32 v6, 0, v8, vcc
v_cmp_eq_u32 vcc, 3, v9
s_nop 1
v_cndmask_b32 v7, 0, v8, vcc
s_waitcnt lgkmcnt(0)
s_load_dword s88, s[30:31], 0x18000
v_mov_b32 v8, 0
s_lshr_b32 s35, s32, 4
s_lshr_b32 s36, s34, 1
s_and_b32 s37, s34, 1
s_lshl_b32 s60, s32, 19
s_mov_b32 s61, 0x80000
s_add_u32 s40, s16, s60
s_addc_u32 s41, s17, 0
s_and_b32 s41, s41, 0xffff
s_mov_b32 s42, s61
s_mov_b32 s43, 0x20000
s_mov_b32 s44, s30
s_and_b32 s45, s31, 0xffff
s_mov_b32 s46, 0x4000000
s_mov_b32 s47, 0x20000
v_lshlrev_b32 v9, 4, v1
s_lshl_b32 s62, s34, 13
v_add_u32 v9, s62, v9
s_mul_i32 s38, s34, 8448
s_mov_b32 s51, 4096
s_add_u32 s50, s38, 5120
s_waitcnt vmcnt(3)
s_add_u32 m0, s50, 0
s_nop 0
buffer_load_dwordx4 v9, s[40:43], 0 offen offset:0 nt lds
s_waitcnt vmcnt(3)
s_add_u32 m0, s50, 32
s_nop 0
buffer_load_dwordx4 v9, s[40:43], 0 offen offset:1024 nt lds
s_waitcnt vmcnt(3)
s_add_u32 m0, s50, 64
s_nop 0
buffer_load_dwordx4 v9, s[40:43], 0 offen offset:2048 nt lds
s_waitcnt vmcnt(3)
s_add_u32 m0, s50, 96
s_nop 0
buffer_load_dwordx4 v9, s[40:43], 0 offen offset:3072 nt lds
s_waitcnt vmcnt(3)
s_add_u32 m0, s50, 4224
s_nop 0
buffer_load_dwordx4 v9, s[40:43], s51 offen offset:0 nt lds
s_waitcnt vmcnt(3)
s_add_u32 m0, s50, 4256
s_nop 0
buffer_load_dwordx4 v9, s[40:43], s51 offen offset:1024 nt lds
s_waitcnt vmcnt(3)
s_add_u32 m0, s50, 4288
s_nop 0
buffer_load_dwordx4 v9, s[40:43], s51 offen offset:2048 nt lds
s_waitcnt vmcnt(3)
s_add_u32 m0, s50, 4320
s_nop 0
buffer_load_dwordx4 v9, s[40:43], s51 offen offset:3072 nt lds
v_add_u32 v9, 0x10000, v9
s_lshl_b32 s60, s89, 8
s_sub_u32 s61, 0x400000, s60
s_add_u32 s52, s10, s60
s_addc_u32 s53, s11, 0
s_and_b32 s53, s53, 0xffff
s_mov_b32 s54, s61
s_mov_b32 s55, 0x20000
s_mov_b32 s56, s4
s_and_b32 s57, s5, 0xffff
s_mov_b32 s58, 0x800
s_mov_b32 s59, 0x20000
v_lshrrev_b32 v192, 3, v2
v_lshlrev_b32 v192, 10, v192
v_lshl_add_u32 v192, v3, 5, v192
s_lshl_b32 s62, s34, 7
v_add_u32 v192, s62, v192
buffer_load_dwordx4 v[12:15], v192, s[56:59], 0 offen
buffer_load_dwordx4 v[16:19], v192, s[56:59], 0 offen offset:16
v_lshlrev_b32 v10, 17, v3
v_lshl_add_u32 v10, v2, 4, v10
s_lshl_b32 s62, s34, 19
v_add_u32 v10, s62, v10
s_mov_b32 s62, 0
buffer_load_dwordx4 v[64:67], v10, s[52:55], s62 offen nt
s_mov_b32 s62, 8192
buffer_load_dwordx4 v[68:71], v10, s[52:55], s62 offen nt
s_mov_b32 s62, 16384
buffer_load_dwordx4 v[72:75], v10, s[52:55], s62 offen nt
s_mov_b32 s62, 24576
buffer_load_dwordx4 v[76:79], v10, s[52:55], s62 offen nt
s_mov_b32 s62, 32768
buffer_load_dwordx4 v[80:83], v10, s[52:55], s62 offen nt
s_mov_b32 s62, 40960
buffer_load_dwordx4 v[84:87], v10, s[52:55], s62 offen nt
v_lshrrev_b32 v192, 1, v3
v_lshlrev_b32 v192, 9, v192
v_lshl_add_u32 v192, v2, 5, v192
v_and_b32 v193, 1, v3
v_lshl_add_u32 v192, v193, 4, v192
s_lshl_b32 s63, s34, 10
s_add_u32 s63, s63, 140288
v_add_u32 v192, s63, v192
v_lshlrev_b32 v193, 4, v1
s_lshl_b32 s63, s32, 10
s_add_u32 s63, s63, 0x40000
v_add_u32 v194, s63, v193
v_add_u32 v193, 140288, v193
s_mov_b32 s66, 0x01000100
s_mov_b32 s67, 0x03020302
s_waitcnt vmcnt(5)
s_mov_b32 s62, 49152
buffer_load_dwordx4 v[88:91], v10, s[52:55], s62 offen nt
v_perm_b32 v195, v12, v12, s66
v_and_b32 v28, v195, v4
v_and_b32 v29, v195, v5
v_and_b32 v30, v195, v6
v_and_b32 v31, v195, v7
s_nop 1
v_mfma_f32_16x16x32_bf16 v[44:47], v[28:31], v[64:67], 0
s_waitcnt vmcnt(5)
s_mov_b32 s62, 57344
buffer_load_dwordx4 v[92:95], v10, s[52:55], s62 offen nt
v_perm_b32 v195, v12, v12, s67
v_and_b32 v32, v195, v4
v_and_b32 v33, v195, v5
v_and_b32 v34, v195, v6
v_and_b32 v35, v195, v7
s_nop 1
v_mfma_f32_16x16x32_bf16 v[44:47], v[32:35], v[68:71], v[44:47]
s_waitcnt vmcnt(5)
s_mov_b32 s62, 65536
buffer_load_dwordx4 v[96:99], v10, s[52:55], s62 offen nt
v_perm_b32 v195, v13, v13, s66
v_and_b32 v28, v195, v4
v_and_b32 v29, v195, v5
v_and_b32 v30, v195, v6
v_and_b32 v31, v195, v7
s_nop 1
v_mfma_f32_16x16x32_bf16 v[44:47], v[28:31], v[72:75], v[44:47]
s_waitcnt vmcnt(5)
s_mov_b32 s62, 73728
buffer_load_dwordx4 v[100:103], v10, s[52:55], s62 offen nt
v_perm_b32 v195, v13, v13, s67
v_and_b32 v32, v195, v4
v_and_b32 v33, v195, v5
v_and_b32 v34, v195, v6
v_and_b32 v35, v195, v7
s_nop 1
v_mfma_f32_16x16x32_bf16 v[44:47], v[32:35], v[76:79], v[44:47]
s_waitcnt vmcnt(5)
s_mov_b32 s62, 81920
buffer_load_dwordx4 v[104:107], v10, s[52:55], s62 offen nt
v_perm_b32 v195, v14, v14, s66
v_and_b32 v28, v195, v4
v_and_b32 v29, v195, v5
v_and_b32 v30, v195, v6
v_and_b32 v31, v195, v7
s_nop 1
v_mfma_f32_16x16x32_bf16 v[44:47], v[28:31], v[80:83], v[44:47]
s_waitcnt vmcnt(5)
s_mov_b32 s62, 90112
buffer_load_dwordx4 v[108:111], v10, s[52:55], s62 offen nt
v_perm_b32 v195, v14, v14, s67
v_and_b32 v32, v195, v4
v_and_b32 v33, v195, v5
v_and_b32 v34, v195, v6
v_and_b32 v35, v195, v7
s_nop 1
v_mfma_f32_16x16x32_bf16 v[44:47], v[32:35], v[84:87], v[44:47]
s_waitcnt vmcnt(5)
s_mov_b32 s62, 98304
buffer_load_dwordx4 v[112:115], v10, s[52:55], s62 offen nt
v_perm_b32 v195, v15, v15, s66
v_and_b32 v28, v195, v4
v_and_b32 v29, v195, v5
v_and_b32 v30, v195, v6
v_and_b32 v31, v195, v7
s_nop 1
v_mfma_f32_16x16x32_bf16 v[44:47], v[28:31], v[88:91], v[44:47]
s_waitcnt vmcnt(5)
s_mov_b32 s62, 106496
buffer_load_dwordx4 v[116:119], v10, s[52:55], s62 offen nt
v_perm_b32 v195, v15, v15, s67
v_and_b32 v32, v195, v4
v_and_b32 v33, v195, v5
v_and_b32 v34, v195, v6
v_and_b32 v35, v195, v7
s_nop 1
v_mfma_f32_16x16x32_bf16 v[44:47], v[32:35], v[92:95], v[44:47]
s_waitcnt vmcnt(5)
s_mov_b32 s62, 114688
buffer_load_dwordx4 v[120:123], v10, s[52:55], s62 offen nt
v_perm_b32 v195, v16, v16, s66
v_and_b32 v28, v195, v4
v_and_b32 v29, v195, v5
v_and_b32 v30, v195, v6
v_and_b32 v31, v195, v7
s_nop 1
v_mfma_f32_16x16x32_bf16 v[44:47], v[28:31], v[96:99], v[44:47]
s_waitcnt vmcnt(5)
s_mov_b32 s62, 122880
buffer_load_dwordx4 v[124:127], v10, s[52:55], s62 offen nt
v_perm_b32 v195, v16, v16, s67
v_and_b32 v32, v195, v4
v_and_b32 v33, v195, v5
v_and_b32 v34, v195, v6
v_and_b32 v35, v195, v7
s_nop 1
v_mfma_f32_16x16x32_bf16 v[44:47], v[32:35], v[100:103], v[44:47]
s_waitcnt vmcnt(5)
v_perm_b32 v195, v17, v17, s66
v_and_b32 v28, v195, v4
v_and_b32 v29, v195, v5
v_and_b32 v30, v195, v6
v_and_b32 v31, v195, v7
s_nop 1
v_mfma_f32_16x16x32_bf16 v[44:47], v[28:31], v[104:107], v[44:47]
s_waitcnt vmcnt(4)
v_perm_b32 v195, v17, v17, s67
v_and_b32 v32, v195, v4
v_and_b32 v33, v195, v5
v_and_b32 v34, v195, v6
v_and_b32 v35, v195, v7
s_nop 1
v_mfma_f32_16x16x32_bf16 v[44:47], v[32:35], v[108:111], v[44:47]
s_waitcnt vmcnt(3)
v_perm_b32 v195, v18, v18, s66
v_and_b32 v28, v195, v4
v_and_b32 v29, v195, v5
v_and_b32 v30, v195, v6
v_and_b32 v31, v195, v7
s_nop 1
v_mfma_f32_16x16x32_bf16 v[44:47], v[28:31], v[112:115], v[44:47]
s_waitcnt vmcnt(2)
v_perm_b32 v195, v18, v18, s67
v_and_b32 v32, v195, v4
v_and_b32 v33, v195, v5
v_and_b32 v34, v195, v6
v_and_b32 v35, v195, v7
s_nop 1
v_mfma_f32_16x16x32_bf16 v[44:47], v[32:35], v[116:119], v[44:47]
s_waitcnt vmcnt(1)
v_perm_b32 v195, v19, v19, s66
v_and_b32 v28, v195, v4
v_and_b32 v29, v195, v5
v_and_b32 v30, v195, v6
v_and_b32 v31, v195, v7
s_nop 1
v_mfma_f32_16x16x32_bf16 v[44:47], v[28:31], v[120:123], v[44:47]
s_waitcnt vmcnt(0)
v_perm_b32 v195, v19, v19, s67
v_and_b32 v32, v195, v4
v_and_b32 v33, v195, v5
v_and_b32 v34, v195, v6
v_and_b32 v35, v195, v7
s_nop 1
v_mfma_f32_16x16x32_bf16 v[44:47], v[32:35], v[124:127], v[44:47]
s_nop 7
ds_write_b128 v192, v[44:47]
s_waitcnt lgkmcnt(0)
s_add_u32 s88, s88, 0x9e3779b9
s_barrier
s_cmp_lg_u32 s34, 0
s_cbranch_scc1 L_C_qdone
ds_read_b128 v[64:67], v193 offset:0
ds_read_b128 v[68:71], v193 offset:1024
ds_read_b128 v[72:75], v193 offset:2048
ds_read_b128 v[76:79], v193 offset:3072
ds_read_b128 v[80:83], v193 offset:4096
ds_read_b128 v[84:87], v193 offset:5120
ds_read_b128 v[88:91], v193 offset:6144
ds_read_b128 v[92:95], v193 offset:7168
s_waitcnt lgkmcnt(6)
v_add_f32 v64, v64, v68
v_add_f32 v65, v65, v69
v_add_f32 v66, v66, v70
v_add_f32 v67, v67, v71
s_waitcnt lgkmcnt(5)
v_add_f32 v64, v64, v72
v_add_f32 v65, v65, v73
v_add_f32 v66, v66, v74
v_add_f32 v67, v67, v75
s_waitcnt lgkmcnt(4)
v_add_f32 v64, v64, v76
v_add_f32 v65, v65, v77
v_add_f32 v66, v66, v78
v_add_f32 v67, v67, v79
s_waitcnt lgkmcnt(3)
v_add_f32 v64, v64, v80
v_add_f32 v65, v65, v81
v_add_f32 v66, v66, v82
v_add_f32 v67, v67, v83
s_waitcnt lgkmcnt(2)
v_add_f32 v64, v64, v84
v_add_f32 v65, v65, v85
v_add_f32 v66, v66, v86
v_add_f32 v67, v67, v87
s_waitcnt lgkmcnt(1)
v_add_f32 v64, v64, v88
v_add_f32 v65, v65, v89
v_add_f32 v66, v66, v90
v_add_f32 v67, v67, v91
s_waitcnt lgkmcnt(0)
v_add_f32 v64, v64, v92
v_add_f32 v65, v65, v93
v_add_f32 v66, v66, v94
v_add_f32 v67, v67, v95
v_cvt_pk_bf16_f32 v64, v64, v65
v_cvt_pk_bf16_f32 v66, v66, v67
v_mov_b32 v65, s88
v_mov_b32 v67, s88
buffer_store_dwordx4 v[64:67], v194, s[44:47], 0 offen sc1
L_C_qdone:
s_barrier
s_add_u32 s50, s38, 72704
s_waitcnt vmcnt(3)
s_add_u32 m0, s50, 0
s_nop 0
buffer_load_dwordx4 v9, s[40:43], 0 offen offset:0 nt lds
s_waitcnt vmcnt(3)
s_add_u32 m0, s50, 32
s_nop 0
buffer_load_dwordx4 v9, s[40:43], 0 offen offset:1024 nt lds
s_waitcnt vmcnt(3)
s_add_u32 m0, s50, 64
s_nop 0
buffer_load_dwordx4 v9, s[40:43], 0 offen offset:2048 nt lds
s_waitcnt vmcnt(3)
s_add_u32 m0, s50, 96
s_nop 0
buffer_load_dwordx4 v9, s[40:43], 0 offen offset:3072 nt lds
s_waitcnt vmcnt(3)
s_add_u32 m0, s50, 4224
s_nop 0
buffer_load_dwordx4 v9, s[40:43], s51 offen offset:0 nt lds
s_waitcnt vmcnt(3)
s_add_u32 m0, s50, 4256
s_nop 0
buffer_load_dwordx4 v9, s[40:43], s51 offen offset:1024 nt lds
s_waitcnt vmcnt(3)
s_add_u32 m0, s50, 4288
s_nop 0
buffer_load_dwordx4 v9, s[40:43], s51 offen offset:2048 nt lds
s_waitcnt vmcnt(3)
s_add_u32 m0, s50, 4320
s_nop 0
buffer_load_dwordx4 v9, s[40:43], s51 offen offset:3072 nt lds
v_add_u32 v9, 0x10000, v9
s_waitcnt vmcnt(3)
buffer_load_dwordx4 v[208:211], v9, s[40:43], 0 offen offset:0 nt
s_waitcnt vmcnt(3)
buffer_load_dwordx4 v[212:215], v9, s[40:43], 0 offen offset:1024 nt
s_waitcnt vmcnt(3)
buffer_load_dwordx4 v[216:219], v9, s[40:43], 0 offen offset:2048 nt
s_waitcnt vmcnt(3)
buffer_load_dwordx4 v[220:223], v9, s[40:43], 0 offen offset:3072 nt
s_waitcnt vmcnt(3)
buffer_load_dwordx4 v[224:227], v9, s[40:43], s51 offen offset:0 nt
s_waitcnt vmcnt(3)
buffer_load_dwordx4 v[228:231], v9, s[40:43], s51 offen offset:1024 nt
s_waitcnt vmcnt(3)
buffer_load_dwordx4 v[232:235], v9, s[40:43], s51 offen offset:2048 nt
s_waitcnt vmcnt(3)
buffer_load_dwordx4 v[236:239], v9, s[40:43], s51 offen offset:3072 nt
v_add_u32 v9, 0x10000, v9
s_add_u32 s62, s38, 5120
v_lshl_add_u32 v22, v1, 4, s62
s_lshl_b32 s62, s36, 4
v_add_u32 v240, s62, v2
v_mul_u32_u24 v10, 1056, v240
v_lshl_add_u32 v10, v3, 4, v10
v_add_u32 v10, 5120, v10
v_lshrrev_b32 v240, 1, v3
v_lshlrev_b32 v240, 3, v240
v_lshrrev_b32 v241, 2, v2
v_add_u32 v240, v240, v241
v_mul_u32_u24 v11, 1056, v240
v_and_b32 v240, 1, v3
v_lshl_add_u32 v11, v240, 5, v11
v_and_b32 v240, 3, v2
v_lshl_add_u32 v11, v240, 3, v11
s_lshl_b32 s62, s34, 7
s_add_u32 s62, s62, 5120
v_add_u32 v11, s62, v11
s_lshl_b32 s62, s37, 4
v_add_u32 v240, s62, v2
v_mul_u32_u24 v12, 144, v240
v_lshl_add_u32 v12, v3, 3, v12
s_lshl_b32 s62, s36, 5
v_add_u32 v12, s62, v12
v_lshlrev_b32 v15, 4, v240
s_lshl_b32 s62, s36, 2
v_add_u32 v14, s62, v15
v_and_b32 v240, 31, v1
v_mul_u32_u24 v13, 144, v240
v_lshrrev_b32 v241, 5, v1
v_lshl_add_u32 v13, v241, 4, v13
v_lshlrev_b32 v16, 4, v240
v_mov_b32 v17, 0x3e0293ee
v_mov_b32 v18, 0xff800000
v_mov_b32 v19, 0xff800000
v_mov_b32 v20, 0
v_mov_b32 v96, 0
v_mov_b32 v97, 0
v_mov_b32 v98, 0
v_mov_b32 v99, 0
v_mov_b32 v100, 0
v_mov_b32 v101, 0
v_mov_b32 v102, 0
v_mov_b32 v103, 0
v_mov_b32 v104, 0
v_mov_b32 v105, 0
v_mov_b32 v106, 0
v_mov_b32 v107, 0
v_mov_b32 v108, 0
v_mov_b32 v109, 0
v_mov_b32 v110, 0
v_mov_b32 v111, 0
v_mov_b32 v112, 0
v_mov_b32 v113, 0
v_mov_b32 v114, 0
v_mov_b32 v115, 0
v_mov_b32 v116, 0
v_mov_b32 v117, 0
v_mov_b32 v118, 0
v_mov_b32 v119, 0
v_mov_b32 v120, 0
v_mov_b32 v121, 0
v_mov_b32 v122, 0
v_mov_b32 v123, 0
v_mov_b32 v124, 0
v_mov_b32 v125, 0
v_mov_b32 v126, 0
v_mov_b32 v127, 0
s_cmp_lg_u32 s34, 0
s_cbranch_scc1 L_wc_Cq
s_mov_b32 s62, 0x1a000
v_lshl_add_u32 v240, v1, 8, s62
s_lshl_b64 exec, 1, s32
s_mov_b32 s64, 0
L_tp_Cq0:
buffer_load_dword v241, v240, s[44:47], 0 offen sc1
s_waitcnt vmcnt(0)
v_cmp_ne_u32 vcc, s88, v241
s_add_u32 s64, s64, 1
s_nop 0
s_or_b64 vcc, vcc, vcc
s_cbranch_scc0 L_tp_Cq0_ok
s_sleep 32
s_cmp_lt_u32 s64, 65536
s_cbranch_scc1 L_tp_Cq0
L_tp_Cq0_ok:
s_mov_b32 exec_lo, -1
s_mov_b32 exec_hi, 0
s_mov_b32 s64, 0
L_tp_Cq:
buffer_load_dword v241, v240, s[44:47], 0 offen sc1
s_waitcnt vmcnt(0)
v_cmp_ne_u32 vcc, s88, v241
s_add_u32 s64, s64, 1
s_nop 0
s_or_b64 vcc, vcc, vcc
s_cbranch_scc0 L_tp_Cq_ok
s_mov_b64 exec, vcc
s_sleep 8
s_cmp_lt_u32 s64, 65536
s_cbranch_scc1 L_tp_Cq
L_tp_Cq_ok:
s_mov_b64 exec, -1
L_wc_Cq:
s_barrier
s_lshl_b32 s62, s35, 5
s_lshl_b32 s63, s37, 4
s_add_u32 s62, s62, s63
v_add_u32 v240, s62, v2
v_lshlrev_b32 v240, 10, v240
v_lshl_add_u32 v240, v3, 4, v240
v_add_u32 v240, 0x0, v240
buffer_load_dwordx4 v[32:35], v240, s[44:47], 0 offen offset:0 sc1
buffer_load_dwordx4 v[36:39], v240, s[44:47], 0 offen offset:64 sc1
buffer_load_dwordx4 v[40:43], v240, s[44:47], 0 offen offset:128 sc1
buffer_load_dwordx4 v[44:47], v240, s[44:47], 0 offen offset:192 sc1
buffer_load_dwordx4 v[48:51], v240, s[44:47], 0 offen offset:256 sc1
buffer_load_dwordx4 v[52:55], v240, s[44:47], 0 offen offset:320 sc1
buffer_load_dwordx4 v[56:59], v240, s[44:47], 0 offen offset:384 sc1
buffer_load_dwordx4 v[60:63], v240, s[44:47], 0 offen offset:448 sc1
buffer_load_dwordx4 v[64:67], v240, s[44:47], 0 offen offset:512 sc1
buffer_load_dwordx4 v[68:71], v240, s[44:47], 0 offen offset:576 sc1
buffer_load_dwordx4 v[72:75], v240, s[44:47], 0 offen offset:640 sc1
buffer_load_dwordx4 v[76:79], v240, s[44:47], 0 offen offset:704 sc1
buffer_load_dwordx4 v[80:83], v240, s[44:47], 0 offen offset:768 sc1
buffer_load_dwordx4 v[84:87], v240, s[44:47], 0 offen offset:832 sc1
buffer_load_dwordx4 v[88:91], v240, s[44:47], 0 offen offset:896 sc1
buffer_load_dwordx4 v[92:95], v240, s[44:47], 0 offen offset:960 sc1
s_mov_b32 s39, 0
s_mov_b32 s48, 0
.p2align 6
L_C_loop:
s_cmp_lg_u32 s39, 0
s_cbranch_scc1 L_C_top
s_waitcnt vmcnt(0)
L_C_top:
s_waitcnt lgkmcnt(0)
s_barrier
s_mov_b32 s52, 1
s_cmp_eq_u32 s39, 0
s_cselect_b32 s52, 0, s52
s_cmp_ge_u32 s39, 7
s_cselect_b32 s52, 0, s52
s_sub_u32 s50, 67584, s48
v_add_u32 v23, s50, v22
s_cmp_eq_u32 s52, 0
s_cbranch_scc1 L_C_st0
s_waitcnt vmcnt(7)
ds_write_b128 v23, v[208:211] offset:0
buffer_load_dwordx4 v[208:211], v9, s[40:43], 0 offen offset:0 nt
s_waitcnt vmcnt(7)
ds_write_b128 v23, v[212:215] offset:1056
buffer_load_dwordx4 v[212:215], v9, s[40:43], 0 offen offset:1024 nt
s_waitcnt vmcnt(7)
ds_write_b128 v23, v[216:219] offset:2112
buffer_load_dwordx4 v[216:219], v9, s[40:43], 0 offen offset:2048 nt
s_waitcnt vmcnt(7)
ds_write_b128 v23, v[220:223] offset:3168
buffer_load_dwordx4 v[220:223], v9, s[40:43], 0 offen offset:3072 nt
s_waitcnt vmcnt(7)
ds_write_b128 v23, v[224:227] offset:4224
buffer_load_dwordx4 v[224:227], v9, s[40:43], s51 offen offset:0 nt
s_waitcnt vmcnt(7)
ds_write_b128 v23, v[228:231] offset:5280
buffer_load_dwordx4 v[228:231], v9, s[40:43], s51 offen offset:1024 nt
s_waitcnt vmcnt(7)
ds_write_b128 v23, v[232:235] offset:6336
buffer_load_dwordx4 v[232:235], v9, s[40:43], s51 offen offset:2048 nt
s_waitcnt vmcnt(7)
ds_write_b128 v23, v[236:239] offset:7392
buffer_load_dwordx4 v[236:239], v9, s[40:43], s51 offen offset:3072 nt
v_add_u32 v9, 0x10000, v9
L_C_st0:
v_add_u32 v240, s48, v10
v_add_u32 v241, s48, v11
ds_read_b128 v[128:131], v240 offset:0
ds_read_b128 v[132:135], v240 offset:64
ds_read_b128 v[136:139], v240 offset:128
ds_read_b128 v[140:143], v240 offset:192
ds_read_b128 v[144:147], v240 offset:256
ds_read_b128 v[148:151], v240 offset:320
ds_read_b128 v[152:155], v240 offset:384
ds_read_b128 v[156:159], v240 offset:448
ds_read_b128 v[160:163], v240 offset:512
ds_read_b128 v[164:167], v240 offset:576
ds_read_b128 v[168:171], v240 offset:640
ds_read_b128 v[172:175], v240 offset:704
ds_read_b128 v[176:179], v240 offset:768
ds_read_b128 v[180:183], v240 offset:832
ds_read_b128 v[184:187], v240 offset:896
ds_read_b128 v[188:191], v240 offset:960
s_waitcnt lgkmcnt(15)
v_mfma_f32_16x16x32_bf16 v[28:31], v[128:131], v[32:35], 0
s_waitcnt lgkmcnt(14)
v_mfma_f32_16x16x32_bf16 v[28:31], v[132:135], v[36:39], v[28:31]
s_waitcnt lgkmcnt(13)
v_mfma_f32_16x16x32_bf16 v[28:31], v[136:139], v[40:43], v[28:31]
s_waitcnt lgkmcnt(12)
v_mfma_f32_16x16x32_bf16 v[28:31], v[140:143], v[44:47], v[28:31]
s_waitcnt lgkmcnt(11)
v_mfma_f32_16x16x32_bf16 v[28:31], v[144:147], v[48:51], v[28:31]
s_waitcnt lgkmcnt(10)
v_mfma_f32_16x16x32_bf16 v[28:31], v[148:151], v[52:55], v[28:31]
s_waitcnt lgkmcnt(9)
v_mfma_f32_16x16x32_bf16 v[28:31], v[152:155], v[56:59], v[28:31]
s_waitcnt lgkmcnt(8)
v_mfma_f32_16x16x32_bf16 v[28:31], v[156:159], v[60:63], v[28:31]
s_waitcnt lgkmcnt(7)
v_mfma_f32_16x16x32_bf16 v[28:31], v[160:163], v[64:67], v[28:31]
s_waitcnt lgkmcnt(6)
v_mfma_f32_16x16x32_bf16 v[28:31], v[164:167], v[68:71], v[28:31]
s_waitcnt lgkmcnt(5)
v_mfma_f32_16x16x32_bf16 v[28:31], v[168:171], v[72:75], v[28:31]
s_waitcnt lgkmcnt(4)
v_mfma_f32_16x16x32_bf16 v[28:31], v[172:175], v[76:79], v[28:31]
s_waitcnt lgkmcnt(3)
v_mfma_f32_16x16x32_bf16 v[28:31], v[176:179], v[80:83], v[28:31]
s_waitcnt lgkmcnt(2)
v_mfma_f32_16x16x32_bf16 v[28:31], v[180:183], v[84:87], v[28:31]
s_waitcnt lgkmcnt(1)
v_mfma_f32_16x16x32_bf16 v[28:31], v[184:187], v[88:91], v[28:31]
s_waitcnt lgkmcnt(0)
v_mfma_f32_16x16x32_bf16 v[28:31], v[188:191], v[92:95], v[28:31]
s_nop 7
v_mul_f32 v24, v28, v17
v_mul_f32 v25, v29, v17
v_mul_f32 v26, v30, v17
v_mul_f32 v27, v31, v17
v_max3_f32 v242, v24, v25, v26
v_max_f32 v242, v242, v27
v_mov_b32 v243, v242
s_nop 1
v_permlane16_swap_b32 v242, v243
s_nop 0
v_max_f32 v242, v242, v243
v_mov_b32 v243, v242
s_nop 1
v_permlane32_swap_b32 v242, v243
s_nop 0
v_max_f32 v242, v242, v243
s_mov_b64 exec, 0xffff
ds_write_b32 v14, v242 offset:0
s_mov_b64 exec, -1
s_waitcnt lgkmcnt(0)
s_barrier
ds_read_b128 v[192:195], v15 offset:0
ds_read_b128 v[196:199], v16 offset:0
s_waitcnt lgkmcnt(1)
v_max3_f32 v242, v192, v193, v194
v_max3_f32 v242, v242, v195, v18
v_sub_f32 v21, v18, v242
v_sub_f32 v24, v24, v242
v_sub_f32 v25, v25, v242
v_sub_f32 v26, v26, v242
v_sub_f32 v27, v27, v242
v_exp_f32 v21, v21
v_exp_f32 v24, v24
v_exp_f32 v25, v25
v_exp_f32 v26, v26
v_exp_f32 v27, v27
v_mov_b32 v18, v242
v_cvt_pk_bf16_f32 v244, v24, v25
v_cvt_pk_bf16_f32 v245, v26, v27
ds_write_b64 v12, v[244:245] offset:512
v_add_f32 v24, v24, v25
v_add_f32 v26, v26, v27
v_fma_f32 v20, v20, v21, v24
v_add_f32 v20, v20, v26
s_waitcnt lgkmcnt(1)
v_max3_f32 v242, v196, v197, v198
v_max3_f32 v242, v242, v199, v19
v_sub_f32 v21, v19, v242
v_exp_f32 v21, v21
v_mov_b32 v19, v242
v_mul_f32 v96, v96, v21
v_mul_f32 v97, v97, v21
v_mul_f32 v98, v98, v21
v_mul_f32 v99, v99, v21
v_mul_f32 v100, v100, v21
v_mul_f32 v101, v101, v21
v_mul_f32 v102, v102, v21
v_mul_f32 v103, v103, v21
v_mul_f32 v104, v104, v21
v_mul_f32 v105, v105, v21
v_mul_f32 v106, v106, v21
v_mul_f32 v107, v107, v21
v_mul_f32 v108, v108, v21
v_mul_f32 v109, v109, v21
v_mul_f32 v110, v110, v21
v_mul_f32 v111, v111, v21
v_mul_f32 v112, v112, v21
v_mul_f32 v113, v113, v21
v_mul_f32 v114, v114, v21
v_mul_f32 v115, v115, v21
v_mul_f32 v116, v116, v21
v_mul_f32 v117, v117, v21
v_mul_f32 v118, v118, v21
v_mul_f32 v119, v119, v21
v_mul_f32 v120, v120, v21
v_mul_f32 v121, v121, v21
v_mul_f32 v122, v122, v21
v_mul_f32 v123, v123, v21
v_mul_f32 v124, v124, v21
v_mul_f32 v125, v125, v21
v_mul_f32 v126, v126, v21
v_mul_f32 v127, v127, v21
s_waitcnt lgkmcnt(0)
s_barrier
ds_read_b128 v[192:195], v13 offset:512
ds_read_b128 v[196:199], v13 offset:544
ds_read_b128 v[200:203], v13 offset:576
ds_read_b128 v[204:207], v13 offset:608
ds_read_b64_tr_b16 v[128:129], v241 offset:0
ds_read_b64_tr_b16 v[130:131], v241 offset:4224
ds_read_b64_tr_b16 v[132:133], v241 offset:64
ds_read_b64_tr_b16 v[134:135], v241 offset:4288
ds_read_b64_tr_b16 v[136:137], v241 offset:16896
ds_read_b64_tr_b16 v[138:139], v241 offset:21120
ds_read_b64_tr_b16 v[140:141], v241 offset:16960
ds_read_b64_tr_b16 v[142:143], v241 offset:21184
ds_read_b64_tr_b16 v[144:145], v241 offset:33792
ds_read_b64_tr_b16 v[146:147], v241 offset:38016
ds_read_b64_tr_b16 v[148:149], v241 offset:33856
ds_read_b64_tr_b16 v[150:151], v241 offset:38080
ds_read_b64_tr_b16 v[152:153], v241 offset:50688
ds_read_b64_tr_b16 v[154:155], v241 offset:54912
ds_read_b64_tr_b16 v[156:157], v241 offset:50752
ds_read_b64_tr_b16 v[158:159], v241 offset:54976
s_waitcnt lgkmcnt(12)
v_mfma_f32_32x32x16_bf16 v[96:111], v[128:131], v[192:195], v[96:111]
v_mfma_f32_32x32x16_bf16 v[112:127], v[132:135], v[192:195], v[112:127]
s_waitcnt lgkmcnt(8)
v_mfma_f32_32x32x16_bf16 v[96:111], v[136:139], v[196:199], v[96:111]
v_mfma_f32_32x32x16_bf16 v[112:127], v[140:143], v[196:199], v[112:127]
s_waitcnt lgkmcnt(4)
v_mfma_f32_32x32x16_bf16 v[96:111], v[144:147], v[200:203], v[96:111]
v_mfma_f32_32x32x16_bf16 v[112:127], v[148:151], v[200:203], v[112:127]
s_waitcnt lgkmcnt(0)
v_mfma_f32_32x32x16_bf16 v[96:111], v[152:155], v[204:207], v[96:111]
v_mfma_f32_32x32x16_bf16 v[112:127], v[156:159], v[204:207], v[112:127]
s_sub_u32 s48, 67584, s48
s_add_u32 s39, s39, 1
s_cmp_lt_u32 s39, 8
s_cbranch_scc1 L_C_loop
v_mov_b32 v243, v20
s_nop 1
v_permlane16_swap_b32 v20, v243
s_nop 0
v_add_f32 v20, v20, v243
v_mov_b32 v243, v20
s_nop 1
v_permlane32_swap_b32 v20, v243
s_nop 0
v_add_f32 v20, v20, v243
s_barrier
s_mov_b64 exec, 0xffff
ds_write_b32 v14, v20 offset:0
s_mov_b64 exec, -1
v_and_b32 v240, 31, v1
v_mul_u32_u24 v240, 2064, v240
v_lshrrev_b32 v241, 5, v1
v_lshl_add_u32 v240, v241, 4, v240
s_lshl_b32 s62, s34, 8
s_add_u32 s62, s62, 5120
v_add_u32 v240, s62, v240
s_nop 5
ds_write_b128 v240, v[96:99] offset:0
ds_write_b128 v240, v[100:103] offset:32
ds_write_b128 v240, v[104:107] offset:64
ds_write_b128 v240, v[108:111] offset:96
ds_write_b128 v240, v[112:115] offset:128
ds_write_b128 v240, v[116:119] offset:160
ds_write_b128 v240, v[120:123] offset:192
ds_write_b128 v240, v[124:127] offset:224
s_waitcnt lgkmcnt(0)
s_barrier
s_mul_i32 s62, s34, 8256
s_add_u32 s62, s62, 5120
v_lshl_add_u32 v240, v1, 5, s62
ds_read_b128 v[128:131], v240 offset:0
ds_read_b128 v[132:135], v240 offset:16
ds_read_b128 v[136:139], v240 offset:2064
ds_read_b128 v[140:143], v240 offset:2080
ds_read_b128 v[144:147], v240 offset:4128
ds_read_b128 v[148:151], v240 offset:4144
ds_read_b128 v[152:155], v240 offset:6192
ds_read_b128 v[156:159], v240 offset:6208
s_lshl_b32 s62, s35, 5
s_lshl_b32 s63, s34, 2
s_add_u32 s62, s62, s63
s_lshl_b32 s62, s62, 4
s_and_b32 s63, s32, 15
s_add_u32 s62, s62, s63
s_lshl_b32 s62, s62, 10
s_add_u32 s62, s62, 0x200000
v_lshl_add_u32 v241, v1, 4, s62
s_waitcnt lgkmcnt(6)
v_cvt_pk_bf16_f32 v160, v128, v129
v_cvt_pk_bf16_f32 v161, v130, v131
v_cvt_pk_bf16_f32 v162, v132, v133
v_cvt_pk_bf16_f32 v163, v134, v135
s_mov_b32 s63, 0
buffer_store_dwordx4 v[160:163], v241, s[44:47], s63 offen sc1 nt
s_waitcnt lgkmcnt(4)
v_cvt_pk_bf16_f32 v164, v136, v137
v_cvt_pk_bf16_f32 v165, v138, v139
v_cvt_pk_bf16_f32 v166, v140, v141
v_cvt_pk_bf16_f32 v167, v142, v143
s_mov_b32 s63, 16384
buffer_store_dwordx4 v[164:167], v241, s[44:47], s63 offen sc1 nt
s_waitcnt lgkmcnt(2)
v_cvt_pk_bf16_f32 v168, v144, v145
v_cvt_pk_bf16_f32 v169, v146, v147
v_cvt_pk_bf16_f32 v170, v148, v149
v_cvt_pk_bf16_f32 v171, v150, v151
s_mov_b32 s63, 32768
buffer_store_dwordx4 v[168:171], v241, s[44:47], s63 offen sc1 nt
s_waitcnt lgkmcnt(0)
v_cvt_pk_bf16_f32 v172, v152, v153
v_cvt_pk_bf16_f32 v173, v154, v155
v_cvt_pk_bf16_f32 v174, v156, v157
v_cvt_pk_bf16_f32 v175, v158, v159
s_mov_b32 s63, 49152
buffer_store_dwordx4 v[172:175], v241, s[44:47], s63 offen sc1 nt
ds_read_b128 v[192:195], v16 offset:0
v_and_b32 v240, 31, v1
s_lshl_b32 s63, s32, 9
s_add_u32 s63, s63, 0x10000
v_lshl_add_u32 v240, v240, 4, s63
s_waitcnt lgkmcnt(0)
v_add_f32 v192, v192, v193
v_add_f32 v194, v194, v195
v_add_f32 v194, v192, v194
v_mov_b32 v192, v19
v_mov_b32 v193, s88
v_mov_b32 v195, s88
s_waitcnt vmcnt(0)
s_barrier
s_cmp_lg_u32 s34, 1
s_cbranch_scc1 L_C_noas
s_and_b32 s63, s32, 7
s_mul_i32 s63, s63, 0x100
s_add_u32 s63, s63, 0xc0000
s_add_u32 s56, s30, s63
s_addc_u32 s57, s31, 0
s_lshl_b32 s62, s89, 21
s_sub_u32 s63, 0x8000000, s62
s_add_u32 s68, s6, s62
s_addc_u32 s69, s7, 0
s_and_b32 s69, s69, 0xffff
s_mov_b32 s70, s63
s_mov_b32 s71, 0x20000
s_add_u32 s72, s8, s62
s_addc_u32 s73, s9, 0
s_and_b32 s73, s73, 0xffff
s_mov_b32 s74, s63
s_mov_b32 s75, 0x20000
s_mov_b64 s[76:77], s[68:69]
s_mov_b64 s[78:79], s[70:71]
s_lshr_b32 s62, s32, 3
s_mul_i32 s62, s62, 6
s_sub_u32 s62, s62, 32
v_add_u32 v136, s62, v1
v_cmp_gt_u32 vcc, 32, v1
v_lshlrev_b32 v133, 7, v1
v_add_u32 v134, 0x4000000, v133
v_cndmask_b32 v128, v136, v1, vcc
v_lshlrev_b32 v128, 2, v128
v_mov_b32 v132, 0
s_mov_b32 s64, 0
L_as_C:
s_mov_b64 exec, 0x1ffffff
s_mov_b32 exec_hi, 0x3f
global_load_dword v129, v128, s[56:57] nt
s_waitcnt vmcnt(0)
v_subrev_u32 v129, s88, v129
s_mov_b64 exec, 0xffffff
v_cmp_le_u32 vcc, 0x400, v129
v_readlane_b32 s62, v129, 24
v_add_u32_dpp v129, v129, v129 row_shr:1 row_mask:0xf bank_mask:0xf bound_ctrl:0
s_nop 1
v_add_u32_dpp v129, v129, v129 row_shr:2 row_mask:0xf bank_mask:0xf bound_ctrl:0
s_nop 1
v_add_u32_dpp v129, v129, v129 row_shr:4 row_mask:0xf bank_mask:0xf bound_ctrl:0
s_nop 1
v_add_u32_dpp v129, v129, v129 row_shr:8 row_mask:0xf bank_mask:0xf bound_ctrl:0
s_nop 0
v_readlane_b32 s61, v129, 15
v_readlane_b32 s63, v129, 23
s_add_u32 s61, s61, s63
s_cbranch_vccnz L_as_C_x
s_cmp_ge_u32 s61, 15168
s_cbranch_scc1 L_as_C_x
s_sub_u32 s61, s61, 120
s_mov_b32 exec_lo, 0
s_mov_b32 exec_hi, 0x3f
v_cmp_gt_u32 vcc, 280, v129
v_add_u32 v130, 56, v129
s_nop 0
v_cndmask_b32 v136, 0, 8, vcc
v_add_u32 v130, v130, v136
v_lshrrev_b32 v130, 4, v130
v_sub_u32 v136, v130, v132
v_cmp_gt_i32 vcc, 4, v136
v_cmp_le_i32 s[66:67], 2, v136
s_nop 0
v_cndmask_b32 v131, 0, 7, vcc
v_cmp_ge_u32 vcc, 41, v130
v_add_u32 v131, v131, v129
v_lshl_add_u32 v131, v131, 6, v1
s_and_b64 vcc, vcc, s[66:67]
v_cndmask_b32 v131, -1, v131, vcc
s_nop 1
v_min_u32_dpp v131, v131, v131 row_shr:1 row_mask:0xf bank_mask:0xf
s_nop 1
v_min_u32_dpp v131, v131, v131 row_shr:2 row_mask:0xf bank_mask:0xf
s_nop 1
v_min_u32_dpp v131, v131, v131 row_shr:4 row_mask:0xf bank_mask:0xf
s_nop 0
v_readlane_b32 s63, v131, 37
s_lshr_b32 s65, s63, 6
s_and_b32 s63, s63, 63
s_mul_i32 s65, s65, 24
s_cmp_ge_i32 s65, s61
s_cbranch_scc1 L_as_C_idle
v_readlane_b32 s65, v130, s63
s_mov_b32 m0, s63
s_mov_b64 exec, -1
s_cmp_lt_u32 s65, 21
s_cselect_b64 s[76:77], s[68:69], s[72:73]
v_writelane_b32 v132, s65, m0
s_cselect_b32 s66, 0, 21
s_sub_u32 s65, s65, s66
s_mul_i32 s65, s65, 0x18000
s_and_b32 s63, s63, 7
s_lshl_b32 s63, s63, 14
s_add_u32 s65, s65, s63
s_add_u32 s66, s65, 0x2000
buffer_load_dword v135, v133, s[76:79], s65 offen
buffer_load_dword v135, v133, s[76:79], s66 offen
buffer_load_dword v135, v134, s[76:79], s65 offen
buffer_load_dword v135, v134, s[76:79], s66 offen
s_waitcnt vmcnt(1)
s_branch L_as_C_next
L_as_C_idle:
s_sleep 4
L_as_C_next:
s_add_u32 s64, s64, 1
s_cmp_lt_u32 s64, 96
s_cbranch_scc1 L_as_C
L_as_C_x:
s_mov_b64 exec, -1
s_waitcnt vmcnt(0)
L_C_noas:
s_cmp_lg_u32 s34, 0
s_cbranch_scc1 L_C_done
s_mov_b32 exec_hi, 0
buffer_store_dwordx4 v[192:195], v240, s[44:47], 0 offen sc1
s_mov_b64 exec, -1
s_cmp_ge_u32 s32, 8
s_cbranch_scc1 L_C_done
s_and_b32 s63, s32, 7
s_mul_i32 s63, s63, 0x100
s_add_u32 s63, s63, 0xc0000
s_add_u32 s56, s30, s63
s_addc_u32 s57, s31, 0
s_mov_b32 s64, 0
s_mov_b32 s59, 0
s_mov_b32 s58, 0
s_lshl_b32 s62, s32, 12
s_add_u32 s62, s62, 0xd0000
v_lshl_add_u32 v132, v1, 4, s62
v_lshrrev_b32 v133, 2, v1
s_mov_b32 s62, 0xd0000
v_lshl_add_u32 v133, v133, 12, s62
v_and_b32 v134, 3, v1
v_lshlrev_b32 v136, 2, v1
v_mov_b32 v139, 0
L_gm_C:
s_mov_b32 exec_lo, -1
s_mov_b32 exec_hi, 0
v_add_u32 v135, s58, v134
v_and_b32 v135, 15, v135
v_lshl_add_u32 v135, v135, 8, v133
global_load_dword v138, v135, s[30:31] sc1
s_mov_b64 exec, 0x1ffffff
global_load_dword v137, v136, s[56:57] nt
s_waitcnt vmcnt(0)
v_subrev_u32 v137, s88, v137
s_mov_b64 exec, 0xffffff
v_cmp_le_u32 vcc, 0x400, v137
v_readlane_b32 s62, v137, 24
v_add_u32_dpp v137, v137, v137 row_shr:1 row_mask:0xf bank_mask:0xf bound_ctrl:0
s_nop 1
v_add_u32_dpp v137, v137, v137 row_shr:2 row_mask:0xf bank_mask:0xf bound_ctrl:0
s_nop 1
v_add_u32_dpp v137, v137, v137 row_shr:4 row_mask:0xf bank_mask:0xf bound_ctrl:0
s_nop 1
v_add_u32_dpp v137, v137, v137 row_shr:8 row_mask:0xf bank_mask:0xf bound_ctrl:0
s_nop 0
v_readlane_b32 s61, v137, 15
v_readlane_b32 s63, v137, 23
s_add_u32 s61, s61, s63
s_mov_b64 exec, 0xff
s_cbranch_vccnz L_gm_C_x
s_add_u32 s63, s61, s88
v_mov_b32 v128, s63
v_mov_b32 v129, s63
v_mov_b32 v130, s63
v_mov_b32 v131, s63
s_lshr_b32 s58, s61, 9
s_and_b32 s63, s58, 15
s_lshl_b32 s63, s63, 8
v_add_u32 v135, s63, v132
s_sub_u32 s58, s58, 2
global_store_dwordx4 v135, v[128:131], s[30:31] sc1
s_mul_i32 s63, s61, 0
s_mul_i32 s65, s59, 8
s_add_u32 s65, s65, s63
s_cmp_eq_u32 s59, 0
s_mov_b32 s59, s61
s_cbranch_scc1 L_gm_C_next
s_mov_b32 exec_lo, -1
v_subrev_u32 v138, s88, v138
v_cmp_gt_u32 vcc, 0x8000, v138
s_nop 1
v_cndmask_b32 v138, 0, v138, vcc
v_max_u32 v139, v139, v138
s_nop 1
v_max_u32_dpp v139, v139, v139 quad_perm:[1,0,3,2] row_mask:0xf bank_mask:0xf
s_nop 1
v_max_u32_dpp v139, v139, v139 quad_perm:[2,3,0,1] row_mask:0xf bank_mask:0xf
v_cmp_eq_u32 vcc, 0, v139
s_nop 0
v_add_u32_dpp v138, v139, v139 row_shr:4 row_mask:0xf bank_mask:0xf bound_ctrl:0
s_nop 1
v_add_u32_dpp v138, v138, v138 row_shr:8 row_mask:0xf bank_mask:0xf bound_ctrl:0
s_cbranch_vccnz L_gm_C_next
s_nop 0
v_readlane_b32 s63, v138, 15
v_readlane_b32 s62, v138, 31
s_add_u32 s63, s63, s62
s_sub_u32 s63, s63, s65
s_ashr_i32 s63, s63, 3
s_add_u32 s63, s63, 0x4000
s_add_u32 s63, s63, s88
s_mov_b64 exec, 0x1000000
v_mov_b32 v140, s63
global_store_dword v136, v140, s[56:57]
L_gm_C_next:
s_cmp_ge_u32 s61, 14400
s_cbranch_scc1 L_gm_C_x
s_add_u32 s64, s64, 1
s_cmp_lt_u32 s64, 128
s_cbranch_scc1 L_gm_C
L_gm_C_x:
s_mov_b64 exec, -1
L_C_done:
s_endpgm
L_exit:
s_endpgm
.section .rodata,"a"
.p2align 6
.amdhsa_kernel concat_heads__gqa_block_cached__compressed_kv_cla__decode_kernel
  .amdhsa_next_free_vgpr 256
  .amdhsa_next_free_sgpr 102
  .amdhsa_accum_offset 256
  .amdhsa_group_segment_fixed_size 0
  .amdhsa_kernarg_size 112
  .amdhsa_user_sgpr_count 2
  .amdhsa_user_sgpr_kernarg_segment_ptr 1
  .amdhsa_system_sgpr_workgroup_id_x 1
.end_amdhsa_kernel
```
